```python
import torch

def _softmax(x, axis=-1):
    return torch.softmax(x, dim=axis)
def _gelu(x):
    return torch.nn.functional.gelu(x, approximate="tanh")
def _silu(x):
    return torch.nn.functional.silu(x)
def _sigmoid(x):
    return torch.sigmoid(x)
def _layernorm(x, axis=-1, eps=1e-5):
    m = x.mean(dim=axis, keepdim=True)
    v = x.var(dim=axis, keepdim=True, unbiased=False)
    return (x - m) / torch.sqrt(v + eps)
def _scatter_add(tgt, idx, src, axis=0):
    return tgt.clone().index_add_(axis, idx, src)
def _segment_sum(src, seg, n):
    out = torch.zeros((n,) + src.shape[1:], dtype=src.dtype)
    return out.index_add_(0, seg, src)
def _pad(x, pw):
    flat = tuple(v for pair in reversed(pw) for v in pair)
    return torch.nn.functional.pad(x, flat)

kernel_name = 'concat_heads__compressed_kv_cla__mha_block_cached__decode'

def setup_inputs():

    _w = (lambda a: (lambda t: t.to(torch.bfloat16) if t.is_floating_point() else t)(torch.as_tensor(a)))
    def _A_setup():
        B, H, Sq, Sk, D, M = 4, 32, 1, 4096, 128, 512
        Dc = 4 * D
        return {
            "x": _w((lambda *s: torch.randn(*s, dtype=torch.bfloat16) * 3.2)(B, Sq, M)),
            "c_kv": _w((lambda *s: torch.randn(*s, dtype=torch.bfloat16) * 0.1)(B, Sk, Dc)),
            "w_q": _w((lambda *s: torch.randn(*s, dtype=torch.bfloat16) * 6.4)(M, H, D) * (M ** -0.5)),
            "w_uk": _w((lambda *s: torch.randn(*s, dtype=torch.bfloat16) * 6.4)(Dc, H, D) * (Dc ** -0.5)),
            "w_uv": _w((lambda *s: torch.randn(*s, dtype=torch.bfloat16) * 0.1)(Dc, H, D) * (Dc ** -0.5)),
            "w_o": _w((lambda *s: torch.randn(*s, dtype=torch.bfloat16) * 0.1)(H, D, M) * ((H * D) ** -0.5)),
        }
    _A_in = _A_setup()

    def _B_setup():
        B, Sq, D = 4, 1, 512
        H, Sk, Dh = 32, 4096, 128
        return {
            "x": _w((lambda *s: torch.randn(*s, dtype=torch.bfloat16) * 1.6)(B, Sq, D)),
            "k_cache": _w((lambda *s: torch.randn(*s, dtype=torch.bfloat16) * 1.6)(B, H, Sk, Dh)),
            "v_cache": _w((lambda *s: torch.randn(*s, dtype=torch.bfloat16) * 0.05)(B, H, Sk, Dh)),
            "wq": _w((lambda *s: torch.randn(*s, dtype=torch.bfloat16) * 1.6)(D, H * Dh) * (D ** -0.5)),
            "wo": _w((lambda *s: torch.randn(*s, dtype=torch.bfloat16) * 0.05)(H * Dh, D) * ((H * Dh) ** -0.5)),
        }
    _B_in = _B_setup()

    return {
        "A_x": _A_in["x"],
        "A_c_kv": _A_in["c_kv"],
        "A_w_q": _A_in["w_q"],
        "A_w_uk": _A_in["w_uk"],
        "A_w_uv": _A_in["w_uv"],
        "A_w_o": _A_in["w_o"],
        "B_x": _B_in["x"],
        "B_k_cache": _B_in["k_cache"],
        "B_v_cache": _B_in["v_cache"],
        "B_wq": _B_in["wq"],
        "B_wo": _B_in["wo"],
    }

def reference(A_x, A_c_kv, A_w_q, A_w_uk, A_w_uv, A_w_o, B_x, B_k_cache, B_v_cache, B_wq, B_wo):
    def _A_ref(x, c_kv, w_q, w_uk, w_uv, w_o):
        B, Sq, M = x.shape[0], x.shape[1], x.shape[2]
        Sk = c_kv.shape[1]
        H, D = w_q.shape[1], w_q.shape[2]
        q = torch.einsum("bqm,mhd->bhqd", x, w_q)
        k = torch.einsum("bkc,chd->bhkd", c_kv, w_uk)
        v = torch.einsum("bkc,chd->bhkd", c_kv, w_uv)
        scores = torch.einsum("bhqd,bhkd->bhqk", q, k) * (D ** -0.5)
        off = Sk - Sq
        qi = torch.arange(Sq)[:, None]
        kj = torch.arange(Sk)[None, :]
        cmask = kj <= (qi + off)
        scores = torch.where(cmask[None, None], scores, -1e9)
        p = _softmax(scores, axis=-1)
        ctx = torch.einsum("bhqk,bhkd->bhqd", p, v)
        return torch.einsum("bhqd,hdm->bqm", ctx, w_o)

    def _B_ref(x, k_cache, v_cache, wq, wo):
        B, Sq, D = x.shape
        H, Dh = 32, 128
        q = (lambda x, *d: x.permute(*d))((x @ wq).reshape(B, Sq, H, Dh), 0, 2, 1, 3)
        scores = torch.einsum("bhqd,bhkd->bhqk", q, k_cache) * (Dh ** -0.5)
        p = _softmax(scores, axis=-1)
        o = torch.einsum("bhqk,bhkd->bhqd", p, v_cache)
        return (lambda x, *d: x.permute(*d))(o, 0, 2, 1, 3).reshape(B, Sq, H * Dh) @ wo

    a = _A_ref(A_x, A_c_kv, A_w_q, A_w_uk, A_w_uv, A_w_o)
    b = _B_ref(B_x, B_k_cache, B_v_cache, B_wq, B_wo)
    return torch.concatenate([a, b], axis=-1)
```

```asm
; @launch grid=(256,1,1) block=(256,1,1) lds=163840
    .amdgcn_target "amdgcn-amd-amdhsa--gfx950"
    .text
    .globl concat_heads__compressed_kv_cla__mha_block_cached__decode_kernel
    .p2align 8
    .type concat_heads__compressed_kv_cla__mha_block_cached__decode_kernel,@function
concat_heads__compressed_kv_cla__mha_block_cached__decode_kernel:
    s_cmp_ge_u32 s2, 256
    s_cbranch_scc1 L_end
    s_load_dwordx16 s[4:19], s[0:1], 0
    s_load_dwordx8 s[20:27], s[0:1], 64
    s_load_dwordx4 s[28:31], s[0:1], 96
    v_lshrrev_b32 v4, 6, v0
    v_and_b32 v1, 63, v0
    v_readfirstlane_b32 s34, v4
    s_lshr_b32 s32, s2, 3
    s_sub_u32 s33, s2, s32
    s_sub_u32 s33, s33, 1
    s_and_b32 s33, s33, 7
    v_lshrrev_b32 v2, 4, v1
    v_and_b32 v3, 15, v1
    v_lshlrev_b32 v4, 16, v2
    v_lshl_add_u32 v14, v3, 4, v4
    v_lshrrev_b32 v5, 3, v3
    v_lshlrev_b32 v5, 10, v5
    v_lshl_add_u32 v15, v2, 4, v5
    s_and_b32 s36, s33, 3
    s_lshl_b32 s36, s36, 2
    s_add_u32 s36, s36, s34
    s_lshl_b32 s37, s36, 6
    s_lshl_b32 s36, s36, 18
    s_lshl_b32 s38, s32, 8
    s_add_u32 s36, s36, s38
    s_mov_b32 s42, 4194304
    s_mov_b32 s43, 0x20000
    s_mov_b32 s46, 4096
    s_mov_b32 s47, 0x20000
    s_cmp_ge_u32 s33, 4
    s_waitcnt lgkmcnt(0)
    s_cselect_b64 s[40:41], s[8:9], s[22:23]
    s_cselect_b64 s[44:45], s[4:5], s[16:17]
    s_load_dword s35, s[30:31], 0
    buffer_load_dwordx4 v[20:23], v15, s[44:47], s37 offen offset:0
    buffer_load_dwordx4 v[24:27], v15, s[44:47], s37 offen offset:2048
    buffer_load_dwordx4 v[44:47], v14, s[40:43], s36 offen nt
    s_add_u32 s36, s36, 8192
    buffer_load_dwordx4 v[48:51], v14, s[40:43], s36 offen nt
    s_add_u32 s36, s36, 8192
    buffer_load_dwordx4 v[52:55], v14, s[40:43], s36 offen nt
    s_add_u32 s36, s36, 8192
    buffer_load_dwordx4 v[56:59], v14, s[40:43], s36 offen nt
    s_add_u32 s36, s36, 8192
    buffer_load_dwordx4 v[60:63], v14, s[40:43], s36 offen nt
    s_add_u32 s36, s36, 8192
    buffer_load_dwordx4 v[64:67], v14, s[40:43], s36 offen nt
    s_add_u32 s36, s36, 8192
    buffer_load_dwordx4 v[68:71], v14, s[40:43], s36 offen nt
    s_add_u32 s36, s36, 8192
    buffer_load_dwordx4 v[72:75], v14, s[40:43], s36 offen nt
    s_mov_b32 s48, s30
    s_and_b32 s49, s31, 0xffff
    s_mov_b32 s50, 8388608
    s_mov_b32 s51, 0x20000
    s_mov_b32 s80, 0x01000100
    s_mov_b32 s81, 0x03020302
    s_mov_b32 s82, 0xffffff00
    s_mov_b32 s83, 0x3e0293ee
    s_mov_b32 s84, 1048576
    v_and_b32 v4, 1, v1
    v_lshlrev_b32 v4, 4, v4
    v_mov_b32 v5, 0xffff
    v_lshlrev_b32 v4, v4, v5
    v_bfe_u32 v5, v1, 1, 2
    v_cmp_eq_u32 vcc, 0, v5
    s_nop 1
    v_cndmask_b32 v10, 0, v4, vcc
    v_cmp_eq_u32 vcc, 1, v5
    s_nop 1
    v_cndmask_b32 v11, 0, v4, vcc
    v_cmp_eq_u32 vcc, 2, v5
    s_nop 1
    v_cndmask_b32 v12, 0, v4, vcc
    v_cmp_eq_u32 vcc, 3, v5
    s_nop 1
    v_cndmask_b32 v13, 0, v4, vcc
    s_cmp_eq_u32 s33, 7
    s_cbranch_scc1 L_aux
    s_mov_b32 s52, s18
    s_and_b32 s53, s19, 0xffff
    s_mov_b32 s54, 134217728
    s_mov_b32 s55, 0x20000
    s_mov_b32 s56, s20
    s_and_b32 s57, s21, 0xffff
    s_mov_b32 s58, 134217728
    s_mov_b32 s59, 0x20000
    v_lshrrev_b32 v4, 2, v3
    v_and_b32 v5, 3, v3
    v_lshlrev_b32 v76, 8, v4
    v_lshl_add_u32 v76, v2, 6, v76
    v_lshl_add_u32 v76, v5, 4, v76
    v_lshlrev_b32 v77, 8, v2
    v_lshl_add_u32 v77, v3, 4, v77
    v_lshlrev_b32 v78, 11, v4
    v_lshl_add_u32 v78, v2, 7, v78
    v_lshl_add_u32 v78, v5, 5, v78
    s_lshl_b32 s89, s34, 5
    s_add_u32 s89, s89, s32
    s_lshl_b32 s89, s89, 20
    s_mul_i32 s88, s32, 8
    s_mul_i32 s38, s34, 1
    s_add_u32 s88, s88, s38
    s_mov_b32 s87, s33
    s_waitcnt vmcnt(7)
    v_perm_b32 v4, v20, v20, s80
    v_perm_b32 v5, v24, v24, s80
    v_and_b32 v28, v4, v10
    v_and_b32 v29, v4, v11
    v_and_b32 v30, v4, v12
    v_and_b32 v31, v4, v13
    v_and_b32 v32, v5, v10
    v_and_b32 v33, v5, v11
    v_and_b32 v34, v5, v12
    v_and_b32 v35, v5, v13
    v_mfma_f32_16x16x32_bf16 v[36:39], v[44:47], v[28:31], 0
    s_nop 0
    v_mfma_f32_16x16x32_bf16 v[40:43], v[44:47], v[32:35], 0
    s_waitcnt vmcnt(6)
    v_perm_b32 v4, v20, v20, s81
    v_perm_b32 v5, v24, v24, s81
    v_and_b32 v28, v4, v10
    v_and_b32 v29, v4, v11
    v_and_b32 v30, v4, v12
    v_and_b32 v31, v4, v13
    v_and_b32 v32, v5, v10
    v_and_b32 v33, v5, v11
    v_and_b32 v34, v5, v12
    v_and_b32 v35, v5, v13
    v_mfma_f32_16x16x32_bf16 v[36:39], v[48:51], v[28:31], v[36:39]
    s_nop 0
    v_mfma_f32_16x16x32_bf16 v[40:43], v[48:51], v[32:35], v[40:43]
    s_waitcnt vmcnt(5)
    v_perm_b32 v4, v21, v21, s80
    v_perm_b32 v5, v25, v25, s80
    v_and_b32 v28, v4, v10
    v_and_b32 v29, v4, v11
    v_and_b32 v30, v4, v12
    v_and_b32 v31, v4, v13
    v_and_b32 v32, v5, v10
    v_and_b32 v33, v5, v11
    v_and_b32 v34, v5, v12
    v_and_b32 v35, v5, v13
    v_mfma_f32_16x16x32_bf16 v[36:39], v[52:55], v[28:31], v[36:39]
    s_nop 0
    v_mfma_f32_16x16x32_bf16 v[40:43], v[52:55], v[32:35], v[40:43]
    s_waitcnt vmcnt(4)
    s_add_u32 s39, s87, s88
    s_and_b32 s39, s39, 255
    s_lshl_b32 s39, s39, 12
    s_add_u32 s85, s39, s89
    buffer_load_dwordx4 v[128:131], v76, s[52:55], s85 offen offset:0 nt
    v_perm_b32 v4, v21, v21, s81
    v_perm_b32 v5, v25, v25, s81
    v_and_b32 v28, v4, v10
    v_and_b32 v29, v4, v11
    v_and_b32 v30, v4, v12
    v_and_b32 v31, v4, v13
    v_and_b32 v32, v5, v10
    v_and_b32 v33, v5, v11
    v_and_b32 v34, v5, v12
    v_and_b32 v35, v5, v13
    v_mfma_f32_16x16x32_bf16 v[36:39], v[56:59], v[28:31], v[36:39]
    s_nop 0
    v_mfma_f32_16x16x32_bf16 v[40:43], v[56:59], v[32:35], v[40:43]
    s_waitcnt vmcnt(4)
    buffer_load_dwordx4 v[132:135], v76, s[52:55], s85 offen offset:1024 nt
    v_perm_b32 v4, v22, v22, s80
    v_perm_b32 v5, v26, v26, s80
    v_and_b32 v28, v4, v10
    v_and_b32 v29, v4, v11
    v_and_b32 v30, v4, v12
    v_and_b32 v31, v4, v13
    v_and_b32 v32, v5, v10
    v_and_b32 v33, v5, v11
    v_and_b32 v34, v5, v12
    v_and_b32 v35, v5, v13
    v_mfma_f32_16x16x32_bf16 v[36:39], v[60:63], v[28:31], v[36:39]
    s_nop 0
    v_mfma_f32_16x16x32_bf16 v[40:43], v[60:63], v[32:35], v[40:43]
    s_waitcnt vmcnt(4)
    buffer_load_dwordx4 v[136:139], v76, s[52:55], s85 offen offset:2048 nt
    v_perm_b32 v4, v22, v22, s81
    v_perm_b32 v5, v26, v26, s81
    v_and_b32 v28, v4, v10
    v_and_b32 v29, v4, v11
    v_and_b32 v30, v4, v12
    v_and_b32 v31, v4, v13
    v_and_b32 v32, v5, v10
    v_and_b32 v33, v5, v11
    v_and_b32 v34, v5, v12
    v_and_b32 v35, v5, v13
    v_mfma_f32_16x16x32_bf16 v[36:39], v[64:67], v[28:31], v[36:39]
    s_nop 0
    v_mfma_f32_16x16x32_bf16 v[40:43], v[64:67], v[32:35], v[40:43]
    s_waitcnt vmcnt(4)
    buffer_load_dwordx4 v[140:143], v76, s[52:55], s85 offen offset:3072 nt
    v_perm_b32 v4, v23, v23, s80
    v_perm_b32 v5, v27, v27, s80
    v_and_b32 v28, v4, v10
    v_and_b32 v29, v4, v11
    v_and_b32 v30, v4, v12
    v_and_b32 v31, v4, v13
    v_and_b32 v32, v5, v10
    v_and_b32 v33, v5, v11
    v_and_b32 v34, v5, v12
    v_and_b32 v35, v5, v13
    v_mfma_f32_16x16x32_bf16 v[36:39], v[68:71], v[28:31], v[36:39]
    s_nop 0
    v_mfma_f32_16x16x32_bf16 v[40:43], v[68:71], v[32:35], v[40:43]
    s_waitcnt vmcnt(4)
    buffer_load_dwordx4 v[144:147], v77, s[56:59], s85 offen offset:0 nt
    v_perm_b32 v4, v23, v23, s81
    v_perm_b32 v5, v27, v27, s81
    v_and_b32 v28, v4, v10
    v_and_b32 v29, v4, v11
    v_and_b32 v30, v4, v12
    v_and_b32 v31, v4, v13
    v_and_b32 v32, v5, v10
    v_and_b32 v33, v5, v11
    v_and_b32 v34, v5, v12
    v_and_b32 v35, v5, v13
    v_mfma_f32_16x16x32_bf16 v[36:39], v[72:75], v[28:31], v[36:39]
    s_nop 0
    v_mfma_f32_16x16x32_bf16 v[40:43], v[72:75], v[32:35], v[40:43]
    s_lshl_b32 s38, s34, 11
    s_add_u32 s38, s38, 131072
    v_lshrrev_b32 v4, 3, v3
    v_lshlrev_b32 v4, 9, v4
    v_lshl_add_u32 v4, v2, 7, v4
    v_and_b32 v5, 7, v3
    v_lshl_add_u32 v4, v5, 2, v4
    v_add_u32 v4, s38, v4
    s_lshl_b32 s38, s34, 9
    v_and_b32 v5, 31, v1
    v_lshl_add_u32 v5, v5, 4, s38
    v_add_u32 v6, 131072, v5
    ds_write_b32 v4, v36 offset:0
    ds_write_b32 v4, v37 offset:32
    ds_write_b32 v4, v38 offset:64
    ds_write_b32 v4, v39 offset:96
    ds_write_b32 v4, v40 offset:1024
    ds_write_b32 v4, v41 offset:1056
    ds_write_b32 v4, v42 offset:1088
    ds_write_b32 v4, v43 offset:1120
    s_waitcnt lgkmcnt(0)
    s_barrier
    ds_read_b128 v[44:47], v6 offset:0
    ds_read_b128 v[48:51], v6 offset:2048
    ds_read_b128 v[52:55], v6 offset:4096
    ds_read_b128 v[56:59], v6 offset:6144
    s_add_u32 s35, s35, 0x5b
    s_and_b32 s35, s35, 0xff
    v_mov_b32 v8, s35
    s_lshl_b32 s38, s32, 3
    s_add_u32 s38, s38, s33
    s_lshl_b32 s38, s38, 11
    s_add_u32 s38, s38, 1048576
    s_waitcnt lgkmcnt(0)
    v_add_f32 v44, v44, v48
    v_add_f32 v52, v52, v56
    v_add_f32 v45, v45, v49
    v_add_f32 v53, v53, v57
    v_add_f32 v46, v46, v50
    v_add_f32 v54, v54, v58
    v_add_f32 v47, v47, v51
    v_add_f32 v55, v55, v59
    v_add_f32 v44, v44, v52
    v_add_f32 v45, v45, v53
    v_add_f32 v46, v46, v54
    v_add_f32 v47, v47, v55
    v_and_or_b32 v44, v44, s82, v8
    v_and_or_b32 v45, v45, s82, v8
    v_and_or_b32 v46, v46, s82, v8
    v_and_or_b32 v47, v47, s82, v8
    s_mov_b32 exec_lo, 0xffffffff
    s_mov_b32 exec_hi, 0x0
    buffer_store_dwordx4 v[44:47], v5, s[48:51], s38 offen sc1
    s_mov_b64 exec, -1
    s_lshl_b32 s86, s32, 14
    s_lshl_b32 s38, s34, 9
    s_add_u32 s86, s86, s38
    s_add_u32 s86, s86, 1048576
    v_mov_b32 v120, 0xff7f0000
    v_mov_b32 v121, 0
    v_mov_b32 v116, 0
    v_mov_b32 v117, 0
    v_mov_b32 v118, 0
    v_mov_b32 v119, 0
    v_lshlrev_b32 v4, 7, v2
    v_lshl_add_u32 v4, v3, 4, v4
    v_mov_b32 v5, 512
    v_cmp_gt_u32 vcc, 8, v3
    s_nop 1
    v_cndmask_b32 v79, v5, v4, vcc
    s_waitcnt vmcnt(5)
    buffer_load_dwordx4 v[148:151], v77, s[56:59], s85 offen offset:1024 nt
    s_waitcnt vmcnt(5)
    buffer_load_dwordx4 v[152:155], v77, s[56:59], s85 offen offset:2048 nt
    s_waitcnt vmcnt(5)
    buffer_load_dwordx4 v[156:159], v77, s[56:59], s85 offen offset:3072 nt
    s_waitcnt vmcnt(5)
    s_add_u32 s87, s87, 7
    s_add_u32 s39, s87, s88
    s_and_b32 s39, s39, 255
    s_lshl_b32 s39, s39, 12
    s_add_u32 s85, s39, s89
    buffer_load_dwordx4 v[160:163], v76, s[52:55], s85 offen offset:0 nt
    s_waitcnt vmcnt(5)
    buffer_load_dwordx4 v[164:167], v76, s[52:55], s85 offen offset:1024 nt
    s_waitcnt vmcnt(4)
    buffer_load_dwordx4 v[168:171], v76, s[52:55], s85 offen offset:2048 nt
    s_waitcnt vmcnt(4)
    buffer_load_dwordx4 v[172:175], v76, s[52:55], s85 offen offset:3072 nt
    s_waitcnt vmcnt(4)
    buffer_load_dwordx4 v[176:179], v77, s[56:59], s85 offen offset:0 nt
    s_waitcnt vmcnt(4)
    buffer_load_dwordx4 v[180:183], v77, s[56:59], s85 offen offset:1024 nt
    s_waitcnt vmcnt(4)
    buffer_load_dwordx4 v[184:187], v77, s[56:59], s85 offen offset:2048 nt
    s_waitcnt vmcnt(4)
    buffer_load_dwordx4 v[188:191], v77, s[56:59], s85 offen offset:3072 nt
    s_waitcnt vmcnt(4)
    s_add_u32 s87, s87, 7
    s_add_u32 s39, s87, s88
    s_and_b32 s39, s39, 255
    s_lshl_b32 s39, s39, 12
    s_add_u32 s85, s39, s89
    buffer_load_dwordx4 v[192:195], v76, s[52:55], s85 offen offset:0 nt
    s_waitcnt vmcnt(4)
    buffer_load_dwordx4 v[196:199], v76, s[52:55], s85 offen offset:1024 nt
    s_waitcnt vmcnt(4)
    buffer_load_dwordx4 v[200:203], v76, s[52:55], s85 offen offset:2048 nt
    s_waitcnt vmcnt(4)
    buffer_load_dwordx4 v[204:207], v76, s[52:55], s85 offen offset:3072 nt
    s_waitcnt vmcnt(4)
    buffer_load_dwordx4 v[208:211], v77, s[56:59], s85 offen offset:0 nt
    s_waitcnt vmcnt(4)
    buffer_load_dwordx4 v[212:215], v77, s[56:59], s85 offen offset:1024 nt
    s_waitcnt vmcnt(4)
    buffer_load_dwordx4 v[44:47], v78, s[48:51], s86 offen offset:0 sc1
    buffer_load_dwordx4 v[48:51], v78, s[48:51], s86 offen offset:16 sc1
    buffer_load_dwordx4 v[216:219], v77, s[56:59], s85 offen offset:2048 nt
    s_waitcnt vmcnt(6)
    buffer_load_dwordx4 v[220:223], v77, s[56:59], s85 offen offset:3072 nt
    s_waitcnt vmcnt(6)
    s_add_u32 s87, s87, 7
    s_add_u32 s39, s87, s88
    s_and_b32 s39, s39, 255
    s_lshl_b32 s39, s39, 12
    s_add_u32 s85, s39, s89
    buffer_load_dwordx4 v[224:227], v76, s[52:55], s85 offen offset:0 nt
    s_waitcnt vmcnt(6)
    buffer_load_dwordx4 v[228:231], v76, s[52:55], s85 offen offset:1024 nt
    s_waitcnt vmcnt(6)
    buffer_load_dwordx4 v[232:235], v76, s[52:55], s85 offen offset:2048 nt
    s_waitcnt vmcnt(4)
    buffer_load_dwordx4 v[236:239], v76, s[52:55], s85 offen offset:3072 nt
    s_waitcnt vmcnt(4)
    buffer_load_dwordx4 v[240:243], v77, s[56:59], s85 offen offset:0 nt
    s_waitcnt vmcnt(4)
    buffer_load_dwordx4 v[244:247], v77, s[56:59], s85 offen offset:1024 nt
    s_waitcnt vmcnt(4)
    buffer_load_dwordx4 v[248:251], v77, s[56:59], s85 offen offset:2048 nt
    s_waitcnt vmcnt(4)
    buffer_load_dwordx4 v[252:255], v77, s[56:59], s85 offen offset:3072 nt
L_qcheck_1:
    v_xor_b32 v44, s35, v44
    v_xor_b32 v45, s35, v45
    v_xor_b32 v46, s35, v46
    v_xor_b32 v47, s35, v47
    v_xor_b32 v48, s35, v48
    v_xor_b32 v49, s35, v49
    v_xor_b32 v50, s35, v50
    v_xor_b32 v51, s35, v51
    v_or_b32 v4, v44, v45
    v_or3_b32 v4, v4, v46, v47
    v_or3_b32 v4, v4, v48, v49
    v_or3_b32 v4, v4, v50, v51
    v_and_b32 v4, 0xff, v4
    v_cmp_ne_u32 vcc, 0, v4
    s_cbranch_vccz L_qok_2
    buffer_load_dwordx4 v[44:47], v78, s[48:51], s86 offen offset:0 sc1
    buffer_load_dwordx4 v[48:51], v78, s[48:51], s86 offen offset:16 sc1
    s_waitcnt vmcnt(0)
    s_sub_u32 s84, s84, 1
    s_cmp_lg_u32 s84, 0
    s_cbranch_scc1 L_qcheck_1
    s_branch L_end
L_qok_2:
    v_add_f32_dpp v44, v44, v44 row_ror:8 row_mask:0xf bank_mask:0xf
    v_add_f32_dpp v45, v45, v45 row_ror:8 row_mask:0xf bank_mask:0xf
    v_add_f32_dpp v46, v46, v46 row_ror:8 row_mask:0xf bank_mask:0xf
    v_add_f32_dpp v47, v47, v47 row_ror:8 row_mask:0xf bank_mask:0xf
    v_add_f32_dpp v48, v48, v48 row_ror:8 row_mask:0xf bank_mask:0xf
    v_add_f32_dpp v49, v49, v49 row_ror:8 row_mask:0xf bank_mask:0xf
    v_add_f32_dpp v50, v50, v50 row_ror:8 row_mask:0xf bank_mask:0xf
    v_add_f32_dpp v51, v51, v51 row_ror:8 row_mask:0xf bank_mask:0xf
    v_add_f32_dpp v44, v44, v44 row_ror:4 row_mask:0xf bank_mask:0xf
    v_add_f32_dpp v45, v45, v45 row_ror:4 row_mask:0xf bank_mask:0xf
    v_add_f32_dpp v46, v46, v46 row_ror:4 row_mask:0xf bank_mask:0xf
    v_add_f32_dpp v47, v47, v47 row_ror:4 row_mask:0xf bank_mask:0xf
    v_add_f32_dpp v48, v48, v48 row_ror:4 row_mask:0xf bank_mask:0xf
    v_add_f32_dpp v49, v49, v49 row_ror:4 row_mask:0xf bank_mask:0xf
    v_add_f32_dpp v50, v50, v50 row_ror:4 row_mask:0xf bank_mask:0xf
    v_add_f32_dpp v51, v51, v51 row_ror:4 row_mask:0xf bank_mask:0xf
    v_cvt_pk_bf16_f32 v44, v44, v45
    v_cvt_pk_bf16_f32 v45, v46, v47
    v_cvt_pk_bf16_f32 v46, v48, v49
    v_cvt_pk_bf16_f32 v47, v50, v51
    s_mov_b32 vcc_lo, 0xf000f
    s_mov_b32 vcc_hi, 0xf000f
    v_cndmask_b32 v80, 0, v44, vcc
    v_cndmask_b32 v81, 0, v45, vcc
    v_cndmask_b32 v82, 0, v46, vcc
    v_cndmask_b32 v83, 0, v47, vcc
    s_mov_b32 vcc_lo, 0xf000f0
    s_mov_b32 vcc_hi, 0xf000f0
    v_cndmask_b32 v84, 0, v44, vcc
    v_cndmask_b32 v85, 0, v45, vcc
    v_cndmask_b32 v86, 0, v46, vcc
    v_cndmask_b32 v87, 0, v47, vcc
    s_mov_b32 vcc_lo, 0xf000f00
    s_mov_b32 vcc_hi, 0xf000f00
    v_cndmask_b32 v88, 0, v44, vcc
    v_cndmask_b32 v89, 0, v45, vcc
    v_cndmask_b32 v90, 0, v46, vcc
    v_cndmask_b32 v91, 0, v47, vcc
    s_mov_b32 vcc_lo, 0xf000f000
    s_mov_b32 vcc_hi, 0xf000f000
    v_cndmask_b32 v92, 0, v44, vcc
    v_cndmask_b32 v93, 0, v45, vcc
    v_cndmask_b32 v94, 0, v46, vcc
    v_cndmask_b32 v95, 0, v47, vcc
    s_add_u32 s87, s87, 7
    s_add_u32 s39, s87, s88
    s_and_b32 s39, s39, 255
    s_lshl_b32 s39, s39, 12
    s_add_u32 s85, s39, s89
    v_mfma_f32_16x16x32_bf16 v[112:115], v[128:131], v[80:83], 0
    buffer_load_dwordx4 v[128:131], v76, s[52:55], s85 offen offset:0 nt
    v_mfma_f32_16x16x32_bf16 v[112:115], v[132:135], v[84:87], v[112:115]
    buffer_load_dwordx4 v[132:135], v76, s[52:55], s85 offen offset:1024 nt
    v_mfma_f32_16x16x32_bf16 v[112:115], v[136:139], v[88:91], v[112:115]
    buffer_load_dwordx4 v[136:139], v76, s[52:55], s85 offen offset:2048 nt
    v_mfma_f32_16x16x32_bf16 v[112:115], v[140:143], v[92:95], v[112:115]
    s_nop 7
    v_mov_b32_dpp v122, v112 quad_perm:[0,0,0,0] row_mask:0xf bank_mask:0xf
    v_mov_b32_dpp v124, v114 quad_perm:[2,2,2,2] row_mask:0xf bank_mask:0xf
    s_nop 0
    v_add_f32_dpp v122, v113, v122 quad_perm:[1,1,1,1] row_mask:0xf bank_mask:0xf
    v_add_f32_dpp v124, v115, v124 quad_perm:[3,3,3,3] row_mask:0xf bank_mask:0xf
    v_add_f32 v122, v122, v124
    v_fma_f32 v123, v122, s83, -v120
    v_cmp_lt_f32 vcc, 0, v123
    s_cbranch_vccz L_nomax_3
    v_mul_f32 v122, s83, v122
    s_nop 1
    v_max_f32_dpp v124, v122, v122 row_ror:4 row_mask:0xf bank_mask:0xf
    s_nop 1
    v_max_f32_dpp v124, v124, v124 row_ror:8 row_mask:0xf bank_mask:0xf
    v_mov_b32 v125, v124
    s_nop 1
    v_permlane16_swap_b32 v124, v125
    v_max_f32 v124, v124, v125
    v_mov_b32 v125, v124
    s_nop 1
    v_permlane32_swap_b32 v124, v125
    v_max_f32 v124, v124, v125
    v_and_b32 v124, s82, v124
    v_max_f32 v124, v124, v120
    v_sub_f32 v125, v120, v124
    v_exp_f32 v125, v125
    v_mov_b32 v120, v124
    v_sub_f32 v123, v122, v124
    v_mul_f32 v121, v121, v125
    v_mul_f32 v116, v116, v125
    v_mul_f32 v117, v117, v125
    v_mul_f32 v118, v118, v125
    v_mul_f32 v119, v119, v125
L_nomax_3:
    v_exp_f32 v123, v123
    s_nop 0
    v_cvt_pk_bf16_f32 v124, v123, v123
    v_add_f32 v121, v121, v123
    s_nop 0
    v_and_b32_dpp v96, v124, v10 row_newbcast:0 row_mask:0xf bank_mask:0xf
    v_and_b32_dpp v97, v124, v11 row_newbcast:0 row_mask:0xf bank_mask:0xf
    v_and_b32_dpp v98, v124, v12 row_newbcast:0 row_mask:0xf bank_mask:0xf
    v_and_b32_dpp v99, v124, v13 row_newbcast:0 row_mask:0xf bank_mask:0xf
    v_and_b32_dpp v100, v124, v10 row_newbcast:4 row_mask:0xf bank_mask:0xf
    v_and_b32_dpp v101, v124, v11 row_newbcast:4 row_mask:0xf bank_mask:0xf
    v_and_b32_dpp v102, v124, v12 row_newbcast:4 row_mask:0xf bank_mask:0xf
    v_and_b32_dpp v103, v124, v13 row_newbcast:4 row_mask:0xf bank_mask:0xf
    v_and_b32_dpp v104, v124, v10 row_newbcast:8 row_mask:0xf bank_mask:0xf
    v_and_b32_dpp v105, v124, v11 row_newbcast:8 row_mask:0xf bank_mask:0xf
    v_and_b32_dpp v106, v124, v12 row_newbcast:8 row_mask:0xf bank_mask:0xf
    v_and_b32_dpp v107, v124, v13 row_newbcast:8 row_mask:0xf bank_mask:0xf
    v_and_b32_dpp v108, v124, v10 row_newbcast:12 row_mask:0xf bank_mask:0xf
    v_and_b32_dpp v109, v124, v11 row_newbcast:12 row_mask:0xf bank_mask:0xf
    v_and_b32_dpp v110, v124, v12 row_newbcast:12 row_mask:0xf bank_mask:0xf
    v_and_b32_dpp v111, v124, v13 row_newbcast:12 row_mask:0xf bank_mask:0xf
    buffer_load_dwordx4 v[140:143], v76, s[52:55], s85 offen offset:3072 nt
    v_mfma_f32_16x16x32_bf16 v[116:119], v[144:147], v[96:99], v[116:119]
    buffer_load_dwordx4 v[144:147], v77, s[56:59], s85 offen offset:0 nt
    v_mfma_f32_16x16x32_bf16 v[116:119], v[148:151], v[100:103], v[116:119]
    v_mfma_f32_16x16x32_bf16 v[116:119], v[152:155], v[104:107], v[116:119]
    v_mfma_f32_16x16x32_bf16 v[116:119], v[156:159], v[108:111], v[116:119]
    v_mfma_f32_16x16x32_bf16 v[112:115], v[160:163], v[80:83], 0
    v_mfma_f32_16x16x32_bf16 v[112:115], v[164:167], v[84:87], v[112:115]
    v_mfma_f32_16x16x32_bf16 v[112:115], v[168:171], v[88:91], v[112:115]
    v_mfma_f32_16x16x32_bf16 v[112:115], v[172:175], v[92:95], v[112:115]
    s_nop 7
    v_mov_b32_dpp v122, v112 quad_perm:[0,0,0,0] row_mask:0xf bank_mask:0xf
    v_mov_b32_dpp v124, v114 quad_perm:[2,2,2,2] row_mask:0xf bank_mask:0xf
    s_nop 0
    v_add_f32_dpp v122, v113, v122 quad_perm:[1,1,1,1] row_mask:0xf bank_mask:0xf
    v_add_f32_dpp v124, v115, v124 quad_perm:[3,3,3,3] row_mask:0xf bank_mask:0xf
    v_add_f32 v122, v122, v124
    v_fma_f32 v123, v122, s83, -v120
    v_cmp_lt_f32 vcc, 0, v123
    s_cbranch_vccz L_nomax_4
    v_mul_f32 v122, s83, v122
    s_nop 1
    v_max_f32_dpp v124, v122, v122 row_ror:4 row_mask:0xf bank_mask:0xf
    s_nop 1
    v_max_f32_dpp v124, v124, v124 row_ror:8 row_mask:0xf bank_mask:0xf
    v_mov_b32 v125, v124
    s_nop 1
    v_permlane16_swap_b32 v124, v125
    v_max_f32 v124, v124, v125
    v_mov_b32 v125, v124
    s_nop 1
    v_permlane32_swap_b32 v124, v125
    v_max_f32 v124, v124, v125
    v_and_b32 v124, s82, v124
    v_max_f32 v124, v124, v120
    v_sub_f32 v125, v120, v124
    v_exp_f32 v125, v125
    v_mov_b32 v120, v124
    v_sub_f32 v123, v122, v124
    v_mul_f32 v121, v121, v125
    v_mul_f32 v116, v116, v125
    v_mul_f32 v117, v117, v125
    v_mul_f32 v118, v118, v125
    v_mul_f32 v119, v119, v125
L_nomax_4:
    v_exp_f32 v123, v123
    s_nop 0
    v_cvt_pk_bf16_f32 v124, v123, v123
    v_add_f32 v121, v121, v123
    s_nop 0
    v_and_b32_dpp v96, v124, v10 row_newbcast:0 row_mask:0xf bank_mask:0xf
    v_and_b32_dpp v97, v124, v11 row_newbcast:0 row_mask:0xf bank_mask:0xf
    v_and_b32_dpp v98, v124, v12 row_newbcast:0 row_mask:0xf bank_mask:0xf
    v_and_b32_dpp v99, v124, v13 row_newbcast:0 row_mask:0xf bank_mask:0xf
    v_and_b32_dpp v100, v124, v10 row_newbcast:4 row_mask:0xf bank_mask:0xf
    v_and_b32_dpp v101, v124, v11 row_newbcast:4 row_mask:0xf bank_mask:0xf
    v_and_b32_dpp v102, v124, v12 row_newbcast:4 row_mask:0xf bank_mask:0xf
    v_and_b32_dpp v103, v124, v13 row_newbcast:4 row_mask:0xf bank_mask:0xf
    v_and_b32_dpp v104, v124, v10 row_newbcast:8 row_mask:0xf bank_mask:0xf
    v_and_b32_dpp v105, v124, v11 row_newbcast:8 row_mask:0xf bank_mask:0xf
    v_and_b32_dpp v106, v124, v12 row_newbcast:8 row_mask:0xf bank_mask:0xf
    v_and_b32_dpp v107, v124, v13 row_newbcast:8 row_mask:0xf bank_mask:0xf
    v_and_b32_dpp v108, v124, v10 row_newbcast:12 row_mask:0xf bank_mask:0xf
    v_and_b32_dpp v109, v124, v11 row_newbcast:12 row_mask:0xf bank_mask:0xf
    v_and_b32_dpp v110, v124, v12 row_newbcast:12 row_mask:0xf bank_mask:0xf
    v_and_b32_dpp v111, v124, v13 row_newbcast:12 row_mask:0xf bank_mask:0xf
    v_mfma_f32_16x16x32_bf16 v[116:119], v[176:179], v[96:99], v[116:119]
    v_mfma_f32_16x16x32_bf16 v[116:119], v[180:183], v[100:103], v[116:119]
    v_mfma_f32_16x16x32_bf16 v[116:119], v[184:187], v[104:107], v[116:119]
    v_mfma_f32_16x16x32_bf16 v[116:119], v[188:191], v[108:111], v[116:119]
    v_mfma_f32_16x16x32_bf16 v[112:115], v[192:195], v[80:83], 0
    v_mfma_f32_16x16x32_bf16 v[112:115], v[196:199], v[84:87], v[112:115]
    v_mfma_f32_16x16x32_bf16 v[112:115], v[200:203], v[88:91], v[112:115]
    v_mfma_f32_16x16x32_bf16 v[112:115], v[204:207], v[92:95], v[112:115]
    s_nop 7
    v_mov_b32_dpp v122, v112 quad_perm:[0,0,0,0] row_mask:0xf bank_mask:0xf
    v_mov_b32_dpp v124, v114 quad_perm:[2,2,2,2] row_mask:0xf bank_mask:0xf
    s_nop 0
    v_add_f32_dpp v122, v113, v122 quad_perm:[1,1,1,1] row_mask:0xf bank_mask:0xf
    v_add_f32_dpp v124, v115, v124 quad_perm:[3,3,3,3] row_mask:0xf bank_mask:0xf
    v_add_f32 v122, v122, v124
    v_fma_f32 v123, v122, s83, -v120
    v_cmp_lt_f32 vcc, 0, v123
    s_cbranch_vccz L_nomax_5
    v_mul_f32 v122, s83, v122
    s_nop 1
    v_max_f32_dpp v124, v122, v122 row_ror:4 row_mask:0xf bank_mask:0xf
    s_nop 1
    v_max_f32_dpp v124, v124, v124 row_ror:8 row_mask:0xf bank_mask:0xf
    v_mov_b32 v125, v124
    s_nop 1
    v_permlane16_swap_b32 v124, v125
    v_max_f32 v124, v124, v125
    v_mov_b32 v125, v124
    s_nop 1
    v_permlane32_swap_b32 v124, v125
    v_max_f32 v124, v124, v125
    v_and_b32 v124, s82, v124
    v_max_f32 v124, v124, v120
    v_sub_f32 v125, v120, v124
    v_exp_f32 v125, v125
    v_mov_b32 v120, v124
    v_sub_f32 v123, v122, v124
    v_mul_f32 v121, v121, v125
    v_mul_f32 v116, v116, v125
    v_mul_f32 v117, v117, v125
    v_mul_f32 v118, v118, v125
    v_mul_f32 v119, v119, v125
L_nomax_5:
    v_exp_f32 v123, v123
    s_nop 0
    v_cvt_pk_bf16_f32 v124, v123, v123
    v_add_f32 v121, v121, v123
    s_nop 0
    v_and_b32_dpp v96, v124, v10 row_newbcast:0 row_mask:0xf bank_mask:0xf
    v_and_b32_dpp v97, v124, v11 row_newbcast:0 row_mask:0xf bank_mask:0xf
    v_and_b32_dpp v98, v124, v12 row_newbcast:0 row_mask:0xf bank_mask:0xf
    v_and_b32_dpp v99, v124, v13 row_newbcast:0 row_mask:0xf bank_mask:0xf
    v_and_b32_dpp v100, v124, v10 row_newbcast:4 row_mask:0xf bank_mask:0xf
    v_and_b32_dpp v101, v124, v11 row_newbcast:4 row_mask:0xf bank_mask:0xf
    v_and_b32_dpp v102, v124, v12 row_newbcast:4 row_mask:0xf bank_mask:0xf
    v_and_b32_dpp v103, v124, v13 row_newbcast:4 row_mask:0xf bank_mask:0xf
    v_and_b32_dpp v104, v124, v10 row_newbcast:8 row_mask:0xf bank_mask:0xf
    v_and_b32_dpp v105, v124, v11 row_newbcast:8 row_mask:0xf bank_mask:0xf
    v_and_b32_dpp v106, v124, v12 row_newbcast:8 row_mask:0xf bank_mask:0xf
    v_and_b32_dpp v107, v124, v13 row_newbcast:8 row_mask:0xf bank_mask:0xf
    v_and_b32_dpp v108, v124, v10 row_newbcast:12 row_mask:0xf bank_mask:0xf
    v_and_b32_dpp v109, v124, v11 row_newbcast:12 row_mask:0xf bank_mask:0xf
    v_and_b32_dpp v110, v124, v12 row_newbcast:12 row_mask:0xf bank_mask:0xf
    v_and_b32_dpp v111, v124, v13 row_newbcast:12 row_mask:0xf bank_mask:0xf
    v_mfma_f32_16x16x32_bf16 v[116:119], v[208:211], v[96:99], v[116:119]
    v_mfma_f32_16x16x32_bf16 v[116:119], v[212:215], v[100:103], v[116:119]
    v_mfma_f32_16x16x32_bf16 v[116:119], v[216:219], v[104:107], v[116:119]
    v_mfma_f32_16x16x32_bf16 v[116:119], v[220:223], v[108:111], v[116:119]
    v_mfma_f32_16x16x32_bf16 v[112:115], v[224:227], v[80:83], 0
    v_mfma_f32_16x16x32_bf16 v[112:115], v[228:231], v[84:87], v[112:115]
    v_mfma_f32_16x16x32_bf16 v[112:115], v[232:235], v[88:91], v[112:115]
    s_waitcnt vmcnt(9)
    v_mfma_f32_16x16x32_bf16 v[112:115], v[236:239], v[92:95], v[112:115]
    s_nop 7
    v_mov_b32_dpp v122, v112 quad_perm:[0,0,0,0] row_mask:0xf bank_mask:0xf
    v_mov_b32_dpp v124, v114 quad_perm:[2,2,2,2] row_mask:0xf bank_mask:0xf
    s_nop 0
    v_add_f32_dpp v122, v113, v122 quad_perm:[1,1,1,1] row_mask:0xf bank_mask:0xf
    v_add_f32_dpp v124, v115, v124 quad_perm:[3,3,3,3] row_mask:0xf bank_mask:0xf
    v_add_f32 v122, v122, v124
    v_fma_f32 v123, v122, s83, -v120
    v_cmp_lt_f32 vcc, 0, v123
    s_cbranch_vccz L_nomax_6
    v_mul_f32 v122, s83, v122
    s_nop 1
    v_max_f32_dpp v124, v122, v122 row_ror:4 row_mask:0xf bank_mask:0xf
    s_nop 1
    v_max_f32_dpp v124, v124, v124 row_ror:8 row_mask:0xf bank_mask:0xf
    v_mov_b32 v125, v124
    s_nop 1
    v_permlane16_swap_b32 v124, v125
    v_max_f32 v124, v124, v125
    v_mov_b32 v125, v124
    s_nop 1
    v_permlane32_swap_b32 v124, v125
    v_max_f32 v124, v124, v125
    v_and_b32 v124, s82, v124
    v_max_f32 v124, v124, v120
    v_sub_f32 v125, v120, v124
    v_exp_f32 v125, v125
    v_mov_b32 v120, v124
    v_sub_f32 v123, v122, v124
    v_mul_f32 v121, v121, v125
    v_mul_f32 v116, v116, v125
    v_mul_f32 v117, v117, v125
    v_mul_f32 v118, v118, v125
    v_mul_f32 v119, v119, v125
L_nomax_6:
    v_exp_f32 v123, v123
    s_nop 0
    v_cvt_pk_bf16_f32 v124, v123, v123
    v_add_f32 v121, v121, v123
    s_nop 0
    v_and_b32_dpp v96, v124, v10 row_newbcast:0 row_mask:0xf bank_mask:0xf
    v_and_b32_dpp v97, v124, v11 row_newbcast:0 row_mask:0xf bank_mask:0xf
    v_and_b32_dpp v98, v124, v12 row_newbcast:0 row_mask:0xf bank_mask:0xf
    v_and_b32_dpp v99, v124, v13 row_newbcast:0 row_mask:0xf bank_mask:0xf
    v_and_b32_dpp v100, v124, v10 row_newbcast:4 row_mask:0xf bank_mask:0xf
    v_and_b32_dpp v101, v124, v11 row_newbcast:4 row_mask:0xf bank_mask:0xf
    v_and_b32_dpp v102, v124, v12 row_newbcast:4 row_mask:0xf bank_mask:0xf
    v_and_b32_dpp v103, v124, v13 row_newbcast:4 row_mask:0xf bank_mask:0xf
    v_and_b32_dpp v104, v124, v10 row_newbcast:8 row_mask:0xf bank_mask:0xf
    v_and_b32_dpp v105, v124, v11 row_newbcast:8 row_mask:0xf bank_mask:0xf
    v_and_b32_dpp v106, v124, v12 row_newbcast:8 row_mask:0xf bank_mask:0xf
    v_and_b32_dpp v107, v124, v13 row_newbcast:8 row_mask:0xf bank_mask:0xf
    v_and_b32_dpp v108, v124, v10 row_newbcast:12 row_mask:0xf bank_mask:0xf
    v_and_b32_dpp v109, v124, v11 row_newbcast:12 row_mask:0xf bank_mask:0xf
    v_and_b32_dpp v110, v124, v12 row_newbcast:12 row_mask:0xf bank_mask:0xf
    v_and_b32_dpp v111, v124, v13 row_newbcast:12 row_mask:0xf bank_mask:0xf
    s_waitcnt vmcnt(8)
    v_mfma_f32_16x16x32_bf16 v[116:119], v[240:243], v[96:99], v[116:119]
    s_waitcnt vmcnt(7)
    v_mfma_f32_16x16x32_bf16 v[116:119], v[244:247], v[100:103], v[116:119]
    s_waitcnt vmcnt(6)
    v_mfma_f32_16x16x32_bf16 v[116:119], v[248:251], v[104:107], v[116:119]
    s_waitcnt vmcnt(5)
    v_mfma_f32_16x16x32_bf16 v[116:119], v[252:255], v[108:111], v[116:119]
L_bloop:
    s_waitcnt vmcnt(4)
    buffer_load_dwordx4 v[148:151], v77, s[56:59], s85 offen offset:1024 nt
    v_mfma_f32_16x16x32_bf16 v[112:115], v[128:131], v[80:83], 0
    s_waitcnt vmcnt(4)
    buffer_load_dwordx4 v[152:155], v77, s[56:59], s85 offen offset:2048 nt
    v_mfma_f32_16x16x32_bf16 v[112:115], v[132:135], v[84:87], v[112:115]
    s_waitcnt vmcnt(4)
    buffer_load_dwordx4 v[156:159], v77, s[56:59], s85 offen offset:3072 nt
    v_mfma_f32_16x16x32_bf16 v[112:115], v[136:139], v[88:91], v[112:115]
    s_waitcnt vmcnt(4)
    s_add_u32 s87, s87, 7
    s_add_u32 s39, s87, s88
    s_and_b32 s39, s39, 255
    s_lshl_b32 s39, s39, 12
    s_add_u32 s86, s39, s89
    s_cmp_ge_u32 s87, 256
    s_cselect_b32 s86, 134217728, s86
    buffer_load_dwordx4 v[160:163], v76, s[52:55], s86 offen offset:0 nt
    v_mfma_f32_16x16x32_bf16 v[112:115], v[140:143], v[92:95], v[112:115]
    s_nop 7
    v_mov_b32_dpp v122, v112 quad_perm:[0,0,0,0] row_mask:0xf bank_mask:0xf
    v_mov_b32_dpp v124, v114 quad_perm:[2,2,2,2] row_mask:0xf bank_mask:0xf
    s_nop 0
    v_add_f32_dpp v122, v113, v122 quad_perm:[1,1,1,1] row_mask:0xf bank_mask:0xf
    v_add_f32_dpp v124, v115, v124 quad_perm:[3,3,3,3] row_mask:0xf bank_mask:0xf
    v_add_f32 v122, v122, v124
    v_fma_f32 v123, v122, s83, -v120
    v_cmp_lt_f32 vcc, 0, v123
    s_cbranch_vccz L_nomax_7
    v_mul_f32 v122, s83, v122
    s_nop 1
    v_max_f32_dpp v124, v122, v122 row_ror:4 row_mask:0xf bank_mask:0xf
    s_nop 1
    v_max_f32_dpp v124, v124, v124 row_ror:8 row_mask:0xf bank_mask:0xf
    v_mov_b32 v125, v124
    s_nop 1
    v_permlane16_swap_b32 v124, v125
    v_max_f32 v124, v124, v125
    v_mov_b32 v125, v124
    s_nop 1
    v_permlane32_swap_b32 v124, v125
    v_max_f32 v124, v124, v125
    v_and_b32 v124, s82, v124
    v_max_f32 v124, v124, v120
    v_sub_f32 v125, v120, v124
    v_exp_f32 v125, v125
    v_mov_b32 v120, v124
    v_sub_f32 v123, v122, v124
    v_mul_f32 v121, v121, v125
    v_mul_f32 v116, v116, v125
    v_mul_f32 v117, v117, v125
    v_mul_f32 v118, v118, v125
    v_mul_f32 v119, v119, v125
L_nomax_7:
    v_exp_f32 v123, v123
    s_nop 0
    v_cvt_pk_bf16_f32 v124, v123, v123
    v_add_f32 v121, v121, v123
    s_nop 0
    v_and_b32_dpp v96, v124, v10 row_newbcast:0 row_mask:0xf bank_mask:0xf
    v_and_b32_dpp v97, v124, v11 row_newbcast:0 row_mask:0xf bank_mask:0xf
    v_and_b32_dpp v98, v124, v12 row_newbcast:0 row_mask:0xf bank_mask:0xf
    v_and_b32_dpp v99, v124, v13 row_newbcast:0 row_mask:0xf bank_mask:0xf
    v_and_b32_dpp v100, v124, v10 row_newbcast:4 row_mask:0xf bank_mask:0xf
    v_and_b32_dpp v101, v124, v11 row_newbcast:4 row_mask:0xf bank_mask:0xf
    v_and_b32_dpp v102, v124, v12 row_newbcast:4 row_mask:0xf bank_mask:0xf
    v_and_b32_dpp v103, v124, v13 row_newbcast:4 row_mask:0xf bank_mask:0xf
    v_and_b32_dpp v104, v124, v10 row_newbcast:8 row_mask:0xf bank_mask:0xf
    v_and_b32_dpp v105, v124, v11 row_newbcast:8 row_mask:0xf bank_mask:0xf
    v_and_b32_dpp v106, v124, v12 row_newbcast:8 row_mask:0xf bank_mask:0xf
    v_and_b32_dpp v107, v124, v13 row_newbcast:8 row_mask:0xf bank_mask:0xf
    v_and_b32_dpp v108, v124, v10 row_newbcast:12 row_mask:0xf bank_mask:0xf
    v_and_b32_dpp v109, v124, v11 row_newbcast:12 row_mask:0xf bank_mask:0xf
    v_and_b32_dpp v110, v124, v12 row_newbcast:12 row_mask:0xf bank_mask:0xf
    v_and_b32_dpp v111, v124, v13 row_newbcast:12 row_mask:0xf bank_mask:0xf
    s_waitcnt vmcnt(4)
    buffer_load_dwordx4 v[164:167], v76, s[52:55], s86 offen offset:1024 nt
    v_mfma_f32_16x16x32_bf16 v[116:119], v[144:147], v[96:99], v[116:119]
    s_waitcnt vmcnt(4)
    buffer_load_dwordx4 v[168:171], v76, s[52:55], s86 offen offset:2048 nt
    v_mfma_f32_16x16x32_bf16 v[116:119], v[148:151], v[100:103], v[116:119]
    s_waitcnt vmcnt(4)
    buffer_load_dwordx4 v[172:175], v76, s[52:55], s86 offen offset:3072 nt
    v_mfma_f32_16x16x32_bf16 v[116:119], v[152:155], v[104:107], v[116:119]
    s_waitcnt vmcnt(4)
    buffer_load_dwordx4 v[176:179], v77, s[56:59], s86 offen offset:0 nt
    v_mfma_f32_16x16x32_bf16 v[116:119], v[156:159], v[108:111], v[116:119]
    s_cmp_ge_u32 s87, 256
    s_cbranch_scc1 L_bdone
    s_waitcnt vmcnt(4)
    buffer_load_dwordx4 v[180:183], v77, s[56:59], s86 offen offset:1024 nt
    v_mfma_f32_16x16x32_bf16 v[112:115], v[160:163], v[80:83], 0
    s_waitcnt vmcnt(4)
    buffer_load_dwordx4 v[184:187], v77, s[56:59], s86 offen offset:2048 nt
    v_mfma_f32_16x16x32_bf16 v[112:115], v[164:167], v[84:87], v[112:115]
    s_waitcnt vmcnt(4)
    buffer_load_dwordx4 v[188:191], v77, s[56:59], s86 offen offset:3072 nt
    v_mfma_f32_16x16x32_bf16 v[112:115], v[168:171], v[88:91], v[112:115]
    s_waitcnt vmcnt(4)
    s_add_u32 s87, s87, 7
    s_add_u32 s39, s87, s88
    s_and_b32 s39, s39, 255
    s_lshl_b32 s39, s39, 12
    s_add_u32 s85, s39, s89
    s_cmp_ge_u32 s87, 256
    s_cselect_b32 s85, 134217728, s85
    buffer_load_dwordx4 v[128:131], v76, s[52:55], s85 offen offset:0 nt
    v_mfma_f32_16x16x32_bf16 v[112:115], v[172:175], v[92:95], v[112:115]
    s_nop 7
    v_mov_b32_dpp v122, v112 quad_perm:[0,0,0,0] row_mask:0xf bank_mask:0xf
    v_mov_b32_dpp v124, v114 quad_perm:[2,2,2,2] row_mask:0xf bank_mask:0xf
    s_nop 0
    v_add_f32_dpp v122, v113, v122 quad_perm:[1,1,1,1] row_mask:0xf bank_mask:0xf
    v_add_f32_dpp v124, v115, v124 quad_perm:[3,3,3,3] row_mask:0xf bank_mask:0xf
    v_add_f32 v122, v122, v124
    v_fma_f32 v123, v122, s83, -v120
    v_cmp_lt_f32 vcc, 0, v123
    s_cbranch_vccz L_nomax_8
    v_mul_f32 v122, s83, v122
    s_nop 1
    v_max_f32_dpp v124, v122, v122 row_ror:4 row_mask:0xf bank_mask:0xf
    s_nop 1
    v_max_f32_dpp v124, v124, v124 row_ror:8 row_mask:0xf bank_mask:0xf
    v_mov_b32 v125, v124
    s_nop 1
    v_permlane16_swap_b32 v124, v125
    v_max_f32 v124, v124, v125
    v_mov_b32 v125, v124
    s_nop 1
    v_permlane32_swap_b32 v124, v125
    v_max_f32 v124, v124, v125
    v_and_b32 v124, s82, v124
    v_max_f32 v124, v124, v120
    v_sub_f32 v125, v120, v124
    v_exp_f32 v125, v125
    v_mov_b32 v120, v124
    v_sub_f32 v123, v122, v124
    v_mul_f32 v121, v121, v125
    v_mul_f32 v116, v116, v125
    v_mul_f32 v117, v117, v125
    v_mul_f32 v118, v118, v125
    v_mul_f32 v119, v119, v125
L_nomax_8:
    v_exp_f32 v123, v123
    s_nop 0
    v_cvt_pk_bf16_f32 v124, v123, v123
    v_add_f32 v121, v121, v123
    s_nop 0
    v_and_b32_dpp v96, v124, v10 row_newbcast:0 row_mask:0xf bank_mask:0xf
    v_and_b32_dpp v97, v124, v11 row_newbcast:0 row_mask:0xf bank_mask:0xf
    v_and_b32_dpp v98, v124, v12 row_newbcast:0 row_mask:0xf bank_mask:0xf
    v_and_b32_dpp v99, v124, v13 row_newbcast:0 row_mask:0xf bank_mask:0xf
    v_and_b32_dpp v100, v124, v10 row_newbcast:4 row_mask:0xf bank_mask:0xf
    v_and_b32_dpp v101, v124, v11 row_newbcast:4 row_mask:0xf bank_mask:0xf
    v_and_b32_dpp v102, v124, v12 row_newbcast:4 row_mask:0xf bank_mask:0xf
    v_and_b32_dpp v103, v124, v13 row_newbcast:4 row_mask:0xf bank_mask:0xf
    v_and_b32_dpp v104, v124, v10 row_newbcast:8 row_mask:0xf bank_mask:0xf
    v_and_b32_dpp v105, v124, v11 row_newbcast:8 row_mask:0xf bank_mask:0xf
    v_and_b32_dpp v106, v124, v12 row_newbcast:8 row_mask:0xf bank_mask:0xf
    v_and_b32_dpp v107, v124, v13 row_newbcast:8 row_mask:0xf bank_mask:0xf
    v_and_b32_dpp v108, v124, v10 row_newbcast:12 row_mask:0xf bank_mask:0xf
    v_and_b32_dpp v109, v124, v11 row_newbcast:12 row_mask:0xf bank_mask:0xf
    v_and_b32_dpp v110, v124, v12 row_newbcast:12 row_mask:0xf bank_mask:0xf
    v_and_b32_dpp v111, v124, v13 row_newbcast:12 row_mask:0xf bank_mask:0xf
    s_waitcnt vmcnt(4)
    buffer_load_dwordx4 v[132:135], v76, s[52:55], s85 offen offset:1024 nt
    v_mfma_f32_16x16x32_bf16 v[116:119], v[176:179], v[96:99], v[116:119]
    s_waitcnt vmcnt(4)
    buffer_load_dwordx4 v[136:139], v76, s[52:55], s85 offen offset:2048 nt
    v_mfma_f32_16x16x32_bf16 v[116:119], v[180:183], v[100:103], v[116:119]
    s_waitcnt vmcnt(4)
    buffer_load_dwordx4 v[140:143], v76, s[52:55], s85 offen offset:3072 nt
    v_mfma_f32_16x16x32_bf16 v[116:119], v[184:187], v[104:107], v[116:119]
    s_waitcnt vmcnt(4)
    buffer_load_dwordx4 v[144:147], v77, s[56:59], s85 offen offset:0 nt
    v_mfma_f32_16x16x32_bf16 v[116:119], v[188:191], v[108:111], v[116:119]
    s_cmp_ge_u32 s87, 256
    s_cbranch_scc0 L_bloop
L_bdone:
    v_add_f32_dpp v121, v121, v121 row_ror:8 row_mask:0xf bank_mask:0xf
    s_lshl_b32 s38, s32, 2
    s_add_u32 s38, s38, s34
    v_add_f32_dpp v121, v121, v121 row_ror:4 row_mask:0xf bank_mask:0xf
    v_mov_b32 v125, v121
    s_lshl_b32 s38, s38, 3
    s_add_u32 s38, s38, s33
    v_permlane16_swap_b32 v121, v125
    v_add_f32 v121, v121, v125
    v_mov_b32 v125, v121
    s_lshl_b32 s38, s38, 10
    s_add_u32 s38, s38, 5242880
    v_permlane32_swap_b32 v121, v125
    s_mov_b32 exec_lo, 0x100
    s_mov_b32 exec_hi, 0x0
    v_add_f32 v117, v121, v125
    v_mov_b32 v116, v120
    s_mov_b32 exec_lo, 0xff01ff
    s_mov_b32 exec_hi, 0xff00ff
    v_and_or_b32 v116, v116, s82, v8
    v_and_or_b32 v117, v117, s82, v8
    v_and_or_b32 v118, v118, s82, v8
    v_and_or_b32 v119, v119, s82, v8
    buffer_store_dwordx4 v[116:119], v79, s[48:51], s38 offen sc1
    s_endpgm
L_aux:
    s_mov_b32 s56, s10
    s_and_b32 s57, s11, 0xffff
    s_mov_b32 s58, 4194304
    s_mov_b32 s59, 0x20000
    s_mov_b32 s52, s6
    s_and_b32 s53, s7, 0xffff
    s_mov_b32 s54, 16777216
    s_mov_b32 s55, 0x20000
    v_lshrrev_b32 v4, 2, v3
    v_and_b32 v5, 3, v3
    v_lshlrev_b32 v18, 18, v4
    v_lshl_add_u32 v18, v2, 6, v18
    v_lshl_add_u32 v18, v5, 4, v18
    s_lshl_b32 s85, s34, 20
    s_lshl_b32 s38, s32, 8
    s_add_u32 s85, s85, s38
    s_mov_b32 s89, s85
    s_waitcnt vmcnt(7)
    buffer_load_dwordx4 a[0:3], v18, s[56:59], s85 offen nt
    s_add_u32 s85, s85, 8192
    v_perm_b32 v4, v20, v20, s80
    v_perm_b32 v5, v24, v24, s80
    v_and_b32 v28, v4, v10
    v_and_b32 v29, v4, v11
    v_and_b32 v30, v4, v12
    v_and_b32 v31, v4, v13
    v_and_b32 v32, v5, v10
    v_and_b32 v33, v5, v11
    v_and_b32 v34, v5, v12
    v_and_b32 v35, v5, v13
    v_mfma_f32_16x16x32_bf16 v[36:39], v[44:47], v[28:31], 0
    s_nop 0
    v_mfma_f32_16x16x32_bf16 v[40:43], v[44:47], v[32:35], 0
    s_waitcnt vmcnt(7)
    buffer_load_dwordx4 a[4:7], v18, s[56:59], s85 offen nt
    s_add_u32 s85, s85, 8192
    v_perm_b32 v4, v20, v20, s81
    v_perm_b32 v5, v24, v24, s81
    v_and_b32 v28, v4, v10
    v_and_b32 v29, v4, v11
    v_and_b32 v30, v4, v12
    v_and_b32 v31, v4, v13
    v_and_b32 v32, v5, v10
    v_and_b32 v33, v5, v11
    v_and_b32 v34, v5, v12
    v_and_b32 v35, v5, v13
    v_mfma_f32_16x16x32_bf16 v[36:39], v[48:51], v[28:31], v[36:39]
    s_nop 0
    v_mfma_f32_16x16x32_bf16 v[40:43], v[48:51], v[32:35], v[40:43]
    s_waitcnt vmcnt(7)
    buffer_load_dwordx4 a[8:11], v18, s[56:59], s85 offen nt
    s_add_u32 s85, s85, 8192
    v_perm_b32 v4, v21, v21, s80
    v_perm_b32 v5, v25, v25, s80
    v_and_b32 v28, v4, v10
    v_and_b32 v29, v4, v11
    v_and_b32 v30, v4, v12
    v_and_b32 v31, v4, v13
    v_and_b32 v32, v5, v10
    v_and_b32 v33, v5, v11
    v_and_b32 v34, v5, v12
    v_and_b32 v35, v5, v13
    v_mfma_f32_16x16x32_bf16 v[36:39], v[52:55], v[28:31], v[36:39]
    s_nop 0
    v_mfma_f32_16x16x32_bf16 v[40:43], v[52:55], v[32:35], v[40:43]
    s_waitcnt vmcnt(7)
    buffer_load_dwordx4 a[12:15], v18, s[56:59], s85 offen nt
    s_add_u32 s85, s85, 8192
    v_perm_b32 v4, v21, v21, s81
    v_perm_b32 v5, v25, v25, s81
    v_and_b32 v28, v4, v10
    v_and_b32 v29, v4, v11
    v_and_b32 v30, v4, v12
    v_and_b32 v31, v4, v13
    v_and_b32 v32, v5, v10
    v_and_b32 v33, v5, v11
    v_and_b32 v34, v5, v12
    v_and_b32 v35, v5, v13
    v_mfma_f32_16x16x32_bf16 v[36:39], v[56:59], v[28:31], v[36:39]
    s_nop 0
    v_mfma_f32_16x16x32_bf16 v[40:43], v[56:59], v[32:35], v[40:43]
    s_waitcnt vmcnt(7)
    buffer_load_dwordx4 a[16:19], v18, s[56:59], s85 offen nt
    s_add_u32 s85, s85, 8192
    v_perm_b32 v4, v22, v22, s80
    v_perm_b32 v5, v26, v26, s80
    v_and_b32 v28, v4, v10
    v_and_b32 v29, v4, v11
    v_and_b32 v30, v4, v12
    v_and_b32 v31, v4, v13
    v_and_b32 v32, v5, v10
    v_and_b32 v33, v5, v11
    v_and_b32 v34, v5, v12
    v_and_b32 v35, v5, v13
    v_mfma_f32_16x16x32_bf16 v[36:39], v[60:63], v[28:31], v[36:39]
    s_nop 0
    v_mfma_f32_16x16x32_bf16 v[40:43], v[60:63], v[32:35], v[40:43]
    s_waitcnt vmcnt(7)
    buffer_load_dwordx4 a[20:23], v18, s[56:59], s85 offen nt
    s_add_u32 s85, s85, 8192
    v_perm_b32 v4, v22, v22, s81
    v_perm_b32 v5, v26, v26, s81
    v_and_b32 v28, v4, v10
    v_and_b32 v29, v4, v11
    v_and_b32 v30, v4, v12
    v_and_b32 v31, v4, v13
    v_and_b32 v32, v5, v10
    v_and_b32 v33, v5, v11
    v_and_b32 v34, v5, v12
    v_and_b32 v35, v5, v13
    v_mfma_f32_16x16x32_bf16 v[36:39], v[64:67], v[28:31], v[36:39]
    s_nop 0
    v_mfma_f32_16x16x32_bf16 v[40:43], v[64:67], v[32:35], v[40:43]
    s_waitcnt vmcnt(7)
    buffer_load_dwordx4 a[24:27], v18, s[56:59], s85 offen nt
    s_add_u32 s85, s85, 8192
    v_perm_b32 v4, v23, v23, s80
    v_perm_b32 v5, v27, v27, s80
    v_and_b32 v28, v4, v10
    v_and_b32 v29, v4, v11
    v_and_b32 v30, v4, v12
    v_and_b32 v31, v4, v13
    v_and_b32 v32, v5, v10
    v_and_b32 v33, v5, v11
    v_and_b32 v34, v5, v12
    v_and_b32 v35, v5, v13
    v_mfma_f32_16x16x32_bf16 v[36:39], v[68:71], v[28:31], v[36:39]
    s_nop 0
    v_mfma_f32_16x16x32_bf16 v[40:43], v[68:71], v[32:35], v[40:43]
    s_waitcnt vmcnt(7)
    buffer_load_dwordx4 a[28:31], v18, s[56:59], s85 offen nt
    s_add_u32 s85, s85, 8192
    v_perm_b32 v4, v23, v23, s81
    v_perm_b32 v5, v27, v27, s81
    v_and_b32 v28, v4, v10
    v_and_b32 v29, v4, v11
    v_and_b32 v30, v4, v12
    v_and_b32 v31, v4, v13
    v_and_b32 v32, v5, v10
    v_and_b32 v33, v5, v11
    v_and_b32 v34, v5, v12
    v_and_b32 v35, v5, v13
    v_mfma_f32_16x16x32_bf16 v[36:39], v[72:75], v[28:31], v[36:39]
    s_nop 0
    v_mfma_f32_16x16x32_bf16 v[40:43], v[72:75], v[32:35], v[40:43]
    s_lshl_b32 s38, s34, 11
    s_add_u32 s38, s38, 131072
    v_lshrrev_b32 v4, 3, v3
    v_lshlrev_b32 v4, 9, v4
    v_lshl_add_u32 v4, v2, 7, v4
    v_and_b32 v5, 7, v3
    v_lshl_add_u32 v4, v5, 2, v4
    v_add_u32 v4, s38, v4
    s_lshl_b32 s38, s34, 9
    v_and_b32 v5, 31, v1
    v_lshl_add_u32 v5, v5, 4, s38
    v_add_u32 v6, 131072, v5
    ds_write_b32 v4, v36 offset:0
    ds_write_b32 v4, v37 offset:32
    ds_write_b32 v4, v38 offset:64
    ds_write_b32 v4, v39 offset:96
    ds_write_b32 v4, v40 offset:1024
    ds_write_b32 v4, v41 offset:1056
    ds_write_b32 v4, v42 offset:1088
    ds_write_b32 v4, v43 offset:1120
    s_waitcnt lgkmcnt(0)
    s_barrier
    ds_read_b128 v[44:47], v6 offset:0
    ds_read_b128 v[48:51], v6 offset:2048
    ds_read_b128 v[52:55], v6 offset:4096
    ds_read_b128 v[56:59], v6 offset:6144
    s_add_u32 s35, s35, 0x5b
    s_and_b32 s35, s35, 0xff
    v_mov_b32 v8, s35
    s_lshl_b32 s38, s32, 3
    s_add_u32 s38, s38, s33
    s_lshl_b32 s38, s38, 11
    s_add_u32 s38, s38, 1048576
    s_waitcnt lgkmcnt(0)
    v_add_f32 v44, v44, v48
    v_add_f32 v52, v52, v56
    v_add_f32 v45, v45, v49
    v_add_f32 v53, v53, v57
    v_add_f32 v46, v46, v50
    v_add_f32 v54, v54, v58
    v_add_f32 v47, v47, v51
    v_add_f32 v55, v55, v59
    v_add_f32 v44, v44, v52
    v_add_f32 v45, v45, v53
    v_add_f32 v46, v46, v54
    v_add_f32 v47, v47, v55
    v_and_or_b32 v44, v44, s82, v8
    v_and_or_b32 v45, v45, s82, v8
    v_and_or_b32 v46, v46, s82, v8
    v_and_or_b32 v47, v47, s82, v8
    s_mov_b32 exec_lo, 0xffffffff
    s_mov_b32 exec_hi, 0x0
    buffer_store_dwordx4 v[44:47], v5, s[48:51], s38 offen sc1
    s_mov_b64 exec, -1
    buffer_load_dwordx4 a[32:35], v18, s[56:59], s85 offen nt
    s_add_u32 s85, s85, 8192
    buffer_load_dwordx4 a[36:39], v18, s[56:59], s85 offen nt
    s_add_u32 s85, s85, 8192
    buffer_load_dwordx4 a[40:43], v18, s[56:59], s85 offen nt
    s_add_u32 s85, s85, 8192
    buffer_load_dwordx4 a[44:47], v18, s[56:59], s85 offen nt
    s_add_u32 s85, s85, 8192
    buffer_load_dwordx4 a[48:51], v18, s[56:59], s85 offen nt
    s_add_u32 s85, s85, 8192
    buffer_load_dwordx4 a[52:55], v18, s[56:59], s85 offen nt
    s_add_u32 s85, s85, 8192
    buffer_load_dwordx4 a[56:59], v18, s[56:59], s85 offen nt
    s_add_u32 s85, s85, 8192
    buffer_load_dwordx4 a[60:63], v18, s[56:59], s85 offen nt
    s_add_u32 s85, s85, 8192
    buffer_load_dwordx4 a[64:67], v18, s[56:59], s85 offen nt
    s_add_u32 s85, s85, 8192
    buffer_load_dwordx4 a[68:71], v18, s[56:59], s85 offen nt
    s_add_u32 s85, s85, 8192
    buffer_load_dwordx4 a[72:75], v18, s[56:59], s85 offen nt
    s_add_u32 s85, s85, 8192
    buffer_load_dwordx4 a[76:79], v18, s[56:59], s85 offen nt
    s_add_u32 s85, s85, 8192
    buffer_load_dwordx4 a[80:83], v18, s[56:59], s85 offen nt
    s_add_u32 s85, s85, 8192
    buffer_load_dwordx4 a[84:87], v18, s[56:59], s85 offen nt
    s_add_u32 s85, s85, 8192
    buffer_load_dwordx4 a[88:91], v18, s[56:59], s85 offen nt
    s_add_u32 s85, s85, 8192
    buffer_load_dwordx4 a[92:95], v18, s[56:59], s85 offen nt
    s_add_u32 s85, s85, 8192
    buffer_load_dwordx4 a[96:99], v18, s[56:59], s85 offen nt
    s_add_u32 s85, s85, 8192
    buffer_load_dwordx4 a[100:103], v18, s[56:59], s85 offen nt
    s_add_u32 s85, s85, 8192
    buffer_load_dwordx4 a[104:107], v18, s[56:59], s85 offen nt
    s_add_u32 s85, s85, 8192
    buffer_load_dwordx4 a[108:111], v18, s[56:59], s85 offen nt
    s_add_u32 s85, s85, 8192
    buffer_load_dwordx4 a[112:115], v18, s[56:59], s85 offen nt
    s_add_u32 s85, s85, 8192
    buffer_load_dwordx4 a[116:119], v18, s[56:59], s85 offen nt
    s_add_u32 s85, s85, 8192
    buffer_load_dwordx4 a[120:123], v18, s[56:59], s85 offen nt
    s_add_u32 s85, s85, 8192
    buffer_load_dwordx4 a[124:127], v18, s[56:59], s85 offen nt
    s_add_u32 s85, s85, 8192
    v_lshrrev_b32 v4, 2, v3
    v_and_b32 v5, 3, v3
    v_lshlrev_b32 v6, 9, v4
    v_lshl_add_u32 v6, v2, 7, v6
    v_lshl_add_u32 v6, v5, 5, v6
    s_lshl_b32 s86, s32, 14
    s_add_u32 s86, s86, 1056768
    s_add_u32 s36, s86, 4096
    buffer_load_dwordx4 v[136:139], v6, s[48:51], s86 offen offset:0 sc1
    buffer_load_dwordx4 v[140:143], v6, s[48:51], s86 offen offset:16 sc1
    buffer_load_dwordx4 v[144:147], v6, s[48:51], s86 offen offset:2048 sc1
    buffer_load_dwordx4 v[148:151], v6, s[48:51], s86 offen offset:2064 sc1
    buffer_load_dwordx4 v[152:155], v6, s[48:51], s36 offen offset:0 sc1
    buffer_load_dwordx4 v[156:159], v6, s[48:51], s36 offen offset:16 sc1
    buffer_load_dwordx4 v[160:163], v6, s[48:51], s36 offen offset:2048 sc1
    buffer_load_dwordx4 v[164:167], v6, s[48:51], s36 offen offset:2064 sc1
    v_lshlrev_b32 v4, 2, v2
    v_xor_b32 v4, v4, v3
    v_xor_b32 v5, 0, v4
    v_lshlrev_b32 v5, 4, v5
    v_lshl_add_u32 v76, v2, 10, v5
    v_lshl_add_u32 v96, v2, 8, v5
    v_xor_b32 v5, 1, v4
    v_lshlrev_b32 v5, 4, v5
    v_lshl_add_u32 v77, v2, 10, v5
    v_lshl_add_u32 v97, v2, 8, v5
    v_add_u32 v77, 3072, v77
    v_xor_b32 v5, 2, v4
    v_lshlrev_b32 v5, 4, v5
    v_lshl_add_u32 v78, v2, 10, v5
    v_lshl_add_u32 v98, v2, 8, v5
    v_add_u32 v78, 6144, v78
    v_xor_b32 v5, 3, v4
    v_lshlrev_b32 v5, 4, v5
    v_lshl_add_u32 v79, v2, 10, v5
    v_lshl_add_u32 v99, v2, 8, v5
    v_add_u32 v79, 9216, v79
    s_lshl_b32 s90, s34, 15
    v_add_u32 v96, s90, v96
    v_add_u32 v97, s90, v97
    v_add_u32 v98, s90, v98
    v_add_u32 v99, s90, v99
    s_lshl_b32 s95, s32, 19
    s_lshl_b32 s38, s34, 8
    s_add_u32 s95, s95, s38
    s_mov_b32 s94, 0
    s_add_u32 s39, s90, s94
    s_mov_b32 m0, s39
    s_nop 0
    buffer_load_dwordx4 v76, s[52:55], s95 offen offset:0 nt lds
    buffer_load_dwordx4 v77, s[52:55], s95 offen offset:1024 nt lds
    buffer_load_dwordx4 v78, s[52:55], s95 offen offset:2048 nt lds
    buffer_load_dwordx4 v79, s[52:55], s95 offen offset:3072 nt lds
    s_add_u32 s95, s95, 16384
    s_add_u32 s39, s90, s94
    s_add_u32 s39, s39, 4096
    s_mov_b32 m0, s39
    s_nop 0
    buffer_load_dwordx4 v76, s[52:55], s95 offen offset:0 nt lds
    buffer_load_dwordx4 v77, s[52:55], s95 offen offset:1024 nt lds
    buffer_load_dwordx4 v78, s[52:55], s95 offen offset:2048 nt lds
    buffer_load_dwordx4 v79, s[52:55], s95 offen offset:3072 nt lds
    s_add_u32 s95, s95, 16384
    s_add_u32 s94, s94, 8192
    s_and_b32 s94, s94, 0x7fff
    s_waitcnt vmcnt(8)
L_qacheck_9:
    v_xor_b32 v136, s35, v136
    v_xor_b32 v137, s35, v137
    v_xor_b32 v138, s35, v138
    v_xor_b32 v139, s35, v139
    v_xor_b32 v140, s35, v140
    v_xor_b32 v141, s35, v141
    v_xor_b32 v142, s35, v142
    v_xor_b32 v143, s35, v143
    v_xor_b32 v144, s35, v144
    v_xor_b32 v145, s35, v145
    v_xor_b32 v146, s35, v146
    v_xor_b32 v147, s35, v147
    v_xor_b32 v148, s35, v148
    v_xor_b32 v149, s35, v149
    v_xor_b32 v150, s35, v150
    v_xor_b32 v151, s35, v151
    v_xor_b32 v152, s35, v152
    v_xor_b32 v153, s35, v153
    v_xor_b32 v154, s35, v154
    v_xor_b32 v155, s35, v155
    v_xor_b32 v156, s35, v156
    v_xor_b32 v157, s35, v157
    v_xor_b32 v158, s35, v158
    v_xor_b32 v159, s35, v159
    v_xor_b32 v160, s35, v160
    v_xor_b32 v161, s35, v161
    v_xor_b32 v162, s35, v162
    v_xor_b32 v163, s35, v163
    v_xor_b32 v164, s35, v164
    v_xor_b32 v165, s35, v165
    v_xor_b32 v166, s35, v166
    v_xor_b32 v167, s35, v167
    v_or_b32 v4, v136, v137
    v_or3_b32 v4, v4, v138, v139
    v_or3_b32 v4, v4, v140, v141
    v_or3_b32 v4, v4, v142, v143
    v_or3_b32 v4, v4, v144, v145
    v_or3_b32 v4, v4, v146, v147
    v_or3_b32 v4, v4, v148, v149
    v_or3_b32 v4, v4, v150, v151
    v_or3_b32 v4, v4, v152, v153
    v_or3_b32 v4, v4, v154, v155
    v_or3_b32 v4, v4, v156, v157
    v_or3_b32 v4, v4, v158, v159
    v_or3_b32 v4, v4, v160, v161
    v_or3_b32 v4, v4, v162, v163
    v_or3_b32 v4, v4, v164, v165
    v_or3_b32 v4, v4, v166, v167
    v_and_b32 v4, 0xff, v4
    v_cmp_ne_u32 vcc, 0, v4
    s_cbranch_vccz L_qaok_10
    buffer_load_dwordx4 v[136:139], v6, s[48:51], s86 offen offset:0 sc1
    buffer_load_dwordx4 v[140:143], v6, s[48:51], s86 offen offset:16 sc1
    buffer_load_dwordx4 v[144:147], v6, s[48:51], s86 offen offset:2048 sc1
    buffer_load_dwordx4 v[148:151], v6, s[48:51], s86 offen offset:2064 sc1
    buffer_load_dwordx4 v[152:155], v6, s[48:51], s36 offen offset:0 sc1
    buffer_load_dwordx4 v[156:159], v6, s[48:51], s36 offen offset:16 sc1
    buffer_load_dwordx4 v[160:163], v6, s[48:51], s36 offen offset:2048 sc1
    buffer_load_dwordx4 v[164:167], v6, s[48:51], s36 offen offset:2064 sc1
    s_waitcnt vmcnt(0)
    s_sub_u32 s84, s84, 1
    s_cmp_lg_u32 s84, 0
    s_cbranch_scc1 L_qacheck_9
    s_branch L_end
L_qaok_10:
    v_add_f32 v136, v136, v152
    v_add_f32 v144, v144, v160
    v_add_f32 v137, v137, v153
    v_add_f32 v145, v145, v161
    v_add_f32 v138, v138, v154
    v_add_f32 v146, v146, v162
    v_add_f32 v139, v139, v155
    v_add_f32 v147, v147, v163
    v_add_f32 v140, v140, v156
    v_add_f32 v148, v148, v164
    v_add_f32 v141, v141, v157
    v_add_f32 v149, v149, v165
    v_add_f32 v142, v142, v158
    v_add_f32 v150, v150, v166
    v_add_f32 v143, v143, v159
    v_add_f32 v151, v151, v167
    v_add_f32 v136, v136, v144
    v_add_f32 v137, v137, v145
    v_add_f32 v138, v138, v146
    v_add_f32 v139, v139, v147
    v_add_f32 v140, v140, v148
    v_add_f32 v141, v141, v149
    v_add_f32 v142, v142, v150
    v_add_f32 v143, v143, v151
    v_cvt_pk_bf16_f32 v28, v136, v137
    v_cvt_pk_bf16_f32 v29, v138, v139
    v_cvt_pk_bf16_f32 v30, v140, v141
    v_cvt_pk_bf16_f32 v31, v142, v143
    s_add_u32 s39, s90, s94
    s_mov_b32 m0, s39
    s_nop 0
    buffer_load_dwordx4 v76, s[52:55], s95 offen offset:0 nt lds
    buffer_load_dwordx4 v77, s[52:55], s95 offen offset:1024 nt lds
    buffer_load_dwordx4 v78, s[52:55], s95 offen offset:2048 nt lds
    buffer_load_dwordx4 v79, s[52:55], s95 offen offset:3072 nt lds
    s_add_u32 s95, s95, 16384
    s_add_u32 s39, s90, s94
    s_add_u32 s39, s39, 4096
    s_mov_b32 m0, s39
    s_nop 0
    buffer_load_dwordx4 v76, s[52:55], s95 offen offset:0 nt lds
    buffer_load_dwordx4 v77, s[52:55], s95 offen offset:1024 nt lds
    buffer_load_dwordx4 v78, s[52:55], s95 offen offset:2048 nt lds
    buffer_load_dwordx4 v79, s[52:55], s95 offen offset:3072 nt lds
    s_add_u32 s95, s95, 16384
    s_add_u32 s94, s94, 8192
    s_and_b32 s94, s94, 0x7fff
    v_mfma_f32_16x16x32_bf16 v[136:139], a[0:3], v[28:31], 0
    v_mfma_f32_16x16x32_bf16 v[140:143], a[4:7], v[28:31], 0
    v_mfma_f32_16x16x32_bf16 v[144:147], a[8:11], v[28:31], 0
    v_mfma_f32_16x16x32_bf16 v[148:151], a[12:15], v[28:31], 0
    s_nop 4
    v_mov_b32_dpp v168, v136 quad_perm:[0,0,0,0] row_mask:0xf bank_mask:0xf
    v_mov_b32_dpp v4, v138 quad_perm:[2,2,2,2] row_mask:0xf bank_mask:0xf
    s_nop 0
    v_add_f32_dpp v168, v137, v168 quad_perm:[1,1,1,1] row_mask:0xf bank_mask:0xf
    v_add_f32_dpp v4, v139, v4 quad_perm:[3,3,3,3] row_mask:0xf bank_mask:0xf
    v_add_f32 v168, v168, v4
    v_mfma_f32_16x16x32_bf16 v[152:155], a[16:19], v[28:31], 0
    v_mov_b32_dpp v169, v140 quad_perm:[0,0,0,0] row_mask:0xf bank_mask:0xf
    v_mov_b32_dpp v4, v142 quad_perm:[2,2,2,2] row_mask:0xf bank_mask:0xf
    s_nop 0
    v_add_f32_dpp v169, v141, v169 quad_perm:[1,1,1,1] row_mask:0xf bank_mask:0xf
    v_add_f32_dpp v4, v143, v4 quad_perm:[3,3,3,3] row_mask:0xf bank_mask:0xf
    v_add_f32 v169, v169, v4
    v_mfma_f32_16x16x32_bf16 v[156:159], a[20:23], v[28:31], 0
    v_mov_b32_dpp v170, v144 quad_perm:[0,0,0,0] row_mask:0xf bank_mask:0xf
    v_mov_b32_dpp v4, v146 quad_perm:[2,2,2,2] row_mask:0xf bank_mask:0xf
    s_nop 0
    v_add_f32_dpp v170, v145, v170 quad_perm:[1,1,1,1] row_mask:0xf bank_mask:0xf
    v_add_f32_dpp v4, v147, v4 quad_perm:[3,3,3,3] row_mask:0xf bank_mask:0xf
    v_add_f32 v170, v170, v4
    v_mfma_f32_16x16x32_bf16 v[160:163], a[24:27], v[28:31], 0
    v_mov_b32_dpp v171, v148 quad_perm:[0,0,0,0] row_mask:0xf bank_mask:0xf
    v_mov_b32_dpp v4, v150 quad_perm:[2,2,2,2] row_mask:0xf bank_mask:0xf
    s_nop 0
    v_add_f32_dpp v171, v149, v171 quad_perm:[1,1,1,1] row_mask:0xf bank_mask:0xf
    v_add_f32_dpp v4, v151, v4 quad_perm:[3,3,3,3] row_mask:0xf bank_mask:0xf
    v_add_f32 v171, v171, v4
    v_mfma_f32_16x16x32_bf16 v[164:167], a[28:31], v[28:31], 0
    v_mov_b32_dpp v172, v152 quad_perm:[0,0,0,0] row_mask:0xf bank_mask:0xf
    v_mov_b32_dpp v4, v154 quad_perm:[2,2,2,2] row_mask:0xf bank_mask:0xf
    s_nop 0
    v_add_f32_dpp v172, v153, v172 quad_perm:[1,1,1,1] row_mask:0xf bank_mask:0xf
    v_add_f32_dpp v4, v155, v4 quad_perm:[3,3,3,3] row_mask:0xf bank_mask:0xf
    v_add_f32 v172, v172, v4
    v_mfma_f32_16x16x32_bf16 v[136:139], a[32:35], v[28:31], 0
    v_mov_b32_dpp v173, v156 quad_perm:[0,0,0,0] row_mask:0xf bank_mask:0xf
    v_mov_b32_dpp v4, v158 quad_perm:[2,2,2,2] row_mask:0xf bank_mask:0xf
    s_nop 0
    v_add_f32_dpp v173, v157, v173 quad_perm:[1,1,1,1] row_mask:0xf bank_mask:0xf
    v_add_f32_dpp v4, v159, v4 quad_perm:[3,3,3,3] row_mask:0xf bank_mask:0xf
    v_add_f32 v173, v173, v4
    v_mfma_f32_16x16x32_bf16 v[140:143], a[36:39], v[28:31], 0
    v_mov_b32_dpp v174, v160 quad_perm:[0,0,0,0] row_mask:0xf bank_mask:0xf
    v_mov_b32_dpp v4, v162 quad_perm:[2,2,2,2] row_mask:0xf bank_mask:0xf
    s_nop 0
    v_add_f32_dpp v174, v161, v174 quad_perm:[1,1,1,1] row_mask:0xf bank_mask:0xf
    v_add_f32_dpp v4, v163, v4 quad_perm:[3,3,3,3] row_mask:0xf bank_mask:0xf
    v_add_f32 v174, v174, v4
    v_mfma_f32_16x16x32_bf16 v[144:147], a[40:43], v[28:31], 0
    v_mov_b32_dpp v175, v164 quad_perm:[0,0,0,0] row_mask:0xf bank_mask:0xf
    v_mov_b32_dpp v4, v166 quad_perm:[2,2,2,2] row_mask:0xf bank_mask:0xf
    s_nop 0
    v_add_f32_dpp v175, v165, v175 quad_perm:[1,1,1,1] row_mask:0xf bank_mask:0xf
    v_add_f32_dpp v4, v167, v4 quad_perm:[3,3,3,3] row_mask:0xf bank_mask:0xf
    v_add_f32 v175, v175, v4
    v_mfma_f32_16x16x32_bf16 v[148:151], a[44:47], v[28:31], 0
    v_mov_b32_dpp v176, v136 quad_perm:[0,0,0,0] row_mask:0xf bank_mask:0xf
    v_mov_b32_dpp v4, v138 quad_perm:[2,2,2,2] row_mask:0xf bank_mask:0xf
    s_nop 0
    v_add_f32_dpp v176, v137, v176 quad_perm:[1,1,1,1] row_mask:0xf bank_mask:0xf
    v_add_f32_dpp v4, v139, v4 quad_perm:[3,3,3,3] row_mask:0xf bank_mask:0xf
    v_add_f32 v176, v176, v4
    v_mfma_f32_16x16x32_bf16 v[152:155], a[48:51], v[28:31], 0
    v_mov_b32_dpp v177, v140 quad_perm:[0,0,0,0] row_mask:0xf bank_mask:0xf
    v_mov_b32_dpp v4, v142 quad_perm:[2,2,2,2] row_mask:0xf bank_mask:0xf
    s_nop 0
    v_add_f32_dpp v177, v141, v177 quad_perm:[1,1,1,1] row_mask:0xf bank_mask:0xf
    v_add_f32_dpp v4, v143, v4 quad_perm:[3,3,3,3] row_mask:0xf bank_mask:0xf
    v_add_f32 v177, v177, v4
    v_mfma_f32_16x16x32_bf16 v[156:159], a[52:55], v[28:31], 0
    v_mov_b32_dpp v178, v144 quad_perm:[0,0,0,0] row_mask:0xf bank_mask:0xf
    v_mov_b32_dpp v4, v146 quad_perm:[2,2,2,2] row_mask:0xf bank_mask:0xf
    s_nop 0
    v_add_f32_dpp v178, v145, v178 quad_perm:[1,1,1,1] row_mask:0xf bank_mask:0xf
    v_add_f32_dpp v4, v147, v4 quad_perm:[3,3,3,3] row_mask:0xf bank_mask:0xf
    v_add_f32 v178, v178, v4
    v_mfma_f32_16x16x32_bf16 v[160:163], a[56:59], v[28:31], 0
    v_mov_b32_dpp v179, v148 quad_perm:[0,0,0,0] row_mask:0xf bank_mask:0xf
    v_mov_b32_dpp v4, v150 quad_perm:[2,2,2,2] row_mask:0xf bank_mask:0xf
    s_nop 0
    v_add_f32_dpp v179, v149, v179 quad_perm:[1,1,1,1] row_mask:0xf bank_mask:0xf
    v_add_f32_dpp v4, v151, v4 quad_perm:[3,3,3,3] row_mask:0xf bank_mask:0xf
    v_add_f32 v179, v179, v4
    v_mfma_f32_16x16x32_bf16 v[164:167], a[60:63], v[28:31], 0
    v_mov_b32_dpp v180, v152 quad_perm:[0,0,0,0] row_mask:0xf bank_mask:0xf
    v_mov_b32_dpp v4, v154 quad_perm:[2,2,2,2] row_mask:0xf bank_mask:0xf
    s_nop 0
    v_add_f32_dpp v180, v153, v180 quad_perm:[1,1,1,1] row_mask:0xf bank_mask:0xf
    v_add_f32_dpp v4, v155, v4 quad_perm:[3,3,3,3] row_mask:0xf bank_mask:0xf
    v_add_f32 v180, v180, v4
    v_mfma_f32_16x16x32_bf16 v[136:139], a[64:67], v[28:31], 0
    v_mov_b32_dpp v181, v156 quad_perm:[0,0,0,0] row_mask:0xf bank_mask:0xf
    v_mov_b32_dpp v4, v158 quad_perm:[2,2,2,2] row_mask:0xf bank_mask:0xf
    s_nop 0
    v_add_f32_dpp v181, v157, v181 quad_perm:[1,1,1,1] row_mask:0xf bank_mask:0xf
    v_add_f32_dpp v4, v159, v4 quad_perm:[3,3,3,3] row_mask:0xf bank_mask:0xf
    v_add_f32 v181, v181, v4
    v_mfma_f32_16x16x32_bf16 v[140:143], a[68:71], v[28:31], 0
    v_mov_b32_dpp v182, v160 quad_perm:[0,0,0,0] row_mask:0xf bank_mask:0xf
    v_mov_b32_dpp v4, v162 quad_perm:[2,2,2,2] row_mask:0xf bank_mask:0xf
    s_nop 0
    v_add_f32_dpp v182, v161, v182 quad_perm:[1,1,1,1] row_mask:0xf bank_mask:0xf
    v_add_f32_dpp v4, v163, v4 quad_perm:[3,3,3,3] row_mask:0xf bank_mask:0xf
    v_add_f32 v182, v182, v4
    v_mfma_f32_16x16x32_bf16 v[144:147], a[72:75], v[28:31], 0
    v_mov_b32_dpp v183, v164 quad_perm:[0,0,0,0] row_mask:0xf bank_mask:0xf
    v_mov_b32_dpp v4, v166 quad_perm:[2,2,2,2] row_mask:0xf bank_mask:0xf
    s_nop 0
    v_add_f32_dpp v183, v165, v183 quad_perm:[1,1,1,1] row_mask:0xf bank_mask:0xf
    v_add_f32_dpp v4, v167, v4 quad_perm:[3,3,3,3] row_mask:0xf bank_mask:0xf
    v_add_f32 v183, v183, v4
    v_mfma_f32_16x16x32_bf16 v[148:151], a[76:79], v[28:31], 0
    v_mov_b32_dpp v184, v136 quad_perm:[0,0,0,0] row_mask:0xf bank_mask:0xf
    v_mov_b32_dpp v4, v138 quad_perm:[2,2,2,2] row_mask:0xf bank_mask:0xf
    s_nop 0
    v_add_f32_dpp v184, v137, v184 quad_perm:[1,1,1,1] row_mask:0xf bank_mask:0xf
    v_add_f32_dpp v4, v139, v4 quad_perm:[3,3,3,3] row_mask:0xf bank_mask:0xf
    v_add_f32 v184, v184, v4
    v_mfma_f32_16x16x32_bf16 v[152:155], a[80:83], v[28:31], 0
    v_mov_b32_dpp v185, v140 quad_perm:[0,0,0,0] row_mask:0xf bank_mask:0xf
    v_mov_b32_dpp v4, v142 quad_perm:[2,2,2,2] row_mask:0xf bank_mask:0xf
    s_nop 0
    v_add_f32_dpp v185, v141, v185 quad_perm:[1,1,1,1] row_mask:0xf bank_mask:0xf
    v_add_f32_dpp v4, v143, v4 quad_perm:[3,3,3,3] row_mask:0xf bank_mask:0xf
    v_add_f32 v185, v185, v4
    v_mfma_f32_16x16x32_bf16 v[156:159], a[84:87], v[28:31], 0
    v_mov_b32_dpp v186, v144 quad_perm:[0,0,0,0] row_mask:0xf bank_mask:0xf
    v_mov_b32_dpp v4, v146 quad_perm:[2,2,2,2] row_mask:0xf bank_mask:0xf
    s_nop 0
    v_add_f32_dpp v186, v145, v186 quad_perm:[1,1,1,1] row_mask:0xf bank_mask:0xf
    v_add_f32_dpp v4, v147, v4 quad_perm:[3,3,3,3] row_mask:0xf bank_mask:0xf
    v_add_f32 v186, v186, v4
    v_mfma_f32_16x16x32_bf16 v[160:163], a[88:91], v[28:31], 0
    v_mov_b32_dpp v187, v148 quad_perm:[0,0,0,0] row_mask:0xf bank_mask:0xf
    v_mov_b32_dpp v4, v150 quad_perm:[2,2,2,2] row_mask:0xf bank_mask:0xf
    s_nop 0
    v_add_f32_dpp v187, v149, v187 quad_perm:[1,1,1,1] row_mask:0xf bank_mask:0xf
    v_add_f32_dpp v4, v151, v4 quad_perm:[3,3,3,3] row_mask:0xf bank_mask:0xf
    v_add_f32 v187, v187, v4
    v_mfma_f32_16x16x32_bf16 v[164:167], a[92:95], v[28:31], 0
    v_mov_b32_dpp v188, v152 quad_perm:[0,0,0,0] row_mask:0xf bank_mask:0xf
    v_mov_b32_dpp v4, v154 quad_perm:[2,2,2,2] row_mask:0xf bank_mask:0xf
    s_nop 0
    v_add_f32_dpp v188, v153, v188 quad_perm:[1,1,1,1] row_mask:0xf bank_mask:0xf
    v_add_f32_dpp v4, v155, v4 quad_perm:[3,3,3,3] row_mask:0xf bank_mask:0xf
    v_add_f32 v188, v188, v4
    v_mfma_f32_16x16x32_bf16 v[136:139], a[96:99], v[28:31], 0
    v_mov_b32_dpp v189, v156 quad_perm:[0,0,0,0] row_mask:0xf bank_mask:0xf
    v_mov_b32_dpp v4, v158 quad_perm:[2,2,2,2] row_mask:0xf bank_mask:0xf
    s_nop 0
    v_add_f32_dpp v189, v157, v189 quad_perm:[1,1,1,1] row_mask:0xf bank_mask:0xf
    v_add_f32_dpp v4, v159, v4 quad_perm:[3,3,3,3] row_mask:0xf bank_mask:0xf
    v_add_f32 v189, v189, v4
    v_mfma_f32_16x16x32_bf16 v[140:143], a[100:103], v[28:31], 0
    v_mov_b32_dpp v190, v160 quad_perm:[0,0,0,0] row_mask:0xf bank_mask:0xf
    v_mov_b32_dpp v4, v162 quad_perm:[2,2,2,2] row_mask:0xf bank_mask:0xf
    s_nop 0
    v_add_f32_dpp v190, v161, v190 quad_perm:[1,1,1,1] row_mask:0xf bank_mask:0xf
    v_add_f32_dpp v4, v163, v4 quad_perm:[3,3,3,3] row_mask:0xf bank_mask:0xf
    v_add_f32 v190, v190, v4
    v_mfma_f32_16x16x32_bf16 v[144:147], a[104:107], v[28:31], 0
    v_mov_b32_dpp v191, v164 quad_perm:[0,0,0,0] row_mask:0xf bank_mask:0xf
    v_mov_b32_dpp v4, v166 quad_perm:[2,2,2,2] row_mask:0xf bank_mask:0xf
    s_nop 0
    v_add_f32_dpp v191, v165, v191 quad_perm:[1,1,1,1] row_mask:0xf bank_mask:0xf
    v_add_f32_dpp v4, v167, v4 quad_perm:[3,3,3,3] row_mask:0xf bank_mask:0xf
    v_add_f32 v191, v191, v4
    v_mfma_f32_16x16x32_bf16 v[148:151], a[108:111], v[28:31], 0
    v_mov_b32_dpp v192, v136 quad_perm:[0,0,0,0] row_mask:0xf bank_mask:0xf
    v_mov_b32_dpp v4, v138 quad_perm:[2,2,2,2] row_mask:0xf bank_mask:0xf
    s_nop 0
    v_add_f32_dpp v192, v137, v192 quad_perm:[1,1,1,1] row_mask:0xf bank_mask:0xf
    v_add_f32_dpp v4, v139, v4 quad_perm:[3,3,3,3] row_mask:0xf bank_mask:0xf
    v_add_f32 v192, v192, v4
    v_mfma_f32_16x16x32_bf16 v[152:155], a[112:115], v[28:31], 0
    v_mov_b32_dpp v193, v140 quad_perm:[0,0,0,0] row_mask:0xf bank_mask:0xf
    v_mov_b32_dpp v4, v142 quad_perm:[2,2,2,2] row_mask:0xf bank_mask:0xf
    s_nop 0
    v_add_f32_dpp v193, v141, v193 quad_perm:[1,1,1,1] row_mask:0xf bank_mask:0xf
    v_add_f32_dpp v4, v143, v4 quad_perm:[3,3,3,3] row_mask:0xf bank_mask:0xf
    v_add_f32 v193, v193, v4
    v_mfma_f32_16x16x32_bf16 v[156:159], a[116:119], v[28:31], 0
    v_mov_b32_dpp v194, v144 quad_perm:[0,0,0,0] row_mask:0xf bank_mask:0xf
    v_mov_b32_dpp v4, v146 quad_perm:[2,2,2,2] row_mask:0xf bank_mask:0xf
    s_nop 0
    v_add_f32_dpp v194, v145, v194 quad_perm:[1,1,1,1] row_mask:0xf bank_mask:0xf
    v_add_f32_dpp v4, v147, v4 quad_perm:[3,3,3,3] row_mask:0xf bank_mask:0xf
    v_add_f32 v194, v194, v4
    v_mfma_f32_16x16x32_bf16 v[160:163], a[120:123], v[28:31], 0
    v_mov_b32_dpp v195, v148 quad_perm:[0,0,0,0] row_mask:0xf bank_mask:0xf
    v_mov_b32_dpp v4, v150 quad_perm:[2,2,2,2] row_mask:0xf bank_mask:0xf
    s_nop 0
    v_add_f32_dpp v195, v149, v195 quad_perm:[1,1,1,1] row_mask:0xf bank_mask:0xf
    v_add_f32_dpp v4, v151, v4 quad_perm:[3,3,3,3] row_mask:0xf bank_mask:0xf
    v_add_f32 v195, v195, v4
    v_mfma_f32_16x16x32_bf16 v[164:167], a[124:127], v[28:31], 0
    v_mov_b32_dpp v196, v152 quad_perm:[0,0,0,0] row_mask:0xf bank_mask:0xf
    v_mov_b32_dpp v4, v154 quad_perm:[2,2,2,2] row_mask:0xf bank_mask:0xf
    s_nop 0
    v_add_f32_dpp v196, v153, v196 quad_perm:[1,1,1,1] row_mask:0xf bank_mask:0xf
    v_add_f32_dpp v4, v155, v4 quad_perm:[3,3,3,3] row_mask:0xf bank_mask:0xf
    v_add_f32 v196, v196, v4
    v_mov_b32_dpp v197, v156 quad_perm:[0,0,0,0] row_mask:0xf bank_mask:0xf
    v_mov_b32_dpp v4, v158 quad_perm:[2,2,2,2] row_mask:0xf bank_mask:0xf
    s_nop 0
    v_add_f32_dpp v197, v157, v197 quad_perm:[1,1,1,1] row_mask:0xf bank_mask:0xf
    v_add_f32_dpp v4, v159, v4 quad_perm:[3,3,3,3] row_mask:0xf bank_mask:0xf
    v_add_f32 v197, v197, v4
    v_mov_b32_dpp v198, v160 quad_perm:[0,0,0,0] row_mask:0xf bank_mask:0xf
    v_mov_b32_dpp v4, v162 quad_perm:[2,2,2,2] row_mask:0xf bank_mask:0xf
    s_nop 0
    v_add_f32_dpp v198, v161, v198 quad_perm:[1,1,1,1] row_mask:0xf bank_mask:0xf
    v_add_f32_dpp v4, v163, v4 quad_perm:[3,3,3,3] row_mask:0xf bank_mask:0xf
    v_add_f32 v198, v198, v4
    v_mov_b32_dpp v199, v164 quad_perm:[0,0,0,0] row_mask:0xf bank_mask:0xf
    v_mov_b32_dpp v4, v166 quad_perm:[2,2,2,2] row_mask:0xf bank_mask:0xf
    s_nop 0
    v_add_f32_dpp v199, v165, v199 quad_perm:[1,1,1,1] row_mask:0xf bank_mask:0xf
    v_add_f32_dpp v4, v167, v4 quad_perm:[3,3,3,3] row_mask:0xf bank_mask:0xf
    v_add_f32 v199, v199, v4
    v_cvt_pk_bf16_f32 v200, v168, v169
    v_cvt_pk_bf16_f32 v201, v170, v171
    v_cvt_pk_bf16_f32 v202, v172, v173
    v_cvt_pk_bf16_f32 v203, v174, v175
    v_cvt_pk_bf16_f32 v204, v176, v177
    v_cvt_pk_bf16_f32 v205, v178, v179
    v_cvt_pk_bf16_f32 v206, v180, v181
    v_cvt_pk_bf16_f32 v207, v182, v183
    v_cvt_pk_bf16_f32 v208, v184, v185
    v_cvt_pk_bf16_f32 v209, v186, v187
    v_cvt_pk_bf16_f32 v210, v188, v189
    v_cvt_pk_bf16_f32 v211, v190, v191
    v_cvt_pk_bf16_f32 v212, v192, v193
    v_cvt_pk_bf16_f32 v213, v194, v195
    v_cvt_pk_bf16_f32 v214, v196, v197
    v_cvt_pk_bf16_f32 v215, v198, v199
    s_mov_b32 exec_lo, 0x22222222
    s_mov_b32 exec_hi, 0x22222222
    v_mov_b32 v200, v204
    v_mov_b32 v201, v205
    v_mov_b32 v202, v206
    v_mov_b32 v203, v207
    s_mov_b32 exec_lo, 0x44444444
    s_mov_b32 exec_hi, 0x44444444
    v_mov_b32 v200, v208
    v_mov_b32 v201, v209
    v_mov_b32 v202, v210
    v_mov_b32 v203, v211
    s_mov_b32 exec_lo, 0x88888888
    s_mov_b32 exec_hi, 0x88888888
    v_mov_b32 v200, v212
    v_mov_b32 v201, v213
    v_mov_b32 v202, v214
    v_mov_b32 v203, v215
    s_mov_b64 exec, -1
    v_lshrrev_b32 v4, 2, v3
    v_and_b32 v5, 3, v3
    v_lshlrev_b32 v6, 15, v4
    v_lshl_add_u32 v6, v2, 6, v6
    v_lshl_add_u32 v6, v5, 4, v6
    s_lshl_b32 s36, s32, 10
    s_lshl_b32 s38, s34, 8
    s_add_u32 s36, s36, s38
    s_add_u32 s36, s36, 2097152
    buffer_store_dwordx4 v[200:203], v6, s[48:51], s36 offen sc1
    s_add_u32 s39, s90, s94
    s_mov_b32 m0, s39
    s_nop 0
    buffer_load_dwordx4 v76, s[52:55], s95 offen offset:0 nt lds
    buffer_load_dwordx4 v77, s[52:55], s95 offen offset:1024 nt lds
    buffer_load_dwordx4 v78, s[52:55], s95 offen offset:2048 nt lds
    buffer_load_dwordx4 v79, s[52:55], s95 offen offset:3072 nt lds
    s_add_u32 s95, s95, 16384
    s_add_u32 s39, s90, s94
    s_add_u32 s39, s39, 4096
    s_mov_b32 m0, s39
    s_nop 0
    buffer_load_dwordx4 v76, s[52:55], s95 offen offset:0 nt lds
    buffer_load_dwordx4 v77, s[52:55], s95 offen offset:1024 nt lds
    buffer_load_dwordx4 v78, s[52:55], s95 offen offset:2048 nt lds
    buffer_load_dwordx4 v79, s[52:55], s95 offen offset:3072 nt lds
    s_add_u32 s95, s95, 16384
    s_add_u32 s94, s94, 8192
    s_and_b32 s94, s94, 0x7fff
    s_mov_b32 s76, s28
    s_and_b32 s77, s29, 0xffff
    s_mov_b32 s78, 256
    s_mov_b32 s79, 0x20000
    s_mov_b32 s60, s12
    s_and_b32 s61, s13, 0xffff
    s_mov_b32 s62, 4194304
    s_mov_b32 s63, 0x20000
    s_mov_b32 s64, s14
    s_and_b32 s65, s15, 0xffff
    s_mov_b32 s66, 4194304
    s_mov_b32 s67, 0x20000
    s_mov_b32 s68, s24
    s_and_b32 s69, s25, 0xffff
    s_mov_b32 s70, 4194304
    s_mov_b32 s71, 0x20000
    s_mov_b32 s72, s26
    s_and_b32 s73, s27, 0xffff
    s_mov_b32 s74, 8192
    s_mov_b32 s75, 0x20000
    v_mov_b32 v100, 0
    v_mov_b32 v101, 1
    v_lshlrev_b32 v4, 4, v3
    v_lshl_add_u32 v19, v2, 13, v4
    v_lshl_add_u32 v9, v2, 10, v4
    s_waitcnt vmcnt(8)
    s_barrier
    s_cmp_lg_u32 s34, 0
    s_cbranch_scc1 L_nosig_11
    s_mov_b64 exec, 1
    buffer_atomic_add v101, v100, s[76:79], 0 offen offset:0 sc1
    s_mov_b64 exec, -1
L_nosig_11:
    s_add_u32 s39, s90, s94
    s_mov_b32 m0, s39
    s_nop 0
    buffer_load_dwordx4 v76, s[52:55], s95 offen offset:0 nt lds
    buffer_load_dwordx4 v77, s[52:55], s95 offen offset:1024 nt lds
    buffer_load_dwordx4 v78, s[52:55], s95 offen offset:2048 nt lds
    buffer_load_dwordx4 v79, s[52:55], s95 offen offset:3072 nt lds
    s_add_u32 s95, s95, 16384
    s_add_u32 s39, s90, s94
    s_add_u32 s39, s39, 4096
    s_mov_b32 m0, s39
    s_nop 0
    buffer_load_dwordx4 v76, s[52:55], s95 offen offset:0 nt lds
    buffer_load_dwordx4 v77, s[52:55], s95 offen offset:1024 nt lds
    buffer_load_dwordx4 v78, s[52:55], s95 offen offset:2048 nt lds
    buffer_load_dwordx4 v79, s[52:55], s95 offen offset:3072 nt lds
    s_add_u32 s95, s95, 16384
    s_add_u32 s94, s94, 8192
    s_and_b32 s94, s94, 0x7fff
    s_mov_b32 s85, s89
    s_lshl_b32 s86, s32, 17
    s_lshl_b32 s38, s34, 8
    s_add_u32 s86, s86, s38
    buffer_load_dword v7, v100, s[76:79], 0 offen offset:0 sc1
    buffer_load_dwordx4 a[128:131], v19, s[60:63], s85 offen nt
    s_add_u32 s85, s85, 32768
    buffer_load_dwordx4 a[132:135], v19, s[60:63], s85 offen nt
    s_add_u32 s85, s85, 32768
    buffer_load_dwordx4 a[136:139], v19, s[60:63], s85 offen nt
    s_add_u32 s85, s85, 32768
    buffer_load_dwordx4 a[140:143], v19, s[60:63], s85 offen nt
    s_add_u32 s85, s85, 32768
    buffer_load_dwordx4 a[144:147], v19, s[60:63], s85 offen nt
    s_add_u32 s85, s85, 32768
    buffer_load_dwordx4 a[148:151], v19, s[60:63], s85 offen nt
    s_add_u32 s85, s85, 32768
    buffer_load_dwordx4 a[152:155], v19, s[60:63], s85 offen nt
    s_add_u32 s85, s85, 32768
    buffer_load_dwordx4 a[156:159], v19, s[60:63], s85 offen nt
    s_add_u32 s85, s85, 32768
    s_waitcnt vmcnt(8)
L_fcheck_12:
    v_cmp_gt_u32 vcc, 32, v7
    s_cbranch_vccz L_fok_13
    s_sleep 4
    buffer_load_dword v7, v100, s[76:79], 0 offen offset:0 sc1
    s_waitcnt vmcnt(0)
    s_sub_u32 s84, s84, 1
    s_cmp_lg_u32 s84, 0
    s_cbranch_scc1 L_fcheck_12
    s_branch L_end
L_fok_13:
    s_lshr_b32 s36, s32, 3
    s_lshl_b32 s36, s36, 15
    s_lshl_b32 s38, s34, 8
    s_add_u32 s36, s36, s38
    s_add_u32 s36, s36, 2097152
    buffer_load_dwordx4 v[20:23], v9, s[48:51], s36 offen sc1
    s_add_u32 s36, s36, 4096
    buffer_load_dwordx4 v[24:27], v9, s[48:51], s36 offen sc1
    s_add_u32 s36, s36, 4096
    buffer_load_dwordx4 v[28:31], v9, s[48:51], s36 offen sc1
    s_add_u32 s36, s36, 4096
    buffer_load_dwordx4 v[32:35], v9, s[48:51], s36 offen sc1
    s_add_u32 s36, s36, 4096
    buffer_load_dwordx4 v[36:39], v9, s[48:51], s36 offen sc1
    s_add_u32 s36, s36, 4096
    buffer_load_dwordx4 v[40:43], v9, s[48:51], s36 offen sc1
    s_add_u32 s36, s36, 4096
    buffer_load_dwordx4 v[44:47], v9, s[48:51], s36 offen sc1
    s_add_u32 s36, s36, 4096
    buffer_load_dwordx4 v[48:51], v9, s[48:51], s36 offen sc1
    buffer_load_dwordx4 a[160:163], v19, s[60:63], s85 offen nt
    s_add_u32 s85, s85, 32768
    buffer_load_dwordx4 a[164:167], v19, s[60:63], s85 offen nt
    s_add_u32 s85, s85, 32768
    buffer_load_dwordx4 a[168:171], v19, s[60:63], s85 offen nt
    s_add_u32 s85, s85, 32768
    buffer_load_dwordx4 a[172:175], v19, s[60:63], s85 offen nt
    s_add_u32 s85, s85, 32768
    buffer_load_dwordx4 a[176:179], v19, s[60:63], s85 offen nt
    s_add_u32 s85, s85, 32768
    buffer_load_dwordx4 a[180:183], v19, s[60:63], s85 offen nt
    s_add_u32 s85, s85, 32768
    buffer_load_dwordx4 a[184:187], v19, s[60:63], s85 offen nt
    s_add_u32 s85, s85, 32768
    buffer_load_dwordx4 a[188:191], v19, s[60:63], s85 offen nt
    s_add_u32 s85, s85, 32768
    v_and_b32 v4, 3, v1
    v_bfe_u32 v5, v1, 2, 2
    v_lshrrev_b32 v6, 5, v1
    v_lshl_add_u32 v7, v4, 2, v5
    v_xor_b32 v7, v7, v6
    v_lshlrev_b32 v7, 4, v7
    v_and_b32 v80, 31, v1
    v_lshl_add_u32 v80, v80, 8, v7
    v_lshl_add_u32 v81, v6, 2, v5
    v_lshlrev_b32 v81, 8, v81
    v_lshl_add_u32 v81, v5, 6, v81
    v_bfe_u32 v7, v1, 4, 1
    v_lshlrev_b32 v7, 1, v7
    v_bfe_u32 v124, v1, 1, 1
    v_add_u32 v7, v7, v124
    v_xor_b32 v7, v7, v6
    v_lshl_add_u32 v81, v7, 4, v81
    v_and_b32 v7, 1, v1
    v_lshl_add_u32 v81, v7, 3, v81
    v_lshl_add_u32 v95, v2, 3, v5
    v_lshlrev_b32 v95, 8, v95
    v_lshl_add_u32 v95, v5, 6, v95
    v_bfe_u32 v4, v1, 4, 1
    v_lshl_add_u32 v4, v4, 1, v124
    v_lshl_add_u32 v95, v4, 4, v95
    v_lshl_add_u32 v95, v7, 3, v95
    v_add_u32 v95, s90, v95
    s_lshl_b32 s37, s34, 13
    s_add_u32 s37, s37, 131072
    v_lshl_add_u32 v94, v1, 4, s37
    s_sub_u32 s38, s37, s90
    v_add_u32 v82, s38, v96
    v_add_u32 v83, s38, v97
    v_add_u32 v84, s38, v98
    v_add_u32 v85, s38, v99
    s_waitcnt vmcnt(8)
    ds_write_b128 v82, v[20:23] offset:0
    ds_write_b128 v83, v[24:27] offset:1024
    ds_write_b128 v84, v[28:31] offset:2048
    ds_write_b128 v85, v[32:35] offset:3072
    ds_write_b128 v82, v[36:39] offset:4096
    ds_write_b128 v83, v[40:43] offset:5120
    ds_write_b128 v84, v[44:47] offset:6144
    ds_write_b128 v85, v[48:51] offset:7168
    v_add_u32 v4, s37, v80
    v_xor_b32 v82, 0, v4
    v_xor_b32 v83, 32, v4
    v_xor_b32 v84, 64, v4
    v_xor_b32 v85, 96, v4
    v_xor_b32 v86, 128, v4
    v_xor_b32 v87, 160, v4
    v_xor_b32 v88, 192, v4
    v_xor_b32 v89, 224, v4
    s_waitcnt lgkmcnt(0)
    ds_read_b128 v[104:107], v82
    ds_read_b128 v[108:111], v83
    ds_read_b128 v[112:115], v84
    ds_read_b128 v[116:119], v85
    ds_read_b128 v[120:123], v86
    ds_read_b128 v[124:127], v87
    ds_read_b128 v[128:131], v88
    ds_read_b128 v[132:135], v89
    v_mov_b32 v136, 0
    v_mov_b32 v137, 0
    v_mov_b32 v138, 0
    v_mov_b32 v139, 0
    v_mov_b32 v140, 0
    v_mov_b32 v141, 0
    v_mov_b32 v142, 0
    v_mov_b32 v143, 0
    v_mov_b32 v144, 0
    v_mov_b32 v145, 0
    v_mov_b32 v146, 0
    v_mov_b32 v147, 0
    v_mov_b32 v148, 0
    v_mov_b32 v149, 0
    v_mov_b32 v150, 0
    v_mov_b32 v151, 0
    v_mov_b32 v152, 0
    v_mov_b32 v153, 0
    v_mov_b32 v154, 0
    v_mov_b32 v155, 0
    v_mov_b32 v156, 0
    v_mov_b32 v157, 0
    v_mov_b32 v158, 0
    v_mov_b32 v159, 0
    v_mov_b32 v160, 0
    v_mov_b32 v161, 0
    v_mov_b32 v162, 0
    v_mov_b32 v163, 0
    v_mov_b32 v164, 0
    v_mov_b32 v165, 0
    v_mov_b32 v166, 0
    v_mov_b32 v167, 0
    v_mov_b32 v168, 0
    v_mov_b32 v169, 0
    v_mov_b32 v170, 0
    v_mov_b32 v171, 0
    v_mov_b32 v172, 0
    v_mov_b32 v173, 0
    v_mov_b32 v174, 0
    v_mov_b32 v175, 0
    v_mov_b32 v176, 0
    v_mov_b32 v177, 0
    v_mov_b32 v178, 0
    v_mov_b32 v179, 0
    v_mov_b32 v180, 0
    v_mov_b32 v181, 0
    v_mov_b32 v182, 0
    v_mov_b32 v183, 0
    v_mov_b32 v184, 0
    v_mov_b32 v185, 0
    v_mov_b32 v186, 0
    v_mov_b32 v187, 0
    v_mov_b32 v188, 0
    v_mov_b32 v189, 0
    v_mov_b32 v190, 0
    v_mov_b32 v191, 0
    v_mov_b32 v192, 0
    v_mov_b32 v193, 0
    v_mov_b32 v194, 0
    v_mov_b32 v195, 0
    v_mov_b32 v196, 0
    v_mov_b32 v197, 0
    v_mov_b32 v198, 0
    v_mov_b32 v199, 0
    v_mov_b32 v90, 0xff7f0000
    v_mov_b32 v91, 0
    s_mov_b32 s93, 0
    v_add_u32 v80, s90, v80
    v_add_u32 v81, s90, v81
    s_waitcnt lgkmcnt(0)
L_att:
    v_add_u32 v4, s94, v80
    v_xor_b32 v82, 0, v4
    v_xor_b32 v83, 32, v4
    v_xor_b32 v84, 64, v4
    v_xor_b32 v85, 96, v4
    v_xor_b32 v86, 128, v4
    v_xor_b32 v87, 160, v4
    v_xor_b32 v88, 192, v4
    v_xor_b32 v89, 224, v4
    s_waitcnt vmcnt(24)
    ds_read_b128 v[20:23], v82
    ds_read_b128 v[24:27], v83
    ds_read_b128 v[28:31], v84
    ds_read_b128 v[32:35], v85
    ds_read_b128 v[36:39], v86
    ds_read_b128 v[40:43], v87
    ds_read_b128 v[44:47], v88
    ds_read_b128 v[48:51], v89
    v_add_u32 v4, s94, v81
    s_waitcnt lgkmcnt(7)
    v_mfma_f32_32x32x16_bf16 v[200:215], v[20:23], v[104:107], 0
    v_xor_b32 v82, 0, v4
    s_waitcnt lgkmcnt(6)
    v_mfma_f32_32x32x16_bf16 v[200:215], v[24:27], v[108:111], v[200:215]
    v_xor_b32 v83, 32, v4
    s_waitcnt lgkmcnt(5)
    v_mfma_f32_32x32x16_bf16 v[200:215], v[28:31], v[112:115], v[200:215]
    v_xor_b32 v84, 64, v4
    s_waitcnt lgkmcnt(4)
    v_mfma_f32_32x32x16_bf16 v[200:215], v[32:35], v[116:119], v[200:215]
    v_xor_b32 v85, 96, v4
    s_waitcnt lgkmcnt(3)
    v_mfma_f32_32x32x16_bf16 v[200:215], v[36:39], v[120:123], v[200:215]
    v_xor_b32 v86, 128, v4
    s_waitcnt lgkmcnt(2)
    v_mfma_f32_32x32x16_bf16 v[200:215], v[40:43], v[124:127], v[200:215]
    v_xor_b32 v87, 160, v4
    s_waitcnt lgkmcnt(1)
    v_mfma_f32_32x32x16_bf16 v[200:215], v[44:47], v[128:131], v[200:215]
    v_xor_b32 v88, 192, v4
    s_waitcnt lgkmcnt(0)
    v_mfma_f32_32x32x16_bf16 v[200:215], v[48:51], v[132:135], v[200:215]
    v_xor_b32 v89, 224, v4
    ds_read_b64_tr_b16 v[20:21], v82 offset:0
    ds_read_b64_tr_b16 v[22:23], v83 offset:2048
    ds_read_b64_tr_b16 v[24:25], v82 offset:4096
    ds_read_b64_tr_b16 v[26:27], v83 offset:6144
    ds_read_b64_tr_b16 v[28:29], v84 offset:0
    ds_read_b64_tr_b16 v[30:31], v85 offset:2048
    ds_read_b64_tr_b16 v[32:33], v84 offset:4096
    ds_read_b64_tr_b16 v[34:35], v85 offset:6144
    ds_read_b64_tr_b16 v[36:37], v86 offset:0
    ds_read_b64_tr_b16 v[38:39], v87 offset:2048
    ds_read_b64_tr_b16 v[40:41], v86 offset:4096
    ds_read_b64_tr_b16 v[42:43], v87 offset:6144
    ds_read_b64_tr_b16 v[44:45], v88 offset:0
    ds_read_b64_tr_b16 v[46:47], v89 offset:2048
    ds_read_b64_tr_b16 v[48:49], v88 offset:4096
    ds_read_b64_tr_b16 v[50:51], v89 offset:6144
    v_xor_b32 v5, 0x2000, v94
    v_xor_b32 v6, 0x4000, v94
    v_xor_b32 v7, 0x6000, v94
    ds_write_b128 v94, v[200:203] offset:0
    ds_write_b128 v94, v[204:207] offset:1024
    ds_write_b128 v94, v[208:211] offset:2048
    ds_write_b128 v94, v[212:215] offset:3072
    s_waitcnt lgkmcnt(0)
    s_barrier
    ds_read_b128 v[60:63], v5 offset:0
    ds_read_b128 v[216:219], v6 offset:0
    ds_read_b128 v[232:235], v7 offset:0
    ds_read_b128 v[64:67], v5 offset:1024
    ds_read_b128 v[220:223], v6 offset:1024
    ds_read_b128 v[236:239], v7 offset:1024
    ds_read_b128 v[68:71], v5 offset:2048
    ds_read_b128 v[224:227], v6 offset:2048
    ds_read_b128 v[240:243], v7 offset:2048
    ds_read_b128 v[72:75], v5 offset:3072
    ds_read_b128 v[228:231], v6 offset:3072
    ds_read_b128 v[244:247], v7 offset:3072
    v_xor_b32 v94, 0x1000, v94
    s_cmp_ge_u32 s93, 12
    s_cbranch_scc1 L_fill0_14
    s_add_u32 s39, s90, s94
    s_mov_b32 m0, s39
    s_nop 0
    buffer_load_dwordx4 v76, s[52:55], s95 offen offset:0 nt lds
    buffer_load_dwordx4 v77, s[52:55], s95 offen offset:1024 nt lds
    buffer_load_dwordx4 v78, s[52:55], s95 offen offset:2048 nt lds
    buffer_load_dwordx4 v79, s[52:55], s95 offen offset:3072 nt lds
    s_add_u32 s95, s95, 16384
    s_add_u32 s39, s90, s94
    s_add_u32 s39, s39, 4096
    s_mov_b32 m0, s39
    s_nop 0
    buffer_load_dwordx4 v76, s[52:55], s95 offen offset:0 nt lds
    buffer_load_dwordx4 v77, s[52:55], s95 offen offset:1024 nt lds
    buffer_load_dwordx4 v78, s[52:55], s95 offen offset:2048 nt lds
    buffer_load_dwordx4 v79, s[52:55], s95 offen offset:3072 nt lds
    s_add_u32 s95, s95, 16384
L_filled_18:
    s_add_u32 s94, s94, 8192
    s_and_b32 s94, s94, 0x7fff
    s_waitcnt lgkmcnt(9)
    v_add_f32 v200, v200, v60
    v_add_f32 v216, v216, v232
    v_add_f32 v201, v201, v61
    v_add_f32 v217, v217, v233
    v_add_f32 v202, v202, v62
    v_add_f32 v218, v218, v234
    v_add_f32 v203, v203, v63
    v_add_f32 v219, v219, v235
    v_add_f32 v200, v200, v216
    v_add_f32 v201, v201, v217
    v_add_f32 v202, v202, v218
    v_add_f32 v203, v203, v219
    s_waitcnt lgkmcnt(6)
    v_add_f32 v204, v204, v64
    v_add_f32 v220, v220, v236
    v_add_f32 v205, v205, v65
    v_add_f32 v221, v221, v237
    v_add_f32 v206, v206, v66
    v_add_f32 v222, v222, v238
    v_add_f32 v207, v207, v67
    v_add_f32 v223, v223, v239
    v_add_f32 v204, v204, v220
    v_add_f32 v205, v205, v221
    v_add_f32 v206, v206, v222
    v_add_f32 v207, v207, v223
    s_waitcnt lgkmcnt(3)
    v_add_f32 v208, v208, v68
    v_add_f32 v224, v224, v240
    v_add_f32 v209, v209, v69
    v_add_f32 v225, v225, v241
    v_add_f32 v210, v210, v70
    v_add_f32 v226, v226, v242
    v_add_f32 v211, v211, v71
    v_add_f32 v227, v227, v243
    v_add_f32 v208, v208, v224
    v_add_f32 v209, v209, v225
    v_add_f32 v210, v210, v226
    v_add_f32 v211, v211, v227
    s_waitcnt lgkmcnt(0)
    v_add_f32 v212, v212, v72
    v_add_f32 v228, v228, v244
    v_add_f32 v213, v213, v73
    v_add_f32 v229, v229, v245
    v_add_f32 v214, v214, v74
    v_add_f32 v230, v230, v246
    v_add_f32 v215, v215, v75
    v_add_f32 v231, v231, v247
    v_add_f32 v212, v212, v228
    v_add_f32 v213, v213, v229
    v_add_f32 v214, v214, v230
    v_add_f32 v215, v215, v231
    v_max_f32 v4, v200, v201
    v_max3_f32 v4, v4, v202, v203
    v_max3_f32 v4, v4, v204, v205
    v_max3_f32 v4, v4, v206, v207
    v_max3_f32 v4, v4, v208, v209
    v_max3_f32 v4, v4, v210, v211
    v_max3_f32 v4, v4, v212, v213
    v_max3_f32 v4, v4, v214, v215
    v_mov_b32 v5, v4
    s_nop 1
    v_permlane32_swap_b32 v4, v5
    v_max_f32 v4, v4, v5
    v_mul_f32 v4, s83, v4
    v_max_f32 v4, v4, v90
    v_sub_f32 v92, v90, v4
    v_exp_f32 v92, v92
    v_mov_b32 v90, v4
    v_fma_f32 v200, v200, s83, -v90
    v_fma_f32 v201, v201, s83, -v90
    v_fma_f32 v202, v202, s83, -v90
    v_fma_f32 v203, v203, s83, -v90
    v_fma_f32 v204, v204, s83, -v90
    v_fma_f32 v205, v205, s83, -v90
    v_fma_f32 v206, v206, s83, -v90
    v_fma_f32 v207, v207, s83, -v90
    v_fma_f32 v208, v208, s83, -v90
    v_fma_f32 v209, v209, s83, -v90
    v_fma_f32 v210, v210, s83, -v90
    v_fma_f32 v211, v211, s83, -v90
    v_fma_f32 v212, v212, s83, -v90
    v_fma_f32 v213, v213, s83, -v90
    v_fma_f32 v214, v214, s83, -v90
    v_fma_f32 v215, v215, s83, -v90
    v_mul_f32 v91, v91, v92
    v_exp_f32 v200, v200
    v_pk_mul_f32 v[136:137], v[136:137], v[92:93] op_sel_hi:[1,0]
    v_pk_mul_f32 v[138:139], v[138:139], v[92:93] op_sel_hi:[1,0]
    v_exp_f32 v201, v201
    v_pk_mul_f32 v[140:141], v[140:141], v[92:93] op_sel_hi:[1,0]
    v_pk_mul_f32 v[142:143], v[142:143], v[92:93] op_sel_hi:[1,0]
    v_exp_f32 v202, v202
    v_pk_mul_f32 v[144:145], v[144:145], v[92:93] op_sel_hi:[1,0]
    v_pk_mul_f32 v[146:147], v[146:147], v[92:93] op_sel_hi:[1,0]
    v_exp_f32 v203, v203
    v_pk_mul_f32 v[148:149], v[148:149], v[92:93] op_sel_hi:[1,0]
    v_pk_mul_f32 v[150:151], v[150:151], v[92:93] op_sel_hi:[1,0]
    v_exp_f32 v204, v204
    v_pk_mul_f32 v[152:153], v[152:153], v[92:93] op_sel_hi:[1,0]
    v_pk_mul_f32 v[154:155], v[154:155], v[92:93] op_sel_hi:[1,0]
    v_exp_f32 v205, v205
    v_pk_mul_f32 v[156:157], v[156:157], v[92:93] op_sel_hi:[1,0]
    v_pk_mul_f32 v[158:159], v[158:159], v[92:93] op_sel_hi:[1,0]
    v_exp_f32 v206, v206
    v_pk_mul_f32 v[160:161], v[160:161], v[92:93] op_sel_hi:[1,0]
    v_pk_mul_f32 v[162:163], v[162:163], v[92:93] op_sel_hi:[1,0]
    v_exp_f32 v207, v207
    v_pk_mul_f32 v[164:165], v[164:165], v[92:93] op_sel_hi:[1,0]
    v_pk_mul_f32 v[166:167], v[166:167], v[92:93] op_sel_hi:[1,0]
    v_exp_f32 v208, v208
    v_pk_mul_f32 v[168:169], v[168:169], v[92:93] op_sel_hi:[1,0]
    v_pk_mul_f32 v[170:171], v[170:171], v[92:93] op_sel_hi:[1,0]
    v_exp_f32 v209, v209
    v_pk_mul_f32 v[172:173], v[172:173], v[92:93] op_sel_hi:[1,0]
    v_pk_mul_f32 v[174:175], v[174:175], v[92:93] op_sel_hi:[1,0]
    v_exp_f32 v210, v210
    v_pk_mul_f32 v[176:177], v[176:177], v[92:93] op_sel_hi:[1,0]
    v_pk_mul_f32 v[178:179], v[178:179], v[92:93] op_sel_hi:[1,0]
    v_exp_f32 v211, v211
    v_pk_mul_f32 v[180:181], v[180:181], v[92:93] op_sel_hi:[1,0]
    v_pk_mul_f32 v[182:183], v[182:183], v[92:93] op_sel_hi:[1,0]
    v_exp_f32 v212, v212
    v_pk_mul_f32 v[184:185], v[184:185], v[92:93] op_sel_hi:[1,0]
    v_pk_mul_f32 v[186:187], v[186:187], v[92:93] op_sel_hi:[1,0]
    v_exp_f32 v213, v213
    v_pk_mul_f32 v[188:189], v[188:189], v[92:93] op_sel_hi:[1,0]
    v_pk_mul_f32 v[190:191], v[190:191], v[92:93] op_sel_hi:[1,0]
    v_exp_f32 v214, v214
    v_pk_mul_f32 v[192:193], v[192:193], v[92:93] op_sel_hi:[1,0]
    v_pk_mul_f32 v[194:195], v[194:195], v[92:93] op_sel_hi:[1,0]
    v_exp_f32 v215, v215
    v_pk_mul_f32 v[196:197], v[196:197], v[92:93] op_sel_hi:[1,0]
    v_pk_mul_f32 v[198:199], v[198:199], v[92:93] op_sel_hi:[1,0]
    v_cvt_pk_bf16_f32 v52, v200, v201
    v_cvt_pk_bf16_f32 v53, v202, v203
    v_cvt_pk_bf16_f32 v54, v204, v205
    v_cvt_pk_bf16_f32 v55, v206, v207
    v_cvt_pk_bf16_f32 v56, v208, v209
    v_cvt_pk_bf16_f32 v57, v210, v211
    v_cvt_pk_bf16_f32 v58, v212, v213
    v_cvt_pk_bf16_f32 v59, v214, v215
    v_mfma_f32_32x32x16_bf16 v[136:151], v[20:23], v[52:55], v[136:151]
    v_add_f32 v91, v91, v200
    v_add_f32 v91, v91, v201
    v_mfma_f32_32x32x16_bf16 v[152:167], v[28:31], v[52:55], v[152:167]
    v_add_f32 v91, v91, v202
    v_add_f32 v91, v91, v203
    v_mfma_f32_32x32x16_bf16 v[168:183], v[36:39], v[52:55], v[168:183]
    v_add_f32 v91, v91, v204
    v_add_f32 v91, v91, v205
    v_mfma_f32_32x32x16_bf16 v[184:199], v[44:47], v[52:55], v[184:199]
    v_add_f32 v91, v91, v206
    v_add_f32 v91, v91, v207
    v_mfma_f32_32x32x16_bf16 v[136:151], v[24:27], v[56:59], v[136:151]
    v_add_f32 v91, v91, v208
    v_add_f32 v91, v91, v209
    v_mfma_f32_32x32x16_bf16 v[152:167], v[32:35], v[56:59], v[152:167]
    v_add_f32 v91, v91, v210
    v_add_f32 v91, v91, v211
    v_mfma_f32_32x32x16_bf16 v[168:183], v[40:43], v[56:59], v[168:183]
    v_add_f32 v91, v91, v212
    v_add_f32 v91, v91, v213
    v_mfma_f32_32x32x16_bf16 v[184:199], v[48:51], v[56:59], v[184:199]
    v_add_f32 v91, v91, v214
    v_add_f32 v91, v91, v215
    s_add_u32 s93, s93, 1
    s_cmp_lt_u32 s93, 16
    s_cbranch_scc1 L_att
    s_branch L_attdone
L_fill0_14:
    s_cmp_lg_u32 s93, 12
    s_cbranch_scc1 L_fill1_15
    buffer_load_dwordx4 a[192:195], v19, s[60:63], s85 offen nt
    s_add_u32 s85, s85, 32768
    buffer_load_dwordx4 a[196:199], v19, s[60:63], s85 offen nt
    s_add_u32 s85, s85, 32768
    buffer_load_dwordx4 a[200:203], v19, s[60:63], s85 offen nt
    s_add_u32 s85, s85, 32768
    buffer_load_dwordx4 a[204:207], v19, s[60:63], s85 offen nt
    s_add_u32 s85, s85, 32768
    buffer_load_dwordx4 a[208:211], v19, s[60:63], s85 offen nt
    s_add_u32 s85, s85, 32768
    buffer_load_dwordx4 a[212:215], v19, s[60:63], s85 offen nt
    s_add_u32 s85, s85, 32768
    buffer_load_dwordx4 a[216:219], v19, s[60:63], s85 offen nt
    s_add_u32 s85, s85, 32768
    buffer_load_dwordx4 a[220:223], v19, s[60:63], s85 offen nt
    s_add_u32 s85, s85, 32768
    s_branch L_filled_18
L_fill1_15:
    s_cmp_lg_u32 s93, 13
    s_cbranch_scc1 L_fill2_16
    buffer_load_dwordx4 a[224:227], v19, s[60:63], s85 offen nt
    s_add_u32 s85, s85, 32768
    buffer_load_dwordx4 a[228:231], v19, s[60:63], s85 offen nt
    s_add_u32 s85, s85, 32768
    buffer_load_dwordx4 a[232:235], v19, s[60:63], s85 offen nt
    s_add_u32 s85, s85, 32768
    buffer_load_dwordx4 a[236:239], v19, s[60:63], s85 offen nt
    s_add_u32 s85, s85, 32768
    buffer_load_dwordx4 a[240:243], v19, s[60:63], s85 offen nt
    s_add_u32 s85, s85, 32768
    buffer_load_dwordx4 a[244:247], v19, s[60:63], s85 offen nt
    s_add_u32 s85, s85, 32768
    buffer_load_dwordx4 a[248:251], v19, s[60:63], s85 offen nt
    s_add_u32 s85, s85, 32768
    buffer_load_dwordx4 a[252:255], v19, s[60:63], s85 offen nt
    s_add_u32 s85, s85, 32768
    s_branch L_filled_18
L_fill2_16:
    s_cmp_lg_u32 s93, 14
    s_cbranch_scc1 L_fill3_17
    buffer_load_dwordx4 a[0:3], v9, s[64:67], s86 offen nt
    s_add_u32 s86, s86, 4096
    buffer_load_dwordx4 a[4:7], v9, s[64:67], s86 offen nt
    s_add_u32 s86, s86, 4096
    buffer_load_dwordx4 a[8:11], v9, s[64:67], s86 offen nt
    s_add_u32 s86, s86, 4096
    buffer_load_dwordx4 a[12:15], v9, s[64:67], s86 offen nt
    s_add_u32 s86, s86, 4096
    buffer_load_dwordx4 a[16:19], v9, s[64:67], s86 offen nt
    s_add_u32 s86, s86, 4096
    buffer_load_dwordx4 a[20:23], v9, s[64:67], s86 offen nt
    s_add_u32 s86, s86, 4096
    buffer_load_dwordx4 a[24:27], v9, s[64:67], s86 offen nt
    s_add_u32 s86, s86, 4096
    buffer_load_dwordx4 a[28:31], v9, s[64:67], s86 offen nt
    s_add_u32 s86, s86, 4096
    s_branch L_filled_18
L_fill3_17:
    buffer_load_dwordx4 a[32:35], v9, s[64:67], s86 offen nt
    s_add_u32 s86, s86, 4096
    buffer_load_dwordx4 a[36:39], v9, s[64:67], s86 offen nt
    s_add_u32 s86, s86, 4096
    buffer_load_dwordx4 a[40:43], v9, s[64:67], s86 offen nt
    s_add_u32 s86, s86, 4096
    buffer_load_dwordx4 a[44:47], v9, s[64:67], s86 offen nt
    s_add_u32 s86, s86, 4096
    buffer_load_dwordx4 a[48:51], v9, s[64:67], s86 offen nt
    s_add_u32 s86, s86, 4096
    buffer_load_dwordx4 a[52:55], v9, s[64:67], s86 offen nt
    s_add_u32 s86, s86, 4096
    buffer_load_dwordx4 a[56:59], v9, s[64:67], s86 offen nt
    s_add_u32 s86, s86, 4096
    buffer_load_dwordx4 a[60:63], v9, s[64:67], s86 offen nt
    s_add_u32 s86, s86, 4096
    s_branch L_filled_18
L_attdone:
    v_mov_b32 v5, v91
    s_nop 1
    v_permlane32_swap_b32 v91, v5
    v_add_f32 v91, v91, v5
    v_and_b32 v4, 31, v1
    v_mul_u32_u24 v5, 272, v4
    v_lshrrev_b32 v6, 5, v1
    v_lshl_add_u32 v5, v6, 3, v5
    v_add_u32 v5, s90, v5
    v_cvt_pk_bf16_f32 v20, v136, v137
    v_cvt_pk_bf16_f32 v21, v138, v139
    v_cvt_pk_bf16_f32 v22, v140, v141
    v_cvt_pk_bf16_f32 v23, v142, v143
    v_cvt_pk_bf16_f32 v24, v144, v145
    v_cvt_pk_bf16_f32 v25, v146, v147
    v_cvt_pk_bf16_f32 v26, v148, v149
    v_cvt_pk_bf16_f32 v27, v150, v151
    v_cvt_pk_bf16_f32 v28, v152, v153
    v_cvt_pk_bf16_f32 v29, v154, v155
    v_cvt_pk_bf16_f32 v30, v156, v157
    v_cvt_pk_bf16_f32 v31, v158, v159
    v_cvt_pk_bf16_f32 v32, v160, v161
    v_cvt_pk_bf16_f32 v33, v162, v163
    v_cvt_pk_bf16_f32 v34, v164, v165
    v_cvt_pk_bf16_f32 v35, v166, v167
    v_cvt_pk_bf16_f32 v36, v168, v169
    v_cvt_pk_bf16_f32 v37, v170, v171
    v_cvt_pk_bf16_f32 v38, v172, v173
    v_cvt_pk_bf16_f32 v39, v174, v175
    v_cvt_pk_bf16_f32 v40, v176, v177
    v_cvt_pk_bf16_f32 v41, v178, v179
    v_cvt_pk_bf16_f32 v42, v180, v181
    v_cvt_pk_bf16_f32 v43, v182, v183
    v_cvt_pk_bf16_f32 v44, v184, v185
    v_cvt_pk_bf16_f32 v45, v186, v187
    v_cvt_pk_bf16_f32 v46, v188, v189
    v_cvt_pk_bf16_f32 v47, v190, v191
    v_cvt_pk_bf16_f32 v48, v192, v193
    v_cvt_pk_bf16_f32 v49, v194, v195
    v_cvt_pk_bf16_f32 v50, v196, v197
    v_cvt_pk_bf16_f32 v51, v198, v199
    ds_write_b64 v5, v[20:21] offset:0
    ds_write_b64 v5, v[22:23] offset:16
    ds_write_b64 v5, v[24:25] offset:32
    ds_write_b64 v5, v[26:27] offset:48
    ds_write_b64 v5, v[28:29] offset:64
    ds_write_b64 v5, v[30:31] offset:80
    ds_write_b64 v5, v[32:33] offset:96
    ds_write_b64 v5, v[34:35] offset:112
    ds_write_b64 v5, v[36:37] offset:128
    ds_write_b64 v5, v[38:39] offset:144
    ds_write_b64 v5, v[40:41] offset:160
    ds_write_b64 v5, v[42:43] offset:176
    ds_write_b64 v5, v[44:45] offset:192
    ds_write_b64 v5, v[46:47] offset:208
    ds_write_b64 v5, v[48:49] offset:224
    ds_write_b64 v5, v[50:51] offset:240
    v_mul_u32_u24 v6, 272, v2
    v_lshl_add_u32 v6, v3, 4, v6
    v_add_u32 v6, s90, v6
    v_lshlrev_b32 v7, 4, v3
    v_lshl_add_u32 v7, v2, 15, v7
    s_lshl_b32 s36, s32, 10
    s_lshl_b32 s38, s34, 8
    s_add_u32 s36, s36, s38
    s_add_u32 s36, s36, 4194304
    s_waitcnt lgkmcnt(0)
    ds_read_b128 v[136:139], v6 offset:0
    ds_read_b128 v[140:143], v6 offset:1088
    ds_read_b128 v[144:147], v6 offset:2176
    ds_read_b128 v[148:151], v6 offset:3264
    ds_read_b128 v[152:155], v6 offset:4352
    ds_read_b128 v[156:159], v6 offset:5440
    ds_read_b128 v[160:163], v6 offset:6528
    ds_read_b128 v[164:167], v6 offset:7616
    v_lshlrev_b32 v4, 3, v4
    s_lshl_b32 s37, s32, 8
    s_add_u32 s37, s37, 2621440
    s_lshl_b32 s38, s34, 3
    s_lshl_b32 exec_lo, 0xff, s38
    s_mov_b32 exec_hi, 0
    buffer_store_dwordx2 v[90:91], v4, s[48:51], s37 offen sc1
    s_mov_b64 exec, -1
    s_waitcnt lgkmcnt(7)
    buffer_store_dwordx4 v[136:139], v7, s[48:51], s36 offen sc1
    s_add_u32 s36, s36, 131072
    s_waitcnt lgkmcnt(6)
    buffer_store_dwordx4 v[140:143], v7, s[48:51], s36 offen sc1
    s_add_u32 s36, s36, 131072
    s_waitcnt lgkmcnt(5)
    buffer_store_dwordx4 v[144:147], v7, s[48:51], s36 offen sc1
    s_add_u32 s36, s36, 131072
    s_waitcnt lgkmcnt(4)
    buffer_store_dwordx4 v[148:151], v7, s[48:51], s36 offen sc1
    s_add_u32 s36, s36, 131072
    s_waitcnt lgkmcnt(3)
    buffer_store_dwordx4 v[152:155], v7, s[48:51], s36 offen sc1
    s_add_u32 s36, s36, 131072
    s_waitcnt lgkmcnt(2)
    buffer_store_dwordx4 v[156:159], v7, s[48:51], s36 offen sc1
    s_add_u32 s36, s36, 131072
    s_waitcnt lgkmcnt(1)
    buffer_store_dwordx4 v[160:163], v7, s[48:51], s36 offen sc1
    s_add_u32 s36, s36, 131072
    s_waitcnt lgkmcnt(0)
    buffer_store_dwordx4 v[164:167], v7, s[48:51], s36 offen sc1
    buffer_load_dwordx4 a[64:67], v9, s[64:67], s86 offen nt
    s_add_u32 s86, s86, 4096
    buffer_load_dwordx4 a[68:71], v9, s[64:67], s86 offen nt
    s_add_u32 s86, s86, 4096
    buffer_load_dwordx4 a[72:75], v9, s[64:67], s86 offen nt
    s_add_u32 s86, s86, 4096
    buffer_load_dwordx4 a[76:79], v9, s[64:67], s86 offen nt
    s_add_u32 s86, s86, 4096
    buffer_load_dwordx4 a[80:83], v9, s[64:67], s86 offen nt
    s_add_u32 s86, s86, 4096
    buffer_load_dwordx4 a[84:87], v9, s[64:67], s86 offen nt
    s_add_u32 s86, s86, 4096
    buffer_load_dwordx4 a[88:91], v9, s[64:67], s86 offen nt
    s_add_u32 s86, s86, 4096
    buffer_load_dwordx4 a[92:95], v9, s[64:67], s86 offen nt
    s_add_u32 s86, s86, 4096
    s_waitcnt vmcnt(8)
    s_barrier
    s_cmp_lg_u32 s34, 0
    s_cbranch_scc1 L_nosig_19
    s_mov_b64 exec, 1
    buffer_atomic_add v101, v100, s[76:79], 0 offen offset:128 sc1
    s_mov_b64 exec, -1
L_nosig_19:
    buffer_load_dwordx4 a[96:99], v9, s[64:67], s86 offen nt
    s_add_u32 s86, s86, 4096
    buffer_load_dwordx4 a[100:103], v9, s[64:67], s86 offen nt
    s_add_u32 s86, s86, 4096
    buffer_load_dwordx4 a[104:107], v9, s[64:67], s86 offen nt
    s_add_u32 s86, s86, 4096
    buffer_load_dwordx4 a[108:111], v9, s[64:67], s86 offen nt
    s_add_u32 s86, s86, 4096
    buffer_load_dwordx4 a[112:115], v9, s[64:67], s86 offen nt
    s_add_u32 s86, s86, 4096
    buffer_load_dwordx4 a[116:119], v9, s[64:67], s86 offen nt
    s_add_u32 s86, s86, 4096
    buffer_load_dwordx4 a[120:123], v9, s[64:67], s86 offen nt
    s_add_u32 s86, s86, 4096
    buffer_load_dwordx4 a[124:127], v9, s[64:67], s86 offen nt
    s_add_u32 s86, s86, 4096
    ds_write_b128 v96, a[128:131] offset:0
    ds_write_b128 v97, a[132:135] offset:1024
    ds_write_b128 v98, a[136:139] offset:2048
    ds_write_b128 v99, a[140:143] offset:3072
    ds_write_b128 v96, a[144:147] offset:4096
    ds_write_b128 v97, a[148:151] offset:5120
    ds_write_b128 v98, a[152:155] offset:6144
    ds_write_b128 v99, a[156:159] offset:7168
    ds_write_b128 v96, a[160:163] offset:8192
    ds_write_b128 v97, a[164:167] offset:9216
    ds_write_b128 v98, a[168:171] offset:10240
    ds_write_b128 v99, a[172:175] offset:11264
    ds_write_b128 v96, a[176:179] offset:12288
    ds_write_b128 v97, a[180:183] offset:13312
    ds_write_b128 v98, a[184:187] offset:14336
    ds_write_b128 v99, a[188:191] offset:15360
    ds_write_b128 v96, a[192:195] offset:16384
    ds_write_b128 v97, a[196:199] offset:17408
    ds_write_b128 v98, a[200:203] offset:18432
    ds_write_b128 v99, a[204:207] offset:19456
    ds_write_b128 v96, a[208:211] offset:20480
    ds_write_b128 v97, a[212:215] offset:21504
    ds_write_b128 v98, a[216:219] offset:22528
    ds_write_b128 v99, a[220:223] offset:23552
    ds_write_b128 v96, a[224:227] offset:24576
    ds_write_b128 v97, a[228:231] offset:25600
    ds_write_b128 v98, a[232:235] offset:26624
    ds_write_b128 v99, a[236:239] offset:27648
    ds_write_b128 v96, a[240:243] offset:28672
    ds_write_b128 v97, a[244:247] offset:29696
    ds_write_b128 v98, a[248:251] offset:30720
    ds_write_b128 v99, a[252:255] offset:31744
    s_waitcnt lgkmcnt(0)
    s_lshl_b32 s86, s32, 17
    s_lshl_b32 s38, s34, 8
    s_add_u32 s86, s86, s38
    buffer_load_dword v7, v100, s[76:79], 0 offen offset:128 sc1
    buffer_load_dwordx4 a[128:131], v9, s[68:71], s86 offen nt
    s_add_u32 s86, s86, 4096
    buffer_load_dwordx4 a[132:135], v9, s[68:71], s86 offen nt
    s_add_u32 s86, s86, 4096
    buffer_load_dwordx4 a[136:139], v9, s[68:71], s86 offen nt
    s_add_u32 s86, s86, 4096
    buffer_load_dwordx4 a[140:143], v9, s[68:71], s86 offen nt
    s_add_u32 s86, s86, 4096
    buffer_load_dwordx4 a[144:147], v9, s[68:71], s86 offen nt
    s_add_u32 s86, s86, 4096
    buffer_load_dwordx4 a[148:151], v9, s[68:71], s86 offen nt
    s_add_u32 s86, s86, 4096
    buffer_load_dwordx4 a[152:155], v9, s[68:71], s86 offen nt
    s_add_u32 s86, s86, 4096
    buffer_load_dwordx4 a[156:159], v9, s[68:71], s86 offen nt
    s_add_u32 s86, s86, 4096
    v_xor_b32 v4, 0, v95
    ds_read_b64_tr_b16 v[128:129], v4 offset:0
    ds_read_b64_tr_b16 v[132:133], v4 offset:8192
    ds_read_b64_tr_b16 v[136:137], v4 offset:16384
    ds_read_b64_tr_b16 v[140:141], v4 offset:24576
    v_xor_b32 v5, 16, v95
    ds_read_b64_tr_b16 v[130:131], v5 offset:1024
    ds_read_b64_tr_b16 v[134:135], v5 offset:9216
    ds_read_b64_tr_b16 v[138:139], v5 offset:17408
    ds_read_b64_tr_b16 v[142:143], v5 offset:25600
    v_xor_b32 v4, 32, v95
    ds_read_b64_tr_b16 v[144:145], v4 offset:0
    ds_read_b64_tr_b16 v[148:149], v4 offset:8192
    ds_read_b64_tr_b16 v[152:153], v4 offset:16384
    ds_read_b64_tr_b16 v[156:157], v4 offset:24576
    v_xor_b32 v5, 48, v95
    ds_read_b64_tr_b16 v[146:147], v5 offset:1024
    ds_read_b64_tr_b16 v[150:151], v5 offset:9216
    ds_read_b64_tr_b16 v[154:155], v5 offset:17408
    ds_read_b64_tr_b16 v[158:159], v5 offset:25600
    v_xor_b32 v4, 64, v95
    ds_read_b64_tr_b16 v[160:161], v4 offset:0
    ds_read_b64_tr_b16 v[164:165], v4 offset:8192
    ds_read_b64_tr_b16 v[168:169], v4 offset:16384
    ds_read_b64_tr_b16 v[172:173], v4 offset:24576
    v_xor_b32 v5, 80, v95
    ds_read_b64_tr_b16 v[162:163], v5 offset:1024
    ds_read_b64_tr_b16 v[166:167], v5 offset:9216
    ds_read_b64_tr_b16 v[170:171], v5 offset:17408
    ds_read_b64_tr_b16 v[174:175], v5 offset:25600
    v_xor_b32 v4, 96, v95
    ds_read_b64_tr_b16 v[176:177], v4 offset:0
    ds_read_b64_tr_b16 v[180:181], v4 offset:8192
    ds_read_b64_tr_b16 v[184:185], v4 offset:16384
    ds_read_b64_tr_b16 v[188:189], v4 offset:24576
    v_xor_b32 v5, 112, v95
    ds_read_b64_tr_b16 v[178:179], v5 offset:1024
    ds_read_b64_tr_b16 v[182:183], v5 offset:9216
    ds_read_b64_tr_b16 v[186:187], v5 offset:17408
    ds_read_b64_tr_b16 v[190:191], v5 offset:25600
    v_xor_b32 v4, 128, v95
    ds_read_b64_tr_b16 v[192:193], v4 offset:0
    ds_read_b64_tr_b16 v[196:197], v4 offset:8192
    ds_read_b64_tr_b16 v[200:201], v4 offset:16384
    ds_read_b64_tr_b16 v[204:205], v4 offset:24576
    v_xor_b32 v5, 144, v95
    ds_read_b64_tr_b16 v[194:195], v5 offset:1024
    ds_read_b64_tr_b16 v[198:199], v5 offset:9216
    ds_read_b64_tr_b16 v[202:203], v5 offset:17408
    ds_read_b64_tr_b16 v[206:207], v5 offset:25600
    v_xor_b32 v4, 160, v95
    ds_read_b64_tr_b16 v[208:209], v4 offset:0
    ds_read_b64_tr_b16 v[212:213], v4 offset:8192
    ds_read_b64_tr_b16 v[216:217], v4 offset:16384
    ds_read_b64_tr_b16 v[220:221], v4 offset:24576
    v_xor_b32 v5, 176, v95
    ds_read_b64_tr_b16 v[210:211], v5 offset:1024
    ds_read_b64_tr_b16 v[214:215], v5 offset:9216
    ds_read_b64_tr_b16 v[218:219], v5 offset:17408
    ds_read_b64_tr_b16 v[222:223], v5 offset:25600
    v_xor_b32 v4, 192, v95
    ds_read_b64_tr_b16 v[224:225], v4 offset:0
    ds_read_b64_tr_b16 v[228:229], v4 offset:8192
    ds_read_b64_tr_b16 v[232:233], v4 offset:16384
    ds_read_b64_tr_b16 v[236:237], v4 offset:24576
    v_xor_b32 v5, 208, v95
    ds_read_b64_tr_b16 v[226:227], v5 offset:1024
    ds_read_b64_tr_b16 v[230:231], v5 offset:9216
    ds_read_b64_tr_b16 v[234:235], v5 offset:17408
    ds_read_b64_tr_b16 v[238:239], v5 offset:25600
    v_xor_b32 v4, 224, v95
    ds_read_b64_tr_b16 v[240:241], v4 offset:0
    ds_read_b64_tr_b16 v[244:245], v4 offset:8192
    ds_read_b64_tr_b16 v[248:249], v4 offset:16384
    ds_read_b64_tr_b16 v[252:253], v4 offset:24576
    v_xor_b32 v5, 240, v95
    ds_read_b64_tr_b16 v[242:243], v5 offset:1024
    ds_read_b64_tr_b16 v[246:247], v5 offset:9216
    ds_read_b64_tr_b16 v[250:251], v5 offset:17408
    ds_read_b64_tr_b16 v[254:255], v5 offset:25600
    s_waitcnt lgkmcnt(0)
    s_waitcnt vmcnt(8)
L_fcheck_20:
    v_cmp_gt_u32 vcc, 32, v7
    s_cbranch_vccz L_fok_21
    s_sleep 4
    buffer_load_dword v7, v100, s[76:79], 0 offen offset:128 sc1
    s_waitcnt vmcnt(0)
    s_sub_u32 s84, s84, 1
    s_cmp_lg_u32 s84, 0
    s_cbranch_scc1 L_fcheck_20
    s_branch L_end
L_fok_21:
    v_and_b32 v4, 3, v3
    v_lshrrev_b32 v5, 2, v3
    v_lshl_add_u32 v6, v4, 3, v5
    v_lshlrev_b32 v7, 8, v6
    v_lshlrev_b32 v6, 10, v6
    v_lshl_add_u32 v6, v2, 4, v6
    s_lshl_b32 s36, s32, 15
    s_lshl_b32 s38, s34, 8
    s_add_u32 s36, s36, s38
    s_add_u32 s36, s36, 4194304
    s_lshl_b32 s37, s32, 3
    s_add_u32 s37, s37, 2621440
    buffer_load_dwordx2 v[52:53], v7, s[48:51], s37 offen offset:0 sc1
    buffer_load_dwordx2 v[54:55], v7, s[48:51], s37 offen offset:1024 sc1
    buffer_load_dwordx4 v[20:23], v6, s[48:51], s36 offen offset:0 sc1
    buffer_load_dwordx4 v[24:27], v6, s[48:51], s36 offen offset:64 sc1
    buffer_load_dwordx4 v[28:31], v6, s[48:51], s36 offen offset:128 sc1
    buffer_load_dwordx4 v[32:35], v6, s[48:51], s36 offen offset:192 sc1
    s_add_u32 s36, s36, 4096
    buffer_load_dwordx4 v[36:39], v6, s[48:51], s36 offen offset:0 sc1
    buffer_load_dwordx4 v[40:43], v6, s[48:51], s36 offen offset:64 sc1
    buffer_load_dwordx4 v[44:47], v6, s[48:51], s36 offen offset:128 sc1
    buffer_load_dwordx4 v[48:51], v6, s[48:51], s36 offen offset:192 sc1
    s_add_u32 s36, s36, 4096
    buffer_load_dwordx4 a[160:163], v9, s[68:71], s86 offen nt
    s_add_u32 s86, s86, 4096
    buffer_load_dwordx4 a[164:167], v9, s[68:71], s86 offen nt
    s_add_u32 s86, s86, 4096
    buffer_load_dwordx4 a[168:171], v9, s[68:71], s86 offen nt
    s_add_u32 s86, s86, 4096
    buffer_load_dwordx4 a[172:175], v9, s[68:71], s86 offen nt
    s_add_u32 s86, s86, 4096
    buffer_load_dwordx4 a[176:179], v9, s[68:71], s86 offen nt
    s_add_u32 s86, s86, 4096
    buffer_load_dwordx4 a[180:183], v9, s[68:71], s86 offen nt
    s_add_u32 s86, s86, 4096
    buffer_load_dwordx4 a[184:187], v9, s[68:71], s86 offen nt
    s_add_u32 s86, s86, 4096
    buffer_load_dwordx4 a[188:191], v9, s[68:71], s86 offen nt
    s_add_u32 s86, s86, 4096
    buffer_load_dwordx4 a[192:195], v9, s[68:71], s86 offen nt
    s_add_u32 s86, s86, 4096
    buffer_load_dwordx4 a[196:199], v9, s[68:71], s86 offen nt
    s_add_u32 s86, s86, 4096
    buffer_load_dwordx4 a[200:203], v9, s[68:71], s86 offen nt
    s_add_u32 s86, s86, 4096
    buffer_load_dwordx4 a[204:207], v9, s[68:71], s86 offen nt
    s_add_u32 s86, s86, 4096
    buffer_load_dwordx4 a[208:211], v9, s[68:71], s86 offen nt
    s_add_u32 s86, s86, 4096
    buffer_load_dwordx4 a[212:215], v9, s[68:71], s86 offen nt
    s_add_u32 s86, s86, 4096
    buffer_load_dwordx4 a[216:219], v9, s[68:71], s86 offen nt
    s_add_u32 s86, s86, 4096
    buffer_load_dwordx4 a[220:223], v9, s[68:71], s86 offen nt
    s_add_u32 s86, s86, 4096
    buffer_load_dwordx4 a[224:227], v9, s[68:71], s86 offen nt
    s_add_u32 s86, s86, 4096
    buffer_load_dwordx4 a[228:231], v9, s[68:71], s86 offen nt
    s_add_u32 s86, s86, 4096
    buffer_load_dwordx4 a[232:235], v9, s[68:71], s86 offen nt
    s_add_u32 s86, s86, 4096
    buffer_load_dwordx4 a[236:239], v9, s[68:71], s86 offen nt
    s_add_u32 s86, s86, 4096
    buffer_load_dwordx4 a[240:243], v9, s[68:71], s86 offen nt
    s_add_u32 s86, s86, 4096
    buffer_load_dwordx4 a[244:247], v9, s[68:71], s86 offen nt
    s_add_u32 s86, s86, 4096
    buffer_load_dwordx4 a[248:251], v9, s[68:71], s86 offen nt
    s_add_u32 s86, s86, 4096
    buffer_load_dwordx4 a[252:255], v9, s[68:71], s86 offen nt
    s_add_u32 s86, s86, 4096
    s_waitcnt vmcnt(32)
    v_max_f32 v4, v52, v54
    s_nop 1
    v_max_f32_dpp v4, v4, v4 row_ror:8 row_mask:0xf bank_mask:0xf
    s_nop 1
    v_max_f32_dpp v4, v4, v4 row_ror:4 row_mask:0xf bank_mask:0xf
    v_sub_f32 v52, v52, v4
    v_sub_f32 v54, v54, v4
    v_exp_f32 v52, v52
    v_exp_f32 v54, v54
    v_mul_f32 v5, v52, v53
    v_fmac_f32 v5, v54, v55
    s_nop 1
    v_add_f32_dpp v5, v5, v5 row_ror:8 row_mask:0xf bank_mask:0xf
    s_nop 1
    v_add_f32_dpp v5, v5, v5 row_ror:4 row_mask:0xf bank_mask:0xf
    v_rcp_f32 v5, v5
    s_nop 0
    v_mul_f32 v52, v52, v5
    v_mul_f32 v54, v54, v5
    s_lshl_b32 s38, s34, 11
    s_add_u32 s38, s38, 131072
    v_and_b32 v4, 3, v3
    v_lshlrev_b32 v4, 9, v4
    v_lshl_add_u32 v4, v2, 4, v4
    v_add_u32 v4, s38, v4
    s_waitcnt vmcnt(24)
    v_mfma_f32_16x16x32_bf16 v[60:63], v[128:131], v[20:23], 0
    v_mfma_f32_16x16x32_bf16 v[64:67], v[128:131], v[36:39], 0
    v_mfma_f32_16x16x32_bf16 v[60:63], v[132:135], v[24:27], v[60:63]
    v_mfma_f32_16x16x32_bf16 v[64:67], v[132:135], v[40:43], v[64:67]
    v_mfma_f32_16x16x32_bf16 v[60:63], v[136:139], v[28:31], v[60:63]
    v_mfma_f32_16x16x32_bf16 v[64:67], v[136:139], v[44:47], v[64:67]
    v_mfma_f32_16x16x32_bf16 v[60:63], v[140:143], v[32:35], v[60:63]
    v_mfma_f32_16x16x32_bf16 v[64:67], v[140:143], v[48:51], v[64:67]
    v_mfma_f32_16x16x32_bf16 v[68:71], v[144:147], v[20:23], 0
    v_mfma_f32_16x16x32_bf16 v[72:75], v[144:147], v[36:39], 0
    v_mfma_f32_16x16x32_bf16 v[68:71], v[148:151], v[24:27], v[68:71]
    v_mfma_f32_16x16x32_bf16 v[72:75], v[148:151], v[40:43], v[72:75]
    v_mfma_f32_16x16x32_bf16 v[68:71], v[152:155], v[28:31], v[68:71]
    v_mfma_f32_16x16x32_bf16 v[72:75], v[152:155], v[44:47], v[72:75]
    v_mfma_f32_16x16x32_bf16 v[68:71], v[156:159], v[32:35], v[68:71]
    v_mfma_f32_16x16x32_bf16 v[72:75], v[156:159], v[48:51], v[72:75]
    v_mul_f32 v104, v60, v52
    v_mul_f32 v105, v61, v52
    v_mul_f32 v106, v62, v52
    v_mul_f32 v107, v63, v52
    v_fmac_f32 v104, v64, v54
    v_fmac_f32 v105, v65, v54
    v_fmac_f32 v106, v66, v54
    v_fmac_f32 v107, v67, v54
    v_add_f32_dpp v104, v104, v104 row_ror:8 row_mask:0xf bank_mask:0xf
    v_add_f32_dpp v105, v105, v105 row_ror:8 row_mask:0xf bank_mask:0xf
    v_add_f32_dpp v106, v106, v106 row_ror:8 row_mask:0xf bank_mask:0xf
    v_add_f32_dpp v107, v107, v107 row_ror:8 row_mask:0xf bank_mask:0xf
    v_add_f32_dpp v104, v104, v104 row_ror:4 row_mask:0xf bank_mask:0xf
    v_add_f32_dpp v105, v105, v105 row_ror:4 row_mask:0xf bank_mask:0xf
    v_add_f32_dpp v106, v106, v106 row_ror:4 row_mask:0xf bank_mask:0xf
    v_add_f32_dpp v107, v107, v107 row_ror:4 row_mask:0xf bank_mask:0xf
    ds_write_b128 v4, v[104:107] offset:0
    v_mfma_f32_16x16x32_bf16 v[60:63], v[160:163], v[20:23], 0
    v_mfma_f32_16x16x32_bf16 v[64:67], v[160:163], v[36:39], 0
    v_mfma_f32_16x16x32_bf16 v[60:63], v[164:167], v[24:27], v[60:63]
    v_mfma_f32_16x16x32_bf16 v[64:67], v[164:167], v[40:43], v[64:67]
    v_mfma_f32_16x16x32_bf16 v[60:63], v[168:171], v[28:31], v[60:63]
    v_mfma_f32_16x16x32_bf16 v[64:67], v[168:171], v[44:47], v[64:67]
    v_mfma_f32_16x16x32_bf16 v[60:63], v[172:175], v[32:35], v[60:63]
    v_mfma_f32_16x16x32_bf16 v[64:67], v[172:175], v[48:51], v[64:67]
    v_mul_f32 v108, v68, v52
    v_mul_f32 v109, v69, v52
    v_mul_f32 v110, v70, v52
    v_mul_f32 v111, v71, v52
    v_fmac_f32 v108, v72, v54
    v_fmac_f32 v109, v73, v54
    v_fmac_f32 v110, v74, v54
    v_fmac_f32 v111, v75, v54
    v_add_f32_dpp v108, v108, v108 row_ror:8 row_mask:0xf bank_mask:0xf
    v_add_f32_dpp v109, v109, v109 row_ror:8 row_mask:0xf bank_mask:0xf
    v_add_f32_dpp v110, v110, v110 row_ror:8 row_mask:0xf bank_mask:0xf
    v_add_f32_dpp v111, v111, v111 row_ror:8 row_mask:0xf bank_mask:0xf
    v_add_f32_dpp v108, v108, v108 row_ror:4 row_mask:0xf bank_mask:0xf
    v_add_f32_dpp v109, v109, v109 row_ror:4 row_mask:0xf bank_mask:0xf
    v_add_f32_dpp v110, v110, v110 row_ror:4 row_mask:0xf bank_mask:0xf
    v_add_f32_dpp v111, v111, v111 row_ror:4 row_mask:0xf bank_mask:0xf
    ds_write_b128 v4, v[108:111] offset:64
    v_mfma_f32_16x16x32_bf16 v[68:71], v[176:179], v[20:23], 0
    v_mfma_f32_16x16x32_bf16 v[72:75], v[176:179], v[36:39], 0
    v_mfma_f32_16x16x32_bf16 v[68:71], v[180:183], v[24:27], v[68:71]
    v_mfma_f32_16x16x32_bf16 v[72:75], v[180:183], v[40:43], v[72:75]
    v_mfma_f32_16x16x32_bf16 v[68:71], v[184:187], v[28:31], v[68:71]
    v_mfma_f32_16x16x32_bf16 v[72:75], v[184:187], v[44:47], v[72:75]
    v_mfma_f32_16x16x32_bf16 v[68:71], v[188:191], v[32:35], v[68:71]
    v_mfma_f32_16x16x32_bf16 v[72:75], v[188:191], v[48:51], v[72:75]
    v_mul_f32 v104, v60, v52
    v_mul_f32 v105, v61, v52
    v_mul_f32 v106, v62, v52
    v_mul_f32 v107, v63, v52
    v_fmac_f32 v104, v64, v54
    v_fmac_f32 v105, v65, v54
    v_fmac_f32 v106, v66, v54
    v_fmac_f32 v107, v67, v54
    v_add_f32_dpp v104, v104, v104 row_ror:8 row_mask:0xf bank_mask:0xf
    v_add_f32_dpp v105, v105, v105 row_ror:8 row_mask:0xf bank_mask:0xf
    v_add_f32_dpp v106, v106, v106 row_ror:8 row_mask:0xf bank_mask:0xf
    v_add_f32_dpp v107, v107, v107 row_ror:8 row_mask:0xf bank_mask:0xf
    v_add_f32_dpp v104, v104, v104 row_ror:4 row_mask:0xf bank_mask:0xf
    v_add_f32_dpp v105, v105, v105 row_ror:4 row_mask:0xf bank_mask:0xf
    v_add_f32_dpp v106, v106, v106 row_ror:4 row_mask:0xf bank_mask:0xf
    v_add_f32_dpp v107, v107, v107 row_ror:4 row_mask:0xf bank_mask:0xf
    ds_write_b128 v4, v[104:107] offset:128
    v_mfma_f32_16x16x32_bf16 v[60:63], v[192:195], v[20:23], 0
    v_mfma_f32_16x16x32_bf16 v[64:67], v[192:195], v[36:39], 0
    v_mfma_f32_16x16x32_bf16 v[60:63], v[196:199], v[24:27], v[60:63]
    v_mfma_f32_16x16x32_bf16 v[64:67], v[196:199], v[40:43], v[64:67]
    v_mfma_f32_16x16x32_bf16 v[60:63], v[200:203], v[28:31], v[60:63]
    v_mfma_f32_16x16x32_bf16 v[64:67], v[200:203], v[44:47], v[64:67]
    v_mfma_f32_16x16x32_bf16 v[60:63], v[204:207], v[32:35], v[60:63]
    v_mfma_f32_16x16x32_bf16 v[64:67], v[204:207], v[48:51], v[64:67]
    v_mul_f32 v108, v68, v52
    v_mul_f32 v109, v69, v52
    v_mul_f32 v110, v70, v52
    v_mul_f32 v111, v71, v52
    v_fmac_f32 v108, v72, v54
    v_fmac_f32 v109, v73, v54
    v_fmac_f32 v110, v74, v54
    v_fmac_f32 v111, v75, v54
    v_add_f32_dpp v108, v108, v108 row_ror:8 row_mask:0xf bank_mask:0xf
    v_add_f32_dpp v109, v109, v109 row_ror:8 row_mask:0xf bank_mask:0xf
    v_add_f32_dpp v110, v110, v110 row_ror:8 row_mask:0xf bank_mask:0xf
    v_add_f32_dpp v111, v111, v111 row_ror:8 row_mask:0xf bank_mask:0xf
    v_add_f32_dpp v108, v108, v108 row_ror:4 row_mask:0xf bank_mask:0xf
    v_add_f32_dpp v109, v109, v109 row_ror:4 row_mask:0xf bank_mask:0xf
    v_add_f32_dpp v110, v110, v110 row_ror:4 row_mask:0xf bank_mask:0xf
    v_add_f32_dpp v111, v111, v111 row_ror:4 row_mask:0xf bank_mask:0xf
    ds_write_b128 v4, v[108:111] offset:192
    v_mfma_f32_16x16x32_bf16 v[68:71], v[208:211], v[20:23], 0
    v_mfma_f32_16x16x32_bf16 v[72:75], v[208:211], v[36:39], 0
    v_mfma_f32_16x16x32_bf16 v[68:71], v[212:215], v[24:27], v[68:71]
    v_mfma_f32_16x16x32_bf16 v[72:75], v[212:215], v[40:43], v[72:75]
    v_mfma_f32_16x16x32_bf16 v[68:71], v[216:219], v[28:31], v[68:71]
    v_mfma_f32_16x16x32_bf16 v[72:75], v[216:219], v[44:47], v[72:75]
    v_mfma_f32_16x16x32_bf16 v[68:71], v[220:223], v[32:35], v[68:71]
    v_mfma_f32_16x16x32_bf16 v[72:75], v[220:223], v[48:51], v[72:75]
    v_mul_f32 v104, v60, v52
    v_mul_f32 v105, v61, v52
    v_mul_f32 v106, v62, v52
    v_mul_f32 v107, v63, v52
    v_fmac_f32 v104, v64, v54
    v_fmac_f32 v105, v65, v54
    v_fmac_f32 v106, v66, v54
    v_fmac_f32 v107, v67, v54
    v_add_f32_dpp v104, v104, v104 row_ror:8 row_mask:0xf bank_mask:0xf
    v_add_f32_dpp v105, v105, v105 row_ror:8 row_mask:0xf bank_mask:0xf
    v_add_f32_dpp v106, v106, v106 row_ror:8 row_mask:0xf bank_mask:0xf
    v_add_f32_dpp v107, v107, v107 row_ror:8 row_mask:0xf bank_mask:0xf
    v_add_f32_dpp v104, v104, v104 row_ror:4 row_mask:0xf bank_mask:0xf
    v_add_f32_dpp v105, v105, v105 row_ror:4 row_mask:0xf bank_mask:0xf
    v_add_f32_dpp v106, v106, v106 row_ror:4 row_mask:0xf bank_mask:0xf
    v_add_f32_dpp v107, v107, v107 row_ror:4 row_mask:0xf bank_mask:0xf
    ds_write_b128 v4, v[104:107] offset:256
    v_mfma_f32_16x16x32_bf16 v[60:63], v[224:227], v[20:23], 0
    v_mfma_f32_16x16x32_bf16 v[64:67], v[224:227], v[36:39], 0
    v_mfma_f32_16x16x32_bf16 v[60:63], v[228:231], v[24:27], v[60:63]
    v_mfma_f32_16x16x32_bf16 v[64:67], v[228:231], v[40:43], v[64:67]
    v_mfma_f32_16x16x32_bf16 v[60:63], v[232:235], v[28:31], v[60:63]
    v_mfma_f32_16x16x32_bf16 v[64:67], v[232:235], v[44:47], v[64:67]
    v_mfma_f32_16x16x32_bf16 v[60:63], v[236:239], v[32:35], v[60:63]
    v_mfma_f32_16x16x32_bf16 v[64:67], v[236:239], v[48:51], v[64:67]
    v_mul_f32 v108, v68, v52
    v_mul_f32 v109, v69, v52
    v_mul_f32 v110, v70, v52
    v_mul_f32 v111, v71, v52
    v_fmac_f32 v108, v72, v54
    v_fmac_f32 v109, v73, v54
    v_fmac_f32 v110, v74, v54
    v_fmac_f32 v111, v75, v54
    v_add_f32_dpp v108, v108, v108 row_ror:8 row_mask:0xf bank_mask:0xf
    v_add_f32_dpp v109, v109, v109 row_ror:8 row_mask:0xf bank_mask:0xf
    v_add_f32_dpp v110, v110, v110 row_ror:8 row_mask:0xf bank_mask:0xf
    v_add_f32_dpp v111, v111, v111 row_ror:8 row_mask:0xf bank_mask:0xf
    v_add_f32_dpp v108, v108, v108 row_ror:4 row_mask:0xf bank_mask:0xf
    v_add_f32_dpp v109, v109, v109 row_ror:4 row_mask:0xf bank_mask:0xf
    v_add_f32_dpp v110, v110, v110 row_ror:4 row_mask:0xf bank_mask:0xf
    v_add_f32_dpp v111, v111, v111 row_ror:4 row_mask:0xf bank_mask:0xf
    ds_write_b128 v4, v[108:111] offset:320
    v_mfma_f32_16x16x32_bf16 v[68:71], v[240:243], v[20:23], 0
    v_mfma_f32_16x16x32_bf16 v[72:75], v[240:243], v[36:39], 0
    v_mfma_f32_16x16x32_bf16 v[68:71], v[244:247], v[24:27], v[68:71]
    v_mfma_f32_16x16x32_bf16 v[72:75], v[244:247], v[40:43], v[72:75]
    v_mfma_f32_16x16x32_bf16 v[68:71], v[248:251], v[28:31], v[68:71]
    v_mfma_f32_16x16x32_bf16 v[72:75], v[248:251], v[44:47], v[72:75]
    v_mfma_f32_16x16x32_bf16 v[68:71], v[252:255], v[32:35], v[68:71]
    v_mfma_f32_16x16x32_bf16 v[72:75], v[252:255], v[48:51], v[72:75]
    v_mul_f32 v104, v60, v52
    v_mul_f32 v105, v61, v52
    v_mul_f32 v106, v62, v52
    v_mul_f32 v107, v63, v52
    v_fmac_f32 v104, v64, v54
    v_fmac_f32 v105, v65, v54
    v_fmac_f32 v106, v66, v54
    v_fmac_f32 v107, v67, v54
    v_add_f32_dpp v104, v104, v104 row_ror:8 row_mask:0xf bank_mask:0xf
    v_add_f32_dpp v105, v105, v105 row_ror:8 row_mask:0xf bank_mask:0xf
    v_add_f32_dpp v106, v106, v106 row_ror:8 row_mask:0xf bank_mask:0xf
    v_add_f32_dpp v107, v107, v107 row_ror:8 row_mask:0xf bank_mask:0xf
    v_add_f32_dpp v104, v104, v104 row_ror:4 row_mask:0xf bank_mask:0xf
    v_add_f32_dpp v105, v105, v105 row_ror:4 row_mask:0xf bank_mask:0xf
    v_add_f32_dpp v106, v106, v106 row_ror:4 row_mask:0xf bank_mask:0xf
    v_add_f32_dpp v107, v107, v107 row_ror:4 row_mask:0xf bank_mask:0xf
    ds_write_b128 v4, v[104:107] offset:384
    v_mul_f32 v108, v68, v52
    v_mul_f32 v109, v69, v52
    v_mul_f32 v110, v70, v52
    v_mul_f32 v111, v71, v52
    v_fmac_f32 v108, v72, v54
    v_fmac_f32 v109, v73, v54
    v_fmac_f32 v110, v74, v54
    v_fmac_f32 v111, v75, v54
    v_add_f32_dpp v108, v108, v108 row_ror:8 row_mask:0xf bank_mask:0xf
    v_add_f32_dpp v109, v109, v109 row_ror:8 row_mask:0xf bank_mask:0xf
    v_add_f32_dpp v110, v110, v110 row_ror:8 row_mask:0xf bank_mask:0xf
    v_add_f32_dpp v111, v111, v111 row_ror:8 row_mask:0xf bank_mask:0xf
    v_add_f32_dpp v108, v108, v108 row_ror:4 row_mask:0xf bank_mask:0xf
    v_add_f32_dpp v109, v109, v109 row_ror:4 row_mask:0xf bank_mask:0xf
    v_add_f32_dpp v110, v110, v110 row_ror:4 row_mask:0xf bank_mask:0xf
    v_add_f32_dpp v111, v111, v111 row_ror:4 row_mask:0xf bank_mask:0xf
    ds_write_b128 v4, v[108:111] offset:448
    s_lshl_b32 s38, s34, 9
    s_add_u32 s38, s38, 131072
    v_and_b32 v5, 31, v1
    v_lshl_add_u32 v6, v5, 4, s38
    s_mul_i32 s38, s34, 320
    s_add_u32 s38, s38, 147456
    v_lshl_add_u32 v7, v5, 3, s38
    s_waitcnt lgkmcnt(0)
    s_barrier
    ds_read_b128 v[20:23], v6 offset:0
    ds_read_b128 v[24:27], v6 offset:2048
    ds_read_b128 v[28:31], v6 offset:4096
    ds_read_b128 v[32:35], v6 offset:6144
    s_waitcnt lgkmcnt(0)
    v_add_f32 v20, v20, v24
    v_add_f32 v28, v28, v32
    v_add_f32 v21, v21, v25
    v_add_f32 v29, v29, v33
    v_add_f32 v22, v22, v26
    v_add_f32 v30, v30, v34
    v_add_f32 v23, v23, v27
    v_add_f32 v31, v31, v35
    v_add_f32 v20, v20, v28
    v_add_f32 v21, v21, v29
    v_add_f32 v22, v22, v30
    v_add_f32 v23, v23, v31
    v_cvt_pk_bf16_f32 v20, v20, v21
    v_cvt_pk_bf16_f32 v21, v22, v23
    ds_write_b64 v7, v[20:21]
    ds_write_b128 v96, a[0:3] offset:0
    ds_write_b128 v97, a[4:7] offset:1024
    ds_write_b128 v98, a[8:11] offset:2048
    ds_write_b128 v99, a[12:15] offset:3072
    ds_write_b128 v96, a[16:19] offset:4096
    ds_write_b128 v97, a[20:23] offset:5120
    ds_write_b128 v98, a[24:27] offset:6144
    ds_write_b128 v99, a[28:31] offset:7168
    ds_write_b128 v96, a[32:35] offset:8192
    ds_write_b128 v97, a[36:39] offset:9216
    ds_write_b128 v98, a[40:43] offset:10240
    ds_write_b128 v99, a[44:47] offset:11264
    ds_write_b128 v96, a[48:51] offset:12288
    ds_write_b128 v97, a[52:55] offset:13312
    ds_write_b128 v98, a[56:59] offset:14336
    ds_write_b128 v99, a[60:63] offset:15360
    ds_write_b128 v96, a[64:67] offset:16384
    ds_write_b128 v97, a[68:71] offset:17408
    ds_write_b128 v98, a[72:75] offset:18432
    ds_write_b128 v99, a[76:79] offset:19456
    ds_write_b128 v96, a[80:83] offset:20480
    ds_write_b128 v97, a[84:87] offset:21504
    ds_write_b128 v98, a[88:91] offset:22528
    ds_write_b128 v99, a[92:95] offset:23552
    ds_write_b128 v96, a[96:99] offset:24576
    ds_write_b128 v97, a[100:103] offset:25600
    ds_write_b128 v98, a[104:107] offset:26624
    ds_write_b128 v99, a[108:111] offset:27648
    ds_write_b128 v96, a[112:115] offset:28672
    ds_write_b128 v97, a[116:119] offset:29696
    ds_write_b128 v98, a[120:123] offset:30720
    ds_write_b128 v99, a[124:127] offset:31744
    s_waitcnt lgkmcnt(0)
    v_xor_b32 v4, 0, v95
    ds_read_b64_tr_b16 v[128:129], v4 offset:0
    ds_read_b64_tr_b16 v[132:133], v4 offset:8192
    ds_read_b64_tr_b16 v[136:137], v4 offset:16384
    ds_read_b64_tr_b16 v[140:141], v4 offset:24576
    v_xor_b32 v5, 16, v95
    ds_read_b64_tr_b16 v[130:131], v5 offset:1024
    ds_read_b64_tr_b16 v[134:135], v5 offset:9216
    ds_read_b64_tr_b16 v[138:139], v5 offset:17408
    ds_read_b64_tr_b16 v[142:143], v5 offset:25600
    v_xor_b32 v4, 32, v95
    ds_read_b64_tr_b16 v[144:145], v4 offset:0
    ds_read_b64_tr_b16 v[148:149], v4 offset:8192
    ds_read_b64_tr_b16 v[152:153], v4 offset:16384
    ds_read_b64_tr_b16 v[156:157], v4 offset:24576
    v_xor_b32 v5, 48, v95
    ds_read_b64_tr_b16 v[146:147], v5 offset:1024
    ds_read_b64_tr_b16 v[150:151], v5 offset:9216
    ds_read_b64_tr_b16 v[154:155], v5 offset:17408
    ds_read_b64_tr_b16 v[158:159], v5 offset:25600
    v_xor_b32 v4, 64, v95
    ds_read_b64_tr_b16 v[160:161], v4 offset:0
    ds_read_b64_tr_b16 v[164:165], v4 offset:8192
    ds_read_b64_tr_b16 v[168:169], v4 offset:16384
    ds_read_b64_tr_b16 v[172:173], v4 offset:24576
    v_xor_b32 v5, 80, v95
    ds_read_b64_tr_b16 v[162:163], v5 offset:1024
    ds_read_b64_tr_b16 v[166:167], v5 offset:9216
    ds_read_b64_tr_b16 v[170:171], v5 offset:17408
    ds_read_b64_tr_b16 v[174:175], v5 offset:25600
    v_xor_b32 v4, 96, v95
    ds_read_b64_tr_b16 v[176:177], v4 offset:0
    ds_read_b64_tr_b16 v[180:181], v4 offset:8192
    ds_read_b64_tr_b16 v[184:185], v4 offset:16384
    ds_read_b64_tr_b16 v[188:189], v4 offset:24576
    v_xor_b32 v5, 112, v95
    ds_read_b64_tr_b16 v[178:179], v5 offset:1024
    ds_read_b64_tr_b16 v[182:183], v5 offset:9216
    ds_read_b64_tr_b16 v[186:187], v5 offset:17408
    ds_read_b64_tr_b16 v[190:191], v5 offset:25600
    v_xor_b32 v4, 128, v95
    ds_read_b64_tr_b16 v[192:193], v4 offset:0
    ds_read_b64_tr_b16 v[196:197], v4 offset:8192
    ds_read_b64_tr_b16 v[200:201], v4 offset:16384
    ds_read_b64_tr_b16 v[204:205], v4 offset:24576
    v_xor_b32 v5, 144, v95
    ds_read_b64_tr_b16 v[194:195], v5 offset:1024
    ds_read_b64_tr_b16 v[198:199], v5 offset:9216
    ds_read_b64_tr_b16 v[202:203], v5 offset:17408
    ds_read_b64_tr_b16 v[206:207], v5 offset:25600
    v_xor_b32 v4, 160, v95
    ds_read_b64_tr_b16 v[208:209], v4 offset:0
    ds_read_b64_tr_b16 v[212:213], v4 offset:8192
    ds_read_b64_tr_b16 v[216:217], v4 offset:16384
    ds_read_b64_tr_b16 v[220:221], v4 offset:24576
    v_xor_b32 v5, 176, v95
    ds_read_b64_tr_b16 v[210:211], v5 offset:1024
    ds_read_b64_tr_b16 v[214:215], v5 offset:9216
    ds_read_b64_tr_b16 v[218:219], v5 offset:17408
    ds_read_b64_tr_b16 v[222:223], v5 offset:25600
    v_xor_b32 v4, 192, v95
    ds_read_b64_tr_b16 v[224:225], v4 offset:0
    ds_read_b64_tr_b16 v[228:229], v4 offset:8192
    ds_read_b64_tr_b16 v[232:233], v4 offset:16384
    ds_read_b64_tr_b16 v[236:237], v4 offset:24576
    v_xor_b32 v5, 208, v95
    ds_read_b64_tr_b16 v[226:227], v5 offset:1024
    ds_read_b64_tr_b16 v[230:231], v5 offset:9216
    ds_read_b64_tr_b16 v[234:235], v5 offset:17408
    ds_read_b64_tr_b16 v[238:239], v5 offset:25600
    v_xor_b32 v4, 224, v95
    ds_read_b64_tr_b16 v[240:241], v4 offset:0
    ds_read_b64_tr_b16 v[244:245], v4 offset:8192
    ds_read_b64_tr_b16 v[248:249], v4 offset:16384
    ds_read_b64_tr_b16 v[252:253], v4 offset:24576
    v_xor_b32 v5, 240, v95
    ds_read_b64_tr_b16 v[242:243], v5 offset:1024
    ds_read_b64_tr_b16 v[246:247], v5 offset:9216
    ds_read_b64_tr_b16 v[250:251], v5 offset:17408
    ds_read_b64_tr_b16 v[254:255], v5 offset:25600
    s_waitcnt lgkmcnt(0)
    v_mov_b32 v20, 0
    v_mov_b32 v21, 0
    v_mov_b32 v22, 0
    v_mov_b32 v23, 0
    v_mov_b32 v24, 0
    v_mov_b32 v25, 0
    v_mov_b32 v26, 0
    v_mov_b32 v27, 0
    v_mov_b32 v28, 0
    v_mov_b32 v29, 0
    v_mov_b32 v30, 0
    v_mov_b32 v31, 0
    v_mov_b32 v32, 0
    v_mov_b32 v33, 0
    v_mov_b32 v34, 0
    v_mov_b32 v35, 0
    v_mov_b32 v36, 0
    v_mov_b32 v37, 0
    v_mov_b32 v38, 0
    v_mov_b32 v39, 0
    v_mov_b32 v40, 0
    v_mov_b32 v41, 0
    v_mov_b32 v42, 0
    v_mov_b32 v43, 0
    v_mov_b32 v44, 0
    v_mov_b32 v45, 0
    v_mov_b32 v46, 0
    v_mov_b32 v47, 0
    v_mov_b32 v48, 0
    v_mov_b32 v49, 0
    v_mov_b32 v50, 0
    v_mov_b32 v51, 0
    v_mov_b32 v52, 0
    v_mov_b32 v53, 0
    v_mov_b32 v54, 0
    v_mov_b32 v55, 0
    v_mov_b32 v56, 0
    v_mov_b32 v57, 0
    v_mov_b32 v58, 0
    v_mov_b32 v59, 0
    v_mov_b32 v60, 0
    v_mov_b32 v61, 0
    v_mov_b32 v62, 0
    v_mov_b32 v63, 0
    v_mov_b32 v64, 0
    v_mov_b32 v65, 0
    v_mov_b32 v66, 0
    v_mov_b32 v67, 0
    v_mov_b32 v68, 0
    v_mov_b32 v69, 0
    v_mov_b32 v70, 0
    v_mov_b32 v71, 0
    v_mov_b32 v72, 0
    v_mov_b32 v73, 0
    v_mov_b32 v74, 0
    v_mov_b32 v75, 0
    v_mov_b32 v76, 0
    v_mov_b32 v77, 0
    v_mov_b32 v78, 0
    v_mov_b32 v79, 0
    v_mov_b32 v80, 0
    v_mov_b32 v81, 0
    v_mov_b32 v82, 0
    v_mov_b32 v83, 0
    v_and_b32 v4, 3, v3
    v_mul_u32_u24 v100, 320, v4
    v_lshl_add_u32 v100, v2, 4, v100
    v_add_u32 v100, 147456, v100
    s_lshl_b32 s36, s34, 16
    s_lshl_b32 s38, s32, 8
    s_add_u32 s36, s36, s38
    v_add_u32 v101, s36, v19
    s_lshl_b32 s36, s32, 13
    s_lshl_b32 s38, s34, 6
    s_add_u32 s36, s36, s38
    v_lshrrev_b32 v5, 2, v1
    v_lshlrev_b32 v5, 8, v5
    v_lshl_add_u32 v5, v4, 4, v5
    v_add_u32 v102, s36, v5
    s_lshr_b32 s36, s32, 2
    s_lshl_b32 s36, s36, 7
    s_lshl_b32 s38, s34, 5
    s_add_u32 s36, s36, s38
    s_and_b32 s38, s32, 3
    s_lshl_b32 s38, s38, 3
    s_add_u32 s36, s36, s38
    v_lshlrev_b32 v5, 11, v4
    v_lshl_add_u32 v5, v2, 1, v5
    v_add_u32 v103, s36, v5
    v_lshlrev_b32 v4, 7, v2
    v_lshl_add_u32 v4, v3, 4, v4
    v_mov_b32 v5, 512
    v_cmp_gt_u32 vcc, 8, v3
    s_nop 1
    v_cndmask_b32 v92, v5, v4, vcc
    s_mul_i32 s38, s34, 320
    s_add_u32 s38, s38, 147456
    v_lshlrev_b32 v4, 6, v2
    v_lshl_add_u32 v4, v3, 1, v4
    v_add_u32 v93, s38, v4
    s_mov_b32 s92, 0
    s_mov_b32 s96, 3145728
    s_mov_b32 s97, 0
L_final:
    s_waitcnt lgkmcnt(0)
    s_barrier
    s_mov_b32 exec_lo, 0xf000f
    s_mov_b32 exec_hi, 0xf000f
    ds_read_b128 v[20:23], v100 offset:0
    ds_read_b128 v[24:27], v100 offset:64
    ds_read_b128 v[28:31], v100 offset:128
    ds_read_b128 v[32:35], v100 offset:192
    s_mov_b32 exec_lo, 0xf000f0
    s_mov_b32 exec_hi, 0xf000f0
    ds_read_b128 v[36:39], v100 offset:0
    ds_read_b128 v[40:43], v100 offset:64
    ds_read_b128 v[44:47], v100 offset:128
    ds_read_b128 v[48:51], v100 offset:192
    s_mov_b32 exec_lo, 0xf000f00
    s_mov_b32 exec_hi, 0xf000f00
    ds_read_b128 v[52:55], v100 offset:0
    ds_read_b128 v[56:59], v100 offset:64
    ds_read_b128 v[60:63], v100 offset:128
    ds_read_b128 v[64:67], v100 offset:192
    s_mov_b32 exec_lo, 0xf000f000
    s_mov_b32 exec_hi, 0xf000f000
    ds_read_b128 v[68:71], v100 offset:0
    ds_read_b128 v[72:75], v100 offset:64
    ds_read_b128 v[76:79], v100 offset:128
    ds_read_b128 v[80:83], v100 offset:192
    s_mov_b64 exec, -1
    s_add_u32 s36, s96, 32768
    s_waitcnt lgkmcnt(12)
    v_mfma_f32_16x16x32_bf16 v[84:87], v[128:131], v[20:23], 0
    v_mfma_f32_16x16x32_bf16 v[88:91], v[192:195], v[20:23], 0
    v_mfma_f32_16x16x32_bf16 v[84:87], v[132:135], v[24:27], v[84:87]
    v_mfma_f32_16x16x32_bf16 v[88:91], v[196:199], v[24:27], v[88:91]
    v_mfma_f32_16x16x32_bf16 v[84:87], v[136:139], v[28:31], v[84:87]
    v_mfma_f32_16x16x32_bf16 v[88:91], v[200:203], v[28:31], v[88:91]
    v_mfma_f32_16x16x32_bf16 v[84:87], v[140:143], v[32:35], v[84:87]
    v_mfma_f32_16x16x32_bf16 v[88:91], v[204:207], v[32:35], v[88:91]
    s_waitcnt lgkmcnt(8)
    v_mfma_f32_16x16x32_bf16 v[84:87], v[144:147], v[36:39], v[84:87]
    v_mfma_f32_16x16x32_bf16 v[88:91], v[208:211], v[36:39], v[88:91]
    v_mfma_f32_16x16x32_bf16 v[84:87], v[148:151], v[40:43], v[84:87]
    v_mfma_f32_16x16x32_bf16 v[88:91], v[212:215], v[40:43], v[88:91]
    v_mfma_f32_16x16x32_bf16 v[84:87], v[152:155], v[44:47], v[84:87]
    v_mfma_f32_16x16x32_bf16 v[88:91], v[216:219], v[44:47], v[88:91]
    v_mfma_f32_16x16x32_bf16 v[84:87], v[156:159], v[48:51], v[84:87]
    v_mfma_f32_16x16x32_bf16 v[88:91], v[220:223], v[48:51], v[88:91]
    s_waitcnt lgkmcnt(4)
    v_mfma_f32_16x16x32_bf16 v[84:87], v[160:163], v[52:55], v[84:87]
    v_mfma_f32_16x16x32_bf16 v[88:91], v[224:227], v[52:55], v[88:91]
    v_mfma_f32_16x16x32_bf16 v[84:87], v[164:167], v[56:59], v[84:87]
    v_mfma_f32_16x16x32_bf16 v[88:91], v[228:231], v[56:59], v[88:91]
    v_mfma_f32_16x16x32_bf16 v[84:87], v[168:171], v[60:63], v[84:87]
    v_mfma_f32_16x16x32_bf16 v[88:91], v[232:235], v[60:63], v[88:91]
    v_mfma_f32_16x16x32_bf16 v[84:87], v[172:175], v[64:67], v[84:87]
    v_mfma_f32_16x16x32_bf16 v[88:91], v[236:239], v[64:67], v[88:91]
    s_waitcnt lgkmcnt(0)
    v_mfma_f32_16x16x32_bf16 v[84:87], v[176:179], v[68:71], v[84:87]
    v_mfma_f32_16x16x32_bf16 v[88:91], v[240:243], v[68:71], v[88:91]
    v_mfma_f32_16x16x32_bf16 v[84:87], v[180:183], v[72:75], v[84:87]
    v_mfma_f32_16x16x32_bf16 v[88:91], v[244:247], v[72:75], v[88:91]
    v_mfma_f32_16x16x32_bf16 v[84:87], v[184:187], v[76:79], v[84:87]
    v_mfma_f32_16x16x32_bf16 v[88:91], v[248:251], v[76:79], v[88:91]
    v_mfma_f32_16x16x32_bf16 v[84:87], v[188:191], v[80:83], v[84:87]
    v_mfma_f32_16x16x32_bf16 v[88:91], v[252:255], v[80:83], v[88:91]
    s_nop 6
    v_and_or_b32 v84, v84, s82, v8
    v_and_or_b32 v85, v85, s82, v8
    v_and_or_b32 v86, v86, s82, v8
    v_and_or_b32 v87, v87, s82, v8
    buffer_store_dwordx4 v[84:87], v101, s[48:51], s96 offen sc1
    v_and_or_b32 v88, v88, s82, v8
    v_and_or_b32 v89, v89, s82, v8
    v_and_or_b32 v90, v90, s82, v8
    v_and_or_b32 v91, v91, s82, v8
    buffer_store_dwordx4 v[88:91], v101, s[48:51], s36 offen sc1
    s_cmp_eq_u32 s92, 0
    s_cbranch_scc1 L_prepb
L_hop2:
    s_add_u32 s36, s96, 4096
    buffer_load_dwordx4 v[104:107], v102, s[48:51], s96 offen sc1
    buffer_load_dwordx4 v[108:111], v102, s[48:51], s36 offen sc1
    s_waitcnt vmcnt(0)
    v_xor_b32 v104, s35, v104
    v_xor_b32 v105, s35, v105
    v_xor_b32 v106, s35, v106
    v_xor_b32 v107, s35, v107
    v_xor_b32 v108, s35, v108
    v_xor_b32 v109, s35, v109
    v_xor_b32 v110, s35, v110
    v_xor_b32 v111, s35, v111
    v_or_b32 v4, v104, v105
    v_or3_b32 v4, v4, v106, v107
    v_or3_b32 v4, v4, v108, v109
    v_or3_b32 v4, v4, v110, v111
    v_and_b32 v4, 0xff, v4
    v_cmp_ne_u32 vcc, 0, v4
    s_cbranch_vccz L_hop2ok
    s_sub_u32 s84, s84, 1
    s_cmp_lg_u32 s84, 0
    s_cbranch_scc1 L_hop2
    s_branch L_end
L_hop2ok:
    v_add_f32 v104, v104, v108
    v_add_f32 v105, v105, v109
    v_add_f32 v106, v106, v110
    v_add_f32 v107, v107, v111
    v_permlane16_swap_b32 v104, v105
    s_nop 0
    v_permlane16_swap_b32 v106, v107
    v_add_f32 v104, v104, v105
    v_add_f32 v106, v106, v107
    s_nop 1
    v_permlane32_swap_b32 v104, v106
    v_add_f32 v104, v104, v106
    s_nop 1
    v_add_f32_dpp v104, v104, v104 row_ror:8 row_mask:0xf bank_mask:0xf
    s_nop 1
    v_add_f32_dpp v104, v104, v104 row_ror:4 row_mask:0xf bank_mask:0xf
    v_cvt_pk_bf16_f32 v104, v104, v104
    s_mov_b32 exec_lo, 0xf000f
    s_mov_b32 exec_hi, 0xf000f
    buffer_store_short v104, v103, s[72:75], s97 offen
    s_mov_b64 exec, -1
    s_cmp_lg_u32 s92, 0
    s_cbranch_scc1 L_fin
    s_mov_b32 s92, 1
    s_mov_b32 s96, 3670016
    s_mov_b32 s97, 1024
    s_lshl_b32 s85, s32, 2
    s_add_u32 s85, s85, s34
    s_lshl_b32 s85, s85, 13
    s_add_u32 s85, s85, 5242880
    s_add_u32 s86, s85, 4096
    v_min_u32 v5, 6, v1
    v_lshlrev_b32 v5, 10, v5
L_light:
    buffer_load_dword v6, v5, s[48:51], s85 offen offset:512 sc1
    s_waitcnt vmcnt(0)
    v_xor_b32 v6, s35, v6
    v_and_b32 v6, 0xff, v6
    v_cmp_ne_u32 vcc, 0, v6
    s_nop 0
    s_and_b32 s36, vcc_lo, 0x7f
    s_bcnt1_i32_b32 s36, s36
    s_cmp_le_u32 s36, 2
    s_cbranch_scc1 L_hop1
    s_sleep 2
    s_sub_u32 s84, s84, 1
    s_cmp_lg_u32 s84, 0
    s_cbranch_scc1 L_light
    s_branch L_end
L_hop1:
    buffer_load_dwordx4 v[104:107], v92, s[48:51], s85 offen offset:0 sc1
    buffer_load_dwordx4 v[108:111], v92, s[48:51], s85 offen offset:1024 sc1
    buffer_load_dwordx4 v[112:115], v92, s[48:51], s85 offen offset:2048 sc1
    buffer_load_dwordx4 v[116:119], v92, s[48:51], s85 offen offset:3072 sc1
    buffer_load_dwordx4 v[120:123], v92, s[48:51], s86 offen offset:0 sc1
    buffer_load_dwordx4 v[124:127], v92, s[48:51], s86 offen offset:1024 sc1
    buffer_load_dwordx4 v[84:87], v92, s[48:51], s86 offen offset:2048 sc1
    s_waitcnt vmcnt(0)
    v_xor_b32 v104, s35, v104
    v_xor_b32 v105, s35, v105
    v_xor_b32 v106, s35, v106
    v_xor_b32 v107, s35, v107
    v_xor_b32 v108, s35, v108
    v_xor_b32 v109, s35, v109
    v_xor_b32 v110, s35, v110
    v_xor_b32 v111, s35, v111
    v_xor_b32 v112, s35, v112
    v_xor_b32 v113, s35, v113
    v_xor_b32 v114, s35, v114
    v_xor_b32 v115, s35, v115
    v_xor_b32 v116, s35, v116
    v_xor_b32 v117, s35, v117
    v_xor_b32 v118, s35, v118
    v_xor_b32 v119, s35, v119
    v_xor_b32 v120, s35, v120
    v_xor_b32 v121, s35, v121
    v_xor_b32 v122, s35, v122
    v_xor_b32 v123, s35, v123
    v_xor_b32 v124, s35, v124
    v_xor_b32 v125, s35, v125
    v_xor_b32 v126, s35, v126
    v_xor_b32 v127, s35, v127
    v_xor_b32 v84, s35, v84
    v_xor_b32 v85, s35, v85
    v_xor_b32 v86, s35, v86
    v_xor_b32 v87, s35, v87
    v_or_b32 v4, v104, v105
    v_or3_b32 v4, v4, v106, v107
    v_or3_b32 v4, v4, v108, v109
    v_or3_b32 v4, v4, v110, v111
    v_or3_b32 v4, v4, v112, v113
    v_or3_b32 v4, v4, v114, v115
    v_or3_b32 v4, v4, v116, v117
    v_or3_b32 v4, v4, v118, v119
    v_or3_b32 v4, v4, v120, v121
    v_or3_b32 v4, v4, v122, v123
    v_or3_b32 v4, v4, v124, v125
    v_or3_b32 v4, v4, v126, v127
    v_or3_b32 v4, v4, v84, v85
    v_or3_b32 v4, v4, v86, v87
    v_and_b32 v4, 0xff, v4
    v_cmp_ne_u32 vcc, 0, v4
    s_cbranch_vccz L_hop1ok
    s_sub_u32 s84, s84, 1
    s_cmp_lg_u32 s84, 0
    s_cbranch_scc1 L_hop1
    s_branch L_end
L_hop1ok:
    v_max3_f32 v91, v104, v108, v112
    v_max3_f32 v91, v91, v116, v120
    v_max3_f32 v91, v91, v124, v84
    v_sub_f32 v4, v104, v91
    v_sub_f32 v5, v108, v91
    v_sub_f32 v6, v112, v91
    v_sub_f32 v7, v116, v91
    v_sub_f32 v88, v120, v91
    v_sub_f32 v89, v124, v91
    v_sub_f32 v90, v84, v91
    v_exp_f32 v4, v4
    v_exp_f32 v5, v5
    v_exp_f32 v6, v6
    v_exp_f32 v7, v7
    v_exp_f32 v88, v88
    v_exp_f32 v89, v89
    v_exp_f32 v90, v90
    v_mul_f32_dpp v11, v4, v105 row_newbcast:8 row_mask:0xf bank_mask:0xf
    v_mul_f32_dpp v10, v4, v104 row_newbcast:8 row_mask:0xf bank_mask:0xf
    v_mul_f32_dpp v12, v4, v106 row_newbcast:8 row_mask:0xf bank_mask:0xf
    v_mul_f32_dpp v13, v4, v107 row_newbcast:8 row_mask:0xf bank_mask:0xf
    v_fmac_f32_dpp v11, v5, v109 row_newbcast:8 row_mask:0xf bank_mask:0xf
    v_fmac_f32_dpp v10, v5, v108 row_newbcast:8 row_mask:0xf bank_mask:0xf
    v_fmac_f32_dpp v12, v5, v110 row_newbcast:8 row_mask:0xf bank_mask:0xf
    v_fmac_f32_dpp v13, v5, v111 row_newbcast:8 row_mask:0xf bank_mask:0xf
    v_fmac_f32_dpp v11, v6, v113 row_newbcast:8 row_mask:0xf bank_mask:0xf
    v_fmac_f32_dpp v10, v6, v112 row_newbcast:8 row_mask:0xf bank_mask:0xf
    v_fmac_f32_dpp v12, v6, v114 row_newbcast:8 row_mask:0xf bank_mask:0xf
    v_fmac_f32_dpp v13, v6, v115 row_newbcast:8 row_mask:0xf bank_mask:0xf
    v_fmac_f32_dpp v11, v7, v117 row_newbcast:8 row_mask:0xf bank_mask:0xf
    v_fmac_f32_dpp v10, v7, v116 row_newbcast:8 row_mask:0xf bank_mask:0xf
    v_fmac_f32_dpp v12, v7, v118 row_newbcast:8 row_mask:0xf bank_mask:0xf
    v_fmac_f32_dpp v13, v7, v119 row_newbcast:8 row_mask:0xf bank_mask:0xf
    v_fmac_f32_dpp v11, v88, v121 row_newbcast:8 row_mask:0xf bank_mask:0xf
    v_fmac_f32_dpp v10, v88, v120 row_newbcast:8 row_mask:0xf bank_mask:0xf
    v_fmac_f32_dpp v12, v88, v122 row_newbcast:8 row_mask:0xf bank_mask:0xf
    v_fmac_f32_dpp v13, v88, v123 row_newbcast:8 row_mask:0xf bank_mask:0xf
    v_fmac_f32_dpp v11, v89, v125 row_newbcast:8 row_mask:0xf bank_mask:0xf
    v_fmac_f32_dpp v10, v89, v124 row_newbcast:8 row_mask:0xf bank_mask:0xf
    v_fmac_f32_dpp v12, v89, v126 row_newbcast:8 row_mask:0xf bank_mask:0xf
    v_fmac_f32_dpp v13, v89, v127 row_newbcast:8 row_mask:0xf bank_mask:0xf
    v_fmac_f32_dpp v11, v90, v85 row_newbcast:8 row_mask:0xf bank_mask:0xf
    v_fmac_f32_dpp v10, v90, v84 row_newbcast:8 row_mask:0xf bank_mask:0xf
    v_fmac_f32_dpp v12, v90, v86 row_newbcast:8 row_mask:0xf bank_mask:0xf
    v_fmac_f32_dpp v13, v90, v87 row_newbcast:8 row_mask:0xf bank_mask:0xf
    v_rcp_f32 v91, v11
    s_nop 1
    v_mul_f32_dpp v10, v91, v10 row_newbcast:8 row_mask:0xf bank_mask:0xf
    v_mul_f32_dpp v11, v91, v11 row_newbcast:8 row_mask:0xf bank_mask:0xf
    v_mul_f32_dpp v12, v91, v12 row_newbcast:8 row_mask:0xf bank_mask:0xf
    v_mul_f32_dpp v13, v91, v13 row_newbcast:8 row_mask:0xf bank_mask:0xf
    v_cvt_pk_bf16_f32 v10, v10, v11
    v_cvt_pk_bf16_f32 v12, v12, v13
    s_mov_b32 exec_lo, 0xff00ff
    s_mov_b32 exec_hi, 0xff00ff
    ds_write_b16 v93, v10
    ds_write_b16_d16_hi v93, v10 offset:16
    ds_write_b16 v93, v12 offset:32
    ds_write_b16_d16_hi v93, v12 offset:48
    s_mov_b64 exec, -1
    s_branch L_final
L_prepb:
    s_waitcnt vmcnt(0)
    ds_write_b128 v96, a[128:131] offset:0
    ds_write_b128 v97, a[132:135] offset:1024
    ds_write_b128 v98, a[136:139] offset:2048
    ds_write_b128 v99, a[140:143] offset:3072
    ds_write_b128 v96, a[144:147] offset:4096
    ds_write_b128 v97, a[148:151] offset:5120
    ds_write_b128 v98, a[152:155] offset:6144
    ds_write_b128 v99, a[156:159] offset:7168
    ds_write_b128 v96, a[160:163] offset:8192
    ds_write_b128 v97, a[164:167] offset:9216
    ds_write_b128 v98, a[168:171] offset:10240
    ds_write_b128 v99, a[172:175] offset:11264
    ds_write_b128 v96, a[176:179] offset:12288
    ds_write_b128 v97, a[180:183] offset:13312
    ds_write_b128 v98, a[184:187] offset:14336
    ds_write_b128 v99, a[188:191] offset:15360
    ds_write_b128 v96, a[192:195] offset:16384
    ds_write_b128 v97, a[196:199] offset:17408
    ds_write_b128 v98, a[200:203] offset:18432
    ds_write_b128 v99, a[204:207] offset:19456
    ds_write_b128 v96, a[208:211] offset:20480
    ds_write_b128 v97, a[212:215] offset:21504
    ds_write_b128 v98, a[216:219] offset:22528
    ds_write_b128 v99, a[220:223] offset:23552
    ds_write_b128 v96, a[224:227] offset:24576
    ds_write_b128 v97, a[228:231] offset:25600
    ds_write_b128 v98, a[232:235] offset:26624
    ds_write_b128 v99, a[236:239] offset:27648
    ds_write_b128 v96, a[240:243] offset:28672
    ds_write_b128 v97, a[244:247] offset:29696
    ds_write_b128 v98, a[248:251] offset:30720
    ds_write_b128 v99, a[252:255] offset:31744
    s_waitcnt lgkmcnt(0)
    v_xor_b32 v4, 0, v95
    ds_read_b64_tr_b16 v[128:129], v4 offset:0
    ds_read_b64_tr_b16 v[132:133], v4 offset:8192
    ds_read_b64_tr_b16 v[136:137], v4 offset:16384
    ds_read_b64_tr_b16 v[140:141], v4 offset:24576
    v_xor_b32 v5, 16, v95
    ds_read_b64_tr_b16 v[130:131], v5 offset:1024
    ds_read_b64_tr_b16 v[134:135], v5 offset:9216
    ds_read_b64_tr_b16 v[138:139], v5 offset:17408
    ds_read_b64_tr_b16 v[142:143], v5 offset:25600
    v_xor_b32 v4, 32, v95
    ds_read_b64_tr_b16 v[144:145], v4 offset:0
    ds_read_b64_tr_b16 v[148:149], v4 offset:8192
    ds_read_b64_tr_b16 v[152:153], v4 offset:16384
    ds_read_b64_tr_b16 v[156:157], v4 offset:24576
    v_xor_b32 v5, 48, v95
    ds_read_b64_tr_b16 v[146:147], v5 offset:1024
    ds_read_b64_tr_b16 v[150:151], v5 offset:9216
    ds_read_b64_tr_b16 v[154:155], v5 offset:17408
    ds_read_b64_tr_b16 v[158:159], v5 offset:25600
    v_xor_b32 v4, 64, v95
    ds_read_b64_tr_b16 v[160:161], v4 offset:0
    ds_read_b64_tr_b16 v[164:165], v4 offset:8192
    ds_read_b64_tr_b16 v[168:169], v4 offset:16384
    ds_read_b64_tr_b16 v[172:173], v4 offset:24576
    v_xor_b32 v5, 80, v95
    ds_read_b64_tr_b16 v[162:163], v5 offset:1024
    ds_read_b64_tr_b16 v[166:167], v5 offset:9216
    ds_read_b64_tr_b16 v[170:171], v5 offset:17408
    ds_read_b64_tr_b16 v[174:175], v5 offset:25600
    v_xor_b32 v4, 96, v95
    ds_read_b64_tr_b16 v[176:177], v4 offset:0
    ds_read_b64_tr_b16 v[180:181], v4 offset:8192
    ds_read_b64_tr_b16 v[184:185], v4 offset:16384
    ds_read_b64_tr_b16 v[188:189], v4 offset:24576
    v_xor_b32 v5, 112, v95
    ds_read_b64_tr_b16 v[178:179], v5 offset:1024
    ds_read_b64_tr_b16 v[182:183], v5 offset:9216
    ds_read_b64_tr_b16 v[186:187], v5 offset:17408
    ds_read_b64_tr_b16 v[190:191], v5 offset:25600
    v_xor_b32 v4, 128, v95
    ds_read_b64_tr_b16 v[192:193], v4 offset:0
    ds_read_b64_tr_b16 v[196:197], v4 offset:8192
    ds_read_b64_tr_b16 v[200:201], v4 offset:16384
    ds_read_b64_tr_b16 v[204:205], v4 offset:24576
    v_xor_b32 v5, 144, v95
    ds_read_b64_tr_b16 v[194:195], v5 offset:1024
    ds_read_b64_tr_b16 v[198:199], v5 offset:9216
    ds_read_b64_tr_b16 v[202:203], v5 offset:17408
    ds_read_b64_tr_b16 v[206:207], v5 offset:25600
    v_xor_b32 v4, 160, v95
    ds_read_b64_tr_b16 v[208:209], v4 offset:0
    ds_read_b64_tr_b16 v[212:213], v4 offset:8192
    ds_read_b64_tr_b16 v[216:217], v4 offset:16384
    ds_read_b64_tr_b16 v[220:221], v4 offset:24576
    v_xor_b32 v5, 176, v95
    ds_read_b64_tr_b16 v[210:211], v5 offset:1024
    ds_read_b64_tr_b16 v[214:215], v5 offset:9216
    ds_read_b64_tr_b16 v[218:219], v5 offset:17408
    ds_read_b64_tr_b16 v[222:223], v5 offset:25600
    v_xor_b32 v4, 192, v95
    ds_read_b64_tr_b16 v[224:225], v4 offset:0
    ds_read_b64_tr_b16 v[228:229], v4 offset:8192
    ds_read_b64_tr_b16 v[232:233], v4 offset:16384
    ds_read_b64_tr_b16 v[236:237], v4 offset:24576
    v_xor_b32 v5, 208, v95
    ds_read_b64_tr_b16 v[226:227], v5 offset:1024
    ds_read_b64_tr_b16 v[230:231], v5 offset:9216
    ds_read_b64_tr_b16 v[234:235], v5 offset:17408
    ds_read_b64_tr_b16 v[238:239], v5 offset:25600
    v_xor_b32 v4, 224, v95
    ds_read_b64_tr_b16 v[240:241], v4 offset:0
    ds_read_b64_tr_b16 v[244:245], v4 offset:8192
    ds_read_b64_tr_b16 v[248:249], v4 offset:16384
    ds_read_b64_tr_b16 v[252:253], v4 offset:24576
    v_xor_b32 v5, 240, v95
    ds_read_b64_tr_b16 v[242:243], v5 offset:1024
    ds_read_b64_tr_b16 v[246:247], v5 offset:9216
    ds_read_b64_tr_b16 v[250:251], v5 offset:17408
    ds_read_b64_tr_b16 v[254:255], v5 offset:25600
    s_waitcnt lgkmcnt(0)
    s_barrier
    s_branch L_hop2
L_fin:
    s_or_b32 s36, s32, s34
    s_cmp_lg_u32 s36, 0
    s_cbranch_scc1 L_end
    v_mov_b32 v4, 0
    s_mov_b64 exec, 1
    buffer_store_dword v8, v4, s[48:51], 0 offen
L_end:
    s_endpgm
.section .rodata,"a"
.p2align 6
.amdhsa_kernel concat_heads__compressed_kv_cla__mha_block_cached__decode_kernel
  .amdhsa_next_free_vgpr 512
  .amdhsa_next_free_sgpr 102
  .amdhsa_accum_offset 256
  .amdhsa_group_segment_fixed_size 0
  .amdhsa_kernarg_size 112
  .amdhsa_user_sgpr_count 2
  .amdhsa_user_sgpr_kernarg_segment_ptr 1
  .amdhsa_system_sgpr_workgroup_id_x 1
.end_amdhsa_kernel
```

```asm
; @launch grid=(256,1,1) block=(256,1,1) lds=163840
    .amdgcn_target "amdgcn-amd-amdhsa--gfx950"
    .text
    .globl concat_heads__compressed_kv_cla__mha_block_cached__decode_kernel
    .p2align 8
    .type concat_heads__compressed_kv_cla__mha_block_cached__decode_kernel,@function
concat_heads__compressed_kv_cla__mha_block_cached__decode_kernel:
    s_cmp_ge_u32 s2, 256
    s_cbranch_scc1 L_end
    s_load_dwordx16 s[4:19], s[0:1], 0
    s_load_dwordx8 s[20:27], s[0:1], 64
    s_load_dwordx4 s[28:31], s[0:1], 96
    v_lshrrev_b32 v4, 6, v0
    v_and_b32 v1, 63, v0
    v_readfirstlane_b32 s34, v4
    s_lshr_b32 s32, s2, 3
    s_sub_u32 s33, s2, s32
    s_sub_u32 s33, s33, 1
    s_and_b32 s33, s33, 7
    v_lshrrev_b32 v2, 4, v1
    v_and_b32 v3, 15, v1
    v_lshlrev_b32 v4, 16, v2
    v_lshl_add_u32 v14, v3, 4, v4
    v_lshrrev_b32 v5, 3, v3
    v_lshlrev_b32 v5, 10, v5
    v_lshl_add_u32 v15, v2, 4, v5
    s_and_b32 s36, s33, 3
    s_lshl_b32 s36, s36, 2
    s_add_u32 s36, s36, s34
    s_lshl_b32 s37, s36, 6
    s_lshl_b32 s36, s36, 18
    s_lshl_b32 s38, s32, 8
    s_add_u32 s36, s36, s38
    s_mov_b32 s42, 4194304
    s_mov_b32 s43, 0x20000
    s_mov_b32 s46, 4096
    s_mov_b32 s47, 0x20000
    s_cmp_ge_u32 s33, 4
    s_waitcnt lgkmcnt(0)
    s_cselect_b64 s[40:41], s[8:9], s[22:23]
    s_cselect_b64 s[44:45], s[4:5], s[16:17]
    s_load_dword s35, s[30:31], 0
    buffer_load_dwordx4 v[20:23], v15, s[44:47], s37 offen offset:0
    buffer_load_dwordx4 v[24:27], v15, s[44:47], s37 offen offset:2048
    buffer_load_dwordx4 v[44:47], v14, s[40:43], s36 offen nt
    s_add_u32 s36, s36, 8192
    buffer_load_dwordx4 v[48:51], v14, s[40:43], s36 offen nt
    s_add_u32 s36, s36, 8192
    buffer_load_dwordx4 v[52:55], v14, s[40:43], s36 offen nt
    s_add_u32 s36, s36, 8192
    buffer_load_dwordx4 v[56:59], v14, s[40:43], s36 offen nt
    s_add_u32 s36, s36, 8192
    buffer_load_dwordx4 v[60:63], v14, s[40:43], s36 offen nt
    s_add_u32 s36, s36, 8192
    buffer_load_dwordx4 v[64:67], v14, s[40:43], s36 offen nt
    s_add_u32 s36, s36, 8192
    buffer_load_dwordx4 v[68:71], v14, s[40:43], s36 offen nt
    s_add_u32 s36, s36, 8192
    buffer_load_dwordx4 v[72:75], v14, s[40:43], s36 offen nt
    s_mov_b32 s48, s30
    s_and_b32 s49, s31, 0xffff
    s_mov_b32 s50, 8388608
    s_mov_b32 s51, 0x20000
    s_mov_b32 s80, 0x01000100
    s_mov_b32 s81, 0x03020302
    s_mov_b32 s82, 0xffffff00
    s_mov_b32 s83, 0x3e0293ee
    s_mov_b32 s84, 1048576
    v_and_b32 v4, 1, v1
    v_lshlrev_b32 v4, 4, v4
    v_mov_b32 v5, 0xffff
    v_lshlrev_b32 v4, v4, v5
    v_bfe_u32 v5, v1, 1, 2
    v_cmp_eq_u32 vcc, 0, v5
    s_nop 1
    v_cndmask_b32 v10, 0, v4, vcc
    v_cmp_eq_u32 vcc, 1, v5
    s_nop 1
    v_cndmask_b32 v11, 0, v4, vcc
    v_cmp_eq_u32 vcc, 2, v5
    s_nop 1
    v_cndmask_b32 v12, 0, v4, vcc
    v_cmp_eq_u32 vcc, 3, v5
    s_nop 1
    v_cndmask_b32 v13, 0, v4, vcc
    s_cmp_eq_u32 s33, 7
    s_cbranch_scc1 L_aux
    s_mov_b32 s52, s18
    s_and_b32 s53, s19, 0xffff
    s_mov_b32 s54, 134217728
    s_mov_b32 s55, 0x20000
    s_mov_b32 s56, s20
    s_and_b32 s57, s21, 0xffff
    s_mov_b32 s58, 134217728
    s_mov_b32 s59, 0x20000
    v_lshrrev_b32 v4, 2, v3
    v_and_b32 v5, 3, v3
    v_lshlrev_b32 v76, 12, v4
    v_lshlrev_b32 v126, 12, v2
    v_lshl_add_u32 v76, v2, 6, v76
    v_lshl_add_u32 v76, v5, 4, v76
    v_lshl_add_u32 v126, v3, 4, v126
    v_xor_b32 v77, 32768, v76
    v_xor_b32 v127, 32768, v126
    v_lshlrev_b32 v78, 11, v4
    v_lshl_add_u32 v78, v2, 7, v78
    v_lshl_add_u32 v78, v5, 5, v78
    s_lshl_b32 s89, s34, 5
    s_add_u32 s89, s89, s32
    s_lshl_b32 s89, s89, 20
    s_mul_i32 s88, s32, 8
    s_mul_i32 s38, s34, 1
    s_add_u32 s88, s88, s38
    s_mov_b32 s87, s33
    s_lshl_b32 s38, s32, 2
    s_add_u32 s38, s38, s34
    s_lshl_b32 s38, s38, 8
    s_add_u32 s38, s38, 65536
    v_mov_b32 v9, s38
    v_mov_b32 v18, 1
    v_mov_b32 v19, 0
    s_cmp_eq_u32 s33, 0
    s_cselect_b32 s38, 0, 8388608
    s_mov_b64 exec, 1
    buffer_store_dword v19, v9, s[48:51], s38 offen sc1
    s_mov_b64 exec, -1
    s_waitcnt vmcnt(8)
    v_perm_b32 v4, v20, v20, s80
    v_perm_b32 v5, v24, v24, s80
    v_and_b32 v28, v4, v10
    v_and_b32 v29, v4, v11
    v_and_b32 v30, v4, v12
    v_and_b32 v31, v4, v13
    v_and_b32 v32, v5, v10
    v_and_b32 v33, v5, v11
    v_and_b32 v34, v5, v12
    v_and_b32 v35, v5, v13
    v_mfma_f32_16x16x32_bf16 v[36:39], v[44:47], v[28:31], 0
    s_nop 0
    v_mfma_f32_16x16x32_bf16 v[40:43], v[44:47], v[32:35], 0
    s_waitcnt vmcnt(7)
    s_add_u32 s39, s87, s88
    s_bfe_u32 s37, s39, 0x10000
    s_lshl_b32 s37, s37, 14
    s_add_u32 s85, s37, s89
    s_bfe_u32 s37, s39, 0x30001
    s_lshl_b32 s37, s37, 9
    s_add_u32 s85, s37, s85
    s_bfe_u32 s37, s39, 0x40004
    s_lshl_b32 s37, s37, 16
    s_add_u32 s85, s37, s85
    buffer_load_dwordx4 v[128:131], v76, s[52:55], s85 offen offset:0 nt
    v_perm_b32 v4, v20, v20, s81
    v_perm_b32 v5, v24, v24, s81
    v_and_b32 v28, v4, v10
    v_and_b32 v29, v4, v11
    v_and_b32 v30, v4, v12
    v_and_b32 v31, v4, v13
    v_and_b32 v32, v5, v10
    v_and_b32 v33, v5, v11
    v_and_b32 v34, v5, v12
    v_and_b32 v35, v5, v13
    v_mfma_f32_16x16x32_bf16 v[36:39], v[48:51], v[28:31], v[36:39]
    s_nop 0
    v_mfma_f32_16x16x32_bf16 v[40:43], v[48:51], v[32:35], v[40:43]
    s_waitcnt vmcnt(7)
    buffer_load_dwordx4 v[132:135], v77, s[52:55], s85 offen offset:256 nt
    v_perm_b32 v4, v21, v21, s80
    v_perm_b32 v5, v25, v25, s80
    v_and_b32 v28, v4, v10
    v_and_b32 v29, v4, v11
    v_and_b32 v30, v4, v12
    v_and_b32 v31, v4, v13
    v_and_b32 v32, v5, v10
    v_and_b32 v33, v5, v11
    v_and_b32 v34, v5, v12
    v_and_b32 v35, v5, v13
    v_mfma_f32_16x16x32_bf16 v[36:39], v[52:55], v[28:31], v[36:39]
    s_nop 0
    v_mfma_f32_16x16x32_bf16 v[40:43], v[52:55], v[32:35], v[40:43]
    s_waitcnt vmcnt(7)
    buffer_load_dwordx4 v[136:139], v76, s[52:55], s85 offen offset:256 nt
    v_perm_b32 v4, v21, v21, s81
    v_perm_b32 v5, v25, v25, s81
    v_and_b32 v28, v4, v10
    v_and_b32 v29, v4, v11
    v_and_b32 v30, v4, v12
    v_and_b32 v31, v4, v13
    v_and_b32 v32, v5, v10
    v_and_b32 v33, v5, v11
    v_and_b32 v34, v5, v12
    v_and_b32 v35, v5, v13
    v_mfma_f32_16x16x32_bf16 v[36:39], v[56:59], v[28:31], v[36:39]
    s_nop 0
    v_mfma_f32_16x16x32_bf16 v[40:43], v[56:59], v[32:35], v[40:43]
    s_waitcnt vmcnt(7)
    buffer_load_dwordx4 v[140:143], v77, s[52:55], s85 offen offset:0 nt
    v_perm_b32 v4, v22, v22, s80
    v_perm_b32 v5, v26, v26, s80
    v_and_b32 v28, v4, v10
    v_and_b32 v29, v4, v11
    v_and_b32 v30, v4, v12
    v_and_b32 v31, v4, v13
    v_and_b32 v32, v5, v10
    v_and_b32 v33, v5, v11
    v_and_b32 v34, v5, v12
    v_and_b32 v35, v5, v13
    v_mfma_f32_16x16x32_bf16 v[36:39], v[60:63], v[28:31], v[36:39]
    s_nop 0
    v_mfma_f32_16x16x32_bf16 v[40:43], v[60:63], v[32:35], v[40:43]
    s_waitcnt vmcnt(7)
    buffer_load_dwordx4 v[144:147], v126, s[56:59], s85 offen offset:0 nt
    v_perm_b32 v4, v22, v22, s81
    v_perm_b32 v5, v26, v26, s81
    v_and_b32 v28, v4, v10
    v_and_b32 v29, v4, v11
    v_and_b32 v30, v4, v12
    v_and_b32 v31, v4, v13
    v_and_b32 v32, v5, v10
    v_and_b32 v33, v5, v11
    v_and_b32 v34, v5, v12
    v_and_b32 v35, v5, v13
    v_mfma_f32_16x16x32_bf16 v[36:39], v[64:67], v[28:31], v[36:39]
    s_nop 0
    v_mfma_f32_16x16x32_bf16 v[40:43], v[64:67], v[32:35], v[40:43]
    s_waitcnt vmcnt(7)
    buffer_load_dwordx4 v[148:151], v127, s[56:59], s85 offen offset:256 nt
    v_perm_b32 v4, v23, v23, s80
    v_perm_b32 v5, v27, v27, s80
    v_and_b32 v28, v4, v10
    v_and_b32 v29, v4, v11
    v_and_b32 v30, v4, v12
    v_and_b32 v31, v4, v13
    v_and_b32 v32, v5, v10
    v_and_b32 v33, v5, v11
    v_and_b32 v34, v5, v12
    v_and_b32 v35, v5, v13
    v_mfma_f32_16x16x32_bf16 v[36:39], v[68:71], v[28:31], v[36:39]
    s_nop 0
    v_mfma_f32_16x16x32_bf16 v[40:43], v[68:71], v[32:35], v[40:43]
    s_waitcnt vmcnt(7)
    buffer_load_dwordx4 v[152:155], v126, s[56:59], s85 offen offset:256 nt
    v_perm_b32 v4, v23, v23, s81
    v_perm_b32 v5, v27, v27, s81
    v_and_b32 v28, v4, v10
    v_and_b32 v29, v4, v11
    v_and_b32 v30, v4, v12
    v_and_b32 v31, v4, v13
    v_and_b32 v32, v5, v10
    v_and_b32 v33, v5, v11
    v_and_b32 v34, v5, v12
    v_and_b32 v35, v5, v13
    v_mfma_f32_16x16x32_bf16 v[36:39], v[72:75], v[28:31], v[36:39]
    s_nop 0
    v_mfma_f32_16x16x32_bf16 v[40:43], v[72:75], v[32:35], v[40:43]
    s_lshl_b32 s38, s34, 11
    s_add_u32 s38, s38, 131072
    v_lshrrev_b32 v4, 3, v3
    v_lshlrev_b32 v4, 9, v4
    v_lshl_add_u32 v4, v2, 7, v4
    v_and_b32 v5, 7, v3
    v_lshl_add_u32 v4, v5, 2, v4
    v_add_u32 v4, s38, v4
    s_lshl_b32 s38, s34, 9
    v_and_b32 v5, 31, v1
    v_lshl_add_u32 v5, v5, 4, s38
    v_add_u32 v6, 131072, v5
    ds_write_b32 v4, v36 offset:0
    ds_write_b32 v4, v37 offset:32
    ds_write_b32 v4, v38 offset:64
    ds_write_b32 v4, v39 offset:96
    ds_write_b32 v4, v40 offset:1024
    ds_write_b32 v4, v41 offset:1056
    ds_write_b32 v4, v42 offset:1088
    ds_write_b32 v4, v43 offset:1120
    s_waitcnt lgkmcnt(0)
    s_barrier
    ds_read_b128 v[44:47], v6 offset:0
    ds_read_b128 v[48:51], v6 offset:2048
    ds_read_b128 v[52:55], v6 offset:4096
    ds_read_b128 v[56:59], v6 offset:6144
    s_add_u32 s35, s35, 0x5b
    s_and_b32 s35, s35, 0xff
    v_mov_b32 v8, s35
    s_lshl_b32 s38, s32, 3
    s_add_u32 s38, s38, s33
    s_lshl_b32 s38, s38, 11
    s_add_u32 s38, s38, 1048576
    s_waitcnt lgkmcnt(0)
    v_add_f32 v44, v44, v48
    v_add_f32 v52, v52, v56
    v_add_f32 v45, v45, v49
    v_add_f32 v53, v53, v57
    v_add_f32 v46, v46, v50
    v_add_f32 v54, v54, v58
    v_add_f32 v47, v47, v51
    v_add_f32 v55, v55, v59
    v_add_f32 v44, v44, v52
    v_add_f32 v45, v45, v53
    v_add_f32 v46, v46, v54
    v_add_f32 v47, v47, v55
    v_and_or_b32 v44, v44, s82, v8
    v_and_or_b32 v45, v45, s82, v8
    v_and_or_b32 v46, v46, s82, v8
    v_and_or_b32 v47, v47, s82, v8
    s_waitcnt vmcnt(7)
    s_mov_b32 exec_lo, 0xffffffff
    s_mov_b32 exec_hi, 0x0
    buffer_store_dwordx4 v[44:47], v5, s[48:51], s38 offen sc1
    s_mov_b64 exec, -1
    s_lshl_b32 s86, s32, 14
    s_lshl_b32 s38, s34, 9
    s_add_u32 s86, s86, s38
    s_add_u32 s86, s86, 1048576
    v_mov_b32 v120, 0xff7f0000
    v_mov_b32 v121, 0
    v_mov_b32 v116, 0
    v_mov_b32 v117, 0
    v_mov_b32 v118, 0
    v_mov_b32 v119, 0
    v_lshlrev_b32 v4, 7, v2
    v_lshl_add_u32 v4, v3, 4, v4
    v_mov_b32 v5, 512
    v_cmp_gt_u32 vcc, 8, v3
    s_nop 1
    v_cndmask_b32 v79, v5, v4, vcc
    s_waitcnt vmcnt(7)
    buffer_load_dwordx4 v[156:159], v127, s[56:59], s85 offen offset:0 nt
    s_waitcnt vmcnt(7)
    s_add_u32 s87, s87, 7
    s_add_u32 s39, s87, s88
    s_bfe_u32 s37, s39, 0x10000
    s_lshl_b32 s37, s37, 14
    s_add_u32 s85, s37, s89
    s_bfe_u32 s37, s39, 0x30001
    s_lshl_b32 s37, s37, 9
    s_add_u32 s85, s37, s85
    s_bfe_u32 s37, s39, 0x40004
    s_lshl_b32 s37, s37, 16
    s_add_u32 s85, s37, s85
    buffer_load_dwordx4 v[160:163], v76, s[52:55], s85 offen offset:0 nt
    s_waitcnt vmcnt(7)
    buffer_load_dwordx4 v[164:167], v77, s[52:55], s85 offen offset:256 nt
    s_waitcnt vmcnt(7)
    buffer_load_dwordx4 v[168:171], v76, s[52:55], s85 offen offset:256 nt
    s_waitcnt vmcnt(7)
    buffer_load_dwordx4 v[172:175], v77, s[52:55], s85 offen offset:0 nt
    s_waitcnt vmcnt(7)
    buffer_load_dwordx4 v[176:179], v126, s[56:59], s85 offen offset:0 nt
    s_waitcnt vmcnt(7)
    buffer_load_dwordx4 v[180:183], v127, s[56:59], s85 offen offset:256 nt
    s_waitcnt vmcnt(6)
    buffer_load_dwordx4 v[184:187], v126, s[56:59], s85 offen offset:256 nt
    s_waitcnt vmcnt(6)
    buffer_load_dwordx4 v[188:191], v127, s[56:59], s85 offen offset:0 nt
    s_waitcnt vmcnt(6)
    s_add_u32 s87, s87, 7
    s_add_u32 s39, s87, s88
    s_bfe_u32 s37, s39, 0x10000
    s_lshl_b32 s37, s37, 14
    s_add_u32 s85, s37, s89
    s_bfe_u32 s37, s39, 0x30001
    s_lshl_b32 s37, s37, 9
    s_add_u32 s85, s37, s85
    s_bfe_u32 s37, s39, 0x40004
    s_lshl_b32 s37, s37, 16
    s_add_u32 s85, s37, s85
    buffer_load_dwordx4 v[192:195], v76, s[52:55], s85 offen offset:0 nt
    s_waitcnt vmcnt(6)
    buffer_load_dwordx4 v[196:199], v77, s[52:55], s85 offen offset:256 nt
    s_waitcnt vmcnt(6)
    buffer_load_dwordx4 v[200:203], v76, s[52:55], s85 offen offset:256 nt
    s_waitcnt vmcnt(6)
    buffer_load_dwordx4 v[204:207], v77, s[52:55], s85 offen offset:0 nt
    buffer_load_dwordx4 v[44:47], v78, s[48:51], s86 offen offset:0 sc1
    buffer_load_dwordx4 v[48:51], v78, s[48:51], s86 offen offset:16 sc1
    s_waitcnt vmcnt(8)
    buffer_load_dwordx4 v[208:211], v126, s[56:59], s85 offen offset:0 nt
    s_waitcnt vmcnt(8)
    buffer_load_dwordx4 v[212:215], v127, s[56:59], s85 offen offset:256 nt
    s_waitcnt vmcnt(8)
    buffer_load_dwordx4 v[216:219], v126, s[56:59], s85 offen offset:256 nt
    s_waitcnt vmcnt(8)
    buffer_load_dwordx4 v[220:223], v127, s[56:59], s85 offen offset:0 nt
    s_waitcnt vmcnt(8)
    s_add_u32 s87, s87, 7
    s_add_u32 s39, s87, s88
    s_bfe_u32 s37, s39, 0x10000
    s_lshl_b32 s37, s37, 14
    s_add_u32 s85, s37, s89
    s_bfe_u32 s37, s39, 0x30001
    s_lshl_b32 s37, s37, 9
    s_add_u32 s85, s37, s85
    s_bfe_u32 s37, s39, 0x40004
    s_lshl_b32 s37, s37, 16
    s_add_u32 s85, s37, s85
    buffer_load_dwordx4 v[224:227], v76, s[52:55], s85 offen offset:0 nt
    s_waitcnt vmcnt(8)
    buffer_load_dwordx4 v[228:231], v77, s[52:55], s85 offen offset:256 nt
    s_waitcnt vmcnt(6)
L_qcheck_1:
    v_xor_b32 v44, s35, v44
    v_xor_b32 v45, s35, v45
    v_xor_b32 v46, s35, v46
    v_xor_b32 v47, s35, v47
    v_xor_b32 v48, s35, v48
    v_xor_b32 v49, s35, v49
    v_xor_b32 v50, s35, v50
    v_xor_b32 v51, s35, v51
    v_or_b32 v4, v44, v45
    v_or3_b32 v4, v4, v46, v47
    v_or3_b32 v4, v4, v48, v49
    v_or3_b32 v4, v4, v50, v51
    v_and_b32 v4, 0xff, v4
    v_cmp_ne_u32 vcc, 0, v4
    s_cbranch_vccz L_qok_2
    buffer_load_dwordx4 v[44:47], v78, s[48:51], s86 offen offset:0 sc1
    buffer_load_dwordx4 v[48:51], v78, s[48:51], s86 offen offset:16 sc1
    s_waitcnt vmcnt(0)
    s_sub_u32 s84, s84, 1
    s_cmp_lg_u32 s84, 0
    s_cbranch_scc1 L_qcheck_1
    s_branch L_end
L_qok_2:
    v_add_f32_dpp v44, v44, v44 row_ror:8 row_mask:0xf bank_mask:0xf
    v_add_f32_dpp v45, v45, v45 row_ror:8 row_mask:0xf bank_mask:0xf
    v_add_f32_dpp v46, v46, v46 row_ror:8 row_mask:0xf bank_mask:0xf
    v_add_f32_dpp v47, v47, v47 row_ror:8 row_mask:0xf bank_mask:0xf
    v_add_f32_dpp v48, v48, v48 row_ror:8 row_mask:0xf bank_mask:0xf
    v_add_f32_dpp v49, v49, v49 row_ror:8 row_mask:0xf bank_mask:0xf
    v_add_f32_dpp v50, v50, v50 row_ror:8 row_mask:0xf bank_mask:0xf
    v_add_f32_dpp v51, v51, v51 row_ror:8 row_mask:0xf bank_mask:0xf
    v_add_f32_dpp v44, v44, v44 row_ror:4 row_mask:0xf bank_mask:0xf
    v_add_f32_dpp v45, v45, v45 row_ror:4 row_mask:0xf bank_mask:0xf
    v_add_f32_dpp v46, v46, v46 row_ror:4 row_mask:0xf bank_mask:0xf
    v_add_f32_dpp v47, v47, v47 row_ror:4 row_mask:0xf bank_mask:0xf
    v_add_f32_dpp v48, v48, v48 row_ror:4 row_mask:0xf bank_mask:0xf
    v_add_f32_dpp v49, v49, v49 row_ror:4 row_mask:0xf bank_mask:0xf
    v_add_f32_dpp v50, v50, v50 row_ror:4 row_mask:0xf bank_mask:0xf
    v_add_f32_dpp v51, v51, v51 row_ror:4 row_mask:0xf bank_mask:0xf
    v_cvt_pk_bf16_f32 v44, v44, v45
    v_cvt_pk_bf16_f32 v45, v46, v47
    v_cvt_pk_bf16_f32 v46, v48, v49
    v_cvt_pk_bf16_f32 v47, v50, v51
    s_mov_b32 vcc_lo, 0xf000f
    s_mov_b32 vcc_hi, 0xf000f
    v_cndmask_b32 v80, 0, v44, vcc
    v_cndmask_b32 v81, 0, v45, vcc
    v_cndmask_b32 v82, 0, v46, vcc
    v_cndmask_b32 v83, 0, v47, vcc
    s_mov_b32 vcc_lo, 0xf000f0
    s_mov_b32 vcc_hi, 0xf000f0
    v_cndmask_b32 v84, 0, v44, vcc
    v_cndmask_b32 v85, 0, v45, vcc
    v_cndmask_b32 v86, 0, v46, vcc
    v_cndmask_b32 v87, 0, v47, vcc
    s_mov_b32 vcc_lo, 0xf000f00
    s_mov_b32 vcc_hi, 0xf000f00
    v_cndmask_b32 v88, 0, v44, vcc
    v_cndmask_b32 v89, 0, v45, vcc
    v_cndmask_b32 v90, 0, v46, vcc
    v_cndmask_b32 v91, 0, v47, vcc
    s_mov_b32 vcc_lo, 0xf000f000
    s_mov_b32 vcc_hi, 0xf000f000
    v_cndmask_b32 v92, 0, v44, vcc
    v_cndmask_b32 v93, 0, v45, vcc
    v_cndmask_b32 v94, 0, v46, vcc
    v_cndmask_b32 v95, 0, v47, vcc
    buffer_load_dwordx4 v[232:235], v76, s[52:55], s85 offen offset:256 nt
    v_mfma_f32_16x16x32_bf16 v[112:115], v[128:131], v[80:83], 0
    v_mfma_f32_16x16x32_bf16 v[112:115], v[132:135], v[84:87], v[112:115]
    s_waitcnt vmcnt(6)
    buffer_load_dwordx4 v[236:239], v77, s[52:55], s85 offen offset:0 nt
    v_mfma_f32_16x16x32_bf16 v[112:115], v[136:139], v[88:91], v[112:115]
    v_mfma_f32_16x16x32_bf16 v[112:115], v[140:143], v[92:95], v[112:115]
    s_nop 7
    v_mov_b32_dpp v122, v112 quad_perm:[0,0,0,0] row_mask:0xf bank_mask:0xf
    v_mov_b32_dpp v124, v114 quad_perm:[2,2,2,2] row_mask:0xf bank_mask:0xf
    s_nop 0
    v_add_f32_dpp v122, v113, v122 quad_perm:[1,1,1,1] row_mask:0xf bank_mask:0xf
    v_add_f32_dpp v124, v115, v124 quad_perm:[3,3,3,3] row_mask:0xf bank_mask:0xf
    v_add_f32 v122, v122, v124
    v_fma_f32 v123, v122, s83, -v120
    v_cmp_lt_f32 vcc, 0, v123
    s_cbranch_vccz L_nomax_3
    v_mul_f32 v122, s83, v122
    s_nop 1
    v_max_f32_dpp v124, v122, v122 row_ror:4 row_mask:0xf bank_mask:0xf
    s_nop 1
    v_max_f32_dpp v124, v124, v124 row_ror:8 row_mask:0xf bank_mask:0xf
    v_mov_b32 v125, v124
    s_nop 1
    v_permlane16_swap_b32 v124, v125
    v_max_f32 v124, v124, v125
    v_mov_b32 v125, v124
    s_nop 1
    v_permlane32_swap_b32 v124, v125
    v_max_f32 v124, v124, v125
    v_and_b32 v124, s82, v124
    v_max_f32 v124, v124, v120
    v_sub_f32 v125, v120, v124
    v_exp_f32 v125, v125
    v_mov_b32 v120, v124
    v_sub_f32 v123, v122, v124
    v_mul_f32 v121, v121, v125
    v_mul_f32 v116, v116, v125
    v_mul_f32 v117, v117, v125
    v_mul_f32 v118, v118, v125
    v_mul_f32 v119, v119, v125
L_nomax_3:
    v_exp_f32 v123, v123
    s_nop 0
    v_cvt_pk_bf16_f32 v124, v123, v123
    v_add_f32 v121, v121, v123
    s_nop 0
    v_and_b32_dpp v96, v124, v10 row_newbcast:0 row_mask:0xf bank_mask:0xf
    v_and_b32_dpp v97, v124, v11 row_newbcast:0 row_mask:0xf bank_mask:0xf
    v_and_b32_dpp v98, v124, v12 row_newbcast:0 row_mask:0xf bank_mask:0xf
    v_and_b32_dpp v99, v124, v13 row_newbcast:0 row_mask:0xf bank_mask:0xf
    v_and_b32_dpp v100, v124, v10 row_newbcast:4 row_mask:0xf bank_mask:0xf
    v_and_b32_dpp v101, v124, v11 row_newbcast:4 row_mask:0xf bank_mask:0xf
    v_and_b32_dpp v102, v124, v12 row_newbcast:4 row_mask:0xf bank_mask:0xf
    v_and_b32_dpp v103, v124, v13 row_newbcast:4 row_mask:0xf bank_mask:0xf
    v_and_b32_dpp v104, v124, v10 row_newbcast:8 row_mask:0xf bank_mask:0xf
    v_and_b32_dpp v105, v124, v11 row_newbcast:8 row_mask:0xf bank_mask:0xf
    v_and_b32_dpp v106, v124, v12 row_newbcast:8 row_mask:0xf bank_mask:0xf
    v_and_b32_dpp v107, v124, v13 row_newbcast:8 row_mask:0xf bank_mask:0xf
    v_and_b32_dpp v108, v124, v10 row_newbcast:12 row_mask:0xf bank_mask:0xf
    v_and_b32_dpp v109, v124, v11 row_newbcast:12 row_mask:0xf bank_mask:0xf
    v_and_b32_dpp v110, v124, v12 row_newbcast:12 row_mask:0xf bank_mask:0xf
    v_and_b32_dpp v111, v124, v13 row_newbcast:12 row_mask:0xf bank_mask:0xf
    v_mfma_f32_16x16x32_bf16 v[116:119], v[144:147], v[96:99], v[116:119]
    s_waitcnt vmcnt(6)
    buffer_load_dwordx4 v[240:243], v126, s[56:59], s85 offen offset:0 nt
    v_mfma_f32_16x16x32_bf16 v[116:119], v[148:151], v[100:103], v[116:119]
    v_mfma_f32_16x16x32_bf16 v[116:119], v[152:155], v[104:107], v[116:119]
    v_mfma_f32_16x16x32_bf16 v[116:119], v[156:159], v[108:111], v[116:119]
    s_waitcnt vmcnt(6)
    buffer_load_dwordx4 v[244:247], v127, s[56:59], s85 offen offset:256 nt
    v_mfma_f32_16x16x32_bf16 v[112:115], v[160:163], v[80:83], 0
    v_mfma_f32_16x16x32_bf16 v[112:115], v[164:167], v[84:87], v[112:115]
    v_mfma_f32_16x16x32_bf16 v[112:115], v[168:171], v[88:91], v[112:115]
    s_waitcnt vmcnt(6)
    buffer_load_dwordx4 v[248:251], v126, s[56:59], s85 offen offset:256 nt
    v_mfma_f32_16x16x32_bf16 v[112:115], v[172:175], v[92:95], v[112:115]
    s_nop 7
    v_mov_b32_dpp v122, v112 quad_perm:[0,0,0,0] row_mask:0xf bank_mask:0xf
    v_mov_b32_dpp v124, v114 quad_perm:[2,2,2,2] row_mask:0xf bank_mask:0xf
    s_nop 0
    v_add_f32_dpp v122, v113, v122 quad_perm:[1,1,1,1] row_mask:0xf bank_mask:0xf
    v_add_f32_dpp v124, v115, v124 quad_perm:[3,3,3,3] row_mask:0xf bank_mask:0xf
    v_add_f32 v122, v122, v124
    v_fma_f32 v123, v122, s83, -v120
    v_cmp_lt_f32 vcc, 0, v123
    s_cbranch_vccz L_nomax_4
    v_mul_f32 v122, s83, v122
    s_nop 1
    v_max_f32_dpp v124, v122, v122 row_ror:4 row_mask:0xf bank_mask:0xf
    s_nop 1
    v_max_f32_dpp v124, v124, v124 row_ror:8 row_mask:0xf bank_mask:0xf
    v_mov_b32 v125, v124
    s_nop 1
    v_permlane16_swap_b32 v124, v125
    v_max_f32 v124, v124, v125
    v_mov_b32 v125, v124
    s_nop 1
    v_permlane32_swap_b32 v124, v125
    v_max_f32 v124, v124, v125
    v_and_b32 v124, s82, v124
    v_max_f32 v124, v124, v120
    v_sub_f32 v125, v120, v124
    v_exp_f32 v125, v125
    v_mov_b32 v120, v124
    v_sub_f32 v123, v122, v124
    v_mul_f32 v121, v121, v125
    v_mul_f32 v116, v116, v125
    v_mul_f32 v117, v117, v125
    v_mul_f32 v118, v118, v125
    v_mul_f32 v119, v119, v125
L_nomax_4:
    v_exp_f32 v123, v123
    s_nop 0
    v_cvt_pk_bf16_f32 v124, v123, v123
    v_add_f32 v121, v121, v123
    s_nop 0
    v_and_b32_dpp v96, v124, v10 row_newbcast:0 row_mask:0xf bank_mask:0xf
    v_and_b32_dpp v97, v124, v11 row_newbcast:0 row_mask:0xf bank_mask:0xf
    v_and_b32_dpp v98, v124, v12 row_newbcast:0 row_mask:0xf bank_mask:0xf
    v_and_b32_dpp v99, v124, v13 row_newbcast:0 row_mask:0xf bank_mask:0xf
    v_and_b32_dpp v100, v124, v10 row_newbcast:4 row_mask:0xf bank_mask:0xf
    v_and_b32_dpp v101, v124, v11 row_newbcast:4 row_mask:0xf bank_mask:0xf
    v_and_b32_dpp v102, v124, v12 row_newbcast:4 row_mask:0xf bank_mask:0xf
    v_and_b32_dpp v103, v124, v13 row_newbcast:4 row_mask:0xf bank_mask:0xf
    v_and_b32_dpp v104, v124, v10 row_newbcast:8 row_mask:0xf bank_mask:0xf
    v_and_b32_dpp v105, v124, v11 row_newbcast:8 row_mask:0xf bank_mask:0xf
    v_and_b32_dpp v106, v124, v12 row_newbcast:8 row_mask:0xf bank_mask:0xf
    v_and_b32_dpp v107, v124, v13 row_newbcast:8 row_mask:0xf bank_mask:0xf
    v_and_b32_dpp v108, v124, v10 row_newbcast:12 row_mask:0xf bank_mask:0xf
    v_and_b32_dpp v109, v124, v11 row_newbcast:12 row_mask:0xf bank_mask:0xf
    v_and_b32_dpp v110, v124, v12 row_newbcast:12 row_mask:0xf bank_mask:0xf
    v_and_b32_dpp v111, v124, v13 row_newbcast:12 row_mask:0xf bank_mask:0xf
    v_mfma_f32_16x16x32_bf16 v[116:119], v[176:179], v[96:99], v[116:119]
    v_mfma_f32_16x16x32_bf16 v[116:119], v[180:183], v[100:103], v[116:119]
    s_waitcnt vmcnt(6)
    buffer_load_dwordx4 v[252:255], v127, s[56:59], s85 offen offset:0 nt
    v_mfma_f32_16x16x32_bf16 v[116:119], v[184:187], v[104:107], v[116:119]
    v_mfma_f32_16x16x32_bf16 v[116:119], v[188:191], v[108:111], v[116:119]
    v_mfma_f32_16x16x32_bf16 v[112:115], v[192:195], v[80:83], 0
    s_waitcnt vmcnt(5)
    s_add_u32 s87, s87, 7
    s_add_u32 s39, s87, s88
    s_bfe_u32 s37, s39, 0x10000
    s_lshl_b32 s37, s37, 14
    s_add_u32 s85, s37, s89
    s_bfe_u32 s37, s39, 0x30001
    s_lshl_b32 s37, s37, 9
    s_add_u32 s85, s37, s85
    s_bfe_u32 s37, s39, 0x40004
    s_lshl_b32 s37, s37, 16
    s_add_u32 s85, s37, s85
    buffer_load_dwordx4 v[128:131], v76, s[52:55], s85 offen offset:0 nt
    v_mfma_f32_16x16x32_bf16 v[112:115], v[196:199], v[84:87], v[112:115]
    v_mfma_f32_16x16x32_bf16 v[112:115], v[200:203], v[88:91], v[112:115]
    v_mfma_f32_16x16x32_bf16 v[112:115], v[204:207], v[92:95], v[112:115]
    s_nop 7
    v_mov_b32_dpp v122, v112 quad_perm:[0,0,0,0] row_mask:0xf bank_mask:0xf
    v_mov_b32_dpp v124, v114 quad_perm:[2,2,2,2] row_mask:0xf bank_mask:0xf
    s_nop 0
    v_add_f32_dpp v122, v113, v122 quad_perm:[1,1,1,1] row_mask:0xf bank_mask:0xf
    v_add_f32_dpp v124, v115, v124 quad_perm:[3,3,3,3] row_mask:0xf bank_mask:0xf
    v_add_f32 v122, v122, v124
    v_fma_f32 v123, v122, s83, -v120
    v_cmp_lt_f32 vcc, 0, v123
    s_cbranch_vccz L_nomax_5
    v_mul_f32 v122, s83, v122
    s_nop 1
    v_max_f32_dpp v124, v122, v122 row_ror:4 row_mask:0xf bank_mask:0xf
    s_nop 1
    v_max_f32_dpp v124, v124, v124 row_ror:8 row_mask:0xf bank_mask:0xf
    v_mov_b32 v125, v124
    s_nop 1
    v_permlane16_swap_b32 v124, v125
    v_max_f32 v124, v124, v125
    v_mov_b32 v125, v124
    s_nop 1
    v_permlane32_swap_b32 v124, v125
    v_max_f32 v124, v124, v125
    v_and_b32 v124, s82, v124
    v_max_f32 v124, v124, v120
    v_sub_f32 v125, v120, v124
    v_exp_f32 v125, v125
    v_mov_b32 v120, v124
    v_sub_f32 v123, v122, v124
    v_mul_f32 v121, v121, v125
    v_mul_f32 v116, v116, v125
    v_mul_f32 v117, v117, v125
    v_mul_f32 v118, v118, v125
    v_mul_f32 v119, v119, v125
L_nomax_5:
    v_exp_f32 v123, v123
    s_nop 0
    v_cvt_pk_bf16_f32 v124, v123, v123
    v_add_f32 v121, v121, v123
    s_nop 0
    v_and_b32_dpp v96, v124, v10 row_newbcast:0 row_mask:0xf bank_mask:0xf
    v_and_b32_dpp v97, v124, v11 row_newbcast:0 row_mask:0xf bank_mask:0xf
    v_and_b32_dpp v98, v124, v12 row_newbcast:0 row_mask:0xf bank_mask:0xf
    v_and_b32_dpp v99, v124, v13 row_newbcast:0 row_mask:0xf bank_mask:0xf
    v_and_b32_dpp v100, v124, v10 row_newbcast:4 row_mask:0xf bank_mask:0xf
    v_and_b32_dpp v101, v124, v11 row_newbcast:4 row_mask:0xf bank_mask:0xf
    v_and_b32_dpp v102, v124, v12 row_newbcast:4 row_mask:0xf bank_mask:0xf
    v_and_b32_dpp v103, v124, v13 row_newbcast:4 row_mask:0xf bank_mask:0xf
    v_and_b32_dpp v104, v124, v10 row_newbcast:8 row_mask:0xf bank_mask:0xf
    v_and_b32_dpp v105, v124, v11 row_newbcast:8 row_mask:0xf bank_mask:0xf
    v_and_b32_dpp v106, v124, v12 row_newbcast:8 row_mask:0xf bank_mask:0xf
    v_and_b32_dpp v107, v124, v13 row_newbcast:8 row_mask:0xf bank_mask:0xf
    v_and_b32_dpp v108, v124, v10 row_newbcast:12 row_mask:0xf bank_mask:0xf
    v_and_b32_dpp v109, v124, v11 row_newbcast:12 row_mask:0xf bank_mask:0xf
    v_and_b32_dpp v110, v124, v12 row_newbcast:12 row_mask:0xf bank_mask:0xf
    v_and_b32_dpp v111, v124, v13 row_newbcast:12 row_mask:0xf bank_mask:0xf
    s_waitcnt vmcnt(5)
    buffer_load_dwordx4 v[132:135], v77, s[52:55], s85 offen offset:256 nt
    v_mfma_f32_16x16x32_bf16 v[116:119], v[208:211], v[96:99], v[116:119]
    v_mfma_f32_16x16x32_bf16 v[116:119], v[212:215], v[100:103], v[116:119]
    v_mfma_f32_16x16x32_bf16 v[116:119], v[216:219], v[104:107], v[116:119]
    s_waitcnt vmcnt(5)
    buffer_load_dwordx4 v[136:139], v76, s[52:55], s85 offen offset:256 nt
    v_mfma_f32_16x16x32_bf16 v[116:119], v[220:223], v[108:111], v[116:119]
    v_mfma_f32_16x16x32_bf16 v[112:115], v[224:227], v[80:83], 0
    v_mfma_f32_16x16x32_bf16 v[112:115], v[228:231], v[84:87], v[112:115]
    s_waitcnt vmcnt(5)
    buffer_load_dwordx4 v[140:143], v77, s[52:55], s85 offen offset:0 nt
    v_mfma_f32_16x16x32_bf16 v[112:115], v[232:235], v[88:91], v[112:115]
    v_mfma_f32_16x16x32_bf16 v[112:115], v[236:239], v[92:95], v[112:115]
    s_nop 7
    v_mov_b32_dpp v122, v112 quad_perm:[0,0,0,0] row_mask:0xf bank_mask:0xf
    v_mov_b32_dpp v124, v114 quad_perm:[2,2,2,2] row_mask:0xf bank_mask:0xf
    s_nop 0
    v_add_f32_dpp v122, v113, v122 quad_perm:[1,1,1,1] row_mask:0xf bank_mask:0xf
    v_add_f32_dpp v124, v115, v124 quad_perm:[3,3,3,3] row_mask:0xf bank_mask:0xf
    v_add_f32 v122, v122, v124
    v_fma_f32 v123, v122, s83, -v120
    v_cmp_lt_f32 vcc, 0, v123
    s_cbranch_vccz L_nomax_6
    v_mul_f32 v122, s83, v122
    s_nop 1
    v_max_f32_dpp v124, v122, v122 row_ror:4 row_mask:0xf bank_mask:0xf
    s_nop 1
    v_max_f32_dpp v124, v124, v124 row_ror:8 row_mask:0xf bank_mask:0xf
    v_mov_b32 v125, v124
    s_nop 1
    v_permlane16_swap_b32 v124, v125
    v_max_f32 v124, v124, v125
    v_mov_b32 v125, v124
    s_nop 1
    v_permlane32_swap_b32 v124, v125
    v_max_f32 v124, v124, v125
    v_and_b32 v124, s82, v124
    v_max_f32 v124, v124, v120
    v_sub_f32 v125, v120, v124
    v_exp_f32 v125, v125
    v_mov_b32 v120, v124
    v_sub_f32 v123, v122, v124
    v_mul_f32 v121, v121, v125
    v_mul_f32 v116, v116, v125
    v_mul_f32 v117, v117, v125
    v_mul_f32 v118, v118, v125
    v_mul_f32 v119, v119, v125
L_nomax_6:
    v_exp_f32 v123, v123
    s_nop 0
    v_cvt_pk_bf16_f32 v124, v123, v123
    v_add_f32 v121, v121, v123
    s_nop 0
    v_and_b32_dpp v96, v124, v10 row_newbcast:0 row_mask:0xf bank_mask:0xf
    v_and_b32_dpp v97, v124, v11 row_newbcast:0 row_mask:0xf bank_mask:0xf
    v_and_b32_dpp v98, v124, v12 row_newbcast:0 row_mask:0xf bank_mask:0xf
    v_and_b32_dpp v99, v124, v13 row_newbcast:0 row_mask:0xf bank_mask:0xf
    v_and_b32_dpp v100, v124, v10 row_newbcast:4 row_mask:0xf bank_mask:0xf
    v_and_b32_dpp v101, v124, v11 row_newbcast:4 row_mask:0xf bank_mask:0xf
    v_and_b32_dpp v102, v124, v12 row_newbcast:4 row_mask:0xf bank_mask:0xf
    v_and_b32_dpp v103, v124, v13 row_newbcast:4 row_mask:0xf bank_mask:0xf
    v_and_b32_dpp v104, v124, v10 row_newbcast:8 row_mask:0xf bank_mask:0xf
    v_and_b32_dpp v105, v124, v11 row_newbcast:8 row_mask:0xf bank_mask:0xf
    v_and_b32_dpp v106, v124, v12 row_newbcast:8 row_mask:0xf bank_mask:0xf
    v_and_b32_dpp v107, v124, v13 row_newbcast:8 row_mask:0xf bank_mask:0xf
    v_and_b32_dpp v108, v124, v10 row_newbcast:12 row_mask:0xf bank_mask:0xf
    v_and_b32_dpp v109, v124, v11 row_newbcast:12 row_mask:0xf bank_mask:0xf
    v_and_b32_dpp v110, v124, v12 row_newbcast:12 row_mask:0xf bank_mask:0xf
    v_and_b32_dpp v111, v124, v13 row_newbcast:12 row_mask:0xf bank_mask:0xf
    v_mfma_f32_16x16x32_bf16 v[116:119], v[240:243], v[96:99], v[116:119]
    s_waitcnt vmcnt(5)
    buffer_load_dwordx4 v[144:147], v126, s[56:59], s85 offen offset:0 nt
    v_mfma_f32_16x16x32_bf16 v[116:119], v[244:247], v[100:103], v[116:119]
    v_mfma_f32_16x16x32_bf16 v[116:119], v[248:251], v[104:107], v[116:119]
    s_waitcnt vmcnt(5)
    v_mfma_f32_16x16x32_bf16 v[116:119], v[252:255], v[108:111], v[116:119]
    s_add_u32 s87, s87, 7
    s_add_u32 s39, s87, s88
    s_bfe_u32 s37, s39, 0x10000
    s_lshl_b32 s37, s37, 14
    s_add_u32 s86, s37, s89
    s_bfe_u32 s37, s39, 0x30001
    s_lshl_b32 s37, s37, 9
    s_add_u32 s86, s37, s86
    s_bfe_u32 s37, s39, 0x40004
    s_lshl_b32 s37, s37, 16
    s_add_u32 s86, s37, s86
    s_cmp_ge_u32 s87, 256
    s_cselect_b32 s86, 134217728, s86
L_bloop:
    s_waitcnt vmcnt(4)
    buffer_load_dwordx4 v[148:151], v127, s[56:59], s85 offen offset:256 nt
    v_mfma_f32_16x16x32_bf16 v[112:115], v[128:131], v[80:83], 0
    s_waitcnt vmcnt(4)
    buffer_load_dwordx4 v[152:155], v126, s[56:59], s85 offen offset:256 nt
    v_mfma_f32_16x16x32_bf16 v[112:115], v[132:135], v[84:87], v[112:115]
    s_waitcnt vmcnt(4)
    buffer_load_dwordx4 v[156:159], v127, s[56:59], s85 offen offset:0 nt
    v_mfma_f32_16x16x32_bf16 v[112:115], v[136:139], v[88:91], v[112:115]
    s_waitcnt vmcnt(4)
    buffer_load_dwordx4 v[160:163], v76, s[52:55], s86 offen offset:0 nt
    buffer_load_dwordx4 v[164:167], v77, s[52:55], s86 offen offset:256 nt
    v_mfma_f32_16x16x32_bf16 v[112:115], v[140:143], v[92:95], v[112:115]
    s_mov_b32 s93, s87
    s_add_u32 s87, s87, 7
    s_add_u32 s39, s87, s88
    s_bfe_u32 s37, s39, 0x10000
    s_lshl_b32 s37, s37, 14
    s_add_u32 s85, s37, s89
    s_bfe_u32 s37, s39, 0x30001
    s_lshl_b32 s37, s37, 9
    s_add_u32 s85, s37, s85
    s_bfe_u32 s37, s39, 0x40004
    s_lshl_b32 s37, s37, 16
    s_add_u32 s85, s37, s85
    s_cmp_ge_u32 s87, 256
    s_cselect_b32 s85, 134217728, s85
    v_mov_b32_dpp v122, v112 quad_perm:[0,0,0,0] row_mask:0xf bank_mask:0xf
    v_mov_b32_dpp v124, v114 quad_perm:[2,2,2,2] row_mask:0xf bank_mask:0xf
    s_nop 0
    v_add_f32_dpp v122, v113, v122 quad_perm:[1,1,1,1] row_mask:0xf bank_mask:0xf
    v_add_f32_dpp v124, v115, v124 quad_perm:[3,3,3,3] row_mask:0xf bank_mask:0xf
    v_add_f32 v122, v122, v124
    v_fma_f32 v123, v122, s83, -v120
    v_cmp_lt_f32 vcc, 0, v123
    s_cbranch_vccz L_nomax_7
    v_mul_f32 v122, s83, v122
    s_nop 1
    v_max_f32_dpp v124, v122, v122 row_ror:4 row_mask:0xf bank_mask:0xf
    s_nop 1
    v_max_f32_dpp v124, v124, v124 row_ror:8 row_mask:0xf bank_mask:0xf
    v_mov_b32 v125, v124
    s_nop 1
    v_permlane16_swap_b32 v124, v125
    v_max_f32 v124, v124, v125
    v_mov_b32 v125, v124
    s_nop 1
    v_permlane32_swap_b32 v124, v125
    v_max_f32 v124, v124, v125
    v_and_b32 v124, s82, v124
    v_max_f32 v124, v124, v120
    v_sub_f32 v125, v120, v124
    v_exp_f32 v125, v125
    v_mov_b32 v120, v124
    v_sub_f32 v123, v122, v124
    v_mul_f32 v121, v121, v125
    v_mul_f32 v116, v116, v125
    v_mul_f32 v117, v117, v125
    v_mul_f32 v118, v118, v125
    v_mul_f32 v119, v119, v125
L_nomax_7:
    v_exp_f32 v123, v123
    s_nop 0
    v_cvt_pk_bf16_f32 v124, v123, v123
    v_add_f32 v121, v121, v123
    s_nop 0
    v_and_b32_dpp v96, v124, v10 row_newbcast:0 row_mask:0xf bank_mask:0xf
    v_and_b32_dpp v97, v124, v11 row_newbcast:0 row_mask:0xf bank_mask:0xf
    v_and_b32_dpp v98, v124, v12 row_newbcast:0 row_mask:0xf bank_mask:0xf
    v_and_b32_dpp v99, v124, v13 row_newbcast:0 row_mask:0xf bank_mask:0xf
    v_and_b32_dpp v100, v124, v10 row_newbcast:4 row_mask:0xf bank_mask:0xf
    v_and_b32_dpp v101, v124, v11 row_newbcast:4 row_mask:0xf bank_mask:0xf
    v_and_b32_dpp v102, v124, v12 row_newbcast:4 row_mask:0xf bank_mask:0xf
    v_and_b32_dpp v103, v124, v13 row_newbcast:4 row_mask:0xf bank_mask:0xf
    v_and_b32_dpp v104, v124, v10 row_newbcast:8 row_mask:0xf bank_mask:0xf
    v_and_b32_dpp v105, v124, v11 row_newbcast:8 row_mask:0xf bank_mask:0xf
    v_and_b32_dpp v106, v124, v12 row_newbcast:8 row_mask:0xf bank_mask:0xf
    v_and_b32_dpp v107, v124, v13 row_newbcast:8 row_mask:0xf bank_mask:0xf
    v_and_b32_dpp v108, v124, v10 row_newbcast:12 row_mask:0xf bank_mask:0xf
    v_and_b32_dpp v109, v124, v11 row_newbcast:12 row_mask:0xf bank_mask:0xf
    v_and_b32_dpp v110, v124, v12 row_newbcast:12 row_mask:0xf bank_mask:0xf
    v_and_b32_dpp v111, v124, v13 row_newbcast:12 row_mask:0xf bank_mask:0xf
    s_waitcnt vmcnt(5)
    v_mfma_f32_16x16x32_bf16 v[116:119], v[144:147], v[96:99], v[116:119]
    s_waitcnt vmcnt(4)
    buffer_load_dwordx4 v[168:171], v76, s[52:55], s86 offen offset:256 nt
    v_mfma_f32_16x16x32_bf16 v[116:119], v[148:151], v[100:103], v[116:119]
    s_waitcnt vmcnt(4)
    buffer_load_dwordx4 v[172:175], v77, s[52:55], s86 offen offset:0 nt
    v_mfma_f32_16x16x32_bf16 v[116:119], v[152:155], v[104:107], v[116:119]
    s_waitcnt vmcnt(4)
    buffer_load_dwordx4 v[176:179], v126, s[56:59], s86 offen offset:0 nt
    v_mfma_f32_16x16x32_bf16 v[116:119], v[156:159], v[108:111], v[116:119]
    s_waitcnt vmcnt(4)
    buffer_load_dwordx4 v[180:183], v127, s[56:59], s86 offen offset:256 nt
    v_mfma_f32_16x16x32_bf16 v[112:115], v[160:163], v[80:83], 0
    s_waitcnt vmcnt(4)
    buffer_load_dwordx4 v[184:187], v126, s[56:59], s86 offen offset:256 nt
    v_mfma_f32_16x16x32_bf16 v[112:115], v[164:167], v[84:87], v[112:115]
    s_waitcnt vmcnt(4)
    buffer_load_dwordx4 v[188:191], v127, s[56:59], s86 offen offset:0 nt
    v_mfma_f32_16x16x32_bf16 v[112:115], v[168:171], v[88:91], v[112:115]
    s_waitcnt vmcnt(4)
    buffer_load_dwordx4 v[128:131], v76, s[52:55], s85 offen offset:0 nt
    buffer_load_dwordx4 v[132:135], v77, s[52:55], s85 offen offset:256 nt
    v_mfma_f32_16x16x32_bf16 v[112:115], v[172:175], v[92:95], v[112:115]
    s_mov_b32 s93, s87
    s_add_u32 s87, s87, 7
    s_add_u32 s39, s87, s88
    s_bfe_u32 s37, s39, 0x10000
    s_lshl_b32 s37, s37, 14
    s_add_u32 s86, s37, s89
    s_bfe_u32 s37, s39, 0x30001
    s_lshl_b32 s37, s37, 9
    s_add_u32 s86, s37, s86
    s_bfe_u32 s37, s39, 0x40004
    s_lshl_b32 s37, s37, 16
    s_add_u32 s86, s37, s86
    s_cmp_ge_u32 s87, 256
    s_cselect_b32 s86, 134217728, s86
    v_mov_b32_dpp v122, v112 quad_perm:[0,0,0,0] row_mask:0xf bank_mask:0xf
    v_mov_b32_dpp v124, v114 quad_perm:[2,2,2,2] row_mask:0xf bank_mask:0xf
    s_nop 0
    v_add_f32_dpp v122, v113, v122 quad_perm:[1,1,1,1] row_mask:0xf bank_mask:0xf
    v_add_f32_dpp v124, v115, v124 quad_perm:[3,3,3,3] row_mask:0xf bank_mask:0xf
    v_add_f32 v122, v122, v124
    v_fma_f32 v123, v122, s83, -v120
    v_cmp_lt_f32 vcc, 0, v123
    s_cbranch_vccz L_nomax_8
    v_mul_f32 v122, s83, v122
    s_nop 1
    v_max_f32_dpp v124, v122, v122 row_ror:4 row_mask:0xf bank_mask:0xf
    s_nop 1
    v_max_f32_dpp v124, v124, v124 row_ror:8 row_mask:0xf bank_mask:0xf
    v_mov_b32 v125, v124
    s_nop 1
    v_permlane16_swap_b32 v124, v125
    v_max_f32 v124, v124, v125
    v_mov_b32 v125, v124
    s_nop 1
    v_permlane32_swap_b32 v124, v125
    v_max_f32 v124, v124, v125
    v_and_b32 v124, s82, v124
    v_max_f32 v124, v124, v120
    v_sub_f32 v125, v120, v124
    v_exp_f32 v125, v125
    v_mov_b32 v120, v124
    v_sub_f32 v123, v122, v124
    v_mul_f32 v121, v121, v125
    v_mul_f32 v116, v116, v125
    v_mul_f32 v117, v117, v125
    v_mul_f32 v118, v118, v125
    v_mul_f32 v119, v119, v125
L_nomax_8:
    v_exp_f32 v123, v123
    s_nop 0
    v_cvt_pk_bf16_f32 v124, v123, v123
    v_add_f32 v121, v121, v123
    s_nop 0
    v_and_b32_dpp v96, v124, v10 row_newbcast:0 row_mask:0xf bank_mask:0xf
    v_and_b32_dpp v97, v124, v11 row_newbcast:0 row_mask:0xf bank_mask:0xf
    v_and_b32_dpp v98, v124, v12 row_newbcast:0 row_mask:0xf bank_mask:0xf
    v_and_b32_dpp v99, v124, v13 row_newbcast:0 row_mask:0xf bank_mask:0xf
    v_and_b32_dpp v100, v124, v10 row_newbcast:4 row_mask:0xf bank_mask:0xf
    v_and_b32_dpp v101, v124, v11 row_newbcast:4 row_mask:0xf bank_mask:0xf
    v_and_b32_dpp v102, v124, v12 row_newbcast:4 row_mask:0xf bank_mask:0xf
    v_and_b32_dpp v103, v124, v13 row_newbcast:4 row_mask:0xf bank_mask:0xf
    v_and_b32_dpp v104, v124, v10 row_newbcast:8 row_mask:0xf bank_mask:0xf
    v_and_b32_dpp v105, v124, v11 row_newbcast:8 row_mask:0xf bank_mask:0xf
    v_and_b32_dpp v106, v124, v12 row_newbcast:8 row_mask:0xf bank_mask:0xf
    v_and_b32_dpp v107, v124, v13 row_newbcast:8 row_mask:0xf bank_mask:0xf
    v_and_b32_dpp v108, v124, v10 row_newbcast:12 row_mask:0xf bank_mask:0xf
    v_and_b32_dpp v109, v124, v11 row_newbcast:12 row_mask:0xf bank_mask:0xf
    v_and_b32_dpp v110, v124, v12 row_newbcast:12 row_mask:0xf bank_mask:0xf
    v_and_b32_dpp v111, v124, v13 row_newbcast:12 row_mask:0xf bank_mask:0xf
    s_waitcnt vmcnt(5)
    v_mfma_f32_16x16x32_bf16 v[116:119], v[176:179], v[96:99], v[116:119]
    s_waitcnt vmcnt(4)
    buffer_load_dwordx4 v[136:139], v76, s[52:55], s85 offen offset:256 nt
    v_mfma_f32_16x16x32_bf16 v[116:119], v[180:183], v[100:103], v[116:119]
    s_waitcnt vmcnt(4)
    buffer_load_dwordx4 v[140:143], v77, s[52:55], s85 offen offset:0 nt
    v_mfma_f32_16x16x32_bf16 v[116:119], v[184:187], v[104:107], v[116:119]
    s_waitcnt vmcnt(4)
    buffer_load_dwordx4 v[144:147], v126, s[56:59], s85 offen offset:0 nt
    v_mfma_f32_16x16x32_bf16 v[116:119], v[188:191], v[108:111], v[116:119]
    s_cmp_lt_u32 s87, 231
    s_cbranch_scc1 L_bloop
    buffer_load_dwordx4 v[148:151], v127, s[56:59], s85 offen offset:256 nt
    s_sub_u32 s37, s87, 238
    v_mov_b32 v19, s37
L_dloop:
    s_waitcnt vmcnt(5)
    buffer_load_dwordx4 v[152:155], v126, s[56:59], s85 offen offset:256 nt
    v_mfma_f32_16x16x32_bf16 v[112:115], v[128:131], v[80:83], 0
    s_waitcnt vmcnt(5)
    buffer_load_dwordx4 v[156:159], v127, s[56:59], s85 offen offset:0 nt
    v_mfma_f32_16x16x32_bf16 v[112:115], v[132:135], v[84:87], v[112:115]
    s_waitcnt vmcnt(5)
    v_readfirstlane_b32 s87, v19
    s_nop 0
    s_add_u32 s87, s87, 238
    s_add_u32 s39, s87, s88
    s_bfe_u32 s37, s39, 0x10000
    s_lshl_b32 s37, s37, 14
    s_add_u32 s86, s37, s89
    s_bfe_u32 s37, s39, 0x30001
    s_lshl_b32 s37, s37, 9
    s_add_u32 s86, s37, s86
    s_bfe_u32 s37, s39, 0x40004
    s_lshl_b32 s37, s37, 16
    s_add_u32 s86, s37, s86
    s_cmp_ge_u32 s87, 256
    s_cselect_b32 s86, 134217728, s86
    buffer_load_dwordx4 v[160:163], v76, s[52:55], s86 offen offset:0 nt
    v_mfma_f32_16x16x32_bf16 v[112:115], v[136:139], v[88:91], v[112:115]
    s_waitcnt vmcnt(5)
    buffer_load_dwordx4 v[164:167], v77, s[52:55], s86 offen offset:256 nt
    v_mfma_f32_16x16x32_bf16 v[112:115], v[140:143], v[92:95], v[112:115]
    s_nop 7
    v_mov_b32_dpp v122, v112 quad_perm:[0,0,0,0] row_mask:0xf bank_mask:0xf
    v_mov_b32_dpp v124, v114 quad_perm:[2,2,2,2] row_mask:0xf bank_mask:0xf
    s_nop 0
    v_add_f32_dpp v122, v113, v122 quad_perm:[1,1,1,1] row_mask:0xf bank_mask:0xf
    v_add_f32_dpp v124, v115, v124 quad_perm:[3,3,3,3] row_mask:0xf bank_mask:0xf
    v_add_f32 v122, v122, v124
    v_fma_f32 v123, v122, s83, -v120
    v_cmp_lt_f32 vcc, 0, v123
    s_cbranch_vccz L_nomax_9
    v_mul_f32 v122, s83, v122
    s_nop 1
    v_max_f32_dpp v124, v122, v122 row_ror:4 row_mask:0xf bank_mask:0xf
    s_nop 1
    v_max_f32_dpp v124, v124, v124 row_ror:8 row_mask:0xf bank_mask:0xf
    v_mov_b32 v125, v124
    s_nop 1
    v_permlane16_swap_b32 v124, v125
    v_max_f32 v124, v124, v125
    v_mov_b32 v125, v124
    s_nop 1
    v_permlane32_swap_b32 v124, v125
    v_max_f32 v124, v124, v125
    v_and_b32 v124, s82, v124
    v_max_f32 v124, v124, v120
    v_sub_f32 v125, v120, v124
    v_exp_f32 v125, v125
    v_mov_b32 v120, v124
    v_sub_f32 v123, v122, v124
    v_mul_f32 v121, v121, v125
    v_mul_f32 v116, v116, v125
    v_mul_f32 v117, v117, v125
    v_mul_f32 v118, v118, v125
    v_mul_f32 v119, v119, v125
L_nomax_9:
    v_exp_f32 v123, v123
    s_nop 0
    v_cvt_pk_bf16_f32 v124, v123, v123
    v_add_f32 v121, v121, v123
    s_nop 0
    v_and_b32_dpp v96, v124, v10 row_newbcast:0 row_mask:0xf bank_mask:0xf
    v_and_b32_dpp v97, v124, v11 row_newbcast:0 row_mask:0xf bank_mask:0xf
    v_and_b32_dpp v98, v124, v12 row_newbcast:0 row_mask:0xf bank_mask:0xf
    v_and_b32_dpp v99, v124, v13 row_newbcast:0 row_mask:0xf bank_mask:0xf
    v_and_b32_dpp v100, v124, v10 row_newbcast:4 row_mask:0xf bank_mask:0xf
    v_and_b32_dpp v101, v124, v11 row_newbcast:4 row_mask:0xf bank_mask:0xf
    v_and_b32_dpp v102, v124, v12 row_newbcast:4 row_mask:0xf bank_mask:0xf
    v_and_b32_dpp v103, v124, v13 row_newbcast:4 row_mask:0xf bank_mask:0xf
    v_and_b32_dpp v104, v124, v10 row_newbcast:8 row_mask:0xf bank_mask:0xf
    v_and_b32_dpp v105, v124, v11 row_newbcast:8 row_mask:0xf bank_mask:0xf
    v_and_b32_dpp v106, v124, v12 row_newbcast:8 row_mask:0xf bank_mask:0xf
    v_and_b32_dpp v107, v124, v13 row_newbcast:8 row_mask:0xf bank_mask:0xf
    v_and_b32_dpp v108, v124, v10 row_newbcast:12 row_mask:0xf bank_mask:0xf
    v_and_b32_dpp v109, v124, v11 row_newbcast:12 row_mask:0xf bank_mask:0xf
    v_and_b32_dpp v110, v124, v12 row_newbcast:12 row_mask:0xf bank_mask:0xf
    v_and_b32_dpp v111, v124, v13 row_newbcast:12 row_mask:0xf bank_mask:0xf
    s_waitcnt vmcnt(5)
    v_mov_b32 v19, 256
    s_cmp_ge_u32 s87, 255
    s_cbranch_scc1 L_noclaim_10
    s_mov_b64 exec, 1
    global_atomic_add v19, v9, v18, s[30:31] sc0 sc1
    s_mov_b64 exec, -1
L_noclaim_10:
    buffer_load_dwordx4 v[168:171], v76, s[52:55], s86 offen offset:256 nt
    v_mfma_f32_16x16x32_bf16 v[116:119], v[144:147], v[96:99], v[116:119]
    s_waitcnt vmcnt(5)
    buffer_load_dwordx4 v[172:175], v77, s[52:55], s86 offen offset:0 nt
    v_mfma_f32_16x16x32_bf16 v[116:119], v[148:151], v[100:103], v[116:119]
    s_waitcnt vmcnt(5)
    buffer_load_dwordx4 v[176:179], v126, s[56:59], s86 offen offset:0 nt
    v_mfma_f32_16x16x32_bf16 v[116:119], v[152:155], v[104:107], v[116:119]
    s_waitcnt vmcnt(5)
    buffer_load_dwordx4 v[180:183], v127, s[56:59], s86 offen offset:256 nt
    v_mfma_f32_16x16x32_bf16 v[116:119], v[156:159], v[108:111], v[116:119]
    s_cmp_ge_u32 s87, 256
    s_cbranch_scc1 L_bdone
    s_waitcnt vmcnt(5)
    buffer_load_dwordx4 v[184:187], v126, s[56:59], s86 offen offset:256 nt
    v_mfma_f32_16x16x32_bf16 v[112:115], v[160:163], v[80:83], 0
    s_waitcnt vmcnt(5)
    buffer_load_dwordx4 v[188:191], v127, s[56:59], s86 offen offset:0 nt
    v_mfma_f32_16x16x32_bf16 v[112:115], v[164:167], v[84:87], v[112:115]
    s_waitcnt vmcnt(5)
    v_readfirstlane_b32 s87, v19
    s_nop 0
    s_add_u32 s87, s87, 238
    s_add_u32 s39, s87, s88
    s_bfe_u32 s37, s39, 0x10000
    s_lshl_b32 s37, s37, 14
    s_add_u32 s85, s37, s89
    s_bfe_u32 s37, s39, 0x30001
    s_lshl_b32 s37, s37, 9
    s_add_u32 s85, s37, s85
    s_bfe_u32 s37, s39, 0x40004
    s_lshl_b32 s37, s37, 16
    s_add_u32 s85, s37, s85
    s_cmp_ge_u32 s87, 256
    s_cselect_b32 s85, 134217728, s85
    buffer_load_dwordx4 v[128:131], v76, s[52:55], s85 offen offset:0 nt
    v_mfma_f32_16x16x32_bf16 v[112:115], v[168:171], v[88:91], v[112:115]
    s_waitcnt vmcnt(5)
    buffer_load_dwordx4 v[132:135], v77, s[52:55], s85 offen offset:256 nt
    v_mfma_f32_16x16x32_bf16 v[112:115], v[172:175], v[92:95], v[112:115]
    s_nop 7
    v_mov_b32_dpp v122, v112 quad_perm:[0,0,0,0] row_mask:0xf bank_mask:0xf
    v_mov_b32_dpp v124, v114 quad_perm:[2,2,2,2] row_mask:0xf bank_mask:0xf
    s_nop 0
    v_add_f32_dpp v122, v113, v122 quad_perm:[1,1,1,1] row_mask:0xf bank_mask:0xf
    v_add_f32_dpp v124, v115, v124 quad_perm:[3,3,3,3] row_mask:0xf bank_mask:0xf
    v_add_f32 v122, v122, v124
    v_fma_f32 v123, v122, s83, -v120
    v_cmp_lt_f32 vcc, 0, v123
    s_cbranch_vccz L_nomax_11
    v_mul_f32 v122, s83, v122
    s_nop 1
    v_max_f32_dpp v124, v122, v122 row_ror:4 row_mask:0xf bank_mask:0xf
    s_nop 1
    v_max_f32_dpp v124, v124, v124 row_ror:8 row_mask:0xf bank_mask:0xf
    v_mov_b32 v125, v124
    s_nop 1
    v_permlane16_swap_b32 v124, v125
    v_max_f32 v124, v124, v125
    v_mov_b32 v125, v124
    s_nop 1
    v_permlane32_swap_b32 v124, v125
    v_max_f32 v124, v124, v125
    v_and_b32 v124, s82, v124
    v_max_f32 v124, v124, v120
    v_sub_f32 v125, v120, v124
    v_exp_f32 v125, v125
    v_mov_b32 v120, v124
    v_sub_f32 v123, v122, v124
    v_mul_f32 v121, v121, v125
    v_mul_f32 v116, v116, v125
    v_mul_f32 v117, v117, v125
    v_mul_f32 v118, v118, v125
    v_mul_f32 v119, v119, v125
L_nomax_11:
    v_exp_f32 v123, v123
    s_nop 0
    v_cvt_pk_bf16_f32 v124, v123, v123
    v_add_f32 v121, v121, v123
    s_nop 0
    v_and_b32_dpp v96, v124, v10 row_newbcast:0 row_mask:0xf bank_mask:0xf
    v_and_b32_dpp v97, v124, v11 row_newbcast:0 row_mask:0xf bank_mask:0xf
    v_and_b32_dpp v98, v124, v12 row_newbcast:0 row_mask:0xf bank_mask:0xf
    v_and_b32_dpp v99, v124, v13 row_newbcast:0 row_mask:0xf bank_mask:0xf
    v_and_b32_dpp v100, v124, v10 row_newbcast:4 row_mask:0xf bank_mask:0xf
    v_and_b32_dpp v101, v124, v11 row_newbcast:4 row_mask:0xf bank_mask:0xf
    v_and_b32_dpp v102, v124, v12 row_newbcast:4 row_mask:0xf bank_mask:0xf
    v_and_b32_dpp v103, v124, v13 row_newbcast:4 row_mask:0xf bank_mask:0xf
    v_and_b32_dpp v104, v124, v10 row_newbcast:8 row_mask:0xf bank_mask:0xf
    v_and_b32_dpp v105, v124, v11 row_newbcast:8 row_mask:0xf bank_mask:0xf
    v_and_b32_dpp v106, v124, v12 row_newbcast:8 row_mask:0xf bank_mask:0xf
    v_and_b32_dpp v107, v124, v13 row_newbcast:8 row_mask:0xf bank_mask:0xf
    v_and_b32_dpp v108, v124, v10 row_newbcast:12 row_mask:0xf bank_mask:0xf
    v_and_b32_dpp v109, v124, v11 row_newbcast:12 row_mask:0xf bank_mask:0xf
    v_and_b32_dpp v110, v124, v12 row_newbcast:12 row_mask:0xf bank_mask:0xf
    v_and_b32_dpp v111, v124, v13 row_newbcast:12 row_mask:0xf bank_mask:0xf
    s_waitcnt vmcnt(5)
    v_mov_b32 v19, 256
    s_cmp_ge_u32 s87, 255
    s_cbranch_scc1 L_noclaim_12
    s_mov_b64 exec, 1
    global_atomic_add v19, v9, v18, s[30:31] sc0 sc1
    s_mov_b64 exec, -1
L_noclaim_12:
    buffer_load_dwordx4 v[136:139], v76, s[52:55], s85 offen offset:256 nt
    v_mfma_f32_16x16x32_bf16 v[116:119], v[176:179], v[96:99], v[116:119]
    s_waitcnt vmcnt(5)
    buffer_load_dwordx4 v[140:143], v77, s[52:55], s85 offen offset:0 nt
    v_mfma_f32_16x16x32_bf16 v[116:119], v[180:183], v[100:103], v[116:119]
    s_waitcnt vmcnt(5)
    buffer_load_dwordx4 v[144:147], v126, s[56:59], s85 offen offset:0 nt
    v_mfma_f32_16x16x32_bf16 v[116:119], v[184:187], v[104:107], v[116:119]
    s_waitcnt vmcnt(5)
    buffer_load_dwordx4 v[148:151], v127, s[56:59], s85 offen offset:256 nt
    v_mfma_f32_16x16x32_bf16 v[116:119], v[188:191], v[108:111], v[116:119]
    s_cmp_ge_u32 s87, 256
    s_cbranch_scc0 L_dloop
L_bdone:
    v_add_f32_dpp v121, v121, v121 row_ror:8 row_mask:0xf bank_mask:0xf
    s_lshl_b32 s38, s32, 2
    s_add_u32 s38, s38, s34
    v_add_f32_dpp v121, v121, v121 row_ror:4 row_mask:0xf bank_mask:0xf
    v_mov_b32 v125, v121
    s_lshl_b32 s38, s38, 3
    s_add_u32 s38, s38, s33
    v_permlane16_swap_b32 v121, v125
    v_add_f32 v121, v121, v125
    v_mov_b32 v125, v121
    s_lshl_b32 s38, s38, 10
    s_add_u32 s38, s38, 5242880
    v_permlane32_swap_b32 v121, v125
    s_mov_b32 exec_lo, 0x100
    s_mov_b32 exec_hi, 0x0
    v_add_f32 v117, v121, v125
    v_mov_b32 v116, v120
    s_mov_b32 exec_lo, 0xff01ff
    s_mov_b32 exec_hi, 0xff00ff
    v_and_or_b32 v116, v116, s82, v8
    v_and_or_b32 v117, v117, s82, v8
    v_and_or_b32 v118, v118, s82, v8
    v_and_or_b32 v119, v119, s82, v8
    buffer_store_dwordx4 v[116:119], v79, s[48:51], s38 offen sc1
    s_endpgm
L_aux:
    s_mov_b32 s56, s10
    s_and_b32 s57, s11, 0xffff
    s_mov_b32 s58, 4194304
    s_mov_b32 s59, 0x20000
    s_mov_b32 s52, s6
    s_and_b32 s53, s7, 0xffff
    s_mov_b32 s54, 16777216
    s_mov_b32 s55, 0x20000
    v_lshrrev_b32 v4, 2, v3
    v_and_b32 v5, 3, v3
    v_lshlrev_b32 v18, 18, v4
    v_lshl_add_u32 v18, v2, 6, v18
    v_lshl_add_u32 v18, v5, 4, v18
    s_lshl_b32 s85, s34, 20
    s_lshl_b32 s38, s32, 8
    s_add_u32 s85, s85, s38
    s_mov_b32 s89, s85
    s_waitcnt vmcnt(7)
    buffer_load_dwordx4 a[0:3], v18, s[56:59], s85 offen nt
    s_add_u32 s85, s85, 8192
    v_perm_b32 v4, v20, v20, s80
    v_perm_b32 v5, v24, v24, s80
    v_and_b32 v28, v4, v10
    v_and_b32 v29, v4, v11
    v_and_b32 v30, v4, v12
    v_and_b32 v31, v4, v13
    v_and_b32 v32, v5, v10
    v_and_b32 v33, v5, v11
    v_and_b32 v34, v5, v12
    v_and_b32 v35, v5, v13
    v_mfma_f32_16x16x32_bf16 v[36:39], v[44:47], v[28:31], 0
    s_nop 0
    v_mfma_f32_16x16x32_bf16 v[40:43], v[44:47], v[32:35], 0
    s_waitcnt vmcnt(7)
    buffer_load_dwordx4 a[4:7], v18, s[56:59], s85 offen nt
    s_add_u32 s85, s85, 8192
    v_perm_b32 v4, v20, v20, s81
    v_perm_b32 v5, v24, v24, s81
    v_and_b32 v28, v4, v10
    v_and_b32 v29, v4, v11
    v_and_b32 v30, v4, v12
    v_and_b32 v31, v4, v13
    v_and_b32 v32, v5, v10
    v_and_b32 v33, v5, v11
    v_and_b32 v34, v5, v12
    v_and_b32 v35, v5, v13
    v_mfma_f32_16x16x32_bf16 v[36:39], v[48:51], v[28:31], v[36:39]
    s_nop 0
    v_mfma_f32_16x16x32_bf16 v[40:43], v[48:51], v[32:35], v[40:43]
    s_waitcnt vmcnt(7)
    buffer_load_dwordx4 a[8:11], v18, s[56:59], s85 offen nt
    s_add_u32 s85, s85, 8192
    v_perm_b32 v4, v21, v21, s80
    v_perm_b32 v5, v25, v25, s80
    v_and_b32 v28, v4, v10
    v_and_b32 v29, v4, v11
    v_and_b32 v30, v4, v12
    v_and_b32 v31, v4, v13
    v_and_b32 v32, v5, v10
    v_and_b32 v33, v5, v11
    v_and_b32 v34, v5, v12
    v_and_b32 v35, v5, v13
    v_mfma_f32_16x16x32_bf16 v[36:39], v[52:55], v[28:31], v[36:39]
    s_nop 0
    v_mfma_f32_16x16x32_bf16 v[40:43], v[52:55], v[32:35], v[40:43]
    s_waitcnt vmcnt(7)
    buffer_load_dwordx4 a[12:15], v18, s[56:59], s85 offen nt
    s_add_u32 s85, s85, 8192
    v_perm_b32 v4, v21, v21, s81
    v_perm_b32 v5, v25, v25, s81
    v_and_b32 v28, v4, v10
    v_and_b32 v29, v4, v11
    v_and_b32 v30, v4, v12
    v_and_b32 v31, v4, v13
    v_and_b32 v32, v5, v10
    v_and_b32 v33, v5, v11
    v_and_b32 v34, v5, v12
    v_and_b32 v35, v5, v13
    v_mfma_f32_16x16x32_bf16 v[36:39], v[56:59], v[28:31], v[36:39]
    s_nop 0
    v_mfma_f32_16x16x32_bf16 v[40:43], v[56:59], v[32:35], v[40:43]
    s_waitcnt vmcnt(7)
    buffer_load_dwordx4 a[16:19], v18, s[56:59], s85 offen nt
    s_add_u32 s85, s85, 8192
    v_perm_b32 v4, v22, v22, s80
    v_perm_b32 v5, v26, v26, s80
    v_and_b32 v28, v4, v10
    v_and_b32 v29, v4, v11
    v_and_b32 v30, v4, v12
    v_and_b32 v31, v4, v13
    v_and_b32 v32, v5, v10
    v_and_b32 v33, v5, v11
    v_and_b32 v34, v5, v12
    v_and_b32 v35, v5, v13
    v_mfma_f32_16x16x32_bf16 v[36:39], v[60:63], v[28:31], v[36:39]
    s_nop 0
    v_mfma_f32_16x16x32_bf16 v[40:43], v[60:63], v[32:35], v[40:43]
    s_waitcnt vmcnt(7)
    buffer_load_dwordx4 a[20:23], v18, s[56:59], s85 offen nt
    s_add_u32 s85, s85, 8192
    v_perm_b32 v4, v22, v22, s81
    v_perm_b32 v5, v26, v26, s81
    v_and_b32 v28, v4, v10
    v_and_b32 v29, v4, v11
    v_and_b32 v30, v4, v12
    v_and_b32 v31, v4, v13
    v_and_b32 v32, v5, v10
    v_and_b32 v33, v5, v11
    v_and_b32 v34, v5, v12
    v_and_b32 v35, v5, v13
    v_mfma_f32_16x16x32_bf16 v[36:39], v[64:67], v[28:31], v[36:39]
    s_nop 0
    v_mfma_f32_16x16x32_bf16 v[40:43], v[64:67], v[32:35], v[40:43]
    s_waitcnt vmcnt(7)
    buffer_load_dwordx4 a[24:27], v18, s[56:59], s85 offen nt
    s_add_u32 s85, s85, 8192
    v_perm_b32 v4, v23, v23, s80
    v_perm_b32 v5, v27, v27, s80
    v_and_b32 v28, v4, v10
    v_and_b32 v29, v4, v11
    v_and_b32 v30, v4, v12
    v_and_b32 v31, v4, v13
    v_and_b32 v32, v5, v10
    v_and_b32 v33, v5, v11
    v_and_b32 v34, v5, v12
    v_and_b32 v35, v5, v13
    v_mfma_f32_16x16x32_bf16 v[36:39], v[68:71], v[28:31], v[36:39]
    s_nop 0
    v_mfma_f32_16x16x32_bf16 v[40:43], v[68:71], v[32:35], v[40:43]
    s_waitcnt vmcnt(7)
    buffer_load_dwordx4 a[28:31], v18, s[56:59], s85 offen nt
    s_add_u32 s85, s85, 8192
    v_perm_b32 v4, v23, v23, s81
    v_perm_b32 v5, v27, v27, s81
    v_and_b32 v28, v4, v10
    v_and_b32 v29, v4, v11
    v_and_b32 v30, v4, v12
    v_and_b32 v31, v4, v13
    v_and_b32 v32, v5, v10
    v_and_b32 v33, v5, v11
    v_and_b32 v34, v5, v12
    v_and_b32 v35, v5, v13
    v_mfma_f32_16x16x32_bf16 v[36:39], v[72:75], v[28:31], v[36:39]
    s_nop 0
    v_mfma_f32_16x16x32_bf16 v[40:43], v[72:75], v[32:35], v[40:43]
    s_lshl_b32 s38, s34, 11
    s_add_u32 s38, s38, 131072
    v_lshrrev_b32 v4, 3, v3
    v_lshlrev_b32 v4, 9, v4
    v_lshl_add_u32 v4, v2, 7, v4
    v_and_b32 v5, 7, v3
    v_lshl_add_u32 v4, v5, 2, v4
    v_add_u32 v4, s38, v4
    s_lshl_b32 s38, s34, 9
    v_and_b32 v5, 31, v1
    v_lshl_add_u32 v5, v5, 4, s38
    v_add_u32 v6, 131072, v5
    ds_write_b32 v4, v36 offset:0
    ds_write_b32 v4, v37 offset:32
    ds_write_b32 v4, v38 offset:64
    ds_write_b32 v4, v39 offset:96
    ds_write_b32 v4, v40 offset:1024
    ds_write_b32 v4, v41 offset:1056
    ds_write_b32 v4, v42 offset:1088
    ds_write_b32 v4, v43 offset:1120
    s_waitcnt lgkmcnt(0)
    s_barrier
    ds_read_b128 v[44:47], v6 offset:0
    ds_read_b128 v[48:51], v6 offset:2048
    ds_read_b128 v[52:55], v6 offset:4096
    ds_read_b128 v[56:59], v6 offset:6144
    s_add_u32 s35, s35, 0x5b
    s_and_b32 s35, s35, 0xff
    v_mov_b32 v8, s35
    s_lshl_b32 s38, s32, 3
    s_add_u32 s38, s38, s33
    s_lshl_b32 s38, s38, 11
    s_add_u32 s38, s38, 1048576
    s_waitcnt lgkmcnt(0)
    v_add_f32 v44, v44, v48
    v_add_f32 v52, v52, v56
    v_add_f32 v45, v45, v49
    v_add_f32 v53, v53, v57
    v_add_f32 v46, v46, v50
    v_add_f32 v54, v54, v58
    v_add_f32 v47, v47, v51
    v_add_f32 v55, v55, v59
    v_add_f32 v44, v44, v52
    v_add_f32 v45, v45, v53
    v_add_f32 v46, v46, v54
    v_add_f32 v47, v47, v55
    v_and_or_b32 v44, v44, s82, v8
    v_and_or_b32 v45, v45, s82, v8
    v_and_or_b32 v46, v46, s82, v8
    v_and_or_b32 v47, v47, s82, v8
    s_mov_b32 exec_lo, 0xffffffff
    s_mov_b32 exec_hi, 0x0
    buffer_store_dwordx4 v[44:47], v5, s[48:51], s38 offen sc1
    s_mov_b64 exec, -1
    v_lshrrev_b32 v4, 2, v3
    v_and_b32 v5, 3, v3
    v_lshlrev_b32 v6, 9, v4
    v_lshl_add_u32 v6, v2, 7, v6
    v_lshl_add_u32 v6, v5, 5, v6
    s_lshl_b32 s86, s32, 14
    s_add_u32 s86, s86, 1056768
    s_add_u32 s36, s86, 4096
    v_lshlrev_b32 v4, 2, v2
    v_xor_b32 v4, v4, v3
    v_xor_b32 v5, 0, v4
    v_lshlrev_b32 v5, 4, v5
    v_lshl_add_u32 v76, v2, 10, v5
    v_lshl_add_u32 v96, v2, 8, v5
    v_xor_b32 v5, 1, v4
    v_lshlrev_b32 v5, 4, v5
    v_lshl_add_u32 v77, v2, 10, v5
    v_lshl_add_u32 v97, v2, 8, v5
    v_add_u32 v77, 3072, v77
    v_xor_b32 v5, 2, v4
    v_lshlrev_b32 v5, 4, v5
    v_lshl_add_u32 v78, v2, 10, v5
    v_lshl_add_u32 v98, v2, 8, v5
    v_add_u32 v78, 6144, v78
    v_xor_b32 v5, 3, v4
    v_lshlrev_b32 v5, 4, v5
    v_lshl_add_u32 v79, v2, 10, v5
    v_lshl_add_u32 v99, v2, 8, v5
    v_add_u32 v79, 9216, v79
    s_lshl_b32 s90, s34, 15
    v_add_u32 v96, s90, v96
    v_add_u32 v97, s90, v97
    v_add_u32 v98, s90, v98
    v_add_u32 v99, s90, v99
    s_lshl_b32 s95, s32, 19
    s_lshl_b32 s38, s34, 8
    s_add_u32 s95, s95, s38
    s_mov_b32 s94, 0
    s_mov_b32 s91, 16384
    s_mov_b32 s62, 0
    buffer_load_dwordx4 a[32:35], v18, s[56:59], s85 offen nt
    s_add_u32 s85, s85, 8192
    buffer_load_dwordx4 a[36:39], v18, s[56:59], s85 offen nt
    s_add_u32 s85, s85, 8192
    buffer_load_dwordx4 a[40:43], v18, s[56:59], s85 offen nt
    s_add_u32 s85, s85, 8192
    s_add_u32 s39, s90, s62
    s_mov_b32 m0, s39
    s_add_u32 s62, s62, 4096
    s_and_b32 s62, s62, 0x7fff
    buffer_load_dwordx4 v76, s[52:55], s95 offen offset:0 nt lds
    buffer_load_dwordx4 a[44:47], v18, s[56:59], s85 offen nt
    s_add_u32 s85, s85, 8192
    buffer_load_dwordx4 a[48:51], v18, s[56:59], s85 offen nt
    s_add_u32 s85, s85, 8192
    buffer_load_dwordx4 a[52:55], v18, s[56:59], s85 offen nt
    s_add_u32 s85, s85, 8192
    buffer_load_dwordx4 v77, s[52:55], s95 offen offset:1024 nt lds
    buffer_load_dwordx4 a[56:59], v18, s[56:59], s85 offen nt
    s_add_u32 s85, s85, 8192
    buffer_load_dwordx4 a[60:63], v18, s[56:59], s85 offen nt
    s_add_u32 s85, s85, 8192
    buffer_load_dwordx4 a[64:67], v18, s[56:59], s85 offen nt
    s_add_u32 s85, s85, 8192
    buffer_load_dwordx4 v78, s[52:55], s95 offen offset:2048 nt lds
    buffer_load_dwordx4 a[68:71], v18, s[56:59], s85 offen nt
    s_add_u32 s85, s85, 8192
    buffer_load_dwordx4 a[72:75], v18, s[56:59], s85 offen nt
    s_add_u32 s85, s85, 8192
    buffer_load_dwordx4 a[76:79], v18, s[56:59], s85 offen nt
    s_add_u32 s85, s85, 8192
    buffer_load_dwordx4 v79, s[52:55], s95 offen offset:3072 nt lds
    s_add_u32 s95, s95, s91
    buffer_load_dwordx4 a[80:83], v18, s[56:59], s85 offen nt
    s_add_u32 s85, s85, 8192
    buffer_load_dwordx4 a[84:87], v18, s[56:59], s85 offen nt
    s_add_u32 s85, s85, 8192
    buffer_load_dwordx4 a[88:91], v18, s[56:59], s85 offen nt
    s_add_u32 s85, s85, 8192
    s_add_u32 s39, s90, s62
    s_mov_b32 m0, s39
    s_add_u32 s62, s62, 4096
    s_and_b32 s62, s62, 0x7fff
    buffer_load_dwordx4 v76, s[52:55], s95 offen offset:0 nt lds
    buffer_load_dwordx4 a[92:95], v18, s[56:59], s85 offen nt
    s_add_u32 s85, s85, 8192
    buffer_load_dwordx4 a[96:99], v18, s[56:59], s85 offen nt
    s_add_u32 s85, s85, 8192
    buffer_load_dwordx4 a[100:103], v18, s[56:59], s85 offen nt
    s_add_u32 s85, s85, 8192
    buffer_load_dwordx4 v77, s[52:55], s95 offen offset:1024 nt lds
    buffer_load_dwordx4 a[104:107], v18, s[56:59], s85 offen nt
    s_add_u32 s85, s85, 8192
    buffer_load_dwordx4 a[108:111], v18, s[56:59], s85 offen nt
    s_add_u32 s85, s85, 8192
    buffer_load_dwordx4 a[112:115], v18, s[56:59], s85 offen nt
    s_add_u32 s85, s85, 8192
    buffer_load_dwordx4 v78, s[52:55], s95 offen offset:2048 nt lds
    buffer_load_dwordx4 a[116:119], v18, s[56:59], s85 offen nt
    s_add_u32 s85, s85, 8192
    buffer_load_dwordx4 a[120:123], v18, s[56:59], s85 offen nt
    s_add_u32 s85, s85, 8192
    buffer_load_dwordx4 a[124:127], v18, s[56:59], s85 offen nt
    s_add_u32 s85, s85, 8192
    buffer_load_dwordx4 v79, s[52:55], s95 offen offset:3072 nt lds
    s_add_u32 s95, s95, s91
    buffer_load_dwordx4 v[136:139], v6, s[48:51], s86 offen offset:0 sc1
    buffer_load_dwordx4 v[140:143], v6, s[48:51], s86 offen offset:16 sc1
    buffer_load_dwordx4 v[144:147], v6, s[48:51], s86 offen offset:2048 sc1
    buffer_load_dwordx4 v[148:151], v6, s[48:51], s86 offen offset:2064 sc1
    buffer_load_dwordx4 v[152:155], v6, s[48:51], s36 offen offset:0 sc1
    buffer_load_dwordx4 v[156:159], v6, s[48:51], s36 offen offset:16 sc1
    buffer_load_dwordx4 v[160:163], v6, s[48:51], s36 offen offset:2048 sc1
    buffer_load_dwordx4 v[164:167], v6, s[48:51], s36 offen offset:2064 sc1
    s_add_u32 s39, s90, s62
    s_mov_b32 m0, s39
    s_add_u32 s62, s62, 4096
    s_and_b32 s62, s62, 0x7fff
    buffer_load_dwordx4 v76, s[52:55], s95 offen offset:0 nt lds
    buffer_load_dwordx4 v77, s[52:55], s95 offen offset:1024 nt lds
    buffer_load_dwordx4 v78, s[52:55], s95 offen offset:2048 nt lds
    buffer_load_dwordx4 v79, s[52:55], s95 offen offset:3072 nt lds
    s_add_u32 s95, s95, s91
    s_waitcnt vmcnt(4)
L_qacheck_13:
    v_xor_b32 v136, s35, v136
    v_xor_b32 v137, s35, v137
    v_xor_b32 v138, s35, v138
    v_xor_b32 v139, s35, v139
    v_xor_b32 v140, s35, v140
    v_xor_b32 v141, s35, v141
    v_xor_b32 v142, s35, v142
    v_xor_b32 v143, s35, v143
    v_xor_b32 v144, s35, v144
    v_xor_b32 v145, s35, v145
    v_xor_b32 v146, s35, v146
    v_xor_b32 v147, s35, v147
    v_xor_b32 v148, s35, v148
    v_xor_b32 v149, s35, v149
    v_xor_b32 v150, s35, v150
    v_xor_b32 v151, s35, v151
    v_xor_b32 v152, s35, v152
    v_xor_b32 v153, s35, v153
    v_xor_b32 v154, s35, v154
    v_xor_b32 v155, s35, v155
    v_xor_b32 v156, s35, v156
    v_xor_b32 v157, s35, v157
    v_xor_b32 v158, s35, v158
    v_xor_b32 v159, s35, v159
    v_xor_b32 v160, s35, v160
    v_xor_b32 v161, s35, v161
    v_xor_b32 v162, s35, v162
    v_xor_b32 v163, s35, v163
    v_xor_b32 v164, s35, v164
    v_xor_b32 v165, s35, v165
    v_xor_b32 v166, s35, v166
    v_xor_b32 v167, s35, v167
    v_or_b32 v4, v136, v137
    v_or3_b32 v4, v4, v138, v139
    v_or3_b32 v4, v4, v140, v141
    v_or3_b32 v4, v4, v142, v143
    v_or3_b32 v4, v4, v144, v145
    v_or3_b32 v4, v4, v146, v147
    v_or3_b32 v4, v4, v148, v149
    v_or3_b32 v4, v4, v150, v151
    v_or3_b32 v4, v4, v152, v153
    v_or3_b32 v4, v4, v154, v155
    v_or3_b32 v4, v4, v156, v157
    v_or3_b32 v4, v4, v158, v159
    v_or3_b32 v4, v4, v160, v161
    v_or3_b32 v4, v4, v162, v163
    v_or3_b32 v4, v4, v164, v165
    v_or3_b32 v4, v4, v166, v167
    v_and_b32 v4, 0xff, v4
    v_cmp_ne_u32 vcc, 0, v4
    s_cbranch_vccz L_qaok_14
    buffer_load_dwordx4 v[136:139], v6, s[48:51], s86 offen offset:0 sc1
    buffer_load_dwordx4 v[140:143], v6, s[48:51], s86 offen offset:16 sc1
    buffer_load_dwordx4 v[144:147], v6, s[48:51], s86 offen offset:2048 sc1
    buffer_load_dwordx4 v[148:151], v6, s[48:51], s86 offen offset:2064 sc1
    buffer_load_dwordx4 v[152:155], v6, s[48:51], s36 offen offset:0 sc1
    buffer_load_dwordx4 v[156:159], v6, s[48:51], s36 offen offset:16 sc1
    buffer_load_dwordx4 v[160:163], v6, s[48:51], s36 offen offset:2048 sc1
    buffer_load_dwordx4 v[164:167], v6, s[48:51], s36 offen offset:2064 sc1
    s_waitcnt vmcnt(0)
    s_sub_u32 s84, s84, 1
    s_cmp_lg_u32 s84, 0
    s_cbranch_scc1 L_qacheck_13
    s_branch L_end
L_qaok_14:
    v_add_f32 v136, v136, v152
    v_add_f32 v144, v144, v160
    v_add_f32 v137, v137, v153
    v_add_f32 v145, v145, v161
    v_add_f32 v138, v138, v154
    v_add_f32 v146, v146, v162
    v_add_f32 v139, v139, v155
    v_add_f32 v147, v147, v163
    v_add_f32 v140, v140, v156
    v_add_f32 v148, v148, v164
    v_add_f32 v141, v141, v157
    v_add_f32 v149, v149, v165
    v_add_f32 v142, v142, v158
    v_add_f32 v150, v150, v166
    v_add_f32 v143, v143, v159
    v_add_f32 v151, v151, v167
    v_add_f32 v136, v136, v144
    v_add_f32 v137, v137, v145
    v_add_f32 v138, v138, v146
    v_add_f32 v139, v139, v147
    v_add_f32 v140, v140, v148
    v_add_f32 v141, v141, v149
    v_add_f32 v142, v142, v150
    v_add_f32 v143, v143, v151
    v_cvt_pk_bf16_f32 v28, v136, v137
    v_cvt_pk_bf16_f32 v29, v138, v139
    v_cvt_pk_bf16_f32 v30, v140, v141
    v_cvt_pk_bf16_f32 v31, v142, v143
    s_add_u32 s39, s90, s62
    s_mov_b32 m0, s39
    s_add_u32 s62, s62, 4096
    s_and_b32 s62, s62, 0x7fff
    buffer_load_dwordx4 v76, s[52:55], s95 offen offset:0 nt lds
    v_mfma_f32_16x16x32_bf16 v[136:139], a[0:3], v[28:31], 0
    v_mfma_f32_16x16x32_bf16 v[140:143], a[4:7], v[28:31], 0
    v_mfma_f32_16x16x32_bf16 v[144:147], a[8:11], v[28:31], 0
    v_mfma_f32_16x16x32_bf16 v[148:151], a[12:15], v[28:31], 0
    s_nop 4
    v_mov_b32_dpp v168, v136 quad_perm:[0,0,0,0] row_mask:0xf bank_mask:0xf
    v_mov_b32_dpp v4, v138 quad_perm:[2,2,2,2] row_mask:0xf bank_mask:0xf
    s_nop 0
    v_add_f32_dpp v168, v137, v168 quad_perm:[1,1,1,1] row_mask:0xf bank_mask:0xf
    v_add_f32_dpp v4, v139, v4 quad_perm:[3,3,3,3] row_mask:0xf bank_mask:0xf
    v_add_f32 v168, v168, v4
    v_mfma_f32_16x16x32_bf16 v[152:155], a[16:19], v[28:31], 0
    v_mov_b32_dpp v169, v140 quad_perm:[0,0,0,0] row_mask:0xf bank_mask:0xf
    v_mov_b32_dpp v4, v142 quad_perm:[2,2,2,2] row_mask:0xf bank_mask:0xf
    s_nop 0
    v_add_f32_dpp v169, v141, v169 quad_perm:[1,1,1,1] row_mask:0xf bank_mask:0xf
    v_add_f32_dpp v4, v143, v4 quad_perm:[3,3,3,3] row_mask:0xf bank_mask:0xf
    v_add_f32 v169, v169, v4
    buffer_load_dwordx4 v77, s[52:55], s95 offen offset:1024 nt lds
    v_mfma_f32_16x16x32_bf16 v[156:159], a[20:23], v[28:31], 0
    v_mov_b32_dpp v170, v144 quad_perm:[0,0,0,0] row_mask:0xf bank_mask:0xf
    v_mov_b32_dpp v4, v146 quad_perm:[2,2,2,2] row_mask:0xf bank_mask:0xf
    s_nop 0
    v_add_f32_dpp v170, v145, v170 quad_perm:[1,1,1,1] row_mask:0xf bank_mask:0xf
    v_add_f32_dpp v4, v147, v4 quad_perm:[3,3,3,3] row_mask:0xf bank_mask:0xf
    v_add_f32 v170, v170, v4
    v_mfma_f32_16x16x32_bf16 v[160:163], a[24:27], v[28:31], 0
    v_mov_b32_dpp v171, v148 quad_perm:[0,0,0,0] row_mask:0xf bank_mask:0xf
    v_mov_b32_dpp v4, v150 quad_perm:[2,2,2,2] row_mask:0xf bank_mask:0xf
    s_nop 0
    v_add_f32_dpp v171, v149, v171 quad_perm:[1,1,1,1] row_mask:0xf bank_mask:0xf
    v_add_f32_dpp v4, v151, v4 quad_perm:[3,3,3,3] row_mask:0xf bank_mask:0xf
    v_add_f32 v171, v171, v4
    v_mfma_f32_16x16x32_bf16 v[164:167], a[28:31], v[28:31], 0
    v_mov_b32_dpp v172, v152 quad_perm:[0,0,0,0] row_mask:0xf bank_mask:0xf
    v_mov_b32_dpp v4, v154 quad_perm:[2,2,2,2] row_mask:0xf bank_mask:0xf
    s_nop 0
    v_add_f32_dpp v172, v153, v172 quad_perm:[1,1,1,1] row_mask:0xf bank_mask:0xf
    v_add_f32_dpp v4, v155, v4 quad_perm:[3,3,3,3] row_mask:0xf bank_mask:0xf
    v_add_f32 v172, v172, v4
    v_mfma_f32_16x16x32_bf16 v[136:139], a[32:35], v[28:31], 0
    v_mov_b32_dpp v173, v156 quad_perm:[0,0,0,0] row_mask:0xf bank_mask:0xf
    v_mov_b32_dpp v4, v158 quad_perm:[2,2,2,2] row_mask:0xf bank_mask:0xf
    s_nop 0
    v_add_f32_dpp v173, v157, v173 quad_perm:[1,1,1,1] row_mask:0xf bank_mask:0xf
    v_add_f32_dpp v4, v159, v4 quad_perm:[3,3,3,3] row_mask:0xf bank_mask:0xf
    v_add_f32 v173, v173, v4
    v_mfma_f32_16x16x32_bf16 v[140:143], a[36:39], v[28:31], 0
    v_mov_b32_dpp v174, v160 quad_perm:[0,0,0,0] row_mask:0xf bank_mask:0xf
    v_mov_b32_dpp v4, v162 quad_perm:[2,2,2,2] row_mask:0xf bank_mask:0xf
    s_nop 0
    v_add_f32_dpp v174, v161, v174 quad_perm:[1,1,1,1] row_mask:0xf bank_mask:0xf
    v_add_f32_dpp v4, v163, v4 quad_perm:[3,3,3,3] row_mask:0xf bank_mask:0xf
    v_add_f32 v174, v174, v4
    v_mfma_f32_16x16x32_bf16 v[144:147], a[40:43], v[28:31], 0
    v_mov_b32_dpp v175, v164 quad_perm:[0,0,0,0] row_mask:0xf bank_mask:0xf
    v_mov_b32_dpp v4, v166 quad_perm:[2,2,2,2] row_mask:0xf bank_mask:0xf
    s_nop 0
    v_add_f32_dpp v175, v165, v175 quad_perm:[1,1,1,1] row_mask:0xf bank_mask:0xf
    v_add_f32_dpp v4, v167, v4 quad_perm:[3,3,3,3] row_mask:0xf bank_mask:0xf
    v_add_f32 v175, v175, v4
    v_mfma_f32_16x16x32_bf16 v[148:151], a[44:47], v[28:31], 0
    v_mov_b32_dpp v176, v136 quad_perm:[0,0,0,0] row_mask:0xf bank_mask:0xf
    v_mov_b32_dpp v4, v138 quad_perm:[2,2,2,2] row_mask:0xf bank_mask:0xf
    s_nop 0
    v_add_f32_dpp v176, v137, v176 quad_perm:[1,1,1,1] row_mask:0xf bank_mask:0xf
    v_add_f32_dpp v4, v139, v4 quad_perm:[3,3,3,3] row_mask:0xf bank_mask:0xf
    v_add_f32 v176, v176, v4
    v_mfma_f32_16x16x32_bf16 v[152:155], a[48:51], v[28:31], 0
    v_mov_b32_dpp v177, v140 quad_perm:[0,0,0,0] row_mask:0xf bank_mask:0xf
    v_mov_b32_dpp v4, v142 quad_perm:[2,2,2,2] row_mask:0xf bank_mask:0xf
    s_nop 0
    v_add_f32_dpp v177, v141, v177 quad_perm:[1,1,1,1] row_mask:0xf bank_mask:0xf
    v_add_f32_dpp v4, v143, v4 quad_perm:[3,3,3,3] row_mask:0xf bank_mask:0xf
    v_add_f32 v177, v177, v4
    buffer_load_dwordx4 v78, s[52:55], s95 offen offset:2048 nt lds
    v_mfma_f32_16x16x32_bf16 v[156:159], a[52:55], v[28:31], 0
    v_mov_b32_dpp v178, v144 quad_perm:[0,0,0,0] row_mask:0xf bank_mask:0xf
    v_mov_b32_dpp v4, v146 quad_perm:[2,2,2,2] row_mask:0xf bank_mask:0xf
    s_nop 0
    v_add_f32_dpp v178, v145, v178 quad_perm:[1,1,1,1] row_mask:0xf bank_mask:0xf
    v_add_f32_dpp v4, v147, v4 quad_perm:[3,3,3,3] row_mask:0xf bank_mask:0xf
    v_add_f32 v178, v178, v4
    v_mfma_f32_16x16x32_bf16 v[160:163], a[56:59], v[28:31], 0
    v_mov_b32_dpp v179, v148 quad_perm:[0,0,0,0] row_mask:0xf bank_mask:0xf
    v_mov_b32_dpp v4, v150 quad_perm:[2,2,2,2] row_mask:0xf bank_mask:0xf
    s_nop 0
    v_add_f32_dpp v179, v149, v179 quad_perm:[1,1,1,1] row_mask:0xf bank_mask:0xf
    v_add_f32_dpp v4, v151, v4 quad_perm:[3,3,3,3] row_mask:0xf bank_mask:0xf
    v_add_f32 v179, v179, v4
    v_mfma_f32_16x16x32_bf16 v[164:167], a[60:63], v[28:31], 0
    v_mov_b32_dpp v180, v152 quad_perm:[0,0,0,0] row_mask:0xf bank_mask:0xf
    v_mov_b32_dpp v4, v154 quad_perm:[2,2,2,2] row_mask:0xf bank_mask:0xf
    s_nop 0
    v_add_f32_dpp v180, v153, v180 quad_perm:[1,1,1,1] row_mask:0xf bank_mask:0xf
    v_add_f32_dpp v4, v155, v4 quad_perm:[3,3,3,3] row_mask:0xf bank_mask:0xf
    v_add_f32 v180, v180, v4
    v_mfma_f32_16x16x32_bf16 v[136:139], a[64:67], v[28:31], 0
    v_mov_b32_dpp v181, v156 quad_perm:[0,0,0,0] row_mask:0xf bank_mask:0xf
    v_mov_b32_dpp v4, v158 quad_perm:[2,2,2,2] row_mask:0xf bank_mask:0xf
    s_nop 0
    v_add_f32_dpp v181, v157, v181 quad_perm:[1,1,1,1] row_mask:0xf bank_mask:0xf
    v_add_f32_dpp v4, v159, v4 quad_perm:[3,3,3,3] row_mask:0xf bank_mask:0xf
    v_add_f32 v181, v181, v4
    v_mfma_f32_16x16x32_bf16 v[140:143], a[68:71], v[28:31], 0
    v_mov_b32_dpp v182, v160 quad_perm:[0,0,0,0] row_mask:0xf bank_mask:0xf
    v_mov_b32_dpp v4, v162 quad_perm:[2,2,2,2] row_mask:0xf bank_mask:0xf
    s_nop 0
    v_add_f32_dpp v182, v161, v182 quad_perm:[1,1,1,1] row_mask:0xf bank_mask:0xf
    v_add_f32_dpp v4, v163, v4 quad_perm:[3,3,3,3] row_mask:0xf bank_mask:0xf
    v_add_f32 v182, v182, v4
    v_mfma_f32_16x16x32_bf16 v[144:147], a[72:75], v[28:31], 0
    v_mov_b32_dpp v183, v164 quad_perm:[0,0,0,0] row_mask:0xf bank_mask:0xf
    v_mov_b32_dpp v4, v166 quad_perm:[2,2,2,2] row_mask:0xf bank_mask:0xf
    s_nop 0
    v_add_f32_dpp v183, v165, v183 quad_perm:[1,1,1,1] row_mask:0xf bank_mask:0xf
    v_add_f32_dpp v4, v167, v4 quad_perm:[3,3,3,3] row_mask:0xf bank_mask:0xf
    v_add_f32 v183, v183, v4
    v_mfma_f32_16x16x32_bf16 v[148:151], a[76:79], v[28:31], 0
    v_mov_b32_dpp v184, v136 quad_perm:[0,0,0,0] row_mask:0xf bank_mask:0xf
    v_mov_b32_dpp v4, v138 quad_perm:[2,2,2,2] row_mask:0xf bank_mask:0xf
    s_nop 0
    v_add_f32_dpp v184, v137, v184 quad_perm:[1,1,1,1] row_mask:0xf bank_mask:0xf
    v_add_f32_dpp v4, v139, v4 quad_perm:[3,3,3,3] row_mask:0xf bank_mask:0xf
    v_add_f32 v184, v184, v4
    v_mfma_f32_16x16x32_bf16 v[152:155], a[80:83], v[28:31], 0
    v_mov_b32_dpp v185, v140 quad_perm:[0,0,0,0] row_mask:0xf bank_mask:0xf
    v_mov_b32_dpp v4, v142 quad_perm:[2,2,2,2] row_mask:0xf bank_mask:0xf
    s_nop 0
    v_add_f32_dpp v185, v141, v185 quad_perm:[1,1,1,1] row_mask:0xf bank_mask:0xf
    v_add_f32_dpp v4, v143, v4 quad_perm:[3,3,3,3] row_mask:0xf bank_mask:0xf
    v_add_f32 v185, v185, v4
    buffer_load_dwordx4 v79, s[52:55], s95 offen offset:3072 nt lds
    s_add_u32 s95, s95, s91
    v_mfma_f32_16x16x32_bf16 v[156:159], a[84:87], v[28:31], 0
    v_mov_b32_dpp v186, v144 quad_perm:[0,0,0,0] row_mask:0xf bank_mask:0xf
    v_mov_b32_dpp v4, v146 quad_perm:[2,2,2,2] row_mask:0xf bank_mask:0xf
    s_nop 0
    v_add_f32_dpp v186, v145, v186 quad_perm:[1,1,1,1] row_mask:0xf bank_mask:0xf
    v_add_f32_dpp v4, v147, v4 quad_perm:[3,3,3,3] row_mask:0xf bank_mask:0xf
    v_add_f32 v186, v186, v4
    v_mfma_f32_16x16x32_bf16 v[160:163], a[88:91], v[28:31], 0
    v_mov_b32_dpp v187, v148 quad_perm:[0,0,0,0] row_mask:0xf bank_mask:0xf
    v_mov_b32_dpp v4, v150 quad_perm:[2,2,2,2] row_mask:0xf bank_mask:0xf
    s_nop 0
    v_add_f32_dpp v187, v149, v187 quad_perm:[1,1,1,1] row_mask:0xf bank_mask:0xf
    v_add_f32_dpp v4, v151, v4 quad_perm:[3,3,3,3] row_mask:0xf bank_mask:0xf
    v_add_f32 v187, v187, v4
    v_mfma_f32_16x16x32_bf16 v[164:167], a[92:95], v[28:31], 0
    v_mov_b32_dpp v188, v152 quad_perm:[0,0,0,0] row_mask:0xf bank_mask:0xf
    v_mov_b32_dpp v4, v154 quad_perm:[2,2,2,2] row_mask:0xf bank_mask:0xf
    s_nop 0
    v_add_f32_dpp v188, v153, v188 quad_perm:[1,1,1,1] row_mask:0xf bank_mask:0xf
    v_add_f32_dpp v4, v155, v4 quad_perm:[3,3,3,3] row_mask:0xf bank_mask:0xf
    v_add_f32 v188, v188, v4
    v_mfma_f32_16x16x32_bf16 v[136:139], a[96:99], v[28:31], 0
    v_mov_b32_dpp v189, v156 quad_perm:[0,0,0,0] row_mask:0xf bank_mask:0xf
    v_mov_b32_dpp v4, v158 quad_perm:[2,2,2,2] row_mask:0xf bank_mask:0xf
    s_nop 0
    v_add_f32_dpp v189, v157, v189 quad_perm:[1,1,1,1] row_mask:0xf bank_mask:0xf
    v_add_f32_dpp v4, v159, v4 quad_perm:[3,3,3,3] row_mask:0xf bank_mask:0xf
    v_add_f32 v189, v189, v4
    v_mfma_f32_16x16x32_bf16 v[140:143], a[100:103], v[28:31], 0
    v_mov_b32_dpp v190, v160 quad_perm:[0,0,0,0] row_mask:0xf bank_mask:0xf
    v_mov_b32_dpp v4, v162 quad_perm:[2,2,2,2] row_mask:0xf bank_mask:0xf
    s_nop 0
    v_add_f32_dpp v190, v161, v190 quad_perm:[1,1,1,1] row_mask:0xf bank_mask:0xf
    v_add_f32_dpp v4, v163, v4 quad_perm:[3,3,3,3] row_mask:0xf bank_mask:0xf
    v_add_f32 v190, v190, v4
    v_mfma_f32_16x16x32_bf16 v[144:147], a[104:107], v[28:31], 0
    v_mov_b32_dpp v191, v164 quad_perm:[0,0,0,0] row_mask:0xf bank_mask:0xf
    v_mov_b32_dpp v4, v166 quad_perm:[2,2,2,2] row_mask:0xf bank_mask:0xf
    s_nop 0
    v_add_f32_dpp v191, v165, v191 quad_perm:[1,1,1,1] row_mask:0xf bank_mask:0xf
    v_add_f32_dpp v4, v167, v4 quad_perm:[3,3,3,3] row_mask:0xf bank_mask:0xf
    v_add_f32 v191, v191, v4
    v_mfma_f32_16x16x32_bf16 v[148:151], a[108:111], v[28:31], 0
    v_mov_b32_dpp v192, v136 quad_perm:[0,0,0,0] row_mask:0xf bank_mask:0xf
    v_mov_b32_dpp v4, v138 quad_perm:[2,2,2,2] row_mask:0xf bank_mask:0xf
    s_nop 0
    v_add_f32_dpp v192, v137, v192 quad_perm:[1,1,1,1] row_mask:0xf bank_mask:0xf
    v_add_f32_dpp v4, v139, v4 quad_perm:[3,3,3,3] row_mask:0xf bank_mask:0xf
    v_add_f32 v192, v192, v4
    v_mfma_f32_16x16x32_bf16 v[152:155], a[112:115], v[28:31], 0
    v_mov_b32_dpp v193, v140 quad_perm:[0,0,0,0] row_mask:0xf bank_mask:0xf
    v_mov_b32_dpp v4, v142 quad_perm:[2,2,2,2] row_mask:0xf bank_mask:0xf
    s_nop 0
    v_add_f32_dpp v193, v141, v193 quad_perm:[1,1,1,1] row_mask:0xf bank_mask:0xf
    v_add_f32_dpp v4, v143, v4 quad_perm:[3,3,3,3] row_mask:0xf bank_mask:0xf
    v_add_f32 v193, v193, v4
    s_add_u32 s39, s90, s62
    s_mov_b32 m0, s39
    s_add_u32 s62, s62, 4096
    s_and_b32 s62, s62, 0x7fff
    buffer_load_dwordx4 v76, s[52:55], s95 offen offset:0 nt lds
    v_mfma_f32_16x16x32_bf16 v[156:159], a[116:119], v[28:31], 0
    v_mov_b32_dpp v194, v144 quad_perm:[0,0,0,0] row_mask:0xf bank_mask:0xf
    v_mov_b32_dpp v4, v146 quad_perm:[2,2,2,2] row_mask:0xf bank_mask:0xf
    s_nop 0
    v_add_f32_dpp v194, v145, v194 quad_perm:[1,1,1,1] row_mask:0xf bank_mask:0xf
    v_add_f32_dpp v4, v147, v4 quad_perm:[3,3,3,3] row_mask:0xf bank_mask:0xf
    v_add_f32 v194, v194, v4
    v_mfma_f32_16x16x32_bf16 v[160:163], a[120:123], v[28:31], 0
    v_mov_b32_dpp v195, v148 quad_perm:[0,0,0,0] row_mask:0xf bank_mask:0xf
    v_mov_b32_dpp v4, v150 quad_perm:[2,2,2,2] row_mask:0xf bank_mask:0xf
    s_nop 0
    v_add_f32_dpp v195, v149, v195 quad_perm:[1,1,1,1] row_mask:0xf bank_mask:0xf
    v_add_f32_dpp v4, v151, v4 quad_perm:[3,3,3,3] row_mask:0xf bank_mask:0xf
    v_add_f32 v195, v195, v4
    v_mfma_f32_16x16x32_bf16 v[164:167], a[124:127], v[28:31], 0
    v_mov_b32_dpp v196, v152 quad_perm:[0,0,0,0] row_mask:0xf bank_mask:0xf
    v_mov_b32_dpp v4, v154 quad_perm:[2,2,2,2] row_mask:0xf bank_mask:0xf
    s_nop 0
    v_add_f32_dpp v196, v153, v196 quad_perm:[1,1,1,1] row_mask:0xf bank_mask:0xf
    v_add_f32_dpp v4, v155, v4 quad_perm:[3,3,3,3] row_mask:0xf bank_mask:0xf
    v_add_f32 v196, v196, v4
    v_mov_b32_dpp v197, v156 quad_perm:[0,0,0,0] row_mask:0xf bank_mask:0xf
    v_mov_b32_dpp v4, v158 quad_perm:[2,2,2,2] row_mask:0xf bank_mask:0xf
    s_nop 0
    v_add_f32_dpp v197, v157, v197 quad_perm:[1,1,1,1] row_mask:0xf bank_mask:0xf
    v_add_f32_dpp v4, v159, v4 quad_perm:[3,3,3,3] row_mask:0xf bank_mask:0xf
    v_add_f32 v197, v197, v4
    v_mov_b32_dpp v198, v160 quad_perm:[0,0,0,0] row_mask:0xf bank_mask:0xf
    v_mov_b32_dpp v4, v162 quad_perm:[2,2,2,2] row_mask:0xf bank_mask:0xf
    s_nop 0
    v_add_f32_dpp v198, v161, v198 quad_perm:[1,1,1,1] row_mask:0xf bank_mask:0xf
    v_add_f32_dpp v4, v163, v4 quad_perm:[3,3,3,3] row_mask:0xf bank_mask:0xf
    v_add_f32 v198, v198, v4
    v_mov_b32_dpp v199, v164 quad_perm:[0,0,0,0] row_mask:0xf bank_mask:0xf
    v_mov_b32_dpp v4, v166 quad_perm:[2,2,2,2] row_mask:0xf bank_mask:0xf
    s_nop 0
    v_add_f32_dpp v199, v165, v199 quad_perm:[1,1,1,1] row_mask:0xf bank_mask:0xf
    v_add_f32_dpp v4, v167, v4 quad_perm:[3,3,3,3] row_mask:0xf bank_mask:0xf
    v_add_f32 v199, v199, v4
    v_cvt_pk_bf16_f32 v200, v168, v169
    v_cvt_pk_bf16_f32 v201, v170, v171
    v_cvt_pk_bf16_f32 v202, v172, v173
    v_cvt_pk_bf16_f32 v203, v174, v175
    v_cvt_pk_bf16_f32 v204, v176, v177
    v_cvt_pk_bf16_f32 v205, v178, v179
    v_cvt_pk_bf16_f32 v206, v180, v181
    v_cvt_pk_bf16_f32 v207, v182, v183
    v_cvt_pk_bf16_f32 v208, v184, v185
    v_cvt_pk_bf16_f32 v209, v186, v187
    v_cvt_pk_bf16_f32 v210, v188, v189
    v_cvt_pk_bf16_f32 v211, v190, v191
    v_cvt_pk_bf16_f32 v212, v192, v193
    v_cvt_pk_bf16_f32 v213, v194, v195
    v_cvt_pk_bf16_f32 v214, v196, v197
    v_cvt_pk_bf16_f32 v215, v198, v199
    s_mov_b32 exec_lo, 0x22222222
    s_mov_b32 exec_hi, 0x22222222
    v_mov_b32 v200, v204
    v_mov_b32 v201, v205
    v_mov_b32 v202, v206
    v_mov_b32 v203, v207
    s_mov_b32 exec_lo, 0x44444444
    s_mov_b32 exec_hi, 0x44444444
    v_mov_b32 v200, v208
    v_mov_b32 v201, v209
    v_mov_b32 v202, v210
    v_mov_b32 v203, v211
    s_mov_b32 exec_lo, 0x88888888
    s_mov_b32 exec_hi, 0x88888888
    v_mov_b32 v200, v212
    v_mov_b32 v201, v213
    v_mov_b32 v202, v214
    v_mov_b32 v203, v215
    s_mov_b64 exec, -1
    v_lshrrev_b32 v4, 2, v3
    v_and_b32 v5, 3, v3
    v_lshlrev_b32 v6, 15, v4
    v_lshl_add_u32 v6, v2, 6, v6
    v_lshl_add_u32 v6, v5, 4, v6
    s_lshl_b32 s36, s32, 10
    s_lshl_b32 s38, s34, 8
    s_add_u32 s36, s36, s38
    s_add_u32 s36, s36, 2097152
    buffer_store_dwordx4 v[200:203], v6, s[48:51], s36 offen sc1
    buffer_load_dwordx4 v77, s[52:55], s95 offen offset:1024 nt lds
    buffer_load_dwordx4 v78, s[52:55], s95 offen offset:2048 nt lds
    buffer_load_dwordx4 v79, s[52:55], s95 offen offset:3072 nt lds
    s_add_u32 s95, s95, s91
    s_add_u32 s39, s90, s62
    s_mov_b32 m0, s39
    s_add_u32 s62, s62, 4096
    s_and_b32 s62, s62, 0x7fff
    buffer_load_dwordx4 v76, s[52:55], s95 offen offset:0 nt lds
    buffer_load_dwordx4 v77, s[52:55], s95 offen offset:1024 nt lds
    buffer_load_dwordx4 v78, s[52:55], s95 offen offset:2048 nt lds
    s_mov_b32 s76, s28
    s_and_b32 s77, s29, 0xffff
    s_mov_b32 s78, 256
    s_mov_b32 s79, 0x20000
    s_mov_b32 s64, s14
    s_and_b32 s65, s15, 0xffff
    s_mov_b32 s66, 4194304
    s_mov_b32 s67, 0x20000
    s_mov_b32 s68, s24
    s_and_b32 s69, s25, 0xffff
    s_mov_b32 s70, 4194304
    s_mov_b32 s71, 0x20000
    s_mov_b32 s72, s26
    s_and_b32 s73, s27, 0xffff
    s_mov_b32 s74, 8192
    s_mov_b32 s75, 0x20000
    v_mov_b32 v100, 0
    v_mov_b32 v101, 1
    v_lshlrev_b32 v4, 4, v3
    v_lshl_add_u32 v19, v2, 13, v4
    v_lshl_add_u32 v9, v2, 10, v4
    s_waitcnt vmcnt(6)
    s_barrier
    s_cmp_lg_u32 s34, 0
    s_cbranch_scc1 L_nosig_15
    s_mov_b64 exec, 1
    buffer_atomic_add v101, v100, s[76:79], 0 offen offset:0 sc1
    s_mov_b64 exec, -1
L_nosig_15:
    buffer_load_dwordx4 v79, s[52:55], s95 offen offset:3072 nt lds
    s_add_u32 s95, s95, s91
    s_add_u32 s39, s90, s62
    s_mov_b32 m0, s39
    s_add_u32 s62, s62, 4096
    s_and_b32 s62, s62, 0x7fff
    buffer_load_dwordx4 v76, s[52:55], s95 offen offset:0 nt lds
    buffer_load_dwordx4 v77, s[52:55], s95 offen offset:1024 nt lds
    buffer_load_dwordx4 v78, s[52:55], s95 offen offset:2048 nt lds
    buffer_load_dwordx4 v79, s[52:55], s95 offen offset:3072 nt lds
    s_add_u32 s95, s95, s91
    s_add_u32 s39, s90, s62
    s_mov_b32 m0, s39
    s_add_u32 s62, s62, 4096
    s_and_b32 s62, s62, 0x7fff
    buffer_load_dwordx4 v76, s[52:55], s95 offen offset:0 nt lds
    s_lshl_b32 s85, s32, 17
    s_lshl_b32 s38, s34, 8
    s_add_u32 s85, s85, s38
    s_mov_b32 s86, s85
    buffer_load_dword v7, v100, s[76:79], 0 offen offset:0 sc1
    buffer_load_dwordx4 a[0:3], v9, s[64:67], s85 offen nt
    s_add_u32 s85, s85, 4096
    buffer_load_dwordx4 a[4:7], v9, s[64:67], s85 offen nt
    s_add_u32 s85, s85, 4096
    buffer_load_dwordx4 a[8:11], v9, s[64:67], s85 offen nt
    s_add_u32 s85, s85, 4096
    buffer_load_dwordx4 a[12:15], v9, s[64:67], s85 offen nt
    s_add_u32 s85, s85, 4096
    buffer_load_dwordx4 a[16:19], v9, s[64:67], s85 offen nt
    s_add_u32 s85, s85, 4096
    buffer_load_dwordx4 a[20:23], v9, s[64:67], s85 offen nt
    s_add_u32 s85, s85, 4096
    buffer_load_dwordx4 a[24:27], v9, s[64:67], s85 offen nt
    s_add_u32 s85, s85, 4096
    buffer_load_dwordx4 a[28:31], v9, s[64:67], s85 offen nt
    s_add_u32 s85, s85, 4096
    s_waitcnt vmcnt(8)
L_fcheck_16:
    v_cmp_gt_u32 vcc, 32, v7
    s_cbranch_vccz L_fok_17
    s_sleep 4
    buffer_load_dword v7, v100, s[76:79], 0 offen offset:0 sc1
    s_waitcnt vmcnt(0)
    s_sub_u32 s84, s84, 1
    s_cmp_lg_u32 s84, 0
    s_cbranch_scc1 L_fcheck_16
    s_branch L_end
L_fok_17:
    s_lshr_b32 s36, s32, 3
    s_lshl_b32 s36, s36, 15
    s_lshl_b32 s38, s34, 8
    s_add_u32 s36, s36, s38
    s_add_u32 s36, s36, 2097152
    buffer_load_dwordx4 v[20:23], v9, s[48:51], s36 offen sc1
    s_add_u32 s36, s36, 4096
    buffer_load_dwordx4 v[24:27], v9, s[48:51], s36 offen sc1
    s_add_u32 s36, s36, 4096
    buffer_load_dwordx4 v[28:31], v9, s[48:51], s36 offen sc1
    s_add_u32 s36, s36, 4096
    buffer_load_dwordx4 v[32:35], v9, s[48:51], s36 offen sc1
    s_add_u32 s36, s36, 4096
    buffer_load_dwordx4 v[36:39], v9, s[48:51], s36 offen sc1
    s_add_u32 s36, s36, 4096
    buffer_load_dwordx4 v[40:43], v9, s[48:51], s36 offen sc1
    s_add_u32 s36, s36, 4096
    buffer_load_dwordx4 v[44:47], v9, s[48:51], s36 offen sc1
    s_add_u32 s36, s36, 4096
    buffer_load_dwordx4 v[48:51], v9, s[48:51], s36 offen sc1
    buffer_load_dwordx4 a[32:35], v9, s[64:67], s85 offen nt
    s_add_u32 s85, s85, 4096
    buffer_load_dwordx4 a[36:39], v9, s[64:67], s85 offen nt
    s_add_u32 s85, s85, 4096
    buffer_load_dwordx4 a[40:43], v9, s[64:67], s85 offen nt
    s_add_u32 s85, s85, 4096
    buffer_load_dwordx4 a[44:47], v9, s[64:67], s85 offen nt
    s_add_u32 s85, s85, 4096
    buffer_load_dwordx4 a[48:51], v9, s[64:67], s85 offen nt
    s_add_u32 s85, s85, 4096
    buffer_load_dwordx4 a[52:55], v9, s[64:67], s85 offen nt
    s_add_u32 s85, s85, 4096
    buffer_load_dwordx4 a[56:59], v9, s[64:67], s85 offen nt
    s_add_u32 s85, s85, 4096
    buffer_load_dwordx4 a[60:63], v9, s[64:67], s85 offen nt
    s_add_u32 s85, s85, 4096
    v_and_b32 v4, 3, v1
    v_bfe_u32 v5, v1, 2, 2
    v_lshrrev_b32 v6, 5, v1
    v_lshl_add_u32 v7, v4, 2, v5
    v_xor_b32 v7, v7, v6
    v_lshlrev_b32 v7, 4, v7
    v_and_b32 v80, 31, v1
    v_lshl_add_u32 v80, v80, 8, v7
    v_lshl_add_u32 v81, v6, 2, v5
    v_lshlrev_b32 v81, 8, v81
    v_lshl_add_u32 v81, v5, 6, v81
    v_bfe_u32 v7, v1, 4, 1
    v_lshlrev_b32 v7, 1, v7
    v_bfe_u32 v124, v1, 1, 1
    v_add_u32 v7, v7, v124
    v_xor_b32 v7, v7, v6
    v_lshl_add_u32 v81, v7, 4, v81
    v_and_b32 v7, 1, v1
    v_lshl_add_u32 v81, v7, 3, v81
    v_lshl_add_u32 v95, v2, 3, v5
    v_lshlrev_b32 v95, 8, v95
    v_lshl_add_u32 v95, v5, 6, v95
    v_bfe_u32 v4, v1, 4, 1
    v_lshl_add_u32 v4, v4, 1, v124
    v_lshl_add_u32 v95, v4, 4, v95
    v_lshl_add_u32 v95, v7, 3, v95
    v_add_u32 v95, s90, v95
    s_lshl_b32 s37, s34, 13
    s_add_u32 s37, s37, 131072
    v_lshl_add_u32 v94, v1, 4, s37
    s_sub_u32 s38, s37, s90
    v_add_u32 v82, s38, v96
    v_add_u32 v83, s38, v97
    v_add_u32 v84, s38, v98
    v_add_u32 v85, s38, v99
    s_waitcnt vmcnt(8)
    ds_write_b128 v82, v[20:23] offset:0
    ds_write_b128 v83, v[24:27] offset:1024
    ds_write_b128 v84, v[28:31] offset:2048
    ds_write_b128 v85, v[32:35] offset:3072
    ds_write_b128 v82, v[36:39] offset:4096
    ds_write_b128 v83, v[40:43] offset:5120
    ds_write_b128 v84, v[44:47] offset:6144
    ds_write_b128 v85, v[48:51] offset:7168
    v_add_u32 v4, s37, v80
    v_xor_b32 v82, 0, v4
    v_xor_b32 v83, 32, v4
    v_xor_b32 v84, 64, v4
    v_xor_b32 v85, 96, v4
    v_xor_b32 v86, 128, v4
    v_xor_b32 v87, 160, v4
    v_xor_b32 v88, 192, v4
    v_xor_b32 v89, 224, v4
    s_waitcnt lgkmcnt(0)
    ds_read_b128 v[104:107], v82
    ds_read_b128 v[108:111], v83
    ds_read_b128 v[112:115], v84
    ds_read_b128 v[116:119], v85
    ds_read_b128 v[120:123], v86
    ds_read_b128 v[124:127], v87
    ds_read_b128 v[128:131], v88
    ds_read_b128 v[132:135], v89
    v_mov_b32 v136, 0
    v_mov_b32 v137, 0
    v_mov_b32 v138, 0
    v_mov_b32 v139, 0
    v_mov_b32 v140, 0
    v_mov_b32 v141, 0
    v_mov_b32 v142, 0
    v_mov_b32 v143, 0
    v_mov_b32 v144, 0
    v_mov_b32 v145, 0
    v_mov_b32 v146, 0
    v_mov_b32 v147, 0
    v_mov_b32 v148, 0
    v_mov_b32 v149, 0
    v_mov_b32 v150, 0
    v_mov_b32 v151, 0
    v_mov_b32 v152, 0
    v_mov_b32 v153, 0
    v_mov_b32 v154, 0
    v_mov_b32 v155, 0
    v_mov_b32 v156, 0
    v_mov_b32 v157, 0
    v_mov_b32 v158, 0
    v_mov_b32 v159, 0
    v_mov_b32 v160, 0
    v_mov_b32 v161, 0
    v_mov_b32 v162, 0
    v_mov_b32 v163, 0
    v_mov_b32 v164, 0
    v_mov_b32 v165, 0
    v_mov_b32 v166, 0
    v_mov_b32 v167, 0
    v_mov_b32 v168, 0
    v_mov_b32 v169, 0
    v_mov_b32 v170, 0
    v_mov_b32 v171, 0
    v_mov_b32 v172, 0
    v_mov_b32 v173, 0
    v_mov_b32 v174, 0
    v_mov_b32 v175, 0
    v_mov_b32 v176, 0
    v_mov_b32 v177, 0
    v_mov_b32 v178, 0
    v_mov_b32 v179, 0
    v_mov_b32 v180, 0
    v_mov_b32 v181, 0
    v_mov_b32 v182, 0
    v_mov_b32 v183, 0
    v_mov_b32 v184, 0
    v_mov_b32 v185, 0
    v_mov_b32 v186, 0
    v_mov_b32 v187, 0
    v_mov_b32 v188, 0
    v_mov_b32 v189, 0
    v_mov_b32 v190, 0
    v_mov_b32 v191, 0
    v_mov_b32 v192, 0
    v_mov_b32 v193, 0
    v_mov_b32 v194, 0
    v_mov_b32 v195, 0
    v_mov_b32 v196, 0
    v_mov_b32 v197, 0
    v_mov_b32 v198, 0
    v_mov_b32 v199, 0
    v_mov_b32 v90, 0xff7f0000
    v_mov_b32 v91, 0
    s_mov_b32 s93, 0
    v_add_u32 v80, s90, v80
    v_add_u32 v81, s90, v81
    s_waitcnt lgkmcnt(0)
    v_mov_b32 v102, 0
    v_mov_b32 v103, 0
    s_mov_b32 s60, s83
    s_mov_b32 s61, s83
    v_xor_b32 v82, 0, v80
    ds_read_b128 v[216:219], v82
    v_xor_b32 v83, 32, v80
    ds_read_b128 v[220:223], v83
    v_xor_b32 v84, 64, v80
    ds_read_b128 v[224:227], v84
    v_xor_b32 v85, 96, v80
    ds_read_b128 v[228:231], v85
    v_xor_b32 v86, 128, v80
    ds_read_b128 v[232:235], v86
    v_xor_b32 v87, 160, v80
    ds_read_b128 v[236:239], v87
    v_xor_b32 v88, 192, v80
    ds_read_b128 v[240:243], v88
    v_xor_b32 v89, 224, v80
    ds_read_b128 v[244:247], v89
L_att:
    v_add_u32 v4, s94, v81
    s_waitcnt lgkmcnt(0)
    v_mfma_f32_32x32x16_bf16 v[200:215], v[216:219], v[104:107], 0
    v_xor_b32 v82, 0, v4
    ds_read_b64_tr_b16 v[20:21], v82 offset:0
    ds_read_b64_tr_b16 v[24:25], v82 offset:4096
    buffer_load_dwordx4 v77, s[52:55], s95 offen offset:1024 nt lds
    v_mfma_f32_32x32x16_bf16 v[200:215], v[220:223], v[108:111], v[200:215]
    v_xor_b32 v83, 32, v4
    ds_read_b64_tr_b16 v[22:23], v83 offset:2048
    ds_read_b64_tr_b16 v[26:27], v83 offset:6144
    v_mfma_f32_32x32x16_bf16 v[200:215], v[224:227], v[112:115], v[200:215]
    v_xor_b32 v84, 64, v4
    ds_read_b64_tr_b16 v[28:29], v84 offset:0
    ds_read_b64_tr_b16 v[32:33], v84 offset:4096
    v_mfma_f32_32x32x16_bf16 v[200:215], v[228:231], v[116:119], v[200:215]
    v_xor_b32 v85, 96, v4
    ds_read_b64_tr_b16 v[30:31], v85 offset:2048
    ds_read_b64_tr_b16 v[34:35], v85 offset:6144
    v_mfma_f32_32x32x16_bf16 v[200:215], v[232:235], v[120:123], v[200:215]
    v_xor_b32 v86, 128, v4
    ds_read_b64_tr_b16 v[36:37], v86 offset:0
    ds_read_b64_tr_b16 v[40:41], v86 offset:4096
    buffer_load_dwordx4 v78, s[52:55], s95 offen offset:2048 nt lds
    v_mfma_f32_32x32x16_bf16 v[200:215], v[236:239], v[124:127], v[200:215]
    v_xor_b32 v87, 160, v4
    ds_read_b64_tr_b16 v[38:39], v87 offset:2048
    ds_read_b64_tr_b16 v[42:43], v87 offset:6144
    v_mfma_f32_32x32x16_bf16 v[200:215], v[240:243], v[128:131], v[200:215]
    v_xor_b32 v88, 192, v4
    ds_read_b64_tr_b16 v[44:45], v88 offset:0
    ds_read_b64_tr_b16 v[48:49], v88 offset:4096
    v_mfma_f32_32x32x16_bf16 v[200:215], v[244:247], v[132:135], v[200:215]
    v_xor_b32 v89, 224, v4
    ds_read_b64_tr_b16 v[46:47], v89 offset:2048
    ds_read_b64_tr_b16 v[50:51], v89 offset:6144
    buffer_load_dwordx4 v79, s[52:55], s95 offen offset:3072 nt lds
    s_add_u32 s95, s95, s91
    v_xor_b32 v5, 0x2000, v94
    v_xor_b32 v6, 0x4000, v94
    v_xor_b32 v7, 0x6000, v94
    s_cmp_lg_u32 s93, 12
    s_cbranch_scc1 L_noswitch_18
    s_mov_b32 s52, s12
    s_and_b32 s53, s13, 0xffff
    s_mov_b32 s54, 4194304
    s_mov_b32 s55, 0x20000
    s_mov_b32 s95, s89
    s_mov_b32 s91, 131072
    v_mul_u32_u24 v4, 7168, v2
    v_add_u32 v76, v76, v4
    v_add_u32 v77, v77, v4
    v_add_u32 v77, 28672, v77
    v_add_u32 v78, v78, v4
    v_add_u32 v78, 57344, v78
    v_add_u32 v79, v79, v4
    v_add_u32 v79, 86016, v79
L_noswitch_18:
    s_nop 1
    ds_write_b128 v94, v[200:203] offset:0
    ds_write_b128 v94, v[204:207] offset:1024
    ds_write_b128 v94, v[208:211] offset:2048
    ds_write_b128 v94, v[212:215] offset:3072
    s_waitcnt lgkmcnt(0)
    s_barrier
    ds_read_b128 v[60:63], v5 offset:0
    ds_read_b128 v[216:219], v6 offset:0
    ds_read_b128 v[232:235], v7 offset:0
    ds_read_b128 v[64:67], v5 offset:1024
    ds_read_b128 v[220:223], v6 offset:1024
    ds_read_b128 v[236:239], v7 offset:1024
    ds_read_b128 v[68:71], v5 offset:2048
    ds_read_b128 v[224:227], v6 offset:2048
    ds_read_b128 v[240:243], v7 offset:2048
    ds_read_b128 v[72:75], v5 offset:3072
    ds_read_b128 v[228:231], v6 offset:3072
    ds_read_b128 v[244:247], v7 offset:3072
    v_xor_b32 v94, 0x1000, v94
    s_add_u32 s39, s90, s62
    s_mov_b32 m0, s39
    s_add_u32 s62, s62, 4096
    s_and_b32 s62, s62, 0x7fff
    buffer_load_dwordx4 v76, s[52:55], s95 offen offset:0 nt lds
    s_add_u32 s94, s94, 8192
    s_and_b32 s94, s94, 0x7fff
    s_waitcnt lgkmcnt(9)
    v_pk_add_f32 v[200:201], v[200:201], v[60:61]
    v_pk_add_f32 v[216:217], v[216:217], v[232:233]
    v_pk_add_f32 v[202:203], v[202:203], v[62:63]
    v_pk_add_f32 v[218:219], v[218:219], v[234:235]
    v_pk_add_f32 v[200:201], v[200:201], v[216:217]
    v_pk_add_f32 v[202:203], v[202:203], v[218:219]
    s_waitcnt lgkmcnt(6)
    v_pk_add_f32 v[204:205], v[204:205], v[64:65]
    v_pk_add_f32 v[220:221], v[220:221], v[236:237]
    v_pk_add_f32 v[206:207], v[206:207], v[66:67]
    v_pk_add_f32 v[222:223], v[222:223], v[238:239]
    v_pk_add_f32 v[204:205], v[204:205], v[220:221]
    v_pk_add_f32 v[206:207], v[206:207], v[222:223]
    s_waitcnt lgkmcnt(3)
    v_pk_add_f32 v[208:209], v[208:209], v[68:69]
    v_pk_add_f32 v[224:225], v[224:225], v[240:241]
    v_pk_add_f32 v[210:211], v[210:211], v[70:71]
    v_pk_add_f32 v[226:227], v[226:227], v[242:243]
    v_pk_add_f32 v[208:209], v[208:209], v[224:225]
    v_pk_add_f32 v[210:211], v[210:211], v[226:227]
    s_waitcnt lgkmcnt(0)
    v_pk_add_f32 v[212:213], v[212:213], v[72:73]
    v_pk_add_f32 v[228:229], v[228:229], v[244:245]
    v_pk_add_f32 v[214:215], v[214:215], v[74:75]
    v_pk_add_f32 v[230:231], v[230:231], v[246:247]
    v_pk_add_f32 v[212:213], v[212:213], v[228:229]
    v_pk_add_f32 v[214:215], v[214:215], v[230:231]
    buffer_load_dwordx4 v77, s[52:55], s95 offen offset:1024 nt lds
    v_max_f32 v4, v200, v201
    v_max3_f32 v4, v4, v202, v203
    v_max3_f32 v4, v4, v204, v205
    v_max3_f32 v4, v4, v206, v207
    v_max3_f32 v4, v4, v208, v209
    v_max3_f32 v4, v4, v210, v211
    v_max3_f32 v4, v4, v212, v213
    v_max3_f32 v4, v4, v214, v215
    v_mov_b32 v5, v4
    s_nop 1
    v_permlane32_swap_b32 v4, v5
    v_max_f32 v4, v4, v5
    v_mul_f32 v4, s83, v4
    v_max_f32 v4, v4, v90
    v_sub_f32 v92, v90, v4
    v_exp_f32 v92, v92
    v_mov_b32 v90, v4
    v_pk_fma_f32 v[200:201], v[200:201], s[60:61], v[90:91] op_sel_hi:[1,1,0] neg_lo:[0,0,1] neg_hi:[0,0,1]
    v_pk_fma_f32 v[202:203], v[202:203], s[60:61], v[90:91] op_sel_hi:[1,1,0] neg_lo:[0,0,1] neg_hi:[0,0,1]
    v_pk_fma_f32 v[204:205], v[204:205], s[60:61], v[90:91] op_sel_hi:[1,1,0] neg_lo:[0,0,1] neg_hi:[0,0,1]
    v_pk_fma_f32 v[206:207], v[206:207], s[60:61], v[90:91] op_sel_hi:[1,1,0] neg_lo:[0,0,1] neg_hi:[0,0,1]
    v_pk_fma_f32 v[208:209], v[208:209], s[60:61], v[90:91] op_sel_hi:[1,1,0] neg_lo:[0,0,1] neg_hi:[0,0,1]
    v_pk_fma_f32 v[210:211], v[210:211], s[60:61], v[90:91] op_sel_hi:[1,1,0] neg_lo:[0,0,1] neg_hi:[0,0,1]
    v_pk_fma_f32 v[212:213], v[212:213], s[60:61], v[90:91] op_sel_hi:[1,1,0] neg_lo:[0,0,1] neg_hi:[0,0,1]
    v_pk_fma_f32 v[214:215], v[214:215], s[60:61], v[90:91] op_sel_hi:[1,1,0] neg_lo:[0,0,1] neg_hi:[0,0,1]
    v_exp_f32 v200, v200
    v_exp_f32 v201, v201
    v_exp_f32 v202, v202
    v_exp_f32 v203, v203
    v_exp_f32 v204, v204
    buffer_load_dwordx4 v78, s[52:55], s95 offen offset:2048 nt lds
    v_exp_f32 v205, v205
    v_exp_f32 v206, v206
    v_exp_f32 v207, v207
    v_exp_f32 v208, v208
    v_exp_f32 v209, v209
    v_exp_f32 v210, v210
    v_exp_f32 v211, v211
    v_exp_f32 v212, v212
    v_exp_f32 v213, v213
    v_exp_f32 v214, v214
    v_exp_f32 v215, v215
    v_add_u32 v4, s94, v80
    v_pk_mul_f32 v[102:103], v[102:103], v[92:93] op_sel_hi:[1,0]
    v_pk_mul_f32 v[136:137], v[136:137], v[92:93] op_sel_hi:[1,0]
    v_pk_mul_f32 v[138:139], v[138:139], v[92:93] op_sel_hi:[1,0]
    v_pk_mul_f32 v[140:141], v[140:141], v[92:93] op_sel_hi:[1,0]
    v_pk_mul_f32 v[142:143], v[142:143], v[92:93] op_sel_hi:[1,0]
    v_pk_mul_f32 v[144:145], v[144:145], v[92:93] op_sel_hi:[1,0]
    v_pk_mul_f32 v[146:147], v[146:147], v[92:93] op_sel_hi:[1,0]
    v_pk_mul_f32 v[148:149], v[148:149], v[92:93] op_sel_hi:[1,0]
    v_pk_mul_f32 v[150:151], v[150:151], v[92:93] op_sel_hi:[1,0]
    v_pk_mul_f32 v[152:153], v[152:153], v[92:93] op_sel_hi:[1,0]
    v_pk_mul_f32 v[154:155], v[154:155], v[92:93] op_sel_hi:[1,0]
    v_pk_mul_f32 v[156:157], v[156:157], v[92:93] op_sel_hi:[1,0]
    v_pk_mul_f32 v[158:159], v[158:159], v[92:93] op_sel_hi:[1,0]
    v_pk_mul_f32 v[160:161], v[160:161], v[92:93] op_sel_hi:[1,0]
    v_pk_mul_f32 v[162:163], v[162:163], v[92:93] op_sel_hi:[1,0]
    v_pk_mul_f32 v[164:165], v[164:165], v[92:93] op_sel_hi:[1,0]
    v_pk_mul_f32 v[166:167], v[166:167], v[92:93] op_sel_hi:[1,0]
    v_pk_mul_f32 v[168:169], v[168:169], v[92:93] op_sel_hi:[1,0]
    v_pk_mul_f32 v[170:171], v[170:171], v[92:93] op_sel_hi:[1,0]
    v_pk_mul_f32 v[172:173], v[172:173], v[92:93] op_sel_hi:[1,0]
    v_pk_mul_f32 v[174:175], v[174:175], v[92:93] op_sel_hi:[1,0]
    v_pk_mul_f32 v[176:177], v[176:177], v[92:93] op_sel_hi:[1,0]
    buffer_load_dwordx4 v79, s[52:55], s95 offen offset:3072 nt lds
    s_add_u32 s95, s95, s91
    v_pk_mul_f32 v[178:179], v[178:179], v[92:93] op_sel_hi:[1,0]
    v_pk_mul_f32 v[180:181], v[180:181], v[92:93] op_sel_hi:[1,0]
    v_pk_mul_f32 v[182:183], v[182:183], v[92:93] op_sel_hi:[1,0]
    v_pk_mul_f32 v[184:185], v[184:185], v[92:93] op_sel_hi:[1,0]
    v_pk_mul_f32 v[186:187], v[186:187], v[92:93] op_sel_hi:[1,0]
    v_pk_mul_f32 v[188:189], v[188:189], v[92:93] op_sel_hi:[1,0]
    v_pk_mul_f32 v[190:191], v[190:191], v[92:93] op_sel_hi:[1,0]
    v_pk_mul_f32 v[192:193], v[192:193], v[92:93] op_sel_hi:[1,0]
    v_pk_mul_f32 v[194:195], v[194:195], v[92:93] op_sel_hi:[1,0]
    v_pk_mul_f32 v[196:197], v[196:197], v[92:93] op_sel_hi:[1,0]
    v_pk_mul_f32 v[198:199], v[198:199], v[92:93] op_sel_hi:[1,0]
    v_cvt_pk_bf16_f32 v52, v200, v201
    v_pk_add_f32 v[102:103], v[102:103], v[200:201]
    v_cvt_pk_bf16_f32 v53, v202, v203
    v_pk_add_f32 v[102:103], v[102:103], v[202:203]
    v_cvt_pk_bf16_f32 v54, v204, v205
    v_pk_add_f32 v[102:103], v[102:103], v[204:205]
    v_cvt_pk_bf16_f32 v55, v206, v207
    v_pk_add_f32 v[102:103], v[102:103], v[206:207]
    v_cvt_pk_bf16_f32 v56, v208, v209
    v_pk_add_f32 v[102:103], v[102:103], v[208:209]
    v_cvt_pk_bf16_f32 v57, v210, v211
    v_pk_add_f32 v[102:103], v[102:103], v[210:211]
    v_cvt_pk_bf16_f32 v58, v212, v213
    v_pk_add_f32 v[102:103], v[102:103], v[212:213]
    v_cvt_pk_bf16_f32 v59, v214, v215
    v_pk_add_f32 v[102:103], v[102:103], v[214:215]
    s_waitcnt vmcnt(20)
    v_mfma_f32_32x32x16_bf16 v[136:151], v[20:23], v[52:55], v[136:151]
    v_xor_b32 v82, 0, v4
    ds_read_b128 v[216:219], v82
    v_xor_b32 v83, 32, v4
    ds_read_b128 v[220:223], v83
    v_mfma_f32_32x32x16_bf16 v[152:167], v[28:31], v[52:55], v[152:167]
    v_xor_b32 v84, 64, v4
    ds_read_b128 v[224:227], v84
    v_xor_b32 v85, 96, v4
    ds_read_b128 v[228:231], v85
    v_mfma_f32_32x32x16_bf16 v[168:183], v[36:39], v[52:55], v[168:183]
    v_xor_b32 v86, 128, v4
    ds_read_b128 v[232:235], v86
    v_xor_b32 v87, 160, v4
    ds_read_b128 v[236:239], v87
    v_mfma_f32_32x32x16_bf16 v[184:199], v[44:47], v[52:55], v[184:199]
    v_xor_b32 v88, 192, v4
    ds_read_b128 v[240:243], v88
    v_xor_b32 v89, 224, v4
    ds_read_b128 v[244:247], v89
    v_mfma_f32_32x32x16_bf16 v[136:151], v[24:27], v[56:59], v[136:151]
    s_add_u32 s39, s90, s62
    s_mov_b32 m0, s39
    s_add_u32 s62, s62, 4096
    s_and_b32 s62, s62, 0x7fff
    buffer_load_dwordx4 v76, s[52:55], s95 offen offset:0 nt lds
    v_mfma_f32_32x32x16_bf16 v[152:167], v[32:35], v[56:59], v[152:167]
    v_mfma_f32_32x32x16_bf16 v[168:183], v[40:43], v[56:59], v[168:183]
    v_mfma_f32_32x32x16_bf16 v[184:199], v[48:51], v[56:59], v[184:199]
    s_add_u32 s93, s93, 1
    s_cmp_lt_u32 s93, 16
    s_cbranch_scc1 L_att
    buffer_load_dwordx4 v77, s[52:55], s95 offen offset:1024 nt lds
    buffer_load_dwordx4 v78, s[52:55], s95 offen offset:2048 nt lds
    buffer_load_dwordx4 v79, s[52:55], s95 offen offset:3072 nt lds
    s_add_u32 s95, s95, s91
    v_add_f32 v91, v102, v103
    v_mov_b32 v5, v91
    s_nop 1
    v_permlane32_swap_b32 v91, v5
    v_add_f32 v91, v91, v5
    s_lshl_b32 s37, s34, 13
    s_add_u32 s37, s37, 131072
    v_and_b32 v4, 31, v1
    v_lshlrev_b32 v5, 8, v4
    v_lshl_add_u32 v5, v3, 4, v5
    v_lshrrev_b32 v6, 5, v1
    v_lshl_add_u32 v5, v6, 3, v5
    v_add_u32 v5, s37, v5
    s_waitcnt lgkmcnt(0)
    s_barrier
    v_cvt_pk_bf16_f32 v20, v136, v137
    v_cvt_pk_bf16_f32 v21, v138, v139
    v_xor_b32 v82, 0, v5
    ds_write_b64 v82, v[20:21]
    v_cvt_pk_bf16_f32 v22, v140, v141
    v_cvt_pk_bf16_f32 v23, v142, v143
    v_xor_b32 v83, 16, v5
    ds_write_b64 v83, v[22:23]
    v_cvt_pk_bf16_f32 v24, v144, v145
    v_cvt_pk_bf16_f32 v25, v146, v147
    v_xor_b32 v84, 32, v5
    ds_write_b64 v84, v[24:25]
    v_cvt_pk_bf16_f32 v26, v148, v149
    v_cvt_pk_bf16_f32 v27, v150, v151
    v_xor_b32 v85, 48, v5
    ds_write_b64 v85, v[26:27]
    v_cvt_pk_bf16_f32 v28, v152, v153
    v_cvt_pk_bf16_f32 v29, v154, v155
    v_xor_b32 v86, 64, v5
    ds_write_b64 v86, v[28:29]
    v_cvt_pk_bf16_f32 v30, v156, v157
    v_cvt_pk_bf16_f32 v31, v158, v159
    v_xor_b32 v87, 80, v5
    ds_write_b64 v87, v[30:31]
    v_cvt_pk_bf16_f32 v32, v160, v161
    v_cvt_pk_bf16_f32 v33, v162, v163
    v_xor_b32 v88, 96, v5
    ds_write_b64 v88, v[32:33]
    v_cvt_pk_bf16_f32 v34, v164, v165
    v_cvt_pk_bf16_f32 v35, v166, v167
    v_xor_b32 v89, 112, v5
    ds_write_b64 v89, v[34:35]
    v_cvt_pk_bf16_f32 v36, v168, v169
    v_cvt_pk_bf16_f32 v37, v170, v171
    v_xor_b32 v82, 128, v5
    ds_write_b64 v82, v[36:37]
    v_cvt_pk_bf16_f32 v38, v172, v173
    v_cvt_pk_bf16_f32 v39, v174, v175
    v_xor_b32 v83, 144, v5
    ds_write_b64 v83, v[38:39]
    v_cvt_pk_bf16_f32 v40, v176, v177
    v_cvt_pk_bf16_f32 v41, v178, v179
    v_xor_b32 v84, 160, v5
    ds_write_b64 v84, v[40:41]
    v_cvt_pk_bf16_f32 v42, v180, v181
    v_cvt_pk_bf16_f32 v43, v182, v183
    v_xor_b32 v85, 176, v5
    ds_write_b64 v85, v[42:43]
    v_cvt_pk_bf16_f32 v44, v184, v185
    v_cvt_pk_bf16_f32 v45, v186, v187
    v_xor_b32 v86, 192, v5
    ds_write_b64 v86, v[44:45]
    v_cvt_pk_bf16_f32 v46, v188, v189
    v_cvt_pk_bf16_f32 v47, v190, v191
    v_xor_b32 v87, 208, v5
    ds_write_b64 v87, v[46:47]
    v_cvt_pk_bf16_f32 v48, v192, v193
    v_cvt_pk_bf16_f32 v49, v194, v195
    v_xor_b32 v88, 224, v5
    ds_write_b64 v88, v[48:49]
    v_cvt_pk_bf16_f32 v50, v196, v197
    v_cvt_pk_bf16_f32 v51, v198, v199
    v_xor_b32 v89, 240, v5
    ds_write_b64 v89, v[50:51]
    v_xor_b32 v6, v3, v2
    v_lshlrev_b32 v6, 4, v6
    v_lshl_add_u32 v6, v2, 8, v6
    v_add_u32 v6, s37, v6
    v_xor_b32 v82, 0, v6
    v_xor_b32 v83, 64, v6
    v_xor_b32 v84, 128, v6
    v_xor_b32 v85, 192, v6
    v_lshlrev_b32 v7, 4, v3
    v_lshl_add_u32 v7, v2, 15, v7
    s_lshl_b32 s36, s32, 10
    s_lshl_b32 s38, s34, 8
    s_add_u32 s36, s36, s38
    s_add_u32 s36, s36, 4194304
    s_waitcnt lgkmcnt(0)
    ds_read_b128 v[136:139], v82 offset:0
    ds_read_b128 v[140:143], v83 offset:1024
    ds_read_b128 v[144:147], v84 offset:2048
    ds_read_b128 v[148:151], v85 offset:3072
    ds_read_b128 v[152:155], v82 offset:4096
    ds_read_b128 v[156:159], v83 offset:5120
    ds_read_b128 v[160:163], v84 offset:6144
    ds_read_b128 v[164:167], v85 offset:7168
    v_lshlrev_b32 v4, 3, v4
    s_lshl_b32 s37, s32, 8
    s_add_u32 s37, s37, 2621440
    s_lshl_b32 s38, s34, 3
    s_lshl_b32 exec_lo, 0xff, s38
    s_mov_b32 exec_hi, 0
    buffer_store_dwordx2 v[90:91], v4, s[48:51], s37 offen sc1
    s_mov_b64 exec, -1
    s_waitcnt lgkmcnt(7)
    buffer_store_dwordx4 v[136:139], v7, s[48:51], s36 offen sc1
    s_add_u32 s36, s36, 131072
    s_waitcnt lgkmcnt(6)
    buffer_store_dwordx4 v[140:143], v7, s[48:51], s36 offen sc1
    s_add_u32 s36, s36, 131072
    s_waitcnt lgkmcnt(5)
    buffer_store_dwordx4 v[144:147], v7, s[48:51], s36 offen sc1
    s_add_u32 s36, s36, 131072
    s_waitcnt lgkmcnt(4)
    buffer_store_dwordx4 v[148:151], v7, s[48:51], s36 offen sc1
    s_add_u32 s36, s36, 131072
    s_waitcnt lgkmcnt(3)
    buffer_store_dwordx4 v[152:155], v7, s[48:51], s36 offen sc1
    s_add_u32 s36, s36, 131072
    s_waitcnt lgkmcnt(2)
    buffer_store_dwordx4 v[156:159], v7, s[48:51], s36 offen sc1
    s_add_u32 s36, s36, 131072
    s_waitcnt lgkmcnt(1)
    buffer_store_dwordx4 v[160:163], v7, s[48:51], s36 offen sc1
    s_add_u32 s36, s36, 131072
    s_waitcnt lgkmcnt(0)
    buffer_store_dwordx4 v[164:167], v7, s[48:51], s36 offen sc1
    buffer_load_dwordx4 a[64:67], v9, s[64:67], s85 offen nt
    s_add_u32 s85, s85, 4096
    buffer_load_dwordx4 a[68:71], v9, s[64:67], s85 offen nt
    s_add_u32 s85, s85, 4096
    buffer_load_dwordx4 a[72:75], v9, s[64:67], s85 offen nt
    s_add_u32 s85, s85, 4096
    buffer_load_dwordx4 a[76:79], v9, s[64:67], s85 offen nt
    s_add_u32 s85, s85, 4096
    buffer_load_dwordx4 a[80:83], v9, s[64:67], s85 offen nt
    s_add_u32 s85, s85, 4096
    buffer_load_dwordx4 a[84:87], v9, s[64:67], s85 offen nt
    s_add_u32 s85, s85, 4096
    buffer_load_dwordx4 a[88:91], v9, s[64:67], s85 offen nt
    s_add_u32 s85, s85, 4096
    buffer_load_dwordx4 a[92:95], v9, s[64:67], s85 offen nt
    s_add_u32 s85, s85, 4096
    s_waitcnt vmcnt(8)
    s_barrier
    s_cmp_lg_u32 s34, 0
    s_cbranch_scc1 L_nosig_19
    s_mov_b64 exec, 1
    buffer_atomic_add v101, v100, s[76:79], 0 offen offset:128 sc1
    s_mov_b64 exec, -1
L_nosig_19:
    buffer_load_dwordx4 a[96:99], v9, s[64:67], s85 offen nt
    s_add_u32 s85, s85, 4096
    buffer_load_dwordx4 a[100:103], v9, s[64:67], s85 offen nt
    s_add_u32 s85, s85, 4096
    buffer_load_dwordx4 a[104:107], v9, s[64:67], s85 offen nt
    s_add_u32 s85, s85, 4096
    buffer_load_dwordx4 a[108:111], v9, s[64:67], s85 offen nt
    s_add_u32 s85, s85, 4096
    buffer_load_dwordx4 a[112:115], v9, s[64:67], s85 offen nt
    s_add_u32 s85, s85, 4096
    buffer_load_dwordx4 a[116:119], v9, s[64:67], s85 offen nt
    s_add_u32 s85, s85, 4096
    buffer_load_dwordx4 a[120:123], v9, s[64:67], s85 offen nt
    s_add_u32 s85, s85, 4096
    buffer_load_dwordx4 a[124:127], v9, s[64:67], s85 offen nt
    s_add_u32 s85, s85, 4096
    v_xor_b32 v4, 0, v95
    ds_read_b64_tr_b16 v[128:129], v4 offset:0
    ds_read_b64_tr_b16 v[132:133], v4 offset:8192
    ds_read_b64_tr_b16 v[136:137], v4 offset:16384
    ds_read_b64_tr_b16 v[140:141], v4 offset:24576
    v_xor_b32 v5, 16, v95
    ds_read_b64_tr_b16 v[130:131], v5 offset:1024
    ds_read_b64_tr_b16 v[134:135], v5 offset:9216
    ds_read_b64_tr_b16 v[138:139], v5 offset:17408
    ds_read_b64_tr_b16 v[142:143], v5 offset:25600
    v_xor_b32 v4, 32, v95
    ds_read_b64_tr_b16 v[144:145], v4 offset:0
    ds_read_b64_tr_b16 v[148:149], v4 offset:8192
    ds_read_b64_tr_b16 v[152:153], v4 offset:16384
    ds_read_b64_tr_b16 v[156:157], v4 offset:24576
    v_xor_b32 v5, 48, v95
    ds_read_b64_tr_b16 v[146:147], v5 offset:1024
    ds_read_b64_tr_b16 v[150:151], v5 offset:9216
    ds_read_b64_tr_b16 v[154:155], v5 offset:17408
    ds_read_b64_tr_b16 v[158:159], v5 offset:25600
    v_xor_b32 v4, 64, v95
    ds_read_b64_tr_b16 v[160:161], v4 offset:0
    ds_read_b64_tr_b16 v[164:165], v4 offset:8192
    ds_read_b64_tr_b16 v[168:169], v4 offset:16384
    ds_read_b64_tr_b16 v[172:173], v4 offset:24576
    v_xor_b32 v5, 80, v95
    ds_read_b64_tr_b16 v[162:163], v5 offset:1024
    ds_read_b64_tr_b16 v[166:167], v5 offset:9216
    ds_read_b64_tr_b16 v[170:171], v5 offset:17408
    ds_read_b64_tr_b16 v[174:175], v5 offset:25600
    v_xor_b32 v4, 96, v95
    ds_read_b64_tr_b16 v[176:177], v4 offset:0
    ds_read_b64_tr_b16 v[180:181], v4 offset:8192
    ds_read_b64_tr_b16 v[184:185], v4 offset:16384
    ds_read_b64_tr_b16 v[188:189], v4 offset:24576
    v_xor_b32 v5, 112, v95
    ds_read_b64_tr_b16 v[178:179], v5 offset:1024
    ds_read_b64_tr_b16 v[182:183], v5 offset:9216
    ds_read_b64_tr_b16 v[186:187], v5 offset:17408
    ds_read_b64_tr_b16 v[190:191], v5 offset:25600
    v_xor_b32 v4, 128, v95
    ds_read_b64_tr_b16 v[192:193], v4 offset:0
    ds_read_b64_tr_b16 v[196:197], v4 offset:8192
    ds_read_b64_tr_b16 v[200:201], v4 offset:16384
    ds_read_b64_tr_b16 v[204:205], v4 offset:24576
    v_xor_b32 v5, 144, v95
    ds_read_b64_tr_b16 v[194:195], v5 offset:1024
    ds_read_b64_tr_b16 v[198:199], v5 offset:9216
    ds_read_b64_tr_b16 v[202:203], v5 offset:17408
    ds_read_b64_tr_b16 v[206:207], v5 offset:25600
    v_xor_b32 v4, 160, v95
    ds_read_b64_tr_b16 v[208:209], v4 offset:0
    ds_read_b64_tr_b16 v[212:213], v4 offset:8192
    ds_read_b64_tr_b16 v[216:217], v4 offset:16384
    ds_read_b64_tr_b16 v[220:221], v4 offset:24576
    v_xor_b32 v5, 176, v95
    ds_read_b64_tr_b16 v[210:211], v5 offset:1024
    ds_read_b64_tr_b16 v[214:215], v5 offset:9216
    ds_read_b64_tr_b16 v[218:219], v5 offset:17408
    ds_read_b64_tr_b16 v[222:223], v5 offset:25600
    v_xor_b32 v4, 192, v95
    ds_read_b64_tr_b16 v[224:225], v4 offset:0
    ds_read_b64_tr_b16 v[228:229], v4 offset:8192
    ds_read_b64_tr_b16 v[232:233], v4 offset:16384
    ds_read_b64_tr_b16 v[236:237], v4 offset:24576
    v_xor_b32 v5, 208, v95
    ds_read_b64_tr_b16 v[226:227], v5 offset:1024
    ds_read_b64_tr_b16 v[230:231], v5 offset:9216
    ds_read_b64_tr_b16 v[234:235], v5 offset:17408
    ds_read_b64_tr_b16 v[238:239], v5 offset:25600
    v_xor_b32 v4, 224, v95
    ds_read_b64_tr_b16 v[240:241], v4 offset:0
    ds_read_b64_tr_b16 v[244:245], v4 offset:8192
    ds_read_b64_tr_b16 v[248:249], v4 offset:16384
    ds_read_b64_tr_b16 v[252:253], v4 offset:24576
    v_xor_b32 v5, 240, v95
    ds_read_b64_tr_b16 v[242:243], v5 offset:1024
    ds_read_b64_tr_b16 v[246:247], v5 offset:9216
    ds_read_b64_tr_b16 v[250:251], v5 offset:17408
    ds_read_b64_tr_b16 v[254:255], v5 offset:25600
    s_waitcnt lgkmcnt(0)
    buffer_load_dword v7, v100, s[76:79], 0 offen offset:128 sc1
    buffer_load_dwordx4 a[128:131], v9, s[68:71], s86 offen nt
    s_add_u32 s86, s86, 4096
    buffer_load_dwordx4 a[132:135], v9, s[68:71], s86 offen nt
    s_add_u32 s86, s86, 4096
    buffer_load_dwordx4 a[136:139], v9, s[68:71], s86 offen nt
    s_add_u32 s86, s86, 4096
    buffer_load_dwordx4 a[140:143], v9, s[68:71], s86 offen nt
    s_add_u32 s86, s86, 4096
    buffer_load_dwordx4 a[144:147], v9, s[68:71], s86 offen nt
    s_add_u32 s86, s86, 4096
    buffer_load_dwordx4 a[148:151], v9, s[68:71], s86 offen nt
    s_add_u32 s86, s86, 4096
    s_waitcnt vmcnt(6)
L_fcheck_20:
    v_cmp_gt_u32 vcc, 32, v7
    s_cbranch_vccz L_fok_21
    s_sleep 4
    buffer_load_dword v7, v100, s[76:79], 0 offen offset:128 sc1
    s_waitcnt vmcnt(0)
    s_sub_u32 s84, s84, 1
    s_cmp_lg_u32 s84, 0
    s_cbranch_scc1 L_fcheck_20
    s_branch L_end
L_fok_21:
    v_and_b32 v4, 3, v3
    v_lshrrev_b32 v5, 2, v3
    v_lshl_add_u32 v6, v4, 3, v5
    v_lshlrev_b32 v7, 8, v6
    v_lshlrev_b32 v6, 10, v6
    v_lshl_add_u32 v6, v2, 4, v6
    s_lshl_b32 s36, s32, 15
    s_lshl_b32 s38, s34, 8
    s_add_u32 s36, s36, s38
    s_add_u32 s36, s36, 4194304
    s_lshl_b32 s37, s32, 3
    s_add_u32 s37, s37, 2621440
    buffer_load_dwordx2 v[52:53], v7, s[48:51], s37 offen offset:0 sc1
    buffer_load_dwordx2 v[54:55], v7, s[48:51], s37 offen offset:1024 sc1
    buffer_load_dwordx4 v[20:23], v6, s[48:51], s36 offen offset:0 sc1
    buffer_load_dwordx4 v[24:27], v6, s[48:51], s36 offen offset:64 sc1
    buffer_load_dwordx4 v[28:31], v6, s[48:51], s36 offen offset:128 sc1
    buffer_load_dwordx4 v[32:35], v6, s[48:51], s36 offen offset:192 sc1
    s_add_u32 s36, s36, 4096
    buffer_load_dwordx4 v[36:39], v6, s[48:51], s36 offen offset:0 sc1
    buffer_load_dwordx4 v[40:43], v6, s[48:51], s36 offen offset:64 sc1
    buffer_load_dwordx4 v[44:47], v6, s[48:51], s36 offen offset:128 sc1
    buffer_load_dwordx4 v[48:51], v6, s[48:51], s36 offen offset:192 sc1
    s_add_u32 s36, s36, 4096
    buffer_load_dwordx4 a[152:155], v9, s[68:71], s86 offen nt
    s_add_u32 s86, s86, 4096
    buffer_load_dwordx4 a[156:159], v9, s[68:71], s86 offen nt
    s_add_u32 s86, s86, 4096
    ds_write_b128 v96, a[0:3] offset:0
    buffer_load_dwordx4 a[160:163], v9, s[68:71], s86 offen nt
    s_add_u32 s86, s86, 4096
    ds_write_b128 v97, a[4:7] offset:1024
    ds_write_b128 v98, a[8:11] offset:2048
    ds_write_b128 v99, a[12:15] offset:3072
    ds_write_b128 v96, a[16:19] offset:4096
    buffer_load_dwordx4 a[164:167], v9, s[68:71], s86 offen nt
    s_add_u32 s86, s86, 4096
    ds_write_b128 v97, a[20:23] offset:5120
    ds_write_b128 v98, a[24:27] offset:6144
    ds_write_b128 v99, a[28:31] offset:7168
    ds_write_b128 v96, a[32:35] offset:8192
    buffer_load_dwordx4 a[168:171], v9, s[68:71], s86 offen nt
    s_add_u32 s86, s86, 4096
    ds_write_b128 v97, a[36:39] offset:9216
    ds_write_b128 v98, a[40:43] offset:10240
    ds_write_b128 v99, a[44:47] offset:11264
    ds_write_b128 v96, a[48:51] offset:12288
    buffer_load_dwordx4 a[172:175], v9, s[68:71], s86 offen nt
    s_add_u32 s86, s86, 4096
    ds_write_b128 v97, a[52:55] offset:13312
    ds_write_b128 v98, a[56:59] offset:14336
    ds_write_b128 v99, a[60:63] offset:15360
    ds_write_b128 v96, a[64:67] offset:16384
    buffer_load_dwordx4 a[176:179], v9, s[68:71], s86 offen nt
    s_add_u32 s86, s86, 4096
    ds_write_b128 v97, a[68:71] offset:17408
    ds_write_b128 v98, a[72:75] offset:18432
    ds_write_b128 v99, a[76:79] offset:19456
    ds_write_b128 v96, a[80:83] offset:20480
    buffer_load_dwordx4 a[180:183], v9, s[68:71], s86 offen nt
    s_add_u32 s86, s86, 4096
    ds_write_b128 v97, a[84:87] offset:21504
    ds_write_b128 v98, a[88:91] offset:22528
    ds_write_b128 v99, a[92:95] offset:23552
    ds_write_b128 v96, a[96:99] offset:24576
    buffer_load_dwordx4 a[184:187], v9, s[68:71], s86 offen nt
    s_add_u32 s86, s86, 4096
    ds_write_b128 v97, a[100:103] offset:25600
    ds_write_b128 v98, a[104:107] offset:26624
    ds_write_b128 v99, a[108:111] offset:27648
    ds_write_b128 v96, a[112:115] offset:28672
    buffer_load_dwordx4 a[188:191], v9, s[68:71], s86 offen nt
    s_add_u32 s86, s86, 4096
    ds_write_b128 v97, a[116:119] offset:29696
    ds_write_b128 v98, a[120:123] offset:30720
    ds_write_b128 v99, a[124:127] offset:31744
    s_waitcnt lgkmcnt(0)
    v_xor_b32 v4, 0, v95
    ds_read_b64_tr_b16 a[0:1], v4 offset:0
    ds_read_b64_tr_b16 a[4:5], v4 offset:8192
    ds_read_b64_tr_b16 a[8:9], v4 offset:16384
    ds_read_b64_tr_b16 a[12:13], v4 offset:24576
    v_xor_b32 v5, 16, v95
    ds_read_b64_tr_b16 a[2:3], v5 offset:1024
    ds_read_b64_tr_b16 a[6:7], v5 offset:9216
    ds_read_b64_tr_b16 a[10:11], v5 offset:17408
    ds_read_b64_tr_b16 a[14:15], v5 offset:25600
    v_xor_b32 v4, 32, v95
    ds_read_b64_tr_b16 a[16:17], v4 offset:0
    ds_read_b64_tr_b16 a[20:21], v4 offset:8192
    ds_read_b64_tr_b16 a[24:25], v4 offset:16384
    ds_read_b64_tr_b16 a[28:29], v4 offset:24576
    v_xor_b32 v5, 48, v95
    ds_read_b64_tr_b16 a[18:19], v5 offset:1024
    ds_read_b64_tr_b16 a[22:23], v5 offset:9216
    ds_read_b64_tr_b16 a[26:27], v5 offset:17408
    ds_read_b64_tr_b16 a[30:31], v5 offset:25600
    v_xor_b32 v4, 64, v95
    ds_read_b64_tr_b16 a[32:33], v4 offset:0
    ds_read_b64_tr_b16 a[36:37], v4 offset:8192
    ds_read_b64_tr_b16 a[40:41], v4 offset:16384
    ds_read_b64_tr_b16 a[44:45], v4 offset:24576
    v_xor_b32 v5, 80, v95
    ds_read_b64_tr_b16 a[34:35], v5 offset:1024
    ds_read_b64_tr_b16 a[38:39], v5 offset:9216
    ds_read_b64_tr_b16 a[42:43], v5 offset:17408
    ds_read_b64_tr_b16 a[46:47], v5 offset:25600
    v_xor_b32 v4, 96, v95
    ds_read_b64_tr_b16 a[48:49], v4 offset:0
    ds_read_b64_tr_b16 a[52:53], v4 offset:8192
    ds_read_b64_tr_b16 a[56:57], v4 offset:16384
    ds_read_b64_tr_b16 a[60:61], v4 offset:24576
    v_xor_b32 v5, 112, v95
    ds_read_b64_tr_b16 a[50:51], v5 offset:1024
    ds_read_b64_tr_b16 a[54:55], v5 offset:9216
    ds_read_b64_tr_b16 a[58:59], v5 offset:17408
    ds_read_b64_tr_b16 a[62:63], v5 offset:25600
    v_xor_b32 v4, 128, v95
    ds_read_b64_tr_b16 a[64:65], v4 offset:0
    ds_read_b64_tr_b16 a[68:69], v4 offset:8192
    ds_read_b64_tr_b16 a[72:73], v4 offset:16384
    ds_read_b64_tr_b16 a[76:77], v4 offset:24576
    v_xor_b32 v5, 144, v95
    ds_read_b64_tr_b16 a[66:67], v5 offset:1024
    ds_read_b64_tr_b16 a[70:71], v5 offset:9216
    ds_read_b64_tr_b16 a[74:75], v5 offset:17408
    ds_read_b64_tr_b16 a[78:79], v5 offset:25600
    v_xor_b32 v4, 160, v95
    ds_read_b64_tr_b16 a[80:81], v4 offset:0
    ds_read_b64_tr_b16 a[84:85], v4 offset:8192
    ds_read_b64_tr_b16 a[88:89], v4 offset:16384
    ds_read_b64_tr_b16 a[92:93], v4 offset:24576
    v_xor_b32 v5, 176, v95
    ds_read_b64_tr_b16 a[82:83], v5 offset:1024
    ds_read_b64_tr_b16 a[86:87], v5 offset:9216
    ds_read_b64_tr_b16 a[90:91], v5 offset:17408
    ds_read_b64_tr_b16 a[94:95], v5 offset:25600
    v_xor_b32 v4, 192, v95
    ds_read_b64_tr_b16 a[96:97], v4 offset:0
    ds_read_b64_tr_b16 a[100:101], v4 offset:8192
    ds_read_b64_tr_b16 a[104:105], v4 offset:16384
    ds_read_b64_tr_b16 a[108:109], v4 offset:24576
    v_xor_b32 v5, 208, v95
    ds_read_b64_tr_b16 a[98:99], v5 offset:1024
    ds_read_b64_tr_b16 a[102:103], v5 offset:9216
    ds_read_b64_tr_b16 a[106:107], v5 offset:17408
    ds_read_b64_tr_b16 a[110:111], v5 offset:25600
    v_xor_b32 v4, 224, v95
    ds_read_b64_tr_b16 a[112:113], v4 offset:0
    ds_read_b64_tr_b16 a[116:117], v4 offset:8192
    ds_read_b64_tr_b16 a[120:121], v4 offset:16384
    ds_read_b64_tr_b16 a[124:125], v4 offset:24576
    v_xor_b32 v5, 240, v95
    ds_read_b64_tr_b16 a[114:115], v5 offset:1024
    ds_read_b64_tr_b16 a[118:119], v5 offset:9216
    ds_read_b64_tr_b16 a[122:123], v5 offset:17408
    ds_read_b64_tr_b16 a[126:127], v5 offset:25600
    s_waitcnt lgkmcnt(0)
    s_waitcnt vmcnt(18)
    v_max_f32 v4, v52, v54
    s_nop 1
    v_max_f32_dpp v4, v4, v4 row_ror:8 row_mask:0xf bank_mask:0xf
    s_nop 1
    v_max_f32_dpp v4, v4, v4 row_ror:4 row_mask:0xf bank_mask:0xf
    v_sub_f32 v52, v52, v4
    v_sub_f32 v54, v54, v4
    v_exp_f32 v52, v52
    v_exp_f32 v54, v54
    v_mul_f32 v5, v52, v53
    v_fmac_f32 v5, v54, v55
    s_nop 1
    v_add_f32_dpp v5, v5, v5 row_ror:8 row_mask:0xf bank_mask:0xf
    s_nop 1
    v_add_f32_dpp v5, v5, v5 row_ror:4 row_mask:0xf bank_mask:0xf
    v_rcp_f32 v5, v5
    s_nop 0
    v_mul_f32 v52, v52, v5
    v_mul_f32 v54, v54, v5
    s_lshl_b32 s38, s34, 11
    s_add_u32 s38, s38, 131072
    v_and_b32 v4, 3, v3
    v_lshlrev_b32 v4, 9, v4
    v_lshl_add_u32 v4, v2, 4, v4
    v_add_u32 v4, s38, v4
    s_waitcnt vmcnt(10)
    v_mfma_f32_16x16x32_bf16 v[60:63], v[128:131], v[20:23], 0
    v_mfma_f32_16x16x32_bf16 v[64:67], v[128:131], v[36:39], 0
    v_mfma_f32_16x16x32_bf16 v[60:63], v[132:135], v[24:27], v[60:63]
    v_mfma_f32_16x16x32_bf16 v[64:67], v[132:135], v[40:43], v[64:67]
    v_mfma_f32_16x16x32_bf16 v[60:63], v[136:139], v[28:31], v[60:63]
    v_mfma_f32_16x16x32_bf16 v[64:67], v[136:139], v[44:47], v[64:67]
    v_mfma_f32_16x16x32_bf16 v[60:63], v[140:143], v[32:35], v[60:63]
    v_mfma_f32_16x16x32_bf16 v[64:67], v[140:143], v[48:51], v[64:67]
    buffer_load_dwordx4 a[192:195], v9, s[68:71], s86 offen nt
    s_add_u32 s86, s86, 4096
    buffer_load_dwordx4 a[196:199], v9, s[68:71], s86 offen nt
    s_add_u32 s86, s86, 4096
    v_mfma_f32_16x16x32_bf16 v[68:71], v[144:147], v[20:23], 0
    v_mfma_f32_16x16x32_bf16 v[72:75], v[144:147], v[36:39], 0
    v_mfma_f32_16x16x32_bf16 v[68:71], v[148:151], v[24:27], v[68:71]
    v_mfma_f32_16x16x32_bf16 v[72:75], v[148:151], v[40:43], v[72:75]
    v_mfma_f32_16x16x32_bf16 v[68:71], v[152:155], v[28:31], v[68:71]
    v_mfma_f32_16x16x32_bf16 v[72:75], v[152:155], v[44:47], v[72:75]
    v_mfma_f32_16x16x32_bf16 v[68:71], v[156:159], v[32:35], v[68:71]
    v_mfma_f32_16x16x32_bf16 v[72:75], v[156:159], v[48:51], v[72:75]
    buffer_load_dwordx4 a[200:203], v9, s[68:71], s86 offen nt
    s_add_u32 s86, s86, 4096
    buffer_load_dwordx4 a[204:207], v9, s[68:71], s86 offen nt
    s_add_u32 s86, s86, 4096
    v_mul_f32 v104, v60, v52
    v_mul_f32 v105, v61, v52
    v_mul_f32 v106, v62, v52
    v_mul_f32 v107, v63, v52
    v_fmac_f32 v104, v64, v54
    v_fmac_f32 v105, v65, v54
    v_fmac_f32 v106, v66, v54
    v_fmac_f32 v107, v67, v54
    v_add_f32_dpp v104, v104, v104 row_ror:8 row_mask:0xf bank_mask:0xf
    v_add_f32_dpp v105, v105, v105 row_ror:8 row_mask:0xf bank_mask:0xf
    v_add_f32_dpp v106, v106, v106 row_ror:8 row_mask:0xf bank_mask:0xf
    v_add_f32_dpp v107, v107, v107 row_ror:8 row_mask:0xf bank_mask:0xf
    v_add_f32_dpp v104, v104, v104 row_ror:4 row_mask:0xf bank_mask:0xf
    v_add_f32_dpp v105, v105, v105 row_ror:4 row_mask:0xf bank_mask:0xf
    v_add_f32_dpp v106, v106, v106 row_ror:4 row_mask:0xf bank_mask:0xf
    v_add_f32_dpp v107, v107, v107 row_ror:4 row_mask:0xf bank_mask:0xf
    ds_write_b128 v4, v[104:107] offset:0
    v_mfma_f32_16x16x32_bf16 v[60:63], v[160:163], v[20:23], 0
    v_mfma_f32_16x16x32_bf16 v[64:67], v[160:163], v[36:39], 0
    v_mfma_f32_16x16x32_bf16 v[60:63], v[164:167], v[24:27], v[60:63]
    v_mfma_f32_16x16x32_bf16 v[64:67], v[164:167], v[40:43], v[64:67]
    v_mfma_f32_16x16x32_bf16 v[60:63], v[168:171], v[28:31], v[60:63]
    v_mfma_f32_16x16x32_bf16 v[64:67], v[168:171], v[44:47], v[64:67]
    v_mfma_f32_16x16x32_bf16 v[60:63], v[172:175], v[32:35], v[60:63]
    v_mfma_f32_16x16x32_bf16 v[64:67], v[172:175], v[48:51], v[64:67]
    buffer_load_dwordx4 a[208:211], v9, s[68:71], s86 offen nt
    s_add_u32 s86, s86, 4096
    buffer_load_dwordx4 a[212:215], v9, s[68:71], s86 offen nt
    s_add_u32 s86, s86, 4096
    v_mul_f32 v108, v68, v52
    v_mul_f32 v109, v69, v52
    v_mul_f32 v110, v70, v52
    v_mul_f32 v111, v71, v52
    v_fmac_f32 v108, v72, v54
    v_fmac_f32 v109, v73, v54
    v_fmac_f32 v110, v74, v54
    v_fmac_f32 v111, v75, v54
    v_add_f32_dpp v108, v108, v108 row_ror:8 row_mask:0xf bank_mask:0xf
    v_add_f32_dpp v109, v109, v109 row_ror:8 row_mask:0xf bank_mask:0xf
    v_add_f32_dpp v110, v110, v110 row_ror:8 row_mask:0xf bank_mask:0xf
    v_add_f32_dpp v111, v111, v111 row_ror:8 row_mask:0xf bank_mask:0xf
    v_add_f32_dpp v108, v108, v108 row_ror:4 row_mask:0xf bank_mask:0xf
    v_add_f32_dpp v109, v109, v109 row_ror:4 row_mask:0xf bank_mask:0xf
    v_add_f32_dpp v110, v110, v110 row_ror:4 row_mask:0xf bank_mask:0xf
    v_add_f32_dpp v111, v111, v111 row_ror:4 row_mask:0xf bank_mask:0xf
    ds_write_b128 v4, v[108:111] offset:64
    v_mfma_f32_16x16x32_bf16 v[68:71], v[176:179], v[20:23], 0
    v_mfma_f32_16x16x32_bf16 v[72:75], v[176:179], v[36:39], 0
    v_mfma_f32_16x16x32_bf16 v[68:71], v[180:183], v[24:27], v[68:71]
    v_mfma_f32_16x16x32_bf16 v[72:75], v[180:183], v[40:43], v[72:75]
    v_mfma_f32_16x16x32_bf16 v[68:71], v[184:187], v[28:31], v[68:71]
    v_mfma_f32_16x16x32_bf16 v[72:75], v[184:187], v[44:47], v[72:75]
    v_mfma_f32_16x16x32_bf16 v[68:71], v[188:191], v[32:35], v[68:71]
    v_mfma_f32_16x16x32_bf16 v[72:75], v[188:191], v[48:51], v[72:75]
    buffer_load_dwordx4 a[216:219], v9, s[68:71], s86 offen nt
    s_add_u32 s86, s86, 4096
    buffer_load_dwordx4 a[220:223], v9, s[68:71], s86 offen nt
    s_add_u32 s86, s86, 4096
    v_mul_f32 v104, v60, v52
    v_mul_f32 v105, v61, v52
    v_mul_f32 v106, v62, v52
    v_mul_f32 v107, v63, v52
    v_fmac_f32 v104, v64, v54
    v_fmac_f32 v105, v65, v54
    v_fmac_f32 v106, v66, v54
    v_fmac_f32 v107, v67, v54
    v_add_f32_dpp v104, v104, v104 row_ror:8 row_mask:0xf bank_mask:0xf
    v_add_f32_dpp v105, v105, v105 row_ror:8 row_mask:0xf bank_mask:0xf
    v_add_f32_dpp v106, v106, v106 row_ror:8 row_mask:0xf bank_mask:0xf
    v_add_f32_dpp v107, v107, v107 row_ror:8 row_mask:0xf bank_mask:0xf
    v_add_f32_dpp v104, v104, v104 row_ror:4 row_mask:0xf bank_mask:0xf
    v_add_f32_dpp v105, v105, v105 row_ror:4 row_mask:0xf bank_mask:0xf
    v_add_f32_dpp v106, v106, v106 row_ror:4 row_mask:0xf bank_mask:0xf
    v_add_f32_dpp v107, v107, v107 row_ror:4 row_mask:0xf bank_mask:0xf
    ds_write_b128 v4, v[104:107] offset:128
    v_mfma_f32_16x16x32_bf16 v[60:63], v[192:195], v[20:23], 0
    v_mfma_f32_16x16x32_bf16 v[64:67], v[192:195], v[36:39], 0
    v_mfma_f32_16x16x32_bf16 v[60:63], v[196:199], v[24:27], v[60:63]
    v_mfma_f32_16x16x32_bf16 v[64:67], v[196:199], v[40:43], v[64:67]
    v_mfma_f32_16x16x32_bf16 v[60:63], v[200:203], v[28:31], v[60:63]
    v_mfma_f32_16x16x32_bf16 v[64:67], v[200:203], v[44:47], v[64:67]
    v_mfma_f32_16x16x32_bf16 v[60:63], v[204:207], v[32:35], v[60:63]
    v_mfma_f32_16x16x32_bf16 v[64:67], v[204:207], v[48:51], v[64:67]
    buffer_load_dwordx4 a[224:227], v9, s[68:71], s86 offen nt
    s_add_u32 s86, s86, 4096
    buffer_load_dwordx4 a[228:231], v9, s[68:71], s86 offen nt
    s_add_u32 s86, s86, 4096
    v_mul_f32 v108, v68, v52
    v_mul_f32 v109, v69, v52
    v_mul_f32 v110, v70, v52
    v_mul_f32 v111, v71, v52
    v_fmac_f32 v108, v72, v54
    v_fmac_f32 v109, v73, v54
    v_fmac_f32 v110, v74, v54
    v_fmac_f32 v111, v75, v54
    v_add_f32_dpp v108, v108, v108 row_ror:8 row_mask:0xf bank_mask:0xf
    v_add_f32_dpp v109, v109, v109 row_ror:8 row_mask:0xf bank_mask:0xf
    v_add_f32_dpp v110, v110, v110 row_ror:8 row_mask:0xf bank_mask:0xf
    v_add_f32_dpp v111, v111, v111 row_ror:8 row_mask:0xf bank_mask:0xf
    v_add_f32_dpp v108, v108, v108 row_ror:4 row_mask:0xf bank_mask:0xf
    v_add_f32_dpp v109, v109, v109 row_ror:4 row_mask:0xf bank_mask:0xf
    v_add_f32_dpp v110, v110, v110 row_ror:4 row_mask:0xf bank_mask:0xf
    v_add_f32_dpp v111, v111, v111 row_ror:4 row_mask:0xf bank_mask:0xf
    ds_write_b128 v4, v[108:111] offset:192
    v_mfma_f32_16x16x32_bf16 v[68:71], v[208:211], v[20:23], 0
    v_mfma_f32_16x16x32_bf16 v[72:75], v[208:211], v[36:39], 0
    v_mfma_f32_16x16x32_bf16 v[68:71], v[212:215], v[24:27], v[68:71]
    v_mfma_f32_16x16x32_bf16 v[72:75], v[212:215], v[40:43], v[72:75]
    v_mfma_f32_16x16x32_bf16 v[68:71], v[216:219], v[28:31], v[68:71]
    v_mfma_f32_16x16x32_bf16 v[72:75], v[216:219], v[44:47], v[72:75]
    v_mfma_f32_16x16x32_bf16 v[68:71], v[220:223], v[32:35], v[68:71]
    v_mfma_f32_16x16x32_bf16 v[72:75], v[220:223], v[48:51], v[72:75]
    buffer_load_dwordx4 a[232:235], v9, s[68:71], s86 offen nt
    s_add_u32 s86, s86, 4096
    buffer_load_dwordx4 a[236:239], v9, s[68:71], s86 offen nt
    s_add_u32 s86, s86, 4096
    v_mul_f32 v104, v60, v52
    v_mul_f32 v105, v61, v52
    v_mul_f32 v106, v62, v52
    v_mul_f32 v107, v63, v52
    v_fmac_f32 v104, v64, v54
    v_fmac_f32 v105, v65, v54
    v_fmac_f32 v106, v66, v54
    v_fmac_f32 v107, v67, v54
    v_add_f32_dpp v104, v104, v104 row_ror:8 row_mask:0xf bank_mask:0xf
    v_add_f32_dpp v105, v105, v105 row_ror:8 row_mask:0xf bank_mask:0xf
    v_add_f32_dpp v106, v106, v106 row_ror:8 row_mask:0xf bank_mask:0xf
    v_add_f32_dpp v107, v107, v107 row_ror:8 row_mask:0xf bank_mask:0xf
    v_add_f32_dpp v104, v104, v104 row_ror:4 row_mask:0xf bank_mask:0xf
    v_add_f32_dpp v105, v105, v105 row_ror:4 row_mask:0xf bank_mask:0xf
    v_add_f32_dpp v106, v106, v106 row_ror:4 row_mask:0xf bank_mask:0xf
    v_add_f32_dpp v107, v107, v107 row_ror:4 row_mask:0xf bank_mask:0xf
    ds_write_b128 v4, v[104:107] offset:256
    v_mfma_f32_16x16x32_bf16 v[60:63], v[224:227], v[20:23], 0
    v_mfma_f32_16x16x32_bf16 v[64:67], v[224:227], v[36:39], 0
    v_mfma_f32_16x16x32_bf16 v[60:63], v[228:231], v[24:27], v[60:63]
    v_mfma_f32_16x16x32_bf16 v[64:67], v[228:231], v[40:43], v[64:67]
    v_mfma_f32_16x16x32_bf16 v[60:63], v[232:235], v[28:31], v[60:63]
    v_mfma_f32_16x16x32_bf16 v[64:67], v[232:235], v[44:47], v[64:67]
    v_mfma_f32_16x16x32_bf16 v[60:63], v[236:239], v[32:35], v[60:63]
    v_mfma_f32_16x16x32_bf16 v[64:67], v[236:239], v[48:51], v[64:67]
    buffer_load_dwordx4 a[240:243], v9, s[68:71], s86 offen nt
    s_add_u32 s86, s86, 4096
    buffer_load_dwordx4 a[244:247], v9, s[68:71], s86 offen nt
    s_add_u32 s86, s86, 4096
    v_mul_f32 v108, v68, v52
    v_mul_f32 v109, v69, v52
    v_mul_f32 v110, v70, v52
    v_mul_f32 v111, v71, v52
    v_fmac_f32 v108, v72, v54
    v_fmac_f32 v109, v73, v54
    v_fmac_f32 v110, v74, v54
    v_fmac_f32 v111, v75, v54
    v_add_f32_dpp v108, v108, v108 row_ror:8 row_mask:0xf bank_mask:0xf
    v_add_f32_dpp v109, v109, v109 row_ror:8 row_mask:0xf bank_mask:0xf
    v_add_f32_dpp v110, v110, v110 row_ror:8 row_mask:0xf bank_mask:0xf
    v_add_f32_dpp v111, v111, v111 row_ror:8 row_mask:0xf bank_mask:0xf
    v_add_f32_dpp v108, v108, v108 row_ror:4 row_mask:0xf bank_mask:0xf
    v_add_f32_dpp v109, v109, v109 row_ror:4 row_mask:0xf bank_mask:0xf
    v_add_f32_dpp v110, v110, v110 row_ror:4 row_mask:0xf bank_mask:0xf
    v_add_f32_dpp v111, v111, v111 row_ror:4 row_mask:0xf bank_mask:0xf
    ds_write_b128 v4, v[108:111] offset:320
    v_mfma_f32_16x16x32_bf16 v[68:71], v[240:243], v[20:23], 0
    v_mfma_f32_16x16x32_bf16 v[72:75], v[240:243], v[36:39], 0
    v_mfma_f32_16x16x32_bf16 v[68:71], v[244:247], v[24:27], v[68:71]
    v_mfma_f32_16x16x32_bf16 v[72:75], v[244:247], v[40:43], v[72:75]
    v_mfma_f32_16x16x32_bf16 v[68:71], v[248:251], v[28:31], v[68:71]
    v_mfma_f32_16x16x32_bf16 v[72:75], v[248:251], v[44:47], v[72:75]
    v_mfma_f32_16x16x32_bf16 v[68:71], v[252:255], v[32:35], v[68:71]
    v_mfma_f32_16x16x32_bf16 v[72:75], v[252:255], v[48:51], v[72:75]
    buffer_load_dwordx4 a[248:251], v9, s[68:71], s86 offen nt
    s_add_u32 s86, s86, 4096
    buffer_load_dwordx4 a[252:255], v9, s[68:71], s86 offen nt
    s_add_u32 s86, s86, 4096
    v_mul_f32 v104, v60, v52
    v_mul_f32 v105, v61, v52
    v_mul_f32 v106, v62, v52
    v_mul_f32 v107, v63, v52
    v_fmac_f32 v104, v64, v54
    v_fmac_f32 v105, v65, v54
    v_fmac_f32 v106, v66, v54
    v_fmac_f32 v107, v67, v54
    v_add_f32_dpp v104, v104, v104 row_ror:8 row_mask:0xf bank_mask:0xf
    v_add_f32_dpp v105, v105, v105 row_ror:8 row_mask:0xf bank_mask:0xf
    v_add_f32_dpp v106, v106, v106 row_ror:8 row_mask:0xf bank_mask:0xf
    v_add_f32_dpp v107, v107, v107 row_ror:8 row_mask:0xf bank_mask:0xf
    v_add_f32_dpp v104, v104, v104 row_ror:4 row_mask:0xf bank_mask:0xf
    v_add_f32_dpp v105, v105, v105 row_ror:4 row_mask:0xf bank_mask:0xf
    v_add_f32_dpp v106, v106, v106 row_ror:4 row_mask:0xf bank_mask:0xf
    v_add_f32_dpp v107, v107, v107 row_ror:4 row_mask:0xf bank_mask:0xf
    ds_write_b128 v4, v[104:107] offset:384
    v_mul_f32 v108, v68, v52
    v_mul_f32 v109, v69, v52
    v_mul_f32 v110, v70, v52
    v_mul_f32 v111, v71, v52
    v_fmac_f32 v108, v72, v54
    v_fmac_f32 v109, v73, v54
    v_fmac_f32 v110, v74, v54
    v_fmac_f32 v111, v75, v54
    v_add_f32_dpp v108, v108, v108 row_ror:8 row_mask:0xf bank_mask:0xf
    v_add_f32_dpp v109, v109, v109 row_ror:8 row_mask:0xf bank_mask:0xf
    v_add_f32_dpp v110, v110, v110 row_ror:8 row_mask:0xf bank_mask:0xf
    v_add_f32_dpp v111, v111, v111 row_ror:8 row_mask:0xf bank_mask:0xf
    v_add_f32_dpp v108, v108, v108 row_ror:4 row_mask:0xf bank_mask:0xf
    v_add_f32_dpp v109, v109, v109 row_ror:4 row_mask:0xf bank_mask:0xf
    v_add_f32_dpp v110, v110, v110 row_ror:4 row_mask:0xf bank_mask:0xf
    v_add_f32_dpp v111, v111, v111 row_ror:4 row_mask:0xf bank_mask:0xf
    ds_write_b128 v4, v[108:111] offset:448
    s_lshl_b32 s38, s34, 9
    s_add_u32 s38, s38, 131072
    v_and_b32 v5, 31, v1
    v_lshl_add_u32 v6, v5, 4, s38
    s_mul_i32 s38, s34, 320
    s_add_u32 s38, s38, 147456
    v_lshl_add_u32 v7, v5, 3, s38
    s_waitcnt lgkmcnt(0)
    s_barrier
    ds_read_b128 v[20:23], v6 offset:0
    ds_read_b128 v[24:27], v6 offset:2048
    ds_read_b128 v[28:31], v6 offset:4096
    ds_read_b128 v[32:35], v6 offset:6144
    s_waitcnt lgkmcnt(0)
    v_add_f32 v20, v20, v24
    v_add_f32 v28, v28, v32
    v_add_f32 v21, v21, v25
    v_add_f32 v29, v29, v33
    v_add_f32 v22, v22, v26
    v_add_f32 v30, v30, v34
    v_add_f32 v23, v23, v27
    v_add_f32 v31, v31, v35
    v_add_f32 v20, v20, v28
    v_add_f32 v21, v21, v29
    v_add_f32 v22, v22, v30
    v_add_f32 v23, v23, v31
    v_cvt_pk_bf16_f32 v20, v20, v21
    v_cvt_pk_bf16_f32 v21, v22, v23
    ds_write_b64 v7, v[20:21]
    v_mov_b32 v128, 0
    v_mov_b32 v129, 0
    v_mov_b32 v130, 0
    v_mov_b32 v131, 0
    v_mov_b32 v132, 0
    v_mov_b32 v133, 0
    v_mov_b32 v134, 0
    v_mov_b32 v135, 0
    v_mov_b32 v136, 0
    v_mov_b32 v137, 0
    v_mov_b32 v138, 0
    v_mov_b32 v139, 0
    v_mov_b32 v140, 0
    v_mov_b32 v141, 0
    v_mov_b32 v142, 0
    v_mov_b32 v143, 0
    v_mov_b32 v144, 0
    v_mov_b32 v145, 0
    v_mov_b32 v146, 0
    v_mov_b32 v147, 0
    v_mov_b32 v148, 0
    v_mov_b32 v149, 0
    v_mov_b32 v150, 0
    v_mov_b32 v151, 0
    v_mov_b32 v152, 0
    v_mov_b32 v153, 0
    v_mov_b32 v154, 0
    v_mov_b32 v155, 0
    v_mov_b32 v156, 0
    v_mov_b32 v157, 0
    v_mov_b32 v158, 0
    v_mov_b32 v159, 0
    v_mov_b32 v160, 0
    v_mov_b32 v161, 0
    v_mov_b32 v162, 0
    v_mov_b32 v163, 0
    v_mov_b32 v164, 0
    v_mov_b32 v165, 0
    v_mov_b32 v166, 0
    v_mov_b32 v167, 0
    v_mov_b32 v168, 0
    v_mov_b32 v169, 0
    v_mov_b32 v170, 0
    v_mov_b32 v171, 0
    v_mov_b32 v172, 0
    v_mov_b32 v173, 0
    v_mov_b32 v174, 0
    v_mov_b32 v175, 0
    v_mov_b32 v176, 0
    v_mov_b32 v177, 0
    v_mov_b32 v178, 0
    v_mov_b32 v179, 0
    v_mov_b32 v180, 0
    v_mov_b32 v181, 0
    v_mov_b32 v182, 0
    v_mov_b32 v183, 0
    v_mov_b32 v184, 0
    v_mov_b32 v185, 0
    v_mov_b32 v186, 0
    v_mov_b32 v187, 0
    v_mov_b32 v188, 0
    v_mov_b32 v189, 0
    v_mov_b32 v190, 0
    v_mov_b32 v191, 0
    v_and_b32 v4, 3, v3
    v_mul_u32_u24 v100, 320, v4
    v_lshl_add_u32 v100, v2, 4, v100
    v_add_u32 v100, 147456, v100
    s_lshl_b32 s36, s34, 16
    s_lshl_b32 s38, s32, 8
    s_add_u32 s36, s36, s38
    v_add_u32 v101, s36, v19
    s_lshl_b32 s36, s32, 13
    s_lshl_b32 s38, s34, 6
    s_add_u32 s36, s36, s38
    v_lshrrev_b32 v5, 2, v1
    v_lshlrev_b32 v5, 8, v5
    v_lshl_add_u32 v5, v4, 4, v5
    v_add_u32 v102, s36, v5
    s_lshr_b32 s36, s32, 2
    s_lshl_b32 s36, s36, 7
    s_lshl_b32 s38, s34, 5
    s_add_u32 s36, s36, s38
    s_and_b32 s38, s32, 3
    s_lshl_b32 s38, s38, 3
    s_add_u32 s36, s36, s38
    v_lshlrev_b32 v5, 11, v4
    v_lshl_add_u32 v5, v2, 1, v5
    v_add_u32 v103, s36, v5
    v_lshlrev_b32 v4, 7, v2
    v_lshl_add_u32 v4, v3, 4, v4
    v_mov_b32 v5, 512
    v_cmp_gt_u32 vcc, 8, v3
    s_nop 1
    v_cndmask_b32 v92, v5, v4, vcc
    s_mul_i32 s38, s34, 320
    s_add_u32 s38, s38, 147456
    v_lshlrev_b32 v4, 6, v2
    v_lshl_add_u32 v4, v3, 1, v4
    v_add_u32 v93, s38, v4
    s_mov_b32 s92, 0
    s_mov_b32 s96, 3145728
    s_mov_b32 s97, 0
L_final:
    s_waitcnt lgkmcnt(0)
    s_barrier
    s_mov_b32 exec_lo, 0xf000f
    s_mov_b32 exec_hi, 0xf000f
    ds_read_b128 v[128:131], v100 offset:0
    ds_read_b128 v[132:135], v100 offset:64
    ds_read_b128 v[136:139], v100 offset:128
    ds_read_b128 v[140:143], v100 offset:192
    s_mov_b32 exec_lo, 0xf000f0
    s_mov_b32 exec_hi, 0xf000f0
    ds_read_b128 v[144:147], v100 offset:0
    ds_read_b128 v[148:151], v100 offset:64
    ds_read_b128 v[152:155], v100 offset:128
    ds_read_b128 v[156:159], v100 offset:192
    s_mov_b32 exec_lo, 0xf000f00
    s_mov_b32 exec_hi, 0xf000f00
    ds_read_b128 v[160:163], v100 offset:0
    ds_read_b128 v[164:167], v100 offset:64
    ds_read_b128 v[168:171], v100 offset:128
    ds_read_b128 v[172:175], v100 offset:192
    s_mov_b32 exec_lo, 0xf000f000
    s_mov_b32 exec_hi, 0xf000f000
    ds_read_b128 v[176:179], v100 offset:0
    ds_read_b128 v[180:183], v100 offset:64
    ds_read_b128 v[184:187], v100 offset:128
    ds_read_b128 v[188:191], v100 offset:192
    s_mov_b64 exec, -1
    s_add_u32 s36, s96, 32768
    s_waitcnt lgkmcnt(12)
    v_mfma_f32_16x16x32_bf16 v[84:87], a[0:3], v[128:131], 0
    v_mfma_f32_16x16x32_bf16 v[88:91], a[64:67], v[128:131], 0
    v_mfma_f32_16x16x32_bf16 v[84:87], a[4:7], v[132:135], v[84:87]
    v_mfma_f32_16x16x32_bf16 v[88:91], a[68:71], v[132:135], v[88:91]
    v_mfma_f32_16x16x32_bf16 v[84:87], a[8:11], v[136:139], v[84:87]
    v_mfma_f32_16x16x32_bf16 v[88:91], a[72:75], v[136:139], v[88:91]
    v_mfma_f32_16x16x32_bf16 v[84:87], a[12:15], v[140:143], v[84:87]
    v_mfma_f32_16x16x32_bf16 v[88:91], a[76:79], v[140:143], v[88:91]
    s_waitcnt lgkmcnt(8)
    v_mfma_f32_16x16x32_bf16 v[84:87], a[16:19], v[144:147], v[84:87]
    v_mfma_f32_16x16x32_bf16 v[88:91], a[80:83], v[144:147], v[88:91]
    v_mfma_f32_16x16x32_bf16 v[84:87], a[20:23], v[148:151], v[84:87]
    v_mfma_f32_16x16x32_bf16 v[88:91], a[84:87], v[148:151], v[88:91]
    v_mfma_f32_16x16x32_bf16 v[84:87], a[24:27], v[152:155], v[84:87]
    v_mfma_f32_16x16x32_bf16 v[88:91], a[88:91], v[152:155], v[88:91]
    v_mfma_f32_16x16x32_bf16 v[84:87], a[28:31], v[156:159], v[84:87]
    v_mfma_f32_16x16x32_bf16 v[88:91], a[92:95], v[156:159], v[88:91]
    s_waitcnt lgkmcnt(4)
    v_mfma_f32_16x16x32_bf16 v[84:87], a[32:35], v[160:163], v[84:87]
    v_mfma_f32_16x16x32_bf16 v[88:91], a[96:99], v[160:163], v[88:91]
    v_mfma_f32_16x16x32_bf16 v[84:87], a[36:39], v[164:167], v[84:87]
    v_mfma_f32_16x16x32_bf16 v[88:91], a[100:103], v[164:167], v[88:91]
    v_mfma_f32_16x16x32_bf16 v[84:87], a[40:43], v[168:171], v[84:87]
    v_mfma_f32_16x16x32_bf16 v[88:91], a[104:107], v[168:171], v[88:91]
    v_mfma_f32_16x16x32_bf16 v[84:87], a[44:47], v[172:175], v[84:87]
    v_mfma_f32_16x16x32_bf16 v[88:91], a[108:111], v[172:175], v[88:91]
    s_waitcnt lgkmcnt(0)
    v_mfma_f32_16x16x32_bf16 v[84:87], a[48:51], v[176:179], v[84:87]
    v_mfma_f32_16x16x32_bf16 v[88:91], a[112:115], v[176:179], v[88:91]
    v_mfma_f32_16x16x32_bf16 v[84:87], a[52:55], v[180:183], v[84:87]
    v_mfma_f32_16x16x32_bf16 v[88:91], a[116:119], v[180:183], v[88:91]
    v_mfma_f32_16x16x32_bf16 v[84:87], a[56:59], v[184:187], v[84:87]
    v_mfma_f32_16x16x32_bf16 v[88:91], a[120:123], v[184:187], v[88:91]
    v_mfma_f32_16x16x32_bf16 v[84:87], a[60:63], v[188:191], v[84:87]
    v_mfma_f32_16x16x32_bf16 v[88:91], a[124:127], v[188:191], v[88:91]
    s_nop 6
    v_and_or_b32 v84, v84, s82, v8
    v_and_or_b32 v85, v85, s82, v8
    v_and_or_b32 v86, v86, s82, v8
    v_and_or_b32 v87, v87, s82, v8
    buffer_store_dwordx4 v[84:87], v101, s[48:51], s96 offen sc1
    v_and_or_b32 v88, v88, s82, v8
    v_and_or_b32 v89, v89, s82, v8
    v_and_or_b32 v90, v90, s82, v8
    v_and_or_b32 v91, v91, s82, v8
    buffer_store_dwordx4 v[88:91], v101, s[48:51], s36 offen sc1
    s_cmp_eq_u32 s92, 0
    s_cbranch_scc1 L_prepb
L_hop2:
    s_add_u32 s36, s96, 4096
    buffer_load_dwordx4 v[104:107], v102, s[48:51], s96 offen sc1
    buffer_load_dwordx4 v[108:111], v102, s[48:51], s36 offen sc1
    s_waitcnt vmcnt(0)
    v_xor_b32 v104, s35, v104
    v_xor_b32 v105, s35, v105
    v_xor_b32 v106, s35, v106
    v_xor_b32 v107, s35, v107
    v_xor_b32 v108, s35, v108
    v_xor_b32 v109, s35, v109
    v_xor_b32 v110, s35, v110
    v_xor_b32 v111, s35, v111
    v_or_b32 v4, v104, v105
    v_or3_b32 v4, v4, v106, v107
    v_or3_b32 v4, v4, v108, v109
    v_or3_b32 v4, v4, v110, v111
    v_and_b32 v4, 0xff, v4
    v_cmp_ne_u32 vcc, 0, v4
    s_cbranch_vccz L_hop2ok
    s_sub_u32 s84, s84, 1
    s_cmp_lg_u32 s84, 0
    s_cbranch_scc1 L_hop2
    s_branch L_end
L_hop2ok:
    v_add_f32 v104, v104, v108
    v_add_f32 v105, v105, v109
    v_add_f32 v106, v106, v110
    v_add_f32 v107, v107, v111
    v_permlane16_swap_b32 v104, v105
    s_nop 0
    v_permlane16_swap_b32 v106, v107
    v_add_f32 v104, v104, v105
    v_add_f32 v106, v106, v107
    s_nop 1
    v_permlane32_swap_b32 v104, v106
    v_add_f32 v104, v104, v106
    s_nop 1
    v_add_f32_dpp v104, v104, v104 row_ror:8 row_mask:0xf bank_mask:0xf
    s_nop 1
    v_add_f32_dpp v104, v104, v104 row_ror:4 row_mask:0xf bank_mask:0xf
    v_cvt_pk_bf16_f32 v104, v104, v104
    s_mov_b32 exec_lo, 0xf000f
    s_mov_b32 exec_hi, 0xf000f
    buffer_store_short v104, v103, s[72:75], s97 offen
    s_mov_b64 exec, -1
    s_cmp_lg_u32 s92, 0
    s_cbranch_scc1 L_fin
    s_mov_b32 s92, 1
    s_mov_b32 s96, 3670016
    s_mov_b32 s97, 1024
    s_lshl_b32 s85, s32, 2
    s_add_u32 s85, s85, s34
    s_lshl_b32 s85, s85, 13
    s_add_u32 s85, s85, 5242880
    s_add_u32 s86, s85, 4096
    v_min_u32 v5, 6, v1
    v_lshlrev_b32 v5, 10, v5
L_light:
    buffer_load_dword v6, v5, s[48:51], s85 offen offset:512 sc1
    s_waitcnt vmcnt(0)
    v_xor_b32 v6, s35, v6
    v_and_b32 v6, 0xff, v6
    v_cmp_ne_u32 vcc, 0, v6
    s_nop 0
    s_and_b32 s36, vcc_lo, 0x7f
    s_bcnt1_i32_b32 s36, s36
    s_cmp_le_u32 s36, 2
    s_cbranch_scc1 L_hop1
    s_sleep 2
    s_sub_u32 s84, s84, 1
    s_cmp_lg_u32 s84, 0
    s_cbranch_scc1 L_light
    s_branch L_end
L_hop1:
    buffer_load_dwordx4 v[104:107], v92, s[48:51], s85 offen offset:0 sc1
    buffer_load_dwordx4 v[108:111], v92, s[48:51], s85 offen offset:1024 sc1
    buffer_load_dwordx4 v[112:115], v92, s[48:51], s85 offen offset:2048 sc1
    buffer_load_dwordx4 v[116:119], v92, s[48:51], s85 offen offset:3072 sc1
    buffer_load_dwordx4 v[120:123], v92, s[48:51], s86 offen offset:0 sc1
    buffer_load_dwordx4 v[124:127], v92, s[48:51], s86 offen offset:1024 sc1
    buffer_load_dwordx4 v[84:87], v92, s[48:51], s86 offen offset:2048 sc1
    s_waitcnt vmcnt(0)
    v_xor_b32 v104, s35, v104
    v_xor_b32 v105, s35, v105
    v_xor_b32 v106, s35, v106
    v_xor_b32 v107, s35, v107
    v_xor_b32 v108, s35, v108
    v_xor_b32 v109, s35, v109
    v_xor_b32 v110, s35, v110
    v_xor_b32 v111, s35, v111
    v_xor_b32 v112, s35, v112
    v_xor_b32 v113, s35, v113
    v_xor_b32 v114, s35, v114
    v_xor_b32 v115, s35, v115
    v_xor_b32 v116, s35, v116
    v_xor_b32 v117, s35, v117
    v_xor_b32 v118, s35, v118
    v_xor_b32 v119, s35, v119
    v_xor_b32 v120, s35, v120
    v_xor_b32 v121, s35, v121
    v_xor_b32 v122, s35, v122
    v_xor_b32 v123, s35, v123
    v_xor_b32 v124, s35, v124
    v_xor_b32 v125, s35, v125
    v_xor_b32 v126, s35, v126
    v_xor_b32 v127, s35, v127
    v_xor_b32 v84, s35, v84
    v_xor_b32 v85, s35, v85
    v_xor_b32 v86, s35, v86
    v_xor_b32 v87, s35, v87
    v_or_b32 v4, v104, v105
    v_or3_b32 v4, v4, v106, v107
    v_or3_b32 v4, v4, v108, v109
    v_or3_b32 v4, v4, v110, v111
    v_or3_b32 v4, v4, v112, v113
    v_or3_b32 v4, v4, v114, v115
    v_or3_b32 v4, v4, v116, v117
    v_or3_b32 v4, v4, v118, v119
    v_or3_b32 v4, v4, v120, v121
    v_or3_b32 v4, v4, v122, v123
    v_or3_b32 v4, v4, v124, v125
    v_or3_b32 v4, v4, v126, v127
    v_or3_b32 v4, v4, v84, v85
    v_or3_b32 v4, v4, v86, v87
    v_and_b32 v4, 0xff, v4
    v_cmp_ne_u32 vcc, 0, v4
    s_cbranch_vccz L_hop1ok
    s_sub_u32 s84, s84, 1
    s_cmp_lg_u32 s84, 0
    s_cbranch_scc1 L_hop1
    s_branch L_end
L_hop1ok:
    v_max3_f32 v91, v104, v108, v112
    v_max3_f32 v91, v91, v116, v120
    v_max3_f32 v91, v91, v124, v84
    v_sub_f32 v4, v104, v91
    v_sub_f32 v5, v108, v91
    v_sub_f32 v6, v112, v91
    v_sub_f32 v7, v116, v91
    v_sub_f32 v88, v120, v91
    v_sub_f32 v89, v124, v91
    v_sub_f32 v90, v84, v91
    v_exp_f32 v4, v4
    v_exp_f32 v5, v5
    v_exp_f32 v6, v6
    v_exp_f32 v7, v7
    v_exp_f32 v88, v88
    v_exp_f32 v89, v89
    v_exp_f32 v90, v90
    v_mul_f32_dpp v11, v4, v105 row_newbcast:8 row_mask:0xf bank_mask:0xf
    v_mul_f32_dpp v10, v4, v104 row_newbcast:8 row_mask:0xf bank_mask:0xf
    v_mul_f32_dpp v12, v4, v106 row_newbcast:8 row_mask:0xf bank_mask:0xf
    v_mul_f32_dpp v13, v4, v107 row_newbcast:8 row_mask:0xf bank_mask:0xf
    v_fmac_f32_dpp v11, v5, v109 row_newbcast:8 row_mask:0xf bank_mask:0xf
    v_fmac_f32_dpp v10, v5, v108 row_newbcast:8 row_mask:0xf bank_mask:0xf
    v_fmac_f32_dpp v12, v5, v110 row_newbcast:8 row_mask:0xf bank_mask:0xf
    v_fmac_f32_dpp v13, v5, v111 row_newbcast:8 row_mask:0xf bank_mask:0xf
    v_fmac_f32_dpp v11, v6, v113 row_newbcast:8 row_mask:0xf bank_mask:0xf
    v_fmac_f32_dpp v10, v6, v112 row_newbcast:8 row_mask:0xf bank_mask:0xf
    v_fmac_f32_dpp v12, v6, v114 row_newbcast:8 row_mask:0xf bank_mask:0xf
    v_fmac_f32_dpp v13, v6, v115 row_newbcast:8 row_mask:0xf bank_mask:0xf
    v_fmac_f32_dpp v11, v7, v117 row_newbcast:8 row_mask:0xf bank_mask:0xf
    v_fmac_f32_dpp v10, v7, v116 row_newbcast:8 row_mask:0xf bank_mask:0xf
    v_fmac_f32_dpp v12, v7, v118 row_newbcast:8 row_mask:0xf bank_mask:0xf
    v_fmac_f32_dpp v13, v7, v119 row_newbcast:8 row_mask:0xf bank_mask:0xf
    v_fmac_f32_dpp v11, v88, v121 row_newbcast:8 row_mask:0xf bank_mask:0xf
    v_fmac_f32_dpp v10, v88, v120 row_newbcast:8 row_mask:0xf bank_mask:0xf
    v_fmac_f32_dpp v12, v88, v122 row_newbcast:8 row_mask:0xf bank_mask:0xf
    v_fmac_f32_dpp v13, v88, v123 row_newbcast:8 row_mask:0xf bank_mask:0xf
    v_fmac_f32_dpp v11, v89, v125 row_newbcast:8 row_mask:0xf bank_mask:0xf
    v_fmac_f32_dpp v10, v89, v124 row_newbcast:8 row_mask:0xf bank_mask:0xf
    v_fmac_f32_dpp v12, v89, v126 row_newbcast:8 row_mask:0xf bank_mask:0xf
    v_fmac_f32_dpp v13, v89, v127 row_newbcast:8 row_mask:0xf bank_mask:0xf
    v_fmac_f32_dpp v11, v90, v85 row_newbcast:8 row_mask:0xf bank_mask:0xf
    v_fmac_f32_dpp v10, v90, v84 row_newbcast:8 row_mask:0xf bank_mask:0xf
    v_fmac_f32_dpp v12, v90, v86 row_newbcast:8 row_mask:0xf bank_mask:0xf
    v_fmac_f32_dpp v13, v90, v87 row_newbcast:8 row_mask:0xf bank_mask:0xf
    v_rcp_f32 v91, v11
    s_nop 1
    v_mul_f32_dpp v10, v91, v10 row_newbcast:8 row_mask:0xf bank_mask:0xf
    v_mul_f32_dpp v11, v91, v11 row_newbcast:8 row_mask:0xf bank_mask:0xf
    v_mul_f32_dpp v12, v91, v12 row_newbcast:8 row_mask:0xf bank_mask:0xf
    v_mul_f32_dpp v13, v91, v13 row_newbcast:8 row_mask:0xf bank_mask:0xf
    v_cvt_pk_bf16_f32 v10, v10, v11
    v_cvt_pk_bf16_f32 v12, v12, v13
    s_mov_b32 exec_lo, 0xff00ff
    s_mov_b32 exec_hi, 0xff00ff
    ds_write_b16 v93, v10
    ds_write_b16_d16_hi v93, v10 offset:16
    ds_write_b16 v93, v12 offset:32
    ds_write_b16_d16_hi v93, v12 offset:48
    s_mov_b64 exec, -1
    s_branch L_final
L_prepb:
    s_waitcnt vmcnt(0)
    ds_write_b128 v96, a[128:131] offset:0
    ds_write_b128 v97, a[132:135] offset:1024
    ds_write_b128 v98, a[136:139] offset:2048
    ds_write_b128 v99, a[140:143] offset:3072
    ds_write_b128 v96, a[144:147] offset:4096
    ds_write_b128 v97, a[148:151] offset:5120
    ds_write_b128 v98, a[152:155] offset:6144
    ds_write_b128 v99, a[156:159] offset:7168
    ds_write_b128 v96, a[160:163] offset:8192
    ds_write_b128 v97, a[164:167] offset:9216
    ds_write_b128 v98, a[168:171] offset:10240
    ds_write_b128 v99, a[172:175] offset:11264
    ds_write_b128 v96, a[176:179] offset:12288
    ds_write_b128 v97, a[180:183] offset:13312
    ds_write_b128 v98, a[184:187] offset:14336
    ds_write_b128 v99, a[188:191] offset:15360
    ds_write_b128 v96, a[192:195] offset:16384
    ds_write_b128 v97, a[196:199] offset:17408
    ds_write_b128 v98, a[200:203] offset:18432
    ds_write_b128 v99, a[204:207] offset:19456
    ds_write_b128 v96, a[208:211] offset:20480
    ds_write_b128 v97, a[212:215] offset:21504
    ds_write_b128 v98, a[216:219] offset:22528
    ds_write_b128 v99, a[220:223] offset:23552
    ds_write_b128 v96, a[224:227] offset:24576
    ds_write_b128 v97, a[228:231] offset:25600
    ds_write_b128 v98, a[232:235] offset:26624
    ds_write_b128 v99, a[236:239] offset:27648
    ds_write_b128 v96, a[240:243] offset:28672
    ds_write_b128 v97, a[244:247] offset:29696
    ds_write_b128 v98, a[248:251] offset:30720
    ds_write_b128 v99, a[252:255] offset:31744
    s_waitcnt lgkmcnt(0)
    v_xor_b32 v4, 0, v95
    ds_read_b64_tr_b16 a[0:1], v4 offset:0
    ds_read_b64_tr_b16 a[4:5], v4 offset:8192
    ds_read_b64_tr_b16 a[8:9], v4 offset:16384
    ds_read_b64_tr_b16 a[12:13], v4 offset:24576
    v_xor_b32 v5, 16, v95
    ds_read_b64_tr_b16 a[2:3], v5 offset:1024
    ds_read_b64_tr_b16 a[6:7], v5 offset:9216
    ds_read_b64_tr_b16 a[10:11], v5 offset:17408
    ds_read_b64_tr_b16 a[14:15], v5 offset:25600
    v_xor_b32 v4, 32, v95
    ds_read_b64_tr_b16 a[16:17], v4 offset:0
    ds_read_b64_tr_b16 a[20:21], v4 offset:8192
    ds_read_b64_tr_b16 a[24:25], v4 offset:16384
    ds_read_b64_tr_b16 a[28:29], v4 offset:24576
    v_xor_b32 v5, 48, v95
    ds_read_b64_tr_b16 a[18:19], v5 offset:1024
    ds_read_b64_tr_b16 a[22:23], v5 offset:9216
    ds_read_b64_tr_b16 a[26:27], v5 offset:17408
    ds_read_b64_tr_b16 a[30:31], v5 offset:25600
    v_xor_b32 v4, 64, v95
    ds_read_b64_tr_b16 a[32:33], v4 offset:0
    ds_read_b64_tr_b16 a[36:37], v4 offset:8192
    ds_read_b64_tr_b16 a[40:41], v4 offset:16384
    ds_read_b64_tr_b16 a[44:45], v4 offset:24576
    v_xor_b32 v5, 80, v95
    ds_read_b64_tr_b16 a[34:35], v5 offset:1024
    ds_read_b64_tr_b16 a[38:39], v5 offset:9216
    ds_read_b64_tr_b16 a[42:43], v5 offset:17408
    ds_read_b64_tr_b16 a[46:47], v5 offset:25600
    v_xor_b32 v4, 96, v95
    ds_read_b64_tr_b16 a[48:49], v4 offset:0
    ds_read_b64_tr_b16 a[52:53], v4 offset:8192
    ds_read_b64_tr_b16 a[56:57], v4 offset:16384
    ds_read_b64_tr_b16 a[60:61], v4 offset:24576
    v_xor_b32 v5, 112, v95
    ds_read_b64_tr_b16 a[50:51], v5 offset:1024
    ds_read_b64_tr_b16 a[54:55], v5 offset:9216
    ds_read_b64_tr_b16 a[58:59], v5 offset:17408
    ds_read_b64_tr_b16 a[62:63], v5 offset:25600
    v_xor_b32 v4, 128, v95
    ds_read_b64_tr_b16 a[64:65], v4 offset:0
    ds_read_b64_tr_b16 a[68:69], v4 offset:8192
    ds_read_b64_tr_b16 a[72:73], v4 offset:16384
    ds_read_b64_tr_b16 a[76:77], v4 offset:24576
    v_xor_b32 v5, 144, v95
    ds_read_b64_tr_b16 a[66:67], v5 offset:1024
    ds_read_b64_tr_b16 a[70:71], v5 offset:9216
    ds_read_b64_tr_b16 a[74:75], v5 offset:17408
    ds_read_b64_tr_b16 a[78:79], v5 offset:25600
    v_xor_b32 v4, 160, v95
    ds_read_b64_tr_b16 a[80:81], v4 offset:0
    ds_read_b64_tr_b16 a[84:85], v4 offset:8192
    ds_read_b64_tr_b16 a[88:89], v4 offset:16384
    ds_read_b64_tr_b16 a[92:93], v4 offset:24576
    v_xor_b32 v5, 176, v95
    ds_read_b64_tr_b16 a[82:83], v5 offset:1024
    ds_read_b64_tr_b16 a[86:87], v5 offset:9216
    ds_read_b64_tr_b16 a[90:91], v5 offset:17408
    ds_read_b64_tr_b16 a[94:95], v5 offset:25600
    v_xor_b32 v4, 192, v95
    ds_read_b64_tr_b16 a[96:97], v4 offset:0
    ds_read_b64_tr_b16 a[100:101], v4 offset:8192
    ds_read_b64_tr_b16 a[104:105], v4 offset:16384
    ds_read_b64_tr_b16 a[108:109], v4 offset:24576
    v_xor_b32 v5, 208, v95
    ds_read_b64_tr_b16 a[98:99], v5 offset:1024
    ds_read_b64_tr_b16 a[102:103], v5 offset:9216
    ds_read_b64_tr_b16 a[106:107], v5 offset:17408
    ds_read_b64_tr_b16 a[110:111], v5 offset:25600
    v_xor_b32 v4, 224, v95
    ds_read_b64_tr_b16 a[112:113], v4 offset:0
    ds_read_b64_tr_b16 a[116:117], v4 offset:8192
    ds_read_b64_tr_b16 a[120:121], v4 offset:16384
    ds_read_b64_tr_b16 a[124:125], v4 offset:24576
    v_xor_b32 v5, 240, v95
    ds_read_b64_tr_b16 a[114:115], v5 offset:1024
    ds_read_b64_tr_b16 a[118:119], v5 offset:9216
    ds_read_b64_tr_b16 a[122:123], v5 offset:17408
    ds_read_b64_tr_b16 a[126:127], v5 offset:25600
    s_waitcnt lgkmcnt(0)
    s_barrier
    s_branch L_hop2
L_fin:
    s_or_b32 s36, s32, s34
    s_cmp_lg_u32 s36, 0
    s_cbranch_scc1 L_end
    v_mov_b32 v4, 0
    s_mov_b64 exec, 1
    buffer_store_dword v8, v4, s[48:51], 0 offen
L_end:
    s_endpgm
.section .rodata,"a"
.p2align 6
.amdhsa_kernel concat_heads__compressed_kv_cla__mha_block_cached__decode_kernel
  .amdhsa_next_free_vgpr 512
  .amdhsa_next_free_sgpr 102
  .amdhsa_accum_offset 256
  .amdhsa_group_segment_fixed_size 0
  .amdhsa_kernarg_size 112
  .amdhsa_user_sgpr_count 2
  .amdhsa_user_sgpr_kernarg_segment_ptr 1
  .amdhsa_system_sgpr_workgroup_id_x 1
.end_amdhsa_kernel
```

```asm
; @launch grid=(256,1,1) block=(256,1,1) lds=163840
    .amdgcn_target "amdgcn-amd-amdhsa--gfx950"
    .text
    .globl concat_heads__compressed_kv_cla__mha_block_cached__decode_kernel
    .p2align 8
    .type concat_heads__compressed_kv_cla__mha_block_cached__decode_kernel,@function
concat_heads__compressed_kv_cla__mha_block_cached__decode_kernel:
    s_cmp_ge_u32 s2, 256
    s_cbranch_scc1 L_end
    s_load_dwordx16 s[4:19], s[0:1], 0
    s_load_dwordx8 s[20:27], s[0:1], 64
    s_load_dwordx4 s[28:31], s[0:1], 96
    v_lshrrev_b32 v4, 6, v0
    v_and_b32 v1, 63, v0
    v_readfirstlane_b32 s34, v4
    s_lshr_b32 s32, s2, 3
    s_sub_u32 s33, s2, s32
    s_sub_u32 s33, s33, 1
    s_and_b32 s33, s33, 7
    s_getpc_b64 s[36:37]
L_pc:
    s_lshl_b32 s38, s32, 10
    v_lshl_add_u32 v6, v0, 2, s38
    v_mov_b32 v7, s37
    v_add_co_u32 v6, vcc, s36, v6
    s_nop 1
    v_addc_co_u32 v7, vcc, 0, v7, vcc
    global_load_dword v0, v[6:7], off
    v_lshrrev_b32 v2, 4, v1
    v_and_b32 v3, 15, v1
    s_cmp_lt_u32 s33, 2
    s_cbranch_scc1 L_qb
    s_cmp_eq_u32 s33, 2
    s_cbranch_scc1 L_ql
    s_cmp_eq_u32 s33, 7
    s_cbranch_scc1 L_aux
    v_lshrrev_b32 v4, 2, v3
    v_and_b32 v5, 3, v3
    v_lshlrev_b32 v76, 12, v4
    v_lshlrev_b32 v126, 12, v2
    v_lshl_add_u32 v76, v2, 6, v76
    v_lshl_add_u32 v76, v5, 4, v76
    v_lshl_add_u32 v126, v3, 4, v126
    v_xor_b32 v77, 32768, v76
    v_xor_b32 v127, 32768, v126
    s_lshl_b32 s89, s34, 5
    s_add_u32 s89, s89, s32
    s_lshl_b32 s89, s89, 20
    s_mul_i32 s88, s32, 8
    s_mul_i32 s38, s34, 1
    s_add_u32 s88, s88, s38
    s_add_u32 s87, s33, 0
    s_mov_b32 s54, 134217728
    s_mov_b32 s55, 0x20000
    s_mov_b32 s58, 134217728
    s_mov_b32 s59, 0x20000
    s_waitcnt lgkmcnt(0)
    s_mov_b64 s[52:53], s[18:19]
    s_mov_b64 s[56:57], s[20:21]
    s_add_u32 s39, s87, s88
    s_bfe_u32 s37, s39, 0x10000
    s_lshl_b32 s37, s37, 14
    s_add_u32 s85, s37, s89
    s_bfe_u32 s37, s39, 0x30001
    s_lshl_b32 s37, s37, 9
    s_add_u32 s85, s37, s85
    s_bfe_u32 s37, s39, 0x40004
    s_lshl_b32 s37, s37, 16
    s_add_u32 s85, s37, s85
    buffer_load_dwordx4 v[128:131], v76, s[52:55], s85 offen offset:0 nt
    buffer_load_dwordx4 v[132:135], v77, s[52:55], s85 offen offset:256 nt
    buffer_load_dwordx4 v[136:139], v76, s[52:55], s85 offen offset:256 nt
    buffer_load_dwordx4 v[140:143], v77, s[52:55], s85 offen offset:0 nt
    buffer_load_dwordx4 v[144:147], v126, s[56:59], s85 offen offset:0 nt
    buffer_load_dwordx4 v[148:151], v127, s[56:59], s85 offen offset:256 nt
    buffer_load_dwordx4 v[152:155], v126, s[56:59], s85 offen offset:256 nt
    s_load_dword s35, s[30:31], 0
    s_mov_b32 s48, s30
    s_and_b32 s49, s31, 0xffff
    s_mov_b32 s50, 8388608
    s_mov_b32 s51, 0x20000
    s_mov_b32 s82, 0xffffff00
    s_mov_b32 s83, 0x3e0293ee
    s_mov_b32 s84, 1048576
    v_and_b32 v4, 1, v1
    v_lshlrev_b32 v4, 4, v4
    v_mov_b32 v5, 0xffff
    v_lshlrev_b32 v4, v4, v5
    v_bfe_u32 v5, v1, 1, 2
    v_cmp_eq_u32 vcc, 0, v5
    s_nop 1
    v_cndmask_b32 v10, 0, v4, vcc
    v_cmp_eq_u32 vcc, 1, v5
    s_nop 1
    v_cndmask_b32 v11, 0, v4, vcc
    v_cmp_eq_u32 vcc, 2, v5
    s_nop 1
    v_cndmask_b32 v12, 0, v4, vcc
    v_cmp_eq_u32 vcc, 3, v5
    s_nop 1
    v_cndmask_b32 v13, 0, v4, vcc
    v_mov_b32 v120, 0xff7f0000
    v_mov_b32 v121, 0
    v_mov_b32 v18, 1
    v_mov_b32 v116, 0
    v_mov_b32 v117, 0
    v_mov_b32 v118, 0
    v_mov_b32 v119, 0
    s_lshl_b32 s38, s32, 2
    s_add_u32 s38, s38, s34
    s_lshl_b32 s38, s38, 8
    s_add_u32 s38, s38, 65536
    v_mov_b32 v9, s38
    v_and_b32 v5, 3, v3
    v_lshlrev_b32 v78, 7, v2
    v_lshl_add_u32 v78, v5, 5, v78
    v_bfe_u32 v4, v3, 2, 1
    v_lshl_add_u32 v78, v4, 11, v78
    s_lshl_b32 s91, s32, 12
    s_lshl_b32 s38, s34, 9
    s_add_u32 s91, s91, s38
    s_add_u32 s91, s91, 1048576
    v_lshlrev_b32 v4, 7, v2
    v_lshl_add_u32 v4, v3, 4, v4
    v_mov_b32 v5, 512
    v_cmp_gt_u32 vcc, 8, v3
    s_nop 1
    v_cndmask_b32 v79, v5, v4, vcc
    s_waitcnt vmcnt(6)
    buffer_load_dwordx4 v[156:159], v127, s[56:59], s85 offen offset:0 nt
    s_waitcnt vmcnt(6)
    s_add_u32 s87, s87, 7
    s_add_u32 s39, s87, s88
    s_bfe_u32 s37, s39, 0x10000
    s_lshl_b32 s37, s37, 14
    s_add_u32 s85, s37, s89
    s_bfe_u32 s37, s39, 0x30001
    s_lshl_b32 s37, s37, 9
    s_add_u32 s85, s37, s85
    s_bfe_u32 s37, s39, 0x40004
    s_lshl_b32 s37, s37, 16
    s_add_u32 s85, s37, s85
    buffer_load_dwordx4 v[160:163], v76, s[52:55], s85 offen offset:0 nt
    s_waitcnt vmcnt(6)
    buffer_load_dwordx4 v[164:167], v77, s[52:55], s85 offen offset:256 nt
    s_waitcnt vmcnt(6)
    buffer_load_dwordx4 v[168:171], v76, s[52:55], s85 offen offset:256 nt
    s_waitcnt vmcnt(6)
    buffer_load_dwordx4 v[172:175], v77, s[52:55], s85 offen offset:0 nt
    s_waitcnt vmcnt(6)
    buffer_load_dwordx4 v[176:179], v126, s[56:59], s85 offen offset:0 nt
    s_waitcnt vmcnt(6)
    buffer_load_dwordx4 v[180:183], v127, s[56:59], s85 offen offset:256 nt
    s_waitcnt vmcnt(6)
    buffer_load_dwordx4 v[184:187], v126, s[56:59], s85 offen offset:256 nt
    s_waitcnt vmcnt(6)
    buffer_load_dwordx4 v[188:191], v127, s[56:59], s85 offen offset:0 nt
    s_waitcnt vmcnt(6)
    s_add_u32 s87, s87, 7
    s_add_u32 s39, s87, s88
    s_bfe_u32 s37, s39, 0x10000
    s_lshl_b32 s37, s37, 14
    s_add_u32 s85, s37, s89
    s_bfe_u32 s37, s39, 0x30001
    s_lshl_b32 s37, s37, 9
    s_add_u32 s85, s37, s85
    s_bfe_u32 s37, s39, 0x40004
    s_lshl_b32 s37, s37, 16
    s_add_u32 s85, s37, s85
    buffer_load_dwordx4 v[192:195], v76, s[52:55], s85 offen offset:0 nt
    s_waitcnt vmcnt(6)
    buffer_load_dwordx4 v[196:199], v77, s[52:55], s85 offen offset:256 nt
    s_waitcnt vmcnt(6)
    buffer_load_dwordx4 v[200:203], v76, s[52:55], s85 offen offset:256 nt
    s_waitcnt vmcnt(6)
    buffer_load_dwordx4 v[204:207], v77, s[52:55], s85 offen offset:0 nt
    s_waitcnt vmcnt(6)
    buffer_load_dwordx4 v[208:211], v126, s[56:59], s85 offen offset:0 nt
    s_waitcnt vmcnt(6)
    buffer_load_dwordx4 v[212:215], v127, s[56:59], s85 offen offset:256 nt
    s_waitcnt vmcnt(6)
    buffer_load_dwordx4 v[216:219], v126, s[56:59], s85 offen offset:256 nt
    s_waitcnt vmcnt(6)
    buffer_load_dwordx4 v[220:223], v127, s[56:59], s85 offen offset:0 nt
    s_waitcnt vmcnt(6)
    s_add_u32 s87, s87, 7
    s_add_u32 s39, s87, s88
    s_bfe_u32 s37, s39, 0x10000
    s_lshl_b32 s37, s37, 14
    s_add_u32 s85, s37, s89
    s_bfe_u32 s37, s39, 0x30001
    s_lshl_b32 s37, s37, 9
    s_add_u32 s85, s37, s85
    s_bfe_u32 s37, s39, 0x40004
    s_lshl_b32 s37, s37, 16
    s_add_u32 s85, s37, s85
    buffer_load_dwordx4 v[224:227], v76, s[52:55], s85 offen offset:0 nt
    s_waitcnt vmcnt(6)
    buffer_load_dwordx4 v[228:231], v77, s[52:55], s85 offen offset:256 nt
    s_waitcnt vmcnt(6)
    buffer_load_dwordx4 v[232:235], v76, s[52:55], s85 offen offset:256 nt
    s_waitcnt vmcnt(6)
    buffer_load_dwordx4 v[236:239], v77, s[52:55], s85 offen offset:0 nt
    s_waitcnt vmcnt(6)
    buffer_load_dwordx4 v[240:243], v126, s[56:59], s85 offen offset:0 nt
    s_waitcnt vmcnt(6)
    buffer_load_dwordx4 v[244:247], v127, s[56:59], s85 offen offset:256 nt
    s_waitcnt vmcnt(6)
    buffer_load_dwordx4 v[248:251], v126, s[56:59], s85 offen offset:256 nt
    s_waitcnt vmcnt(6)
    buffer_load_dwordx4 v[252:255], v127, s[56:59], s85 offen offset:0 nt
    s_waitcnt vmcnt(6)
    s_add_u32 s87, s87, 7
    s_add_u32 s39, s87, s88
    s_bfe_u32 s37, s39, 0x10000
    s_lshl_b32 s37, s37, 14
    s_add_u32 s85, s37, s89
    s_bfe_u32 s37, s39, 0x30001
    s_lshl_b32 s37, s37, 9
    s_add_u32 s85, s37, s85
    s_bfe_u32 s37, s39, 0x40004
    s_lshl_b32 s37, s37, 16
    s_add_u32 s85, s37, s85
    buffer_load_dwordx4 a[0:3], v76, s[52:55], s85 offen offset:0 nt
    s_waitcnt vmcnt(6)
    buffer_load_dwordx4 a[4:7], v77, s[52:55], s85 offen offset:256 nt
    s_waitcnt vmcnt(6)
    buffer_load_dwordx4 a[8:11], v76, s[52:55], s85 offen offset:256 nt
    s_waitcnt vmcnt(6)
    buffer_load_dwordx4 a[12:15], v77, s[52:55], s85 offen offset:0 nt
    buffer_load_dwordx4 v[68:71], v78, s[48:51], s91 offen offset:0 sc1
    buffer_load_dwordx4 v[72:75], v78, s[48:51], s91 offen offset:16 sc1
    s_waitcnt vmcnt(8)
    buffer_load_dwordx4 a[16:19], v126, s[56:59], s85 offen offset:0 nt
    s_waitcnt vmcnt(8)
    buffer_load_dwordx4 a[20:23], v127, s[56:59], s85 offen offset:256 nt
    s_waitcnt vmcnt(8)
    buffer_load_dwordx4 a[24:27], v126, s[56:59], s85 offen offset:256 nt
    s_waitcnt vmcnt(8)
    buffer_load_dwordx4 a[28:31], v127, s[56:59], s85 offen offset:0 nt
    s_waitcnt vmcnt(8)
    s_add_u32 s87, s87, 7
    s_add_u32 s39, s87, s88
    s_bfe_u32 s37, s39, 0x10000
    s_lshl_b32 s37, s37, 14
    s_add_u32 s85, s37, s89
    s_bfe_u32 s37, s39, 0x30001
    s_lshl_b32 s37, s37, 9
    s_add_u32 s85, s37, s85
    s_bfe_u32 s37, s39, 0x40004
    s_lshl_b32 s37, s37, 16
    s_add_u32 s85, s37, s85
    buffer_load_dwordx4 a[32:35], v76, s[52:55], s85 offen offset:0 nt
    s_waitcnt vmcnt(8)
    buffer_load_dwordx4 a[36:39], v77, s[52:55], s85 offen offset:256 nt
    s_waitcnt lgkmcnt(0)
    s_add_u32 s35, s35, 0x5b
    s_and_b32 s35, s35, 0xff
    v_mov_b32 v8, s35
    s_waitcnt vmcnt(6)
L_qcheck_1:
    v_xor_b32 v68, s35, v68
    v_xor_b32 v69, s35, v69
    v_xor_b32 v70, s35, v70
    v_xor_b32 v71, s35, v71
    v_xor_b32 v72, s35, v72
    v_xor_b32 v73, s35, v73
    v_xor_b32 v74, s35, v74
    v_xor_b32 v75, s35, v75
    v_or_b32 v4, v68, v69
    v_or3_b32 v4, v4, v70, v71
    v_or3_b32 v4, v4, v72, v73
    v_or3_b32 v4, v4, v74, v75
    v_and_b32 v4, 0xff, v4
    v_cmp_ne_u32 vcc, 0, v4
    s_cbranch_vccz L_qok_2
    buffer_load_dwordx4 v[68:71], v78, s[48:51], s91 offen offset:0 sc1
    buffer_load_dwordx4 v[72:75], v78, s[48:51], s91 offen offset:16 sc1
    s_waitcnt vmcnt(0)
    s_sub_u32 s84, s84, 1
    s_cmp_lg_u32 s84, 0
    s_cbranch_scc1 L_qcheck_1
    s_branch L_end
L_qok_2:
    v_add_f32_dpp v68, v68, v68 row_ror:4 row_mask:0xf bank_mask:0xf
    v_add_f32_dpp v69, v69, v69 row_ror:4 row_mask:0xf bank_mask:0xf
    v_add_f32_dpp v70, v70, v70 row_ror:4 row_mask:0xf bank_mask:0xf
    v_add_f32_dpp v71, v71, v71 row_ror:4 row_mask:0xf bank_mask:0xf
    v_add_f32_dpp v72, v72, v72 row_ror:4 row_mask:0xf bank_mask:0xf
    v_add_f32_dpp v73, v73, v73 row_ror:4 row_mask:0xf bank_mask:0xf
    v_add_f32_dpp v74, v74, v74 row_ror:4 row_mask:0xf bank_mask:0xf
    v_add_f32_dpp v75, v75, v75 row_ror:4 row_mask:0xf bank_mask:0xf
    v_cvt_pk_bf16_f32 v68, v68, v69
    v_cvt_pk_bf16_f32 v69, v70, v71
    v_cvt_pk_bf16_f32 v70, v72, v73
    v_cvt_pk_bf16_f32 v71, v74, v75
    s_mov_b32 vcc_lo, 0xf000f
    s_mov_b32 vcc_hi, 0xf000f
    v_cndmask_b32 v80, 0, v68, vcc
    v_cndmask_b32 v81, 0, v69, vcc
    v_cndmask_b32 v82, 0, v70, vcc
    v_cndmask_b32 v83, 0, v71, vcc
    s_mov_b32 vcc_lo, 0xf000f0
    s_mov_b32 vcc_hi, 0xf000f0
    v_cndmask_b32 v84, 0, v68, vcc
    v_cndmask_b32 v85, 0, v69, vcc
    v_cndmask_b32 v86, 0, v70, vcc
    v_cndmask_b32 v87, 0, v71, vcc
    s_mov_b32 vcc_lo, 0xf000f00
    s_mov_b32 vcc_hi, 0xf000f00
    v_cndmask_b32 v88, 0, v68, vcc
    v_cndmask_b32 v89, 0, v69, vcc
    v_cndmask_b32 v90, 0, v70, vcc
    v_cndmask_b32 v91, 0, v71, vcc
    s_mov_b32 vcc_lo, 0xf000f000
    s_mov_b32 vcc_hi, 0xf000f000
    v_cndmask_b32 v92, 0, v68, vcc
    v_cndmask_b32 v93, 0, v69, vcc
    v_cndmask_b32 v94, 0, v70, vcc
    v_cndmask_b32 v95, 0, v71, vcc
    buffer_load_dwordx4 a[40:43], v76, s[52:55], s85 offen offset:256 nt
    v_mfma_f32_16x16x32_bf16 v[112:115], v[128:131], v[80:83], 0
    v_mfma_f32_16x16x32_bf16 v[112:115], v[132:135], v[84:87], v[112:115]
    v_mfma_f32_16x16x32_bf16 v[112:115], v[136:139], v[88:91], v[112:115]
    v_mfma_f32_16x16x32_bf16 v[112:115], v[140:143], v[92:95], v[112:115]
    s_nop 7
    v_mov_b32_dpp v122, v112 quad_perm:[0,0,0,0] row_mask:0xf bank_mask:0xf
    v_mov_b32_dpp v124, v114 quad_perm:[2,2,2,2] row_mask:0xf bank_mask:0xf
    s_nop 0
    v_add_f32_dpp v122, v113, v122 quad_perm:[1,1,1,1] row_mask:0xf bank_mask:0xf
    v_add_f32_dpp v124, v115, v124 quad_perm:[3,3,3,3] row_mask:0xf bank_mask:0xf
    v_add_f32 v122, v122, v124
    v_fma_f32 v123, v122, s83, -v120
    v_cmp_lt_f32 vcc, 0, v123
    s_cbranch_vccz L_nomax_3
    v_mul_f32 v122, s83, v122
    s_nop 1
    v_max_f32_dpp v124, v122, v122 row_ror:4 row_mask:0xf bank_mask:0xf
    s_nop 1
    v_max_f32_dpp v124, v124, v124 row_ror:8 row_mask:0xf bank_mask:0xf
    v_mov_b32 v125, v124
    s_nop 1
    v_permlane16_swap_b32 v124, v125
    v_max_f32 v124, v124, v125
    v_mov_b32 v125, v124
    s_nop 1
    v_permlane32_swap_b32 v124, v125
    v_max_f32 v124, v124, v125
    v_and_b32 v124, s82, v124
    v_max_f32 v124, v124, v120
    v_sub_f32 v125, v120, v124
    v_exp_f32 v125, v125
    v_mov_b32 v120, v124
    v_sub_f32 v123, v122, v124
    v_mul_f32 v121, v121, v125
    v_mul_f32 v116, v116, v125
    v_mul_f32 v117, v117, v125
    v_mul_f32 v118, v118, v125
    v_mul_f32 v119, v119, v125
L_nomax_3:
    v_exp_f32 v123, v123
    s_nop 0
    v_cvt_pk_bf16_f32 v124, v123, v123
    v_add_f32 v121, v121, v123
    s_nop 0
    v_and_b32_dpp v96, v124, v10 row_newbcast:0 row_mask:0xf bank_mask:0xf
    v_and_b32_dpp v97, v124, v11 row_newbcast:0 row_mask:0xf bank_mask:0xf
    v_and_b32_dpp v98, v124, v12 row_newbcast:0 row_mask:0xf bank_mask:0xf
    v_and_b32_dpp v99, v124, v13 row_newbcast:0 row_mask:0xf bank_mask:0xf
    v_and_b32_dpp v100, v124, v10 row_newbcast:4 row_mask:0xf bank_mask:0xf
    v_and_b32_dpp v101, v124, v11 row_newbcast:4 row_mask:0xf bank_mask:0xf
    v_and_b32_dpp v102, v124, v12 row_newbcast:4 row_mask:0xf bank_mask:0xf
    v_and_b32_dpp v103, v124, v13 row_newbcast:4 row_mask:0xf bank_mask:0xf
    v_and_b32_dpp v104, v124, v10 row_newbcast:8 row_mask:0xf bank_mask:0xf
    v_and_b32_dpp v105, v124, v11 row_newbcast:8 row_mask:0xf bank_mask:0xf
    v_and_b32_dpp v106, v124, v12 row_newbcast:8 row_mask:0xf bank_mask:0xf
    v_and_b32_dpp v107, v124, v13 row_newbcast:8 row_mask:0xf bank_mask:0xf
    v_and_b32_dpp v108, v124, v10 row_newbcast:12 row_mask:0xf bank_mask:0xf
    v_and_b32_dpp v109, v124, v11 row_newbcast:12 row_mask:0xf bank_mask:0xf
    v_and_b32_dpp v110, v124, v12 row_newbcast:12 row_mask:0xf bank_mask:0xf
    v_and_b32_dpp v111, v124, v13 row_newbcast:12 row_mask:0xf bank_mask:0xf
    s_waitcnt vmcnt(6)
    buffer_load_dwordx4 a[44:47], v77, s[52:55], s85 offen offset:0 nt
    v_mfma_f32_16x16x32_bf16 v[116:119], v[144:147], v[96:99], v[116:119]
    v_mfma_f32_16x16x32_bf16 v[116:119], v[148:151], v[100:103], v[116:119]
    v_mfma_f32_16x16x32_bf16 v[116:119], v[152:155], v[104:107], v[116:119]
    v_mfma_f32_16x16x32_bf16 v[116:119], v[156:159], v[108:111], v[116:119]
    s_waitcnt vmcnt(6)
    buffer_load_dwordx4 a[48:51], v126, s[56:59], s85 offen offset:0 nt
    v_mfma_f32_16x16x32_bf16 v[112:115], v[160:163], v[80:83], 0
    v_mfma_f32_16x16x32_bf16 v[112:115], v[164:167], v[84:87], v[112:115]
    v_mfma_f32_16x16x32_bf16 v[112:115], v[168:171], v[88:91], v[112:115]
    v_mfma_f32_16x16x32_bf16 v[112:115], v[172:175], v[92:95], v[112:115]
    s_nop 7
    v_mov_b32_dpp v122, v112 quad_perm:[0,0,0,0] row_mask:0xf bank_mask:0xf
    v_mov_b32_dpp v124, v114 quad_perm:[2,2,2,2] row_mask:0xf bank_mask:0xf
    s_nop 0
    v_add_f32_dpp v122, v113, v122 quad_perm:[1,1,1,1] row_mask:0xf bank_mask:0xf
    v_add_f32_dpp v124, v115, v124 quad_perm:[3,3,3,3] row_mask:0xf bank_mask:0xf
    v_add_f32 v122, v122, v124
    v_fma_f32 v123, v122, s83, -v120
    v_cmp_lt_f32 vcc, 0, v123
    s_cbranch_vccz L_nomax_4
    v_mul_f32 v122, s83, v122
    s_nop 1
    v_max_f32_dpp v124, v122, v122 row_ror:4 row_mask:0xf bank_mask:0xf
    s_nop 1
    v_max_f32_dpp v124, v124, v124 row_ror:8 row_mask:0xf bank_mask:0xf
    v_mov_b32 v125, v124
    s_nop 1
    v_permlane16_swap_b32 v124, v125
    v_max_f32 v124, v124, v125
    v_mov_b32 v125, v124
    s_nop 1
    v_permlane32_swap_b32 v124, v125
    v_max_f32 v124, v124, v125
    v_and_b32 v124, s82, v124
    v_max_f32 v124, v124, v120
    v_sub_f32 v125, v120, v124
    v_exp_f32 v125, v125
    v_mov_b32 v120, v124
    v_sub_f32 v123, v122, v124
    v_mul_f32 v121, v121, v125
    v_mul_f32 v116, v116, v125
    v_mul_f32 v117, v117, v125
    v_mul_f32 v118, v118, v125
    v_mul_f32 v119, v119, v125
L_nomax_4:
    v_exp_f32 v123, v123
    s_nop 0
    v_cvt_pk_bf16_f32 v124, v123, v123
    v_add_f32 v121, v121, v123
    s_nop 0
    v_and_b32_dpp v96, v124, v10 row_newbcast:0 row_mask:0xf bank_mask:0xf
    v_and_b32_dpp v97, v124, v11 row_newbcast:0 row_mask:0xf bank_mask:0xf
    v_and_b32_dpp v98, v124, v12 row_newbcast:0 row_mask:0xf bank_mask:0xf
    v_and_b32_dpp v99, v124, v13 row_newbcast:0 row_mask:0xf bank_mask:0xf
    v_and_b32_dpp v100, v124, v10 row_newbcast:4 row_mask:0xf bank_mask:0xf
    v_and_b32_dpp v101, v124, v11 row_newbcast:4 row_mask:0xf bank_mask:0xf
    v_and_b32_dpp v102, v124, v12 row_newbcast:4 row_mask:0xf bank_mask:0xf
    v_and_b32_dpp v103, v124, v13 row_newbcast:4 row_mask:0xf bank_mask:0xf
    v_and_b32_dpp v104, v124, v10 row_newbcast:8 row_mask:0xf bank_mask:0xf
    v_and_b32_dpp v105, v124, v11 row_newbcast:8 row_mask:0xf bank_mask:0xf
    v_and_b32_dpp v106, v124, v12 row_newbcast:8 row_mask:0xf bank_mask:0xf
    v_and_b32_dpp v107, v124, v13 row_newbcast:8 row_mask:0xf bank_mask:0xf
    v_and_b32_dpp v108, v124, v10 row_newbcast:12 row_mask:0xf bank_mask:0xf
    v_and_b32_dpp v109, v124, v11 row_newbcast:12 row_mask:0xf bank_mask:0xf
    v_and_b32_dpp v110, v124, v12 row_newbcast:12 row_mask:0xf bank_mask:0xf
    v_and_b32_dpp v111, v124, v13 row_newbcast:12 row_mask:0xf bank_mask:0xf
    v_mfma_f32_16x16x32_bf16 v[116:119], v[176:179], v[96:99], v[116:119]
    s_waitcnt vmcnt(6)
    buffer_load_dwordx4 a[52:55], v127, s[56:59], s85 offen offset:256 nt
    v_mfma_f32_16x16x32_bf16 v[116:119], v[180:183], v[100:103], v[116:119]
    v_mfma_f32_16x16x32_bf16 v[116:119], v[184:187], v[104:107], v[116:119]
    v_mfma_f32_16x16x32_bf16 v[116:119], v[188:191], v[108:111], v[116:119]
    v_mfma_f32_16x16x32_bf16 v[112:115], v[192:195], v[80:83], 0
    s_waitcnt vmcnt(6)
    buffer_load_dwordx4 a[56:59], v126, s[56:59], s85 offen offset:256 nt
    v_mfma_f32_16x16x32_bf16 v[112:115], v[196:199], v[84:87], v[112:115]
    v_mfma_f32_16x16x32_bf16 v[112:115], v[200:203], v[88:91], v[112:115]
    v_mfma_f32_16x16x32_bf16 v[112:115], v[204:207], v[92:95], v[112:115]
    s_nop 7
    v_mov_b32_dpp v122, v112 quad_perm:[0,0,0,0] row_mask:0xf bank_mask:0xf
    v_mov_b32_dpp v124, v114 quad_perm:[2,2,2,2] row_mask:0xf bank_mask:0xf
    s_nop 0
    v_add_f32_dpp v122, v113, v122 quad_perm:[1,1,1,1] row_mask:0xf bank_mask:0xf
    v_add_f32_dpp v124, v115, v124 quad_perm:[3,3,3,3] row_mask:0xf bank_mask:0xf
    v_add_f32 v122, v122, v124
    v_fma_f32 v123, v122, s83, -v120
    v_cmp_lt_f32 vcc, 0, v123
    s_cbranch_vccz L_nomax_5
    v_mul_f32 v122, s83, v122
    s_nop 1
    v_max_f32_dpp v124, v122, v122 row_ror:4 row_mask:0xf bank_mask:0xf
    s_nop 1
    v_max_f32_dpp v124, v124, v124 row_ror:8 row_mask:0xf bank_mask:0xf
    v_mov_b32 v125, v124
    s_nop 1
    v_permlane16_swap_b32 v124, v125
    v_max_f32 v124, v124, v125
    v_mov_b32 v125, v124
    s_nop 1
    v_permlane32_swap_b32 v124, v125
    v_max_f32 v124, v124, v125
    v_and_b32 v124, s82, v124
    v_max_f32 v124, v124, v120
    v_sub_f32 v125, v120, v124
    v_exp_f32 v125, v125
    v_mov_b32 v120, v124
    v_sub_f32 v123, v122, v124
    v_mul_f32 v121, v121, v125
    v_mul_f32 v116, v116, v125
    v_mul_f32 v117, v117, v125
    v_mul_f32 v118, v118, v125
    v_mul_f32 v119, v119, v125
L_nomax_5:
    v_exp_f32 v123, v123
    s_nop 0
    v_cvt_pk_bf16_f32 v124, v123, v123
    v_add_f32 v121, v121, v123
    s_nop 0
    v_and_b32_dpp v96, v124, v10 row_newbcast:0 row_mask:0xf bank_mask:0xf
    v_and_b32_dpp v97, v124, v11 row_newbcast:0 row_mask:0xf bank_mask:0xf
    v_and_b32_dpp v98, v124, v12 row_newbcast:0 row_mask:0xf bank_mask:0xf
    v_and_b32_dpp v99, v124, v13 row_newbcast:0 row_mask:0xf bank_mask:0xf
    v_and_b32_dpp v100, v124, v10 row_newbcast:4 row_mask:0xf bank_mask:0xf
    v_and_b32_dpp v101, v124, v11 row_newbcast:4 row_mask:0xf bank_mask:0xf
    v_and_b32_dpp v102, v124, v12 row_newbcast:4 row_mask:0xf bank_mask:0xf
    v_and_b32_dpp v103, v124, v13 row_newbcast:4 row_mask:0xf bank_mask:0xf
    v_and_b32_dpp v104, v124, v10 row_newbcast:8 row_mask:0xf bank_mask:0xf
    v_and_b32_dpp v105, v124, v11 row_newbcast:8 row_mask:0xf bank_mask:0xf
    v_and_b32_dpp v106, v124, v12 row_newbcast:8 row_mask:0xf bank_mask:0xf
    v_and_b32_dpp v107, v124, v13 row_newbcast:8 row_mask:0xf bank_mask:0xf
    v_and_b32_dpp v108, v124, v10 row_newbcast:12 row_mask:0xf bank_mask:0xf
    v_and_b32_dpp v109, v124, v11 row_newbcast:12 row_mask:0xf bank_mask:0xf
    v_and_b32_dpp v110, v124, v12 row_newbcast:12 row_mask:0xf bank_mask:0xf
    v_and_b32_dpp v111, v124, v13 row_newbcast:12 row_mask:0xf bank_mask:0xf
    v_mfma_f32_16x16x32_bf16 v[116:119], v[208:211], v[96:99], v[116:119]
    s_waitcnt vmcnt(6)
    buffer_load_dwordx4 a[60:63], v127, s[56:59], s85 offen offset:0 nt
    v_mfma_f32_16x16x32_bf16 v[116:119], v[212:215], v[100:103], v[116:119]
    v_mfma_f32_16x16x32_bf16 v[116:119], v[216:219], v[104:107], v[116:119]
    v_mfma_f32_16x16x32_bf16 v[116:119], v[220:223], v[108:111], v[116:119]
    v_mfma_f32_16x16x32_bf16 v[112:115], v[224:227], v[80:83], 0
    v_mfma_f32_16x16x32_bf16 v[112:115], v[228:231], v[84:87], v[112:115]
    s_waitcnt vmcnt(5)
    s_add_u32 s87, s87, 7
    s_add_u32 s39, s87, s88
    s_bfe_u32 s37, s39, 0x10000
    s_lshl_b32 s37, s37, 14
    s_add_u32 s85, s37, s89
    s_bfe_u32 s37, s39, 0x30001
    s_lshl_b32 s37, s37, 9
    s_add_u32 s85, s37, s85
    s_bfe_u32 s37, s39, 0x40004
    s_lshl_b32 s37, s37, 16
    s_add_u32 s85, s37, s85
    buffer_load_dwordx4 v[128:131], v76, s[52:55], s85 offen offset:0 nt
    v_mfma_f32_16x16x32_bf16 v[112:115], v[232:235], v[88:91], v[112:115]
    v_mfma_f32_16x16x32_bf16 v[112:115], v[236:239], v[92:95], v[112:115]
    s_nop 7
    v_mov_b32_dpp v122, v112 quad_perm:[0,0,0,0] row_mask:0xf bank_mask:0xf
    v_mov_b32_dpp v124, v114 quad_perm:[2,2,2,2] row_mask:0xf bank_mask:0xf
    s_nop 0
    v_add_f32_dpp v122, v113, v122 quad_perm:[1,1,1,1] row_mask:0xf bank_mask:0xf
    v_add_f32_dpp v124, v115, v124 quad_perm:[3,3,3,3] row_mask:0xf bank_mask:0xf
    v_add_f32 v122, v122, v124
    v_fma_f32 v123, v122, s83, -v120
    v_cmp_lt_f32 vcc, 0, v123
    s_cbranch_vccz L_nomax_6
    v_mul_f32 v122, s83, v122
    s_nop 1
    v_max_f32_dpp v124, v122, v122 row_ror:4 row_mask:0xf bank_mask:0xf
    s_nop 1
    v_max_f32_dpp v124, v124, v124 row_ror:8 row_mask:0xf bank_mask:0xf
    v_mov_b32 v125, v124
    s_nop 1
    v_permlane16_swap_b32 v124, v125
    v_max_f32 v124, v124, v125
    v_mov_b32 v125, v124
    s_nop 1
    v_permlane32_swap_b32 v124, v125
    v_max_f32 v124, v124, v125
    v_and_b32 v124, s82, v124
    v_max_f32 v124, v124, v120
    v_sub_f32 v125, v120, v124
    v_exp_f32 v125, v125
    v_mov_b32 v120, v124
    v_sub_f32 v123, v122, v124
    v_mul_f32 v121, v121, v125
    v_mul_f32 v116, v116, v125
    v_mul_f32 v117, v117, v125
    v_mul_f32 v118, v118, v125
    v_mul_f32 v119, v119, v125
L_nomax_6:
    v_exp_f32 v123, v123
    s_nop 0
    v_cvt_pk_bf16_f32 v124, v123, v123
    v_add_f32 v121, v121, v123
    s_nop 0
    v_and_b32_dpp v96, v124, v10 row_newbcast:0 row_mask:0xf bank_mask:0xf
    v_and_b32_dpp v97, v124, v11 row_newbcast:0 row_mask:0xf bank_mask:0xf
    v_and_b32_dpp v98, v124, v12 row_newbcast:0 row_mask:0xf bank_mask:0xf
    v_and_b32_dpp v99, v124, v13 row_newbcast:0 row_mask:0xf bank_mask:0xf
    v_and_b32_dpp v100, v124, v10 row_newbcast:4 row_mask:0xf bank_mask:0xf
    v_and_b32_dpp v101, v124, v11 row_newbcast:4 row_mask:0xf bank_mask:0xf
    v_and_b32_dpp v102, v124, v12 row_newbcast:4 row_mask:0xf bank_mask:0xf
    v_and_b32_dpp v103, v124, v13 row_newbcast:4 row_mask:0xf bank_mask:0xf
    v_and_b32_dpp v104, v124, v10 row_newbcast:8 row_mask:0xf bank_mask:0xf
    v_and_b32_dpp v105, v124, v11 row_newbcast:8 row_mask:0xf bank_mask:0xf
    v_and_b32_dpp v106, v124, v12 row_newbcast:8 row_mask:0xf bank_mask:0xf
    v_and_b32_dpp v107, v124, v13 row_newbcast:8 row_mask:0xf bank_mask:0xf
    v_and_b32_dpp v108, v124, v10 row_newbcast:12 row_mask:0xf bank_mask:0xf
    v_and_b32_dpp v109, v124, v11 row_newbcast:12 row_mask:0xf bank_mask:0xf
    v_and_b32_dpp v110, v124, v12 row_newbcast:12 row_mask:0xf bank_mask:0xf
    v_and_b32_dpp v111, v124, v13 row_newbcast:12 row_mask:0xf bank_mask:0xf
    v_mfma_f32_16x16x32_bf16 v[116:119], v[240:243], v[96:99], v[116:119]
    v_mfma_f32_16x16x32_bf16 v[116:119], v[244:247], v[100:103], v[116:119]
    s_waitcnt vmcnt(5)
    buffer_load_dwordx4 v[132:135], v77, s[52:55], s85 offen offset:256 nt
    v_mfma_f32_16x16x32_bf16 v[116:119], v[248:251], v[104:107], v[116:119]
    v_mfma_f32_16x16x32_bf16 v[116:119], v[252:255], v[108:111], v[116:119]
    v_mfma_f32_16x16x32_bf16 v[112:115], a[0:3], v[80:83], 0
    v_mfma_f32_16x16x32_bf16 v[112:115], a[4:7], v[84:87], v[112:115]
    s_waitcnt vmcnt(5)
    buffer_load_dwordx4 v[136:139], v76, s[52:55], s85 offen offset:256 nt
    v_mfma_f32_16x16x32_bf16 v[112:115], a[8:11], v[88:91], v[112:115]
    v_mfma_f32_16x16x32_bf16 v[112:115], a[12:15], v[92:95], v[112:115]
    s_nop 7
    v_mov_b32_dpp v122, v112 quad_perm:[0,0,0,0] row_mask:0xf bank_mask:0xf
    v_mov_b32_dpp v124, v114 quad_perm:[2,2,2,2] row_mask:0xf bank_mask:0xf
    s_nop 0
    v_add_f32_dpp v122, v113, v122 quad_perm:[1,1,1,1] row_mask:0xf bank_mask:0xf
    v_add_f32_dpp v124, v115, v124 quad_perm:[3,3,3,3] row_mask:0xf bank_mask:0xf
    v_add_f32 v122, v122, v124
    v_fma_f32 v123, v122, s83, -v120
    v_cmp_lt_f32 vcc, 0, v123
    s_cbranch_vccz L_nomax_7
    v_mul_f32 v122, s83, v122
    s_nop 1
    v_max_f32_dpp v124, v122, v122 row_ror:4 row_mask:0xf bank_mask:0xf
    s_nop 1
    v_max_f32_dpp v124, v124, v124 row_ror:8 row_mask:0xf bank_mask:0xf
    v_mov_b32 v125, v124
    s_nop 1
    v_permlane16_swap_b32 v124, v125
    v_max_f32 v124, v124, v125
    v_mov_b32 v125, v124
    s_nop 1
    v_permlane32_swap_b32 v124, v125
    v_max_f32 v124, v124, v125
    v_and_b32 v124, s82, v124
    v_max_f32 v124, v124, v120
    v_sub_f32 v125, v120, v124
    v_exp_f32 v125, v125
    v_mov_b32 v120, v124
    v_sub_f32 v123, v122, v124
    v_mul_f32 v121, v121, v125
    v_mul_f32 v116, v116, v125
    v_mul_f32 v117, v117, v125
    v_mul_f32 v118, v118, v125
    v_mul_f32 v119, v119, v125
L_nomax_7:
    v_exp_f32 v123, v123
    s_nop 0
    v_cvt_pk_bf16_f32 v124, v123, v123
    v_add_f32 v121, v121, v123
    s_nop 0
    v_and_b32_dpp v96, v124, v10 row_newbcast:0 row_mask:0xf bank_mask:0xf
    v_and_b32_dpp v97, v124, v11 row_newbcast:0 row_mask:0xf bank_mask:0xf
    v_and_b32_dpp v98, v124, v12 row_newbcast:0 row_mask:0xf bank_mask:0xf
    v_and_b32_dpp v99, v124, v13 row_newbcast:0 row_mask:0xf bank_mask:0xf
    v_and_b32_dpp v100, v124, v10 row_newbcast:4 row_mask:0xf bank_mask:0xf
    v_and_b32_dpp v101, v124, v11 row_newbcast:4 row_mask:0xf bank_mask:0xf
    v_and_b32_dpp v102, v124, v12 row_newbcast:4 row_mask:0xf bank_mask:0xf
    v_and_b32_dpp v103, v124, v13 row_newbcast:4 row_mask:0xf bank_mask:0xf
    v_and_b32_dpp v104, v124, v10 row_newbcast:8 row_mask:0xf bank_mask:0xf
    v_and_b32_dpp v105, v124, v11 row_newbcast:8 row_mask:0xf bank_mask:0xf
    v_and_b32_dpp v106, v124, v12 row_newbcast:8 row_mask:0xf bank_mask:0xf
    v_and_b32_dpp v107, v124, v13 row_newbcast:8 row_mask:0xf bank_mask:0xf
    v_and_b32_dpp v108, v124, v10 row_newbcast:12 row_mask:0xf bank_mask:0xf
    v_and_b32_dpp v109, v124, v11 row_newbcast:12 row_mask:0xf bank_mask:0xf
    v_and_b32_dpp v110, v124, v12 row_newbcast:12 row_mask:0xf bank_mask:0xf
    v_and_b32_dpp v111, v124, v13 row_newbcast:12 row_mask:0xf bank_mask:0xf
    v_mfma_f32_16x16x32_bf16 v[116:119], a[16:19], v[96:99], v[116:119]
    v_mfma_f32_16x16x32_bf16 v[116:119], a[20:23], v[100:103], v[116:119]
    v_mfma_f32_16x16x32_bf16 v[116:119], a[24:27], v[104:107], v[116:119]
    s_waitcnt vmcnt(5)
    buffer_load_dwordx4 v[140:143], v77, s[52:55], s85 offen offset:0 nt
    v_mfma_f32_16x16x32_bf16 v[116:119], a[28:31], v[108:111], v[116:119]
    v_mfma_f32_16x16x32_bf16 v[112:115], a[32:35], v[80:83], 0
    v_mfma_f32_16x16x32_bf16 v[112:115], a[36:39], v[84:87], v[112:115]
    v_mfma_f32_16x16x32_bf16 v[112:115], a[40:43], v[88:91], v[112:115]
    s_waitcnt vmcnt(5)
    buffer_load_dwordx4 v[144:147], v126, s[56:59], s85 offen offset:0 nt
    v_mfma_f32_16x16x32_bf16 v[112:115], a[44:47], v[92:95], v[112:115]
    s_nop 7
    v_mov_b32_dpp v122, v112 quad_perm:[0,0,0,0] row_mask:0xf bank_mask:0xf
    v_mov_b32_dpp v124, v114 quad_perm:[2,2,2,2] row_mask:0xf bank_mask:0xf
    s_nop 0
    v_add_f32_dpp v122, v113, v122 quad_perm:[1,1,1,1] row_mask:0xf bank_mask:0xf
    v_add_f32_dpp v124, v115, v124 quad_perm:[3,3,3,3] row_mask:0xf bank_mask:0xf
    v_add_f32 v122, v122, v124
    v_fma_f32 v123, v122, s83, -v120
    v_cmp_lt_f32 vcc, 0, v123
    s_cbranch_vccz L_nomax_8
    v_mul_f32 v122, s83, v122
    s_nop 1
    v_max_f32_dpp v124, v122, v122 row_ror:4 row_mask:0xf bank_mask:0xf
    s_nop 1
    v_max_f32_dpp v124, v124, v124 row_ror:8 row_mask:0xf bank_mask:0xf
    v_mov_b32 v125, v124
    s_nop 1
    v_permlane16_swap_b32 v124, v125
    v_max_f32 v124, v124, v125
    v_mov_b32 v125, v124
    s_nop 1
    v_permlane32_swap_b32 v124, v125
    v_max_f32 v124, v124, v125
    v_and_b32 v124, s82, v124
    v_max_f32 v124, v124, v120
    v_sub_f32 v125, v120, v124
    v_exp_f32 v125, v125
    v_mov_b32 v120, v124
    v_sub_f32 v123, v122, v124
    v_mul_f32 v121, v121, v125
    v_mul_f32 v116, v116, v125
    v_mul_f32 v117, v117, v125
    v_mul_f32 v118, v118, v125
    v_mul_f32 v119, v119, v125
L_nomax_8:
    v_exp_f32 v123, v123
    s_nop 0
    v_cvt_pk_bf16_f32 v124, v123, v123
    v_add_f32 v121, v121, v123
    s_nop 0
    v_and_b32_dpp v96, v124, v10 row_newbcast:0 row_mask:0xf bank_mask:0xf
    v_and_b32_dpp v97, v124, v11 row_newbcast:0 row_mask:0xf bank_mask:0xf
    v_and_b32_dpp v98, v124, v12 row_newbcast:0 row_mask:0xf bank_mask:0xf
    v_and_b32_dpp v99, v124, v13 row_newbcast:0 row_mask:0xf bank_mask:0xf
    v_and_b32_dpp v100, v124, v10 row_newbcast:4 row_mask:0xf bank_mask:0xf
    v_and_b32_dpp v101, v124, v11 row_newbcast:4 row_mask:0xf bank_mask:0xf
    v_and_b32_dpp v102, v124, v12 row_newbcast:4 row_mask:0xf bank_mask:0xf
    v_and_b32_dpp v103, v124, v13 row_newbcast:4 row_mask:0xf bank_mask:0xf
    v_and_b32_dpp v104, v124, v10 row_newbcast:8 row_mask:0xf bank_mask:0xf
    v_and_b32_dpp v105, v124, v11 row_newbcast:8 row_mask:0xf bank_mask:0xf
    v_and_b32_dpp v106, v124, v12 row_newbcast:8 row_mask:0xf bank_mask:0xf
    v_and_b32_dpp v107, v124, v13 row_newbcast:8 row_mask:0xf bank_mask:0xf
    v_and_b32_dpp v108, v124, v10 row_newbcast:12 row_mask:0xf bank_mask:0xf
    v_and_b32_dpp v109, v124, v11 row_newbcast:12 row_mask:0xf bank_mask:0xf
    v_and_b32_dpp v110, v124, v12 row_newbcast:12 row_mask:0xf bank_mask:0xf
    v_and_b32_dpp v111, v124, v13 row_newbcast:12 row_mask:0xf bank_mask:0xf
    v_mfma_f32_16x16x32_bf16 v[116:119], a[48:51], v[96:99], v[116:119]
    v_mfma_f32_16x16x32_bf16 v[116:119], a[52:55], v[100:103], v[116:119]
    v_mfma_f32_16x16x32_bf16 v[116:119], a[56:59], v[104:107], v[116:119]
    s_waitcnt vmcnt(5)
    v_mfma_f32_16x16x32_bf16 v[116:119], a[60:63], v[108:111], v[116:119]
    s_add_u32 s87, s87, 7
    s_add_u32 s39, s87, s88
    s_bfe_u32 s37, s39, 0x10000
    s_lshl_b32 s37, s37, 14
    s_add_u32 s86, s37, s89
    s_bfe_u32 s37, s39, 0x30001
    s_lshl_b32 s37, s37, 9
    s_add_u32 s86, s37, s86
    s_bfe_u32 s37, s39, 0x40004
    s_lshl_b32 s37, s37, 16
    s_add_u32 s86, s37, s86
L_bloop:
    s_waitcnt vmcnt(4)
    buffer_load_dwordx4 v[148:151], v127, s[56:59], s85 offen offset:256 nt
    v_mfma_f32_16x16x32_bf16 v[112:115], v[128:131], v[80:83], 0
    s_waitcnt vmcnt(4)
    buffer_load_dwordx4 v[152:155], v126, s[56:59], s85 offen offset:256 nt
    v_mfma_f32_16x16x32_bf16 v[112:115], v[132:135], v[84:87], v[112:115]
    s_waitcnt vmcnt(4)
    buffer_load_dwordx4 v[156:159], v127, s[56:59], s85 offen offset:0 nt
    v_mfma_f32_16x16x32_bf16 v[112:115], v[136:139], v[88:91], v[112:115]
    s_waitcnt vmcnt(4)
    buffer_load_dwordx4 v[160:163], v76, s[52:55], s86 offen offset:0 nt
    buffer_load_dwordx4 v[164:167], v77, s[52:55], s86 offen offset:256 nt
    v_mfma_f32_16x16x32_bf16 v[112:115], v[140:143], v[92:95], v[112:115]
    s_add_u32 s87, s87, 7
    s_add_u32 s39, s87, s88
    s_bfe_u32 s37, s39, 0x10000
    s_lshl_b32 s37, s37, 14
    s_add_u32 s85, s37, s89
    s_bfe_u32 s37, s39, 0x30001
    s_lshl_b32 s37, s37, 9
    s_add_u32 s85, s37, s85
    s_bfe_u32 s37, s39, 0x40004
    s_lshl_b32 s37, s37, 16
    s_add_u32 s85, s37, s85
    v_mov_b32_dpp v122, v112 quad_perm:[0,0,0,0] row_mask:0xf bank_mask:0xf
    v_mov_b32_dpp v124, v114 quad_perm:[2,2,2,2] row_mask:0xf bank_mask:0xf
    s_nop 0
    v_add_f32_dpp v122, v113, v122 quad_perm:[1,1,1,1] row_mask:0xf bank_mask:0xf
    v_add_f32_dpp v124, v115, v124 quad_perm:[3,3,3,3] row_mask:0xf bank_mask:0xf
    v_add_f32 v122, v122, v124
    v_fma_f32 v123, v122, s83, -v120
    v_cmp_lt_f32 vcc, 0, v123
    s_cbranch_vccz L_nomax_9
    v_mul_f32 v122, s83, v122
    s_nop 1
    v_max_f32_dpp v124, v122, v122 row_ror:4 row_mask:0xf bank_mask:0xf
    s_nop 1
    v_max_f32_dpp v124, v124, v124 row_ror:8 row_mask:0xf bank_mask:0xf
    v_mov_b32 v125, v124
    s_nop 1
    v_permlane16_swap_b32 v124, v125
    v_max_f32 v124, v124, v125
    v_mov_b32 v125, v124
    s_nop 1
    v_permlane32_swap_b32 v124, v125
    v_max_f32 v124, v124, v125
    v_and_b32 v124, s82, v124
    v_max_f32 v124, v124, v120
    v_sub_f32 v125, v120, v124
    v_exp_f32 v125, v125
    v_mov_b32 v120, v124
    v_sub_f32 v123, v122, v124
    v_mul_f32 v121, v121, v125
    v_mul_f32 v116, v116, v125
    v_mul_f32 v117, v117, v125
    v_mul_f32 v118, v118, v125
    v_mul_f32 v119, v119, v125
L_nomax_9:
    v_exp_f32 v123, v123
    s_nop 0
    v_cvt_pk_bf16_f32 v124, v123, v123
    v_add_f32 v121, v121, v123
    s_nop 0
    v_and_b32_dpp v96, v124, v10 row_newbcast:0 row_mask:0xf bank_mask:0xf
    v_and_b32_dpp v97, v124, v11 row_newbcast:0 row_mask:0xf bank_mask:0xf
    v_and_b32_dpp v98, v124, v12 row_newbcast:0 row_mask:0xf bank_mask:0xf
    v_and_b32_dpp v99, v124, v13 row_newbcast:0 row_mask:0xf bank_mask:0xf
    v_and_b32_dpp v100, v124, v10 row_newbcast:4 row_mask:0xf bank_mask:0xf
    v_and_b32_dpp v101, v124, v11 row_newbcast:4 row_mask:0xf bank_mask:0xf
    v_and_b32_dpp v102, v124, v12 row_newbcast:4 row_mask:0xf bank_mask:0xf
    v_and_b32_dpp v103, v124, v13 row_newbcast:4 row_mask:0xf bank_mask:0xf
    v_and_b32_dpp v104, v124, v10 row_newbcast:8 row_mask:0xf bank_mask:0xf
    v_and_b32_dpp v105, v124, v11 row_newbcast:8 row_mask:0xf bank_mask:0xf
    v_and_b32_dpp v106, v124, v12 row_newbcast:8 row_mask:0xf bank_mask:0xf
    v_and_b32_dpp v107, v124, v13 row_newbcast:8 row_mask:0xf bank_mask:0xf
    v_and_b32_dpp v108, v124, v10 row_newbcast:12 row_mask:0xf bank_mask:0xf
    v_and_b32_dpp v109, v124, v11 row_newbcast:12 row_mask:0xf bank_mask:0xf
    v_and_b32_dpp v110, v124, v12 row_newbcast:12 row_mask:0xf bank_mask:0xf
    v_and_b32_dpp v111, v124, v13 row_newbcast:12 row_mask:0xf bank_mask:0xf
    s_waitcnt vmcnt(5)
    v_mfma_f32_16x16x32_bf16 v[116:119], v[144:147], v[96:99], v[116:119]
    s_waitcnt vmcnt(4)
    buffer_load_dwordx4 v[168:171], v76, s[52:55], s86 offen offset:256 nt
    v_mfma_f32_16x16x32_bf16 v[116:119], v[148:151], v[100:103], v[116:119]
    s_waitcnt vmcnt(4)
    buffer_load_dwordx4 v[172:175], v77, s[52:55], s86 offen offset:0 nt
    v_mfma_f32_16x16x32_bf16 v[116:119], v[152:155], v[104:107], v[116:119]
    s_waitcnt vmcnt(4)
    buffer_load_dwordx4 v[176:179], v126, s[56:59], s86 offen offset:0 nt
    v_mfma_f32_16x16x32_bf16 v[116:119], v[156:159], v[108:111], v[116:119]
    s_waitcnt vmcnt(4)
    buffer_load_dwordx4 v[180:183], v127, s[56:59], s86 offen offset:256 nt
    v_mfma_f32_16x16x32_bf16 v[112:115], v[160:163], v[80:83], 0
    s_waitcnt vmcnt(4)
    buffer_load_dwordx4 v[184:187], v126, s[56:59], s86 offen offset:256 nt
    v_mfma_f32_16x16x32_bf16 v[112:115], v[164:167], v[84:87], v[112:115]
    s_waitcnt vmcnt(4)
    buffer_load_dwordx4 v[188:191], v127, s[56:59], s86 offen offset:0 nt
    v_mfma_f32_16x16x32_bf16 v[112:115], v[168:171], v[88:91], v[112:115]
    s_waitcnt vmcnt(4)
    buffer_load_dwordx4 v[128:131], v76, s[52:55], s85 offen offset:0 nt
    buffer_load_dwordx4 v[132:135], v77, s[52:55], s85 offen offset:256 nt
    v_mfma_f32_16x16x32_bf16 v[112:115], v[172:175], v[92:95], v[112:115]
    s_add_u32 s87, s87, 7
    s_add_u32 s39, s87, s88
    s_bfe_u32 s37, s39, 0x10000
    s_lshl_b32 s37, s37, 14
    s_add_u32 s86, s37, s89
    s_bfe_u32 s37, s39, 0x30001
    s_lshl_b32 s37, s37, 9
    s_add_u32 s86, s37, s86
    s_bfe_u32 s37, s39, 0x40004
    s_lshl_b32 s37, s37, 16
    s_add_u32 s86, s37, s86
    v_mov_b32_dpp v122, v112 quad_perm:[0,0,0,0] row_mask:0xf bank_mask:0xf
    v_mov_b32_dpp v124, v114 quad_perm:[2,2,2,2] row_mask:0xf bank_mask:0xf
    s_nop 0
    v_add_f32_dpp v122, v113, v122 quad_perm:[1,1,1,1] row_mask:0xf bank_mask:0xf
    v_add_f32_dpp v124, v115, v124 quad_perm:[3,3,3,3] row_mask:0xf bank_mask:0xf
    v_add_f32 v122, v122, v124
    v_fma_f32 v123, v122, s83, -v120
    v_cmp_lt_f32 vcc, 0, v123
    s_cbranch_vccz L_nomax_10
    v_mul_f32 v122, s83, v122
    s_nop 1
    v_max_f32_dpp v124, v122, v122 row_ror:4 row_mask:0xf bank_mask:0xf
    s_nop 1
    v_max_f32_dpp v124, v124, v124 row_ror:8 row_mask:0xf bank_mask:0xf
    v_mov_b32 v125, v124
    s_nop 1
    v_permlane16_swap_b32 v124, v125
    v_max_f32 v124, v124, v125
    v_mov_b32 v125, v124
    s_nop 1
    v_permlane32_swap_b32 v124, v125
    v_max_f32 v124, v124, v125
    v_and_b32 v124, s82, v124
    v_max_f32 v124, v124, v120
    v_sub_f32 v125, v120, v124
    v_exp_f32 v125, v125
    v_mov_b32 v120, v124
    v_sub_f32 v123, v122, v124
    v_mul_f32 v121, v121, v125
    v_mul_f32 v116, v116, v125
    v_mul_f32 v117, v117, v125
    v_mul_f32 v118, v118, v125
    v_mul_f32 v119, v119, v125
L_nomax_10:
    v_exp_f32 v123, v123
    s_nop 0
    v_cvt_pk_bf16_f32 v124, v123, v123
    v_add_f32 v121, v121, v123
    s_nop 0
    v_and_b32_dpp v96, v124, v10 row_newbcast:0 row_mask:0xf bank_mask:0xf
    v_and_b32_dpp v97, v124, v11 row_newbcast:0 row_mask:0xf bank_mask:0xf
    v_and_b32_dpp v98, v124, v12 row_newbcast:0 row_mask:0xf bank_mask:0xf
    v_and_b32_dpp v99, v124, v13 row_newbcast:0 row_mask:0xf bank_mask:0xf
    v_and_b32_dpp v100, v124, v10 row_newbcast:4 row_mask:0xf bank_mask:0xf
    v_and_b32_dpp v101, v124, v11 row_newbcast:4 row_mask:0xf bank_mask:0xf
    v_and_b32_dpp v102, v124, v12 row_newbcast:4 row_mask:0xf bank_mask:0xf
    v_and_b32_dpp v103, v124, v13 row_newbcast:4 row_mask:0xf bank_mask:0xf
    v_and_b32_dpp v104, v124, v10 row_newbcast:8 row_mask:0xf bank_mask:0xf
    v_and_b32_dpp v105, v124, v11 row_newbcast:8 row_mask:0xf bank_mask:0xf
    v_and_b32_dpp v106, v124, v12 row_newbcast:8 row_mask:0xf bank_mask:0xf
    v_and_b32_dpp v107, v124, v13 row_newbcast:8 row_mask:0xf bank_mask:0xf
    v_and_b32_dpp v108, v124, v10 row_newbcast:12 row_mask:0xf bank_mask:0xf
    v_and_b32_dpp v109, v124, v11 row_newbcast:12 row_mask:0xf bank_mask:0xf
    v_and_b32_dpp v110, v124, v12 row_newbcast:12 row_mask:0xf bank_mask:0xf
    v_and_b32_dpp v111, v124, v13 row_newbcast:12 row_mask:0xf bank_mask:0xf
    s_waitcnt vmcnt(5)
    v_mfma_f32_16x16x32_bf16 v[116:119], v[176:179], v[96:99], v[116:119]
    s_waitcnt vmcnt(4)
    buffer_load_dwordx4 v[136:139], v76, s[52:55], s85 offen offset:256 nt
    v_mfma_f32_16x16x32_bf16 v[116:119], v[180:183], v[100:103], v[116:119]
    s_waitcnt vmcnt(4)
    buffer_load_dwordx4 v[140:143], v77, s[52:55], s85 offen offset:0 nt
    v_mfma_f32_16x16x32_bf16 v[116:119], v[184:187], v[104:107], v[116:119]
    s_waitcnt vmcnt(4)
    buffer_load_dwordx4 v[144:147], v126, s[56:59], s85 offen offset:0 nt
    v_mfma_f32_16x16x32_bf16 v[116:119], v[188:191], v[108:111], v[116:119]
    s_cmp_lt_u32 s87, 245
    s_cbranch_scc1 L_bloop
    buffer_load_dwordx4 v[148:151], v127, s[56:59], s85 offen offset:256 nt
    buffer_load_dwordx4 v[152:155], v126, s[56:59], s85 offen offset:256 nt
    s_sub_u32 s37, s87, 252
    v_mov_b32 v19, s37
L_dloop:
    s_waitcnt vmcnt(6)
    buffer_load_dwordx4 v[156:159], v127, s[56:59], s85 offen offset:0 nt
    v_mfma_f32_16x16x32_bf16 v[112:115], v[128:131], v[80:83], 0
    s_waitcnt vmcnt(6)
    v_readfirstlane_b32 s93, v19
    s_nop 0
    s_sub_u32 s36, s93, 12
    s_lshr_b32 s38, s36, 1
    s_mul_i32 s38, s38, 5
    s_add_u32 s38, s38, s36
    s_mul_i32 s87, s36, 7
    s_add_u32 s87, s87, 58
    s_cmp_lt_i32 s36, 0
    s_cselect_b32 s87, s87, s38
    s_add_u32 s38, s93, 252
    s_cmp_lt_i32 s93, 4
    s_cselect_b32 s87, s38, s87
    s_add_u32 s93, s93, 8
    s_add_u32 s39, s87, s88
    s_bfe_u32 s37, s39, 0x10000
    s_lshl_b32 s37, s37, 14
    s_add_u32 s86, s37, s89
    s_bfe_u32 s37, s39, 0x30001
    s_lshl_b32 s37, s37, 9
    s_add_u32 s86, s37, s86
    s_bfe_u32 s37, s39, 0x40004
    s_lshl_b32 s37, s37, 16
    s_add_u32 s86, s37, s86
    s_cmp_ge_u32 s93, 24
    s_cselect_b32 s86, 134217728, s86
    buffer_load_dwordx4 v[160:163], v76, s[52:55], s86 offen offset:0 nt
    v_mfma_f32_16x16x32_bf16 v[112:115], v[132:135], v[84:87], v[112:115]
    s_waitcnt vmcnt(6)
    v_mov_b32 v19, 16
    s_cmp_ge_u32 s93, 23
    s_cbranch_scc1 L_noclaim_11
    s_mov_b64 exec, 1
    global_atomic_add v19, v9, v18, s[30:31] sc0 sc1
    s_mov_b64 exec, -1
L_noclaim_11:
    buffer_load_dwordx4 v[164:167], v77, s[52:55], s86 offen offset:256 nt
    v_mfma_f32_16x16x32_bf16 v[112:115], v[136:139], v[88:91], v[112:115]
    s_waitcnt vmcnt(6)
    buffer_load_dwordx4 v[168:171], v76, s[52:55], s86 offen offset:256 nt
    v_mfma_f32_16x16x32_bf16 v[112:115], v[140:143], v[92:95], v[112:115]
    s_nop 7
    v_mov_b32_dpp v122, v112 quad_perm:[0,0,0,0] row_mask:0xf bank_mask:0xf
    v_mov_b32_dpp v124, v114 quad_perm:[2,2,2,2] row_mask:0xf bank_mask:0xf
    s_nop 0
    v_add_f32_dpp v122, v113, v122 quad_perm:[1,1,1,1] row_mask:0xf bank_mask:0xf
    v_add_f32_dpp v124, v115, v124 quad_perm:[3,3,3,3] row_mask:0xf bank_mask:0xf
    v_add_f32 v122, v122, v124
    v_fma_f32 v123, v122, s83, -v120
    v_cmp_lt_f32 vcc, 0, v123
    s_cbranch_vccz L_nomax_12
    v_mul_f32 v122, s83, v122
    s_nop 1
    v_max_f32_dpp v124, v122, v122 row_ror:4 row_mask:0xf bank_mask:0xf
    s_nop 1
    v_max_f32_dpp v124, v124, v124 row_ror:8 row_mask:0xf bank_mask:0xf
    v_mov_b32 v125, v124
    s_nop 1
    v_permlane16_swap_b32 v124, v125
    v_max_f32 v124, v124, v125
    v_mov_b32 v125, v124
    s_nop 1
    v_permlane32_swap_b32 v124, v125
    v_max_f32 v124, v124, v125
    v_and_b32 v124, s82, v124
    v_max_f32 v124, v124, v120
    v_sub_f32 v125, v120, v124
    v_exp_f32 v125, v125
    v_mov_b32 v120, v124
    v_sub_f32 v123, v122, v124
    v_mul_f32 v121, v121, v125
    v_mul_f32 v116, v116, v125
    v_mul_f32 v117, v117, v125
    v_mul_f32 v118, v118, v125
    v_mul_f32 v119, v119, v125
L_nomax_12:
    v_exp_f32 v123, v123
    s_nop 0
    v_cvt_pk_bf16_f32 v124, v123, v123
    v_add_f32 v121, v121, v123
    s_nop 0
    v_and_b32_dpp v96, v124, v10 row_newbcast:0 row_mask:0xf bank_mask:0xf
    v_and_b32_dpp v97, v124, v11 row_newbcast:0 row_mask:0xf bank_mask:0xf
    v_and_b32_dpp v98, v124, v12 row_newbcast:0 row_mask:0xf bank_mask:0xf
    v_and_b32_dpp v99, v124, v13 row_newbcast:0 row_mask:0xf bank_mask:0xf
    v_and_b32_dpp v100, v124, v10 row_newbcast:4 row_mask:0xf bank_mask:0xf
    v_and_b32_dpp v101, v124, v11 row_newbcast:4 row_mask:0xf bank_mask:0xf
    v_and_b32_dpp v102, v124, v12 row_newbcast:4 row_mask:0xf bank_mask:0xf
    v_and_b32_dpp v103, v124, v13 row_newbcast:4 row_mask:0xf bank_mask:0xf
    v_and_b32_dpp v104, v124, v10 row_newbcast:8 row_mask:0xf bank_mask:0xf
    v_and_b32_dpp v105, v124, v11 row_newbcast:8 row_mask:0xf bank_mask:0xf
    v_and_b32_dpp v106, v124, v12 row_newbcast:8 row_mask:0xf bank_mask:0xf
    v_and_b32_dpp v107, v124, v13 row_newbcast:8 row_mask:0xf bank_mask:0xf
    v_and_b32_dpp v108, v124, v10 row_newbcast:12 row_mask:0xf bank_mask:0xf
    v_and_b32_dpp v109, v124, v11 row_newbcast:12 row_mask:0xf bank_mask:0xf
    v_and_b32_dpp v110, v124, v12 row_newbcast:12 row_mask:0xf bank_mask:0xf
    v_and_b32_dpp v111, v124, v13 row_newbcast:12 row_mask:0xf bank_mask:0xf
    s_waitcnt vmcnt(6)
    buffer_load_dwordx4 v[172:175], v77, s[52:55], s86 offen offset:0 nt
    v_mfma_f32_16x16x32_bf16 v[116:119], v[144:147], v[96:99], v[116:119]
    s_waitcnt vmcnt(6)
    buffer_load_dwordx4 v[176:179], v126, s[56:59], s86 offen offset:0 nt
    v_mfma_f32_16x16x32_bf16 v[116:119], v[148:151], v[100:103], v[116:119]
    s_waitcnt vmcnt(6)
    buffer_load_dwordx4 v[180:183], v127, s[56:59], s86 offen offset:256 nt
    v_mfma_f32_16x16x32_bf16 v[116:119], v[152:155], v[104:107], v[116:119]
    s_waitcnt vmcnt(6)
    buffer_load_dwordx4 v[184:187], v126, s[56:59], s86 offen offset:256 nt
    v_mfma_f32_16x16x32_bf16 v[116:119], v[156:159], v[108:111], v[116:119]
    s_cmp_ge_u32 s93, 24
    s_cbranch_scc1 L_bdone
    s_waitcnt vmcnt(6)
    buffer_load_dwordx4 v[188:191], v127, s[56:59], s86 offen offset:0 nt
    v_mfma_f32_16x16x32_bf16 v[112:115], v[160:163], v[80:83], 0
    s_waitcnt vmcnt(6)
    v_readfirstlane_b32 s93, v19
    s_nop 0
    s_sub_u32 s36, s93, 12
    s_lshr_b32 s38, s36, 1
    s_mul_i32 s38, s38, 5
    s_add_u32 s38, s38, s36
    s_mul_i32 s87, s36, 7
    s_add_u32 s87, s87, 58
    s_cmp_lt_i32 s36, 0
    s_cselect_b32 s87, s87, s38
    s_add_u32 s38, s93, 252
    s_cmp_lt_i32 s93, 4
    s_cselect_b32 s87, s38, s87
    s_add_u32 s93, s93, 8
    s_add_u32 s39, s87, s88
    s_bfe_u32 s37, s39, 0x10000
    s_lshl_b32 s37, s37, 14
    s_add_u32 s85, s37, s89
    s_bfe_u32 s37, s39, 0x30001
    s_lshl_b32 s37, s37, 9
    s_add_u32 s85, s37, s85
    s_bfe_u32 s37, s39, 0x40004
    s_lshl_b32 s37, s37, 16
    s_add_u32 s85, s37, s85
    s_cmp_ge_u32 s93, 24
    s_cselect_b32 s85, 134217728, s85
    buffer_load_dwordx4 v[128:131], v76, s[52:55], s85 offen offset:0 nt
    v_mfma_f32_16x16x32_bf16 v[112:115], v[164:167], v[84:87], v[112:115]
    s_waitcnt vmcnt(6)
    v_mov_b32 v19, 16
    s_cmp_ge_u32 s93, 23
    s_cbranch_scc1 L_noclaim_13
    s_mov_b64 exec, 1
    global_atomic_add v19, v9, v18, s[30:31] sc0 sc1
    s_mov_b64 exec, -1
L_noclaim_13:
    buffer_load_dwordx4 v[132:135], v77, s[52:55], s85 offen offset:256 nt
    v_mfma_f32_16x16x32_bf16 v[112:115], v[168:171], v[88:91], v[112:115]
    s_waitcnt vmcnt(6)
    buffer_load_dwordx4 v[136:139], v76, s[52:55], s85 offen offset:256 nt
    v_mfma_f32_16x16x32_bf16 v[112:115], v[172:175], v[92:95], v[112:115]
    s_nop 7
    v_mov_b32_dpp v122, v112 quad_perm:[0,0,0,0] row_mask:0xf bank_mask:0xf
    v_mov_b32_dpp v124, v114 quad_perm:[2,2,2,2] row_mask:0xf bank_mask:0xf
    s_nop 0
    v_add_f32_dpp v122, v113, v122 quad_perm:[1,1,1,1] row_mask:0xf bank_mask:0xf
    v_add_f32_dpp v124, v115, v124 quad_perm:[3,3,3,3] row_mask:0xf bank_mask:0xf
    v_add_f32 v122, v122, v124
    v_fma_f32 v123, v122, s83, -v120
    v_cmp_lt_f32 vcc, 0, v123
    s_cbranch_vccz L_nomax_14
    v_mul_f32 v122, s83, v122
    s_nop 1
    v_max_f32_dpp v124, v122, v122 row_ror:4 row_mask:0xf bank_mask:0xf
    s_nop 1
    v_max_f32_dpp v124, v124, v124 row_ror:8 row_mask:0xf bank_mask:0xf
    v_mov_b32 v125, v124
    s_nop 1
    v_permlane16_swap_b32 v124, v125
    v_max_f32 v124, v124, v125
    v_mov_b32 v125, v124
    s_nop 1
    v_permlane32_swap_b32 v124, v125
    v_max_f32 v124, v124, v125
    v_and_b32 v124, s82, v124
    v_max_f32 v124, v124, v120
    v_sub_f32 v125, v120, v124
    v_exp_f32 v125, v125
    v_mov_b32 v120, v124
    v_sub_f32 v123, v122, v124
    v_mul_f32 v121, v121, v125
    v_mul_f32 v116, v116, v125
    v_mul_f32 v117, v117, v125
    v_mul_f32 v118, v118, v125
    v_mul_f32 v119, v119, v125
L_nomax_14:
    v_exp_f32 v123, v123
    s_nop 0
    v_cvt_pk_bf16_f32 v124, v123, v123
    v_add_f32 v121, v121, v123
    s_nop 0
    v_and_b32_dpp v96, v124, v10 row_newbcast:0 row_mask:0xf bank_mask:0xf
    v_and_b32_dpp v97, v124, v11 row_newbcast:0 row_mask:0xf bank_mask:0xf
    v_and_b32_dpp v98, v124, v12 row_newbcast:0 row_mask:0xf bank_mask:0xf
    v_and_b32_dpp v99, v124, v13 row_newbcast:0 row_mask:0xf bank_mask:0xf
    v_and_b32_dpp v100, v124, v10 row_newbcast:4 row_mask:0xf bank_mask:0xf
    v_and_b32_dpp v101, v124, v11 row_newbcast:4 row_mask:0xf bank_mask:0xf
    v_and_b32_dpp v102, v124, v12 row_newbcast:4 row_mask:0xf bank_mask:0xf
    v_and_b32_dpp v103, v124, v13 row_newbcast:4 row_mask:0xf bank_mask:0xf
    v_and_b32_dpp v104, v124, v10 row_newbcast:8 row_mask:0xf bank_mask:0xf
    v_and_b32_dpp v105, v124, v11 row_newbcast:8 row_mask:0xf bank_mask:0xf
    v_and_b32_dpp v106, v124, v12 row_newbcast:8 row_mask:0xf bank_mask:0xf
    v_and_b32_dpp v107, v124, v13 row_newbcast:8 row_mask:0xf bank_mask:0xf
    v_and_b32_dpp v108, v124, v10 row_newbcast:12 row_mask:0xf bank_mask:0xf
    v_and_b32_dpp v109, v124, v11 row_newbcast:12 row_mask:0xf bank_mask:0xf
    v_and_b32_dpp v110, v124, v12 row_newbcast:12 row_mask:0xf bank_mask:0xf
    v_and_b32_dpp v111, v124, v13 row_newbcast:12 row_mask:0xf bank_mask:0xf
    s_waitcnt vmcnt(6)
    buffer_load_dwordx4 v[140:143], v77, s[52:55], s85 offen offset:0 nt
    v_mfma_f32_16x16x32_bf16 v[116:119], v[176:179], v[96:99], v[116:119]
    s_waitcnt vmcnt(6)
    buffer_load_dwordx4 v[144:147], v126, s[56:59], s85 offen offset:0 nt
    v_mfma_f32_16x16x32_bf16 v[116:119], v[180:183], v[100:103], v[116:119]
    s_waitcnt vmcnt(6)
    buffer_load_dwordx4 v[148:151], v127, s[56:59], s85 offen offset:256 nt
    v_mfma_f32_16x16x32_bf16 v[116:119], v[184:187], v[104:107], v[116:119]
    s_waitcnt vmcnt(6)
    buffer_load_dwordx4 v[152:155], v126, s[56:59], s85 offen offset:256 nt
    v_mfma_f32_16x16x32_bf16 v[116:119], v[188:191], v[108:111], v[116:119]
    s_cmp_ge_u32 s93, 24
    s_cbranch_scc0 L_dloop
L_bdone:
    v_add_f32_dpp v121, v121, v121 row_ror:8 row_mask:0xf bank_mask:0xf
    s_lshl_b32 s38, s32, 2
    s_add_u32 s38, s38, s34
    v_add_f32_dpp v121, v121, v121 row_ror:4 row_mask:0xf bank_mask:0xf
    v_mov_b32 v125, v121
    s_lshl_b32 s38, s38, 3
    s_add_u32 s38, s38, s33
    v_permlane16_swap_b32 v121, v125
    v_add_f32 v121, v121, v125
    v_mov_b32 v125, v121
    s_lshl_b32 s38, s38, 10
    s_add_u32 s38, s38, 5242880
    v_permlane32_swap_b32 v121, v125
    s_mov_b32 exec_lo, 0x100
    s_mov_b32 exec_hi, 0x0
    v_add_f32 v117, v121, v125
    v_mov_b32 v116, v120
    s_mov_b32 exec_lo, 0xff01ff
    s_mov_b32 exec_hi, 0xff00ff
    v_and_or_b32 v116, v116, s82, v8
    v_and_or_b32 v117, v117, s82, v8
    v_and_or_b32 v118, v118, s82, v8
    v_and_or_b32 v119, v119, s82, v8
    buffer_store_dwordx4 v[116:119], v79, s[48:51], s38 offen sc1
    s_endpgm
L_qb:
    v_lshlrev_b32 v4, 17, v2
    v_lshl_add_u32 v14, v3, 4, v4
    v_lshrrev_b32 v5, 3, v3
    v_lshlrev_b32 v5, 10, v5
    v_lshl_add_u32 v15, v2, 5, v5
    s_lshl_b32 s36, s33, 2
    s_add_u32 s36, s36, s34
    s_lshl_b32 s37, s36, 7
    s_lshl_b32 s63, s36, 19
    s_lshl_b32 s38, s32, 8
    s_add_u32 s63, s63, s38
    s_mov_b32 s42, 4194304
    s_mov_b32 s43, 0x20000
    s_mov_b32 s46, 4096
    s_mov_b32 s47, 0x20000
    s_waitcnt lgkmcnt(0)
    s_mov_b64 s[40:41], s[22:23]
    s_mov_b64 s[44:45], s[16:17]
    buffer_load_dwordx4 a[128:131], v14, s[40:43], s63 offen nt
    s_add_u32 s63, s63, 8192
    buffer_load_dwordx4 a[132:135], v14, s[40:43], s63 offen nt
    s_add_u32 s63, s63, 8192
    buffer_load_dwordx4 v[20:23], v15, s[44:47], s37 offen offset:0
    buffer_load_dwordx4 v[24:27], v15, s[44:47], s37 offen offset:16
    buffer_load_dwordx4 v[28:31], v15, s[44:47], s37 offen offset:2048
    buffer_load_dwordx4 v[32:35], v15, s[44:47], s37 offen offset:2064
    buffer_load_dwordx4 a[136:139], v14, s[40:43], s63 offen nt
    s_add_u32 s63, s63, 8192
    buffer_load_dwordx4 a[140:143], v14, s[40:43], s63 offen nt
    s_add_u32 s63, s63, 8192
    buffer_load_dwordx4 a[144:147], v14, s[40:43], s63 offen nt
    s_add_u32 s63, s63, 8192
    buffer_load_dwordx4 a[148:151], v14, s[40:43], s63 offen nt
    s_add_u32 s63, s63, 8192
    buffer_load_dwordx4 a[152:155], v14, s[40:43], s63 offen nt
    s_add_u32 s63, s63, 8192
    buffer_load_dwordx4 a[156:159], v14, s[40:43], s63 offen nt
    s_add_u32 s63, s63, 8192
    s_load_dword s35, s[30:31], 0
    s_mov_b32 s48, s30
    s_and_b32 s49, s31, 0xffff
    s_mov_b32 s50, 8388608
    s_mov_b32 s51, 0x20000
    s_mov_b32 s82, 0xffffff00
    s_mov_b32 s83, 0x3e0293ee
    s_mov_b32 s84, 1048576
    v_and_b32 v4, 1, v1
    v_lshlrev_b32 v4, 4, v4
    v_mov_b32 v5, 0xffff
    v_lshlrev_b32 v4, v4, v5
    v_bfe_u32 v5, v1, 1, 2
    v_cmp_eq_u32 vcc, 0, v5
    s_nop 1
    v_cndmask_b32 v10, 0, v4, vcc
    v_cmp_eq_u32 vcc, 1, v5
    s_nop 1
    v_cndmask_b32 v11, 0, v4, vcc
    v_cmp_eq_u32 vcc, 2, v5
    s_nop 1
    v_cndmask_b32 v12, 0, v4, vcc
    v_cmp_eq_u32 vcc, 3, v5
    s_nop 1
    v_cndmask_b32 v13, 0, v4, vcc
    v_lshrrev_b32 v4, 2, v3
    v_and_b32 v5, 3, v3
    v_lshlrev_b32 v76, 12, v4
    v_lshlrev_b32 v126, 12, v2
    v_lshl_add_u32 v76, v2, 6, v76
    v_lshl_add_u32 v76, v5, 4, v76
    v_lshl_add_u32 v126, v3, 4, v126
    v_xor_b32 v77, 32768, v76
    v_xor_b32 v127, 32768, v126
    s_lshl_b32 s89, s34, 5
    s_add_u32 s89, s89, s32
    s_lshl_b32 s89, s89, 20
    s_mul_i32 s88, s32, 8
    s_mul_i32 s38, s34, 1
    s_add_u32 s88, s88, s38
    s_add_u32 s87, s33, 14
    s_mov_b32 s52, s18
    s_and_b32 s53, s19, 0xffff
    s_mov_b32 s54, 134217728
    s_mov_b32 s55, 0x20000
    s_mov_b32 s56, s20
    s_and_b32 s57, s21, 0xffff
    s_mov_b32 s58, 134217728
    s_mov_b32 s59, 0x20000
    v_mov_b32 v120, 0xff7f0000
    v_mov_b32 v121, 0
    v_mov_b32 v18, 1
    v_mov_b32 v116, 0
    v_mov_b32 v117, 0
    v_mov_b32 v118, 0
    v_mov_b32 v119, 0
    s_lshl_b32 s38, s32, 2
    s_add_u32 s38, s38, s34
    s_lshl_b32 s38, s38, 8
    s_add_u32 s38, s38, 65536
    v_mov_b32 v9, s38
    v_and_b32 v5, 3, v3
    v_lshlrev_b32 v78, 7, v2
    v_lshl_add_u32 v78, v5, 5, v78
    v_bfe_u32 v4, v3, 2, 1
    v_lshl_add_u32 v78, v4, 11, v78
    s_lshl_b32 s91, s32, 12
    s_lshl_b32 s38, s34, 9
    s_add_u32 s91, s91, s38
    s_add_u32 s91, s91, 1048576
    v_lshlrev_b32 v4, 7, v2
    v_lshl_add_u32 v4, v3, 4, v4
    v_mov_b32 v5, 512
    v_cmp_gt_u32 vcc, 8, v3
    s_nop 1
    v_cndmask_b32 v79, v5, v4, vcc
    v_mov_b32 v19, 0
    s_cmp_eq_u32 s33, 0
    s_cselect_b32 s38, 0, 8388608
    s_mov_b64 exec, 1
    buffer_store_dword v19, v9, s[48:51], s38 offen sc1
    s_mov_b64 exec, -1
    s_mov_b32 s80, 0x01000100
    s_mov_b32 s81, 0x03020302
    s_waitcnt vmcnt(7)
    buffer_load_dwordx4 a[160:163], v14, s[40:43], s63 offen nt
    s_add_u32 s63, s63, 8192
    v_perm_b32 v4, v20, v20, s80
    v_perm_b32 v5, v28, v28, s80
    v_and_b32 v52, v4, v10
    v_and_b32 v53, v4, v11
    v_and_b32 v54, v4, v12
    v_and_b32 v55, v4, v13
    v_and_b32 v56, v5, v10
    v_and_b32 v57, v5, v11
    v_and_b32 v58, v5, v12
    v_and_b32 v59, v5, v13
    v_mfma_f32_16x16x32_bf16 v[60:63], a[128:131], v[52:55], 0
    s_nop 0
    v_mfma_f32_16x16x32_bf16 v[64:67], a[128:131], v[56:59], 0
    buffer_load_dwordx4 a[164:167], v14, s[40:43], s63 offen nt
    s_add_u32 s63, s63, 8192
    v_perm_b32 v4, v20, v20, s81
    v_perm_b32 v5, v28, v28, s81
    v_and_b32 v52, v4, v10
    v_and_b32 v53, v4, v11
    v_and_b32 v54, v4, v12
    v_and_b32 v55, v4, v13
    v_and_b32 v56, v5, v10
    v_and_b32 v57, v5, v11
    v_and_b32 v58, v5, v12
    v_and_b32 v59, v5, v13
    v_mfma_f32_16x16x32_bf16 v[60:63], a[132:135], v[52:55], v[60:63]
    s_nop 0
    v_mfma_f32_16x16x32_bf16 v[64:67], a[132:135], v[56:59], v[64:67]
    s_waitcnt vmcnt(8)
    buffer_load_dwordx4 a[168:171], v14, s[40:43], s63 offen nt
    s_add_u32 s63, s63, 8192
    v_perm_b32 v4, v21, v21, s80
    v_perm_b32 v5, v29, v29, s80
    v_and_b32 v52, v4, v10
    v_and_b32 v53, v4, v11
    v_and_b32 v54, v4, v12
    v_and_b32 v55, v4, v13
    v_and_b32 v56, v5, v10
    v_and_b32 v57, v5, v11
    v_and_b32 v58, v5, v12
    v_and_b32 v59, v5, v13
    v_mfma_f32_16x16x32_bf16 v[60:63], a[136:139], v[52:55], v[60:63]
    s_nop 0
    v_mfma_f32_16x16x32_bf16 v[64:67], a[136:139], v[56:59], v[64:67]
    s_waitcnt vmcnt(8)
    buffer_load_dwordx4 a[172:175], v14, s[40:43], s63 offen nt
    s_add_u32 s63, s63, 8192
    v_perm_b32 v4, v21, v21, s81
    v_perm_b32 v5, v29, v29, s81
    v_and_b32 v52, v4, v10
    v_and_b32 v53, v4, v11
    v_and_b32 v54, v4, v12
    v_and_b32 v55, v4, v13
    v_and_b32 v56, v5, v10
    v_and_b32 v57, v5, v11
    v_and_b32 v58, v5, v12
    v_and_b32 v59, v5, v13
    v_mfma_f32_16x16x32_bf16 v[60:63], a[140:143], v[52:55], v[60:63]
    s_nop 0
    v_mfma_f32_16x16x32_bf16 v[64:67], a[140:143], v[56:59], v[64:67]
    s_waitcnt vmcnt(8)
    buffer_load_dwordx4 a[176:179], v14, s[40:43], s63 offen nt
    s_add_u32 s63, s63, 8192
    v_perm_b32 v4, v22, v22, s80
    v_perm_b32 v5, v30, v30, s80
    v_and_b32 v52, v4, v10
    v_and_b32 v53, v4, v11
    v_and_b32 v54, v4, v12
    v_and_b32 v55, v4, v13
    v_and_b32 v56, v5, v10
    v_and_b32 v57, v5, v11
    v_and_b32 v58, v5, v12
    v_and_b32 v59, v5, v13
    v_mfma_f32_16x16x32_bf16 v[60:63], a[144:147], v[52:55], v[60:63]
    s_nop 0
    v_mfma_f32_16x16x32_bf16 v[64:67], a[144:147], v[56:59], v[64:67]
    s_waitcnt vmcnt(8)
    buffer_load_dwordx4 a[180:183], v14, s[40:43], s63 offen nt
    s_add_u32 s63, s63, 8192
    v_perm_b32 v4, v22, v22, s81
    v_perm_b32 v5, v30, v30, s81
    v_and_b32 v52, v4, v10
    v_and_b32 v53, v4, v11
    v_and_b32 v54, v4, v12
    v_and_b32 v55, v4, v13
    v_and_b32 v56, v5, v10
    v_and_b32 v57, v5, v11
    v_and_b32 v58, v5, v12
    v_and_b32 v59, v5, v13
    v_mfma_f32_16x16x32_bf16 v[60:63], a[148:151], v[52:55], v[60:63]
    s_nop 0
    v_mfma_f32_16x16x32_bf16 v[64:67], a[148:151], v[56:59], v[64:67]
    s_waitcnt vmcnt(8)
    buffer_load_dwordx4 a[184:187], v14, s[40:43], s63 offen nt
    s_add_u32 s63, s63, 8192
    v_perm_b32 v4, v23, v23, s80
    v_perm_b32 v5, v31, v31, s80
    v_and_b32 v52, v4, v10
    v_and_b32 v53, v4, v11
    v_and_b32 v54, v4, v12
    v_and_b32 v55, v4, v13
    v_and_b32 v56, v5, v10
    v_and_b32 v57, v5, v11
    v_and_b32 v58, v5, v12
    v_and_b32 v59, v5, v13
    v_mfma_f32_16x16x32_bf16 v[60:63], a[152:155], v[52:55], v[60:63]
    s_nop 0
    v_mfma_f32_16x16x32_bf16 v[64:67], a[152:155], v[56:59], v[64:67]
    s_waitcnt vmcnt(8)
    buffer_load_dwordx4 a[188:191], v14, s[40:43], s63 offen nt
    s_add_u32 s63, s63, 8192
    v_perm_b32 v4, v23, v23, s81
    v_perm_b32 v5, v31, v31, s81
    v_and_b32 v52, v4, v10
    v_and_b32 v53, v4, v11
    v_and_b32 v54, v4, v12
    v_and_b32 v55, v4, v13
    v_and_b32 v56, v5, v10
    v_and_b32 v57, v5, v11
    v_and_b32 v58, v5, v12
    v_and_b32 v59, v5, v13
    v_mfma_f32_16x16x32_bf16 v[60:63], a[156:159], v[52:55], v[60:63]
    s_nop 0
    v_mfma_f32_16x16x32_bf16 v[64:67], a[156:159], v[56:59], v[64:67]
    s_waitcnt vmcnt(7)
    v_perm_b32 v4, v24, v24, s80
    v_perm_b32 v5, v32, v32, s80
    v_and_b32 v52, v4, v10
    v_and_b32 v53, v4, v11
    v_and_b32 v54, v4, v12
    v_and_b32 v55, v4, v13
    v_and_b32 v56, v5, v10
    v_and_b32 v57, v5, v11
    v_and_b32 v58, v5, v12
    v_and_b32 v59, v5, v13
    v_mfma_f32_16x16x32_bf16 v[60:63], a[160:163], v[52:55], v[60:63]
    s_nop 0
    v_mfma_f32_16x16x32_bf16 v[64:67], a[160:163], v[56:59], v[64:67]
    s_waitcnt vmcnt(6)
    s_add_u32 s39, s87, s88
    s_bfe_u32 s37, s39, 0x10000
    s_lshl_b32 s37, s37, 14
    s_add_u32 s85, s37, s89
    s_bfe_u32 s37, s39, 0x30001
    s_lshl_b32 s37, s37, 9
    s_add_u32 s85, s37, s85
    s_bfe_u32 s37, s39, 0x40004
    s_lshl_b32 s37, s37, 16
    s_add_u32 s85, s37, s85
    buffer_load_dwordx4 v[128:131], v76, s[52:55], s85 offen offset:0 nt
    v_perm_b32 v4, v24, v24, s81
    v_perm_b32 v5, v32, v32, s81
    v_and_b32 v52, v4, v10
    v_and_b32 v53, v4, v11
    v_and_b32 v54, v4, v12
    v_and_b32 v55, v4, v13
    v_and_b32 v56, v5, v10
    v_and_b32 v57, v5, v11
    v_and_b32 v58, v5, v12
    v_and_b32 v59, v5, v13
    v_mfma_f32_16x16x32_bf16 v[60:63], a[164:167], v[52:55], v[60:63]
    s_nop 0
    v_mfma_f32_16x16x32_bf16 v[64:67], a[164:167], v[56:59], v[64:67]
    s_waitcnt vmcnt(6)
    buffer_load_dwordx4 v[132:135], v77, s[52:55], s85 offen offset:256 nt
    v_perm_b32 v4, v25, v25, s80
    v_perm_b32 v5, v33, v33, s80
    v_and_b32 v52, v4, v10
    v_and_b32 v53, v4, v11
    v_and_b32 v54, v4, v12
    v_and_b32 v55, v4, v13
    v_and_b32 v56, v5, v10
    v_and_b32 v57, v5, v11
    v_and_b32 v58, v5, v12
    v_and_b32 v59, v5, v13
    v_mfma_f32_16x16x32_bf16 v[60:63], a[168:171], v[52:55], v[60:63]
    s_nop 0
    v_mfma_f32_16x16x32_bf16 v[64:67], a[168:171], v[56:59], v[64:67]
    s_waitcnt vmcnt(6)
    buffer_load_dwordx4 v[136:139], v76, s[52:55], s85 offen offset:256 nt
    v_perm_b32 v4, v25, v25, s81
    v_perm_b32 v5, v33, v33, s81
    v_and_b32 v52, v4, v10
    v_and_b32 v53, v4, v11
    v_and_b32 v54, v4, v12
    v_and_b32 v55, v4, v13
    v_and_b32 v56, v5, v10
    v_and_b32 v57, v5, v11
    v_and_b32 v58, v5, v12
    v_and_b32 v59, v5, v13
    v_mfma_f32_16x16x32_bf16 v[60:63], a[172:175], v[52:55], v[60:63]
    s_nop 0
    v_mfma_f32_16x16x32_bf16 v[64:67], a[172:175], v[56:59], v[64:67]
    s_waitcnt vmcnt(6)
    buffer_load_dwordx4 v[140:143], v77, s[52:55], s85 offen offset:0 nt
    v_perm_b32 v4, v26, v26, s80
    v_perm_b32 v5, v34, v34, s80
    v_and_b32 v52, v4, v10
    v_and_b32 v53, v4, v11
    v_and_b32 v54, v4, v12
    v_and_b32 v55, v4, v13
    v_and_b32 v56, v5, v10
    v_and_b32 v57, v5, v11
    v_and_b32 v58, v5, v12
    v_and_b32 v59, v5, v13
    v_mfma_f32_16x16x32_bf16 v[60:63], a[176:179], v[52:55], v[60:63]
    s_nop 0
    v_mfma_f32_16x16x32_bf16 v[64:67], a[176:179], v[56:59], v[64:67]
    s_waitcnt vmcnt(6)
    buffer_load_dwordx4 v[144:147], v126, s[56:59], s85 offen offset:0 nt
    v_perm_b32 v4, v26, v26, s81
    v_perm_b32 v5, v34, v34, s81
    v_and_b32 v52, v4, v10
    v_and_b32 v53, v4, v11
    v_and_b32 v54, v4, v12
    v_and_b32 v55, v4, v13
    v_and_b32 v56, v5, v10
    v_and_b32 v57, v5, v11
    v_and_b32 v58, v5, v12
    v_and_b32 v59, v5, v13
    v_mfma_f32_16x16x32_bf16 v[60:63], a[180:183], v[52:55], v[60:63]
    s_nop 0
    v_mfma_f32_16x16x32_bf16 v[64:67], a[180:183], v[56:59], v[64:67]
    s_waitcnt vmcnt(6)
    buffer_load_dwordx4 v[148:151], v127, s[56:59], s85 offen offset:256 nt
    v_perm_b32 v4, v27, v27, s80
    v_perm_b32 v5, v35, v35, s80
    v_and_b32 v52, v4, v10
    v_and_b32 v53, v4, v11
    v_and_b32 v54, v4, v12
    v_and_b32 v55, v4, v13
    v_and_b32 v56, v5, v10
    v_and_b32 v57, v5, v11
    v_and_b32 v58, v5, v12
    v_and_b32 v59, v5, v13
    v_mfma_f32_16x16x32_bf16 v[60:63], a[184:187], v[52:55], v[60:63]
    s_nop 0
    v_mfma_f32_16x16x32_bf16 v[64:67], a[184:187], v[56:59], v[64:67]
    s_waitcnt vmcnt(6)
    buffer_load_dwordx4 v[152:155], v126, s[56:59], s85 offen offset:256 nt
    v_perm_b32 v4, v27, v27, s81
    v_perm_b32 v5, v35, v35, s81
    v_and_b32 v52, v4, v10
    v_and_b32 v53, v4, v11
    v_and_b32 v54, v4, v12
    v_and_b32 v55, v4, v13
    v_and_b32 v56, v5, v10
    v_and_b32 v57, v5, v11
    v_and_b32 v58, v5, v12
    v_and_b32 v59, v5, v13
    v_mfma_f32_16x16x32_bf16 v[60:63], a[188:191], v[52:55], v[60:63]
    s_nop 0
    v_mfma_f32_16x16x32_bf16 v[64:67], a[188:191], v[56:59], v[64:67]
    s_lshl_b32 s38, s34, 11
    v_lshrrev_b32 v4, 3, v3
    v_lshlrev_b32 v4, 9, v4
    v_lshl_add_u32 v4, v2, 7, v4
    v_and_b32 v5, 7, v3
    v_lshl_add_u32 v4, v5, 2, v4
    v_add_u32 v4, s38, v4
    ds_write_b32 v4, v60 offset:0
    ds_write_b32 v4, v61 offset:32
    ds_write_b32 v4, v62 offset:64
    ds_write_b32 v4, v63 offset:96
    ds_write_b32 v4, v64 offset:1024
    ds_write_b32 v4, v65 offset:1056
    ds_write_b32 v4, v66 offset:1088
    ds_write_b32 v4, v67 offset:1120
    s_lshl_b32 s38, s34, 9
    v_and_b32 v5, 31, v1
    v_lshl_add_u32 v5, v5, 4, s38
    s_waitcnt lgkmcnt(0)
    s_add_u32 s35, s35, 0x5b
    s_and_b32 s35, s35, 0xff
    v_mov_b32 v8, s35
    s_barrier
    ds_read_b128 v[20:23], v5 offset:0
    ds_read_b128 v[24:27], v5 offset:2048
    ds_read_b128 v[28:31], v5 offset:4096
    ds_read_b128 v[32:35], v5 offset:6144
    s_lshl_b32 s38, s32, 1
    s_add_u32 s38, s38, s33
    s_lshl_b32 s38, s38, 11
    s_add_u32 s38, s38, 1048576
    s_waitcnt lgkmcnt(0)
    v_add_f32 v20, v20, v24
    v_add_f32 v28, v28, v32
    v_add_f32 v21, v21, v25
    v_add_f32 v29, v29, v33
    v_add_f32 v22, v22, v26
    v_add_f32 v30, v30, v34
    v_add_f32 v23, v23, v27
    v_add_f32 v31, v31, v35
    v_add_f32 v20, v20, v28
    v_add_f32 v21, v21, v29
    v_add_f32 v22, v22, v30
    v_add_f32 v23, v23, v31
    v_and_or_b32 v20, v20, s82, v8
    v_and_or_b32 v21, v21, s82, v8
    v_and_or_b32 v22, v22, s82, v8
    v_and_or_b32 v23, v23, s82, v8
    s_mov_b32 exec_lo, 0xffffffff
    s_mov_b32 exec_hi, 0x0
    buffer_store_dwordx4 v[20:23], v5, s[48:51], s38 offen sc1
    s_mov_b64 exec, -1
    s_waitcnt vmcnt(7)
    buffer_load_dwordx4 v[156:159], v127, s[56:59], s85 offen offset:0 nt
    s_waitcnt vmcnt(7)
    s_add_u32 s87, s87, 7
    s_add_u32 s39, s87, s88
    s_bfe_u32 s37, s39, 0x10000
    s_lshl_b32 s37, s37, 14
    s_add_u32 s85, s37, s89
    s_bfe_u32 s37, s39, 0x30001
    s_lshl_b32 s37, s37, 9
    s_add_u32 s85, s37, s85
    s_bfe_u32 s37, s39, 0x40004
    s_lshl_b32 s37, s37, 16
    s_add_u32 s85, s37, s85
    buffer_load_dwordx4 v[160:163], v76, s[52:55], s85 offen offset:0 nt
    s_waitcnt vmcnt(7)
    buffer_load_dwordx4 v[164:167], v77, s[52:55], s85 offen offset:256 nt
    s_waitcnt vmcnt(7)
    buffer_load_dwordx4 v[168:171], v76, s[52:55], s85 offen offset:256 nt
    s_waitcnt vmcnt(7)
    buffer_load_dwordx4 v[172:175], v77, s[52:55], s85 offen offset:0 nt
    s_waitcnt vmcnt(7)
    buffer_load_dwordx4 v[176:179], v126, s[56:59], s85 offen offset:0 nt
    s_waitcnt vmcnt(7)
    buffer_load_dwordx4 v[180:183], v127, s[56:59], s85 offen offset:256 nt
    s_waitcnt vmcnt(6)
    buffer_load_dwordx4 v[184:187], v126, s[56:59], s85 offen offset:256 nt
    s_waitcnt vmcnt(6)
    buffer_load_dwordx4 v[188:191], v127, s[56:59], s85 offen offset:0 nt
    s_waitcnt vmcnt(6)
    s_add_u32 s87, s87, 7
    s_add_u32 s39, s87, s88
    s_bfe_u32 s37, s39, 0x10000
    s_lshl_b32 s37, s37, 14
    s_add_u32 s85, s37, s89
    s_bfe_u32 s37, s39, 0x30001
    s_lshl_b32 s37, s37, 9
    s_add_u32 s85, s37, s85
    s_bfe_u32 s37, s39, 0x40004
    s_lshl_b32 s37, s37, 16
    s_add_u32 s85, s37, s85
    buffer_load_dwordx4 v[192:195], v76, s[52:55], s85 offen offset:0 nt
    s_waitcnt vmcnt(6)
    buffer_load_dwordx4 v[196:199], v77, s[52:55], s85 offen offset:256 nt
    s_waitcnt vmcnt(6)
    buffer_load_dwordx4 v[200:203], v76, s[52:55], s85 offen offset:256 nt
    s_waitcnt vmcnt(6)
    buffer_load_dwordx4 v[204:207], v77, s[52:55], s85 offen offset:0 nt
    buffer_load_dwordx4 v[68:71], v78, s[48:51], s91 offen offset:0 sc1
    buffer_load_dwordx4 v[72:75], v78, s[48:51], s91 offen offset:16 sc1
    s_waitcnt vmcnt(8)
    buffer_load_dwordx4 v[208:211], v126, s[56:59], s85 offen offset:0 nt
    s_waitcnt vmcnt(8)
    buffer_load_dwordx4 v[212:215], v127, s[56:59], s85 offen offset:256 nt
    s_waitcnt vmcnt(8)
    buffer_load_dwordx4 v[216:219], v126, s[56:59], s85 offen offset:256 nt
    s_waitcnt vmcnt(8)
    buffer_load_dwordx4 v[220:223], v127, s[56:59], s85 offen offset:0 nt
    s_waitcnt vmcnt(8)
    s_add_u32 s87, s87, 7
    s_add_u32 s39, s87, s88
    s_bfe_u32 s37, s39, 0x10000
    s_lshl_b32 s37, s37, 14
    s_add_u32 s85, s37, s89
    s_bfe_u32 s37, s39, 0x30001
    s_lshl_b32 s37, s37, 9
    s_add_u32 s85, s37, s85
    s_bfe_u32 s37, s39, 0x40004
    s_lshl_b32 s37, s37, 16
    s_add_u32 s85, s37, s85
    buffer_load_dwordx4 v[224:227], v76, s[52:55], s85 offen offset:0 nt
    s_waitcnt vmcnt(8)
    buffer_load_dwordx4 v[228:231], v77, s[52:55], s85 offen offset:256 nt
    s_waitcnt vmcnt(6)
L_qcheck_15:
    v_xor_b32 v68, s35, v68
    v_xor_b32 v69, s35, v69
    v_xor_b32 v70, s35, v70
    v_xor_b32 v71, s35, v71
    v_xor_b32 v72, s35, v72
    v_xor_b32 v73, s35, v73
    v_xor_b32 v74, s35, v74
    v_xor_b32 v75, s35, v75
    v_or_b32 v4, v68, v69
    v_or3_b32 v4, v4, v70, v71
    v_or3_b32 v4, v4, v72, v73
    v_or3_b32 v4, v4, v74, v75
    v_and_b32 v4, 0xff, v4
    v_cmp_ne_u32 vcc, 0, v4
    s_cbranch_vccz L_qok_16
    buffer_load_dwordx4 v[68:71], v78, s[48:51], s91 offen offset:0 sc1
    buffer_load_dwordx4 v[72:75], v78, s[48:51], s91 offen offset:16 sc1
    s_waitcnt vmcnt(0)
    s_sub_u32 s84, s84, 1
    s_cmp_lg_u32 s84, 0
    s_cbranch_scc1 L_qcheck_15
    s_branch L_end
L_qok_16:
    v_add_f32_dpp v68, v68, v68 row_ror:4 row_mask:0xf bank_mask:0xf
    v_add_f32_dpp v69, v69, v69 row_ror:4 row_mask:0xf bank_mask:0xf
    v_add_f32_dpp v70, v70, v70 row_ror:4 row_mask:0xf bank_mask:0xf
    v_add_f32_dpp v71, v71, v71 row_ror:4 row_mask:0xf bank_mask:0xf
    v_add_f32_dpp v72, v72, v72 row_ror:4 row_mask:0xf bank_mask:0xf
    v_add_f32_dpp v73, v73, v73 row_ror:4 row_mask:0xf bank_mask:0xf
    v_add_f32_dpp v74, v74, v74 row_ror:4 row_mask:0xf bank_mask:0xf
    v_add_f32_dpp v75, v75, v75 row_ror:4 row_mask:0xf bank_mask:0xf
    v_cvt_pk_bf16_f32 v68, v68, v69
    v_cvt_pk_bf16_f32 v69, v70, v71
    v_cvt_pk_bf16_f32 v70, v72, v73
    v_cvt_pk_bf16_f32 v71, v74, v75
    s_mov_b32 vcc_lo, 0xf000f
    s_mov_b32 vcc_hi, 0xf000f
    v_cndmask_b32 v80, 0, v68, vcc
    v_cndmask_b32 v81, 0, v69, vcc
    v_cndmask_b32 v82, 0, v70, vcc
    v_cndmask_b32 v83, 0, v71, vcc
    s_mov_b32 vcc_lo, 0xf000f0
    s_mov_b32 vcc_hi, 0xf000f0
    v_cndmask_b32 v84, 0, v68, vcc
    v_cndmask_b32 v85, 0, v69, vcc
    v_cndmask_b32 v86, 0, v70, vcc
    v_cndmask_b32 v87, 0, v71, vcc
    s_mov_b32 vcc_lo, 0xf000f00
    s_mov_b32 vcc_hi, 0xf000f00
    v_cndmask_b32 v88, 0, v68, vcc
    v_cndmask_b32 v89, 0, v69, vcc
    v_cndmask_b32 v90, 0, v70, vcc
    v_cndmask_b32 v91, 0, v71, vcc
    s_mov_b32 vcc_lo, 0xf000f000
    s_mov_b32 vcc_hi, 0xf000f000
    v_cndmask_b32 v92, 0, v68, vcc
    v_cndmask_b32 v93, 0, v69, vcc
    v_cndmask_b32 v94, 0, v70, vcc
    v_cndmask_b32 v95, 0, v71, vcc
    buffer_load_dwordx4 v[232:235], v76, s[52:55], s85 offen offset:256 nt
    v_mfma_f32_16x16x32_bf16 v[112:115], v[128:131], v[80:83], 0
    v_mfma_f32_16x16x32_bf16 v[112:115], v[132:135], v[84:87], v[112:115]
    s_waitcnt vmcnt(6)
    buffer_load_dwordx4 v[236:239], v77, s[52:55], s85 offen offset:0 nt
    v_mfma_f32_16x16x32_bf16 v[112:115], v[136:139], v[88:91], v[112:115]
    v_mfma_f32_16x16x32_bf16 v[112:115], v[140:143], v[92:95], v[112:115]
    s_nop 7
    v_mov_b32_dpp v122, v112 quad_perm:[0,0,0,0] row_mask:0xf bank_mask:0xf
    v_mov_b32_dpp v124, v114 quad_perm:[2,2,2,2] row_mask:0xf bank_mask:0xf
    s_nop 0
    v_add_f32_dpp v122, v113, v122 quad_perm:[1,1,1,1] row_mask:0xf bank_mask:0xf
    v_add_f32_dpp v124, v115, v124 quad_perm:[3,3,3,3] row_mask:0xf bank_mask:0xf
    v_add_f32 v122, v122, v124
    v_fma_f32 v123, v122, s83, -v120
    v_cmp_lt_f32 vcc, 0, v123
    s_cbranch_vccz L_nomax_17
    v_mul_f32 v122, s83, v122
    s_nop 1
    v_max_f32_dpp v124, v122, v122 row_ror:4 row_mask:0xf bank_mask:0xf
    s_nop 1
    v_max_f32_dpp v124, v124, v124 row_ror:8 row_mask:0xf bank_mask:0xf
    v_mov_b32 v125, v124
    s_nop 1
    v_permlane16_swap_b32 v124, v125
    v_max_f32 v124, v124, v125
    v_mov_b32 v125, v124
    s_nop 1
    v_permlane32_swap_b32 v124, v125
    v_max_f32 v124, v124, v125
    v_and_b32 v124, s82, v124
    v_max_f32 v124, v124, v120
    v_sub_f32 v125, v120, v124
    v_exp_f32 v125, v125
    v_mov_b32 v120, v124
    v_sub_f32 v123, v122, v124
    v_mul_f32 v121, v121, v125
    v_mul_f32 v116, v116, v125
    v_mul_f32 v117, v117, v125
    v_mul_f32 v118, v118, v125
    v_mul_f32 v119, v119, v125
L_nomax_17:
    v_exp_f32 v123, v123
    s_nop 0
    v_cvt_pk_bf16_f32 v124, v123, v123
    v_add_f32 v121, v121, v123
    s_nop 0
    v_and_b32_dpp v96, v124, v10 row_newbcast:0 row_mask:0xf bank_mask:0xf
    v_and_b32_dpp v97, v124, v11 row_newbcast:0 row_mask:0xf bank_mask:0xf
    v_and_b32_dpp v98, v124, v12 row_newbcast:0 row_mask:0xf bank_mask:0xf
    v_and_b32_dpp v99, v124, v13 row_newbcast:0 row_mask:0xf bank_mask:0xf
    v_and_b32_dpp v100, v124, v10 row_newbcast:4 row_mask:0xf bank_mask:0xf
    v_and_b32_dpp v101, v124, v11 row_newbcast:4 row_mask:0xf bank_mask:0xf
    v_and_b32_dpp v102, v124, v12 row_newbcast:4 row_mask:0xf bank_mask:0xf
    v_and_b32_dpp v103, v124, v13 row_newbcast:4 row_mask:0xf bank_mask:0xf
    v_and_b32_dpp v104, v124, v10 row_newbcast:8 row_mask:0xf bank_mask:0xf
    v_and_b32_dpp v105, v124, v11 row_newbcast:8 row_mask:0xf bank_mask:0xf
    v_and_b32_dpp v106, v124, v12 row_newbcast:8 row_mask:0xf bank_mask:0xf
    v_and_b32_dpp v107, v124, v13 row_newbcast:8 row_mask:0xf bank_mask:0xf
    v_and_b32_dpp v108, v124, v10 row_newbcast:12 row_mask:0xf bank_mask:0xf
    v_and_b32_dpp v109, v124, v11 row_newbcast:12 row_mask:0xf bank_mask:0xf
    v_and_b32_dpp v110, v124, v12 row_newbcast:12 row_mask:0xf bank_mask:0xf
    v_and_b32_dpp v111, v124, v13 row_newbcast:12 row_mask:0xf bank_mask:0xf
    v_mfma_f32_16x16x32_bf16 v[116:119], v[144:147], v[96:99], v[116:119]
    s_waitcnt vmcnt(6)
    buffer_load_dwordx4 v[240:243], v126, s[56:59], s85 offen offset:0 nt
    v_mfma_f32_16x16x32_bf16 v[116:119], v[148:151], v[100:103], v[116:119]
    v_mfma_f32_16x16x32_bf16 v[116:119], v[152:155], v[104:107], v[116:119]
    v_mfma_f32_16x16x32_bf16 v[116:119], v[156:159], v[108:111], v[116:119]
    s_waitcnt vmcnt(6)
    buffer_load_dwordx4 v[244:247], v127, s[56:59], s85 offen offset:256 nt
    v_mfma_f32_16x16x32_bf16 v[112:115], v[160:163], v[80:83], 0
    v_mfma_f32_16x16x32_bf16 v[112:115], v[164:167], v[84:87], v[112:115]
    v_mfma_f32_16x16x32_bf16 v[112:115], v[168:171], v[88:91], v[112:115]
    s_waitcnt vmcnt(6)
    buffer_load_dwordx4 v[248:251], v126, s[56:59], s85 offen offset:256 nt
    v_mfma_f32_16x16x32_bf16 v[112:115], v[172:175], v[92:95], v[112:115]
    s_nop 7
    v_mov_b32_dpp v122, v112 quad_perm:[0,0,0,0] row_mask:0xf bank_mask:0xf
    v_mov_b32_dpp v124, v114 quad_perm:[2,2,2,2] row_mask:0xf bank_mask:0xf
    s_nop 0
    v_add_f32_dpp v122, v113, v122 quad_perm:[1,1,1,1] row_mask:0xf bank_mask:0xf
    v_add_f32_dpp v124, v115, v124 quad_perm:[3,3,3,3] row_mask:0xf bank_mask:0xf
    v_add_f32 v122, v122, v124
    v_fma_f32 v123, v122, s83, -v120
    v_cmp_lt_f32 vcc, 0, v123
    s_cbranch_vccz L_nomax_18
    v_mul_f32 v122, s83, v122
    s_nop 1
    v_max_f32_dpp v124, v122, v122 row_ror:4 row_mask:0xf bank_mask:0xf
    s_nop 1
    v_max_f32_dpp v124, v124, v124 row_ror:8 row_mask:0xf bank_mask:0xf
    v_mov_b32 v125, v124
    s_nop 1
    v_permlane16_swap_b32 v124, v125
    v_max_f32 v124, v124, v125
    v_mov_b32 v125, v124
    s_nop 1
    v_permlane32_swap_b32 v124, v125
    v_max_f32 v124, v124, v125
    v_and_b32 v124, s82, v124
    v_max_f32 v124, v124, v120
    v_sub_f32 v125, v120, v124
    v_exp_f32 v125, v125
    v_mov_b32 v120, v124
    v_sub_f32 v123, v122, v124
    v_mul_f32 v121, v121, v125
    v_mul_f32 v116, v116, v125
    v_mul_f32 v117, v117, v125
    v_mul_f32 v118, v118, v125
    v_mul_f32 v119, v119, v125
L_nomax_18:
    v_exp_f32 v123, v123
    s_nop 0
    v_cvt_pk_bf16_f32 v124, v123, v123
    v_add_f32 v121, v121, v123
    s_nop 0
    v_and_b32_dpp v96, v124, v10 row_newbcast:0 row_mask:0xf bank_mask:0xf
    v_and_b32_dpp v97, v124, v11 row_newbcast:0 row_mask:0xf bank_mask:0xf
    v_and_b32_dpp v98, v124, v12 row_newbcast:0 row_mask:0xf bank_mask:0xf
    v_and_b32_dpp v99, v124, v13 row_newbcast:0 row_mask:0xf bank_mask:0xf
    v_and_b32_dpp v100, v124, v10 row_newbcast:4 row_mask:0xf bank_mask:0xf
    v_and_b32_dpp v101, v124, v11 row_newbcast:4 row_mask:0xf bank_mask:0xf
    v_and_b32_dpp v102, v124, v12 row_newbcast:4 row_mask:0xf bank_mask:0xf
    v_and_b32_dpp v103, v124, v13 row_newbcast:4 row_mask:0xf bank_mask:0xf
    v_and_b32_dpp v104, v124, v10 row_newbcast:8 row_mask:0xf bank_mask:0xf
    v_and_b32_dpp v105, v124, v11 row_newbcast:8 row_mask:0xf bank_mask:0xf
    v_and_b32_dpp v106, v124, v12 row_newbcast:8 row_mask:0xf bank_mask:0xf
    v_and_b32_dpp v107, v124, v13 row_newbcast:8 row_mask:0xf bank_mask:0xf
    v_and_b32_dpp v108, v124, v10 row_newbcast:12 row_mask:0xf bank_mask:0xf
    v_and_b32_dpp v109, v124, v11 row_newbcast:12 row_mask:0xf bank_mask:0xf
    v_and_b32_dpp v110, v124, v12 row_newbcast:12 row_mask:0xf bank_mask:0xf
    v_and_b32_dpp v111, v124, v13 row_newbcast:12 row_mask:0xf bank_mask:0xf
    v_mfma_f32_16x16x32_bf16 v[116:119], v[176:179], v[96:99], v[116:119]
    v_mfma_f32_16x16x32_bf16 v[116:119], v[180:183], v[100:103], v[116:119]
    s_waitcnt vmcnt(6)
    buffer_load_dwordx4 v[252:255], v127, s[56:59], s85 offen offset:0 nt
    v_mfma_f32_16x16x32_bf16 v[116:119], v[184:187], v[104:107], v[116:119]
    v_mfma_f32_16x16x32_bf16 v[116:119], v[188:191], v[108:111], v[116:119]
    v_mfma_f32_16x16x32_bf16 v[112:115], v[192:195], v[80:83], 0
    s_waitcnt vmcnt(5)
    s_add_u32 s87, s87, 7
    s_add_u32 s39, s87, s88
    s_bfe_u32 s37, s39, 0x10000
    s_lshl_b32 s37, s37, 14
    s_add_u32 s85, s37, s89
    s_bfe_u32 s37, s39, 0x30001
    s_lshl_b32 s37, s37, 9
    s_add_u32 s85, s37, s85
    s_bfe_u32 s37, s39, 0x40004
    s_lshl_b32 s37, s37, 16
    s_add_u32 s85, s37, s85
    buffer_load_dwordx4 v[128:131], v76, s[52:55], s85 offen offset:0 nt
    v_mfma_f32_16x16x32_bf16 v[112:115], v[196:199], v[84:87], v[112:115]
    v_mfma_f32_16x16x32_bf16 v[112:115], v[200:203], v[88:91], v[112:115]
    v_mfma_f32_16x16x32_bf16 v[112:115], v[204:207], v[92:95], v[112:115]
    s_nop 7
    v_mov_b32_dpp v122, v112 quad_perm:[0,0,0,0] row_mask:0xf bank_mask:0xf
    v_mov_b32_dpp v124, v114 quad_perm:[2,2,2,2] row_mask:0xf bank_mask:0xf
    s_nop 0
    v_add_f32_dpp v122, v113, v122 quad_perm:[1,1,1,1] row_mask:0xf bank_mask:0xf
    v_add_f32_dpp v124, v115, v124 quad_perm:[3,3,3,3] row_mask:0xf bank_mask:0xf
    v_add_f32 v122, v122, v124
    v_fma_f32 v123, v122, s83, -v120
    v_cmp_lt_f32 vcc, 0, v123
    s_cbranch_vccz L_nomax_19
    v_mul_f32 v122, s83, v122
    s_nop 1
    v_max_f32_dpp v124, v122, v122 row_ror:4 row_mask:0xf bank_mask:0xf
    s_nop 1
    v_max_f32_dpp v124, v124, v124 row_ror:8 row_mask:0xf bank_mask:0xf
    v_mov_b32 v125, v124
    s_nop 1
    v_permlane16_swap_b32 v124, v125
    v_max_f32 v124, v124, v125
    v_mov_b32 v125, v124
    s_nop 1
    v_permlane32_swap_b32 v124, v125
    v_max_f32 v124, v124, v125
    v_and_b32 v124, s82, v124
    v_max_f32 v124, v124, v120
    v_sub_f32 v125, v120, v124
    v_exp_f32 v125, v125
    v_mov_b32 v120, v124
    v_sub_f32 v123, v122, v124
    v_mul_f32 v121, v121, v125
    v_mul_f32 v116, v116, v125
    v_mul_f32 v117, v117, v125
    v_mul_f32 v118, v118, v125
    v_mul_f32 v119, v119, v125
L_nomax_19:
    v_exp_f32 v123, v123
    s_nop 0
    v_cvt_pk_bf16_f32 v124, v123, v123
    v_add_f32 v121, v121, v123
    s_nop 0
    v_and_b32_dpp v96, v124, v10 row_newbcast:0 row_mask:0xf bank_mask:0xf
    v_and_b32_dpp v97, v124, v11 row_newbcast:0 row_mask:0xf bank_mask:0xf
    v_and_b32_dpp v98, v124, v12 row_newbcast:0 row_mask:0xf bank_mask:0xf
    v_and_b32_dpp v99, v124, v13 row_newbcast:0 row_mask:0xf bank_mask:0xf
    v_and_b32_dpp v100, v124, v10 row_newbcast:4 row_mask:0xf bank_mask:0xf
    v_and_b32_dpp v101, v124, v11 row_newbcast:4 row_mask:0xf bank_mask:0xf
    v_and_b32_dpp v102, v124, v12 row_newbcast:4 row_mask:0xf bank_mask:0xf
    v_and_b32_dpp v103, v124, v13 row_newbcast:4 row_mask:0xf bank_mask:0xf
    v_and_b32_dpp v104, v124, v10 row_newbcast:8 row_mask:0xf bank_mask:0xf
    v_and_b32_dpp v105, v124, v11 row_newbcast:8 row_mask:0xf bank_mask:0xf
    v_and_b32_dpp v106, v124, v12 row_newbcast:8 row_mask:0xf bank_mask:0xf
    v_and_b32_dpp v107, v124, v13 row_newbcast:8 row_mask:0xf bank_mask:0xf
    v_and_b32_dpp v108, v124, v10 row_newbcast:12 row_mask:0xf bank_mask:0xf
    v_and_b32_dpp v109, v124, v11 row_newbcast:12 row_mask:0xf bank_mask:0xf
    v_and_b32_dpp v110, v124, v12 row_newbcast:12 row_mask:0xf bank_mask:0xf
    v_and_b32_dpp v111, v124, v13 row_newbcast:12 row_mask:0xf bank_mask:0xf
    s_waitcnt vmcnt(5)
    buffer_load_dwordx4 v[132:135], v77, s[52:55], s85 offen offset:256 nt
    v_mfma_f32_16x16x32_bf16 v[116:119], v[208:211], v[96:99], v[116:119]
    v_mfma_f32_16x16x32_bf16 v[116:119], v[212:215], v[100:103], v[116:119]
    v_mfma_f32_16x16x32_bf16 v[116:119], v[216:219], v[104:107], v[116:119]
    s_waitcnt vmcnt(5)
    buffer_load_dwordx4 v[136:139], v76, s[52:55], s85 offen offset:256 nt
    v_mfma_f32_16x16x32_bf16 v[116:119], v[220:223], v[108:111], v[116:119]
    v_mfma_f32_16x16x32_bf16 v[112:115], v[224:227], v[80:83], 0
    v_mfma_f32_16x16x32_bf16 v[112:115], v[228:231], v[84:87], v[112:115]
    s_waitcnt vmcnt(5)
    buffer_load_dwordx4 v[140:143], v77, s[52:55], s85 offen offset:0 nt
    v_mfma_f32_16x16x32_bf16 v[112:115], v[232:235], v[88:91], v[112:115]
    v_mfma_f32_16x16x32_bf16 v[112:115], v[236:239], v[92:95], v[112:115]
    s_nop 7
    v_mov_b32_dpp v122, v112 quad_perm:[0,0,0,0] row_mask:0xf bank_mask:0xf
    v_mov_b32_dpp v124, v114 quad_perm:[2,2,2,2] row_mask:0xf bank_mask:0xf
    s_nop 0
    v_add_f32_dpp v122, v113, v122 quad_perm:[1,1,1,1] row_mask:0xf bank_mask:0xf
    v_add_f32_dpp v124, v115, v124 quad_perm:[3,3,3,3] row_mask:0xf bank_mask:0xf
    v_add_f32 v122, v122, v124
    v_fma_f32 v123, v122, s83, -v120
    v_cmp_lt_f32 vcc, 0, v123
    s_cbranch_vccz L_nomax_20
    v_mul_f32 v122, s83, v122
    s_nop 1
    v_max_f32_dpp v124, v122, v122 row_ror:4 row_mask:0xf bank_mask:0xf
    s_nop 1
    v_max_f32_dpp v124, v124, v124 row_ror:8 row_mask:0xf bank_mask:0xf
    v_mov_b32 v125, v124
    s_nop 1
    v_permlane16_swap_b32 v124, v125
    v_max_f32 v124, v124, v125
    v_mov_b32 v125, v124
    s_nop 1
    v_permlane32_swap_b32 v124, v125
    v_max_f32 v124, v124, v125
    v_and_b32 v124, s82, v124
    v_max_f32 v124, v124, v120
    v_sub_f32 v125, v120, v124
    v_exp_f32 v125, v125
    v_mov_b32 v120, v124
    v_sub_f32 v123, v122, v124
    v_mul_f32 v121, v121, v125
    v_mul_f32 v116, v116, v125
    v_mul_f32 v117, v117, v125
    v_mul_f32 v118, v118, v125
    v_mul_f32 v119, v119, v125
L_nomax_20:
    v_exp_f32 v123, v123
    s_nop 0
    v_cvt_pk_bf16_f32 v124, v123, v123
    v_add_f32 v121, v121, v123
    s_nop 0
    v_and_b32_dpp v96, v124, v10 row_newbcast:0 row_mask:0xf bank_mask:0xf
    v_and_b32_dpp v97, v124, v11 row_newbcast:0 row_mask:0xf bank_mask:0xf
    v_and_b32_dpp v98, v124, v12 row_newbcast:0 row_mask:0xf bank_mask:0xf
    v_and_b32_dpp v99, v124, v13 row_newbcast:0 row_mask:0xf bank_mask:0xf
    v_and_b32_dpp v100, v124, v10 row_newbcast:4 row_mask:0xf bank_mask:0xf
    v_and_b32_dpp v101, v124, v11 row_newbcast:4 row_mask:0xf bank_mask:0xf
    v_and_b32_dpp v102, v124, v12 row_newbcast:4 row_mask:0xf bank_mask:0xf
    v_and_b32_dpp v103, v124, v13 row_newbcast:4 row_mask:0xf bank_mask:0xf
    v_and_b32_dpp v104, v124, v10 row_newbcast:8 row_mask:0xf bank_mask:0xf
    v_and_b32_dpp v105, v124, v11 row_newbcast:8 row_mask:0xf bank_mask:0xf
    v_and_b32_dpp v106, v124, v12 row_newbcast:8 row_mask:0xf bank_mask:0xf
    v_and_b32_dpp v107, v124, v13 row_newbcast:8 row_mask:0xf bank_mask:0xf
    v_and_b32_dpp v108, v124, v10 row_newbcast:12 row_mask:0xf bank_mask:0xf
    v_and_b32_dpp v109, v124, v11 row_newbcast:12 row_mask:0xf bank_mask:0xf
    v_and_b32_dpp v110, v124, v12 row_newbcast:12 row_mask:0xf bank_mask:0xf
    v_and_b32_dpp v111, v124, v13 row_newbcast:12 row_mask:0xf bank_mask:0xf
    v_mfma_f32_16x16x32_bf16 v[116:119], v[240:243], v[96:99], v[116:119]
    s_waitcnt vmcnt(5)
    buffer_load_dwordx4 v[144:147], v126, s[56:59], s85 offen offset:0 nt
    v_mfma_f32_16x16x32_bf16 v[116:119], v[244:247], v[100:103], v[116:119]
    v_mfma_f32_16x16x32_bf16 v[116:119], v[248:251], v[104:107], v[116:119]
    s_waitcnt vmcnt(5)
    v_mfma_f32_16x16x32_bf16 v[116:119], v[252:255], v[108:111], v[116:119]
    s_add_u32 s87, s87, 7
    s_add_u32 s39, s87, s88
    s_bfe_u32 s37, s39, 0x10000
    s_lshl_b32 s37, s37, 14
    s_add_u32 s86, s37, s89
    s_bfe_u32 s37, s39, 0x30001
    s_lshl_b32 s37, s37, 9
    s_add_u32 s86, s37, s86
    s_bfe_u32 s37, s39, 0x40004
    s_lshl_b32 s37, s37, 16
    s_add_u32 s86, s37, s86
    s_branch L_bloop
L_ql:
    v_lshlrev_b32 v4, 18, v2
    v_lshl_add_u32 v14, v3, 4, v4
    v_lshrrev_b32 v5, 3, v3
    v_lshlrev_b32 v5, 10, v5
    v_lshl_add_u32 v15, v2, 6, v5
    s_mov_b32 s36, s34
    s_lshl_b32 s37, s36, 8
    s_lshl_b32 s63, s36, 20
    s_lshl_b32 s38, s32, 8
    s_add_u32 s63, s63, s38
    s_mov_b32 s42, 4194304
    s_mov_b32 s43, 0x20000
    s_mov_b32 s46, 4096
    s_mov_b32 s47, 0x20000
    s_waitcnt lgkmcnt(0)
    s_mov_b64 s[40:41], s[8:9]
    s_mov_b64 s[44:45], s[4:5]
    s_mov_b32 s95, s63
    buffer_load_dwordx4 a[128:131], v14, s[40:43], s63 offen nt
    s_add_u32 s63, s63, 8192
    buffer_load_dwordx4 a[132:135], v14, s[40:43], s63 offen nt
    s_add_u32 s63, s63, 8192
    buffer_load_dwordx4 v[20:23], v15, s[44:47], s37 offen offset:0
    buffer_load_dwordx4 v[24:27], v15, s[44:47], s37 offen offset:16
    buffer_load_dwordx4 v[28:31], v15, s[44:47], s37 offen offset:32
    buffer_load_dwordx4 v[32:35], v15, s[44:47], s37 offen offset:48
    buffer_load_dwordx4 v[36:39], v15, s[44:47], s37 offen offset:2048
    buffer_load_dwordx4 v[40:43], v15, s[44:47], s37 offen offset:2064
    buffer_load_dwordx4 v[44:47], v15, s[44:47], s37 offen offset:2080
    buffer_load_dwordx4 v[48:51], v15, s[44:47], s37 offen offset:2096
    buffer_load_dwordx4 a[136:139], v14, s[40:43], s63 offen nt
    s_add_u32 s63, s63, 8192
    buffer_load_dwordx4 a[140:143], v14, s[40:43], s63 offen nt
    s_add_u32 s63, s63, 8192
    buffer_load_dwordx4 a[144:147], v14, s[40:43], s63 offen nt
    s_add_u32 s63, s63, 8192
    buffer_load_dwordx4 a[148:151], v14, s[40:43], s63 offen nt
    s_add_u32 s63, s63, 8192
    buffer_load_dwordx4 a[152:155], v14, s[40:43], s63 offen nt
    s_add_u32 s63, s63, 8192
    buffer_load_dwordx4 a[156:159], v14, s[40:43], s63 offen nt
    s_add_u32 s63, s63, 8192
    s_load_dword s35, s[30:31], 0
    s_mov_b32 s48, s30
    s_and_b32 s49, s31, 0xffff
    s_mov_b32 s50, 8388608
    s_mov_b32 s51, 0x20000
    s_mov_b32 s82, 0xffffff00
    s_mov_b32 s83, 0x3e0293ee
    s_mov_b32 s84, 1048576
    v_and_b32 v4, 1, v1
    v_lshlrev_b32 v4, 4, v4
    v_mov_b32 v5, 0xffff
    v_lshlrev_b32 v4, v4, v5
    v_bfe_u32 v5, v1, 1, 2
    v_cmp_eq_u32 vcc, 0, v5
    s_nop 1
    v_cndmask_b32 v10, 0, v4, vcc
    v_cmp_eq_u32 vcc, 1, v5
    s_nop 1
    v_cndmask_b32 v11, 0, v4, vcc
    v_cmp_eq_u32 vcc, 2, v5
    s_nop 1
    v_cndmask_b32 v12, 0, v4, vcc
    v_cmp_eq_u32 vcc, 3, v5
    s_nop 1
    v_cndmask_b32 v13, 0, v4, vcc
    v_lshrrev_b32 v4, 2, v3
    v_and_b32 v5, 3, v3
    v_lshlrev_b32 v76, 12, v4
    v_lshlrev_b32 v126, 12, v2
    v_lshl_add_u32 v76, v2, 6, v76
    v_lshl_add_u32 v76, v5, 4, v76
    v_lshl_add_u32 v126, v3, 4, v126
    v_xor_b32 v77, 32768, v76
    v_xor_b32 v127, 32768, v126
    s_lshl_b32 s89, s34, 5
    s_add_u32 s89, s89, s32
    s_lshl_b32 s89, s89, 20
    s_mul_i32 s88, s32, 8
    s_mul_i32 s38, s34, 1
    s_add_u32 s88, s88, s38
    s_add_u32 s87, s33, 56
    s_mov_b32 s52, s18
    s_and_b32 s53, s19, 0xffff
    s_mov_b32 s54, 134217728
    s_mov_b32 s55, 0x20000
    s_mov_b32 s56, s20
    s_and_b32 s57, s21, 0xffff
    s_mov_b32 s58, 134217728
    s_mov_b32 s59, 0x20000
    v_mov_b32 v120, 0xff7f0000
    v_mov_b32 v121, 0
    v_mov_b32 v18, 1
    v_mov_b32 v116, 0
    v_mov_b32 v117, 0
    v_mov_b32 v118, 0
    v_mov_b32 v119, 0
    s_lshl_b32 s38, s32, 2
    s_add_u32 s38, s38, s34
    s_lshl_b32 s38, s38, 8
    s_add_u32 s38, s38, 65536
    v_mov_b32 v9, s38
    v_and_b32 v5, 3, v3
    v_lshlrev_b32 v78, 7, v2
    v_lshl_add_u32 v78, v5, 5, v78
    v_bfe_u32 v4, v3, 2, 1
    v_lshl_add_u32 v78, v4, 11, v78
    s_lshl_b32 s91, s32, 12
    s_lshl_b32 s38, s34, 9
    s_add_u32 s91, s91, s38
    s_add_u32 s91, s91, 1048576
    v_lshlrev_b32 v4, 7, v2
    v_lshl_add_u32 v4, v3, 4, v4
    v_mov_b32 v5, 512
    v_cmp_gt_u32 vcc, 8, v3
    s_nop 1
    v_cndmask_b32 v79, v5, v4, vcc
    s_mov_b32 s64, s10
    s_and_b32 s65, s11, 0xffff
    s_mov_b32 s66, 4194304
    s_mov_b32 s67, 0x20000
    v_lshrrev_b32 v4, 2, v3
    v_and_b32 v5, 3, v3
    v_lshlrev_b32 v19, 18, v4
    v_lshl_add_u32 v19, v2, 6, v19
    v_lshl_add_u32 v19, v5, 4, v19
    s_mov_b32 s80, 0x01000100
    s_mov_b32 s81, 0x03020302
    s_waitcnt vmcnt(6)
    buffer_load_dwordx4 a[160:163], v14, s[40:43], s63 offen nt
    s_add_u32 s63, s63, 8192
    v_perm_b32 v4, v20, v20, s80
    v_perm_b32 v5, v36, v36, s80
    v_and_b32 v52, v4, v10
    v_and_b32 v53, v4, v11
    v_and_b32 v54, v4, v12
    v_and_b32 v55, v4, v13
    v_and_b32 v56, v5, v10
    v_and_b32 v57, v5, v11
    v_and_b32 v58, v5, v12
    v_and_b32 v59, v5, v13
    v_mfma_f32_16x16x32_bf16 v[60:63], a[128:131], v[52:55], 0
    s_nop 0
    v_mfma_f32_16x16x32_bf16 v[64:67], a[128:131], v[56:59], 0
    buffer_load_dwordx4 a[164:167], v14, s[40:43], s63 offen nt
    s_add_u32 s63, s63, 8192
    v_perm_b32 v4, v20, v20, s81
    v_perm_b32 v5, v36, v36, s81
    v_and_b32 v52, v4, v10
    v_and_b32 v53, v4, v11
    v_and_b32 v54, v4, v12
    v_and_b32 v55, v4, v13
    v_and_b32 v56, v5, v10
    v_and_b32 v57, v5, v11
    v_and_b32 v58, v5, v12
    v_and_b32 v59, v5, v13
    v_mfma_f32_16x16x32_bf16 v[60:63], a[132:135], v[52:55], v[60:63]
    s_nop 0
    v_mfma_f32_16x16x32_bf16 v[64:67], a[132:135], v[56:59], v[64:67]
    s_waitcnt vmcnt(7)
    buffer_load_dwordx4 a[168:171], v14, s[40:43], s63 offen nt
    s_add_u32 s63, s63, 8192
    v_perm_b32 v4, v21, v21, s80
    v_perm_b32 v5, v37, v37, s80
    v_and_b32 v52, v4, v10
    v_and_b32 v53, v4, v11
    v_and_b32 v54, v4, v12
    v_and_b32 v55, v4, v13
    v_and_b32 v56, v5, v10
    v_and_b32 v57, v5, v11
    v_and_b32 v58, v5, v12
    v_and_b32 v59, v5, v13
    v_mfma_f32_16x16x32_bf16 v[60:63], a[136:139], v[52:55], v[60:63]
    s_nop 0
    v_mfma_f32_16x16x32_bf16 v[64:67], a[136:139], v[56:59], v[64:67]
    s_waitcnt vmcnt(7)
    buffer_load_dwordx4 a[172:175], v14, s[40:43], s63 offen nt
    s_add_u32 s63, s63, 8192
    v_perm_b32 v4, v21, v21, s81
    v_perm_b32 v5, v37, v37, s81
    v_and_b32 v52, v4, v10
    v_and_b32 v53, v4, v11
    v_and_b32 v54, v4, v12
    v_and_b32 v55, v4, v13
    v_and_b32 v56, v5, v10
    v_and_b32 v57, v5, v11
    v_and_b32 v58, v5, v12
    v_and_b32 v59, v5, v13
    v_mfma_f32_16x16x32_bf16 v[60:63], a[140:143], v[52:55], v[60:63]
    s_nop 0
    v_mfma_f32_16x16x32_bf16 v[64:67], a[140:143], v[56:59], v[64:67]
    s_waitcnt vmcnt(7)
    buffer_load_dwordx4 a[176:179], v14, s[40:43], s63 offen nt
    s_add_u32 s63, s63, 8192
    v_perm_b32 v4, v22, v22, s80
    v_perm_b32 v5, v38, v38, s80
    v_and_b32 v52, v4, v10
    v_and_b32 v53, v4, v11
    v_and_b32 v54, v4, v12
    v_and_b32 v55, v4, v13
    v_and_b32 v56, v5, v10
    v_and_b32 v57, v5, v11
    v_and_b32 v58, v5, v12
    v_and_b32 v59, v5, v13
    v_mfma_f32_16x16x32_bf16 v[60:63], a[144:147], v[52:55], v[60:63]
    s_nop 0
    v_mfma_f32_16x16x32_bf16 v[64:67], a[144:147], v[56:59], v[64:67]
    s_waitcnt vmcnt(7)
    buffer_load_dwordx4 a[180:183], v14, s[40:43], s63 offen nt
    s_add_u32 s63, s63, 8192
    v_perm_b32 v4, v22, v22, s81
    v_perm_b32 v5, v38, v38, s81
    v_and_b32 v52, v4, v10
    v_and_b32 v53, v4, v11
    v_and_b32 v54, v4, v12
    v_and_b32 v55, v4, v13
    v_and_b32 v56, v5, v10
    v_and_b32 v57, v5, v11
    v_and_b32 v58, v5, v12
    v_and_b32 v59, v5, v13
    v_mfma_f32_16x16x32_bf16 v[60:63], a[148:151], v[52:55], v[60:63]
    s_nop 0
    v_mfma_f32_16x16x32_bf16 v[64:67], a[148:151], v[56:59], v[64:67]
    s_waitcnt vmcnt(7)
    buffer_load_dwordx4 a[184:187], v14, s[40:43], s63 offen nt
    s_add_u32 s63, s63, 8192
    v_perm_b32 v4, v23, v23, s80
    v_perm_b32 v5, v39, v39, s80
    v_and_b32 v52, v4, v10
    v_and_b32 v53, v4, v11
    v_and_b32 v54, v4, v12
    v_and_b32 v55, v4, v13
    v_and_b32 v56, v5, v10
    v_and_b32 v57, v5, v11
    v_and_b32 v58, v5, v12
    v_and_b32 v59, v5, v13
    v_mfma_f32_16x16x32_bf16 v[60:63], a[152:155], v[52:55], v[60:63]
    s_nop 0
    v_mfma_f32_16x16x32_bf16 v[64:67], a[152:155], v[56:59], v[64:67]
    s_waitcnt vmcnt(7)
    buffer_load_dwordx4 a[188:191], v14, s[40:43], s63 offen nt
    s_add_u32 s63, s63, 8192
    v_perm_b32 v4, v23, v23, s81
    v_perm_b32 v5, v39, v39, s81
    v_and_b32 v52, v4, v10
    v_and_b32 v53, v4, v11
    v_and_b32 v54, v4, v12
    v_and_b32 v55, v4, v13
    v_and_b32 v56, v5, v10
    v_and_b32 v57, v5, v11
    v_and_b32 v58, v5, v12
    v_and_b32 v59, v5, v13
    v_mfma_f32_16x16x32_bf16 v[60:63], a[156:159], v[52:55], v[60:63]
    s_nop 0
    v_mfma_f32_16x16x32_bf16 v[64:67], a[156:159], v[56:59], v[64:67]
    s_waitcnt vmcnt(7)
    buffer_load_dwordx4 a[192:195], v14, s[40:43], s63 offen nt
    s_add_u32 s63, s63, 8192
    v_perm_b32 v4, v24, v24, s80
    v_perm_b32 v5, v40, v40, s80
    v_and_b32 v52, v4, v10
    v_and_b32 v53, v4, v11
    v_and_b32 v54, v4, v12
    v_and_b32 v55, v4, v13
    v_and_b32 v56, v5, v10
    v_and_b32 v57, v5, v11
    v_and_b32 v58, v5, v12
    v_and_b32 v59, v5, v13
    v_mfma_f32_16x16x32_bf16 v[60:63], a[160:163], v[52:55], v[60:63]
    s_nop 0
    v_mfma_f32_16x16x32_bf16 v[64:67], a[160:163], v[56:59], v[64:67]
    s_waitcnt vmcnt(7)
    buffer_load_dwordx4 a[196:199], v14, s[40:43], s63 offen nt
    s_add_u32 s63, s63, 8192
    v_perm_b32 v4, v24, v24, s81
    v_perm_b32 v5, v40, v40, s81
    v_and_b32 v52, v4, v10
    v_and_b32 v53, v4, v11
    v_and_b32 v54, v4, v12
    v_and_b32 v55, v4, v13
    v_and_b32 v56, v5, v10
    v_and_b32 v57, v5, v11
    v_and_b32 v58, v5, v12
    v_and_b32 v59, v5, v13
    v_mfma_f32_16x16x32_bf16 v[60:63], a[164:167], v[52:55], v[60:63]
    s_nop 0
    v_mfma_f32_16x16x32_bf16 v[64:67], a[164:167], v[56:59], v[64:67]
    s_waitcnt vmcnt(7)
    buffer_load_dwordx4 a[200:203], v14, s[40:43], s63 offen nt
    s_add_u32 s63, s63, 8192
    v_perm_b32 v4, v25, v25, s80
    v_perm_b32 v5, v41, v41, s80
    v_and_b32 v52, v4, v10
    v_and_b32 v53, v4, v11
    v_and_b32 v54, v4, v12
    v_and_b32 v55, v4, v13
    v_and_b32 v56, v5, v10
    v_and_b32 v57, v5, v11
    v_and_b32 v58, v5, v12
    v_and_b32 v59, v5, v13
    v_mfma_f32_16x16x32_bf16 v[60:63], a[168:171], v[52:55], v[60:63]
    s_nop 0
    v_mfma_f32_16x16x32_bf16 v[64:67], a[168:171], v[56:59], v[64:67]
    s_waitcnt vmcnt(7)
    buffer_load_dwordx4 a[204:207], v14, s[40:43], s63 offen nt
    s_add_u32 s63, s63, 8192
    v_perm_b32 v4, v25, v25, s81
    v_perm_b32 v5, v41, v41, s81
    v_and_b32 v52, v4, v10
    v_and_b32 v53, v4, v11
    v_and_b32 v54, v4, v12
    v_and_b32 v55, v4, v13
    v_and_b32 v56, v5, v10
    v_and_b32 v57, v5, v11
    v_and_b32 v58, v5, v12
    v_and_b32 v59, v5, v13
    v_mfma_f32_16x16x32_bf16 v[60:63], a[172:175], v[52:55], v[60:63]
    s_nop 0
    v_mfma_f32_16x16x32_bf16 v[64:67], a[172:175], v[56:59], v[64:67]
    s_waitcnt vmcnt(7)
    buffer_load_dwordx4 a[208:211], v14, s[40:43], s63 offen nt
    s_add_u32 s63, s63, 8192
    v_perm_b32 v4, v26, v26, s80
    v_perm_b32 v5, v42, v42, s80
    v_and_b32 v52, v4, v10
    v_and_b32 v53, v4, v11
    v_and_b32 v54, v4, v12
    v_and_b32 v55, v4, v13
    v_and_b32 v56, v5, v10
    v_and_b32 v57, v5, v11
    v_and_b32 v58, v5, v12
    v_and_b32 v59, v5, v13
    v_mfma_f32_16x16x32_bf16 v[60:63], a[176:179], v[52:55], v[60:63]
    s_nop 0
    v_mfma_f32_16x16x32_bf16 v[64:67], a[176:179], v[56:59], v[64:67]
    s_waitcnt vmcnt(7)
    buffer_load_dwordx4 a[212:215], v14, s[40:43], s63 offen nt
    s_add_u32 s63, s63, 8192
    v_perm_b32 v4, v26, v26, s81
    v_perm_b32 v5, v42, v42, s81
    v_and_b32 v52, v4, v10
    v_and_b32 v53, v4, v11
    v_and_b32 v54, v4, v12
    v_and_b32 v55, v4, v13
    v_and_b32 v56, v5, v10
    v_and_b32 v57, v5, v11
    v_and_b32 v58, v5, v12
    v_and_b32 v59, v5, v13
    v_mfma_f32_16x16x32_bf16 v[60:63], a[180:183], v[52:55], v[60:63]
    s_nop 0
    v_mfma_f32_16x16x32_bf16 v[64:67], a[180:183], v[56:59], v[64:67]
    s_waitcnt vmcnt(7)
    buffer_load_dwordx4 a[216:219], v14, s[40:43], s63 offen nt
    s_add_u32 s63, s63, 8192
    v_perm_b32 v4, v27, v27, s80
    v_perm_b32 v5, v43, v43, s80
    v_and_b32 v52, v4, v10
    v_and_b32 v53, v4, v11
    v_and_b32 v54, v4, v12
    v_and_b32 v55, v4, v13
    v_and_b32 v56, v5, v10
    v_and_b32 v57, v5, v11
    v_and_b32 v58, v5, v12
    v_and_b32 v59, v5, v13
    v_mfma_f32_16x16x32_bf16 v[60:63], a[184:187], v[52:55], v[60:63]
    s_nop 0
    v_mfma_f32_16x16x32_bf16 v[64:67], a[184:187], v[56:59], v[64:67]
    s_waitcnt vmcnt(7)
    buffer_load_dwordx4 a[220:223], v14, s[40:43], s63 offen nt
    s_add_u32 s63, s63, 8192
    v_perm_b32 v4, v27, v27, s81
    v_perm_b32 v5, v43, v43, s81
    v_and_b32 v52, v4, v10
    v_and_b32 v53, v4, v11
    v_and_b32 v54, v4, v12
    v_and_b32 v55, v4, v13
    v_and_b32 v56, v5, v10
    v_and_b32 v57, v5, v11
    v_and_b32 v58, v5, v12
    v_and_b32 v59, v5, v13
    v_mfma_f32_16x16x32_bf16 v[60:63], a[188:191], v[52:55], v[60:63]
    s_nop 0
    v_mfma_f32_16x16x32_bf16 v[64:67], a[188:191], v[56:59], v[64:67]
    s_waitcnt vmcnt(7)
    buffer_load_dwordx4 a[224:227], v14, s[40:43], s63 offen nt
    s_add_u32 s63, s63, 8192
    v_perm_b32 v4, v28, v28, s80
    v_perm_b32 v5, v44, v44, s80
    v_and_b32 v52, v4, v10
    v_and_b32 v53, v4, v11
    v_and_b32 v54, v4, v12
    v_and_b32 v55, v4, v13
    v_and_b32 v56, v5, v10
    v_and_b32 v57, v5, v11
    v_and_b32 v58, v5, v12
    v_and_b32 v59, v5, v13
    v_mfma_f32_16x16x32_bf16 v[60:63], a[192:195], v[52:55], v[60:63]
    s_nop 0
    v_mfma_f32_16x16x32_bf16 v[64:67], a[192:195], v[56:59], v[64:67]
    s_waitcnt vmcnt(7)
    buffer_load_dwordx4 a[228:231], v14, s[40:43], s63 offen nt
    s_add_u32 s63, s63, 8192
    v_perm_b32 v4, v28, v28, s81
    v_perm_b32 v5, v44, v44, s81
    v_and_b32 v52, v4, v10
    v_and_b32 v53, v4, v11
    v_and_b32 v54, v4, v12
    v_and_b32 v55, v4, v13
    v_and_b32 v56, v5, v10
    v_and_b32 v57, v5, v11
    v_and_b32 v58, v5, v12
    v_and_b32 v59, v5, v13
    v_mfma_f32_16x16x32_bf16 v[60:63], a[196:199], v[52:55], v[60:63]
    s_nop 0
    v_mfma_f32_16x16x32_bf16 v[64:67], a[196:199], v[56:59], v[64:67]
    s_waitcnt vmcnt(7)
    buffer_load_dwordx4 a[232:235], v14, s[40:43], s63 offen nt
    s_add_u32 s63, s63, 8192
    v_perm_b32 v4, v29, v29, s80
    v_perm_b32 v5, v45, v45, s80
    v_and_b32 v52, v4, v10
    v_and_b32 v53, v4, v11
    v_and_b32 v54, v4, v12
    v_and_b32 v55, v4, v13
    v_and_b32 v56, v5, v10
    v_and_b32 v57, v5, v11
    v_and_b32 v58, v5, v12
    v_and_b32 v59, v5, v13
    v_mfma_f32_16x16x32_bf16 v[60:63], a[200:203], v[52:55], v[60:63]
    s_nop 0
    v_mfma_f32_16x16x32_bf16 v[64:67], a[200:203], v[56:59], v[64:67]
    s_waitcnt vmcnt(7)
    buffer_load_dwordx4 a[236:239], v14, s[40:43], s63 offen nt
    s_add_u32 s63, s63, 8192
    v_perm_b32 v4, v29, v29, s81
    v_perm_b32 v5, v45, v45, s81
    v_and_b32 v52, v4, v10
    v_and_b32 v53, v4, v11
    v_and_b32 v54, v4, v12
    v_and_b32 v55, v4, v13
    v_and_b32 v56, v5, v10
    v_and_b32 v57, v5, v11
    v_and_b32 v58, v5, v12
    v_and_b32 v59, v5, v13
    v_mfma_f32_16x16x32_bf16 v[60:63], a[204:207], v[52:55], v[60:63]
    s_nop 0
    v_mfma_f32_16x16x32_bf16 v[64:67], a[204:207], v[56:59], v[64:67]
    s_waitcnt vmcnt(7)
    buffer_load_dwordx4 a[240:243], v14, s[40:43], s63 offen nt
    s_add_u32 s63, s63, 8192
    v_perm_b32 v4, v30, v30, s80
    v_perm_b32 v5, v46, v46, s80
    v_and_b32 v52, v4, v10
    v_and_b32 v53, v4, v11
    v_and_b32 v54, v4, v12
    v_and_b32 v55, v4, v13
    v_and_b32 v56, v5, v10
    v_and_b32 v57, v5, v11
    v_and_b32 v58, v5, v12
    v_and_b32 v59, v5, v13
    v_mfma_f32_16x16x32_bf16 v[60:63], a[208:211], v[52:55], v[60:63]
    s_nop 0
    v_mfma_f32_16x16x32_bf16 v[64:67], a[208:211], v[56:59], v[64:67]
    s_waitcnt vmcnt(7)
    buffer_load_dwordx4 a[244:247], v14, s[40:43], s63 offen nt
    s_add_u32 s63, s63, 8192
    v_perm_b32 v4, v30, v30, s81
    v_perm_b32 v5, v46, v46, s81
    v_and_b32 v52, v4, v10
    v_and_b32 v53, v4, v11
    v_and_b32 v54, v4, v12
    v_and_b32 v55, v4, v13
    v_and_b32 v56, v5, v10
    v_and_b32 v57, v5, v11
    v_and_b32 v58, v5, v12
    v_and_b32 v59, v5, v13
    v_mfma_f32_16x16x32_bf16 v[60:63], a[212:215], v[52:55], v[60:63]
    s_nop 0
    v_mfma_f32_16x16x32_bf16 v[64:67], a[212:215], v[56:59], v[64:67]
    s_waitcnt vmcnt(7)
    buffer_load_dwordx4 a[248:251], v14, s[40:43], s63 offen nt
    s_add_u32 s63, s63, 8192
    v_perm_b32 v4, v31, v31, s80
    v_perm_b32 v5, v47, v47, s80
    v_and_b32 v52, v4, v10
    v_and_b32 v53, v4, v11
    v_and_b32 v54, v4, v12
    v_and_b32 v55, v4, v13
    v_and_b32 v56, v5, v10
    v_and_b32 v57, v5, v11
    v_and_b32 v58, v5, v12
    v_and_b32 v59, v5, v13
    v_mfma_f32_16x16x32_bf16 v[60:63], a[216:219], v[52:55], v[60:63]
    s_nop 0
    v_mfma_f32_16x16x32_bf16 v[64:67], a[216:219], v[56:59], v[64:67]
    s_waitcnt vmcnt(7)
    buffer_load_dwordx4 a[252:255], v14, s[40:43], s63 offen nt
    s_add_u32 s63, s63, 8192
    v_perm_b32 v4, v31, v31, s81
    v_perm_b32 v5, v47, v47, s81
    v_and_b32 v52, v4, v10
    v_and_b32 v53, v4, v11
    v_and_b32 v54, v4, v12
    v_and_b32 v55, v4, v13
    v_and_b32 v56, v5, v10
    v_and_b32 v57, v5, v11
    v_and_b32 v58, v5, v12
    v_and_b32 v59, v5, v13
    v_mfma_f32_16x16x32_bf16 v[60:63], a[220:223], v[52:55], v[60:63]
    s_nop 0
    v_mfma_f32_16x16x32_bf16 v[64:67], a[220:223], v[56:59], v[64:67]
    s_waitcnt vmcnt(7)
    buffer_load_dwordx4 a[0:3], v19, s[64:67], s95 offen nt
    s_add_u32 s95, s95, 8192
    v_perm_b32 v4, v32, v32, s80
    v_perm_b32 v5, v48, v48, s80
    v_and_b32 v52, v4, v10
    v_and_b32 v53, v4, v11
    v_and_b32 v54, v4, v12
    v_and_b32 v55, v4, v13
    v_and_b32 v56, v5, v10
    v_and_b32 v57, v5, v11
    v_and_b32 v58, v5, v12
    v_and_b32 v59, v5, v13
    v_mfma_f32_16x16x32_bf16 v[60:63], a[224:227], v[52:55], v[60:63]
    s_nop 0
    v_mfma_f32_16x16x32_bf16 v[64:67], a[224:227], v[56:59], v[64:67]
    s_waitcnt vmcnt(7)
    buffer_load_dwordx4 a[4:7], v19, s[64:67], s95 offen nt
    s_add_u32 s95, s95, 8192
    v_perm_b32 v4, v32, v32, s81
    v_perm_b32 v5, v48, v48, s81
    v_and_b32 v52, v4, v10
    v_and_b32 v53, v4, v11
    v_and_b32 v54, v4, v12
    v_and_b32 v55, v4, v13
    v_and_b32 v56, v5, v10
    v_and_b32 v57, v5, v11
    v_and_b32 v58, v5, v12
    v_and_b32 v59, v5, v13
    v_mfma_f32_16x16x32_bf16 v[60:63], a[228:231], v[52:55], v[60:63]
    s_nop 0
    v_mfma_f32_16x16x32_bf16 v[64:67], a[228:231], v[56:59], v[64:67]
    s_waitcnt vmcnt(7)
    buffer_load_dwordx4 a[8:11], v19, s[64:67], s95 offen nt
    s_add_u32 s95, s95, 8192
    v_perm_b32 v4, v33, v33, s80
    v_perm_b32 v5, v49, v49, s80
    v_and_b32 v52, v4, v10
    v_and_b32 v53, v4, v11
    v_and_b32 v54, v4, v12
    v_and_b32 v55, v4, v13
    v_and_b32 v56, v5, v10
    v_and_b32 v57, v5, v11
    v_and_b32 v58, v5, v12
    v_and_b32 v59, v5, v13
    v_mfma_f32_16x16x32_bf16 v[60:63], a[232:235], v[52:55], v[60:63]
    s_nop 0
    v_mfma_f32_16x16x32_bf16 v[64:67], a[232:235], v[56:59], v[64:67]
    s_waitcnt vmcnt(7)
    buffer_load_dwordx4 a[12:15], v19, s[64:67], s95 offen nt
    s_add_u32 s95, s95, 8192
    v_perm_b32 v4, v33, v33, s81
    v_perm_b32 v5, v49, v49, s81
    v_and_b32 v52, v4, v10
    v_and_b32 v53, v4, v11
    v_and_b32 v54, v4, v12
    v_and_b32 v55, v4, v13
    v_and_b32 v56, v5, v10
    v_and_b32 v57, v5, v11
    v_and_b32 v58, v5, v12
    v_and_b32 v59, v5, v13
    v_mfma_f32_16x16x32_bf16 v[60:63], a[236:239], v[52:55], v[60:63]
    s_nop 0
    v_mfma_f32_16x16x32_bf16 v[64:67], a[236:239], v[56:59], v[64:67]
    s_waitcnt vmcnt(7)
    buffer_load_dwordx4 a[16:19], v19, s[64:67], s95 offen nt
    s_add_u32 s95, s95, 8192
    v_perm_b32 v4, v34, v34, s80
    v_perm_b32 v5, v50, v50, s80
    v_and_b32 v52, v4, v10
    v_and_b32 v53, v4, v11
    v_and_b32 v54, v4, v12
    v_and_b32 v55, v4, v13
    v_and_b32 v56, v5, v10
    v_and_b32 v57, v5, v11
    v_and_b32 v58, v5, v12
    v_and_b32 v59, v5, v13
    v_mfma_f32_16x16x32_bf16 v[60:63], a[240:243], v[52:55], v[60:63]
    s_nop 0
    v_mfma_f32_16x16x32_bf16 v[64:67], a[240:243], v[56:59], v[64:67]
    s_waitcnt vmcnt(7)
    buffer_load_dwordx4 a[20:23], v19, s[64:67], s95 offen nt
    s_add_u32 s95, s95, 8192
    v_perm_b32 v4, v34, v34, s81
    v_perm_b32 v5, v50, v50, s81
    v_and_b32 v52, v4, v10
    v_and_b32 v53, v4, v11
    v_and_b32 v54, v4, v12
    v_and_b32 v55, v4, v13
    v_and_b32 v56, v5, v10
    v_and_b32 v57, v5, v11
    v_and_b32 v58, v5, v12
    v_and_b32 v59, v5, v13
    v_mfma_f32_16x16x32_bf16 v[60:63], a[244:247], v[52:55], v[60:63]
    s_nop 0
    v_mfma_f32_16x16x32_bf16 v[64:67], a[244:247], v[56:59], v[64:67]
    s_waitcnt vmcnt(7)
    buffer_load_dwordx4 a[24:27], v19, s[64:67], s95 offen nt
    s_add_u32 s95, s95, 8192
    v_perm_b32 v4, v35, v35, s80
    v_perm_b32 v5, v51, v51, s80
    v_and_b32 v52, v4, v10
    v_and_b32 v53, v4, v11
    v_and_b32 v54, v4, v12
    v_and_b32 v55, v4, v13
    v_and_b32 v56, v5, v10
    v_and_b32 v57, v5, v11
    v_and_b32 v58, v5, v12
    v_and_b32 v59, v5, v13
    v_mfma_f32_16x16x32_bf16 v[60:63], a[248:251], v[52:55], v[60:63]
    s_nop 0
    v_mfma_f32_16x16x32_bf16 v[64:67], a[248:251], v[56:59], v[64:67]
    s_waitcnt vmcnt(7)
    buffer_load_dwordx4 a[28:31], v19, s[64:67], s95 offen nt
    s_add_u32 s95, s95, 8192
    v_perm_b32 v4, v35, v35, s81
    v_perm_b32 v5, v51, v51, s81
    v_and_b32 v52, v4, v10
    v_and_b32 v53, v4, v11
    v_and_b32 v54, v4, v12
    v_and_b32 v55, v4, v13
    v_and_b32 v56, v5, v10
    v_and_b32 v57, v5, v11
    v_and_b32 v58, v5, v12
    v_and_b32 v59, v5, v13
    v_mfma_f32_16x16x32_bf16 v[60:63], a[252:255], v[52:55], v[60:63]
    s_nop 0
    v_mfma_f32_16x16x32_bf16 v[64:67], a[252:255], v[56:59], v[64:67]
    s_lshl_b32 s38, s34, 11
    v_lshrrev_b32 v4, 3, v3
    v_lshlrev_b32 v4, 9, v4
    v_lshl_add_u32 v4, v2, 7, v4
    v_and_b32 v5, 7, v3
    v_lshl_add_u32 v4, v5, 2, v4
    v_add_u32 v4, s38, v4
    ds_write_b32 v4, v60 offset:0
    ds_write_b32 v4, v61 offset:32
    ds_write_b32 v4, v62 offset:64
    ds_write_b32 v4, v63 offset:96
    ds_write_b32 v4, v64 offset:1024
    ds_write_b32 v4, v65 offset:1056
    ds_write_b32 v4, v66 offset:1088
    ds_write_b32 v4, v67 offset:1120
    v_lshrrev_b32 v4, 2, v3
    v_and_b32 v5, 3, v3
    v_lshlrev_b32 v6, 9, v4
    v_lshl_add_u32 v6, v2, 7, v6
    v_lshl_add_u32 v6, v5, 5, v6
    buffer_load_dwordx4 a[32:35], v19, s[64:67], s95 offen nt
    s_add_u32 s95, s95, 8192
    s_waitcnt lgkmcnt(0)
    s_add_u32 s35, s35, 0x5b
    s_and_b32 s35, s35, 0xff
    v_mov_b32 v8, s35
    s_or_b32 s68, s35, 0x6b3ac500
    s_barrier
    ds_read_b128 v[20:23], v6 offset:0
    ds_read_b128 v[24:27], v6 offset:16
    ds_read_b128 v[28:31], v6 offset:2048
    ds_read_b128 v[32:35], v6 offset:2064
    ds_read_b128 v[36:39], v6 offset:4096
    ds_read_b128 v[40:43], v6 offset:4112
    ds_read_b128 v[44:47], v6 offset:6144
    ds_read_b128 v[48:51], v6 offset:6160
    buffer_load_dwordx4 a[36:39], v19, s[64:67], s95 offen nt
    s_add_u32 s95, s95, 8192
    v_lshlrev_b32 v6, 15, v4
    v_lshl_add_u32 v6, v2, 6, v6
    v_lshl_add_u32 v6, v5, 4, v6
    s_lshl_b32 s36, s32, 10
    s_lshl_b32 s38, s34, 8
    s_add_u32 s36, s36, s38
    s_add_u32 s36, s36, 2097152
    s_waitcnt lgkmcnt(0)
    v_add_f32 v20, v20, v36
    v_add_f32 v28, v28, v44
    v_add_f32 v21, v21, v37
    v_add_f32 v29, v29, v45
    v_add_f32 v22, v22, v38
    v_add_f32 v30, v30, v46
    v_add_f32 v23, v23, v39
    v_add_f32 v31, v31, v47
    v_add_f32 v24, v24, v40
    v_add_f32 v32, v32, v48
    v_add_f32 v25, v25, v41
    v_add_f32 v33, v33, v49
    v_add_f32 v26, v26, v42
    v_add_f32 v34, v34, v50
    v_add_f32 v27, v27, v43
    v_add_f32 v35, v35, v51
    v_add_f32 v20, v20, v28
    v_add_f32 v21, v21, v29
    v_add_f32 v22, v22, v30
    v_add_f32 v23, v23, v31
    v_add_f32 v24, v24, v32
    v_add_f32 v25, v25, v33
    v_add_f32 v26, v26, v34
    v_add_f32 v27, v27, v35
    v_cvt_pk_bf16_f32 v52, v20, v21
    v_cvt_pk_bf16_f32 v53, v22, v23
    v_cvt_pk_bf16_f32 v54, v24, v25
    v_cvt_pk_bf16_f32 v55, v26, v27
    s_waitcnt vmcnt(9)
    buffer_load_dwordx4 a[40:43], v19, s[64:67], s95 offen nt
    s_add_u32 s95, s95, 8192
    v_mfma_f32_16x16x32_bf16 v[192:195], a[0:3], v[52:55], 0
    s_waitcnt vmcnt(9)
    buffer_load_dwordx4 a[44:47], v19, s[64:67], s95 offen nt
    s_add_u32 s95, s95, 8192
    v_mfma_f32_16x16x32_bf16 v[196:199], a[4:7], v[52:55], 0
    s_waitcnt vmcnt(9)
    buffer_load_dwordx4 a[48:51], v19, s[64:67], s95 offen nt
    s_add_u32 s95, s95, 8192
    v_mfma_f32_16x16x32_bf16 v[200:203], a[8:11], v[52:55], 0
    v_mov_b32_dpp v208, v192 quad_perm:[0,0,0,0] row_mask:0xf bank_mask:0xf
    v_mov_b32_dpp v4, v194 quad_perm:[2,2,2,2] row_mask:0xf bank_mask:0xf
    s_nop 0
    v_add_f32_dpp v208, v193, v208 quad_perm:[1,1,1,1] row_mask:0xf bank_mask:0xf
    v_add_f32_dpp v4, v195, v4 quad_perm:[3,3,3,3] row_mask:0xf bank_mask:0xf
    v_add_f32 v208, v208, v4
    s_waitcnt vmcnt(9)
    buffer_load_dwordx4 a[52:55], v19, s[64:67], s95 offen nt
    s_add_u32 s95, s95, 8192
    v_mfma_f32_16x16x32_bf16 v[204:207], a[12:15], v[52:55], 0
    v_mov_b32_dpp v209, v196 quad_perm:[0,0,0,0] row_mask:0xf bank_mask:0xf
    v_mov_b32_dpp v4, v198 quad_perm:[2,2,2,2] row_mask:0xf bank_mask:0xf
    s_nop 0
    v_add_f32_dpp v209, v197, v209 quad_perm:[1,1,1,1] row_mask:0xf bank_mask:0xf
    v_add_f32_dpp v4, v199, v4 quad_perm:[3,3,3,3] row_mask:0xf bank_mask:0xf
    v_add_f32 v209, v209, v4
    s_waitcnt vmcnt(9)
    buffer_load_dwordx4 a[56:59], v19, s[64:67], s95 offen nt
    s_add_u32 s95, s95, 8192
    v_mfma_f32_16x16x32_bf16 v[192:195], a[16:19], v[52:55], 0
    v_mov_b32_dpp v210, v200 quad_perm:[0,0,0,0] row_mask:0xf bank_mask:0xf
    v_mov_b32_dpp v4, v202 quad_perm:[2,2,2,2] row_mask:0xf bank_mask:0xf
    s_nop 0
    v_add_f32_dpp v210, v201, v210 quad_perm:[1,1,1,1] row_mask:0xf bank_mask:0xf
    v_add_f32_dpp v4, v203, v4 quad_perm:[3,3,3,3] row_mask:0xf bank_mask:0xf
    v_add_f32 v210, v210, v4
    s_waitcnt vmcnt(9)
    buffer_load_dwordx4 a[60:63], v19, s[64:67], s95 offen nt
    s_add_u32 s95, s95, 8192
    v_mfma_f32_16x16x32_bf16 v[196:199], a[20:23], v[52:55], 0
    v_mov_b32_dpp v211, v204 quad_perm:[0,0,0,0] row_mask:0xf bank_mask:0xf
    v_mov_b32_dpp v4, v206 quad_perm:[2,2,2,2] row_mask:0xf bank_mask:0xf
    s_nop 0
    v_add_f32_dpp v211, v205, v211 quad_perm:[1,1,1,1] row_mask:0xf bank_mask:0xf
    v_add_f32_dpp v4, v207, v4 quad_perm:[3,3,3,3] row_mask:0xf bank_mask:0xf
    v_add_f32 v211, v211, v4
    s_waitcnt vmcnt(9)
    buffer_load_dwordx4 a[64:67], v19, s[64:67], s95 offen nt
    s_add_u32 s95, s95, 8192
    v_mfma_f32_16x16x32_bf16 v[200:203], a[24:27], v[52:55], 0
    v_mov_b32_dpp v212, v192 quad_perm:[0,0,0,0] row_mask:0xf bank_mask:0xf
    v_mov_b32_dpp v4, v194 quad_perm:[2,2,2,2] row_mask:0xf bank_mask:0xf
    s_nop 0
    v_add_f32_dpp v212, v193, v212 quad_perm:[1,1,1,1] row_mask:0xf bank_mask:0xf
    v_add_f32_dpp v4, v195, v4 quad_perm:[3,3,3,3] row_mask:0xf bank_mask:0xf
    v_add_f32 v212, v212, v4
    s_waitcnt vmcnt(9)
    buffer_load_dwordx4 a[68:71], v19, s[64:67], s95 offen nt
    s_add_u32 s95, s95, 8192
    v_mfma_f32_16x16x32_bf16 v[204:207], a[28:31], v[52:55], 0
    v_mov_b32_dpp v213, v196 quad_perm:[0,0,0,0] row_mask:0xf bank_mask:0xf
    v_mov_b32_dpp v4, v198 quad_perm:[2,2,2,2] row_mask:0xf bank_mask:0xf
    s_nop 0
    v_add_f32_dpp v213, v197, v213 quad_perm:[1,1,1,1] row_mask:0xf bank_mask:0xf
    v_add_f32_dpp v4, v199, v4 quad_perm:[3,3,3,3] row_mask:0xf bank_mask:0xf
    v_add_f32 v213, v213, v4
    s_waitcnt vmcnt(9)
    buffer_load_dwordx4 a[72:75], v19, s[64:67], s95 offen nt
    s_add_u32 s95, s95, 8192
    v_mfma_f32_16x16x32_bf16 v[192:195], a[32:35], v[52:55], 0
    v_mov_b32_dpp v214, v200 quad_perm:[0,0,0,0] row_mask:0xf bank_mask:0xf
    v_mov_b32_dpp v4, v202 quad_perm:[2,2,2,2] row_mask:0xf bank_mask:0xf
    s_nop 0
    v_add_f32_dpp v214, v201, v214 quad_perm:[1,1,1,1] row_mask:0xf bank_mask:0xf
    v_add_f32_dpp v4, v203, v4 quad_perm:[3,3,3,3] row_mask:0xf bank_mask:0xf
    v_add_f32 v214, v214, v4
    s_waitcnt vmcnt(9)
    buffer_load_dwordx4 a[76:79], v19, s[64:67], s95 offen nt
    s_add_u32 s95, s95, 8192
    v_mfma_f32_16x16x32_bf16 v[196:199], a[36:39], v[52:55], 0
    v_mov_b32_dpp v215, v204 quad_perm:[0,0,0,0] row_mask:0xf bank_mask:0xf
    v_mov_b32_dpp v4, v206 quad_perm:[2,2,2,2] row_mask:0xf bank_mask:0xf
    s_nop 0
    v_add_f32_dpp v215, v205, v215 quad_perm:[1,1,1,1] row_mask:0xf bank_mask:0xf
    v_add_f32_dpp v4, v207, v4 quad_perm:[3,3,3,3] row_mask:0xf bank_mask:0xf
    v_add_f32 v215, v215, v4
    s_waitcnt vmcnt(9)
    buffer_load_dwordx4 a[80:83], v19, s[64:67], s95 offen nt
    s_add_u32 s95, s95, 8192
    v_mfma_f32_16x16x32_bf16 v[200:203], a[40:43], v[52:55], 0
    v_mov_b32_dpp v216, v192 quad_perm:[0,0,0,0] row_mask:0xf bank_mask:0xf
    v_mov_b32_dpp v4, v194 quad_perm:[2,2,2,2] row_mask:0xf bank_mask:0xf
    s_nop 0
    v_add_f32_dpp v216, v193, v216 quad_perm:[1,1,1,1] row_mask:0xf bank_mask:0xf
    v_add_f32_dpp v4, v195, v4 quad_perm:[3,3,3,3] row_mask:0xf bank_mask:0xf
    v_add_f32 v216, v216, v4
    s_waitcnt vmcnt(9)
    buffer_load_dwordx4 a[84:87], v19, s[64:67], s95 offen nt
    s_add_u32 s95, s95, 8192
    v_mfma_f32_16x16x32_bf16 v[204:207], a[44:47], v[52:55], 0
    v_mov_b32_dpp v217, v196 quad_perm:[0,0,0,0] row_mask:0xf bank_mask:0xf
    v_mov_b32_dpp v4, v198 quad_perm:[2,2,2,2] row_mask:0xf bank_mask:0xf
    s_nop 0
    v_add_f32_dpp v217, v197, v217 quad_perm:[1,1,1,1] row_mask:0xf bank_mask:0xf
    v_add_f32_dpp v4, v199, v4 quad_perm:[3,3,3,3] row_mask:0xf bank_mask:0xf
    v_add_f32 v217, v217, v4
    s_waitcnt vmcnt(9)
    buffer_load_dwordx4 a[88:91], v19, s[64:67], s95 offen nt
    s_add_u32 s95, s95, 8192
    v_mfma_f32_16x16x32_bf16 v[192:195], a[48:51], v[52:55], 0
    v_mov_b32_dpp v218, v200 quad_perm:[0,0,0,0] row_mask:0xf bank_mask:0xf
    v_mov_b32_dpp v4, v202 quad_perm:[2,2,2,2] row_mask:0xf bank_mask:0xf
    s_nop 0
    v_add_f32_dpp v218, v201, v218 quad_perm:[1,1,1,1] row_mask:0xf bank_mask:0xf
    v_add_f32_dpp v4, v203, v4 quad_perm:[3,3,3,3] row_mask:0xf bank_mask:0xf
    v_add_f32 v218, v218, v4
    s_waitcnt vmcnt(9)
    buffer_load_dwordx4 a[92:95], v19, s[64:67], s95 offen nt
    s_add_u32 s95, s95, 8192
    v_mfma_f32_16x16x32_bf16 v[196:199], a[52:55], v[52:55], 0
    v_mov_b32_dpp v219, v204 quad_perm:[0,0,0,0] row_mask:0xf bank_mask:0xf
    v_mov_b32_dpp v4, v206 quad_perm:[2,2,2,2] row_mask:0xf bank_mask:0xf
    s_nop 0
    v_add_f32_dpp v219, v205, v219 quad_perm:[1,1,1,1] row_mask:0xf bank_mask:0xf
    v_add_f32_dpp v4, v207, v4 quad_perm:[3,3,3,3] row_mask:0xf bank_mask:0xf
    v_add_f32 v219, v219, v4
    s_waitcnt vmcnt(9)
    buffer_load_dwordx4 a[96:99], v19, s[64:67], s95 offen nt
    s_add_u32 s95, s95, 8192
    v_mfma_f32_16x16x32_bf16 v[200:203], a[56:59], v[52:55], 0
    v_mov_b32_dpp v220, v192 quad_perm:[0,0,0,0] row_mask:0xf bank_mask:0xf
    v_mov_b32_dpp v4, v194 quad_perm:[2,2,2,2] row_mask:0xf bank_mask:0xf
    s_nop 0
    v_add_f32_dpp v220, v193, v220 quad_perm:[1,1,1,1] row_mask:0xf bank_mask:0xf
    v_add_f32_dpp v4, v195, v4 quad_perm:[3,3,3,3] row_mask:0xf bank_mask:0xf
    v_add_f32 v220, v220, v4
    s_waitcnt vmcnt(9)
    buffer_load_dwordx4 a[100:103], v19, s[64:67], s95 offen nt
    s_add_u32 s95, s95, 8192
    v_mfma_f32_16x16x32_bf16 v[204:207], a[60:63], v[52:55], 0
    v_mov_b32_dpp v221, v196 quad_perm:[0,0,0,0] row_mask:0xf bank_mask:0xf
    v_mov_b32_dpp v4, v198 quad_perm:[2,2,2,2] row_mask:0xf bank_mask:0xf
    s_nop 0
    v_add_f32_dpp v221, v197, v221 quad_perm:[1,1,1,1] row_mask:0xf bank_mask:0xf
    v_add_f32_dpp v4, v199, v4 quad_perm:[3,3,3,3] row_mask:0xf bank_mask:0xf
    v_add_f32 v221, v221, v4
    s_waitcnt vmcnt(9)
    buffer_load_dwordx4 a[104:107], v19, s[64:67], s95 offen nt
    s_add_u32 s95, s95, 8192
    v_mfma_f32_16x16x32_bf16 v[192:195], a[64:67], v[52:55], 0
    v_mov_b32_dpp v222, v200 quad_perm:[0,0,0,0] row_mask:0xf bank_mask:0xf
    v_mov_b32_dpp v4, v202 quad_perm:[2,2,2,2] row_mask:0xf bank_mask:0xf
    s_nop 0
    v_add_f32_dpp v222, v201, v222 quad_perm:[1,1,1,1] row_mask:0xf bank_mask:0xf
    v_add_f32_dpp v4, v203, v4 quad_perm:[3,3,3,3] row_mask:0xf bank_mask:0xf
    v_add_f32 v222, v222, v4
    s_waitcnt vmcnt(9)
    buffer_load_dwordx4 a[108:111], v19, s[64:67], s95 offen nt
    s_add_u32 s95, s95, 8192
    v_mfma_f32_16x16x32_bf16 v[196:199], a[68:71], v[52:55], 0
    v_mov_b32_dpp v223, v204 quad_perm:[0,0,0,0] row_mask:0xf bank_mask:0xf
    v_mov_b32_dpp v4, v206 quad_perm:[2,2,2,2] row_mask:0xf bank_mask:0xf
    s_nop 0
    v_add_f32_dpp v223, v205, v223 quad_perm:[1,1,1,1] row_mask:0xf bank_mask:0xf
    v_add_f32_dpp v4, v207, v4 quad_perm:[3,3,3,3] row_mask:0xf bank_mask:0xf
    v_add_f32 v223, v223, v4
    s_waitcnt vmcnt(9)
    buffer_load_dwordx4 a[112:115], v19, s[64:67], s95 offen nt
    s_add_u32 s95, s95, 8192
    v_mfma_f32_16x16x32_bf16 v[200:203], a[72:75], v[52:55], 0
    v_mov_b32_dpp v224, v192 quad_perm:[0,0,0,0] row_mask:0xf bank_mask:0xf
    v_mov_b32_dpp v4, v194 quad_perm:[2,2,2,2] row_mask:0xf bank_mask:0xf
    s_nop 0
    v_add_f32_dpp v224, v193, v224 quad_perm:[1,1,1,1] row_mask:0xf bank_mask:0xf
    v_add_f32_dpp v4, v195, v4 quad_perm:[3,3,3,3] row_mask:0xf bank_mask:0xf
    v_add_f32 v224, v224, v4
    s_waitcnt vmcnt(9)
    buffer_load_dwordx4 a[116:119], v19, s[64:67], s95 offen nt
    s_add_u32 s95, s95, 8192
    v_mfma_f32_16x16x32_bf16 v[204:207], a[76:79], v[52:55], 0
    v_mov_b32_dpp v225, v196 quad_perm:[0,0,0,0] row_mask:0xf bank_mask:0xf
    v_mov_b32_dpp v4, v198 quad_perm:[2,2,2,2] row_mask:0xf bank_mask:0xf
    s_nop 0
    v_add_f32_dpp v225, v197, v225 quad_perm:[1,1,1,1] row_mask:0xf bank_mask:0xf
    v_add_f32_dpp v4, v199, v4 quad_perm:[3,3,3,3] row_mask:0xf bank_mask:0xf
    v_add_f32 v225, v225, v4
    s_waitcnt vmcnt(9)
    buffer_load_dwordx4 a[120:123], v19, s[64:67], s95 offen nt
    s_add_u32 s95, s95, 8192
    v_mfma_f32_16x16x32_bf16 v[192:195], a[80:83], v[52:55], 0
    v_mov_b32_dpp v226, v200 quad_perm:[0,0,0,0] row_mask:0xf bank_mask:0xf
    v_mov_b32_dpp v4, v202 quad_perm:[2,2,2,2] row_mask:0xf bank_mask:0xf
    s_nop 0
    v_add_f32_dpp v226, v201, v226 quad_perm:[1,1,1,1] row_mask:0xf bank_mask:0xf
    v_add_f32_dpp v4, v203, v4 quad_perm:[3,3,3,3] row_mask:0xf bank_mask:0xf
    v_add_f32 v226, v226, v4
    s_waitcnt vmcnt(9)
    buffer_load_dwordx4 a[124:127], v19, s[64:67], s95 offen nt
    s_add_u32 s95, s95, 8192
    v_mfma_f32_16x16x32_bf16 v[196:199], a[84:87], v[52:55], 0
    v_mov_b32_dpp v227, v204 quad_perm:[0,0,0,0] row_mask:0xf bank_mask:0xf
    v_mov_b32_dpp v4, v206 quad_perm:[2,2,2,2] row_mask:0xf bank_mask:0xf
    s_nop 0
    v_add_f32_dpp v227, v205, v227 quad_perm:[1,1,1,1] row_mask:0xf bank_mask:0xf
    v_add_f32_dpp v4, v207, v4 quad_perm:[3,3,3,3] row_mask:0xf bank_mask:0xf
    v_add_f32 v227, v227, v4
    s_waitcnt vmcnt(9)
    buffer_load_dwordx4 v[68:71], v78, s[48:51], s91 offen offset:0 sc1
    buffer_load_dwordx4 v[72:75], v78, s[48:51], s91 offen offset:16 sc1
    v_mfma_f32_16x16x32_bf16 v[200:203], a[88:91], v[52:55], 0
    v_mov_b32_dpp v228, v192 quad_perm:[0,0,0,0] row_mask:0xf bank_mask:0xf
    v_mov_b32_dpp v4, v194 quad_perm:[2,2,2,2] row_mask:0xf bank_mask:0xf
    s_nop 0
    v_add_f32_dpp v228, v193, v228 quad_perm:[1,1,1,1] row_mask:0xf bank_mask:0xf
    v_add_f32_dpp v4, v195, v4 quad_perm:[3,3,3,3] row_mask:0xf bank_mask:0xf
    v_add_f32 v228, v228, v4
    s_waitcnt vmcnt(10)
    s_add_u32 s39, s87, s88
    s_bfe_u32 s37, s39, 0x10000
    s_lshl_b32 s37, s37, 14
    s_add_u32 s85, s37, s89
    s_bfe_u32 s37, s39, 0x30001
    s_lshl_b32 s37, s37, 9
    s_add_u32 s85, s37, s85
    s_bfe_u32 s37, s39, 0x40004
    s_lshl_b32 s37, s37, 16
    s_add_u32 s85, s37, s85
    buffer_load_dwordx4 v[128:131], v76, s[52:55], s85 offen offset:0 nt
    v_mfma_f32_16x16x32_bf16 v[204:207], a[92:95], v[52:55], 0
    v_mov_b32_dpp v229, v196 quad_perm:[0,0,0,0] row_mask:0xf bank_mask:0xf
    v_mov_b32_dpp v4, v198 quad_perm:[2,2,2,2] row_mask:0xf bank_mask:0xf
    s_nop 0
    v_add_f32_dpp v229, v197, v229 quad_perm:[1,1,1,1] row_mask:0xf bank_mask:0xf
    v_add_f32_dpp v4, v199, v4 quad_perm:[3,3,3,3] row_mask:0xf bank_mask:0xf
    v_add_f32 v229, v229, v4
    s_waitcnt vmcnt(10)
    buffer_load_dwordx4 v[132:135], v77, s[52:55], s85 offen offset:256 nt
    v_mfma_f32_16x16x32_bf16 v[192:195], a[96:99], v[52:55], 0
    v_mov_b32_dpp v230, v200 quad_perm:[0,0,0,0] row_mask:0xf bank_mask:0xf
    v_mov_b32_dpp v4, v202 quad_perm:[2,2,2,2] row_mask:0xf bank_mask:0xf
    s_nop 0
    v_add_f32_dpp v230, v201, v230 quad_perm:[1,1,1,1] row_mask:0xf bank_mask:0xf
    v_add_f32_dpp v4, v203, v4 quad_perm:[3,3,3,3] row_mask:0xf bank_mask:0xf
    v_add_f32 v230, v230, v4
    s_waitcnt vmcnt(10)
    buffer_load_dwordx4 v[136:139], v76, s[52:55], s85 offen offset:256 nt
    v_mfma_f32_16x16x32_bf16 v[196:199], a[100:103], v[52:55], 0
    v_mov_b32_dpp v231, v204 quad_perm:[0,0,0,0] row_mask:0xf bank_mask:0xf
    v_mov_b32_dpp v4, v206 quad_perm:[2,2,2,2] row_mask:0xf bank_mask:0xf
    s_nop 0
    v_add_f32_dpp v231, v205, v231 quad_perm:[1,1,1,1] row_mask:0xf bank_mask:0xf
    v_add_f32_dpp v4, v207, v4 quad_perm:[3,3,3,3] row_mask:0xf bank_mask:0xf
    v_add_f32 v231, v231, v4
    s_waitcnt vmcnt(10)
    buffer_load_dwordx4 v[140:143], v77, s[52:55], s85 offen offset:0 nt
    v_mfma_f32_16x16x32_bf16 v[200:203], a[104:107], v[52:55], 0
    v_mov_b32_dpp v232, v192 quad_perm:[0,0,0,0] row_mask:0xf bank_mask:0xf
    v_mov_b32_dpp v4, v194 quad_perm:[2,2,2,2] row_mask:0xf bank_mask:0xf
    s_nop 0
    v_add_f32_dpp v232, v193, v232 quad_perm:[1,1,1,1] row_mask:0xf bank_mask:0xf
    v_add_f32_dpp v4, v195, v4 quad_perm:[3,3,3,3] row_mask:0xf bank_mask:0xf
    v_add_f32 v232, v232, v4
    s_waitcnt vmcnt(10)
    buffer_load_dwordx4 v[144:147], v126, s[56:59], s85 offen offset:0 nt
    v_mfma_f32_16x16x32_bf16 v[204:207], a[108:111], v[52:55], 0
    v_mov_b32_dpp v233, v196 quad_perm:[0,0,0,0] row_mask:0xf bank_mask:0xf
    v_mov_b32_dpp v4, v198 quad_perm:[2,2,2,2] row_mask:0xf bank_mask:0xf
    s_nop 0
    v_add_f32_dpp v233, v197, v233 quad_perm:[1,1,1,1] row_mask:0xf bank_mask:0xf
    v_add_f32_dpp v4, v199, v4 quad_perm:[3,3,3,3] row_mask:0xf bank_mask:0xf
    v_add_f32 v233, v233, v4
    s_waitcnt vmcnt(10)
    buffer_load_dwordx4 v[148:151], v127, s[56:59], s85 offen offset:256 nt
    v_mfma_f32_16x16x32_bf16 v[192:195], a[112:115], v[52:55], 0
    v_mov_b32_dpp v234, v200 quad_perm:[0,0,0,0] row_mask:0xf bank_mask:0xf
    v_mov_b32_dpp v4, v202 quad_perm:[2,2,2,2] row_mask:0xf bank_mask:0xf
    s_nop 0
    v_add_f32_dpp v234, v201, v234 quad_perm:[1,1,1,1] row_mask:0xf bank_mask:0xf
    v_add_f32_dpp v4, v203, v4 quad_perm:[3,3,3,3] row_mask:0xf bank_mask:0xf
    v_add_f32 v234, v234, v4
    s_waitcnt vmcnt(10)
    buffer_load_dwordx4 v[152:155], v126, s[56:59], s85 offen offset:256 nt
    v_mfma_f32_16x16x32_bf16 v[196:199], a[116:119], v[52:55], 0
    v_mov_b32_dpp v235, v204 quad_perm:[0,0,0,0] row_mask:0xf bank_mask:0xf
    v_mov_b32_dpp v4, v206 quad_perm:[2,2,2,2] row_mask:0xf bank_mask:0xf
    s_nop 0
    v_add_f32_dpp v235, v205, v235 quad_perm:[1,1,1,1] row_mask:0xf bank_mask:0xf
    v_add_f32_dpp v4, v207, v4 quad_perm:[3,3,3,3] row_mask:0xf bank_mask:0xf
    v_add_f32 v235, v235, v4
    s_waitcnt vmcnt(10)
    buffer_load_dwordx4 v[156:159], v127, s[56:59], s85 offen offset:0 nt
    v_mfma_f32_16x16x32_bf16 v[200:203], a[120:123], v[52:55], 0
    v_mov_b32_dpp v236, v192 quad_perm:[0,0,0,0] row_mask:0xf bank_mask:0xf
    v_mov_b32_dpp v4, v194 quad_perm:[2,2,2,2] row_mask:0xf bank_mask:0xf
    s_nop 0
    v_add_f32_dpp v236, v193, v236 quad_perm:[1,1,1,1] row_mask:0xf bank_mask:0xf
    v_add_f32_dpp v4, v195, v4 quad_perm:[3,3,3,3] row_mask:0xf bank_mask:0xf
    v_add_f32 v236, v236, v4
    s_waitcnt vmcnt(10)
    s_add_u32 s87, s87, 7
    s_add_u32 s39, s87, s88
    s_bfe_u32 s37, s39, 0x10000
    s_lshl_b32 s37, s37, 14
    s_add_u32 s85, s37, s89
    s_bfe_u32 s37, s39, 0x30001
    s_lshl_b32 s37, s37, 9
    s_add_u32 s85, s37, s85
    s_bfe_u32 s37, s39, 0x40004
    s_lshl_b32 s37, s37, 16
    s_add_u32 s85, s37, s85
    buffer_load_dwordx4 v[160:163], v76, s[52:55], s85 offen offset:0 nt
    v_mfma_f32_16x16x32_bf16 v[204:207], a[124:127], v[52:55], 0
    v_mov_b32_dpp v237, v196 quad_perm:[0,0,0,0] row_mask:0xf bank_mask:0xf
    v_mov_b32_dpp v4, v198 quad_perm:[2,2,2,2] row_mask:0xf bank_mask:0xf
    s_nop 0
    v_add_f32_dpp v237, v197, v237 quad_perm:[1,1,1,1] row_mask:0xf bank_mask:0xf
    v_add_f32_dpp v4, v199, v4 quad_perm:[3,3,3,3] row_mask:0xf bank_mask:0xf
    v_add_f32 v237, v237, v4
    v_mov_b32_dpp v238, v200 quad_perm:[0,0,0,0] row_mask:0xf bank_mask:0xf
    v_mov_b32_dpp v4, v202 quad_perm:[2,2,2,2] row_mask:0xf bank_mask:0xf
    s_nop 0
    v_add_f32_dpp v238, v201, v238 quad_perm:[1,1,1,1] row_mask:0xf bank_mask:0xf
    v_add_f32_dpp v4, v203, v4 quad_perm:[3,3,3,3] row_mask:0xf bank_mask:0xf
    v_add_f32 v238, v238, v4
    v_mov_b32_dpp v239, v204 quad_perm:[0,0,0,0] row_mask:0xf bank_mask:0xf
    v_mov_b32_dpp v4, v206 quad_perm:[2,2,2,2] row_mask:0xf bank_mask:0xf
    s_nop 0
    v_add_f32_dpp v239, v205, v239 quad_perm:[1,1,1,1] row_mask:0xf bank_mask:0xf
    v_add_f32_dpp v4, v207, v4 quad_perm:[3,3,3,3] row_mask:0xf bank_mask:0xf
    v_add_f32 v239, v239, v4
    v_cvt_pk_bf16_f32 v240, v208, v209
    v_cvt_pk_bf16_f32 v241, v210, v211
    v_cvt_pk_bf16_f32 v242, v212, v213
    v_cvt_pk_bf16_f32 v243, v214, v215
    v_cvt_pk_bf16_f32 v244, v216, v217
    v_cvt_pk_bf16_f32 v245, v218, v219
    v_cvt_pk_bf16_f32 v246, v220, v221
    v_cvt_pk_bf16_f32 v247, v222, v223
    v_cvt_pk_bf16_f32 v248, v224, v225
    v_cvt_pk_bf16_f32 v249, v226, v227
    v_cvt_pk_bf16_f32 v250, v228, v229
    v_cvt_pk_bf16_f32 v251, v230, v231
    v_cvt_pk_bf16_f32 v252, v232, v233
    v_cvt_pk_bf16_f32 v253, v234, v235
    v_cvt_pk_bf16_f32 v254, v236, v237
    v_cvt_pk_bf16_f32 v255, v238, v239
    s_mov_b32 exec_lo, 0x22222222
    s_mov_b32 exec_hi, 0x22222222
    v_mov_b32 v240, v244
    v_mov_b32 v241, v245
    v_mov_b32 v242, v246
    v_mov_b32 v243, v247
    s_mov_b32 exec_lo, 0x44444444
    s_mov_b32 exec_hi, 0x44444444
    v_mov_b32 v240, v248
    v_mov_b32 v241, v249
    v_mov_b32 v242, v250
    v_mov_b32 v243, v251
    s_mov_b32 exec_lo, 0x88888888
    s_mov_b32 exec_hi, 0x88888888
    v_mov_b32 v240, v252
    v_mov_b32 v241, v253
    v_mov_b32 v242, v254
    v_mov_b32 v243, v255
    s_mov_b64 exec, -1
    buffer_store_dwordx4 v[240:243], v6, s[48:51], s36 offen sc1
    s_waitcnt vmcnt(7)
    buffer_load_dwordx4 v[164:167], v77, s[52:55], s85 offen offset:256 nt
    s_waitcnt vmcnt(7)
    buffer_load_dwordx4 v[168:171], v76, s[52:55], s85 offen offset:256 nt
    s_waitcnt vmcnt(7)
    buffer_load_dwordx4 v[172:175], v77, s[52:55], s85 offen offset:0 nt
    s_waitcnt vmcnt(7)
    buffer_load_dwordx4 v[176:179], v126, s[56:59], s85 offen offset:0 nt
    s_waitcnt vmcnt(7)
    buffer_load_dwordx4 v[180:183], v127, s[56:59], s85 offen offset:256 nt
    s_waitcnt vmcnt(7)
    buffer_load_dwordx4 v[184:187], v126, s[56:59], s85 offen offset:256 nt
    s_waitcnt vmcnt(7)
    buffer_load_dwordx4 v[188:191], v127, s[56:59], s85 offen offset:0 nt
    s_lshl_b32 s38, s34, 5
    s_add_u32 s38, s38, s32
    s_lshl_b32 s38, s38, 8
    s_add_u32 s38, s38, 131072
    v_mov_b32 v192, s38
    v_mov_b32 v193, s68
    s_waitcnt vmcnt(7)
    s_mov_b64 exec, 1
    buffer_store_dword v193, v192, s[48:51], 0 offen sc1
    s_mov_b64 exec, -1
L_qcheck_21:
    v_xor_b32 v68, s35, v68
    v_xor_b32 v69, s35, v69
    v_xor_b32 v70, s35, v70
    v_xor_b32 v71, s35, v71
    v_xor_b32 v72, s35, v72
    v_xor_b32 v73, s35, v73
    v_xor_b32 v74, s35, v74
    v_xor_b32 v75, s35, v75
    v_or_b32 v4, v68, v69
    v_or3_b32 v4, v4, v70, v71
    v_or3_b32 v4, v4, v72, v73
    v_or3_b32 v4, v4, v74, v75
    v_and_b32 v4, 0xff, v4
    v_cmp_ne_u32 vcc, 0, v4
    s_cbranch_vccz L_qok_22
    buffer_load_dwordx4 v[68:71], v78, s[48:51], s91 offen offset:0 sc1
    buffer_load_dwordx4 v[72:75], v78, s[48:51], s91 offen offset:16 sc1
    s_waitcnt vmcnt(0)
    s_sub_u32 s84, s84, 1
    s_cmp_lg_u32 s84, 0
    s_cbranch_scc1 L_qcheck_21
    s_branch L_end
L_qok_22:
    v_add_f32_dpp v68, v68, v68 row_ror:4 row_mask:0xf bank_mask:0xf
    v_add_f32_dpp v69, v69, v69 row_ror:4 row_mask:0xf bank_mask:0xf
    v_add_f32_dpp v70, v70, v70 row_ror:4 row_mask:0xf bank_mask:0xf
    v_add_f32_dpp v71, v71, v71 row_ror:4 row_mask:0xf bank_mask:0xf
    v_add_f32_dpp v72, v72, v72 row_ror:4 row_mask:0xf bank_mask:0xf
    v_add_f32_dpp v73, v73, v73 row_ror:4 row_mask:0xf bank_mask:0xf
    v_add_f32_dpp v74, v74, v74 row_ror:4 row_mask:0xf bank_mask:0xf
    v_add_f32_dpp v75, v75, v75 row_ror:4 row_mask:0xf bank_mask:0xf
    v_cvt_pk_bf16_f32 v68, v68, v69
    v_cvt_pk_bf16_f32 v69, v70, v71
    v_cvt_pk_bf16_f32 v70, v72, v73
    v_cvt_pk_bf16_f32 v71, v74, v75
    s_mov_b32 vcc_lo, 0xf000f
    s_mov_b32 vcc_hi, 0xf000f
    v_cndmask_b32 v80, 0, v68, vcc
    v_cndmask_b32 v81, 0, v69, vcc
    v_cndmask_b32 v82, 0, v70, vcc
    v_cndmask_b32 v83, 0, v71, vcc
    s_mov_b32 vcc_lo, 0xf000f0
    s_mov_b32 vcc_hi, 0xf000f0
    v_cndmask_b32 v84, 0, v68, vcc
    v_cndmask_b32 v85, 0, v69, vcc
    v_cndmask_b32 v86, 0, v70, vcc
    v_cndmask_b32 v87, 0, v71, vcc
    s_mov_b32 vcc_lo, 0xf000f00
    s_mov_b32 vcc_hi, 0xf000f00
    v_cndmask_b32 v88, 0, v68, vcc
    v_cndmask_b32 v89, 0, v69, vcc
    v_cndmask_b32 v90, 0, v70, vcc
    v_cndmask_b32 v91, 0, v71, vcc
    s_mov_b32 vcc_lo, 0xf000f000
    s_mov_b32 vcc_hi, 0xf000f000
    v_cndmask_b32 v92, 0, v68, vcc
    v_cndmask_b32 v93, 0, v69, vcc
    v_cndmask_b32 v94, 0, v70, vcc
    v_cndmask_b32 v95, 0, v71, vcc
    v_mfma_f32_16x16x32_bf16 v[112:115], v[128:131], v[80:83], 0
    s_waitcnt vmcnt(6)
    s_add_u32 s87, s87, 7
    s_add_u32 s39, s87, s88
    s_bfe_u32 s37, s39, 0x10000
    s_lshl_b32 s37, s37, 14
    s_add_u32 s85, s37, s89
    s_bfe_u32 s37, s39, 0x30001
    s_lshl_b32 s37, s37, 9
    s_add_u32 s85, s37, s85
    s_bfe_u32 s37, s39, 0x40004
    s_lshl_b32 s37, s37, 16
    s_add_u32 s85, s37, s85
    buffer_load_dwordx4 v[128:131], v76, s[52:55], s85 offen offset:0 nt
    v_mfma_f32_16x16x32_bf16 v[112:115], v[132:135], v[84:87], v[112:115]
    v_mfma_f32_16x16x32_bf16 v[112:115], v[136:139], v[88:91], v[112:115]
    s_waitcnt vmcnt(6)
    buffer_load_dwordx4 v[132:135], v77, s[52:55], s85 offen offset:256 nt
    v_mfma_f32_16x16x32_bf16 v[112:115], v[140:143], v[92:95], v[112:115]
    s_nop 7
    v_mov_b32_dpp v122, v112 quad_perm:[0,0,0,0] row_mask:0xf bank_mask:0xf
    v_mov_b32_dpp v124, v114 quad_perm:[2,2,2,2] row_mask:0xf bank_mask:0xf
    s_nop 0
    v_add_f32_dpp v122, v113, v122 quad_perm:[1,1,1,1] row_mask:0xf bank_mask:0xf
    v_add_f32_dpp v124, v115, v124 quad_perm:[3,3,3,3] row_mask:0xf bank_mask:0xf
    v_add_f32 v122, v122, v124
    v_fma_f32 v123, v122, s83, -v120
    v_cmp_lt_f32 vcc, 0, v123
    s_cbranch_vccz L_nomax_23
    v_mul_f32 v122, s83, v122
    s_nop 1
    v_max_f32_dpp v124, v122, v122 row_ror:4 row_mask:0xf bank_mask:0xf
    s_nop 1
    v_max_f32_dpp v124, v124, v124 row_ror:8 row_mask:0xf bank_mask:0xf
    v_mov_b32 v125, v124
    s_nop 1
    v_permlane16_swap_b32 v124, v125
    v_max_f32 v124, v124, v125
    v_mov_b32 v125, v124
    s_nop 1
    v_permlane32_swap_b32 v124, v125
    v_max_f32 v124, v124, v125
    v_and_b32 v124, s82, v124
    v_max_f32 v124, v124, v120
    v_sub_f32 v125, v120, v124
    v_exp_f32 v125, v125
    v_mov_b32 v120, v124
    v_sub_f32 v123, v122, v124
    v_mul_f32 v121, v121, v125
    v_mul_f32 v116, v116, v125
    v_mul_f32 v117, v117, v125
    v_mul_f32 v118, v118, v125
    v_mul_f32 v119, v119, v125
L_nomax_23:
    v_exp_f32 v123, v123
    s_nop 0
    v_cvt_pk_bf16_f32 v124, v123, v123
    v_add_f32 v121, v121, v123
    s_nop 0
    v_and_b32_dpp v96, v124, v10 row_newbcast:0 row_mask:0xf bank_mask:0xf
    v_and_b32_dpp v97, v124, v11 row_newbcast:0 row_mask:0xf bank_mask:0xf
    v_and_b32_dpp v98, v124, v12 row_newbcast:0 row_mask:0xf bank_mask:0xf
    v_and_b32_dpp v99, v124, v13 row_newbcast:0 row_mask:0xf bank_mask:0xf
    v_and_b32_dpp v100, v124, v10 row_newbcast:4 row_mask:0xf bank_mask:0xf
    v_and_b32_dpp v101, v124, v11 row_newbcast:4 row_mask:0xf bank_mask:0xf
    v_and_b32_dpp v102, v124, v12 row_newbcast:4 row_mask:0xf bank_mask:0xf
    v_and_b32_dpp v103, v124, v13 row_newbcast:4 row_mask:0xf bank_mask:0xf
    v_and_b32_dpp v104, v124, v10 row_newbcast:8 row_mask:0xf bank_mask:0xf
    v_and_b32_dpp v105, v124, v11 row_newbcast:8 row_mask:0xf bank_mask:0xf
    v_and_b32_dpp v106, v124, v12 row_newbcast:8 row_mask:0xf bank_mask:0xf
    v_and_b32_dpp v107, v124, v13 row_newbcast:8 row_mask:0xf bank_mask:0xf
    v_and_b32_dpp v108, v124, v10 row_newbcast:12 row_mask:0xf bank_mask:0xf
    v_and_b32_dpp v109, v124, v11 row_newbcast:12 row_mask:0xf bank_mask:0xf
    v_and_b32_dpp v110, v124, v12 row_newbcast:12 row_mask:0xf bank_mask:0xf
    v_and_b32_dpp v111, v124, v13 row_newbcast:12 row_mask:0xf bank_mask:0xf
    v_mfma_f32_16x16x32_bf16 v[116:119], v[144:147], v[96:99], v[116:119]
    v_mfma_f32_16x16x32_bf16 v[116:119], v[148:151], v[100:103], v[116:119]
    s_waitcnt vmcnt(6)
    buffer_load_dwordx4 v[136:139], v76, s[52:55], s85 offen offset:256 nt
    v_mfma_f32_16x16x32_bf16 v[116:119], v[152:155], v[104:107], v[116:119]
    v_mfma_f32_16x16x32_bf16 v[116:119], v[156:159], v[108:111], v[116:119]
    v_mfma_f32_16x16x32_bf16 v[112:115], v[160:163], v[80:83], 0
    s_waitcnt vmcnt(6)
    buffer_load_dwordx4 v[140:143], v77, s[52:55], s85 offen offset:0 nt
    v_mfma_f32_16x16x32_bf16 v[112:115], v[164:167], v[84:87], v[112:115]
    v_mfma_f32_16x16x32_bf16 v[112:115], v[168:171], v[88:91], v[112:115]
    v_mfma_f32_16x16x32_bf16 v[112:115], v[172:175], v[92:95], v[112:115]
    s_nop 7
    v_mov_b32_dpp v122, v112 quad_perm:[0,0,0,0] row_mask:0xf bank_mask:0xf
    v_mov_b32_dpp v124, v114 quad_perm:[2,2,2,2] row_mask:0xf bank_mask:0xf
    s_nop 0
    v_add_f32_dpp v122, v113, v122 quad_perm:[1,1,1,1] row_mask:0xf bank_mask:0xf
    v_add_f32_dpp v124, v115, v124 quad_perm:[3,3,3,3] row_mask:0xf bank_mask:0xf
    v_add_f32 v122, v122, v124
    v_fma_f32 v123, v122, s83, -v120
    v_cmp_lt_f32 vcc, 0, v123
    s_cbranch_vccz L_nomax_24
    v_mul_f32 v122, s83, v122
    s_nop 1
    v_max_f32_dpp v124, v122, v122 row_ror:4 row_mask:0xf bank_mask:0xf
    s_nop 1
    v_max_f32_dpp v124, v124, v124 row_ror:8 row_mask:0xf bank_mask:0xf
    v_mov_b32 v125, v124
    s_nop 1
    v_permlane16_swap_b32 v124, v125
    v_max_f32 v124, v124, v125
    v_mov_b32 v125, v124
    s_nop 1
    v_permlane32_swap_b32 v124, v125
    v_max_f32 v124, v124, v125
    v_and_b32 v124, s82, v124
    v_max_f32 v124, v124, v120
    v_sub_f32 v125, v120, v124
    v_exp_f32 v125, v125
    v_mov_b32 v120, v124
    v_sub_f32 v123, v122, v124
    v_mul_f32 v121, v121, v125
    v_mul_f32 v116, v116, v125
    v_mul_f32 v117, v117, v125
    v_mul_f32 v118, v118, v125
    v_mul_f32 v119, v119, v125
L_nomax_24:
    v_exp_f32 v123, v123
    s_nop 0
    v_cvt_pk_bf16_f32 v124, v123, v123
    v_add_f32 v121, v121, v123
    s_nop 0
    v_and_b32_dpp v96, v124, v10 row_newbcast:0 row_mask:0xf bank_mask:0xf
    v_and_b32_dpp v97, v124, v11 row_newbcast:0 row_mask:0xf bank_mask:0xf
    v_and_b32_dpp v98, v124, v12 row_newbcast:0 row_mask:0xf bank_mask:0xf
    v_and_b32_dpp v99, v124, v13 row_newbcast:0 row_mask:0xf bank_mask:0xf
    v_and_b32_dpp v100, v124, v10 row_newbcast:4 row_mask:0xf bank_mask:0xf
    v_and_b32_dpp v101, v124, v11 row_newbcast:4 row_mask:0xf bank_mask:0xf
    v_and_b32_dpp v102, v124, v12 row_newbcast:4 row_mask:0xf bank_mask:0xf
    v_and_b32_dpp v103, v124, v13 row_newbcast:4 row_mask:0xf bank_mask:0xf
    v_and_b32_dpp v104, v124, v10 row_newbcast:8 row_mask:0xf bank_mask:0xf
    v_and_b32_dpp v105, v124, v11 row_newbcast:8 row_mask:0xf bank_mask:0xf
    v_and_b32_dpp v106, v124, v12 row_newbcast:8 row_mask:0xf bank_mask:0xf
    v_and_b32_dpp v107, v124, v13 row_newbcast:8 row_mask:0xf bank_mask:0xf
    v_and_b32_dpp v108, v124, v10 row_newbcast:12 row_mask:0xf bank_mask:0xf
    v_and_b32_dpp v109, v124, v11 row_newbcast:12 row_mask:0xf bank_mask:0xf
    v_and_b32_dpp v110, v124, v12 row_newbcast:12 row_mask:0xf bank_mask:0xf
    v_and_b32_dpp v111, v124, v13 row_newbcast:12 row_mask:0xf bank_mask:0xf
    s_waitcnt vmcnt(6)
    buffer_load_dwordx4 v[144:147], v126, s[56:59], s85 offen offset:0 nt
    v_mfma_f32_16x16x32_bf16 v[116:119], v[176:179], v[96:99], v[116:119]
    v_mfma_f32_16x16x32_bf16 v[116:119], v[180:183], v[100:103], v[116:119]
    v_mfma_f32_16x16x32_bf16 v[116:119], v[184:187], v[104:107], v[116:119]
    s_waitcnt vmcnt(6)
    v_mfma_f32_16x16x32_bf16 v[116:119], v[188:191], v[108:111], v[116:119]
    s_add_u32 s87, s87, 7
    s_add_u32 s39, s87, s88
    s_bfe_u32 s37, s39, 0x10000
    s_lshl_b32 s37, s37, 14
    s_add_u32 s86, s37, s89
    s_bfe_u32 s37, s39, 0x30001
    s_lshl_b32 s37, s37, 9
    s_add_u32 s86, s37, s86
    s_bfe_u32 s37, s39, 0x40004
    s_lshl_b32 s37, s37, 16
    s_add_u32 s86, s37, s86
    s_branch L_bloop
L_aux:
    v_lshlrev_b32 v4, 2, v2
    v_xor_b32 v4, v4, v3
    v_xor_b32 v96, 0, v4
    v_lshlrev_b32 v96, 4, v96
    v_lshl_add_u32 v10, v2, 13, v96
    v_xor_b32 v97, 1, v4
    v_lshlrev_b32 v97, 4, v97
    v_lshl_add_u32 v11, v2, 13, v97
    v_add_u32 v11, 31744, v11
    v_xor_b32 v98, 2, v4
    v_lshlrev_b32 v98, 4, v98
    v_lshl_add_u32 v12, v2, 13, v98
    v_add_u32 v12, 63488, v12
    v_xor_b32 v99, 3, v4
    v_lshlrev_b32 v99, 4, v99
    v_lshl_add_u32 v13, v2, 13, v99
    v_add_u32 v13, 95232, v13
    s_lshl_b32 s90, s34, 15
    s_mov_b32 s62, 0
    s_mov_b32 s94, 0
    s_lshl_b32 s95, s34, 20
    s_lshl_b32 s38, s32, 8
    s_add_u32 s95, s95, s38
    s_waitcnt lgkmcnt(0)
    s_mov_b32 s52, s12
    s_and_b32 s53, s13, 0xffff
    s_mov_b32 s54, 4194304
    s_mov_b32 s55, 0x20000
    s_add_u32 s39, s90, s62
    s_mov_b32 m0, s39
    s_add_u32 s62, s62, 4096
    s_and_b32 s62, s62, 0x7fff
    buffer_load_dwordx4 v10, s[52:55], s95 offen offset:0 nt lds
    buffer_load_dwordx4 v11, s[52:55], s95 offen offset:1024 nt lds
    buffer_load_dwordx4 v12, s[52:55], s95 offen offset:2048 nt lds
    buffer_load_dwordx4 v13, s[52:55], s95 offen offset:3072 nt lds
    s_add_u32 s95, s95, 131072
    s_add_u32 s39, s90, s62
    s_mov_b32 m0, s39
    s_add_u32 s62, s62, 4096
    s_and_b32 s62, s62, 0x7fff
    buffer_load_dwordx4 v10, s[52:55], s95 offen offset:0 nt lds
    buffer_load_dwordx4 v11, s[52:55], s95 offen offset:1024 nt lds
    buffer_load_dwordx4 v12, s[52:55], s95 offen offset:2048 nt lds
    buffer_load_dwordx4 v13, s[52:55], s95 offen offset:3072 nt lds
    s_add_u32 s95, s95, 131072
    s_load_dword s35, s[30:31], 0
    s_mov_b32 s48, s30
    s_and_b32 s49, s31, 0xffff
    s_mov_b32 s50, 8388608
    s_mov_b32 s51, 0x20000
    s_mov_b32 s82, 0xffffff00
    s_mov_b32 s83, 0x3e0293ee
    s_mov_b32 s84, 1048576
    s_mov_b32 s72, s26
    s_and_b32 s73, s27, 0xffff
    s_mov_b32 s74, 8192
    s_mov_b32 s75, 0x20000
    v_lshl_add_u32 v76, v2, 10, v96
    v_lshl_add_u32 v96, v2, 8, v96
    v_lshl_add_u32 v77, v2, 10, v97
    v_lshl_add_u32 v97, v2, 8, v97
    v_add_u32 v77, 3072, v77
    v_lshl_add_u32 v78, v2, 10, v98
    v_lshl_add_u32 v98, v2, 8, v98
    v_add_u32 v78, 6144, v78
    v_lshl_add_u32 v79, v2, 10, v99
    v_lshl_add_u32 v99, v2, 8, v99
    v_add_u32 v79, 9216, v79
    v_mov_b32 v100, 0
    v_and_b32 v101, 31, v1
    s_lshl_b32 s38, s34, 13
    v_lshl_add_u32 v101, v101, 8, s38
    v_lshlrev_b32 v4, 4, v3
    v_lshl_add_u32 v19, v2, 13, v4
    v_lshl_add_u32 v9, v2, 10, v4
    s_lshl_b32 s63, s32, 17
    s_lshl_b32 s38, s34, 8
    s_add_u32 s63, s63, s38
    v_and_b32 v4, 3, v1
    v_bfe_u32 v5, v1, 2, 2
    v_lshrrev_b32 v6, 5, v1
    v_lshl_add_u32 v7, v4, 2, v5
    v_xor_b32 v7, v7, v6
    v_lshlrev_b32 v7, 4, v7
    v_and_b32 v80, 31, v1
    v_lshl_add_u32 v80, v80, 8, v7
    v_lshl_add_u32 v81, v6, 2, v5
    v_lshlrev_b32 v81, 8, v81
    v_lshl_add_u32 v81, v5, 6, v81
    v_bfe_u32 v7, v1, 4, 1
    v_lshlrev_b32 v7, 1, v7
    v_bfe_u32 v82, v1, 1, 1
    v_add_u32 v7, v7, v82
    v_xor_b32 v7, v7, v6
    v_lshl_add_u32 v81, v7, 4, v81
    v_and_b32 v7, 1, v1
    v_lshl_add_u32 v81, v7, 3, v81
    v_lshl_add_u32 v95, v2, 3, v5
    v_lshlrev_b32 v95, 8, v95
    v_lshl_add_u32 v95, v5, 6, v95
    v_bfe_u32 v4, v1, 4, 1
    v_lshl_add_u32 v4, v4, 1, v82
    v_lshl_add_u32 v95, v4, 4, v95
    v_lshl_add_u32 v95, v7, 3, v95
    v_add_u32 v95, s90, v95
    v_xor_b32 v136, 0, v95
    v_xor_b32 v137, 16, v95
    v_xor_b32 v138, 32, v95
    v_xor_b32 v139, 48, v95
    v_xor_b32 v140, 64, v95
    v_xor_b32 v141, 80, v95
    v_xor_b32 v142, 96, v95
    v_xor_b32 v143, 112, v95
    v_xor_b32 v144, 128, v95
    v_xor_b32 v145, 144, v95
    v_xor_b32 v146, 160, v95
    v_xor_b32 v147, 176, v95
    v_xor_b32 v148, 192, v95
    v_xor_b32 v149, 208, v95
    v_xor_b32 v150, 224, v95
    v_xor_b32 v151, 240, v95
    s_lshl_b32 s85, s34, 13
    s_add_u32 s85, s85, 131072
    v_lshl_add_u32 v94, v1, 4, s85
    v_add_u32 v96, s85, v96
    v_add_u32 v97, s85, v97
    v_add_u32 v98, s85, v98
    v_add_u32 v99, s85, v99
    s_add_u32 s39, s90, s62
    s_mov_b32 m0, s39
    s_add_u32 s62, s62, 4096
    s_and_b32 s62, s62, 0x7fff
    buffer_load_dwordx4 v10, s[52:55], s95 offen offset:0 nt lds
    buffer_load_dwordx4 v11, s[52:55], s95 offen offset:1024 nt lds
    buffer_load_dwordx4 v12, s[52:55], s95 offen offset:2048 nt lds
    buffer_load_dwordx4 v13, s[52:55], s95 offen offset:3072 nt lds
    s_add_u32 s95, s95, 131072
    s_add_u32 s39, s90, s62
    s_mov_b32 m0, s39
    s_add_u32 s62, s62, 4096
    s_and_b32 s62, s62, 0x7fff
    buffer_load_dwordx4 v10, s[52:55], s95 offen offset:0 nt lds
    buffer_load_dwordx4 v11, s[52:55], s95 offen offset:1024 nt lds
    buffer_load_dwordx4 v12, s[52:55], s95 offen offset:2048 nt lds
    buffer_load_dwordx4 v13, s[52:55], s95 offen offset:3072 nt lds
    s_add_u32 s95, s95, 131072
    s_add_u32 s39, s90, s62
    s_mov_b32 m0, s39
    s_add_u32 s62, s62, 4096
    s_and_b32 s62, s62, 0x7fff
    buffer_load_dwordx4 v10, s[52:55], s95 offen offset:0 nt lds
    buffer_load_dwordx4 v11, s[52:55], s95 offen offset:1024 nt lds
    buffer_load_dwordx4 v12, s[52:55], s95 offen offset:2048 nt lds
    buffer_load_dwordx4 v13, s[52:55], s95 offen offset:3072 nt lds
    s_add_u32 s95, s95, 131072
    s_add_u32 s39, s90, s62
    s_mov_b32 m0, s39
    s_add_u32 s62, s62, 4096
    s_and_b32 s62, s62, 0x7fff
    buffer_load_dwordx4 v10, s[52:55], s95 offen offset:0 nt lds
    buffer_load_dwordx4 v11, s[52:55], s95 offen offset:1024 nt lds
    buffer_load_dwordx4 v12, s[52:55], s95 offen offset:2048 nt lds
    buffer_load_dwordx4 v13, s[52:55], s95 offen offset:3072 nt lds
    s_add_u32 s95, s95, 131072
    s_add_u32 s39, s90, s62
    s_mov_b32 m0, s39
    s_add_u32 s62, s62, 4096
    s_and_b32 s62, s62, 0x7fff
    buffer_load_dwordx4 v10, s[52:55], s95 offen offset:0 nt lds
    buffer_load_dwordx4 v11, s[52:55], s95 offen offset:1024 nt lds
    buffer_load_dwordx4 v12, s[52:55], s95 offen offset:2048 nt lds
    buffer_load_dwordx4 v13, s[52:55], s95 offen offset:3072 nt lds
    s_add_u32 s95, s95, 131072
    s_add_u32 s39, s90, s62
    s_mov_b32 m0, s39
    s_add_u32 s62, s62, 4096
    s_and_b32 s62, s62, 0x7fff
    buffer_load_dwordx4 v10, s[52:55], s95 offen offset:0 nt lds
    buffer_load_dwordx4 v11, s[52:55], s95 offen offset:1024 nt lds
    buffer_load_dwordx4 v12, s[52:55], s95 offen offset:2048 nt lds
    buffer_load_dwordx4 v13, s[52:55], s95 offen offset:3072 nt lds
    s_add_u32 s95, s95, 131072
    s_waitcnt lgkmcnt(0)
    s_add_u32 s35, s35, 0x5b
    s_and_b32 s35, s35, 0xff
    v_mov_b32 v8, s35
    s_or_b32 s68, s35, 0x6b3ac500
    s_mov_b32 s52, s14
    s_and_b32 s53, s15, 0xffff
    s_mov_b32 s54, 4194304
    s_mov_b32 s55, 0x20000
    s_mov_b32 s95, s63
    s_waitcnt vmcnt(24)
    ds_read_b64_tr_b16 a[128:129], v136 offset:0
    ds_read_b64_tr_b16 a[130:131], v137 offset:1024
    ds_read_b64_tr_b16 a[144:145], v138 offset:0
    ds_read_b64_tr_b16 a[146:147], v139 offset:1024
    ds_read_b64_tr_b16 a[160:161], v140 offset:0
    ds_read_b64_tr_b16 a[162:163], v141 offset:1024
    ds_read_b64_tr_b16 a[176:177], v142 offset:0
    ds_read_b64_tr_b16 a[178:179], v143 offset:1024
    ds_read_b64_tr_b16 a[192:193], v144 offset:0
    ds_read_b64_tr_b16 a[194:195], v145 offset:1024
    ds_read_b64_tr_b16 a[208:209], v146 offset:0
    ds_read_b64_tr_b16 a[210:211], v147 offset:1024
    ds_read_b64_tr_b16 a[224:225], v148 offset:0
    ds_read_b64_tr_b16 a[226:227], v149 offset:1024
    ds_read_b64_tr_b16 a[240:241], v150 offset:0
    ds_read_b64_tr_b16 a[242:243], v151 offset:1024
    s_waitcnt lgkmcnt(0)
    s_add_u32 s39, s90, s62
    s_mov_b32 m0, s39
    s_add_u32 s62, s62, 4096
    s_and_b32 s62, s62, 0x7fff
    buffer_load_dwordx4 v76, s[52:55], s95 offen offset:0 nt lds
    buffer_load_dwordx4 v77, s[52:55], s95 offen offset:1024 nt lds
    buffer_load_dwordx4 v78, s[52:55], s95 offen offset:2048 nt lds
    buffer_load_dwordx4 v79, s[52:55], s95 offen offset:3072 nt lds
    s_add_u32 s95, s95, 16384
    s_add_u32 s39, s90, s62
    s_mov_b32 m0, s39
    s_add_u32 s62, s62, 4096
    s_and_b32 s62, s62, 0x7fff
    buffer_load_dwordx4 v76, s[52:55], s95 offen offset:0 nt lds
    buffer_load_dwordx4 v77, s[52:55], s95 offen offset:1024 nt lds
    buffer_load_dwordx4 v78, s[52:55], s95 offen offset:2048 nt lds
    buffer_load_dwordx4 v79, s[52:55], s95 offen offset:3072 nt lds
    s_add_u32 s95, s95, 16384
    s_waitcnt vmcnt(24)
    ds_read_b64_tr_b16 a[132:133], v136 offset:8192
    ds_read_b64_tr_b16 a[134:135], v137 offset:9216
    ds_read_b64_tr_b16 a[148:149], v138 offset:8192
    ds_read_b64_tr_b16 a[150:151], v139 offset:9216
    ds_read_b64_tr_b16 a[164:165], v140 offset:8192
    ds_read_b64_tr_b16 a[166:167], v141 offset:9216
    ds_read_b64_tr_b16 a[180:181], v142 offset:8192
    ds_read_b64_tr_b16 a[182:183], v143 offset:9216
    ds_read_b64_tr_b16 a[196:197], v144 offset:8192
    ds_read_b64_tr_b16 a[198:199], v145 offset:9216
    ds_read_b64_tr_b16 a[212:213], v146 offset:8192
    ds_read_b64_tr_b16 a[214:215], v147 offset:9216
    ds_read_b64_tr_b16 a[228:229], v148 offset:8192
    ds_read_b64_tr_b16 a[230:231], v149 offset:9216
    ds_read_b64_tr_b16 a[244:245], v150 offset:8192
    ds_read_b64_tr_b16 a[246:247], v151 offset:9216
    s_waitcnt lgkmcnt(0)
    s_add_u32 s39, s90, s62
    s_mov_b32 m0, s39
    s_add_u32 s62, s62, 4096
    s_and_b32 s62, s62, 0x7fff
    buffer_load_dwordx4 v76, s[52:55], s95 offen offset:0 nt lds
    buffer_load_dwordx4 v77, s[52:55], s95 offen offset:1024 nt lds
    buffer_load_dwordx4 v78, s[52:55], s95 offen offset:2048 nt lds
    buffer_load_dwordx4 v79, s[52:55], s95 offen offset:3072 nt lds
    s_add_u32 s95, s95, 16384
    s_add_u32 s39, s90, s62
    s_mov_b32 m0, s39
    s_add_u32 s62, s62, 4096
    s_and_b32 s62, s62, 0x7fff
    buffer_load_dwordx4 v76, s[52:55], s95 offen offset:0 nt lds
    buffer_load_dwordx4 v77, s[52:55], s95 offen offset:1024 nt lds
    buffer_load_dwordx4 v78, s[52:55], s95 offen offset:2048 nt lds
    buffer_load_dwordx4 v79, s[52:55], s95 offen offset:3072 nt lds
    s_add_u32 s95, s95, 16384
    s_waitcnt vmcnt(24)
    ds_read_b64_tr_b16 a[136:137], v136 offset:16384
    ds_read_b64_tr_b16 a[138:139], v137 offset:17408
    ds_read_b64_tr_b16 a[152:153], v138 offset:16384
    ds_read_b64_tr_b16 a[154:155], v139 offset:17408
    ds_read_b64_tr_b16 a[168:169], v140 offset:16384
    ds_read_b64_tr_b16 a[170:171], v141 offset:17408
    ds_read_b64_tr_b16 a[184:185], v142 offset:16384
    ds_read_b64_tr_b16 a[186:187], v143 offset:17408
    ds_read_b64_tr_b16 a[200:201], v144 offset:16384
    ds_read_b64_tr_b16 a[202:203], v145 offset:17408
    ds_read_b64_tr_b16 a[216:217], v146 offset:16384
    ds_read_b64_tr_b16 a[218:219], v147 offset:17408
    ds_read_b64_tr_b16 a[232:233], v148 offset:16384
    ds_read_b64_tr_b16 a[234:235], v149 offset:17408
    ds_read_b64_tr_b16 a[248:249], v150 offset:16384
    ds_read_b64_tr_b16 a[250:251], v151 offset:17408
    s_waitcnt lgkmcnt(0)
    s_add_u32 s39, s90, s62
    s_mov_b32 m0, s39
    s_add_u32 s62, s62, 4096
    s_and_b32 s62, s62, 0x7fff
    buffer_load_dwordx4 v76, s[52:55], s95 offen offset:0 nt lds
    buffer_load_dwordx4 v77, s[52:55], s95 offen offset:1024 nt lds
    buffer_load_dwordx4 v78, s[52:55], s95 offen offset:2048 nt lds
    buffer_load_dwordx4 v79, s[52:55], s95 offen offset:3072 nt lds
    s_add_u32 s95, s95, 16384
    s_add_u32 s39, s90, s62
    s_mov_b32 m0, s39
    s_add_u32 s62, s62, 4096
    s_and_b32 s62, s62, 0x7fff
    buffer_load_dwordx4 v76, s[52:55], s95 offen offset:0 nt lds
    buffer_load_dwordx4 v77, s[52:55], s95 offen offset:1024 nt lds
    buffer_load_dwordx4 v78, s[52:55], s95 offen offset:2048 nt lds
    buffer_load_dwordx4 v79, s[52:55], s95 offen offset:3072 nt lds
    s_add_u32 s95, s95, 16384
    s_waitcnt vmcnt(24)
    ds_read_b64_tr_b16 a[140:141], v136 offset:24576
    ds_read_b64_tr_b16 a[142:143], v137 offset:25600
    ds_read_b64_tr_b16 a[156:157], v138 offset:24576
    ds_read_b64_tr_b16 a[158:159], v139 offset:25600
    ds_read_b64_tr_b16 a[172:173], v140 offset:24576
    ds_read_b64_tr_b16 a[174:175], v141 offset:25600
    ds_read_b64_tr_b16 a[188:189], v142 offset:24576
    ds_read_b64_tr_b16 a[190:191], v143 offset:25600
    ds_read_b64_tr_b16 a[204:205], v144 offset:24576
    ds_read_b64_tr_b16 a[206:207], v145 offset:25600
    ds_read_b64_tr_b16 a[220:221], v146 offset:24576
    ds_read_b64_tr_b16 a[222:223], v147 offset:25600
    ds_read_b64_tr_b16 a[236:237], v148 offset:24576
    ds_read_b64_tr_b16 a[238:239], v149 offset:25600
    ds_read_b64_tr_b16 a[252:253], v150 offset:24576
    ds_read_b64_tr_b16 a[254:255], v151 offset:25600
    s_waitcnt lgkmcnt(0)
    s_add_u32 s39, s90, s62
    s_mov_b32 m0, s39
    s_add_u32 s62, s62, 4096
    s_and_b32 s62, s62, 0x7fff
    buffer_load_dwordx4 v76, s[52:55], s95 offen offset:0 nt lds
    buffer_load_dwordx4 v77, s[52:55], s95 offen offset:1024 nt lds
    buffer_load_dwordx4 v78, s[52:55], s95 offen offset:2048 nt lds
    buffer_load_dwordx4 v79, s[52:55], s95 offen offset:3072 nt lds
    s_add_u32 s95, s95, 16384
    s_add_u32 s39, s90, s62
    s_mov_b32 m0, s39
    s_add_u32 s62, s62, 4096
    s_and_b32 s62, s62, 0x7fff
    buffer_load_dwordx4 v76, s[52:55], s95 offen offset:0 nt lds
    buffer_load_dwordx4 v77, s[52:55], s95 offen offset:1024 nt lds
    buffer_load_dwordx4 v78, s[52:55], s95 offen offset:2048 nt lds
    buffer_load_dwordx4 v79, s[52:55], s95 offen offset:3072 nt lds
    s_add_u32 s95, s95, 16384
    s_mov_b32 s52, s6
    s_and_b32 s53, s7, 0xffff
    s_mov_b32 s54, 16777216
    s_mov_b32 s55, 0x20000
    s_lshl_b32 s95, s32, 19
    s_lshl_b32 s38, s34, 8
    s_add_u32 s95, s95, s38
    s_waitcnt vmcnt(24)
    ds_read_b64_tr_b16 a[0:1], v136 offset:0
    ds_read_b64_tr_b16 a[2:3], v137 offset:1024
    ds_read_b64_tr_b16 a[16:17], v138 offset:0
    ds_read_b64_tr_b16 a[18:19], v139 offset:1024
    ds_read_b64_tr_b16 a[32:33], v140 offset:0
    ds_read_b64_tr_b16 a[34:35], v141 offset:1024
    ds_read_b64_tr_b16 a[48:49], v142 offset:0
    ds_read_b64_tr_b16 a[50:51], v143 offset:1024
    ds_read_b64_tr_b16 a[64:65], v144 offset:0
    ds_read_b64_tr_b16 a[66:67], v145 offset:1024
    ds_read_b64_tr_b16 a[80:81], v146 offset:0
    ds_read_b64_tr_b16 a[82:83], v147 offset:1024
    ds_read_b64_tr_b16 a[96:97], v148 offset:0
    ds_read_b64_tr_b16 a[98:99], v149 offset:1024
    ds_read_b64_tr_b16 a[112:113], v150 offset:0
    ds_read_b64_tr_b16 a[114:115], v151 offset:1024
    s_waitcnt lgkmcnt(0)
    s_add_u32 s39, s90, s62
    s_mov_b32 m0, s39
    s_add_u32 s62, s62, 4096
    s_and_b32 s62, s62, 0x7fff
    buffer_load_dwordx4 v76, s[52:55], s95 offen offset:0 nt lds
    buffer_load_dwordx4 v77, s[52:55], s95 offen offset:1024 nt lds
    buffer_load_dwordx4 v78, s[52:55], s95 offen offset:2048 nt lds
    buffer_load_dwordx4 v79, s[52:55], s95 offen offset:3072 nt lds
    s_add_u32 s95, s95, 16384
    s_add_u32 s39, s90, s62
    s_mov_b32 m0, s39
    s_add_u32 s62, s62, 4096
    s_and_b32 s62, s62, 0x7fff
    buffer_load_dwordx4 v76, s[52:55], s95 offen offset:0 nt lds
    buffer_load_dwordx4 v77, s[52:55], s95 offen offset:1024 nt lds
    buffer_load_dwordx4 v78, s[52:55], s95 offen offset:2048 nt lds
    buffer_load_dwordx4 v79, s[52:55], s95 offen offset:3072 nt lds
    s_add_u32 s95, s95, 16384
    s_waitcnt vmcnt(24)
    ds_read_b64_tr_b16 a[4:5], v136 offset:8192
    ds_read_b64_tr_b16 a[6:7], v137 offset:9216
    ds_read_b64_tr_b16 a[20:21], v138 offset:8192
    ds_read_b64_tr_b16 a[22:23], v139 offset:9216
    ds_read_b64_tr_b16 a[36:37], v140 offset:8192
    ds_read_b64_tr_b16 a[38:39], v141 offset:9216
    ds_read_b64_tr_b16 a[52:53], v142 offset:8192
    ds_read_b64_tr_b16 a[54:55], v143 offset:9216
    ds_read_b64_tr_b16 a[68:69], v144 offset:8192
    ds_read_b64_tr_b16 a[70:71], v145 offset:9216
    ds_read_b64_tr_b16 a[84:85], v146 offset:8192
    ds_read_b64_tr_b16 a[86:87], v147 offset:9216
    ds_read_b64_tr_b16 a[100:101], v148 offset:8192
    ds_read_b64_tr_b16 a[102:103], v149 offset:9216
    ds_read_b64_tr_b16 a[116:117], v150 offset:8192
    ds_read_b64_tr_b16 a[118:119], v151 offset:9216
    s_waitcnt lgkmcnt(0)
    s_add_u32 s39, s90, s62
    s_mov_b32 m0, s39
    s_add_u32 s62, s62, 4096
    s_and_b32 s62, s62, 0x7fff
    buffer_load_dwordx4 v76, s[52:55], s95 offen offset:0 nt lds
    buffer_load_dwordx4 v77, s[52:55], s95 offen offset:1024 nt lds
    buffer_load_dwordx4 v78, s[52:55], s95 offen offset:2048 nt lds
    buffer_load_dwordx4 v79, s[52:55], s95 offen offset:3072 nt lds
    s_add_u32 s95, s95, 16384
    s_add_u32 s39, s90, s62
    s_mov_b32 m0, s39
    s_add_u32 s62, s62, 4096
    s_and_b32 s62, s62, 0x7fff
    buffer_load_dwordx4 v76, s[52:55], s95 offen offset:0 nt lds
    buffer_load_dwordx4 v77, s[52:55], s95 offen offset:1024 nt lds
    buffer_load_dwordx4 v78, s[52:55], s95 offen offset:2048 nt lds
    buffer_load_dwordx4 v79, s[52:55], s95 offen offset:3072 nt lds
    s_add_u32 s95, s95, 16384
    s_waitcnt vmcnt(24)
    ds_read_b64_tr_b16 a[8:9], v136 offset:16384
    ds_read_b64_tr_b16 a[10:11], v137 offset:17408
    ds_read_b64_tr_b16 a[24:25], v138 offset:16384
    ds_read_b64_tr_b16 a[26:27], v139 offset:17408
    ds_read_b64_tr_b16 a[40:41], v140 offset:16384
    ds_read_b64_tr_b16 a[42:43], v141 offset:17408
    ds_read_b64_tr_b16 a[56:57], v142 offset:16384
    ds_read_b64_tr_b16 a[58:59], v143 offset:17408
    ds_read_b64_tr_b16 a[72:73], v144 offset:16384
    ds_read_b64_tr_b16 a[74:75], v145 offset:17408
    ds_read_b64_tr_b16 a[88:89], v146 offset:16384
    ds_read_b64_tr_b16 a[90:91], v147 offset:17408
    ds_read_b64_tr_b16 a[104:105], v148 offset:16384
    ds_read_b64_tr_b16 a[106:107], v149 offset:17408
    ds_read_b64_tr_b16 a[120:121], v150 offset:16384
    ds_read_b64_tr_b16 a[122:123], v151 offset:17408
    s_waitcnt lgkmcnt(0)
    s_add_u32 s39, s90, s62
    s_mov_b32 m0, s39
    s_add_u32 s62, s62, 4096
    s_and_b32 s62, s62, 0x7fff
    buffer_load_dwordx4 v76, s[52:55], s95 offen offset:0 nt lds
    buffer_load_dwordx4 v77, s[52:55], s95 offen offset:1024 nt lds
    buffer_load_dwordx4 v78, s[52:55], s95 offen offset:2048 nt lds
    buffer_load_dwordx4 v79, s[52:55], s95 offen offset:3072 nt lds
    s_add_u32 s95, s95, 16384
    s_add_u32 s39, s90, s62
    s_mov_b32 m0, s39
    s_add_u32 s62, s62, 4096
    s_and_b32 s62, s62, 0x7fff
    buffer_load_dwordx4 v76, s[52:55], s95 offen offset:0 nt lds
    buffer_load_dwordx4 v77, s[52:55], s95 offen offset:1024 nt lds
    buffer_load_dwordx4 v78, s[52:55], s95 offen offset:2048 nt lds
    buffer_load_dwordx4 v79, s[52:55], s95 offen offset:3072 nt lds
    s_add_u32 s95, s95, 16384
    s_waitcnt vmcnt(24)
    ds_read_b64_tr_b16 a[12:13], v136 offset:24576
    ds_read_b64_tr_b16 a[14:15], v137 offset:25600
    ds_read_b64_tr_b16 a[28:29], v138 offset:24576
    ds_read_b64_tr_b16 a[30:31], v139 offset:25600
    ds_read_b64_tr_b16 a[44:45], v140 offset:24576
    ds_read_b64_tr_b16 a[46:47], v141 offset:25600
    ds_read_b64_tr_b16 a[60:61], v142 offset:24576
    ds_read_b64_tr_b16 a[62:63], v143 offset:25600
    ds_read_b64_tr_b16 a[76:77], v144 offset:24576
    ds_read_b64_tr_b16 a[78:79], v145 offset:25600
    ds_read_b64_tr_b16 a[92:93], v146 offset:24576
    ds_read_b64_tr_b16 a[94:95], v147 offset:25600
    ds_read_b64_tr_b16 a[108:109], v148 offset:24576
    ds_read_b64_tr_b16 a[110:111], v149 offset:25600
    ds_read_b64_tr_b16 a[124:125], v150 offset:24576
    ds_read_b64_tr_b16 a[126:127], v151 offset:25600
    s_waitcnt lgkmcnt(0)
    s_mov_b32 s86, 131072
    buffer_load_dword v7, v101, s[48:51], s86 offen sc1
    s_add_u32 s39, s90, s62
    s_mov_b32 m0, s39
    s_add_u32 s62, s62, 4096
    s_and_b32 s62, s62, 0x7fff
    buffer_load_dwordx4 v76, s[52:55], s95 offen offset:0 nt lds
    buffer_load_dwordx4 v77, s[52:55], s95 offen offset:1024 nt lds
    buffer_load_dwordx4 v78, s[52:55], s95 offen offset:2048 nt lds
    buffer_load_dwordx4 v79, s[52:55], s95 offen offset:3072 nt lds
    s_add_u32 s95, s95, 16384
    s_add_u32 s39, s90, s62
    s_mov_b32 m0, s39
    s_add_u32 s62, s62, 4096
    s_and_b32 s62, s62, 0x7fff
    buffer_load_dwordx4 v76, s[52:55], s95 offen offset:0 nt lds
    v_mov_b32 v136, 0
    v_mov_b32 v137, 0
    v_mov_b32 v138, 0
    v_mov_b32 v139, 0
    v_mov_b32 v140, 0
    v_mov_b32 v141, 0
    v_mov_b32 v142, 0
    v_mov_b32 v143, 0
    v_mov_b32 v144, 0
    v_mov_b32 v145, 0
    v_mov_b32 v146, 0
    v_mov_b32 v147, 0
    v_mov_b32 v148, 0
    v_mov_b32 v149, 0
    v_mov_b32 v150, 0
    v_mov_b32 v151, 0
    v_mov_b32 v152, 0
    v_mov_b32 v153, 0
    v_mov_b32 v154, 0
    v_mov_b32 v155, 0
    v_mov_b32 v156, 0
    v_mov_b32 v157, 0
    v_mov_b32 v158, 0
    v_mov_b32 v159, 0
    v_mov_b32 v160, 0
    v_mov_b32 v161, 0
    v_mov_b32 v162, 0
    v_mov_b32 v163, 0
    v_mov_b32 v164, 0
    v_mov_b32 v165, 0
    v_mov_b32 v166, 0
    v_mov_b32 v167, 0
    v_mov_b32 v168, 0
    v_mov_b32 v169, 0
    v_mov_b32 v170, 0
    v_mov_b32 v171, 0
    v_mov_b32 v172, 0
    v_mov_b32 v173, 0
    v_mov_b32 v174, 0
    v_mov_b32 v175, 0
    v_mov_b32 v176, 0
    v_mov_b32 v177, 0
    v_mov_b32 v178, 0
    v_mov_b32 v179, 0
    v_mov_b32 v180, 0
    v_mov_b32 v181, 0
    v_mov_b32 v182, 0
    v_mov_b32 v183, 0
    v_mov_b32 v184, 0
    v_mov_b32 v185, 0
    v_mov_b32 v186, 0
    v_mov_b32 v187, 0
    v_mov_b32 v188, 0
    v_mov_b32 v189, 0
    v_mov_b32 v190, 0
    v_mov_b32 v191, 0
    v_mov_b32 v192, 0
    v_mov_b32 v193, 0
    v_mov_b32 v194, 0
    v_mov_b32 v195, 0
    v_mov_b32 v196, 0
    v_mov_b32 v197, 0
    v_mov_b32 v198, 0
    v_mov_b32 v199, 0
    v_mov_b32 v90, 0xff7f0000
    s_mov_b32 s93, 0
    v_mov_b32 v102, 0
    v_mov_b32 v103, 0
    s_mov_b32 s60, s83
    s_mov_b32 s61, s83
    v_add_u32 v4, s85, v80
    v_xor_b32 v82, 0, v4
    v_xor_b32 v83, 32, v4
    v_xor_b32 v84, 64, v4
    v_xor_b32 v85, 96, v4
    v_xor_b32 v86, 128, v4
    v_xor_b32 v87, 160, v4
    v_xor_b32 v88, 192, v4
    v_xor_b32 v89, 224, v4
    v_add_u32 v80, s90, v80
    v_add_u32 v81, s90, v81
    s_lshr_b32 s36, s32, 3
    s_lshl_b32 s36, s36, 15
    s_lshl_b32 s38, s34, 8
    s_add_u32 s36, s36, s38
    s_add_u32 s36, s36, 2097152
    s_waitcnt vmcnt(5)
L_fcheck_25:
    v_cmp_ne_u32 vcc, s68, v7
    s_cbranch_vccz L_fok_26
    s_sleep 2
    s_mov_b32 s86, 131072
    buffer_load_dword v7, v101, s[48:51], s86 offen sc1
    s_waitcnt vmcnt(0)
    s_sub_u32 s84, s84, 1
    s_cmp_lg_u32 s84, 0
    s_cbranch_scc1 L_fcheck_25
    s_branch L_end
L_fok_26:
    buffer_load_dwordx4 v[20:23], v9, s[48:51], s36 offen sc1
    s_add_u32 s36, s36, 4096
    buffer_load_dwordx4 v[24:27], v9, s[48:51], s36 offen sc1
    s_add_u32 s36, s36, 4096
    buffer_load_dwordx4 v[28:31], v9, s[48:51], s36 offen sc1
    s_add_u32 s36, s36, 4096
    buffer_load_dwordx4 v[32:35], v9, s[48:51], s36 offen sc1
    s_add_u32 s36, s36, 4096
    buffer_load_dwordx4 v[36:39], v9, s[48:51], s36 offen sc1
    s_add_u32 s36, s36, 4096
    buffer_load_dwordx4 v[40:43], v9, s[48:51], s36 offen sc1
    s_add_u32 s36, s36, 4096
    buffer_load_dwordx4 v[44:47], v9, s[48:51], s36 offen sc1
    s_add_u32 s36, s36, 4096
    buffer_load_dwordx4 v[48:51], v9, s[48:51], s36 offen sc1
    s_waitcnt vmcnt(7)
    ds_write_b128 v96, v[20:23] offset:0
    s_waitcnt vmcnt(6)
    ds_write_b128 v97, v[24:27] offset:1024
    s_waitcnt vmcnt(5)
    ds_write_b128 v98, v[28:31] offset:2048
    s_waitcnt vmcnt(4)
    ds_write_b128 v99, v[32:35] offset:3072
    s_waitcnt vmcnt(3)
    ds_write_b128 v96, v[36:39] offset:4096
    s_waitcnt vmcnt(2)
    ds_write_b128 v97, v[40:43] offset:5120
    s_waitcnt vmcnt(1)
    ds_write_b128 v98, v[44:47] offset:6144
    s_waitcnt vmcnt(0)
    ds_write_b128 v99, v[48:51] offset:7168
    s_waitcnt lgkmcnt(0)
    ds_read_b128 v[104:107], v82
    ds_read_b128 v[108:111], v83
    ds_read_b128 v[112:115], v84
    ds_read_b128 v[116:119], v85
    ds_read_b128 v[120:123], v86
    ds_read_b128 v[124:127], v87
    ds_read_b128 v[128:131], v88
    ds_read_b128 v[132:135], v89
    v_xor_b32 v82, 0, v80
    ds_read_b128 v[216:219], v82
    v_xor_b32 v83, 32, v80
    ds_read_b128 v[220:223], v83
    v_xor_b32 v84, 64, v80
    ds_read_b128 v[224:227], v84
    v_xor_b32 v85, 96, v80
    ds_read_b128 v[228:231], v85
    v_xor_b32 v86, 128, v80
    ds_read_b128 v[232:235], v86
    v_xor_b32 v87, 160, v80
    ds_read_b128 v[236:239], v87
    v_xor_b32 v88, 192, v80
    ds_read_b128 v[240:243], v88
    v_xor_b32 v89, 224, v80
    ds_read_b128 v[244:247], v89
L_att:
    v_add_u32 v4, s94, v81
    s_waitcnt lgkmcnt(0)
    v_mfma_f32_32x32x16_bf16 v[200:215], v[216:219], v[104:107], 0
    v_xor_b32 v82, 0, v4
    ds_read_b64_tr_b16 v[20:21], v82 offset:0
    ds_read_b64_tr_b16 v[24:25], v82 offset:4096
    buffer_load_dwordx4 v77, s[52:55], s95 offen offset:1024 nt lds
    v_mfma_f32_32x32x16_bf16 v[200:215], v[220:223], v[108:111], v[200:215]
    v_xor_b32 v83, 32, v4
    ds_read_b64_tr_b16 v[22:23], v83 offset:2048
    ds_read_b64_tr_b16 v[26:27], v83 offset:6144
    v_mfma_f32_32x32x16_bf16 v[200:215], v[224:227], v[112:115], v[200:215]
    v_xor_b32 v84, 64, v4
    ds_read_b64_tr_b16 v[28:29], v84 offset:0
    ds_read_b64_tr_b16 v[32:33], v84 offset:4096
    v_mfma_f32_32x32x16_bf16 v[200:215], v[228:231], v[116:119], v[200:215]
    v_xor_b32 v85, 96, v4
    ds_read_b64_tr_b16 v[30:31], v85 offset:2048
    ds_read_b64_tr_b16 v[34:35], v85 offset:6144
    v_mfma_f32_32x32x16_bf16 v[200:215], v[232:235], v[120:123], v[200:215]
    v_xor_b32 v86, 128, v4
    ds_read_b64_tr_b16 v[36:37], v86 offset:0
    ds_read_b64_tr_b16 v[40:41], v86 offset:4096
    buffer_load_dwordx4 v78, s[52:55], s95 offen offset:2048 nt lds
    v_mfma_f32_32x32x16_bf16 v[200:215], v[236:239], v[124:127], v[200:215]
    v_xor_b32 v87, 160, v4
    ds_read_b64_tr_b16 v[38:39], v87 offset:2048
    ds_read_b64_tr_b16 v[42:43], v87 offset:6144
    v_mfma_f32_32x32x16_bf16 v[200:215], v[240:243], v[128:131], v[200:215]
    v_xor_b32 v88, 192, v4
    ds_read_b64_tr_b16 v[44:45], v88 offset:0
    ds_read_b64_tr_b16 v[48:49], v88 offset:4096
    v_mfma_f32_32x32x16_bf16 v[200:215], v[244:247], v[132:135], v[200:215]
    v_xor_b32 v89, 224, v4
    ds_read_b64_tr_b16 v[46:47], v89 offset:2048
    ds_read_b64_tr_b16 v[50:51], v89 offset:6144
    buffer_load_dwordx4 v79, s[52:55], s95 offen offset:3072 nt lds
    s_add_u32 s95, s95, 16384
    v_xor_b32 v5, 0x2000, v94
    v_xor_b32 v6, 0x4000, v94
    v_xor_b32 v7, 0x6000, v94
    s_cmp_lg_u32 s93, 12
    s_cbranch_scc1 L_noswitch_27
    s_mov_b32 s52, s24
    s_and_b32 s53, s25, 0xffff
    s_mov_b32 s54, 4194304
    s_mov_b32 s55, 0x20000
    s_mov_b32 s95, s63
L_noswitch_27:
    s_nop 1
    ds_write_b128 v94, v[200:203] offset:0
    ds_write_b128 v94, v[204:207] offset:1024
    ds_write_b128 v94, v[208:211] offset:2048
    ds_write_b128 v94, v[212:215] offset:3072
    s_waitcnt lgkmcnt(0)
    s_barrier
    ds_read_b128 v[60:63], v5 offset:0
    ds_read_b128 v[216:219], v6 offset:0
    ds_read_b128 v[232:235], v7 offset:0
    ds_read_b128 v[64:67], v5 offset:1024
    ds_read_b128 v[220:223], v6 offset:1024
    ds_read_b128 v[236:239], v7 offset:1024
    ds_read_b128 v[68:71], v5 offset:2048
    ds_read_b128 v[224:227], v6 offset:2048
    ds_read_b128 v[240:243], v7 offset:2048
    ds_read_b128 v[72:75], v5 offset:3072
    ds_read_b128 v[228:231], v6 offset:3072
    ds_read_b128 v[244:247], v7 offset:3072
    v_xor_b32 v94, 0x1000, v94
    s_add_u32 s39, s90, s62
    s_mov_b32 m0, s39
    s_add_u32 s62, s62, 4096
    s_and_b32 s62, s62, 0x7fff
    buffer_load_dwordx4 v76, s[52:55], s95 offen offset:0 nt lds
    s_add_u32 s94, s94, 8192
    s_and_b32 s94, s94, 0x7fff
    s_waitcnt lgkmcnt(9)
    v_pk_add_f32 v[200:201], v[200:201], v[60:61]
    v_pk_add_f32 v[216:217], v[216:217], v[232:233]
    v_pk_add_f32 v[202:203], v[202:203], v[62:63]
    v_pk_add_f32 v[218:219], v[218:219], v[234:235]
    v_pk_add_f32 v[200:201], v[200:201], v[216:217]
    v_pk_add_f32 v[202:203], v[202:203], v[218:219]
    s_waitcnt lgkmcnt(6)
    v_pk_add_f32 v[204:205], v[204:205], v[64:65]
    v_pk_add_f32 v[220:221], v[220:221], v[236:237]
    v_pk_add_f32 v[206:207], v[206:207], v[66:67]
    v_pk_add_f32 v[222:223], v[222:223], v[238:239]
    v_pk_add_f32 v[204:205], v[204:205], v[220:221]
    v_pk_add_f32 v[206:207], v[206:207], v[222:223]
    s_waitcnt lgkmcnt(3)
    v_pk_add_f32 v[208:209], v[208:209], v[68:69]
    v_pk_add_f32 v[224:225], v[224:225], v[240:241]
    v_pk_add_f32 v[210:211], v[210:211], v[70:71]
    v_pk_add_f32 v[226:227], v[226:227], v[242:243]
    v_pk_add_f32 v[208:209], v[208:209], v[224:225]
    v_pk_add_f32 v[210:211], v[210:211], v[226:227]
    s_waitcnt lgkmcnt(0)
    v_pk_add_f32 v[212:213], v[212:213], v[72:73]
    v_pk_add_f32 v[228:229], v[228:229], v[244:245]
    v_pk_add_f32 v[214:215], v[214:215], v[74:75]
    v_pk_add_f32 v[230:231], v[230:231], v[246:247]
    v_pk_add_f32 v[212:213], v[212:213], v[228:229]
    v_pk_add_f32 v[214:215], v[214:215], v[230:231]
    buffer_load_dwordx4 v77, s[52:55], s95 offen offset:1024 nt lds
    v_max_f32 v4, v200, v201
    v_max3_f32 v4, v4, v202, v203
    v_max3_f32 v4, v4, v204, v205
    v_max3_f32 v4, v4, v206, v207
    v_max3_f32 v4, v4, v208, v209
    v_max3_f32 v4, v4, v210, v211
    v_max3_f32 v4, v4, v212, v213
    v_max3_f32 v4, v4, v214, v215
    v_mov_b32 v5, v4
    s_nop 1
    v_permlane32_swap_b32 v4, v5
    v_max_f32 v4, v4, v5
    v_mul_f32 v4, s83, v4
    v_max_f32 v4, v4, v90
    v_sub_f32 v92, v90, v4
    v_exp_f32 v92, v92
    v_mov_b32 v90, v4
    v_pk_fma_f32 v[200:201], v[200:201], s[60:61], v[90:91] op_sel_hi:[1,1,0] neg_lo:[0,0,1] neg_hi:[0,0,1]
    v_pk_fma_f32 v[202:203], v[202:203], s[60:61], v[90:91] op_sel_hi:[1,1,0] neg_lo:[0,0,1] neg_hi:[0,0,1]
    v_pk_fma_f32 v[204:205], v[204:205], s[60:61], v[90:91] op_sel_hi:[1,1,0] neg_lo:[0,0,1] neg_hi:[0,0,1]
    v_pk_fma_f32 v[206:207], v[206:207], s[60:61], v[90:91] op_sel_hi:[1,1,0] neg_lo:[0,0,1] neg_hi:[0,0,1]
    v_pk_fma_f32 v[208:209], v[208:209], s[60:61], v[90:91] op_sel_hi:[1,1,0] neg_lo:[0,0,1] neg_hi:[0,0,1]
    v_pk_fma_f32 v[210:211], v[210:211], s[60:61], v[90:91] op_sel_hi:[1,1,0] neg_lo:[0,0,1] neg_hi:[0,0,1]
    v_pk_fma_f32 v[212:213], v[212:213], s[60:61], v[90:91] op_sel_hi:[1,1,0] neg_lo:[0,0,1] neg_hi:[0,0,1]
    v_pk_fma_f32 v[214:215], v[214:215], s[60:61], v[90:91] op_sel_hi:[1,1,0] neg_lo:[0,0,1] neg_hi:[0,0,1]
    v_exp_f32 v200, v200
    v_exp_f32 v201, v201
    v_exp_f32 v202, v202
    v_exp_f32 v203, v203
    v_exp_f32 v204, v204
    buffer_load_dwordx4 v78, s[52:55], s95 offen offset:2048 nt lds
    v_exp_f32 v205, v205
    v_exp_f32 v206, v206
    v_exp_f32 v207, v207
    v_exp_f32 v208, v208
    v_exp_f32 v209, v209
    v_exp_f32 v210, v210
    v_exp_f32 v211, v211
    v_exp_f32 v212, v212
    v_exp_f32 v213, v213
    v_exp_f32 v214, v214
    v_exp_f32 v215, v215
    v_add_u32 v4, s94, v80
    v_pk_mul_f32 v[102:103], v[102:103], v[92:93] op_sel_hi:[1,0]
    v_pk_mul_f32 v[136:137], v[136:137], v[92:93] op_sel_hi:[1,0]
    v_pk_mul_f32 v[138:139], v[138:139], v[92:93] op_sel_hi:[1,0]
    v_pk_mul_f32 v[140:141], v[140:141], v[92:93] op_sel_hi:[1,0]
    v_pk_mul_f32 v[142:143], v[142:143], v[92:93] op_sel_hi:[1,0]
    v_pk_mul_f32 v[144:145], v[144:145], v[92:93] op_sel_hi:[1,0]
    v_pk_mul_f32 v[146:147], v[146:147], v[92:93] op_sel_hi:[1,0]
    v_pk_mul_f32 v[148:149], v[148:149], v[92:93] op_sel_hi:[1,0]
    v_pk_mul_f32 v[150:151], v[150:151], v[92:93] op_sel_hi:[1,0]
    v_pk_mul_f32 v[152:153], v[152:153], v[92:93] op_sel_hi:[1,0]
    v_pk_mul_f32 v[154:155], v[154:155], v[92:93] op_sel_hi:[1,0]
    v_pk_mul_f32 v[156:157], v[156:157], v[92:93] op_sel_hi:[1,0]
    v_pk_mul_f32 v[158:159], v[158:159], v[92:93] op_sel_hi:[1,0]
    v_pk_mul_f32 v[160:161], v[160:161], v[92:93] op_sel_hi:[1,0]
    v_pk_mul_f32 v[162:163], v[162:163], v[92:93] op_sel_hi:[1,0]
    v_pk_mul_f32 v[164:165], v[164:165], v[92:93] op_sel_hi:[1,0]
    v_pk_mul_f32 v[166:167], v[166:167], v[92:93] op_sel_hi:[1,0]
    v_pk_mul_f32 v[168:169], v[168:169], v[92:93] op_sel_hi:[1,0]
    v_pk_mul_f32 v[170:171], v[170:171], v[92:93] op_sel_hi:[1,0]
    v_pk_mul_f32 v[172:173], v[172:173], v[92:93] op_sel_hi:[1,0]
    v_pk_mul_f32 v[174:175], v[174:175], v[92:93] op_sel_hi:[1,0]
    v_pk_mul_f32 v[176:177], v[176:177], v[92:93] op_sel_hi:[1,0]
    buffer_load_dwordx4 v79, s[52:55], s95 offen offset:3072 nt lds
    s_add_u32 s95, s95, 16384
    v_pk_mul_f32 v[178:179], v[178:179], v[92:93] op_sel_hi:[1,0]
    v_pk_mul_f32 v[180:181], v[180:181], v[92:93] op_sel_hi:[1,0]
    v_pk_mul_f32 v[182:183], v[182:183], v[92:93] op_sel_hi:[1,0]
    v_pk_mul_f32 v[184:185], v[184:185], v[92:93] op_sel_hi:[1,0]
    v_pk_mul_f32 v[186:187], v[186:187], v[92:93] op_sel_hi:[1,0]
    v_pk_mul_f32 v[188:189], v[188:189], v[92:93] op_sel_hi:[1,0]
    v_pk_mul_f32 v[190:191], v[190:191], v[92:93] op_sel_hi:[1,0]
    v_pk_mul_f32 v[192:193], v[192:193], v[92:93] op_sel_hi:[1,0]
    v_pk_mul_f32 v[194:195], v[194:195], v[92:93] op_sel_hi:[1,0]
    v_pk_mul_f32 v[196:197], v[196:197], v[92:93] op_sel_hi:[1,0]
    v_pk_mul_f32 v[198:199], v[198:199], v[92:93] op_sel_hi:[1,0]
    v_cvt_pk_bf16_f32 v52, v200, v201
    v_pk_add_f32 v[102:103], v[102:103], v[200:201]
    v_cvt_pk_bf16_f32 v53, v202, v203
    v_pk_add_f32 v[102:103], v[102:103], v[202:203]
    v_cvt_pk_bf16_f32 v54, v204, v205
    v_pk_add_f32 v[102:103], v[102:103], v[204:205]
    v_cvt_pk_bf16_f32 v55, v206, v207
    v_pk_add_f32 v[102:103], v[102:103], v[206:207]
    v_cvt_pk_bf16_f32 v56, v208, v209
    v_pk_add_f32 v[102:103], v[102:103], v[208:209]
    v_cvt_pk_bf16_f32 v57, v210, v211
    v_pk_add_f32 v[102:103], v[102:103], v[210:211]
    v_cvt_pk_bf16_f32 v58, v212, v213
    v_pk_add_f32 v[102:103], v[102:103], v[212:213]
    v_cvt_pk_bf16_f32 v59, v214, v215
    v_pk_add_f32 v[102:103], v[102:103], v[214:215]
    s_waitcnt vmcnt(20)
    v_mfma_f32_32x32x16_bf16 v[136:151], v[20:23], v[52:55], v[136:151]
    v_xor_b32 v82, 0, v4
    ds_read_b128 v[216:219], v82
    v_xor_b32 v83, 32, v4
    ds_read_b128 v[220:223], v83
    v_mfma_f32_32x32x16_bf16 v[152:167], v[28:31], v[52:55], v[152:167]
    v_xor_b32 v84, 64, v4
    ds_read_b128 v[224:227], v84
    v_xor_b32 v85, 96, v4
    ds_read_b128 v[228:231], v85
    v_mfma_f32_32x32x16_bf16 v[168:183], v[36:39], v[52:55], v[168:183]
    v_xor_b32 v86, 128, v4
    ds_read_b128 v[232:235], v86
    v_xor_b32 v87, 160, v4
    ds_read_b128 v[236:239], v87
    v_mfma_f32_32x32x16_bf16 v[184:199], v[44:47], v[52:55], v[184:199]
    v_xor_b32 v88, 192, v4
    ds_read_b128 v[240:243], v88
    v_xor_b32 v89, 224, v4
    ds_read_b128 v[244:247], v89
    v_mfma_f32_32x32x16_bf16 v[136:151], v[24:27], v[56:59], v[136:151]
    s_add_u32 s39, s90, s62
    s_mov_b32 m0, s39
    s_add_u32 s62, s62, 4096
    s_and_b32 s62, s62, 0x7fff
    buffer_load_dwordx4 v76, s[52:55], s95 offen offset:0 nt lds
    v_mfma_f32_32x32x16_bf16 v[152:167], v[32:35], v[56:59], v[152:167]
    v_mfma_f32_32x32x16_bf16 v[168:183], v[40:43], v[56:59], v[168:183]
    v_mfma_f32_32x32x16_bf16 v[184:199], v[48:51], v[56:59], v[184:199]
    s_add_u32 s93, s93, 1
    s_cmp_lt_u32 s93, 16
    s_cbranch_scc1 L_att
    v_add_f32 v91, v102, v103
    v_mov_b32 v5, v91
    s_nop 1
    v_permlane32_swap_b32 v91, v5
    v_add_f32 v91, v91, v5
    v_and_b32 v4, 31, v1
    v_lshlrev_b32 v5, 8, v4
    v_lshl_add_u32 v5, v3, 4, v5
    v_lshrrev_b32 v6, 5, v1
    v_lshl_add_u32 v5, v6, 3, v5
    v_add_u32 v5, s85, v5
    s_waitcnt lgkmcnt(0)
    s_barrier
    v_cvt_pk_bf16_f32 v20, v136, v137
    v_cvt_pk_bf16_f32 v21, v138, v139
    v_xor_b32 v82, 0, v5
    ds_write_b64 v82, v[20:21]
    v_cvt_pk_bf16_f32 v22, v140, v141
    v_cvt_pk_bf16_f32 v23, v142, v143
    v_xor_b32 v83, 16, v5
    ds_write_b64 v83, v[22:23]
    v_cvt_pk_bf16_f32 v24, v144, v145
    v_cvt_pk_bf16_f32 v25, v146, v147
    v_xor_b32 v84, 32, v5
    ds_write_b64 v84, v[24:25]
    v_cvt_pk_bf16_f32 v26, v148, v149
    v_cvt_pk_bf16_f32 v27, v150, v151
    v_xor_b32 v85, 48, v5
    ds_write_b64 v85, v[26:27]
    v_cvt_pk_bf16_f32 v28, v152, v153
    v_cvt_pk_bf16_f32 v29, v154, v155
    v_xor_b32 v86, 64, v5
    ds_write_b64 v86, v[28:29]
    v_cvt_pk_bf16_f32 v30, v156, v157
    v_cvt_pk_bf16_f32 v31, v158, v159
    v_xor_b32 v87, 80, v5
    ds_write_b64 v87, v[30:31]
    v_cvt_pk_bf16_f32 v32, v160, v161
    v_cvt_pk_bf16_f32 v33, v162, v163
    v_xor_b32 v88, 96, v5
    ds_write_b64 v88, v[32:33]
    v_cvt_pk_bf16_f32 v34, v164, v165
    v_cvt_pk_bf16_f32 v35, v166, v167
    v_xor_b32 v89, 112, v5
    ds_write_b64 v89, v[34:35]
    v_cvt_pk_bf16_f32 v36, v168, v169
    v_cvt_pk_bf16_f32 v37, v170, v171
    v_xor_b32 v82, 128, v5
    ds_write_b64 v82, v[36:37]
    v_cvt_pk_bf16_f32 v38, v172, v173
    v_cvt_pk_bf16_f32 v39, v174, v175
    v_xor_b32 v83, 144, v5
    ds_write_b64 v83, v[38:39]
    v_cvt_pk_bf16_f32 v40, v176, v177
    v_cvt_pk_bf16_f32 v41, v178, v179
    v_xor_b32 v84, 160, v5
    ds_write_b64 v84, v[40:41]
    v_cvt_pk_bf16_f32 v42, v180, v181
    v_cvt_pk_bf16_f32 v43, v182, v183
    v_xor_b32 v85, 176, v5
    ds_write_b64 v85, v[42:43]
    v_cvt_pk_bf16_f32 v44, v184, v185
    v_cvt_pk_bf16_f32 v45, v186, v187
    v_xor_b32 v86, 192, v5
    ds_write_b64 v86, v[44:45]
    v_cvt_pk_bf16_f32 v46, v188, v189
    v_cvt_pk_bf16_f32 v47, v190, v191
    v_xor_b32 v87, 208, v5
    ds_write_b64 v87, v[46:47]
    v_cvt_pk_bf16_f32 v48, v192, v193
    v_cvt_pk_bf16_f32 v49, v194, v195
    v_xor_b32 v88, 224, v5
    ds_write_b64 v88, v[48:49]
    v_cvt_pk_bf16_f32 v50, v196, v197
    v_cvt_pk_bf16_f32 v51, v198, v199
    v_xor_b32 v89, 240, v5
    ds_write_b64 v89, v[50:51]
    v_xor_b32 v6, v3, v2
    v_lshlrev_b32 v6, 4, v6
    v_lshl_add_u32 v6, v2, 8, v6
    v_add_u32 v6, s85, v6
    v_xor_b32 v82, 0, v6
    v_xor_b32 v83, 64, v6
    v_xor_b32 v84, 128, v6
    v_xor_b32 v85, 192, v6
    v_lshlrev_b32 v7, 4, v3
    v_lshl_add_u32 v7, v2, 15, v7
    s_lshl_b32 s36, s32, 10
    s_lshl_b32 s38, s34, 8
    s_add_u32 s36, s36, s38
    s_add_u32 s36, s36, 4194304
    s_waitcnt lgkmcnt(0)
    ds_read_b128 v[200:203], v82 offset:0
    ds_read_b128 v[204:207], v83 offset:1024
    ds_read_b128 v[208:211], v84 offset:2048
    ds_read_b128 v[212:215], v85 offset:3072
    ds_read_b128 v[216:219], v82 offset:4096
    ds_read_b128 v[220:223], v83 offset:5120
    ds_read_b128 v[224:227], v84 offset:6144
    ds_read_b128 v[228:231], v85 offset:7168
    v_lshlrev_b32 v4, 3, v4
    s_lshl_b32 s37, s32, 8
    s_lshl_b32 s38, s34, 13
    s_add_u32 s37, s37, s38
    s_add_u32 s37, s37, 2621440
    s_mov_b32 exec_lo, 0xffffffff
    s_mov_b32 exec_hi, 0x0
    buffer_store_dwordx2 v[90:91], v4, s[48:51], s37 offen sc1
    s_mov_b64 exec, -1
    s_waitcnt lgkmcnt(7)
    buffer_store_dwordx4 v[200:203], v7, s[48:51], s36 offen sc1
    s_add_u32 s36, s36, 131072
    s_waitcnt lgkmcnt(6)
    buffer_store_dwordx4 v[204:207], v7, s[48:51], s36 offen sc1
    s_add_u32 s36, s36, 131072
    s_waitcnt lgkmcnt(5)
    buffer_store_dwordx4 v[208:211], v7, s[48:51], s36 offen sc1
    s_add_u32 s36, s36, 131072
    s_waitcnt lgkmcnt(4)
    buffer_store_dwordx4 v[212:215], v7, s[48:51], s36 offen sc1
    s_add_u32 s36, s36, 131072
    s_waitcnt lgkmcnt(3)
    buffer_store_dwordx4 v[216:219], v7, s[48:51], s36 offen sc1
    s_add_u32 s36, s36, 131072
    s_waitcnt lgkmcnt(2)
    buffer_store_dwordx4 v[220:223], v7, s[48:51], s36 offen sc1
    s_add_u32 s36, s36, 131072
    s_waitcnt lgkmcnt(1)
    buffer_store_dwordx4 v[224:227], v7, s[48:51], s36 offen sc1
    s_add_u32 s36, s36, 131072
    s_waitcnt lgkmcnt(0)
    buffer_store_dwordx4 v[228:231], v7, s[48:51], s36 offen sc1
    buffer_load_dwordx4 v77, s[52:55], s95 offen offset:1024 nt lds
    buffer_load_dwordx4 v78, s[52:55], s95 offen offset:2048 nt lds
    buffer_load_dwordx4 v79, s[52:55], s95 offen offset:3072 nt lds
    s_add_u32 s95, s95, 16384
    v_mov_b32 v136, 0
    v_mov_b32 v137, 0
    v_mov_b32 v138, 0
    v_mov_b32 v139, 0
    v_mov_b32 v140, 0
    v_mov_b32 v141, 0
    v_mov_b32 v142, 0
    v_mov_b32 v143, 0
    v_mov_b32 v144, 0
    v_mov_b32 v145, 0
    v_mov_b32 v146, 0
    v_mov_b32 v147, 0
    v_mov_b32 v148, 0
    v_mov_b32 v149, 0
    v_mov_b32 v150, 0
    v_mov_b32 v151, 0
    v_mov_b32 v152, 0
    v_mov_b32 v153, 0
    v_mov_b32 v154, 0
    v_mov_b32 v155, 0
    v_mov_b32 v156, 0
    v_mov_b32 v157, 0
    v_mov_b32 v158, 0
    v_mov_b32 v159, 0
    v_mov_b32 v160, 0
    v_mov_b32 v161, 0
    v_mov_b32 v162, 0
    v_mov_b32 v163, 0
    v_mov_b32 v164, 0
    v_mov_b32 v165, 0
    v_mov_b32 v166, 0
    v_mov_b32 v167, 0
    v_mov_b32 v168, 0
    v_mov_b32 v169, 0
    v_mov_b32 v170, 0
    v_mov_b32 v171, 0
    v_mov_b32 v172, 0
    v_mov_b32 v173, 0
    v_mov_b32 v174, 0
    v_mov_b32 v175, 0
    v_mov_b32 v176, 0
    v_mov_b32 v177, 0
    v_mov_b32 v178, 0
    v_mov_b32 v179, 0
    v_mov_b32 v180, 0
    v_mov_b32 v181, 0
    v_mov_b32 v182, 0
    v_mov_b32 v183, 0
    v_mov_b32 v184, 0
    v_mov_b32 v185, 0
    v_mov_b32 v186, 0
    v_mov_b32 v187, 0
    v_mov_b32 v188, 0
    v_mov_b32 v189, 0
    v_mov_b32 v190, 0
    v_mov_b32 v191, 0
    v_mov_b32 v192, 0
    v_mov_b32 v193, 0
    v_mov_b32 v194, 0
    v_mov_b32 v195, 0
    v_mov_b32 v196, 0
    v_mov_b32 v197, 0
    v_mov_b32 v198, 0
    v_mov_b32 v199, 0
    v_and_b32 v4, 3, v3
    v_mul_u32_u24 v76, 320, v4
    v_lshl_add_u32 v76, v2, 4, v76
    v_add_u32 v76, 147456, v76
    s_lshl_b32 s36, s34, 16
    s_lshl_b32 s38, s32, 8
    s_add_u32 s36, s36, s38
    v_add_u32 v77, s36, v19
    s_lshl_b32 s36, s32, 13
    s_lshl_b32 s38, s34, 6
    s_add_u32 s36, s36, s38
    v_lshrrev_b32 v5, 2, v1
    v_lshlrev_b32 v5, 8, v5
    v_lshl_add_u32 v5, v4, 4, v5
    v_add_u32 v78, s36, v5
    s_lshr_b32 s36, s32, 2
    s_lshl_b32 s36, s36, 7
    s_lshl_b32 s38, s34, 5
    s_add_u32 s36, s36, s38
    s_and_b32 s38, s32, 3
    s_lshl_b32 s38, s38, 3
    s_add_u32 s36, s36, s38
    v_lshlrev_b32 v5, 11, v4
    v_lshl_add_u32 v5, v2, 1, v5
    v_add_u32 v79, s36, v5
    v_lshrrev_b32 v5, 2, v3
    v_lshl_add_u32 v6, v4, 3, v5
    v_lshlrev_b32 v81, 8, v6
    v_lshlrev_b32 v6, 10, v6
    v_lshl_add_u32 v80, v2, 4, v6
    s_lshl_b32 s38, s34, 11
    s_add_u32 s38, s38, 131072
    v_lshlrev_b32 v4, 9, v4
    v_lshl_add_u32 v4, v2, 4, v4
    v_add_u32 v94, s38, v4
    s_lshl_b32 s38, s34, 9
    s_add_u32 s38, s38, 131072
    v_and_b32 v5, 31, v1
    v_lshl_add_u32 v96, v5, 4, s38
    s_mul_i32 s38, s34, 320
    s_add_u32 s38, s38, 147456
    v_lshl_add_u32 v97, v5, 3, s38
    v_lshlrev_b32 v4, 6, v2
    v_lshl_add_u32 v4, v3, 1, v4
    v_add_u32 v93, s38, v4
    v_lshlrev_b32 v4, 7, v2
    v_lshl_add_u32 v4, v3, 4, v4
    v_mov_b32 v5, 512
    v_cmp_gt_u32 vcc, 8, v3
    s_nop 1
    v_cndmask_b32 v92, v5, v4, vcc
    s_mov_b32 s92, 0
    s_mov_b32 s96, 3145728
    s_mov_b32 s97, 0
    s_lshl_b32 s36, s32, 15
    s_lshl_b32 s38, s34, 8
    s_add_u32 s36, s36, s38
    s_add_u32 s36, s36, 4194304
    s_lshl_b32 s37, s32, 3
    s_lshl_b32 s38, s34, 13
    s_add_u32 s37, s37, s38
    s_add_u32 s37, s37, 2621440
    s_barrier
    s_lshl_b32 s38, s34, 5
    s_add_u32 s38, s38, s32
    s_lshl_b32 s38, s38, 8
    s_add_u32 s38, s38, 196608
    v_mov_b32 v4, s38
    v_mov_b32 v5, s68
    s_waitcnt vmcnt(3)
    s_mov_b64 exec, 1
    buffer_store_dword v5, v4, s[48:51], 0 offen sc1
    s_mov_b64 exec, -1
    s_mov_b32 s86, 196608
    buffer_load_dword v7, v101, s[48:51], s86 offen sc1
    s_waitcnt vmcnt(0)
L_fcheck_28:
    v_cmp_ne_u32 vcc, s68, v7
    s_cbranch_vccz L_fok_29
    s_sleep 2
    s_mov_b32 s86, 196608
    buffer_load_dword v7, v101, s[48:51], s86 offen sc1
    s_waitcnt vmcnt(0)
    s_sub_u32 s84, s84, 1
    s_cmp_lg_u32 s84, 0
    s_cbranch_scc1 L_fcheck_28
    s_branch L_end
L_fok_29:
    buffer_load_dwordx2 v[52:53], v81, s[48:51], s37 offen offset:0 sc1
    buffer_load_dwordx2 v[54:55], v81, s[48:51], s37 offen offset:1024 sc1
    buffer_load_dwordx4 v[20:23], v80, s[48:51], s36 offen offset:0 sc1
    buffer_load_dwordx4 v[24:27], v80, s[48:51], s36 offen offset:64 sc1
    buffer_load_dwordx4 v[28:31], v80, s[48:51], s36 offen offset:128 sc1
    buffer_load_dwordx4 v[32:35], v80, s[48:51], s36 offen offset:192 sc1
    s_add_u32 s36, s36, 4096
    buffer_load_dwordx4 v[36:39], v80, s[48:51], s36 offen offset:0 sc1
    buffer_load_dwordx4 v[40:43], v80, s[48:51], s36 offen offset:64 sc1
    buffer_load_dwordx4 v[44:47], v80, s[48:51], s36 offen offset:128 sc1
    buffer_load_dwordx4 v[48:51], v80, s[48:51], s36 offen offset:192 sc1
    s_add_u32 s36, s36, 4096
    s_waitcnt vmcnt(8)
    v_max_f32 v4, v52, v54
    s_nop 1
    v_max_f32_dpp v4, v4, v4 row_ror:8 row_mask:0xf bank_mask:0xf
    s_nop 1
    v_max_f32_dpp v4, v4, v4 row_ror:4 row_mask:0xf bank_mask:0xf
    v_sub_f32 v52, v52, v4
    v_sub_f32 v54, v54, v4
    v_exp_f32 v52, v52
    v_exp_f32 v54, v54
    v_mul_f32 v5, v52, v53
    v_fmac_f32 v5, v54, v55
    s_nop 1
    v_add_f32_dpp v5, v5, v5 row_ror:8 row_mask:0xf bank_mask:0xf
    s_nop 1
    v_add_f32_dpp v5, v5, v5 row_ror:4 row_mask:0xf bank_mask:0xf
    v_rcp_f32 v5, v5
    s_nop 0
    v_mul_f32 v52, v52, v5
    v_mul_f32 v54, v54, v5
    s_waitcnt vmcnt(0)
    v_mfma_f32_16x16x32_bf16 v[60:63], a[128:131], v[20:23], 0
    v_mfma_f32_16x16x32_bf16 v[64:67], a[128:131], v[36:39], 0
    v_mfma_f32_16x16x32_bf16 v[60:63], a[132:135], v[24:27], v[60:63]
    v_mfma_f32_16x16x32_bf16 v[64:67], a[132:135], v[40:43], v[64:67]
    v_mfma_f32_16x16x32_bf16 v[60:63], a[136:139], v[28:31], v[60:63]
    v_mfma_f32_16x16x32_bf16 v[64:67], a[136:139], v[44:47], v[64:67]
    v_mfma_f32_16x16x32_bf16 v[60:63], a[140:143], v[32:35], v[60:63]
    v_mfma_f32_16x16x32_bf16 v[64:67], a[140:143], v[48:51], v[64:67]
    v_mfma_f32_16x16x32_bf16 v[68:71], a[144:147], v[20:23], 0
    v_mfma_f32_16x16x32_bf16 v[72:75], a[144:147], v[36:39], 0
    v_mfma_f32_16x16x32_bf16 v[68:71], a[148:151], v[24:27], v[68:71]
    v_mfma_f32_16x16x32_bf16 v[72:75], a[148:151], v[40:43], v[72:75]
    v_mfma_f32_16x16x32_bf16 v[68:71], a[152:155], v[28:31], v[68:71]
    v_mfma_f32_16x16x32_bf16 v[72:75], a[152:155], v[44:47], v[72:75]
    v_mfma_f32_16x16x32_bf16 v[68:71], a[156:159], v[32:35], v[68:71]
    v_mfma_f32_16x16x32_bf16 v[72:75], a[156:159], v[48:51], v[72:75]
    v_mul_f32 v104, v60, v52
    v_mul_f32 v105, v61, v52
    v_mul_f32 v106, v62, v52
    v_mul_f32 v107, v63, v52
    v_fmac_f32 v104, v64, v54
    v_fmac_f32 v105, v65, v54
    v_fmac_f32 v106, v66, v54
    v_fmac_f32 v107, v67, v54
    v_add_f32_dpp v104, v104, v104 row_ror:8 row_mask:0xf bank_mask:0xf
    v_add_f32_dpp v105, v105, v105 row_ror:8 row_mask:0xf bank_mask:0xf
    v_add_f32_dpp v106, v106, v106 row_ror:8 row_mask:0xf bank_mask:0xf
    v_add_f32_dpp v107, v107, v107 row_ror:8 row_mask:0xf bank_mask:0xf
    v_add_f32_dpp v104, v104, v104 row_ror:4 row_mask:0xf bank_mask:0xf
    v_add_f32_dpp v105, v105, v105 row_ror:4 row_mask:0xf bank_mask:0xf
    v_add_f32_dpp v106, v106, v106 row_ror:4 row_mask:0xf bank_mask:0xf
    v_add_f32_dpp v107, v107, v107 row_ror:4 row_mask:0xf bank_mask:0xf
    ds_write_b128 v94, v[104:107] offset:0
    v_mfma_f32_16x16x32_bf16 v[60:63], a[160:163], v[20:23], 0
    v_mfma_f32_16x16x32_bf16 v[64:67], a[160:163], v[36:39], 0
    v_mfma_f32_16x16x32_bf16 v[60:63], a[164:167], v[24:27], v[60:63]
    v_mfma_f32_16x16x32_bf16 v[64:67], a[164:167], v[40:43], v[64:67]
    v_mfma_f32_16x16x32_bf16 v[60:63], a[168:171], v[28:31], v[60:63]
    v_mfma_f32_16x16x32_bf16 v[64:67], a[168:171], v[44:47], v[64:67]
    v_mfma_f32_16x16x32_bf16 v[60:63], a[172:175], v[32:35], v[60:63]
    v_mfma_f32_16x16x32_bf16 v[64:67], a[172:175], v[48:51], v[64:67]
    v_mul_f32 v108, v68, v52
    v_mul_f32 v109, v69, v52
    v_mul_f32 v110, v70, v52
    v_mul_f32 v111, v71, v52
    v_fmac_f32 v108, v72, v54
    v_fmac_f32 v109, v73, v54
    v_fmac_f32 v110, v74, v54
    v_fmac_f32 v111, v75, v54
    v_add_f32_dpp v108, v108, v108 row_ror:8 row_mask:0xf bank_mask:0xf
    v_add_f32_dpp v109, v109, v109 row_ror:8 row_mask:0xf bank_mask:0xf
    v_add_f32_dpp v110, v110, v110 row_ror:8 row_mask:0xf bank_mask:0xf
    v_add_f32_dpp v111, v111, v111 row_ror:8 row_mask:0xf bank_mask:0xf
    v_add_f32_dpp v108, v108, v108 row_ror:4 row_mask:0xf bank_mask:0xf
    v_add_f32_dpp v109, v109, v109 row_ror:4 row_mask:0xf bank_mask:0xf
    v_add_f32_dpp v110, v110, v110 row_ror:4 row_mask:0xf bank_mask:0xf
    v_add_f32_dpp v111, v111, v111 row_ror:4 row_mask:0xf bank_mask:0xf
    ds_write_b128 v94, v[108:111] offset:64
    v_mfma_f32_16x16x32_bf16 v[68:71], a[176:179], v[20:23], 0
    v_mfma_f32_16x16x32_bf16 v[72:75], a[176:179], v[36:39], 0
    v_mfma_f32_16x16x32_bf16 v[68:71], a[180:183], v[24:27], v[68:71]
    v_mfma_f32_16x16x32_bf16 v[72:75], a[180:183], v[40:43], v[72:75]
    v_mfma_f32_16x16x32_bf16 v[68:71], a[184:187], v[28:31], v[68:71]
    v_mfma_f32_16x16x32_bf16 v[72:75], a[184:187], v[44:47], v[72:75]
    v_mfma_f32_16x16x32_bf16 v[68:71], a[188:191], v[32:35], v[68:71]
    v_mfma_f32_16x16x32_bf16 v[72:75], a[188:191], v[48:51], v[72:75]
    v_mul_f32 v104, v60, v52
    v_mul_f32 v105, v61, v52
    v_mul_f32 v106, v62, v52
    v_mul_f32 v107, v63, v52
    v_fmac_f32 v104, v64, v54
    v_fmac_f32 v105, v65, v54
    v_fmac_f32 v106, v66, v54
    v_fmac_f32 v107, v67, v54
    v_add_f32_dpp v104, v104, v104 row_ror:8 row_mask:0xf bank_mask:0xf
    v_add_f32_dpp v105, v105, v105 row_ror:8 row_mask:0xf bank_mask:0xf
    v_add_f32_dpp v106, v106, v106 row_ror:8 row_mask:0xf bank_mask:0xf
    v_add_f32_dpp v107, v107, v107 row_ror:8 row_mask:0xf bank_mask:0xf
    v_add_f32_dpp v104, v104, v104 row_ror:4 row_mask:0xf bank_mask:0xf
    v_add_f32_dpp v105, v105, v105 row_ror:4 row_mask:0xf bank_mask:0xf
    v_add_f32_dpp v106, v106, v106 row_ror:4 row_mask:0xf bank_mask:0xf
    v_add_f32_dpp v107, v107, v107 row_ror:4 row_mask:0xf bank_mask:0xf
    ds_write_b128 v94, v[104:107] offset:128
    v_mfma_f32_16x16x32_bf16 v[60:63], a[192:195], v[20:23], 0
    v_mfma_f32_16x16x32_bf16 v[64:67], a[192:195], v[36:39], 0
    v_mfma_f32_16x16x32_bf16 v[60:63], a[196:199], v[24:27], v[60:63]
    v_mfma_f32_16x16x32_bf16 v[64:67], a[196:199], v[40:43], v[64:67]
    v_mfma_f32_16x16x32_bf16 v[60:63], a[200:203], v[28:31], v[60:63]
    v_mfma_f32_16x16x32_bf16 v[64:67], a[200:203], v[44:47], v[64:67]
    v_mfma_f32_16x16x32_bf16 v[60:63], a[204:207], v[32:35], v[60:63]
    v_mfma_f32_16x16x32_bf16 v[64:67], a[204:207], v[48:51], v[64:67]
    v_mul_f32 v108, v68, v52
    v_mul_f32 v109, v69, v52
    v_mul_f32 v110, v70, v52
    v_mul_f32 v111, v71, v52
    v_fmac_f32 v108, v72, v54
    v_fmac_f32 v109, v73, v54
    v_fmac_f32 v110, v74, v54
    v_fmac_f32 v111, v75, v54
    v_add_f32_dpp v108, v108, v108 row_ror:8 row_mask:0xf bank_mask:0xf
    v_add_f32_dpp v109, v109, v109 row_ror:8 row_mask:0xf bank_mask:0xf
    v_add_f32_dpp v110, v110, v110 row_ror:8 row_mask:0xf bank_mask:0xf
    v_add_f32_dpp v111, v111, v111 row_ror:8 row_mask:0xf bank_mask:0xf
    v_add_f32_dpp v108, v108, v108 row_ror:4 row_mask:0xf bank_mask:0xf
    v_add_f32_dpp v109, v109, v109 row_ror:4 row_mask:0xf bank_mask:0xf
    v_add_f32_dpp v110, v110, v110 row_ror:4 row_mask:0xf bank_mask:0xf
    v_add_f32_dpp v111, v111, v111 row_ror:4 row_mask:0xf bank_mask:0xf
    ds_write_b128 v94, v[108:111] offset:192
    v_mfma_f32_16x16x32_bf16 v[68:71], a[208:211], v[20:23], 0
    v_mfma_f32_16x16x32_bf16 v[72:75], a[208:211], v[36:39], 0
    v_mfma_f32_16x16x32_bf16 v[68:71], a[212:215], v[24:27], v[68:71]
    v_mfma_f32_16x16x32_bf16 v[72:75], a[212:215], v[40:43], v[72:75]
    v_mfma_f32_16x16x32_bf16 v[68:71], a[216:219], v[28:31], v[68:71]
    v_mfma_f32_16x16x32_bf16 v[72:75], a[216:219], v[44:47], v[72:75]
    v_mfma_f32_16x16x32_bf16 v[68:71], a[220:223], v[32:35], v[68:71]
    v_mfma_f32_16x16x32_bf16 v[72:75], a[220:223], v[48:51], v[72:75]
    v_mul_f32 v104, v60, v52
    v_mul_f32 v105, v61, v52
    v_mul_f32 v106, v62, v52
    v_mul_f32 v107, v63, v52
    v_fmac_f32 v104, v64, v54
    v_fmac_f32 v105, v65, v54
    v_fmac_f32 v106, v66, v54
    v_fmac_f32 v107, v67, v54
    v_add_f32_dpp v104, v104, v104 row_ror:8 row_mask:0xf bank_mask:0xf
    v_add_f32_dpp v105, v105, v105 row_ror:8 row_mask:0xf bank_mask:0xf
    v_add_f32_dpp v106, v106, v106 row_ror:8 row_mask:0xf bank_mask:0xf
    v_add_f32_dpp v107, v107, v107 row_ror:8 row_mask:0xf bank_mask:0xf
    v_add_f32_dpp v104, v104, v104 row_ror:4 row_mask:0xf bank_mask:0xf
    v_add_f32_dpp v105, v105, v105 row_ror:4 row_mask:0xf bank_mask:0xf
    v_add_f32_dpp v106, v106, v106 row_ror:4 row_mask:0xf bank_mask:0xf
    v_add_f32_dpp v107, v107, v107 row_ror:4 row_mask:0xf bank_mask:0xf
    ds_write_b128 v94, v[104:107] offset:256
    v_mfma_f32_16x16x32_bf16 v[60:63], a[224:227], v[20:23], 0
    v_mfma_f32_16x16x32_bf16 v[64:67], a[224:227], v[36:39], 0
    v_mfma_f32_16x16x32_bf16 v[60:63], a[228:231], v[24:27], v[60:63]
    v_mfma_f32_16x16x32_bf16 v[64:67], a[228:231], v[40:43], v[64:67]
    v_mfma_f32_16x16x32_bf16 v[60:63], a[232:235], v[28:31], v[60:63]
    v_mfma_f32_16x16x32_bf16 v[64:67], a[232:235], v[44:47], v[64:67]
    v_mfma_f32_16x16x32_bf16 v[60:63], a[236:239], v[32:35], v[60:63]
    v_mfma_f32_16x16x32_bf16 v[64:67], a[236:239], v[48:51], v[64:67]
    v_mul_f32 v108, v68, v52
    v_mul_f32 v109, v69, v52
    v_mul_f32 v110, v70, v52
    v_mul_f32 v111, v71, v52
    v_fmac_f32 v108, v72, v54
    v_fmac_f32 v109, v73, v54
    v_fmac_f32 v110, v74, v54
    v_fmac_f32 v111, v75, v54
    v_add_f32_dpp v108, v108, v108 row_ror:8 row_mask:0xf bank_mask:0xf
    v_add_f32_dpp v109, v109, v109 row_ror:8 row_mask:0xf bank_mask:0xf
    v_add_f32_dpp v110, v110, v110 row_ror:8 row_mask:0xf bank_mask:0xf
    v_add_f32_dpp v111, v111, v111 row_ror:8 row_mask:0xf bank_mask:0xf
    v_add_f32_dpp v108, v108, v108 row_ror:4 row_mask:0xf bank_mask:0xf
    v_add_f32_dpp v109, v109, v109 row_ror:4 row_mask:0xf bank_mask:0xf
    v_add_f32_dpp v110, v110, v110 row_ror:4 row_mask:0xf bank_mask:0xf
    v_add_f32_dpp v111, v111, v111 row_ror:4 row_mask:0xf bank_mask:0xf
    ds_write_b128 v94, v[108:111] offset:320
    v_mfma_f32_16x16x32_bf16 v[68:71], a[240:243], v[20:23], 0
    v_mfma_f32_16x16x32_bf16 v[72:75], a[240:243], v[36:39], 0
    v_mfma_f32_16x16x32_bf16 v[68:71], a[244:247], v[24:27], v[68:71]
    v_mfma_f32_16x16x32_bf16 v[72:75], a[244:247], v[40:43], v[72:75]
    v_mfma_f32_16x16x32_bf16 v[68:71], a[248:251], v[28:31], v[68:71]
    v_mfma_f32_16x16x32_bf16 v[72:75], a[248:251], v[44:47], v[72:75]
    v_mfma_f32_16x16x32_bf16 v[68:71], a[252:255], v[32:35], v[68:71]
    v_mfma_f32_16x16x32_bf16 v[72:75], a[252:255], v[48:51], v[72:75]
    v_mul_f32 v104, v60, v52
    v_mul_f32 v105, v61, v52
    v_mul_f32 v106, v62, v52
    v_mul_f32 v107, v63, v52
    v_fmac_f32 v104, v64, v54
    v_fmac_f32 v105, v65, v54
    v_fmac_f32 v106, v66, v54
    v_fmac_f32 v107, v67, v54
    v_add_f32_dpp v104, v104, v104 row_ror:8 row_mask:0xf bank_mask:0xf
    v_add_f32_dpp v105, v105, v105 row_ror:8 row_mask:0xf bank_mask:0xf
    v_add_f32_dpp v106, v106, v106 row_ror:8 row_mask:0xf bank_mask:0xf
    v_add_f32_dpp v107, v107, v107 row_ror:8 row_mask:0xf bank_mask:0xf
    v_add_f32_dpp v104, v104, v104 row_ror:4 row_mask:0xf bank_mask:0xf
    v_add_f32_dpp v105, v105, v105 row_ror:4 row_mask:0xf bank_mask:0xf
    v_add_f32_dpp v106, v106, v106 row_ror:4 row_mask:0xf bank_mask:0xf
    v_add_f32_dpp v107, v107, v107 row_ror:4 row_mask:0xf bank_mask:0xf
    ds_write_b128 v94, v[104:107] offset:384
    v_mul_f32 v108, v68, v52
    v_mul_f32 v109, v69, v52
    v_mul_f32 v110, v70, v52
    v_mul_f32 v111, v71, v52
    v_fmac_f32 v108, v72, v54
    v_fmac_f32 v109, v73, v54
    v_fmac_f32 v110, v74, v54
    v_fmac_f32 v111, v75, v54
    v_add_f32_dpp v108, v108, v108 row_ror:8 row_mask:0xf bank_mask:0xf
    v_add_f32_dpp v109, v109, v109 row_ror:8 row_mask:0xf bank_mask:0xf
    v_add_f32_dpp v110, v110, v110 row_ror:8 row_mask:0xf bank_mask:0xf
    v_add_f32_dpp v111, v111, v111 row_ror:8 row_mask:0xf bank_mask:0xf
    v_add_f32_dpp v108, v108, v108 row_ror:4 row_mask:0xf bank_mask:0xf
    v_add_f32_dpp v109, v109, v109 row_ror:4 row_mask:0xf bank_mask:0xf
    v_add_f32_dpp v110, v110, v110 row_ror:4 row_mask:0xf bank_mask:0xf
    v_add_f32_dpp v111, v111, v111 row_ror:4 row_mask:0xf bank_mask:0xf
    ds_write_b128 v94, v[108:111] offset:448
    s_waitcnt lgkmcnt(0)
    s_barrier
    ds_read_b128 v[20:23], v96 offset:0
    ds_read_b128 v[24:27], v96 offset:2048
    ds_read_b128 v[28:31], v96 offset:4096
    ds_read_b128 v[32:35], v96 offset:6144
    s_waitcnt lgkmcnt(0)
    v_add_f32 v20, v20, v24
    v_add_f32 v28, v28, v32
    v_add_f32 v21, v21, v25
    v_add_f32 v29, v29, v33
    v_add_f32 v22, v22, v26
    v_add_f32 v30, v30, v34
    v_add_f32 v23, v23, v27
    v_add_f32 v31, v31, v35
    v_add_f32 v20, v20, v28
    v_add_f32 v21, v21, v29
    v_add_f32 v22, v22, v30
    v_add_f32 v23, v23, v31
    v_cvt_pk_bf16_f32 v20, v20, v21
    v_cvt_pk_bf16_f32 v21, v22, v23
    ds_write_b64 v97, v[20:21]
L_final:
    s_waitcnt lgkmcnt(0)
    s_barrier
    s_mov_b32 exec_lo, 0xf000f
    s_mov_b32 exec_hi, 0xf000f
    ds_read_b128 v[136:139], v76 offset:0
    ds_read_b128 v[140:143], v76 offset:64
    ds_read_b128 v[144:147], v76 offset:128
    ds_read_b128 v[148:151], v76 offset:192
    s_mov_b32 exec_lo, 0xf000f0
    s_mov_b32 exec_hi, 0xf000f0
    ds_read_b128 v[152:155], v76 offset:0
    ds_read_b128 v[156:159], v76 offset:64
    ds_read_b128 v[160:163], v76 offset:128
    ds_read_b128 v[164:167], v76 offset:192
    s_mov_b32 exec_lo, 0xf000f00
    s_mov_b32 exec_hi, 0xf000f00
    ds_read_b128 v[168:171], v76 offset:0
    ds_read_b128 v[172:175], v76 offset:64
    ds_read_b128 v[176:179], v76 offset:128
    ds_read_b128 v[180:183], v76 offset:192
    s_mov_b32 exec_lo, 0xf000f000
    s_mov_b32 exec_hi, 0xf000f000
    ds_read_b128 v[184:187], v76 offset:0
    ds_read_b128 v[188:191], v76 offset:64
    ds_read_b128 v[192:195], v76 offset:128
    ds_read_b128 v[196:199], v76 offset:192
    s_mov_b64 exec, -1
    s_add_u32 s36, s96, 32768
    s_waitcnt lgkmcnt(12)
    v_mfma_f32_16x16x32_bf16 v[84:87], a[0:3], v[136:139], 0
    v_mfma_f32_16x16x32_bf16 v[88:91], a[64:67], v[136:139], 0
    v_mfma_f32_16x16x32_bf16 v[84:87], a[4:7], v[140:143], v[84:87]
    v_mfma_f32_16x16x32_bf16 v[88:91], a[68:71], v[140:143], v[88:91]
    v_mfma_f32_16x16x32_bf16 v[84:87], a[8:11], v[144:147], v[84:87]
    v_mfma_f32_16x16x32_bf16 v[88:91], a[72:75], v[144:147], v[88:91]
    v_mfma_f32_16x16x32_bf16 v[84:87], a[12:15], v[148:151], v[84:87]
    v_mfma_f32_16x16x32_bf16 v[88:91], a[76:79], v[148:151], v[88:91]
    s_waitcnt lgkmcnt(8)
    v_mfma_f32_16x16x32_bf16 v[84:87], a[16:19], v[152:155], v[84:87]
    v_mfma_f32_16x16x32_bf16 v[88:91], a[80:83], v[152:155], v[88:91]
    v_mfma_f32_16x16x32_bf16 v[84:87], a[20:23], v[156:159], v[84:87]
    v_mfma_f32_16x16x32_bf16 v[88:91], a[84:87], v[156:159], v[88:91]
    v_mfma_f32_16x16x32_bf16 v[84:87], a[24:27], v[160:163], v[84:87]
    v_mfma_f32_16x16x32_bf16 v[88:91], a[88:91], v[160:163], v[88:91]
    v_mfma_f32_16x16x32_bf16 v[84:87], a[28:31], v[164:167], v[84:87]
    v_mfma_f32_16x16x32_bf16 v[88:91], a[92:95], v[164:167], v[88:91]
    s_waitcnt lgkmcnt(4)
    v_mfma_f32_16x16x32_bf16 v[84:87], a[32:35], v[168:171], v[84:87]
    v_mfma_f32_16x16x32_bf16 v[88:91], a[96:99], v[168:171], v[88:91]
    v_mfma_f32_16x16x32_bf16 v[84:87], a[36:39], v[172:175], v[84:87]
    v_mfma_f32_16x16x32_bf16 v[88:91], a[100:103], v[172:175], v[88:91]
    v_mfma_f32_16x16x32_bf16 v[84:87], a[40:43], v[176:179], v[84:87]
    v_mfma_f32_16x16x32_bf16 v[88:91], a[104:107], v[176:179], v[88:91]
    v_mfma_f32_16x16x32_bf16 v[84:87], a[44:47], v[180:183], v[84:87]
    v_mfma_f32_16x16x32_bf16 v[88:91], a[108:111], v[180:183], v[88:91]
    s_waitcnt lgkmcnt(0)
    v_mfma_f32_16x16x32_bf16 v[84:87], a[48:51], v[184:187], v[84:87]
    v_mfma_f32_16x16x32_bf16 v[88:91], a[112:115], v[184:187], v[88:91]
    v_mfma_f32_16x16x32_bf16 v[84:87], a[52:55], v[188:191], v[84:87]
    v_mfma_f32_16x16x32_bf16 v[88:91], a[116:119], v[188:191], v[88:91]
    v_mfma_f32_16x16x32_bf16 v[84:87], a[56:59], v[192:195], v[84:87]
    v_mfma_f32_16x16x32_bf16 v[88:91], a[120:123], v[192:195], v[88:91]
    v_mfma_f32_16x16x32_bf16 v[84:87], a[60:63], v[196:199], v[84:87]
    v_mfma_f32_16x16x32_bf16 v[88:91], a[124:127], v[196:199], v[88:91]
    s_nop 6
    v_and_or_b32 v84, v84, s82, v8
    v_and_or_b32 v85, v85, s82, v8
    v_and_or_b32 v86, v86, s82, v8
    v_and_or_b32 v87, v87, s82, v8
    buffer_store_dwordx4 v[84:87], v77, s[48:51], s96 offen sc1
    v_and_or_b32 v88, v88, s82, v8
    v_and_or_b32 v89, v89, s82, v8
    v_and_or_b32 v90, v90, s82, v8
    v_and_or_b32 v91, v91, s82, v8
    buffer_store_dwordx4 v[88:91], v77, s[48:51], s36 offen sc1
    s_cmp_eq_u32 s92, 0
    s_cbranch_scc1 L_prepb
L_hop2:
    s_add_u32 s36, s96, 4096
    buffer_load_dwordx4 v[104:107], v78, s[48:51], s96 offen sc1
    buffer_load_dwordx4 v[108:111], v78, s[48:51], s36 offen sc1
    s_waitcnt vmcnt(0)
    v_xor_b32 v104, s35, v104
    v_xor_b32 v105, s35, v105
    v_xor_b32 v106, s35, v106
    v_xor_b32 v107, s35, v107
    v_xor_b32 v108, s35, v108
    v_xor_b32 v109, s35, v109
    v_xor_b32 v110, s35, v110
    v_xor_b32 v111, s35, v111
    v_or_b32 v4, v104, v105
    v_or3_b32 v4, v4, v106, v107
    v_or3_b32 v4, v4, v108, v109
    v_or3_b32 v4, v4, v110, v111
    v_and_b32 v4, 0xff, v4
    v_cmp_ne_u32 vcc, 0, v4
    s_cbranch_vccz L_hop2ok
    s_sub_u32 s84, s84, 1
    s_cmp_lg_u32 s84, 0
    s_cbranch_scc1 L_hop2
    s_branch L_end
L_hop2ok:
    v_add_f32 v104, v104, v108
    v_add_f32 v105, v105, v109
    v_add_f32 v106, v106, v110
    v_add_f32 v107, v107, v111
    v_permlane16_swap_b32 v104, v105
    s_nop 0
    v_permlane16_swap_b32 v106, v107
    v_add_f32 v104, v104, v105
    v_add_f32 v106, v106, v107
    s_nop 1
    v_permlane32_swap_b32 v104, v106
    v_add_f32 v104, v104, v106
    s_nop 1
    v_add_f32_dpp v104, v104, v104 row_ror:8 row_mask:0xf bank_mask:0xf
    s_nop 1
    v_add_f32_dpp v104, v104, v104 row_ror:4 row_mask:0xf bank_mask:0xf
    v_cvt_pk_bf16_f32 v104, v104, v104
    s_mov_b32 exec_lo, 0xf000f
    s_mov_b32 exec_hi, 0xf000f
    buffer_store_short v104, v79, s[72:75], s97 offen
    s_mov_b64 exec, -1
    s_cmp_lg_u32 s92, 0
    s_cbranch_scc1 L_fin
    s_mov_b32 s92, 1
    s_mov_b32 s96, 3670016
    s_mov_b32 s97, 1024
    s_lshl_b32 s85, s32, 2
    s_add_u32 s85, s85, s34
    s_lshl_b32 s85, s85, 13
    s_add_u32 s85, s85, 5242880
    s_add_u32 s86, s85, 4096
    v_min_u32 v5, 6, v1
    v_lshlrev_b32 v5, 10, v5
L_light:
    buffer_load_dword v6, v5, s[48:51], s85 offen offset:512 sc1
    s_waitcnt vmcnt(0)
    v_xor_b32 v6, s35, v6
    v_and_b32 v6, 0xff, v6
    v_cmp_ne_u32 vcc, 0, v6
    s_nop 0
    s_and_b32 s36, vcc_lo, 0x7f
    s_bcnt1_i32_b32 s36, s36
    s_cmp_le_u32 s36, 2
    s_cbranch_scc1 L_hop1
    s_sleep 2
    s_sub_u32 s84, s84, 1
    s_cmp_lg_u32 s84, 0
    s_cbranch_scc1 L_light
    s_branch L_end
L_hop1:
    buffer_load_dwordx4 v[20:23], v92, s[48:51], s85 offen offset:0 sc1
    buffer_load_dwordx4 v[24:27], v92, s[48:51], s85 offen offset:1024 sc1
    buffer_load_dwordx4 v[28:31], v92, s[48:51], s85 offen offset:2048 sc1
    buffer_load_dwordx4 v[32:35], v92, s[48:51], s85 offen offset:3072 sc1
    buffer_load_dwordx4 v[36:39], v92, s[48:51], s86 offen offset:0 sc1
    buffer_load_dwordx4 v[40:43], v92, s[48:51], s86 offen offset:1024 sc1
    buffer_load_dwordx4 v[44:47], v92, s[48:51], s86 offen offset:2048 sc1
    s_waitcnt vmcnt(0)
    v_xor_b32 v20, s35, v20
    v_xor_b32 v21, s35, v21
    v_xor_b32 v22, s35, v22
    v_xor_b32 v23, s35, v23
    v_xor_b32 v24, s35, v24
    v_xor_b32 v25, s35, v25
    v_xor_b32 v26, s35, v26
    v_xor_b32 v27, s35, v27
    v_xor_b32 v28, s35, v28
    v_xor_b32 v29, s35, v29
    v_xor_b32 v30, s35, v30
    v_xor_b32 v31, s35, v31
    v_xor_b32 v32, s35, v32
    v_xor_b32 v33, s35, v33
    v_xor_b32 v34, s35, v34
    v_xor_b32 v35, s35, v35
    v_xor_b32 v36, s35, v36
    v_xor_b32 v37, s35, v37
    v_xor_b32 v38, s35, v38
    v_xor_b32 v39, s35, v39
    v_xor_b32 v40, s35, v40
    v_xor_b32 v41, s35, v41
    v_xor_b32 v42, s35, v42
    v_xor_b32 v43, s35, v43
    v_xor_b32 v44, s35, v44
    v_xor_b32 v45, s35, v45
    v_xor_b32 v46, s35, v46
    v_xor_b32 v47, s35, v47
    v_or_b32 v4, v20, v21
    v_or3_b32 v4, v4, v22, v23
    v_or3_b32 v4, v4, v24, v25
    v_or3_b32 v4, v4, v26, v27
    v_or3_b32 v4, v4, v28, v29
    v_or3_b32 v4, v4, v30, v31
    v_or3_b32 v4, v4, v32, v33
    v_or3_b32 v4, v4, v34, v35
    v_or3_b32 v4, v4, v36, v37
    v_or3_b32 v4, v4, v38, v39
    v_or3_b32 v4, v4, v40, v41
    v_or3_b32 v4, v4, v42, v43
    v_or3_b32 v4, v4, v44, v45
    v_or3_b32 v4, v4, v46, v47
    v_and_b32 v4, 0xff, v4
    v_cmp_ne_u32 vcc, 0, v4
    s_cbranch_vccz L_hop1ok
    s_sub_u32 s84, s84, 1
    s_cmp_lg_u32 s84, 0
    s_cbranch_scc1 L_hop1
    s_branch L_end
L_hop1ok:
    v_max3_f32 v55, v20, v24, v28
    v_max3_f32 v55, v55, v32, v36
    v_max3_f32 v55, v55, v40, v44
    v_sub_f32 v48, v20, v55
    v_sub_f32 v49, v24, v55
    v_sub_f32 v50, v28, v55
    v_sub_f32 v51, v32, v55
    v_sub_f32 v52, v36, v55
    v_sub_f32 v53, v40, v55
    v_sub_f32 v54, v44, v55
    v_exp_f32 v48, v48
    v_exp_f32 v49, v49
    v_exp_f32 v50, v50
    v_exp_f32 v51, v51
    v_exp_f32 v52, v52
    v_exp_f32 v53, v53
    v_exp_f32 v54, v54
    v_mul_f32_dpp v57, v48, v21 row_newbcast:8 row_mask:0xf bank_mask:0xf
    v_mul_f32_dpp v56, v48, v20 row_newbcast:8 row_mask:0xf bank_mask:0xf
    v_mul_f32_dpp v58, v48, v22 row_newbcast:8 row_mask:0xf bank_mask:0xf
    v_mul_f32_dpp v59, v48, v23 row_newbcast:8 row_mask:0xf bank_mask:0xf
    v_fmac_f32_dpp v57, v49, v25 row_newbcast:8 row_mask:0xf bank_mask:0xf
    v_fmac_f32_dpp v56, v49, v24 row_newbcast:8 row_mask:0xf bank_mask:0xf
    v_fmac_f32_dpp v58, v49, v26 row_newbcast:8 row_mask:0xf bank_mask:0xf
    v_fmac_f32_dpp v59, v49, v27 row_newbcast:8 row_mask:0xf bank_mask:0xf
    v_fmac_f32_dpp v57, v50, v29 row_newbcast:8 row_mask:0xf bank_mask:0xf
    v_fmac_f32_dpp v56, v50, v28 row_newbcast:8 row_mask:0xf bank_mask:0xf
    v_fmac_f32_dpp v58, v50, v30 row_newbcast:8 row_mask:0xf bank_mask:0xf
    v_fmac_f32_dpp v59, v50, v31 row_newbcast:8 row_mask:0xf bank_mask:0xf
    v_fmac_f32_dpp v57, v51, v33 row_newbcast:8 row_mask:0xf bank_mask:0xf
    v_fmac_f32_dpp v56, v51, v32 row_newbcast:8 row_mask:0xf bank_mask:0xf
    v_fmac_f32_dpp v58, v51, v34 row_newbcast:8 row_mask:0xf bank_mask:0xf
    v_fmac_f32_dpp v59, v51, v35 row_newbcast:8 row_mask:0xf bank_mask:0xf
    v_fmac_f32_dpp v57, v52, v37 row_newbcast:8 row_mask:0xf bank_mask:0xf
    v_fmac_f32_dpp v56, v52, v36 row_newbcast:8 row_mask:0xf bank_mask:0xf
    v_fmac_f32_dpp v58, v52, v38 row_newbcast:8 row_mask:0xf bank_mask:0xf
    v_fmac_f32_dpp v59, v52, v39 row_newbcast:8 row_mask:0xf bank_mask:0xf
    v_fmac_f32_dpp v57, v53, v41 row_newbcast:8 row_mask:0xf bank_mask:0xf
    v_fmac_f32_dpp v56, v53, v40 row_newbcast:8 row_mask:0xf bank_mask:0xf
    v_fmac_f32_dpp v58, v53, v42 row_newbcast:8 row_mask:0xf bank_mask:0xf
    v_fmac_f32_dpp v59, v53, v43 row_newbcast:8 row_mask:0xf bank_mask:0xf
    v_fmac_f32_dpp v57, v54, v45 row_newbcast:8 row_mask:0xf bank_mask:0xf
    v_fmac_f32_dpp v56, v54, v44 row_newbcast:8 row_mask:0xf bank_mask:0xf
    v_fmac_f32_dpp v58, v54, v46 row_newbcast:8 row_mask:0xf bank_mask:0xf
    v_fmac_f32_dpp v59, v54, v47 row_newbcast:8 row_mask:0xf bank_mask:0xf
    v_rcp_f32 v55, v57
    s_nop 1
    v_mul_f32_dpp v56, v55, v56 row_newbcast:8 row_mask:0xf bank_mask:0xf
    v_mul_f32_dpp v57, v55, v57 row_newbcast:8 row_mask:0xf bank_mask:0xf
    v_mul_f32_dpp v58, v55, v58 row_newbcast:8 row_mask:0xf bank_mask:0xf
    v_mul_f32_dpp v59, v55, v59 row_newbcast:8 row_mask:0xf bank_mask:0xf
    v_cvt_pk_bf16_f32 v56, v56, v57
    v_cvt_pk_bf16_f32 v58, v58, v59
    s_mov_b32 exec_lo, 0xff00ff
    s_mov_b32 exec_hi, 0xff00ff
    ds_write_b16 v93, v56
    ds_write_b16_d16_hi v93, v56 offset:16
    ds_write_b16 v93, v58 offset:32
    ds_write_b16_d16_hi v93, v58 offset:48
    s_mov_b64 exec, -1
    s_branch L_final
L_prepb:
    v_xor_b32 v4, 0, v95
    ds_read_b64_tr_b16 a[0:1], v4 offset:0
    ds_read_b64_tr_b16 a[4:5], v4 offset:8192
    ds_read_b64_tr_b16 a[8:9], v4 offset:16384
    ds_read_b64_tr_b16 a[12:13], v4 offset:24576
    v_xor_b32 v5, 16, v95
    ds_read_b64_tr_b16 a[2:3], v5 offset:1024
    ds_read_b64_tr_b16 a[6:7], v5 offset:9216
    ds_read_b64_tr_b16 a[10:11], v5 offset:17408
    ds_read_b64_tr_b16 a[14:15], v5 offset:25600
    v_xor_b32 v4, 32, v95
    ds_read_b64_tr_b16 a[16:17], v4 offset:0
    ds_read_b64_tr_b16 a[20:21], v4 offset:8192
    ds_read_b64_tr_b16 a[24:25], v4 offset:16384
    ds_read_b64_tr_b16 a[28:29], v4 offset:24576
    v_xor_b32 v5, 48, v95
    ds_read_b64_tr_b16 a[18:19], v5 offset:1024
    ds_read_b64_tr_b16 a[22:23], v5 offset:9216
    ds_read_b64_tr_b16 a[26:27], v5 offset:17408
    ds_read_b64_tr_b16 a[30:31], v5 offset:25600
    v_xor_b32 v4, 64, v95
    ds_read_b64_tr_b16 a[32:33], v4 offset:0
    ds_read_b64_tr_b16 a[36:37], v4 offset:8192
    ds_read_b64_tr_b16 a[40:41], v4 offset:16384
    ds_read_b64_tr_b16 a[44:45], v4 offset:24576
    v_xor_b32 v5, 80, v95
    ds_read_b64_tr_b16 a[34:35], v5 offset:1024
    ds_read_b64_tr_b16 a[38:39], v5 offset:9216
    ds_read_b64_tr_b16 a[42:43], v5 offset:17408
    ds_read_b64_tr_b16 a[46:47], v5 offset:25600
    v_xor_b32 v4, 96, v95
    ds_read_b64_tr_b16 a[48:49], v4 offset:0
    ds_read_b64_tr_b16 a[52:53], v4 offset:8192
    ds_read_b64_tr_b16 a[56:57], v4 offset:16384
    ds_read_b64_tr_b16 a[60:61], v4 offset:24576
    v_xor_b32 v5, 112, v95
    ds_read_b64_tr_b16 a[50:51], v5 offset:1024
    ds_read_b64_tr_b16 a[54:55], v5 offset:9216
    ds_read_b64_tr_b16 a[58:59], v5 offset:17408
    ds_read_b64_tr_b16 a[62:63], v5 offset:25600
    v_xor_b32 v4, 128, v95
    ds_read_b64_tr_b16 a[64:65], v4 offset:0
    ds_read_b64_tr_b16 a[68:69], v4 offset:8192
    ds_read_b64_tr_b16 a[72:73], v4 offset:16384
    ds_read_b64_tr_b16 a[76:77], v4 offset:24576
    v_xor_b32 v5, 144, v95
    ds_read_b64_tr_b16 a[66:67], v5 offset:1024
    ds_read_b64_tr_b16 a[70:71], v5 offset:9216
    ds_read_b64_tr_b16 a[74:75], v5 offset:17408
    ds_read_b64_tr_b16 a[78:79], v5 offset:25600
    v_xor_b32 v4, 160, v95
    ds_read_b64_tr_b16 a[80:81], v4 offset:0
    ds_read_b64_tr_b16 a[84:85], v4 offset:8192
    ds_read_b64_tr_b16 a[88:89], v4 offset:16384
    ds_read_b64_tr_b16 a[92:93], v4 offset:24576
    v_xor_b32 v5, 176, v95
    ds_read_b64_tr_b16 a[82:83], v5 offset:1024
    ds_read_b64_tr_b16 a[86:87], v5 offset:9216
    ds_read_b64_tr_b16 a[90:91], v5 offset:17408
    ds_read_b64_tr_b16 a[94:95], v5 offset:25600
    v_xor_b32 v4, 192, v95
    ds_read_b64_tr_b16 a[96:97], v4 offset:0
    ds_read_b64_tr_b16 a[100:101], v4 offset:8192
    ds_read_b64_tr_b16 a[104:105], v4 offset:16384
    ds_read_b64_tr_b16 a[108:109], v4 offset:24576
    v_xor_b32 v5, 208, v95
    ds_read_b64_tr_b16 a[98:99], v5 offset:1024
    ds_read_b64_tr_b16 a[102:103], v5 offset:9216
    ds_read_b64_tr_b16 a[106:107], v5 offset:17408
    ds_read_b64_tr_b16 a[110:111], v5 offset:25600
    v_xor_b32 v4, 224, v95
    ds_read_b64_tr_b16 a[112:113], v4 offset:0
    ds_read_b64_tr_b16 a[116:117], v4 offset:8192
    ds_read_b64_tr_b16 a[120:121], v4 offset:16384
    ds_read_b64_tr_b16 a[124:125], v4 offset:24576
    v_xor_b32 v5, 240, v95
    ds_read_b64_tr_b16 a[114:115], v5 offset:1024
    ds_read_b64_tr_b16 a[118:119], v5 offset:9216
    ds_read_b64_tr_b16 a[122:123], v5 offset:17408
    ds_read_b64_tr_b16 a[126:127], v5 offset:25600
    s_waitcnt lgkmcnt(0)
    s_barrier
    s_branch L_hop2
L_fin:
    s_or_b32 s36, s32, s34
    s_cmp_lg_u32 s36, 0
    s_cbranch_scc1 L_end
    s_mov_b64 exec, 1
    buffer_store_dword v8, v100, s[48:51], 0 offen
L_end:
    s_endpgm
    .fill (32768 - (. - L_pc)) / 4 + 1, 4, 0xbf810000
.section .rodata,"a"
.p2align 6
.amdhsa_kernel concat_heads__compressed_kv_cla__mha_block_cached__decode_kernel
  .amdhsa_next_free_vgpr 512
  .amdhsa_next_free_sgpr 102
  .amdhsa_accum_offset 256
  .amdhsa_group_segment_fixed_size 0
  .amdhsa_kernarg_size 112
  .amdhsa_user_sgpr_count 2
  .amdhsa_user_sgpr_kernarg_segment_ptr 1
  .amdhsa_system_sgpr_workgroup_id_x 1
.end_amdhsa_kernel
```

```asm
; @launch grid=(256,1,1) block=(256,1,1) lds=163840
    .amdgcn_target "amdgcn-amd-amdhsa--gfx950"
    .text
    .globl concat_heads__compressed_kv_cla__mha_block_cached__decode_kernel
    .p2align 8
    .type concat_heads__compressed_kv_cla__mha_block_cached__decode_kernel,@function
concat_heads__compressed_kv_cla__mha_block_cached__decode_kernel:
    s_cmp_ge_u32 s2, 256
    s_cbranch_scc1 L_end
    s_load_dwordx16 s[4:19], s[0:1], 0
    s_load_dwordx8 s[20:27], s[0:1], 64
    s_load_dwordx4 s[28:31], s[0:1], 96
    v_lshrrev_b32 v4, 6, v0
    v_and_b32 v1, 63, v0
    v_readfirstlane_b32 s34, v4
    s_lshr_b32 s32, s2, 3
    s_sub_u32 s33, s2, s32
    s_sub_u32 s33, s33, 1
    s_and_b32 s33, s33, 7
    s_getpc_b64 s[36:37]
L_pc:
    s_lshl_b32 s38, s32, 10
    v_lshl_add_u32 v6, v0, 2, s38
    v_mov_b32 v7, s37
    v_add_co_u32 v6, vcc, s36, v6
    s_nop 1
    v_addc_co_u32 v7, vcc, 0, v7, vcc
    global_load_dword v0, v[6:7], off
    v_lshrrev_b32 v2, 4, v1
    v_and_b32 v3, 15, v1
    s_cmp_lt_u32 s33, 2
    s_cbranch_scc1 L_qb
    s_cmp_eq_u32 s33, 2
    s_cbranch_scc1 L_ql
    s_cmp_eq_u32 s33, 7
    s_cbranch_scc1 L_aux
    v_lshrrev_b32 v4, 2, v3
    v_and_b32 v5, 3, v3
    v_lshlrev_b32 v76, 8, v4
    v_lshlrev_b32 v126, 8, v2
    v_lshl_add_u32 v76, v2, 6, v76
    v_lshl_add_u32 v76, v5, 4, v76
    v_lshl_add_u32 v126, v3, 4, v126
    v_xor_b32 v77, 32768, v76
    v_xor_b32 v127, 32768, v126
    s_lshl_b32 s89, s34, 5
    s_add_u32 s89, s89, s32
    s_lshl_b32 s89, s89, 20
    s_mul_i32 s88, s32, 8
    s_mul_i32 s38, s34, 1
    s_add_u32 s88, s88, s38
    s_add_u32 s87, s33, 0
    s_mov_b32 s54, 134217728
    s_mov_b32 s55, 0x20000
    s_mov_b32 s58, 134217728
    s_mov_b32 s59, 0x20000
    s_waitcnt lgkmcnt(0)
    s_mov_b64 s[52:53], s[18:19]
    s_mov_b64 s[56:57], s[20:21]
    s_add_u32 s39, s87, s88
    s_bfe_u32 s37, s39, 0x30000
    s_lshl_b32 s37, s37, 12
    s_add_u32 s85, s37, s89
    s_bfe_u32 s37, s39, 0x10003
    s_lshl_b32 s37, s37, 11
    s_add_u32 s85, s37, s85
    s_bfe_u32 s37, s39, 0x40004
    s_lshl_b32 s37, s37, 16
    s_add_u32 s85, s37, s85
    buffer_load_dwordx4 v[128:131], v76, s[52:55], s85 offen offset:0 nt
    buffer_load_dwordx4 v[132:135], v77, s[52:55], s85 offen offset:0 nt
    buffer_load_dwordx4 v[136:139], v76, s[52:55], s85 offen offset:1024 nt
    buffer_load_dwordx4 v[140:143], v77, s[52:55], s85 offen offset:1024 nt
    buffer_load_dwordx4 v[144:147], v126, s[56:59], s85 offen offset:0 nt
    buffer_load_dwordx4 v[148:151], v127, s[56:59], s85 offen offset:0 nt
    buffer_load_dwordx4 v[152:155], v126, s[56:59], s85 offen offset:1024 nt
    s_load_dword s35, s[30:31], 0
    s_mov_b32 s48, s30
    s_and_b32 s49, s31, 0xffff
    s_mov_b32 s50, 8388608
    s_mov_b32 s51, 0x20000
    s_mov_b32 s82, 0xffffff00
    s_mov_b32 s83, 0x3e0293ee
    s_mov_b32 s84, 1048576
    v_and_b32 v4, 1, v1
    v_lshlrev_b32 v4, 4, v4
    v_mov_b32 v5, 0xffff
    v_lshlrev_b32 v4, v4, v5
    v_bfe_u32 v5, v1, 1, 2
    v_cmp_eq_u32 vcc, 0, v5
    s_nop 1
    v_cndmask_b32 v10, 0, v4, vcc
    v_cmp_eq_u32 vcc, 1, v5
    s_nop 1
    v_cndmask_b32 v11, 0, v4, vcc
    v_cmp_eq_u32 vcc, 2, v5
    s_nop 1
    v_cndmask_b32 v12, 0, v4, vcc
    v_cmp_eq_u32 vcc, 3, v5
    s_nop 1
    v_cndmask_b32 v13, 0, v4, vcc
    v_mov_b32 v120, 0xff7f0000
    v_mov_b32 v121, 0
    v_mov_b32 v18, 1
    v_mov_b32 v116, 0
    v_mov_b32 v117, 0
    v_mov_b32 v118, 0
    v_mov_b32 v119, 0
    s_lshl_b32 s38, s32, 2
    s_add_u32 s38, s38, s34
    s_lshl_b32 s38, s38, 8
    s_add_u32 s38, s38, 65536
    v_mov_b32 v9, s38
    v_and_b32 v5, 3, v3
    v_lshlrev_b32 v78, 7, v2
    v_lshl_add_u32 v78, v5, 5, v78
    v_bfe_u32 v4, v3, 2, 1
    v_lshl_add_u32 v78, v4, 11, v78
    s_lshl_b32 s91, s32, 12
    s_lshl_b32 s38, s34, 9
    s_add_u32 s91, s91, s38
    s_add_u32 s91, s91, 1048576
    v_lshlrev_b32 v4, 7, v2
    v_lshl_add_u32 v4, v3, 4, v4
    v_mov_b32 v5, 512
    v_cmp_gt_u32 vcc, 8, v3
    s_nop 1
    v_cndmask_b32 v79, v5, v4, vcc
    s_waitcnt vmcnt(6)
    buffer_load_dwordx4 v[156:159], v127, s[56:59], s85 offen offset:1024 nt
    s_waitcnt vmcnt(6)
    s_add_u32 s87, s87, 7
    s_add_u32 s39, s87, s88
    s_bfe_u32 s37, s39, 0x30000
    s_lshl_b32 s37, s37, 12
    s_add_u32 s85, s37, s89
    s_bfe_u32 s37, s39, 0x10003
    s_lshl_b32 s37, s37, 11
    s_add_u32 s85, s37, s85
    s_bfe_u32 s37, s39, 0x40004
    s_lshl_b32 s37, s37, 16
    s_add_u32 s85, s37, s85
    buffer_load_dwordx4 v[160:163], v76, s[52:55], s85 offen offset:0 nt
    s_waitcnt vmcnt(6)
    buffer_load_dwordx4 v[164:167], v77, s[52:55], s85 offen offset:0 nt
    s_waitcnt vmcnt(6)
    buffer_load_dwordx4 v[168:171], v76, s[52:55], s85 offen offset:1024 nt
    s_waitcnt vmcnt(6)
    buffer_load_dwordx4 v[172:175], v77, s[52:55], s85 offen offset:1024 nt
    s_waitcnt vmcnt(6)
    buffer_load_dwordx4 v[176:179], v126, s[56:59], s85 offen offset:0 nt
    s_waitcnt vmcnt(6)
    buffer_load_dwordx4 v[180:183], v127, s[56:59], s85 offen offset:0 nt
    s_waitcnt vmcnt(6)
    buffer_load_dwordx4 v[184:187], v126, s[56:59], s85 offen offset:1024 nt
    s_waitcnt vmcnt(6)
    buffer_load_dwordx4 v[188:191], v127, s[56:59], s85 offen offset:1024 nt
    s_waitcnt vmcnt(6)
    s_add_u32 s87, s87, 7
    s_add_u32 s39, s87, s88
    s_bfe_u32 s37, s39, 0x30000
    s_lshl_b32 s37, s37, 12
    s_add_u32 s85, s37, s89
    s_bfe_u32 s37, s39, 0x10003
    s_lshl_b32 s37, s37, 11
    s_add_u32 s85, s37, s85
    s_bfe_u32 s37, s39, 0x40004
    s_lshl_b32 s37, s37, 16
    s_add_u32 s85, s37, s85
    buffer_load_dwordx4 v[192:195], v76, s[52:55], s85 offen offset:0 nt
    s_waitcnt vmcnt(6)
    buffer_load_dwordx4 v[196:199], v77, s[52:55], s85 offen offset:0 nt
    s_waitcnt vmcnt(6)
    buffer_load_dwordx4 v[200:203], v76, s[52:55], s85 offen offset:1024 nt
    s_waitcnt vmcnt(6)
    buffer_load_dwordx4 v[204:207], v77, s[52:55], s85 offen offset:1024 nt
    s_waitcnt vmcnt(6)
    buffer_load_dwordx4 v[208:211], v126, s[56:59], s85 offen offset:0 nt
    s_waitcnt vmcnt(6)
    buffer_load_dwordx4 v[212:215], v127, s[56:59], s85 offen offset:0 nt
    s_waitcnt vmcnt(6)
    buffer_load_dwordx4 v[216:219], v126, s[56:59], s85 offen offset:1024 nt
    s_waitcnt vmcnt(6)
    buffer_load_dwordx4 v[220:223], v127, s[56:59], s85 offen offset:1024 nt
    s_waitcnt vmcnt(6)
    s_add_u32 s87, s87, 7
    s_add_u32 s39, s87, s88
    s_bfe_u32 s37, s39, 0x30000
    s_lshl_b32 s37, s37, 12
    s_add_u32 s85, s37, s89
    s_bfe_u32 s37, s39, 0x10003
    s_lshl_b32 s37, s37, 11
    s_add_u32 s85, s37, s85
    s_bfe_u32 s37, s39, 0x40004
    s_lshl_b32 s37, s37, 16
    s_add_u32 s85, s37, s85
    buffer_load_dwordx4 v[224:227], v76, s[52:55], s85 offen offset:0 nt
    s_waitcnt vmcnt(6)
    buffer_load_dwordx4 v[228:231], v77, s[52:55], s85 offen offset:0 nt
    s_waitcnt vmcnt(6)
    buffer_load_dwordx4 v[232:235], v76, s[52:55], s85 offen offset:1024 nt
    s_waitcnt vmcnt(6)
    buffer_load_dwordx4 v[236:239], v77, s[52:55], s85 offen offset:1024 nt
    s_waitcnt vmcnt(6)
    buffer_load_dwordx4 v[240:243], v126, s[56:59], s85 offen offset:0 nt
    s_waitcnt vmcnt(6)
    buffer_load_dwordx4 v[244:247], v127, s[56:59], s85 offen offset:0 nt
    s_waitcnt vmcnt(6)
    buffer_load_dwordx4 v[248:251], v126, s[56:59], s85 offen offset:1024 nt
    s_waitcnt vmcnt(6)
    buffer_load_dwordx4 v[252:255], v127, s[56:59], s85 offen offset:1024 nt
    s_waitcnt vmcnt(6)
    s_add_u32 s87, s87, 7
    s_add_u32 s39, s87, s88
    s_bfe_u32 s37, s39, 0x30000
    s_lshl_b32 s37, s37, 12
    s_add_u32 s85, s37, s89
    s_bfe_u32 s37, s39, 0x10003
    s_lshl_b32 s37, s37, 11
    s_add_u32 s85, s37, s85
    s_bfe_u32 s37, s39, 0x40004
    s_lshl_b32 s37, s37, 16
    s_add_u32 s85, s37, s85
    buffer_load_dwordx4 a[0:3], v76, s[52:55], s85 offen offset:0 nt
    s_waitcnt vmcnt(6)
    buffer_load_dwordx4 a[4:7], v77, s[52:55], s85 offen offset:0 nt
    s_waitcnt vmcnt(6)
    buffer_load_dwordx4 a[8:11], v76, s[52:55], s85 offen offset:1024 nt
    s_waitcnt vmcnt(6)
    buffer_load_dwordx4 a[12:15], v77, s[52:55], s85 offen offset:1024 nt
    buffer_load_dwordx4 v[68:71], v78, s[48:51], s91 offen offset:0 sc1
    buffer_load_dwordx4 v[72:75], v78, s[48:51], s91 offen offset:16 sc1
    s_waitcnt vmcnt(8)
    buffer_load_dwordx4 a[16:19], v126, s[56:59], s85 offen offset:0 nt
    s_waitcnt vmcnt(8)
    buffer_load_dwordx4 a[20:23], v127, s[56:59], s85 offen offset:0 nt
    s_waitcnt vmcnt(8)
    buffer_load_dwordx4 a[24:27], v126, s[56:59], s85 offen offset:1024 nt
    s_waitcnt vmcnt(8)
    buffer_load_dwordx4 a[28:31], v127, s[56:59], s85 offen offset:1024 nt
    s_waitcnt vmcnt(8)
    s_add_u32 s87, s87, 7
    s_add_u32 s39, s87, s88
    s_bfe_u32 s37, s39, 0x30000
    s_lshl_b32 s37, s37, 12
    s_add_u32 s85, s37, s89
    s_bfe_u32 s37, s39, 0x10003
    s_lshl_b32 s37, s37, 11
    s_add_u32 s85, s37, s85
    s_bfe_u32 s37, s39, 0x40004
    s_lshl_b32 s37, s37, 16
    s_add_u32 s85, s37, s85
    buffer_load_dwordx4 a[32:35], v76, s[52:55], s85 offen offset:0 nt
    s_waitcnt vmcnt(8)
    buffer_load_dwordx4 a[36:39], v77, s[52:55], s85 offen offset:0 nt
    s_waitcnt lgkmcnt(0)
    s_add_u32 s35, s35, 0x5b
    s_and_b32 s35, s35, 0xff
    v_mov_b32 v8, s35
    s_waitcnt vmcnt(6)
L_qcheck_1:
    v_xor_b32 v68, s35, v68
    v_xor_b32 v69, s35, v69
    v_xor_b32 v70, s35, v70
    v_xor_b32 v71, s35, v71
    v_xor_b32 v72, s35, v72
    v_xor_b32 v73, s35, v73
    v_xor_b32 v74, s35, v74
    v_xor_b32 v75, s35, v75
    v_or_b32 v4, v68, v69
    v_or3_b32 v4, v4, v70, v71
    v_or3_b32 v4, v4, v72, v73
    v_or3_b32 v4, v4, v74, v75
    v_and_b32 v4, 0xff, v4
    v_cmp_ne_u32 vcc, 0, v4
    s_cbranch_vccz L_qok_2
    buffer_load_dwordx4 v[68:71], v78, s[48:51], s91 offen offset:0 sc1
    buffer_load_dwordx4 v[72:75], v78, s[48:51], s91 offen offset:16 sc1
    s_waitcnt vmcnt(0)
    s_sub_u32 s84, s84, 1
    s_cmp_lg_u32 s84, 0
    s_cbranch_scc1 L_qcheck_1
    s_branch L_end
L_qok_2:
    v_add_f32_dpp v68, v68, v68 row_ror:4 row_mask:0xf bank_mask:0xf
    v_add_f32_dpp v69, v69, v69 row_ror:4 row_mask:0xf bank_mask:0xf
    v_add_f32_dpp v70, v70, v70 row_ror:4 row_mask:0xf bank_mask:0xf
    v_add_f32_dpp v71, v71, v71 row_ror:4 row_mask:0xf bank_mask:0xf
    v_add_f32_dpp v72, v72, v72 row_ror:4 row_mask:0xf bank_mask:0xf
    v_add_f32_dpp v73, v73, v73 row_ror:4 row_mask:0xf bank_mask:0xf
    v_add_f32_dpp v74, v74, v74 row_ror:4 row_mask:0xf bank_mask:0xf
    v_add_f32_dpp v75, v75, v75 row_ror:4 row_mask:0xf bank_mask:0xf
    v_cvt_pk_bf16_f32 v68, v68, v69
    v_cvt_pk_bf16_f32 v69, v70, v71
    v_cvt_pk_bf16_f32 v70, v72, v73
    v_cvt_pk_bf16_f32 v71, v74, v75
    s_mov_b32 vcc_lo, 0xf000f
    s_mov_b32 vcc_hi, 0xf000f
    v_cndmask_b32 v80, 0, v68, vcc
    v_cndmask_b32 v81, 0, v69, vcc
    v_cndmask_b32 v82, 0, v70, vcc
    v_cndmask_b32 v83, 0, v71, vcc
    s_mov_b32 vcc_lo, 0xf000f0
    s_mov_b32 vcc_hi, 0xf000f0
    v_cndmask_b32 v84, 0, v68, vcc
    v_cndmask_b32 v85, 0, v69, vcc
    v_cndmask_b32 v86, 0, v70, vcc
    v_cndmask_b32 v87, 0, v71, vcc
    s_mov_b32 vcc_lo, 0xf000f00
    s_mov_b32 vcc_hi, 0xf000f00
    v_cndmask_b32 v88, 0, v68, vcc
    v_cndmask_b32 v89, 0, v69, vcc
    v_cndmask_b32 v90, 0, v70, vcc
    v_cndmask_b32 v91, 0, v71, vcc
    s_mov_b32 vcc_lo, 0xf000f000
    s_mov_b32 vcc_hi, 0xf000f000
    v_cndmask_b32 v92, 0, v68, vcc
    v_cndmask_b32 v93, 0, v69, vcc
    v_cndmask_b32 v94, 0, v70, vcc
    v_cndmask_b32 v95, 0, v71, vcc
    buffer_load_dwordx4 a[40:43], v76, s[52:55], s85 offen offset:1024 nt
    v_mfma_f32_16x16x32_bf16 v[112:115], v[128:131], v[80:83], 0
    v_mfma_f32_16x16x32_bf16 v[112:115], v[132:135], v[84:87], v[112:115]
    v_mfma_f32_16x16x32_bf16 v[112:115], v[136:139], v[88:91], v[112:115]
    v_mfma_f32_16x16x32_bf16 v[112:115], v[140:143], v[92:95], v[112:115]
    s_nop 7
    v_mov_b32_dpp v122, v112 quad_perm:[0,0,0,0] row_mask:0xf bank_mask:0xf
    v_mov_b32_dpp v124, v114 quad_perm:[2,2,2,2] row_mask:0xf bank_mask:0xf
    s_nop 0
    v_add_f32_dpp v122, v113, v122 quad_perm:[1,1,1,1] row_mask:0xf bank_mask:0xf
    v_add_f32_dpp v124, v115, v124 quad_perm:[3,3,3,3] row_mask:0xf bank_mask:0xf
    v_add_f32 v122, v122, v124
    v_fma_f32 v123, v122, s83, -v120
    v_cmp_lt_f32 vcc, 0, v123
    s_cbranch_vccz L_nomax_3
    v_mul_f32 v122, s83, v122
    s_nop 1
    v_max_f32_dpp v124, v122, v122 row_ror:4 row_mask:0xf bank_mask:0xf
    s_nop 1
    v_max_f32_dpp v124, v124, v124 row_ror:8 row_mask:0xf bank_mask:0xf
    v_mov_b32 v125, v124
    s_nop 1
    v_permlane16_swap_b32 v124, v125
    v_max_f32 v124, v124, v125
    v_mov_b32 v125, v124
    s_nop 1
    v_permlane32_swap_b32 v124, v125
    v_max_f32 v124, v124, v125
    v_and_b32 v124, s82, v124
    v_max_f32 v124, v124, v120
    v_sub_f32 v125, v120, v124
    v_exp_f32 v125, v125
    v_mov_b32 v120, v124
    v_sub_f32 v123, v122, v124
    v_mul_f32 v121, v121, v125
    v_mul_f32 v116, v116, v125
    v_mul_f32 v117, v117, v125
    v_mul_f32 v118, v118, v125
    v_mul_f32 v119, v119, v125
L_nomax_3:
    v_exp_f32 v123, v123
    s_nop 0
    v_cvt_pk_bf16_f32 v124, v123, v123
    v_add_f32 v121, v121, v123
    s_nop 0
    v_and_b32_dpp v96, v124, v10 row_newbcast:0 row_mask:0xf bank_mask:0xf
    v_and_b32_dpp v97, v124, v11 row_newbcast:0 row_mask:0xf bank_mask:0xf
    v_and_b32_dpp v98, v124, v12 row_newbcast:0 row_mask:0xf bank_mask:0xf
    v_and_b32_dpp v99, v124, v13 row_newbcast:0 row_mask:0xf bank_mask:0xf
    v_and_b32_dpp v100, v124, v10 row_newbcast:4 row_mask:0xf bank_mask:0xf
    v_and_b32_dpp v101, v124, v11 row_newbcast:4 row_mask:0xf bank_mask:0xf
    v_and_b32_dpp v102, v124, v12 row_newbcast:4 row_mask:0xf bank_mask:0xf
    v_and_b32_dpp v103, v124, v13 row_newbcast:4 row_mask:0xf bank_mask:0xf
    v_and_b32_dpp v104, v124, v10 row_newbcast:8 row_mask:0xf bank_mask:0xf
    v_and_b32_dpp v105, v124, v11 row_newbcast:8 row_mask:0xf bank_mask:0xf
    v_and_b32_dpp v106, v124, v12 row_newbcast:8 row_mask:0xf bank_mask:0xf
    v_and_b32_dpp v107, v124, v13 row_newbcast:8 row_mask:0xf bank_mask:0xf
    v_and_b32_dpp v108, v124, v10 row_newbcast:12 row_mask:0xf bank_mask:0xf
    v_and_b32_dpp v109, v124, v11 row_newbcast:12 row_mask:0xf bank_mask:0xf
    v_and_b32_dpp v110, v124, v12 row_newbcast:12 row_mask:0xf bank_mask:0xf
    v_and_b32_dpp v111, v124, v13 row_newbcast:12 row_mask:0xf bank_mask:0xf
    s_waitcnt vmcnt(6)
    buffer_load_dwordx4 a[44:47], v77, s[52:55], s85 offen offset:1024 nt
    v_mfma_f32_16x16x32_bf16 v[116:119], v[144:147], v[96:99], v[116:119]
    v_mfma_f32_16x16x32_bf16 v[116:119], v[148:151], v[100:103], v[116:119]
    v_mfma_f32_16x16x32_bf16 v[116:119], v[152:155], v[104:107], v[116:119]
    v_mfma_f32_16x16x32_bf16 v[116:119], v[156:159], v[108:111], v[116:119]
    s_waitcnt vmcnt(6)
    buffer_load_dwordx4 a[48:51], v126, s[56:59], s85 offen offset:0 nt
    v_mfma_f32_16x16x32_bf16 v[112:115], v[160:163], v[80:83], 0
    v_mfma_f32_16x16x32_bf16 v[112:115], v[164:167], v[84:87], v[112:115]
    v_mfma_f32_16x16x32_bf16 v[112:115], v[168:171], v[88:91], v[112:115]
    v_mfma_f32_16x16x32_bf16 v[112:115], v[172:175], v[92:95], v[112:115]
    s_nop 7
    v_mov_b32_dpp v122, v112 quad_perm:[0,0,0,0] row_mask:0xf bank_mask:0xf
    v_mov_b32_dpp v124, v114 quad_perm:[2,2,2,2] row_mask:0xf bank_mask:0xf
    s_nop 0
    v_add_f32_dpp v122, v113, v122 quad_perm:[1,1,1,1] row_mask:0xf bank_mask:0xf
    v_add_f32_dpp v124, v115, v124 quad_perm:[3,3,3,3] row_mask:0xf bank_mask:0xf
    v_add_f32 v122, v122, v124
    v_fma_f32 v123, v122, s83, -v120
    v_cmp_lt_f32 vcc, 0, v123
    s_cbranch_vccz L_nomax_4
    v_mul_f32 v122, s83, v122
    s_nop 1
    v_max_f32_dpp v124, v122, v122 row_ror:4 row_mask:0xf bank_mask:0xf
    s_nop 1
    v_max_f32_dpp v124, v124, v124 row_ror:8 row_mask:0xf bank_mask:0xf
    v_mov_b32 v125, v124
    s_nop 1
    v_permlane16_swap_b32 v124, v125
    v_max_f32 v124, v124, v125
    v_mov_b32 v125, v124
    s_nop 1
    v_permlane32_swap_b32 v124, v125
    v_max_f32 v124, v124, v125
    v_and_b32 v124, s82, v124
    v_max_f32 v124, v124, v120
    v_sub_f32 v125, v120, v124
    v_exp_f32 v125, v125
    v_mov_b32 v120, v124
    v_sub_f32 v123, v122, v124
    v_mul_f32 v121, v121, v125
    v_mul_f32 v116, v116, v125
    v_mul_f32 v117, v117, v125
    v_mul_f32 v118, v118, v125
    v_mul_f32 v119, v119, v125
L_nomax_4:
    v_exp_f32 v123, v123
    s_nop 0
    v_cvt_pk_bf16_f32 v124, v123, v123
    v_add_f32 v121, v121, v123
    s_nop 0
    v_and_b32_dpp v96, v124, v10 row_newbcast:0 row_mask:0xf bank_mask:0xf
    v_and_b32_dpp v97, v124, v11 row_newbcast:0 row_mask:0xf bank_mask:0xf
    v_and_b32_dpp v98, v124, v12 row_newbcast:0 row_mask:0xf bank_mask:0xf
    v_and_b32_dpp v99, v124, v13 row_newbcast:0 row_mask:0xf bank_mask:0xf
    v_and_b32_dpp v100, v124, v10 row_newbcast:4 row_mask:0xf bank_mask:0xf
    v_and_b32_dpp v101, v124, v11 row_newbcast:4 row_mask:0xf bank_mask:0xf
    v_and_b32_dpp v102, v124, v12 row_newbcast:4 row_mask:0xf bank_mask:0xf
    v_and_b32_dpp v103, v124, v13 row_newbcast:4 row_mask:0xf bank_mask:0xf
    v_and_b32_dpp v104, v124, v10 row_newbcast:8 row_mask:0xf bank_mask:0xf
    v_and_b32_dpp v105, v124, v11 row_newbcast:8 row_mask:0xf bank_mask:0xf
    v_and_b32_dpp v106, v124, v12 row_newbcast:8 row_mask:0xf bank_mask:0xf
    v_and_b32_dpp v107, v124, v13 row_newbcast:8 row_mask:0xf bank_mask:0xf
    v_and_b32_dpp v108, v124, v10 row_newbcast:12 row_mask:0xf bank_mask:0xf
    v_and_b32_dpp v109, v124, v11 row_newbcast:12 row_mask:0xf bank_mask:0xf
    v_and_b32_dpp v110, v124, v12 row_newbcast:12 row_mask:0xf bank_mask:0xf
    v_and_b32_dpp v111, v124, v13 row_newbcast:12 row_mask:0xf bank_mask:0xf
    v_mfma_f32_16x16x32_bf16 v[116:119], v[176:179], v[96:99], v[116:119]
    s_waitcnt vmcnt(6)
    buffer_load_dwordx4 a[52:55], v127, s[56:59], s85 offen offset:0 nt
    v_mfma_f32_16x16x32_bf16 v[116:119], v[180:183], v[100:103], v[116:119]
    v_mfma_f32_16x16x32_bf16 v[116:119], v[184:187], v[104:107], v[116:119]
    v_mfma_f32_16x16x32_bf16 v[116:119], v[188:191], v[108:111], v[116:119]
    v_mfma_f32_16x16x32_bf16 v[112:115], v[192:195], v[80:83], 0
    s_waitcnt vmcnt(6)
    buffer_load_dwordx4 a[56:59], v126, s[56:59], s85 offen offset:1024 nt
    v_mfma_f32_16x16x32_bf16 v[112:115], v[196:199], v[84:87], v[112:115]
    v_mfma_f32_16x16x32_bf16 v[112:115], v[200:203], v[88:91], v[112:115]
    v_mfma_f32_16x16x32_bf16 v[112:115], v[204:207], v[92:95], v[112:115]
    s_nop 7
    v_mov_b32_dpp v122, v112 quad_perm:[0,0,0,0] row_mask:0xf bank_mask:0xf
    v_mov_b32_dpp v124, v114 quad_perm:[2,2,2,2] row_mask:0xf bank_mask:0xf
    s_nop 0
    v_add_f32_dpp v122, v113, v122 quad_perm:[1,1,1,1] row_mask:0xf bank_mask:0xf
    v_add_f32_dpp v124, v115, v124 quad_perm:[3,3,3,3] row_mask:0xf bank_mask:0xf
    v_add_f32 v122, v122, v124
    v_fma_f32 v123, v122, s83, -v120
    v_cmp_lt_f32 vcc, 0, v123
    s_cbranch_vccz L_nomax_5
    v_mul_f32 v122, s83, v122
    s_nop 1
    v_max_f32_dpp v124, v122, v122 row_ror:4 row_mask:0xf bank_mask:0xf
    s_nop 1
    v_max_f32_dpp v124, v124, v124 row_ror:8 row_mask:0xf bank_mask:0xf
    v_mov_b32 v125, v124
    s_nop 1
    v_permlane16_swap_b32 v124, v125
    v_max_f32 v124, v124, v125
    v_mov_b32 v125, v124
    s_nop 1
    v_permlane32_swap_b32 v124, v125
    v_max_f32 v124, v124, v125
    v_and_b32 v124, s82, v124
    v_max_f32 v124, v124, v120
    v_sub_f32 v125, v120, v124
    v_exp_f32 v125, v125
    v_mov_b32 v120, v124
    v_sub_f32 v123, v122, v124
    v_mul_f32 v121, v121, v125
    v_mul_f32 v116, v116, v125
    v_mul_f32 v117, v117, v125
    v_mul_f32 v118, v118, v125
    v_mul_f32 v119, v119, v125
L_nomax_5:
    v_exp_f32 v123, v123
    s_nop 0
    v_cvt_pk_bf16_f32 v124, v123, v123
    v_add_f32 v121, v121, v123
    s_nop 0
    v_and_b32_dpp v96, v124, v10 row_newbcast:0 row_mask:0xf bank_mask:0xf
    v_and_b32_dpp v97, v124, v11 row_newbcast:0 row_mask:0xf bank_mask:0xf
    v_and_b32_dpp v98, v124, v12 row_newbcast:0 row_mask:0xf bank_mask:0xf
    v_and_b32_dpp v99, v124, v13 row_newbcast:0 row_mask:0xf bank_mask:0xf
    v_and_b32_dpp v100, v124, v10 row_newbcast:4 row_mask:0xf bank_mask:0xf
    v_and_b32_dpp v101, v124, v11 row_newbcast:4 row_mask:0xf bank_mask:0xf
    v_and_b32_dpp v102, v124, v12 row_newbcast:4 row_mask:0xf bank_mask:0xf
    v_and_b32_dpp v103, v124, v13 row_newbcast:4 row_mask:0xf bank_mask:0xf
    v_and_b32_dpp v104, v124, v10 row_newbcast:8 row_mask:0xf bank_mask:0xf
    v_and_b32_dpp v105, v124, v11 row_newbcast:8 row_mask:0xf bank_mask:0xf
    v_and_b32_dpp v106, v124, v12 row_newbcast:8 row_mask:0xf bank_mask:0xf
    v_and_b32_dpp v107, v124, v13 row_newbcast:8 row_mask:0xf bank_mask:0xf
    v_and_b32_dpp v108, v124, v10 row_newbcast:12 row_mask:0xf bank_mask:0xf
    v_and_b32_dpp v109, v124, v11 row_newbcast:12 row_mask:0xf bank_mask:0xf
    v_and_b32_dpp v110, v124, v12 row_newbcast:12 row_mask:0xf bank_mask:0xf
    v_and_b32_dpp v111, v124, v13 row_newbcast:12 row_mask:0xf bank_mask:0xf
    v_mfma_f32_16x16x32_bf16 v[116:119], v[208:211], v[96:99], v[116:119]
    s_waitcnt vmcnt(6)
    buffer_load_dwordx4 a[60:63], v127, s[56:59], s85 offen offset:1024 nt
    v_mfma_f32_16x16x32_bf16 v[116:119], v[212:215], v[100:103], v[116:119]
    v_mfma_f32_16x16x32_bf16 v[116:119], v[216:219], v[104:107], v[116:119]
    v_mfma_f32_16x16x32_bf16 v[116:119], v[220:223], v[108:111], v[116:119]
    v_mfma_f32_16x16x32_bf16 v[112:115], v[224:227], v[80:83], 0
    v_mfma_f32_16x16x32_bf16 v[112:115], v[228:231], v[84:87], v[112:115]
    s_waitcnt vmcnt(5)
    s_add_u32 s87, s87, 7
    s_add_u32 s39, s87, s88
    s_bfe_u32 s37, s39, 0x30000
    s_lshl_b32 s37, s37, 12
    s_add_u32 s85, s37, s89
    s_bfe_u32 s37, s39, 0x10003
    s_lshl_b32 s37, s37, 11
    s_add_u32 s85, s37, s85
    s_bfe_u32 s37, s39, 0x40004
    s_lshl_b32 s37, s37, 16
    s_add_u32 s85, s37, s85
    buffer_load_dwordx4 v[128:131], v76, s[52:55], s85 offen offset:0 nt
    v_mfma_f32_16x16x32_bf16 v[112:115], v[232:235], v[88:91], v[112:115]
    v_mfma_f32_16x16x32_bf16 v[112:115], v[236:239], v[92:95], v[112:115]
    s_nop 7
    v_mov_b32_dpp v122, v112 quad_perm:[0,0,0,0] row_mask:0xf bank_mask:0xf
    v_mov_b32_dpp v124, v114 quad_perm:[2,2,2,2] row_mask:0xf bank_mask:0xf
    s_nop 0
    v_add_f32_dpp v122, v113, v122 quad_perm:[1,1,1,1] row_mask:0xf bank_mask:0xf
    v_add_f32_dpp v124, v115, v124 quad_perm:[3,3,3,3] row_mask:0xf bank_mask:0xf
    v_add_f32 v122, v122, v124
    v_fma_f32 v123, v122, s83, -v120
    v_cmp_lt_f32 vcc, 0, v123
    s_cbranch_vccz L_nomax_6
    v_mul_f32 v122, s83, v122
    s_nop 1
    v_max_f32_dpp v124, v122, v122 row_ror:4 row_mask:0xf bank_mask:0xf
    s_nop 1
    v_max_f32_dpp v124, v124, v124 row_ror:8 row_mask:0xf bank_mask:0xf
    v_mov_b32 v125, v124
    s_nop 1
    v_permlane16_swap_b32 v124, v125
    v_max_f32 v124, v124, v125
    v_mov_b32 v125, v124
    s_nop 1
    v_permlane32_swap_b32 v124, v125
    v_max_f32 v124, v124, v125
    v_and_b32 v124, s82, v124
    v_max_f32 v124, v124, v120
    v_sub_f32 v125, v120, v124
    v_exp_f32 v125, v125
    v_mov_b32 v120, v124
    v_sub_f32 v123, v122, v124
    v_mul_f32 v121, v121, v125
    v_mul_f32 v116, v116, v125
    v_mul_f32 v117, v117, v125
    v_mul_f32 v118, v118, v125
    v_mul_f32 v119, v119, v125
L_nomax_6:
    v_exp_f32 v123, v123
    s_nop 0
    v_cvt_pk_bf16_f32 v124, v123, v123
    v_add_f32 v121, v121, v123
    s_nop 0
    v_and_b32_dpp v96, v124, v10 row_newbcast:0 row_mask:0xf bank_mask:0xf
    v_and_b32_dpp v97, v124, v11 row_newbcast:0 row_mask:0xf bank_mask:0xf
    v_and_b32_dpp v98, v124, v12 row_newbcast:0 row_mask:0xf bank_mask:0xf
    v_and_b32_dpp v99, v124, v13 row_newbcast:0 row_mask:0xf bank_mask:0xf
    v_and_b32_dpp v100, v124, v10 row_newbcast:4 row_mask:0xf bank_mask:0xf
    v_and_b32_dpp v101, v124, v11 row_newbcast:4 row_mask:0xf bank_mask:0xf
    v_and_b32_dpp v102, v124, v12 row_newbcast:4 row_mask:0xf bank_mask:0xf
    v_and_b32_dpp v103, v124, v13 row_newbcast:4 row_mask:0xf bank_mask:0xf
    v_and_b32_dpp v104, v124, v10 row_newbcast:8 row_mask:0xf bank_mask:0xf
    v_and_b32_dpp v105, v124, v11 row_newbcast:8 row_mask:0xf bank_mask:0xf
    v_and_b32_dpp v106, v124, v12 row_newbcast:8 row_mask:0xf bank_mask:0xf
    v_and_b32_dpp v107, v124, v13 row_newbcast:8 row_mask:0xf bank_mask:0xf
    v_and_b32_dpp v108, v124, v10 row_newbcast:12 row_mask:0xf bank_mask:0xf
    v_and_b32_dpp v109, v124, v11 row_newbcast:12 row_mask:0xf bank_mask:0xf
    v_and_b32_dpp v110, v124, v12 row_newbcast:12 row_mask:0xf bank_mask:0xf
    v_and_b32_dpp v111, v124, v13 row_newbcast:12 row_mask:0xf bank_mask:0xf
    v_mfma_f32_16x16x32_bf16 v[116:119], v[240:243], v[96:99], v[116:119]
    v_mfma_f32_16x16x32_bf16 v[116:119], v[244:247], v[100:103], v[116:119]
    s_waitcnt vmcnt(5)
    buffer_load_dwordx4 v[132:135], v77, s[52:55], s85 offen offset:0 nt
    v_mfma_f32_16x16x32_bf16 v[116:119], v[248:251], v[104:107], v[116:119]
    v_mfma_f32_16x16x32_bf16 v[116:119], v[252:255], v[108:111], v[116:119]
    v_mfma_f32_16x16x32_bf16 v[112:115], a[0:3], v[80:83], 0
    v_mfma_f32_16x16x32_bf16 v[112:115], a[4:7], v[84:87], v[112:115]
    s_waitcnt vmcnt(5)
    buffer_load_dwordx4 v[136:139], v76, s[52:55], s85 offen offset:1024 nt
    v_mfma_f32_16x16x32_bf16 v[112:115], a[8:11], v[88:91], v[112:115]
    v_mfma_f32_16x16x32_bf16 v[112:115], a[12:15], v[92:95], v[112:115]
    s_nop 7
    v_mov_b32_dpp v122, v112 quad_perm:[0,0,0,0] row_mask:0xf bank_mask:0xf
    v_mov_b32_dpp v124, v114 quad_perm:[2,2,2,2] row_mask:0xf bank_mask:0xf
    s_nop 0
    v_add_f32_dpp v122, v113, v122 quad_perm:[1,1,1,1] row_mask:0xf bank_mask:0xf
    v_add_f32_dpp v124, v115, v124 quad_perm:[3,3,3,3] row_mask:0xf bank_mask:0xf
    v_add_f32 v122, v122, v124
    v_fma_f32 v123, v122, s83, -v120
    v_cmp_lt_f32 vcc, 0, v123
    s_cbranch_vccz L_nomax_7
    v_mul_f32 v122, s83, v122
    s_nop 1
    v_max_f32_dpp v124, v122, v122 row_ror:4 row_mask:0xf bank_mask:0xf
    s_nop 1
    v_max_f32_dpp v124, v124, v124 row_ror:8 row_mask:0xf bank_mask:0xf
    v_mov_b32 v125, v124
    s_nop 1
    v_permlane16_swap_b32 v124, v125
    v_max_f32 v124, v124, v125
    v_mov_b32 v125, v124
    s_nop 1
    v_permlane32_swap_b32 v124, v125
    v_max_f32 v124, v124, v125
    v_and_b32 v124, s82, v124
    v_max_f32 v124, v124, v120
    v_sub_f32 v125, v120, v124
    v_exp_f32 v125, v125
    v_mov_b32 v120, v124
    v_sub_f32 v123, v122, v124
    v_mul_f32 v121, v121, v125
    v_mul_f32 v116, v116, v125
    v_mul_f32 v117, v117, v125
    v_mul_f32 v118, v118, v125
    v_mul_f32 v119, v119, v125
L_nomax_7:
    v_exp_f32 v123, v123
    s_nop 0
    v_cvt_pk_bf16_f32 v124, v123, v123
    v_add_f32 v121, v121, v123
    s_nop 0
    v_and_b32_dpp v96, v124, v10 row_newbcast:0 row_mask:0xf bank_mask:0xf
    v_and_b32_dpp v97, v124, v11 row_newbcast:0 row_mask:0xf bank_mask:0xf
    v_and_b32_dpp v98, v124, v12 row_newbcast:0 row_mask:0xf bank_mask:0xf
    v_and_b32_dpp v99, v124, v13 row_newbcast:0 row_mask:0xf bank_mask:0xf
    v_and_b32_dpp v100, v124, v10 row_newbcast:4 row_mask:0xf bank_mask:0xf
    v_and_b32_dpp v101, v124, v11 row_newbcast:4 row_mask:0xf bank_mask:0xf
    v_and_b32_dpp v102, v124, v12 row_newbcast:4 row_mask:0xf bank_mask:0xf
    v_and_b32_dpp v103, v124, v13 row_newbcast:4 row_mask:0xf bank_mask:0xf
    v_and_b32_dpp v104, v124, v10 row_newbcast:8 row_mask:0xf bank_mask:0xf
    v_and_b32_dpp v105, v124, v11 row_newbcast:8 row_mask:0xf bank_mask:0xf
    v_and_b32_dpp v106, v124, v12 row_newbcast:8 row_mask:0xf bank_mask:0xf
    v_and_b32_dpp v107, v124, v13 row_newbcast:8 row_mask:0xf bank_mask:0xf
    v_and_b32_dpp v108, v124, v10 row_newbcast:12 row_mask:0xf bank_mask:0xf
    v_and_b32_dpp v109, v124, v11 row_newbcast:12 row_mask:0xf bank_mask:0xf
    v_and_b32_dpp v110, v124, v12 row_newbcast:12 row_mask:0xf bank_mask:0xf
    v_and_b32_dpp v111, v124, v13 row_newbcast:12 row_mask:0xf bank_mask:0xf
    v_mfma_f32_16x16x32_bf16 v[116:119], a[16:19], v[96:99], v[116:119]
    v_mfma_f32_16x16x32_bf16 v[116:119], a[20:23], v[100:103], v[116:119]
    v_mfma_f32_16x16x32_bf16 v[116:119], a[24:27], v[104:107], v[116:119]
    s_waitcnt vmcnt(5)
    buffer_load_dwordx4 v[140:143], v77, s[52:55], s85 offen offset:1024 nt
    v_mfma_f32_16x16x32_bf16 v[116:119], a[28:31], v[108:111], v[116:119]
    v_mfma_f32_16x16x32_bf16 v[112:115], a[32:35], v[80:83], 0
    v_mfma_f32_16x16x32_bf16 v[112:115], a[36:39], v[84:87], v[112:115]
    v_mfma_f32_16x16x32_bf16 v[112:115], a[40:43], v[88:91], v[112:115]
    s_waitcnt vmcnt(5)
    buffer_load_dwordx4 v[144:147], v126, s[56:59], s85 offen offset:0 nt
    v_mfma_f32_16x16x32_bf16 v[112:115], a[44:47], v[92:95], v[112:115]
    s_nop 7
    v_mov_b32_dpp v122, v112 quad_perm:[0,0,0,0] row_mask:0xf bank_mask:0xf
    v_mov_b32_dpp v124, v114 quad_perm:[2,2,2,2] row_mask:0xf bank_mask:0xf
    s_nop 0
    v_add_f32_dpp v122, v113, v122 quad_perm:[1,1,1,1] row_mask:0xf bank_mask:0xf
    v_add_f32_dpp v124, v115, v124 quad_perm:[3,3,3,3] row_mask:0xf bank_mask:0xf
    v_add_f32 v122, v122, v124
    v_fma_f32 v123, v122, s83, -v120
    v_cmp_lt_f32 vcc, 0, v123
    s_cbranch_vccz L_nomax_8
    v_mul_f32 v122, s83, v122
    s_nop 1
    v_max_f32_dpp v124, v122, v122 row_ror:4 row_mask:0xf bank_mask:0xf
    s_nop 1
    v_max_f32_dpp v124, v124, v124 row_ror:8 row_mask:0xf bank_mask:0xf
    v_mov_b32 v125, v124
    s_nop 1
    v_permlane16_swap_b32 v124, v125
    v_max_f32 v124, v124, v125
    v_mov_b32 v125, v124
    s_nop 1
    v_permlane32_swap_b32 v124, v125
    v_max_f32 v124, v124, v125
    v_and_b32 v124, s82, v124
    v_max_f32 v124, v124, v120
    v_sub_f32 v125, v120, v124
    v_exp_f32 v125, v125
    v_mov_b32 v120, v124
    v_sub_f32 v123, v122, v124
    v_mul_f32 v121, v121, v125
    v_mul_f32 v116, v116, v125
    v_mul_f32 v117, v117, v125
    v_mul_f32 v118, v118, v125
    v_mul_f32 v119, v119, v125
L_nomax_8:
    v_exp_f32 v123, v123
    s_nop 0
    v_cvt_pk_bf16_f32 v124, v123, v123
    v_add_f32 v121, v121, v123
    s_nop 0
    v_and_b32_dpp v96, v124, v10 row_newbcast:0 row_mask:0xf bank_mask:0xf
    v_and_b32_dpp v97, v124, v11 row_newbcast:0 row_mask:0xf bank_mask:0xf
    v_and_b32_dpp v98, v124, v12 row_newbcast:0 row_mask:0xf bank_mask:0xf
    v_and_b32_dpp v99, v124, v13 row_newbcast:0 row_mask:0xf bank_mask:0xf
    v_and_b32_dpp v100, v124, v10 row_newbcast:4 row_mask:0xf bank_mask:0xf
    v_and_b32_dpp v101, v124, v11 row_newbcast:4 row_mask:0xf bank_mask:0xf
    v_and_b32_dpp v102, v124, v12 row_newbcast:4 row_mask:0xf bank_mask:0xf
    v_and_b32_dpp v103, v124, v13 row_newbcast:4 row_mask:0xf bank_mask:0xf
    v_and_b32_dpp v104, v124, v10 row_newbcast:8 row_mask:0xf bank_mask:0xf
    v_and_b32_dpp v105, v124, v11 row_newbcast:8 row_mask:0xf bank_mask:0xf
    v_and_b32_dpp v106, v124, v12 row_newbcast:8 row_mask:0xf bank_mask:0xf
    v_and_b32_dpp v107, v124, v13 row_newbcast:8 row_mask:0xf bank_mask:0xf
    v_and_b32_dpp v108, v124, v10 row_newbcast:12 row_mask:0xf bank_mask:0xf
    v_and_b32_dpp v109, v124, v11 row_newbcast:12 row_mask:0xf bank_mask:0xf
    v_and_b32_dpp v110, v124, v12 row_newbcast:12 row_mask:0xf bank_mask:0xf
    v_and_b32_dpp v111, v124, v13 row_newbcast:12 row_mask:0xf bank_mask:0xf
    v_mfma_f32_16x16x32_bf16 v[116:119], a[48:51], v[96:99], v[116:119]
    v_mfma_f32_16x16x32_bf16 v[116:119], a[52:55], v[100:103], v[116:119]
    v_mfma_f32_16x16x32_bf16 v[116:119], a[56:59], v[104:107], v[116:119]
    s_waitcnt vmcnt(5)
    v_mfma_f32_16x16x32_bf16 v[116:119], a[60:63], v[108:111], v[116:119]
    s_add_u32 s87, s87, 7
    s_add_u32 s39, s87, s88
    s_bfe_u32 s37, s39, 0x30000
    s_lshl_b32 s37, s37, 12
    s_add_u32 s86, s37, s89
    s_bfe_u32 s37, s39, 0x10003
    s_lshl_b32 s37, s37, 11
    s_add_u32 s86, s37, s86
    s_bfe_u32 s37, s39, 0x40004
    s_lshl_b32 s37, s37, 16
    s_add_u32 s86, s37, s86
L_bloop:
    s_waitcnt vmcnt(4)
    buffer_load_dwordx4 v[148:151], v127, s[56:59], s85 offen offset:0 nt
    v_mfma_f32_16x16x32_bf16 v[112:115], v[128:131], v[80:83], 0
    s_waitcnt vmcnt(4)
    buffer_load_dwordx4 v[152:155], v126, s[56:59], s85 offen offset:1024 nt
    v_mfma_f32_16x16x32_bf16 v[112:115], v[132:135], v[84:87], v[112:115]
    s_waitcnt vmcnt(4)
    buffer_load_dwordx4 v[156:159], v127, s[56:59], s85 offen offset:1024 nt
    v_mfma_f32_16x16x32_bf16 v[112:115], v[136:139], v[88:91], v[112:115]
    s_waitcnt vmcnt(4)
    buffer_load_dwordx4 v[160:163], v76, s[52:55], s86 offen offset:0 nt
    buffer_load_dwordx4 v[164:167], v77, s[52:55], s86 offen offset:0 nt
    v_mfma_f32_16x16x32_bf16 v[112:115], v[140:143], v[92:95], v[112:115]
    s_add_u32 s87, s87, 7
    s_add_u32 s39, s87, s88
    s_bfe_u32 s37, s39, 0x30000
    s_lshl_b32 s37, s37, 12
    s_add_u32 s85, s37, s89
    s_bfe_u32 s37, s39, 0x10003
    s_lshl_b32 s37, s37, 11
    s_add_u32 s85, s37, s85
    s_bfe_u32 s37, s39, 0x40004
    s_lshl_b32 s37, s37, 16
    s_add_u32 s85, s37, s85
    v_mov_b32_dpp v122, v112 quad_perm:[0,0,0,0] row_mask:0xf bank_mask:0xf
    v_mov_b32_dpp v124, v114 quad_perm:[2,2,2,2] row_mask:0xf bank_mask:0xf
    s_nop 0
    v_add_f32_dpp v122, v113, v122 quad_perm:[1,1,1,1] row_mask:0xf bank_mask:0xf
    v_add_f32_dpp v124, v115, v124 quad_perm:[3,3,3,3] row_mask:0xf bank_mask:0xf
    v_add_f32 v122, v122, v124
    v_fma_f32 v123, v122, s83, -v120
    v_cmp_lt_f32 vcc, 0, v123
    s_cbranch_vccz L_nomax_9
    v_mul_f32 v122, s83, v122
    s_nop 1
    v_max_f32_dpp v124, v122, v122 row_ror:4 row_mask:0xf bank_mask:0xf
    s_nop 1
    v_max_f32_dpp v124, v124, v124 row_ror:8 row_mask:0xf bank_mask:0xf
    v_mov_b32 v125, v124
    s_nop 1
    v_permlane16_swap_b32 v124, v125
    v_max_f32 v124, v124, v125
    v_mov_b32 v125, v124
    s_nop 1
    v_permlane32_swap_b32 v124, v125
    v_max_f32 v124, v124, v125
    v_and_b32 v124, s82, v124
    v_max_f32 v124, v124, v120
    v_sub_f32 v125, v120, v124
    v_exp_f32 v125, v125
    v_mov_b32 v120, v124
    v_sub_f32 v123, v122, v124
    v_mul_f32 v121, v121, v125
    v_mul_f32 v116, v116, v125
    v_mul_f32 v117, v117, v125
    v_mul_f32 v118, v118, v125
    v_mul_f32 v119, v119, v125
L_nomax_9:
    v_exp_f32 v123, v123
    s_nop 0
    v_cvt_pk_bf16_f32 v124, v123, v123
    v_add_f32 v121, v121, v123
    s_nop 0
    v_and_b32_dpp v96, v124, v10 row_newbcast:0 row_mask:0xf bank_mask:0xf
    v_and_b32_dpp v97, v124, v11 row_newbcast:0 row_mask:0xf bank_mask:0xf
    v_and_b32_dpp v98, v124, v12 row_newbcast:0 row_mask:0xf bank_mask:0xf
    v_and_b32_dpp v99, v124, v13 row_newbcast:0 row_mask:0xf bank_mask:0xf
    v_and_b32_dpp v100, v124, v10 row_newbcast:4 row_mask:0xf bank_mask:0xf
    v_and_b32_dpp v101, v124, v11 row_newbcast:4 row_mask:0xf bank_mask:0xf
    v_and_b32_dpp v102, v124, v12 row_newbcast:4 row_mask:0xf bank_mask:0xf
    v_and_b32_dpp v103, v124, v13 row_newbcast:4 row_mask:0xf bank_mask:0xf
    v_and_b32_dpp v104, v124, v10 row_newbcast:8 row_mask:0xf bank_mask:0xf
    v_and_b32_dpp v105, v124, v11 row_newbcast:8 row_mask:0xf bank_mask:0xf
    v_and_b32_dpp v106, v124, v12 row_newbcast:8 row_mask:0xf bank_mask:0xf
    v_and_b32_dpp v107, v124, v13 row_newbcast:8 row_mask:0xf bank_mask:0xf
    v_and_b32_dpp v108, v124, v10 row_newbcast:12 row_mask:0xf bank_mask:0xf
    v_and_b32_dpp v109, v124, v11 row_newbcast:12 row_mask:0xf bank_mask:0xf
    v_and_b32_dpp v110, v124, v12 row_newbcast:12 row_mask:0xf bank_mask:0xf
    v_and_b32_dpp v111, v124, v13 row_newbcast:12 row_mask:0xf bank_mask:0xf
    s_waitcnt vmcnt(5)
    v_mfma_f32_16x16x32_bf16 v[116:119], v[144:147], v[96:99], v[116:119]
    s_waitcnt vmcnt(4)
    buffer_load_dwordx4 v[168:171], v76, s[52:55], s86 offen offset:1024 nt
    v_mfma_f32_16x16x32_bf16 v[116:119], v[148:151], v[100:103], v[116:119]
    s_waitcnt vmcnt(4)
    buffer_load_dwordx4 v[172:175], v77, s[52:55], s86 offen offset:1024 nt
    v_mfma_f32_16x16x32_bf16 v[116:119], v[152:155], v[104:107], v[116:119]
    s_waitcnt vmcnt(4)
    buffer_load_dwordx4 v[176:179], v126, s[56:59], s86 offen offset:0 nt
    v_mfma_f32_16x16x32_bf16 v[116:119], v[156:159], v[108:111], v[116:119]
    s_waitcnt vmcnt(4)
    buffer_load_dwordx4 v[180:183], v127, s[56:59], s86 offen offset:0 nt
    v_mfma_f32_16x16x32_bf16 v[112:115], v[160:163], v[80:83], 0
    s_waitcnt vmcnt(4)
    buffer_load_dwordx4 v[184:187], v126, s[56:59], s86 offen offset:1024 nt
    v_mfma_f32_16x16x32_bf16 v[112:115], v[164:167], v[84:87], v[112:115]
    s_waitcnt vmcnt(4)
    buffer_load_dwordx4 v[188:191], v127, s[56:59], s86 offen offset:1024 nt
    v_mfma_f32_16x16x32_bf16 v[112:115], v[168:171], v[88:91], v[112:115]
    s_waitcnt vmcnt(4)
    buffer_load_dwordx4 v[128:131], v76, s[52:55], s85 offen offset:0 nt
    buffer_load_dwordx4 v[132:135], v77, s[52:55], s85 offen offset:0 nt
    v_mfma_f32_16x16x32_bf16 v[112:115], v[172:175], v[92:95], v[112:115]
    s_add_u32 s87, s87, 7
    s_add_u32 s39, s87, s88
    s_bfe_u32 s37, s39, 0x30000
    s_lshl_b32 s37, s37, 12
    s_add_u32 s86, s37, s89
    s_bfe_u32 s37, s39, 0x10003
    s_lshl_b32 s37, s37, 11
    s_add_u32 s86, s37, s86
    s_bfe_u32 s37, s39, 0x40004
    s_lshl_b32 s37, s37, 16
    s_add_u32 s86, s37, s86
    v_mov_b32_dpp v122, v112 quad_perm:[0,0,0,0] row_mask:0xf bank_mask:0xf
    v_mov_b32_dpp v124, v114 quad_perm:[2,2,2,2] row_mask:0xf bank_mask:0xf
    s_nop 0
    v_add_f32_dpp v122, v113, v122 quad_perm:[1,1,1,1] row_mask:0xf bank_mask:0xf
    v_add_f32_dpp v124, v115, v124 quad_perm:[3,3,3,3] row_mask:0xf bank_mask:0xf
    v_add_f32 v122, v122, v124
    v_fma_f32 v123, v122, s83, -v120
    v_cmp_lt_f32 vcc, 0, v123
    s_cbranch_vccz L_nomax_10
    v_mul_f32 v122, s83, v122
    s_nop 1
    v_max_f32_dpp v124, v122, v122 row_ror:4 row_mask:0xf bank_mask:0xf
    s_nop 1
    v_max_f32_dpp v124, v124, v124 row_ror:8 row_mask:0xf bank_mask:0xf
    v_mov_b32 v125, v124
    s_nop 1
    v_permlane16_swap_b32 v124, v125
    v_max_f32 v124, v124, v125
    v_mov_b32 v125, v124
    s_nop 1
    v_permlane32_swap_b32 v124, v125
    v_max_f32 v124, v124, v125
    v_and_b32 v124, s82, v124
    v_max_f32 v124, v124, v120
    v_sub_f32 v125, v120, v124
    v_exp_f32 v125, v125
    v_mov_b32 v120, v124
    v_sub_f32 v123, v122, v124
    v_mul_f32 v121, v121, v125
    v_mul_f32 v116, v116, v125
    v_mul_f32 v117, v117, v125
    v_mul_f32 v118, v118, v125
    v_mul_f32 v119, v119, v125
L_nomax_10:
    v_exp_f32 v123, v123
    s_nop 0
    v_cvt_pk_bf16_f32 v124, v123, v123
    v_add_f32 v121, v121, v123
    s_nop 0
    v_and_b32_dpp v96, v124, v10 row_newbcast:0 row_mask:0xf bank_mask:0xf
    v_and_b32_dpp v97, v124, v11 row_newbcast:0 row_mask:0xf bank_mask:0xf
    v_and_b32_dpp v98, v124, v12 row_newbcast:0 row_mask:0xf bank_mask:0xf
    v_and_b32_dpp v99, v124, v13 row_newbcast:0 row_mask:0xf bank_mask:0xf
    v_and_b32_dpp v100, v124, v10 row_newbcast:4 row_mask:0xf bank_mask:0xf
    v_and_b32_dpp v101, v124, v11 row_newbcast:4 row_mask:0xf bank_mask:0xf
    v_and_b32_dpp v102, v124, v12 row_newbcast:4 row_mask:0xf bank_mask:0xf
    v_and_b32_dpp v103, v124, v13 row_newbcast:4 row_mask:0xf bank_mask:0xf
    v_and_b32_dpp v104, v124, v10 row_newbcast:8 row_mask:0xf bank_mask:0xf
    v_and_b32_dpp v105, v124, v11 row_newbcast:8 row_mask:0xf bank_mask:0xf
    v_and_b32_dpp v106, v124, v12 row_newbcast:8 row_mask:0xf bank_mask:0xf
    v_and_b32_dpp v107, v124, v13 row_newbcast:8 row_mask:0xf bank_mask:0xf
    v_and_b32_dpp v108, v124, v10 row_newbcast:12 row_mask:0xf bank_mask:0xf
    v_and_b32_dpp v109, v124, v11 row_newbcast:12 row_mask:0xf bank_mask:0xf
    v_and_b32_dpp v110, v124, v12 row_newbcast:12 row_mask:0xf bank_mask:0xf
    v_and_b32_dpp v111, v124, v13 row_newbcast:12 row_mask:0xf bank_mask:0xf
    s_waitcnt vmcnt(5)
    v_mfma_f32_16x16x32_bf16 v[116:119], v[176:179], v[96:99], v[116:119]
    s_waitcnt vmcnt(4)
    buffer_load_dwordx4 v[136:139], v76, s[52:55], s85 offen offset:1024 nt
    v_mfma_f32_16x16x32_bf16 v[116:119], v[180:183], v[100:103], v[116:119]
    s_waitcnt vmcnt(4)
    buffer_load_dwordx4 v[140:143], v77, s[52:55], s85 offen offset:1024 nt
    v_mfma_f32_16x16x32_bf16 v[116:119], v[184:187], v[104:107], v[116:119]
    s_waitcnt vmcnt(4)
    buffer_load_dwordx4 v[144:147], v126, s[56:59], s85 offen offset:0 nt
    v_mfma_f32_16x16x32_bf16 v[116:119], v[188:191], v[108:111], v[116:119]
    s_cmp_lt_u32 s87, 231
    s_cbranch_scc1 L_bloop
    buffer_load_dwordx4 v[148:151], v127, s[56:59], s85 offen offset:0 nt
    buffer_load_dwordx4 v[152:155], v126, s[56:59], s85 offen offset:1024 nt
    buffer_load_dwordx4 v[156:159], v127, s[56:59], s85 offen offset:1024 nt
    s_sub_u32 s37, s87, 238
    v_mov_b32 v19, s37
L_dloop:
    s_waitcnt vmcnt(7)
    v_readfirstlane_b32 s93, v19
    s_nop 0
    s_sub_u32 s36, s93, 26
    s_lshr_b32 s38, s36, 1
    s_mul_i32 s38, s38, 5
    s_add_u32 s38, s38, s36
    s_mul_i32 s87, s36, 7
    s_add_u32 s87, s87, 58
    s_cmp_lt_i32 s36, 0
    s_cselect_b32 s87, s87, s38
    s_add_u32 s38, s93, 238
    s_cmp_lt_i32 s93, 18
    s_cselect_b32 s87, s38, s87
    s_add_u32 s93, s93, 8
    s_add_u32 s39, s87, s88
    s_bfe_u32 s37, s39, 0x30000
    s_lshl_b32 s37, s37, 12
    s_add_u32 s86, s37, s89
    s_bfe_u32 s37, s39, 0x10003
    s_lshl_b32 s37, s37, 11
    s_add_u32 s86, s37, s86
    s_bfe_u32 s37, s39, 0x40004
    s_lshl_b32 s37, s37, 16
    s_add_u32 s86, s37, s86
    s_cmp_ge_u32 s93, 38
    s_cselect_b32 s86, 134217728, s86
    v_mov_b32 v19, 30
    s_cmp_ge_u32 s93, 37
    s_cbranch_scc1 L_noclaim_11
    s_mov_b64 exec, 1
    global_atomic_add v19, v9, v18, s[30:31] sc0 sc1
    s_mov_b64 exec, -1
L_noclaim_11:
    buffer_load_dwordx4 v[160:163], v76, s[52:55], s86 offen offset:0 nt
    v_mfma_f32_16x16x32_bf16 v[112:115], v[128:131], v[80:83], 0
    s_waitcnt vmcnt(7)
    buffer_load_dwordx4 v[164:167], v77, s[52:55], s86 offen offset:0 nt
    v_mfma_f32_16x16x32_bf16 v[112:115], v[132:135], v[84:87], v[112:115]
    s_waitcnt vmcnt(7)
    buffer_load_dwordx4 v[168:171], v76, s[52:55], s86 offen offset:1024 nt
    v_mfma_f32_16x16x32_bf16 v[112:115], v[136:139], v[88:91], v[112:115]
    s_waitcnt vmcnt(7)
    buffer_load_dwordx4 v[172:175], v77, s[52:55], s86 offen offset:1024 nt
    v_mfma_f32_16x16x32_bf16 v[112:115], v[140:143], v[92:95], v[112:115]
    s_nop 7
    v_mov_b32_dpp v122, v112 quad_perm:[0,0,0,0] row_mask:0xf bank_mask:0xf
    v_mov_b32_dpp v124, v114 quad_perm:[2,2,2,2] row_mask:0xf bank_mask:0xf
    s_nop 0
    v_add_f32_dpp v122, v113, v122 quad_perm:[1,1,1,1] row_mask:0xf bank_mask:0xf
    v_add_f32_dpp v124, v115, v124 quad_perm:[3,3,3,3] row_mask:0xf bank_mask:0xf
    v_add_f32 v122, v122, v124
    v_fma_f32 v123, v122, s83, -v120
    v_cmp_lt_f32 vcc, 0, v123
    s_cbranch_vccz L_nomax_12
    v_mul_f32 v122, s83, v122
    s_nop 1
    v_max_f32_dpp v124, v122, v122 row_ror:4 row_mask:0xf bank_mask:0xf
    s_nop 1
    v_max_f32_dpp v124, v124, v124 row_ror:8 row_mask:0xf bank_mask:0xf
    v_mov_b32 v125, v124
    s_nop 1
    v_permlane16_swap_b32 v124, v125
    v_max_f32 v124, v124, v125
    v_mov_b32 v125, v124
    s_nop 1
    v_permlane32_swap_b32 v124, v125
    v_max_f32 v124, v124, v125
    v_and_b32 v124, s82, v124
    v_max_f32 v124, v124, v120
    v_sub_f32 v125, v120, v124
    v_exp_f32 v125, v125
    v_mov_b32 v120, v124
    v_sub_f32 v123, v122, v124
    v_mul_f32 v121, v121, v125
    v_mul_f32 v116, v116, v125
    v_mul_f32 v117, v117, v125
    v_mul_f32 v118, v118, v125
    v_mul_f32 v119, v119, v125
L_nomax_12:
    v_exp_f32 v123, v123
    s_nop 0
    v_cvt_pk_bf16_f32 v124, v123, v123
    v_add_f32 v121, v121, v123
    s_nop 0
    v_and_b32_dpp v96, v124, v10 row_newbcast:0 row_mask:0xf bank_mask:0xf
    v_and_b32_dpp v97, v124, v11 row_newbcast:0 row_mask:0xf bank_mask:0xf
    v_and_b32_dpp v98, v124, v12 row_newbcast:0 row_mask:0xf bank_mask:0xf
    v_and_b32_dpp v99, v124, v13 row_newbcast:0 row_mask:0xf bank_mask:0xf
    v_and_b32_dpp v100, v124, v10 row_newbcast:4 row_mask:0xf bank_mask:0xf
    v_and_b32_dpp v101, v124, v11 row_newbcast:4 row_mask:0xf bank_mask:0xf
    v_and_b32_dpp v102, v124, v12 row_newbcast:4 row_mask:0xf bank_mask:0xf
    v_and_b32_dpp v103, v124, v13 row_newbcast:4 row_mask:0xf bank_mask:0xf
    v_and_b32_dpp v104, v124, v10 row_newbcast:8 row_mask:0xf bank_mask:0xf
    v_and_b32_dpp v105, v124, v11 row_newbcast:8 row_mask:0xf bank_mask:0xf
    v_and_b32_dpp v106, v124, v12 row_newbcast:8 row_mask:0xf bank_mask:0xf
    v_and_b32_dpp v107, v124, v13 row_newbcast:8 row_mask:0xf bank_mask:0xf
    v_and_b32_dpp v108, v124, v10 row_newbcast:12 row_mask:0xf bank_mask:0xf
    v_and_b32_dpp v109, v124, v11 row_newbcast:12 row_mask:0xf bank_mask:0xf
    v_and_b32_dpp v110, v124, v12 row_newbcast:12 row_mask:0xf bank_mask:0xf
    v_and_b32_dpp v111, v124, v13 row_newbcast:12 row_mask:0xf bank_mask:0xf
    s_waitcnt vmcnt(7)
    buffer_load_dwordx4 v[176:179], v126, s[56:59], s86 offen offset:0 nt
    v_mfma_f32_16x16x32_bf16 v[116:119], v[144:147], v[96:99], v[116:119]
    s_waitcnt vmcnt(7)
    buffer_load_dwordx4 v[180:183], v127, s[56:59], s86 offen offset:0 nt
    v_mfma_f32_16x16x32_bf16 v[116:119], v[148:151], v[100:103], v[116:119]
    s_waitcnt vmcnt(7)
    buffer_load_dwordx4 v[184:187], v126, s[56:59], s86 offen offset:1024 nt
    v_mfma_f32_16x16x32_bf16 v[116:119], v[152:155], v[104:107], v[116:119]
    s_waitcnt vmcnt(7)
    buffer_load_dwordx4 v[188:191], v127, s[56:59], s86 offen offset:1024 nt
    v_mfma_f32_16x16x32_bf16 v[116:119], v[156:159], v[108:111], v[116:119]
    s_cmp_ge_u32 s93, 38
    s_cbranch_scc1 L_bdone
    s_waitcnt vmcnt(7)
    v_readfirstlane_b32 s93, v19
    s_nop 0
    s_sub_u32 s36, s93, 26
    s_lshr_b32 s38, s36, 1
    s_mul_i32 s38, s38, 5
    s_add_u32 s38, s38, s36
    s_mul_i32 s87, s36, 7
    s_add_u32 s87, s87, 58
    s_cmp_lt_i32 s36, 0
    s_cselect_b32 s87, s87, s38
    s_add_u32 s38, s93, 238
    s_cmp_lt_i32 s93, 18
    s_cselect_b32 s87, s38, s87
    s_add_u32 s93, s93, 8
    s_add_u32 s39, s87, s88
    s_bfe_u32 s37, s39, 0x30000
    s_lshl_b32 s37, s37, 12
    s_add_u32 s85, s37, s89
    s_bfe_u32 s37, s39, 0x10003
    s_lshl_b32 s37, s37, 11
    s_add_u32 s85, s37, s85
    s_bfe_u32 s37, s39, 0x40004
    s_lshl_b32 s37, s37, 16
    s_add_u32 s85, s37, s85
    s_cmp_ge_u32 s93, 38
    s_cselect_b32 s85, 134217728, s85
    v_mov_b32 v19, 30
    s_cmp_ge_u32 s93, 37
    s_cbranch_scc1 L_noclaim_13
    s_mov_b64 exec, 1
    global_atomic_add v19, v9, v18, s[30:31] sc0 sc1
    s_mov_b64 exec, -1
L_noclaim_13:
    buffer_load_dwordx4 v[128:131], v76, s[52:55], s85 offen offset:0 nt
    v_mfma_f32_16x16x32_bf16 v[112:115], v[160:163], v[80:83], 0
    s_waitcnt vmcnt(7)
    buffer_load_dwordx4 v[132:135], v77, s[52:55], s85 offen offset:0 nt
    v_mfma_f32_16x16x32_bf16 v[112:115], v[164:167], v[84:87], v[112:115]
    s_waitcnt vmcnt(7)
    buffer_load_dwordx4 v[136:139], v76, s[52:55], s85 offen offset:1024 nt
    v_mfma_f32_16x16x32_bf16 v[112:115], v[168:171], v[88:91], v[112:115]
    s_waitcnt vmcnt(7)
    buffer_load_dwordx4 v[140:143], v77, s[52:55], s85 offen offset:1024 nt
    v_mfma_f32_16x16x32_bf16 v[112:115], v[172:175], v[92:95], v[112:115]
    s_nop 7
    v_mov_b32_dpp v122, v112 quad_perm:[0,0,0,0] row_mask:0xf bank_mask:0xf
    v_mov_b32_dpp v124, v114 quad_perm:[2,2,2,2] row_mask:0xf bank_mask:0xf
    s_nop 0
    v_add_f32_dpp v122, v113, v122 quad_perm:[1,1,1,1] row_mask:0xf bank_mask:0xf
    v_add_f32_dpp v124, v115, v124 quad_perm:[3,3,3,3] row_mask:0xf bank_mask:0xf
    v_add_f32 v122, v122, v124
    v_fma_f32 v123, v122, s83, -v120
    v_cmp_lt_f32 vcc, 0, v123
    s_cbranch_vccz L_nomax_14
    v_mul_f32 v122, s83, v122
    s_nop 1
    v_max_f32_dpp v124, v122, v122 row_ror:4 row_mask:0xf bank_mask:0xf
    s_nop 1
    v_max_f32_dpp v124, v124, v124 row_ror:8 row_mask:0xf bank_mask:0xf
    v_mov_b32 v125, v124
    s_nop 1
    v_permlane16_swap_b32 v124, v125
    v_max_f32 v124, v124, v125
    v_mov_b32 v125, v124
    s_nop 1
    v_permlane32_swap_b32 v124, v125
    v_max_f32 v124, v124, v125
    v_and_b32 v124, s82, v124
    v_max_f32 v124, v124, v120
    v_sub_f32 v125, v120, v124
    v_exp_f32 v125, v125
    v_mov_b32 v120, v124
    v_sub_f32 v123, v122, v124
    v_mul_f32 v121, v121, v125
    v_mul_f32 v116, v116, v125
    v_mul_f32 v117, v117, v125
    v_mul_f32 v118, v118, v125
    v_mul_f32 v119, v119, v125
L_nomax_14:
    v_exp_f32 v123, v123
    s_nop 0
    v_cvt_pk_bf16_f32 v124, v123, v123
    v_add_f32 v121, v121, v123
    s_nop 0
    v_and_b32_dpp v96, v124, v10 row_newbcast:0 row_mask:0xf bank_mask:0xf
    v_and_b32_dpp v97, v124, v11 row_newbcast:0 row_mask:0xf bank_mask:0xf
    v_and_b32_dpp v98, v124, v12 row_newbcast:0 row_mask:0xf bank_mask:0xf
    v_and_b32_dpp v99, v124, v13 row_newbcast:0 row_mask:0xf bank_mask:0xf
    v_and_b32_dpp v100, v124, v10 row_newbcast:4 row_mask:0xf bank_mask:0xf
    v_and_b32_dpp v101, v124, v11 row_newbcast:4 row_mask:0xf bank_mask:0xf
    v_and_b32_dpp v102, v124, v12 row_newbcast:4 row_mask:0xf bank_mask:0xf
    v_and_b32_dpp v103, v124, v13 row_newbcast:4 row_mask:0xf bank_mask:0xf
    v_and_b32_dpp v104, v124, v10 row_newbcast:8 row_mask:0xf bank_mask:0xf
    v_and_b32_dpp v105, v124, v11 row_newbcast:8 row_mask:0xf bank_mask:0xf
    v_and_b32_dpp v106, v124, v12 row_newbcast:8 row_mask:0xf bank_mask:0xf
    v_and_b32_dpp v107, v124, v13 row_newbcast:8 row_mask:0xf bank_mask:0xf
    v_and_b32_dpp v108, v124, v10 row_newbcast:12 row_mask:0xf bank_mask:0xf
    v_and_b32_dpp v109, v124, v11 row_newbcast:12 row_mask:0xf bank_mask:0xf
    v_and_b32_dpp v110, v124, v12 row_newbcast:12 row_mask:0xf bank_mask:0xf
    v_and_b32_dpp v111, v124, v13 row_newbcast:12 row_mask:0xf bank_mask:0xf
    s_waitcnt vmcnt(7)
    buffer_load_dwordx4 v[144:147], v126, s[56:59], s85 offen offset:0 nt
    v_mfma_f32_16x16x32_bf16 v[116:119], v[176:179], v[96:99], v[116:119]
    s_waitcnt vmcnt(7)
    buffer_load_dwordx4 v[148:151], v127, s[56:59], s85 offen offset:0 nt
    v_mfma_f32_16x16x32_bf16 v[116:119], v[180:183], v[100:103], v[116:119]
    s_waitcnt vmcnt(7)
    buffer_load_dwordx4 v[152:155], v126, s[56:59], s85 offen offset:1024 nt
    v_mfma_f32_16x16x32_bf16 v[116:119], v[184:187], v[104:107], v[116:119]
    s_waitcnt vmcnt(7)
    buffer_load_dwordx4 v[156:159], v127, s[56:59], s85 offen offset:1024 nt
    v_mfma_f32_16x16x32_bf16 v[116:119], v[188:191], v[108:111], v[116:119]
    s_cmp_ge_u32 s93, 38
    s_cbranch_scc0 L_dloop
L_bdone:
    v_add_f32_dpp v121, v121, v121 row_ror:8 row_mask:0xf bank_mask:0xf
    s_lshl_b32 s38, s32, 2
    s_add_u32 s38, s38, s34
    v_add_f32_dpp v121, v121, v121 row_ror:4 row_mask:0xf bank_mask:0xf
    v_mov_b32 v125, v121
    s_lshl_b32 s38, s38, 3
    s_add_u32 s38, s38, s33
    v_permlane16_swap_b32 v121, v125
    v_add_f32 v121, v121, v125
    v_mov_b32 v125, v121
    s_lshl_b32 s38, s38, 10
    s_add_u32 s38, s38, 5242880
    v_permlane32_swap_b32 v121, v125
    s_mov_b32 exec_lo, 0x100
    s_mov_b32 exec_hi, 0x0
    v_add_f32 v117, v121, v125
    v_mov_b32 v116, v120
    s_mov_b32 exec_lo, 0xff01ff
    s_mov_b32 exec_hi, 0xff00ff
    v_and_or_b32 v116, v116, s82, v8
    v_and_or_b32 v117, v117, s82, v8
    v_and_or_b32 v118, v118, s82, v8
    v_and_or_b32 v119, v119, s82, v8
    buffer_store_dwordx4 v[116:119], v79, s[48:51], s38 offen sc1
    s_endpgm
L_qb:
    v_lshlrev_b32 v4, 17, v2
    v_lshl_add_u32 v14, v3, 4, v4
    v_lshrrev_b32 v5, 3, v3
    v_lshlrev_b32 v5, 10, v5
    v_lshl_add_u32 v15, v2, 5, v5
    s_lshl_b32 s36, s33, 2
    s_add_u32 s36, s36, s34
    s_lshl_b32 s37, s36, 7
    s_lshl_b32 s63, s36, 19
    s_lshl_b32 s38, s32, 8
    s_add_u32 s63, s63, s38
    s_mov_b32 s42, 4194304
    s_mov_b32 s43, 0x20000
    s_mov_b32 s46, 4096
    s_mov_b32 s47, 0x20000
    s_waitcnt lgkmcnt(0)
    s_mov_b64 s[40:41], s[22:23]
    s_mov_b64 s[44:45], s[16:17]
    buffer_load_dwordx4 a[128:131], v14, s[40:43], s63 offen nt
    s_add_u32 s63, s63, 8192
    buffer_load_dwordx4 a[132:135], v14, s[40:43], s63 offen nt
    s_add_u32 s63, s63, 8192
    buffer_load_dwordx4 v[20:23], v15, s[44:47], s37 offen offset:0
    buffer_load_dwordx4 v[24:27], v15, s[44:47], s37 offen offset:16
    buffer_load_dwordx4 v[28:31], v15, s[44:47], s37 offen offset:2048
    buffer_load_dwordx4 v[32:35], v15, s[44:47], s37 offen offset:2064
    buffer_load_dwordx4 a[136:139], v14, s[40:43], s63 offen nt
    s_add_u32 s63, s63, 8192
    buffer_load_dwordx4 a[140:143], v14, s[40:43], s63 offen nt
    s_add_u32 s63, s63, 8192
    buffer_load_dwordx4 a[144:147], v14, s[40:43], s63 offen nt
    s_add_u32 s63, s63, 8192
    buffer_load_dwordx4 a[148:151], v14, s[40:43], s63 offen nt
    s_add_u32 s63, s63, 8192
    buffer_load_dwordx4 a[152:155], v14, s[40:43], s63 offen nt
    s_add_u32 s63, s63, 8192
    buffer_load_dwordx4 a[156:159], v14, s[40:43], s63 offen nt
    s_add_u32 s63, s63, 8192
    s_load_dword s35, s[30:31], 0
    s_mov_b32 s48, s30
    s_and_b32 s49, s31, 0xffff
    s_mov_b32 s50, 8388608
    s_mov_b32 s51, 0x20000
    s_mov_b32 s82, 0xffffff00
    s_mov_b32 s83, 0x3e0293ee
    s_mov_b32 s84, 1048576
    v_and_b32 v4, 1, v1
    v_lshlrev_b32 v4, 4, v4
    v_mov_b32 v5, 0xffff
    v_lshlrev_b32 v4, v4, v5
    v_bfe_u32 v5, v1, 1, 2
    v_cmp_eq_u32 vcc, 0, v5
    s_nop 1
    v_cndmask_b32 v10, 0, v4, vcc
    v_cmp_eq_u32 vcc, 1, v5
    s_nop 1
    v_cndmask_b32 v11, 0, v4, vcc
    v_cmp_eq_u32 vcc, 2, v5
    s_nop 1
    v_cndmask_b32 v12, 0, v4, vcc
    v_cmp_eq_u32 vcc, 3, v5
    s_nop 1
    v_cndmask_b32 v13, 0, v4, vcc
    v_lshrrev_b32 v4, 2, v3
    v_and_b32 v5, 3, v3
    v_lshlrev_b32 v76, 8, v4
    v_lshlrev_b32 v126, 8, v2
    v_lshl_add_u32 v76, v2, 6, v76
    v_lshl_add_u32 v76, v5, 4, v76
    v_lshl_add_u32 v126, v3, 4, v126
    v_xor_b32 v77, 32768, v76
    v_xor_b32 v127, 32768, v126
    s_lshl_b32 s89, s34, 5
    s_add_u32 s89, s89, s32
    s_lshl_b32 s89, s89, 20
    s_mul_i32 s88, s32, 8
    s_mul_i32 s38, s34, 1
    s_add_u32 s88, s88, s38
    s_add_u32 s87, s33, 14
    s_mov_b32 s52, s18
    s_and_b32 s53, s19, 0xffff
    s_mov_b32 s54, 134217728
    s_mov_b32 s55, 0x20000
    s_mov_b32 s56, s20
    s_and_b32 s57, s21, 0xffff
    s_mov_b32 s58, 134217728
    s_mov_b32 s59, 0x20000
    v_mov_b32 v120, 0xff7f0000
    v_mov_b32 v121, 0
    v_mov_b32 v18, 1
    v_mov_b32 v116, 0
    v_mov_b32 v117, 0
    v_mov_b32 v118, 0
    v_mov_b32 v119, 0
    s_lshl_b32 s38, s32, 2
    s_add_u32 s38, s38, s34
    s_lshl_b32 s38, s38, 8
    s_add_u32 s38, s38, 65536
    v_mov_b32 v9, s38
    v_and_b32 v5, 3, v3
    v_lshlrev_b32 v78, 7, v2
    v_lshl_add_u32 v78, v5, 5, v78
    v_bfe_u32 v4, v3, 2, 1
    v_lshl_add_u32 v78, v4, 11, v78
    s_lshl_b32 s91, s32, 12
    s_lshl_b32 s38, s34, 9
    s_add_u32 s91, s91, s38
    s_add_u32 s91, s91, 1048576
    v_lshlrev_b32 v4, 7, v2
    v_lshl_add_u32 v4, v3, 4, v4
    v_mov_b32 v5, 512
    v_cmp_gt_u32 vcc, 8, v3
    s_nop 1
    v_cndmask_b32 v79, v5, v4, vcc
    v_mov_b32 v19, 0
    s_cmp_eq_u32 s33, 0
    s_cselect_b32 s38, 0, 8388608
    s_mov_b64 exec, 1
    buffer_store_dword v19, v9, s[48:51], s38 offen sc1
    s_mov_b64 exec, -1
    s_mov_b32 s80, 0x01000100
    s_mov_b32 s81, 0x03020302
    s_waitcnt vmcnt(7)
    buffer_load_dwordx4 a[160:163], v14, s[40:43], s63 offen nt
    s_add_u32 s63, s63, 8192
    v_perm_b32 v4, v20, v20, s80
    v_perm_b32 v5, v28, v28, s80
    v_and_b32 v52, v4, v10
    v_and_b32 v53, v4, v11
    v_and_b32 v54, v4, v12
    v_and_b32 v55, v4, v13
    v_and_b32 v56, v5, v10
    v_and_b32 v57, v5, v11
    v_and_b32 v58, v5, v12
    v_and_b32 v59, v5, v13
    v_mfma_f32_16x16x32_bf16 v[60:63], a[128:131], v[52:55], 0
    s_nop 0
    v_mfma_f32_16x16x32_bf16 v[64:67], a[128:131], v[56:59], 0
    buffer_load_dwordx4 a[164:167], v14, s[40:43], s63 offen nt
    s_add_u32 s63, s63, 8192
    v_perm_b32 v4, v20, v20, s81
    v_perm_b32 v5, v28, v28, s81
    v_and_b32 v52, v4, v10
    v_and_b32 v53, v4, v11
    v_and_b32 v54, v4, v12
    v_and_b32 v55, v4, v13
    v_and_b32 v56, v5, v10
    v_and_b32 v57, v5, v11
    v_and_b32 v58, v5, v12
    v_and_b32 v59, v5, v13
    v_mfma_f32_16x16x32_bf16 v[60:63], a[132:135], v[52:55], v[60:63]
    s_nop 0
    v_mfma_f32_16x16x32_bf16 v[64:67], a[132:135], v[56:59], v[64:67]
    s_waitcnt vmcnt(8)
    buffer_load_dwordx4 a[168:171], v14, s[40:43], s63 offen nt
    s_add_u32 s63, s63, 8192
    v_perm_b32 v4, v21, v21, s80
    v_perm_b32 v5, v29, v29, s80
    v_and_b32 v52, v4, v10
    v_and_b32 v53, v4, v11
    v_and_b32 v54, v4, v12
    v_and_b32 v55, v4, v13
    v_and_b32 v56, v5, v10
    v_and_b32 v57, v5, v11
    v_and_b32 v58, v5, v12
    v_and_b32 v59, v5, v13
    v_mfma_f32_16x16x32_bf16 v[60:63], a[136:139], v[52:55], v[60:63]
    s_nop 0
    v_mfma_f32_16x16x32_bf16 v[64:67], a[136:139], v[56:59], v[64:67]
    s_waitcnt vmcnt(8)
    buffer_load_dwordx4 a[172:175], v14, s[40:43], s63 offen nt
    s_add_u32 s63, s63, 8192
    v_perm_b32 v4, v21, v21, s81
    v_perm_b32 v5, v29, v29, s81
    v_and_b32 v52, v4, v10
    v_and_b32 v53, v4, v11
    v_and_b32 v54, v4, v12
    v_and_b32 v55, v4, v13
    v_and_b32 v56, v5, v10
    v_and_b32 v57, v5, v11
    v_and_b32 v58, v5, v12
    v_and_b32 v59, v5, v13
    v_mfma_f32_16x16x32_bf16 v[60:63], a[140:143], v[52:55], v[60:63]
    s_nop 0
    v_mfma_f32_16x16x32_bf16 v[64:67], a[140:143], v[56:59], v[64:67]
    s_waitcnt vmcnt(8)
    buffer_load_dwordx4 a[176:179], v14, s[40:43], s63 offen nt
    s_add_u32 s63, s63, 8192
    v_perm_b32 v4, v22, v22, s80
    v_perm_b32 v5, v30, v30, s80
    v_and_b32 v52, v4, v10
    v_and_b32 v53, v4, v11
    v_and_b32 v54, v4, v12
    v_and_b32 v55, v4, v13
    v_and_b32 v56, v5, v10
    v_and_b32 v57, v5, v11
    v_and_b32 v58, v5, v12
    v_and_b32 v59, v5, v13
    v_mfma_f32_16x16x32_bf16 v[60:63], a[144:147], v[52:55], v[60:63]
    s_nop 0
    v_mfma_f32_16x16x32_bf16 v[64:67], a[144:147], v[56:59], v[64:67]
    s_waitcnt vmcnt(8)
    buffer_load_dwordx4 a[180:183], v14, s[40:43], s63 offen nt
    s_add_u32 s63, s63, 8192
    v_perm_b32 v4, v22, v22, s81
    v_perm_b32 v5, v30, v30, s81
    v_and_b32 v52, v4, v10
    v_and_b32 v53, v4, v11
    v_and_b32 v54, v4, v12
    v_and_b32 v55, v4, v13
    v_and_b32 v56, v5, v10
    v_and_b32 v57, v5, v11
    v_and_b32 v58, v5, v12
    v_and_b32 v59, v5, v13
    v_mfma_f32_16x16x32_bf16 v[60:63], a[148:151], v[52:55], v[60:63]
    s_nop 0
    v_mfma_f32_16x16x32_bf16 v[64:67], a[148:151], v[56:59], v[64:67]
    s_waitcnt vmcnt(8)
    buffer_load_dwordx4 a[184:187], v14, s[40:43], s63 offen nt
    s_add_u32 s63, s63, 8192
    v_perm_b32 v4, v23, v23, s80
    v_perm_b32 v5, v31, v31, s80
    v_and_b32 v52, v4, v10
    v_and_b32 v53, v4, v11
    v_and_b32 v54, v4, v12
    v_and_b32 v55, v4, v13
    v_and_b32 v56, v5, v10
    v_and_b32 v57, v5, v11
    v_and_b32 v58, v5, v12
    v_and_b32 v59, v5, v13
    v_mfma_f32_16x16x32_bf16 v[60:63], a[152:155], v[52:55], v[60:63]
    s_nop 0
    v_mfma_f32_16x16x32_bf16 v[64:67], a[152:155], v[56:59], v[64:67]
    s_waitcnt vmcnt(8)
    buffer_load_dwordx4 a[188:191], v14, s[40:43], s63 offen nt
    s_add_u32 s63, s63, 8192
    v_perm_b32 v4, v23, v23, s81
    v_perm_b32 v5, v31, v31, s81
    v_and_b32 v52, v4, v10
    v_and_b32 v53, v4, v11
    v_and_b32 v54, v4, v12
    v_and_b32 v55, v4, v13
    v_and_b32 v56, v5, v10
    v_and_b32 v57, v5, v11
    v_and_b32 v58, v5, v12
    v_and_b32 v59, v5, v13
    v_mfma_f32_16x16x32_bf16 v[60:63], a[156:159], v[52:55], v[60:63]
    s_nop 0
    v_mfma_f32_16x16x32_bf16 v[64:67], a[156:159], v[56:59], v[64:67]
    s_waitcnt vmcnt(7)
    v_perm_b32 v4, v24, v24, s80
    v_perm_b32 v5, v32, v32, s80
    v_and_b32 v52, v4, v10
    v_and_b32 v53, v4, v11
    v_and_b32 v54, v4, v12
    v_and_b32 v55, v4, v13
    v_and_b32 v56, v5, v10
    v_and_b32 v57, v5, v11
    v_and_b32 v58, v5, v12
    v_and_b32 v59, v5, v13
    v_mfma_f32_16x16x32_bf16 v[60:63], a[160:163], v[52:55], v[60:63]
    s_nop 0
    v_mfma_f32_16x16x32_bf16 v[64:67], a[160:163], v[56:59], v[64:67]
    s_waitcnt vmcnt(6)
    s_add_u32 s39, s87, s88
    s_bfe_u32 s37, s39, 0x30000
    s_lshl_b32 s37, s37, 12
    s_add_u32 s85, s37, s89
    s_bfe_u32 s37, s39, 0x10003
    s_lshl_b32 s37, s37, 11
    s_add_u32 s85, s37, s85
    s_bfe_u32 s37, s39, 0x40004
    s_lshl_b32 s37, s37, 16
    s_add_u32 s85, s37, s85
    buffer_load_dwordx4 v[128:131], v76, s[52:55], s85 offen offset:0 nt
    v_perm_b32 v4, v24, v24, s81
    v_perm_b32 v5, v32, v32, s81
    v_and_b32 v52, v4, v10
    v_and_b32 v53, v4, v11
    v_and_b32 v54, v4, v12
    v_and_b32 v55, v4, v13
    v_and_b32 v56, v5, v10
    v_and_b32 v57, v5, v11
    v_and_b32 v58, v5, v12
    v_and_b32 v59, v5, v13
    v_mfma_f32_16x16x32_bf16 v[60:63], a[164:167], v[52:55], v[60:63]
    s_nop 0
    v_mfma_f32_16x16x32_bf16 v[64:67], a[164:167], v[56:59], v[64:67]
    s_waitcnt vmcnt(6)
    buffer_load_dwordx4 v[132:135], v77, s[52:55], s85 offen offset:0 nt
    v_perm_b32 v4, v25, v25, s80
    v_perm_b32 v5, v33, v33, s80
    v_and_b32 v52, v4, v10
    v_and_b32 v53, v4, v11
    v_and_b32 v54, v4, v12
    v_and_b32 v55, v4, v13
    v_and_b32 v56, v5, v10
    v_and_b32 v57, v5, v11
    v_and_b32 v58, v5, v12
    v_and_b32 v59, v5, v13
    v_mfma_f32_16x16x32_bf16 v[60:63], a[168:171], v[52:55], v[60:63]
    s_nop 0
    v_mfma_f32_16x16x32_bf16 v[64:67], a[168:171], v[56:59], v[64:67]
    s_waitcnt vmcnt(6)
    buffer_load_dwordx4 v[136:139], v76, s[52:55], s85 offen offset:1024 nt
    v_perm_b32 v4, v25, v25, s81
    v_perm_b32 v5, v33, v33, s81
    v_and_b32 v52, v4, v10
    v_and_b32 v53, v4, v11
    v_and_b32 v54, v4, v12
    v_and_b32 v55, v4, v13
    v_and_b32 v56, v5, v10
    v_and_b32 v57, v5, v11
    v_and_b32 v58, v5, v12
    v_and_b32 v59, v5, v13
    v_mfma_f32_16x16x32_bf16 v[60:63], a[172:175], v[52:55], v[60:63]
    s_nop 0
    v_mfma_f32_16x16x32_bf16 v[64:67], a[172:175], v[56:59], v[64:67]
    s_waitcnt vmcnt(6)
    buffer_load_dwordx4 v[140:143], v77, s[52:55], s85 offen offset:1024 nt
    v_perm_b32 v4, v26, v26, s80
    v_perm_b32 v5, v34, v34, s80
    v_and_b32 v52, v4, v10
    v_and_b32 v53, v4, v11
    v_and_b32 v54, v4, v12
    v_and_b32 v55, v4, v13
    v_and_b32 v56, v5, v10
    v_and_b32 v57, v5, v11
    v_and_b32 v58, v5, v12
    v_and_b32 v59, v5, v13
    v_mfma_f32_16x16x32_bf16 v[60:63], a[176:179], v[52:55], v[60:63]
    s_nop 0
    v_mfma_f32_16x16x32_bf16 v[64:67], a[176:179], v[56:59], v[64:67]
    s_waitcnt vmcnt(6)
    buffer_load_dwordx4 v[144:147], v126, s[56:59], s85 offen offset:0 nt
    v_perm_b32 v4, v26, v26, s81
    v_perm_b32 v5, v34, v34, s81
    v_and_b32 v52, v4, v10
    v_and_b32 v53, v4, v11
    v_and_b32 v54, v4, v12
    v_and_b32 v55, v4, v13
    v_and_b32 v56, v5, v10
    v_and_b32 v57, v5, v11
    v_and_b32 v58, v5, v12
    v_and_b32 v59, v5, v13
    v_mfma_f32_16x16x32_bf16 v[60:63], a[180:183], v[52:55], v[60:63]
    s_nop 0
    v_mfma_f32_16x16x32_bf16 v[64:67], a[180:183], v[56:59], v[64:67]
    s_waitcnt vmcnt(6)
    buffer_load_dwordx4 v[148:151], v127, s[56:59], s85 offen offset:0 nt
    v_perm_b32 v4, v27, v27, s80
    v_perm_b32 v5, v35, v35, s80
    v_and_b32 v52, v4, v10
    v_and_b32 v53, v4, v11
    v_and_b32 v54, v4, v12
    v_and_b32 v55, v4, v13
    v_and_b32 v56, v5, v10
    v_and_b32 v57, v5, v11
    v_and_b32 v58, v5, v12
    v_and_b32 v59, v5, v13
    v_mfma_f32_16x16x32_bf16 v[60:63], a[184:187], v[52:55], v[60:63]
    s_nop 0
    v_mfma_f32_16x16x32_bf16 v[64:67], a[184:187], v[56:59], v[64:67]
    s_waitcnt vmcnt(6)
    buffer_load_dwordx4 v[152:155], v126, s[56:59], s85 offen offset:1024 nt
    v_perm_b32 v4, v27, v27, s81
    v_perm_b32 v5, v35, v35, s81
    v_and_b32 v52, v4, v10
    v_and_b32 v53, v4, v11
    v_and_b32 v54, v4, v12
    v_and_b32 v55, v4, v13
    v_and_b32 v56, v5, v10
    v_and_b32 v57, v5, v11
    v_and_b32 v58, v5, v12
    v_and_b32 v59, v5, v13
    v_mfma_f32_16x16x32_bf16 v[60:63], a[188:191], v[52:55], v[60:63]
    s_nop 0
    v_mfma_f32_16x16x32_bf16 v[64:67], a[188:191], v[56:59], v[64:67]
    s_lshl_b32 s38, s34, 11
    v_lshrrev_b32 v4, 3, v3
    v_lshlrev_b32 v4, 9, v4
    v_lshl_add_u32 v4, v2, 7, v4
    v_and_b32 v5, 7, v3
    v_lshl_add_u32 v4, v5, 2, v4
    v_add_u32 v4, s38, v4
    ds_write_b32 v4, v60 offset:0
    ds_write_b32 v4, v61 offset:32
    ds_write_b32 v4, v62 offset:64
    ds_write_b32 v4, v63 offset:96
    ds_write_b32 v4, v64 offset:1024
    ds_write_b32 v4, v65 offset:1056
    ds_write_b32 v4, v66 offset:1088
    ds_write_b32 v4, v67 offset:1120
    s_lshl_b32 s38, s34, 9
    v_and_b32 v5, 31, v1
    v_lshl_add_u32 v5, v5, 4, s38
    s_waitcnt lgkmcnt(0)
    s_add_u32 s35, s35, 0x5b
    s_and_b32 s35, s35, 0xff
    v_mov_b32 v8, s35
    s_barrier
    ds_read_b128 v[20:23], v5 offset:0
    ds_read_b128 v[24:27], v5 offset:2048
    ds_read_b128 v[28:31], v5 offset:4096
    ds_read_b128 v[32:35], v5 offset:6144
    s_lshl_b32 s38, s32, 1
    s_add_u32 s38, s38, s33
    s_lshl_b32 s38, s38, 11
    s_add_u32 s38, s38, 1048576
    s_waitcnt lgkmcnt(0)
    v_add_f32 v20, v20, v24
    v_add_f32 v28, v28, v32
    v_add_f32 v21, v21, v25
    v_add_f32 v29, v29, v33
    v_add_f32 v22, v22, v26
    v_add_f32 v30, v30, v34
    v_add_f32 v23, v23, v27
    v_add_f32 v31, v31, v35
    v_add_f32 v20, v20, v28
    v_add_f32 v21, v21, v29
    v_add_f32 v22, v22, v30
    v_add_f32 v23, v23, v31
    v_and_or_b32 v20, v20, s82, v8
    v_and_or_b32 v21, v21, s82, v8
    v_and_or_b32 v22, v22, s82, v8
    v_and_or_b32 v23, v23, s82, v8
    s_mov_b32 exec_lo, 0xffffffff
    s_mov_b32 exec_hi, 0x0
    buffer_store_dwordx4 v[20:23], v5, s[48:51], s38 offen sc1
    s_mov_b64 exec, -1
    s_waitcnt vmcnt(7)
    buffer_load_dwordx4 v[156:159], v127, s[56:59], s85 offen offset:1024 nt
    s_waitcnt vmcnt(7)
    s_add_u32 s87, s87, 7
    s_add_u32 s39, s87, s88
    s_bfe_u32 s37, s39, 0x30000
    s_lshl_b32 s37, s37, 12
    s_add_u32 s85, s37, s89
    s_bfe_u32 s37, s39, 0x10003
    s_lshl_b32 s37, s37, 11
    s_add_u32 s85, s37, s85
    s_bfe_u32 s37, s39, 0x40004
    s_lshl_b32 s37, s37, 16
    s_add_u32 s85, s37, s85
    buffer_load_dwordx4 v[160:163], v76, s[52:55], s85 offen offset:0 nt
    s_waitcnt vmcnt(7)
    buffer_load_dwordx4 v[164:167], v77, s[52:55], s85 offen offset:0 nt
    s_waitcnt vmcnt(7)
    buffer_load_dwordx4 v[168:171], v76, s[52:55], s85 offen offset:1024 nt
    s_waitcnt vmcnt(7)
    buffer_load_dwordx4 v[172:175], v77, s[52:55], s85 offen offset:1024 nt
    s_waitcnt vmcnt(7)
    buffer_load_dwordx4 v[176:179], v126, s[56:59], s85 offen offset:0 nt
    s_waitcnt vmcnt(7)
    buffer_load_dwordx4 v[180:183], v127, s[56:59], s85 offen offset:0 nt
    s_waitcnt vmcnt(6)
    buffer_load_dwordx4 v[184:187], v126, s[56:59], s85 offen offset:1024 nt
    s_waitcnt vmcnt(6)
    buffer_load_dwordx4 v[188:191], v127, s[56:59], s85 offen offset:1024 nt
    s_waitcnt vmcnt(6)
    s_add_u32 s87, s87, 7
    s_add_u32 s39, s87, s88
    s_bfe_u32 s37, s39, 0x30000
    s_lshl_b32 s37, s37, 12
    s_add_u32 s85, s37, s89
    s_bfe_u32 s37, s39, 0x10003
    s_lshl_b32 s37, s37, 11
    s_add_u32 s85, s37, s85
    s_bfe_u32 s37, s39, 0x40004
    s_lshl_b32 s37, s37, 16
    s_add_u32 s85, s37, s85
    buffer_load_dwordx4 v[192:195], v76, s[52:55], s85 offen offset:0 nt
    s_waitcnt vmcnt(6)
    buffer_load_dwordx4 v[196:199], v77, s[52:55], s85 offen offset:0 nt
    s_waitcnt vmcnt(6)
    buffer_load_dwordx4 v[200:203], v76, s[52:55], s85 offen offset:1024 nt
    s_waitcnt vmcnt(6)
    buffer_load_dwordx4 v[204:207], v77, s[52:55], s85 offen offset:1024 nt
    buffer_load_dwordx4 v[68:71], v78, s[48:51], s91 offen offset:0 sc1
    buffer_load_dwordx4 v[72:75], v78, s[48:51], s91 offen offset:16 sc1
    s_waitcnt vmcnt(8)
    buffer_load_dwordx4 v[208:211], v126, s[56:59], s85 offen offset:0 nt
    s_waitcnt vmcnt(8)
    buffer_load_dwordx4 v[212:215], v127, s[56:59], s85 offen offset:0 nt
    s_waitcnt vmcnt(8)
    buffer_load_dwordx4 v[216:219], v126, s[56:59], s85 offen offset:1024 nt
    s_waitcnt vmcnt(8)
    buffer_load_dwordx4 v[220:223], v127, s[56:59], s85 offen offset:1024 nt
    s_waitcnt vmcnt(8)
    s_add_u32 s87, s87, 7
    s_add_u32 s39, s87, s88
    s_bfe_u32 s37, s39, 0x30000
    s_lshl_b32 s37, s37, 12
    s_add_u32 s85, s37, s89
    s_bfe_u32 s37, s39, 0x10003
    s_lshl_b32 s37, s37, 11
    s_add_u32 s85, s37, s85
    s_bfe_u32 s37, s39, 0x40004
    s_lshl_b32 s37, s37, 16
    s_add_u32 s85, s37, s85
    buffer_load_dwordx4 v[224:227], v76, s[52:55], s85 offen offset:0 nt
    s_waitcnt vmcnt(8)
    buffer_load_dwordx4 v[228:231], v77, s[52:55], s85 offen offset:0 nt
    s_waitcnt vmcnt(6)
L_qcheck_15:
    v_xor_b32 v68, s35, v68
    v_xor_b32 v69, s35, v69
    v_xor_b32 v70, s35, v70
    v_xor_b32 v71, s35, v71
    v_xor_b32 v72, s35, v72
    v_xor_b32 v73, s35, v73
    v_xor_b32 v74, s35, v74
    v_xor_b32 v75, s35, v75
    v_or_b32 v4, v68, v69
    v_or3_b32 v4, v4, v70, v71
    v_or3_b32 v4, v4, v72, v73
    v_or3_b32 v4, v4, v74, v75
    v_and_b32 v4, 0xff, v4
    v_cmp_ne_u32 vcc, 0, v4
    s_cbranch_vccz L_qok_16
    buffer_load_dwordx4 v[68:71], v78, s[48:51], s91 offen offset:0 sc1
    buffer_load_dwordx4 v[72:75], v78, s[48:51], s91 offen offset:16 sc1
    s_waitcnt vmcnt(0)
    s_sub_u32 s84, s84, 1
    s_cmp_lg_u32 s84, 0
    s_cbranch_scc1 L_qcheck_15
    s_branch L_end
L_qok_16:
    v_add_f32_dpp v68, v68, v68 row_ror:4 row_mask:0xf bank_mask:0xf
    v_add_f32_dpp v69, v69, v69 row_ror:4 row_mask:0xf bank_mask:0xf
    v_add_f32_dpp v70, v70, v70 row_ror:4 row_mask:0xf bank_mask:0xf
    v_add_f32_dpp v71, v71, v71 row_ror:4 row_mask:0xf bank_mask:0xf
    v_add_f32_dpp v72, v72, v72 row_ror:4 row_mask:0xf bank_mask:0xf
    v_add_f32_dpp v73, v73, v73 row_ror:4 row_mask:0xf bank_mask:0xf
    v_add_f32_dpp v74, v74, v74 row_ror:4 row_mask:0xf bank_mask:0xf
    v_add_f32_dpp v75, v75, v75 row_ror:4 row_mask:0xf bank_mask:0xf
    v_cvt_pk_bf16_f32 v68, v68, v69
    v_cvt_pk_bf16_f32 v69, v70, v71
    v_cvt_pk_bf16_f32 v70, v72, v73
    v_cvt_pk_bf16_f32 v71, v74, v75
    s_mov_b32 vcc_lo, 0xf000f
    s_mov_b32 vcc_hi, 0xf000f
    v_cndmask_b32 v80, 0, v68, vcc
    v_cndmask_b32 v81, 0, v69, vcc
    v_cndmask_b32 v82, 0, v70, vcc
    v_cndmask_b32 v83, 0, v71, vcc
    s_mov_b32 vcc_lo, 0xf000f0
    s_mov_b32 vcc_hi, 0xf000f0
    v_cndmask_b32 v84, 0, v68, vcc
    v_cndmask_b32 v85, 0, v69, vcc
    v_cndmask_b32 v86, 0, v70, vcc
    v_cndmask_b32 v87, 0, v71, vcc
    s_mov_b32 vcc_lo, 0xf000f00
    s_mov_b32 vcc_hi, 0xf000f00
    v_cndmask_b32 v88, 0, v68, vcc
    v_cndmask_b32 v89, 0, v69, vcc
    v_cndmask_b32 v90, 0, v70, vcc
    v_cndmask_b32 v91, 0, v71, vcc
    s_mov_b32 vcc_lo, 0xf000f000
    s_mov_b32 vcc_hi, 0xf000f000
    v_cndmask_b32 v92, 0, v68, vcc
    v_cndmask_b32 v93, 0, v69, vcc
    v_cndmask_b32 v94, 0, v70, vcc
    v_cndmask_b32 v95, 0, v71, vcc
    buffer_load_dwordx4 v[232:235], v76, s[52:55], s85 offen offset:1024 nt
    v_mfma_f32_16x16x32_bf16 v[112:115], v[128:131], v[80:83], 0
    v_mfma_f32_16x16x32_bf16 v[112:115], v[132:135], v[84:87], v[112:115]
    s_waitcnt vmcnt(6)
    buffer_load_dwordx4 v[236:239], v77, s[52:55], s85 offen offset:1024 nt
    v_mfma_f32_16x16x32_bf16 v[112:115], v[136:139], v[88:91], v[112:115]
    v_mfma_f32_16x16x32_bf16 v[112:115], v[140:143], v[92:95], v[112:115]
    s_nop 7
    v_mov_b32_dpp v122, v112 quad_perm:[0,0,0,0] row_mask:0xf bank_mask:0xf
    v_mov_b32_dpp v124, v114 quad_perm:[2,2,2,2] row_mask:0xf bank_mask:0xf
    s_nop 0
    v_add_f32_dpp v122, v113, v122 quad_perm:[1,1,1,1] row_mask:0xf bank_mask:0xf
    v_add_f32_dpp v124, v115, v124 quad_perm:[3,3,3,3] row_mask:0xf bank_mask:0xf
    v_add_f32 v122, v122, v124
    v_fma_f32 v123, v122, s83, -v120
    v_cmp_lt_f32 vcc, 0, v123
    s_cbranch_vccz L_nomax_17
    v_mul_f32 v122, s83, v122
    s_nop 1
    v_max_f32_dpp v124, v122, v122 row_ror:4 row_mask:0xf bank_mask:0xf
    s_nop 1
    v_max_f32_dpp v124, v124, v124 row_ror:8 row_mask:0xf bank_mask:0xf
    v_mov_b32 v125, v124
    s_nop 1
    v_permlane16_swap_b32 v124, v125
    v_max_f32 v124, v124, v125
    v_mov_b32 v125, v124
    s_nop 1
    v_permlane32_swap_b32 v124, v125
    v_max_f32 v124, v124, v125
    v_and_b32 v124, s82, v124
    v_max_f32 v124, v124, v120
    v_sub_f32 v125, v120, v124
    v_exp_f32 v125, v125
    v_mov_b32 v120, v124
    v_sub_f32 v123, v122, v124
    v_mul_f32 v121, v121, v125
    v_mul_f32 v116, v116, v125
    v_mul_f32 v117, v117, v125
    v_mul_f32 v118, v118, v125
    v_mul_f32 v119, v119, v125
L_nomax_17:
    v_exp_f32 v123, v123
    s_nop 0
    v_cvt_pk_bf16_f32 v124, v123, v123
    v_add_f32 v121, v121, v123
    s_nop 0
    v_and_b32_dpp v96, v124, v10 row_newbcast:0 row_mask:0xf bank_mask:0xf
    v_and_b32_dpp v97, v124, v11 row_newbcast:0 row_mask:0xf bank_mask:0xf
    v_and_b32_dpp v98, v124, v12 row_newbcast:0 row_mask:0xf bank_mask:0xf
    v_and_b32_dpp v99, v124, v13 row_newbcast:0 row_mask:0xf bank_mask:0xf
    v_and_b32_dpp v100, v124, v10 row_newbcast:4 row_mask:0xf bank_mask:0xf
    v_and_b32_dpp v101, v124, v11 row_newbcast:4 row_mask:0xf bank_mask:0xf
    v_and_b32_dpp v102, v124, v12 row_newbcast:4 row_mask:0xf bank_mask:0xf
    v_and_b32_dpp v103, v124, v13 row_newbcast:4 row_mask:0xf bank_mask:0xf
    v_and_b32_dpp v104, v124, v10 row_newbcast:8 row_mask:0xf bank_mask:0xf
    v_and_b32_dpp v105, v124, v11 row_newbcast:8 row_mask:0xf bank_mask:0xf
    v_and_b32_dpp v106, v124, v12 row_newbcast:8 row_mask:0xf bank_mask:0xf
    v_and_b32_dpp v107, v124, v13 row_newbcast:8 row_mask:0xf bank_mask:0xf
    v_and_b32_dpp v108, v124, v10 row_newbcast:12 row_mask:0xf bank_mask:0xf
    v_and_b32_dpp v109, v124, v11 row_newbcast:12 row_mask:0xf bank_mask:0xf
    v_and_b32_dpp v110, v124, v12 row_newbcast:12 row_mask:0xf bank_mask:0xf
    v_and_b32_dpp v111, v124, v13 row_newbcast:12 row_mask:0xf bank_mask:0xf
    v_mfma_f32_16x16x32_bf16 v[116:119], v[144:147], v[96:99], v[116:119]
    s_waitcnt vmcnt(6)
    buffer_load_dwordx4 v[240:243], v126, s[56:59], s85 offen offset:0 nt
    v_mfma_f32_16x16x32_bf16 v[116:119], v[148:151], v[100:103], v[116:119]
    v_mfma_f32_16x16x32_bf16 v[116:119], v[152:155], v[104:107], v[116:119]
    v_mfma_f32_16x16x32_bf16 v[116:119], v[156:159], v[108:111], v[116:119]
    s_waitcnt vmcnt(6)
    buffer_load_dwordx4 v[244:247], v127, s[56:59], s85 offen offset:0 nt
    v_mfma_f32_16x16x32_bf16 v[112:115], v[160:163], v[80:83], 0
    v_mfma_f32_16x16x32_bf16 v[112:115], v[164:167], v[84:87], v[112:115]
    v_mfma_f32_16x16x32_bf16 v[112:115], v[168:171], v[88:91], v[112:115]
    s_waitcnt vmcnt(6)
    buffer_load_dwordx4 v[248:251], v126, s[56:59], s85 offen offset:1024 nt
    v_mfma_f32_16x16x32_bf16 v[112:115], v[172:175], v[92:95], v[112:115]
    s_nop 7
    v_mov_b32_dpp v122, v112 quad_perm:[0,0,0,0] row_mask:0xf bank_mask:0xf
    v_mov_b32_dpp v124, v114 quad_perm:[2,2,2,2] row_mask:0xf bank_mask:0xf
    s_nop 0
    v_add_f32_dpp v122, v113, v122 quad_perm:[1,1,1,1] row_mask:0xf bank_mask:0xf
    v_add_f32_dpp v124, v115, v124 quad_perm:[3,3,3,3] row_mask:0xf bank_mask:0xf
    v_add_f32 v122, v122, v124
    v_fma_f32 v123, v122, s83, -v120
    v_cmp_lt_f32 vcc, 0, v123
    s_cbranch_vccz L_nomax_18
    v_mul_f32 v122, s83, v122
    s_nop 1
    v_max_f32_dpp v124, v122, v122 row_ror:4 row_mask:0xf bank_mask:0xf
    s_nop 1
    v_max_f32_dpp v124, v124, v124 row_ror:8 row_mask:0xf bank_mask:0xf
    v_mov_b32 v125, v124
    s_nop 1
    v_permlane16_swap_b32 v124, v125
    v_max_f32 v124, v124, v125
    v_mov_b32 v125, v124
    s_nop 1
    v_permlane32_swap_b32 v124, v125
    v_max_f32 v124, v124, v125
    v_and_b32 v124, s82, v124
    v_max_f32 v124, v124, v120
    v_sub_f32 v125, v120, v124
    v_exp_f32 v125, v125
    v_mov_b32 v120, v124
    v_sub_f32 v123, v122, v124
    v_mul_f32 v121, v121, v125
    v_mul_f32 v116, v116, v125
    v_mul_f32 v117, v117, v125
    v_mul_f32 v118, v118, v125
    v_mul_f32 v119, v119, v125
L_nomax_18:
    v_exp_f32 v123, v123
    s_nop 0
    v_cvt_pk_bf16_f32 v124, v123, v123
    v_add_f32 v121, v121, v123
    s_nop 0
    v_and_b32_dpp v96, v124, v10 row_newbcast:0 row_mask:0xf bank_mask:0xf
    v_and_b32_dpp v97, v124, v11 row_newbcast:0 row_mask:0xf bank_mask:0xf
    v_and_b32_dpp v98, v124, v12 row_newbcast:0 row_mask:0xf bank_mask:0xf
    v_and_b32_dpp v99, v124, v13 row_newbcast:0 row_mask:0xf bank_mask:0xf
    v_and_b32_dpp v100, v124, v10 row_newbcast:4 row_mask:0xf bank_mask:0xf
    v_and_b32_dpp v101, v124, v11 row_newbcast:4 row_mask:0xf bank_mask:0xf
    v_and_b32_dpp v102, v124, v12 row_newbcast:4 row_mask:0xf bank_mask:0xf
    v_and_b32_dpp v103, v124, v13 row_newbcast:4 row_mask:0xf bank_mask:0xf
    v_and_b32_dpp v104, v124, v10 row_newbcast:8 row_mask:0xf bank_mask:0xf
    v_and_b32_dpp v105, v124, v11 row_newbcast:8 row_mask:0xf bank_mask:0xf
    v_and_b32_dpp v106, v124, v12 row_newbcast:8 row_mask:0xf bank_mask:0xf
    v_and_b32_dpp v107, v124, v13 row_newbcast:8 row_mask:0xf bank_mask:0xf
    v_and_b32_dpp v108, v124, v10 row_newbcast:12 row_mask:0xf bank_mask:0xf
    v_and_b32_dpp v109, v124, v11 row_newbcast:12 row_mask:0xf bank_mask:0xf
    v_and_b32_dpp v110, v124, v12 row_newbcast:12 row_mask:0xf bank_mask:0xf
    v_and_b32_dpp v111, v124, v13 row_newbcast:12 row_mask:0xf bank_mask:0xf
    v_mfma_f32_16x16x32_bf16 v[116:119], v[176:179], v[96:99], v[116:119]
    v_mfma_f32_16x16x32_bf16 v[116:119], v[180:183], v[100:103], v[116:119]
    s_waitcnt vmcnt(6)
    buffer_load_dwordx4 v[252:255], v127, s[56:59], s85 offen offset:1024 nt
    v_mfma_f32_16x16x32_bf16 v[116:119], v[184:187], v[104:107], v[116:119]
    v_mfma_f32_16x16x32_bf16 v[116:119], v[188:191], v[108:111], v[116:119]
    v_mfma_f32_16x16x32_bf16 v[112:115], v[192:195], v[80:83], 0
    s_waitcnt vmcnt(5)
    s_add_u32 s87, s87, 7
    s_add_u32 s39, s87, s88
    s_bfe_u32 s37, s39, 0x30000
    s_lshl_b32 s37, s37, 12
    s_add_u32 s85, s37, s89
    s_bfe_u32 s37, s39, 0x10003
    s_lshl_b32 s37, s37, 11
    s_add_u32 s85, s37, s85
    s_bfe_u32 s37, s39, 0x40004
    s_lshl_b32 s37, s37, 16
    s_add_u32 s85, s37, s85
    buffer_load_dwordx4 v[128:131], v76, s[52:55], s85 offen offset:0 nt
    v_mfma_f32_16x16x32_bf16 v[112:115], v[196:199], v[84:87], v[112:115]
    v_mfma_f32_16x16x32_bf16 v[112:115], v[200:203], v[88:91], v[112:115]
    v_mfma_f32_16x16x32_bf16 v[112:115], v[204:207], v[92:95], v[112:115]
    s_nop 7
    v_mov_b32_dpp v122, v112 quad_perm:[0,0,0,0] row_mask:0xf bank_mask:0xf
    v_mov_b32_dpp v124, v114 quad_perm:[2,2,2,2] row_mask:0xf bank_mask:0xf
    s_nop 0
    v_add_f32_dpp v122, v113, v122 quad_perm:[1,1,1,1] row_mask:0xf bank_mask:0xf
    v_add_f32_dpp v124, v115, v124 quad_perm:[3,3,3,3] row_mask:0xf bank_mask:0xf
    v_add_f32 v122, v122, v124
    v_fma_f32 v123, v122, s83, -v120
    v_cmp_lt_f32 vcc, 0, v123
    s_cbranch_vccz L_nomax_19
    v_mul_f32 v122, s83, v122
    s_nop 1
    v_max_f32_dpp v124, v122, v122 row_ror:4 row_mask:0xf bank_mask:0xf
    s_nop 1
    v_max_f32_dpp v124, v124, v124 row_ror:8 row_mask:0xf bank_mask:0xf
    v_mov_b32 v125, v124
    s_nop 1
    v_permlane16_swap_b32 v124, v125
    v_max_f32 v124, v124, v125
    v_mov_b32 v125, v124
    s_nop 1
    v_permlane32_swap_b32 v124, v125
    v_max_f32 v124, v124, v125
    v_and_b32 v124, s82, v124
    v_max_f32 v124, v124, v120
    v_sub_f32 v125, v120, v124
    v_exp_f32 v125, v125
    v_mov_b32 v120, v124
    v_sub_f32 v123, v122, v124
    v_mul_f32 v121, v121, v125
    v_mul_f32 v116, v116, v125
    v_mul_f32 v117, v117, v125
    v_mul_f32 v118, v118, v125
    v_mul_f32 v119, v119, v125
L_nomax_19:
    v_exp_f32 v123, v123
    s_nop 0
    v_cvt_pk_bf16_f32 v124, v123, v123
    v_add_f32 v121, v121, v123
    s_nop 0
    v_and_b32_dpp v96, v124, v10 row_newbcast:0 row_mask:0xf bank_mask:0xf
    v_and_b32_dpp v97, v124, v11 row_newbcast:0 row_mask:0xf bank_mask:0xf
    v_and_b32_dpp v98, v124, v12 row_newbcast:0 row_mask:0xf bank_mask:0xf
    v_and_b32_dpp v99, v124, v13 row_newbcast:0 row_mask:0xf bank_mask:0xf
    v_and_b32_dpp v100, v124, v10 row_newbcast:4 row_mask:0xf bank_mask:0xf
    v_and_b32_dpp v101, v124, v11 row_newbcast:4 row_mask:0xf bank_mask:0xf
    v_and_b32_dpp v102, v124, v12 row_newbcast:4 row_mask:0xf bank_mask:0xf
    v_and_b32_dpp v103, v124, v13 row_newbcast:4 row_mask:0xf bank_mask:0xf
    v_and_b32_dpp v104, v124, v10 row_newbcast:8 row_mask:0xf bank_mask:0xf
    v_and_b32_dpp v105, v124, v11 row_newbcast:8 row_mask:0xf bank_mask:0xf
    v_and_b32_dpp v106, v124, v12 row_newbcast:8 row_mask:0xf bank_mask:0xf
    v_and_b32_dpp v107, v124, v13 row_newbcast:8 row_mask:0xf bank_mask:0xf
    v_and_b32_dpp v108, v124, v10 row_newbcast:12 row_mask:0xf bank_mask:0xf
    v_and_b32_dpp v109, v124, v11 row_newbcast:12 row_mask:0xf bank_mask:0xf
    v_and_b32_dpp v110, v124, v12 row_newbcast:12 row_mask:0xf bank_mask:0xf
    v_and_b32_dpp v111, v124, v13 row_newbcast:12 row_mask:0xf bank_mask:0xf
    s_waitcnt vmcnt(5)
    buffer_load_dwordx4 v[132:135], v77, s[52:55], s85 offen offset:0 nt
    v_mfma_f32_16x16x32_bf16 v[116:119], v[208:211], v[96:99], v[116:119]
    v_mfma_f32_16x16x32_bf16 v[116:119], v[212:215], v[100:103], v[116:119]
    v_mfma_f32_16x16x32_bf16 v[116:119], v[216:219], v[104:107], v[116:119]
    s_waitcnt vmcnt(5)
    buffer_load_dwordx4 v[136:139], v76, s[52:55], s85 offen offset:1024 nt
    v_mfma_f32_16x16x32_bf16 v[116:119], v[220:223], v[108:111], v[116:119]
    v_mfma_f32_16x16x32_bf16 v[112:115], v[224:227], v[80:83], 0
    v_mfma_f32_16x16x32_bf16 v[112:115], v[228:231], v[84:87], v[112:115]
    s_waitcnt vmcnt(5)
    buffer_load_dwordx4 v[140:143], v77, s[52:55], s85 offen offset:1024 nt
    v_mfma_f32_16x16x32_bf16 v[112:115], v[232:235], v[88:91], v[112:115]
    v_mfma_f32_16x16x32_bf16 v[112:115], v[236:239], v[92:95], v[112:115]
    s_nop 7
    v_mov_b32_dpp v122, v112 quad_perm:[0,0,0,0] row_mask:0xf bank_mask:0xf
    v_mov_b32_dpp v124, v114 quad_perm:[2,2,2,2] row_mask:0xf bank_mask:0xf
    s_nop 0
    v_add_f32_dpp v122, v113, v122 quad_perm:[1,1,1,1] row_mask:0xf bank_mask:0xf
    v_add_f32_dpp v124, v115, v124 quad_perm:[3,3,3,3] row_mask:0xf bank_mask:0xf
    v_add_f32 v122, v122, v124
    v_fma_f32 v123, v122, s83, -v120
    v_cmp_lt_f32 vcc, 0, v123
    s_cbranch_vccz L_nomax_20
    v_mul_f32 v122, s83, v122
    s_nop 1
    v_max_f32_dpp v124, v122, v122 row_ror:4 row_mask:0xf bank_mask:0xf
    s_nop 1
    v_max_f32_dpp v124, v124, v124 row_ror:8 row_mask:0xf bank_mask:0xf
    v_mov_b32 v125, v124
    s_nop 1
    v_permlane16_swap_b32 v124, v125
    v_max_f32 v124, v124, v125
    v_mov_b32 v125, v124
    s_nop 1
    v_permlane32_swap_b32 v124, v125
    v_max_f32 v124, v124, v125
    v_and_b32 v124, s82, v124
    v_max_f32 v124, v124, v120
    v_sub_f32 v125, v120, v124
    v_exp_f32 v125, v125
    v_mov_b32 v120, v124
    v_sub_f32 v123, v122, v124
    v_mul_f32 v121, v121, v125
    v_mul_f32 v116, v116, v125
    v_mul_f32 v117, v117, v125
    v_mul_f32 v118, v118, v125
    v_mul_f32 v119, v119, v125
L_nomax_20:
    v_exp_f32 v123, v123
    s_nop 0
    v_cvt_pk_bf16_f32 v124, v123, v123
    v_add_f32 v121, v121, v123
    s_nop 0
    v_and_b32_dpp v96, v124, v10 row_newbcast:0 row_mask:0xf bank_mask:0xf
    v_and_b32_dpp v97, v124, v11 row_newbcast:0 row_mask:0xf bank_mask:0xf
    v_and_b32_dpp v98, v124, v12 row_newbcast:0 row_mask:0xf bank_mask:0xf
    v_and_b32_dpp v99, v124, v13 row_newbcast:0 row_mask:0xf bank_mask:0xf
    v_and_b32_dpp v100, v124, v10 row_newbcast:4 row_mask:0xf bank_mask:0xf
    v_and_b32_dpp v101, v124, v11 row_newbcast:4 row_mask:0xf bank_mask:0xf
    v_and_b32_dpp v102, v124, v12 row_newbcast:4 row_mask:0xf bank_mask:0xf
    v_and_b32_dpp v103, v124, v13 row_newbcast:4 row_mask:0xf bank_mask:0xf
    v_and_b32_dpp v104, v124, v10 row_newbcast:8 row_mask:0xf bank_mask:0xf
    v_and_b32_dpp v105, v124, v11 row_newbcast:8 row_mask:0xf bank_mask:0xf
    v_and_b32_dpp v106, v124, v12 row_newbcast:8 row_mask:0xf bank_mask:0xf
    v_and_b32_dpp v107, v124, v13 row_newbcast:8 row_mask:0xf bank_mask:0xf
    v_and_b32_dpp v108, v124, v10 row_newbcast:12 row_mask:0xf bank_mask:0xf
    v_and_b32_dpp v109, v124, v11 row_newbcast:12 row_mask:0xf bank_mask:0xf
    v_and_b32_dpp v110, v124, v12 row_newbcast:12 row_mask:0xf bank_mask:0xf
    v_and_b32_dpp v111, v124, v13 row_newbcast:12 row_mask:0xf bank_mask:0xf
    v_mfma_f32_16x16x32_bf16 v[116:119], v[240:243], v[96:99], v[116:119]
    s_waitcnt vmcnt(5)
    buffer_load_dwordx4 v[144:147], v126, s[56:59], s85 offen offset:0 nt
    v_mfma_f32_16x16x32_bf16 v[116:119], v[244:247], v[100:103], v[116:119]
    v_mfma_f32_16x16x32_bf16 v[116:119], v[248:251], v[104:107], v[116:119]
    s_waitcnt vmcnt(5)
    v_mfma_f32_16x16x32_bf16 v[116:119], v[252:255], v[108:111], v[116:119]
    s_add_u32 s87, s87, 7
    s_add_u32 s39, s87, s88
    s_bfe_u32 s37, s39, 0x30000
    s_lshl_b32 s37, s37, 12
    s_add_u32 s86, s37, s89
    s_bfe_u32 s37, s39, 0x10003
    s_lshl_b32 s37, s37, 11
    s_add_u32 s86, s37, s86
    s_bfe_u32 s37, s39, 0x40004
    s_lshl_b32 s37, s37, 16
    s_add_u32 s86, s37, s86
    s_branch L_bloop
L_ql:
    v_lshlrev_b32 v4, 18, v2
    v_lshl_add_u32 v14, v3, 4, v4
    v_lshrrev_b32 v5, 3, v3
    v_lshlrev_b32 v5, 10, v5
    v_lshl_add_u32 v15, v2, 6, v5
    s_mov_b32 s36, s34
    s_lshl_b32 s37, s36, 8
    s_lshl_b32 s63, s36, 20
    s_lshl_b32 s38, s32, 8
    s_add_u32 s63, s63, s38
    s_mov_b32 s42, 4194304
    s_mov_b32 s43, 0x20000
    s_mov_b32 s46, 4096
    s_mov_b32 s47, 0x20000
    s_waitcnt lgkmcnt(0)
    s_mov_b64 s[40:41], s[8:9]
    s_mov_b64 s[44:45], s[4:5]
    s_mov_b32 s95, s63
    buffer_load_dwordx4 a[128:131], v14, s[40:43], s63 offen nt
    s_add_u32 s63, s63, 8192
    buffer_load_dwordx4 a[132:135], v14, s[40:43], s63 offen nt
    s_add_u32 s63, s63, 8192
    buffer_load_dwordx4 v[20:23], v15, s[44:47], s37 offen offset:0
    buffer_load_dwordx4 v[24:27], v15, s[44:47], s37 offen offset:16
    buffer_load_dwordx4 v[28:31], v15, s[44:47], s37 offen offset:32
    buffer_load_dwordx4 v[32:35], v15, s[44:47], s37 offen offset:48
    buffer_load_dwordx4 v[36:39], v15, s[44:47], s37 offen offset:2048
    buffer_load_dwordx4 v[40:43], v15, s[44:47], s37 offen offset:2064
    buffer_load_dwordx4 v[44:47], v15, s[44:47], s37 offen offset:2080
    buffer_load_dwordx4 v[48:51], v15, s[44:47], s37 offen offset:2096
    buffer_load_dwordx4 a[136:139], v14, s[40:43], s63 offen nt
    s_add_u32 s63, s63, 8192
    buffer_load_dwordx4 a[140:143], v14, s[40:43], s63 offen nt
    s_add_u32 s63, s63, 8192
    buffer_load_dwordx4 a[144:147], v14, s[40:43], s63 offen nt
    s_add_u32 s63, s63, 8192
    buffer_load_dwordx4 a[148:151], v14, s[40:43], s63 offen nt
    s_add_u32 s63, s63, 8192
    buffer_load_dwordx4 a[152:155], v14, s[40:43], s63 offen nt
    s_add_u32 s63, s63, 8192
    buffer_load_dwordx4 a[156:159], v14, s[40:43], s63 offen nt
    s_add_u32 s63, s63, 8192
    s_load_dword s35, s[30:31], 0
    s_mov_b32 s48, s30
    s_and_b32 s49, s31, 0xffff
    s_mov_b32 s50, 8388608
    s_mov_b32 s51, 0x20000
    s_mov_b32 s82, 0xffffff00
    s_mov_b32 s83, 0x3e0293ee
    s_mov_b32 s84, 1048576
    v_and_b32 v4, 1, v1
    v_lshlrev_b32 v4, 4, v4
    v_mov_b32 v5, 0xffff
    v_lshlrev_b32 v4, v4, v5
    v_bfe_u32 v5, v1, 1, 2
    v_cmp_eq_u32 vcc, 0, v5
    s_nop 1
    v_cndmask_b32 v10, 0, v4, vcc
    v_cmp_eq_u32 vcc, 1, v5
    s_nop 1
    v_cndmask_b32 v11, 0, v4, vcc
    v_cmp_eq_u32 vcc, 2, v5
    s_nop 1
    v_cndmask_b32 v12, 0, v4, vcc
    v_cmp_eq_u32 vcc, 3, v5
    s_nop 1
    v_cndmask_b32 v13, 0, v4, vcc
    v_lshrrev_b32 v4, 2, v3
    v_and_b32 v5, 3, v3
    v_lshlrev_b32 v76, 8, v4
    v_lshlrev_b32 v126, 8, v2
    v_lshl_add_u32 v76, v2, 6, v76
    v_lshl_add_u32 v76, v5, 4, v76
    v_lshl_add_u32 v126, v3, 4, v126
    v_xor_b32 v77, 32768, v76
    v_xor_b32 v127, 32768, v126
    s_lshl_b32 s89, s34, 5
    s_add_u32 s89, s89, s32
    s_lshl_b32 s89, s89, 20
    s_mul_i32 s88, s32, 8
    s_mul_i32 s38, s34, 1
    s_add_u32 s88, s88, s38
    s_add_u32 s87, s33, 56
    s_mov_b32 s52, s18
    s_and_b32 s53, s19, 0xffff
    s_mov_b32 s54, 134217728
    s_mov_b32 s55, 0x20000
    s_mov_b32 s56, s20
    s_and_b32 s57, s21, 0xffff
    s_mov_b32 s58, 134217728
    s_mov_b32 s59, 0x20000
    v_mov_b32 v120, 0xff7f0000
    v_mov_b32 v121, 0
    v_mov_b32 v18, 1
    v_mov_b32 v116, 0
    v_mov_b32 v117, 0
    v_mov_b32 v118, 0
    v_mov_b32 v119, 0
    s_lshl_b32 s38, s32, 2
    s_add_u32 s38, s38, s34
    s_lshl_b32 s38, s38, 8
    s_add_u32 s38, s38, 65536
    v_mov_b32 v9, s38
    v_and_b32 v5, 3, v3
    v_lshlrev_b32 v78, 7, v2
    v_lshl_add_u32 v78, v5, 5, v78
    v_bfe_u32 v4, v3, 2, 1
    v_lshl_add_u32 v78, v4, 11, v78
    s_lshl_b32 s91, s32, 12
    s_lshl_b32 s38, s34, 9
    s_add_u32 s91, s91, s38
    s_add_u32 s91, s91, 1048576
    v_lshlrev_b32 v4, 7, v2
    v_lshl_add_u32 v4, v3, 4, v4
    v_mov_b32 v5, 512
    v_cmp_gt_u32 vcc, 8, v3
    s_nop 1
    v_cndmask_b32 v79, v5, v4, vcc
    s_mov_b32 s64, s10
    s_and_b32 s65, s11, 0xffff
    s_mov_b32 s66, 4194304
    s_mov_b32 s67, 0x20000
    v_lshrrev_b32 v4, 2, v3
    v_and_b32 v5, 3, v3
    v_lshlrev_b32 v19, 18, v4
    v_lshl_add_u32 v19, v2, 6, v19
    v_lshl_add_u32 v19, v5, 4, v19
    s_mov_b32 s80, 0x01000100
    s_mov_b32 s81, 0x03020302
    s_waitcnt vmcnt(6)
    buffer_load_dwordx4 a[160:163], v14, s[40:43], s63 offen nt
    s_add_u32 s63, s63, 8192
    v_perm_b32 v4, v20, v20, s80
    v_perm_b32 v5, v36, v36, s80
    v_and_b32 v52, v4, v10
    v_and_b32 v53, v4, v11
    v_and_b32 v54, v4, v12
    v_and_b32 v55, v4, v13
    v_and_b32 v56, v5, v10
    v_and_b32 v57, v5, v11
    v_and_b32 v58, v5, v12
    v_and_b32 v59, v5, v13
    v_mfma_f32_16x16x32_bf16 v[60:63], a[128:131], v[52:55], 0
    s_nop 0
    v_mfma_f32_16x16x32_bf16 v[64:67], a[128:131], v[56:59], 0
    buffer_load_dwordx4 a[164:167], v14, s[40:43], s63 offen nt
    s_add_u32 s63, s63, 8192
    v_perm_b32 v4, v20, v20, s81
    v_perm_b32 v5, v36, v36, s81
    v_and_b32 v52, v4, v10
    v_and_b32 v53, v4, v11
    v_and_b32 v54, v4, v12
    v_and_b32 v55, v4, v13
    v_and_b32 v56, v5, v10
    v_and_b32 v57, v5, v11
    v_and_b32 v58, v5, v12
    v_and_b32 v59, v5, v13
    v_mfma_f32_16x16x32_bf16 v[60:63], a[132:135], v[52:55], v[60:63]
    s_nop 0
    v_mfma_f32_16x16x32_bf16 v[64:67], a[132:135], v[56:59], v[64:67]
    s_waitcnt vmcnt(7)
    buffer_load_dwordx4 a[168:171], v14, s[40:43], s63 offen nt
    s_add_u32 s63, s63, 8192
    v_perm_b32 v4, v21, v21, s80
    v_perm_b32 v5, v37, v37, s80
    v_and_b32 v52, v4, v10
    v_and_b32 v53, v4, v11
    v_and_b32 v54, v4, v12
    v_and_b32 v55, v4, v13
    v_and_b32 v56, v5, v10
    v_and_b32 v57, v5, v11
    v_and_b32 v58, v5, v12
    v_and_b32 v59, v5, v13
    v_mfma_f32_16x16x32_bf16 v[60:63], a[136:139], v[52:55], v[60:63]
    s_nop 0
    v_mfma_f32_16x16x32_bf16 v[64:67], a[136:139], v[56:59], v[64:67]
    s_waitcnt vmcnt(7)
    buffer_load_dwordx4 a[172:175], v14, s[40:43], s63 offen nt
    s_add_u32 s63, s63, 8192
    v_perm_b32 v4, v21, v21, s81
    v_perm_b32 v5, v37, v37, s81
    v_and_b32 v52, v4, v10
    v_and_b32 v53, v4, v11
    v_and_b32 v54, v4, v12
    v_and_b32 v55, v4, v13
    v_and_b32 v56, v5, v10
    v_and_b32 v57, v5, v11
    v_and_b32 v58, v5, v12
    v_and_b32 v59, v5, v13
    v_mfma_f32_16x16x32_bf16 v[60:63], a[140:143], v[52:55], v[60:63]
    s_nop 0
    v_mfma_f32_16x16x32_bf16 v[64:67], a[140:143], v[56:59], v[64:67]
    s_waitcnt vmcnt(7)
    buffer_load_dwordx4 a[176:179], v14, s[40:43], s63 offen nt
    s_add_u32 s63, s63, 8192
    v_perm_b32 v4, v22, v22, s80
    v_perm_b32 v5, v38, v38, s80
    v_and_b32 v52, v4, v10
    v_and_b32 v53, v4, v11
    v_and_b32 v54, v4, v12
    v_and_b32 v55, v4, v13
    v_and_b32 v56, v5, v10
    v_and_b32 v57, v5, v11
    v_and_b32 v58, v5, v12
    v_and_b32 v59, v5, v13
    v_mfma_f32_16x16x32_bf16 v[60:63], a[144:147], v[52:55], v[60:63]
    s_nop 0
    v_mfma_f32_16x16x32_bf16 v[64:67], a[144:147], v[56:59], v[64:67]
    s_waitcnt vmcnt(7)
    buffer_load_dwordx4 a[180:183], v14, s[40:43], s63 offen nt
    s_add_u32 s63, s63, 8192
    v_perm_b32 v4, v22, v22, s81
    v_perm_b32 v5, v38, v38, s81
    v_and_b32 v52, v4, v10
    v_and_b32 v53, v4, v11
    v_and_b32 v54, v4, v12
    v_and_b32 v55, v4, v13
    v_and_b32 v56, v5, v10
    v_and_b32 v57, v5, v11
    v_and_b32 v58, v5, v12
    v_and_b32 v59, v5, v13
    v_mfma_f32_16x16x32_bf16 v[60:63], a[148:151], v[52:55], v[60:63]
    s_nop 0
    v_mfma_f32_16x16x32_bf16 v[64:67], a[148:151], v[56:59], v[64:67]
    s_waitcnt vmcnt(7)
    buffer_load_dwordx4 a[184:187], v14, s[40:43], s63 offen nt
    s_add_u32 s63, s63, 8192
    v_perm_b32 v4, v23, v23, s80
    v_perm_b32 v5, v39, v39, s80
    v_and_b32 v52, v4, v10
    v_and_b32 v53, v4, v11
    v_and_b32 v54, v4, v12
    v_and_b32 v55, v4, v13
    v_and_b32 v56, v5, v10
    v_and_b32 v57, v5, v11
    v_and_b32 v58, v5, v12
    v_and_b32 v59, v5, v13
    v_mfma_f32_16x16x32_bf16 v[60:63], a[152:155], v[52:55], v[60:63]
    s_nop 0
    v_mfma_f32_16x16x32_bf16 v[64:67], a[152:155], v[56:59], v[64:67]
    s_waitcnt vmcnt(7)
    buffer_load_dwordx4 a[188:191], v14, s[40:43], s63 offen nt
    s_add_u32 s63, s63, 8192
    v_perm_b32 v4, v23, v23, s81
    v_perm_b32 v5, v39, v39, s81
    v_and_b32 v52, v4, v10
    v_and_b32 v53, v4, v11
    v_and_b32 v54, v4, v12
    v_and_b32 v55, v4, v13
    v_and_b32 v56, v5, v10
    v_and_b32 v57, v5, v11
    v_and_b32 v58, v5, v12
    v_and_b32 v59, v5, v13
    v_mfma_f32_16x16x32_bf16 v[60:63], a[156:159], v[52:55], v[60:63]
    s_nop 0
    v_mfma_f32_16x16x32_bf16 v[64:67], a[156:159], v[56:59], v[64:67]
    s_waitcnt vmcnt(7)
    buffer_load_dwordx4 a[192:195], v14, s[40:43], s63 offen nt
    s_add_u32 s63, s63, 8192
    v_perm_b32 v4, v24, v24, s80
    v_perm_b32 v5, v40, v40, s80
    v_and_b32 v52, v4, v10
    v_and_b32 v53, v4, v11
    v_and_b32 v54, v4, v12
    v_and_b32 v55, v4, v13
    v_and_b32 v56, v5, v10
    v_and_b32 v57, v5, v11
    v_and_b32 v58, v5, v12
    v_and_b32 v59, v5, v13
    v_mfma_f32_16x16x32_bf16 v[60:63], a[160:163], v[52:55], v[60:63]
    s_nop 0
    v_mfma_f32_16x16x32_bf16 v[64:67], a[160:163], v[56:59], v[64:67]
    s_waitcnt vmcnt(7)
    buffer_load_dwordx4 a[196:199], v14, s[40:43], s63 offen nt
    s_add_u32 s63, s63, 8192
    v_perm_b32 v4, v24, v24, s81
    v_perm_b32 v5, v40, v40, s81
    v_and_b32 v52, v4, v10
    v_and_b32 v53, v4, v11
    v_and_b32 v54, v4, v12
    v_and_b32 v55, v4, v13
    v_and_b32 v56, v5, v10
    v_and_b32 v57, v5, v11
    v_and_b32 v58, v5, v12
    v_and_b32 v59, v5, v13
    v_mfma_f32_16x16x32_bf16 v[60:63], a[164:167], v[52:55], v[60:63]
    s_nop 0
    v_mfma_f32_16x16x32_bf16 v[64:67], a[164:167], v[56:59], v[64:67]
    s_waitcnt vmcnt(7)
    buffer_load_dwordx4 a[200:203], v14, s[40:43], s63 offen nt
    s_add_u32 s63, s63, 8192
    v_perm_b32 v4, v25, v25, s80
    v_perm_b32 v5, v41, v41, s80
    v_and_b32 v52, v4, v10
    v_and_b32 v53, v4, v11
    v_and_b32 v54, v4, v12
    v_and_b32 v55, v4, v13
    v_and_b32 v56, v5, v10
    v_and_b32 v57, v5, v11
    v_and_b32 v58, v5, v12
    v_and_b32 v59, v5, v13
    v_mfma_f32_16x16x32_bf16 v[60:63], a[168:171], v[52:55], v[60:63]
    s_nop 0
    v_mfma_f32_16x16x32_bf16 v[64:67], a[168:171], v[56:59], v[64:67]
    s_waitcnt vmcnt(7)
    buffer_load_dwordx4 a[204:207], v14, s[40:43], s63 offen nt
    s_add_u32 s63, s63, 8192
    v_perm_b32 v4, v25, v25, s81
    v_perm_b32 v5, v41, v41, s81
    v_and_b32 v52, v4, v10
    v_and_b32 v53, v4, v11
    v_and_b32 v54, v4, v12
    v_and_b32 v55, v4, v13
    v_and_b32 v56, v5, v10
    v_and_b32 v57, v5, v11
    v_and_b32 v58, v5, v12
    v_and_b32 v59, v5, v13
    v_mfma_f32_16x16x32_bf16 v[60:63], a[172:175], v[52:55], v[60:63]
    s_nop 0
    v_mfma_f32_16x16x32_bf16 v[64:67], a[172:175], v[56:59], v[64:67]
    s_waitcnt vmcnt(7)
    buffer_load_dwordx4 a[208:211], v14, s[40:43], s63 offen nt
    s_add_u32 s63, s63, 8192
    v_perm_b32 v4, v26, v26, s80
    v_perm_b32 v5, v42, v42, s80
    v_and_b32 v52, v4, v10
    v_and_b32 v53, v4, v11
    v_and_b32 v54, v4, v12
    v_and_b32 v55, v4, v13
    v_and_b32 v56, v5, v10
    v_and_b32 v57, v5, v11
    v_and_b32 v58, v5, v12
    v_and_b32 v59, v5, v13
    v_mfma_f32_16x16x32_bf16 v[60:63], a[176:179], v[52:55], v[60:63]
    s_nop 0
    v_mfma_f32_16x16x32_bf16 v[64:67], a[176:179], v[56:59], v[64:67]
    s_waitcnt vmcnt(7)
    buffer_load_dwordx4 a[212:215], v14, s[40:43], s63 offen nt
    s_add_u32 s63, s63, 8192
    v_perm_b32 v4, v26, v26, s81
    v_perm_b32 v5, v42, v42, s81
    v_and_b32 v52, v4, v10
    v_and_b32 v53, v4, v11
    v_and_b32 v54, v4, v12
    v_and_b32 v55, v4, v13
    v_and_b32 v56, v5, v10
    v_and_b32 v57, v5, v11
    v_and_b32 v58, v5, v12
    v_and_b32 v59, v5, v13
    v_mfma_f32_16x16x32_bf16 v[60:63], a[180:183], v[52:55], v[60:63]
    s_nop 0
    v_mfma_f32_16x16x32_bf16 v[64:67], a[180:183], v[56:59], v[64:67]
    s_waitcnt vmcnt(7)
    buffer_load_dwordx4 a[216:219], v14, s[40:43], s63 offen nt
    s_add_u32 s63, s63, 8192
    v_perm_b32 v4, v27, v27, s80
    v_perm_b32 v5, v43, v43, s80
    v_and_b32 v52, v4, v10
    v_and_b32 v53, v4, v11
    v_and_b32 v54, v4, v12
    v_and_b32 v55, v4, v13
    v_and_b32 v56, v5, v10
    v_and_b32 v57, v5, v11
    v_and_b32 v58, v5, v12
    v_and_b32 v59, v5, v13
    v_mfma_f32_16x16x32_bf16 v[60:63], a[184:187], v[52:55], v[60:63]
    s_nop 0
    v_mfma_f32_16x16x32_bf16 v[64:67], a[184:187], v[56:59], v[64:67]
    s_waitcnt vmcnt(7)
    buffer_load_dwordx4 a[220:223], v14, s[40:43], s63 offen nt
    s_add_u32 s63, s63, 8192
    v_perm_b32 v4, v27, v27, s81
    v_perm_b32 v5, v43, v43, s81
    v_and_b32 v52, v4, v10
    v_and_b32 v53, v4, v11
    v_and_b32 v54, v4, v12
    v_and_b32 v55, v4, v13
    v_and_b32 v56, v5, v10
    v_and_b32 v57, v5, v11
    v_and_b32 v58, v5, v12
    v_and_b32 v59, v5, v13
    v_mfma_f32_16x16x32_bf16 v[60:63], a[188:191], v[52:55], v[60:63]
    s_nop 0
    v_mfma_f32_16x16x32_bf16 v[64:67], a[188:191], v[56:59], v[64:67]
    s_waitcnt vmcnt(7)
    buffer_load_dwordx4 a[224:227], v14, s[40:43], s63 offen nt
    s_add_u32 s63, s63, 8192
    v_perm_b32 v4, v28, v28, s80
    v_perm_b32 v5, v44, v44, s80
    v_and_b32 v52, v4, v10
    v_and_b32 v53, v4, v11
    v_and_b32 v54, v4, v12
    v_and_b32 v55, v4, v13
    v_and_b32 v56, v5, v10
    v_and_b32 v57, v5, v11
    v_and_b32 v58, v5, v12
    v_and_b32 v59, v5, v13
    v_mfma_f32_16x16x32_bf16 v[60:63], a[192:195], v[52:55], v[60:63]
    s_nop 0
    v_mfma_f32_16x16x32_bf16 v[64:67], a[192:195], v[56:59], v[64:67]
    s_waitcnt vmcnt(7)
    buffer_load_dwordx4 a[228:231], v14, s[40:43], s63 offen nt
    s_add_u32 s63, s63, 8192
    v_perm_b32 v4, v28, v28, s81
    v_perm_b32 v5, v44, v44, s81
    v_and_b32 v52, v4, v10
    v_and_b32 v53, v4, v11
    v_and_b32 v54, v4, v12
    v_and_b32 v55, v4, v13
    v_and_b32 v56, v5, v10
    v_and_b32 v57, v5, v11
    v_and_b32 v58, v5, v12
    v_and_b32 v59, v5, v13
    v_mfma_f32_16x16x32_bf16 v[60:63], a[196:199], v[52:55], v[60:63]
    s_nop 0
    v_mfma_f32_16x16x32_bf16 v[64:67], a[196:199], v[56:59], v[64:67]
    s_waitcnt vmcnt(7)
    buffer_load_dwordx4 a[232:235], v14, s[40:43], s63 offen nt
    s_add_u32 s63, s63, 8192
    v_perm_b32 v4, v29, v29, s80
    v_perm_b32 v5, v45, v45, s80
    v_and_b32 v52, v4, v10
    v_and_b32 v53, v4, v11
    v_and_b32 v54, v4, v12
    v_and_b32 v55, v4, v13
    v_and_b32 v56, v5, v10
    v_and_b32 v57, v5, v11
    v_and_b32 v58, v5, v12
    v_and_b32 v59, v5, v13
    v_mfma_f32_16x16x32_bf16 v[60:63], a[200:203], v[52:55], v[60:63]
    s_nop 0
    v_mfma_f32_16x16x32_bf16 v[64:67], a[200:203], v[56:59], v[64:67]
    s_waitcnt vmcnt(7)
    buffer_load_dwordx4 a[236:239], v14, s[40:43], s63 offen nt
    s_add_u32 s63, s63, 8192
    v_perm_b32 v4, v29, v29, s81
    v_perm_b32 v5, v45, v45, s81
    v_and_b32 v52, v4, v10
    v_and_b32 v53, v4, v11
    v_and_b32 v54, v4, v12
    v_and_b32 v55, v4, v13
    v_and_b32 v56, v5, v10
    v_and_b32 v57, v5, v11
    v_and_b32 v58, v5, v12
    v_and_b32 v59, v5, v13
    v_mfma_f32_16x16x32_bf16 v[60:63], a[204:207], v[52:55], v[60:63]
    s_nop 0
    v_mfma_f32_16x16x32_bf16 v[64:67], a[204:207], v[56:59], v[64:67]
    s_waitcnt vmcnt(7)
    buffer_load_dwordx4 a[240:243], v14, s[40:43], s63 offen nt
    s_add_u32 s63, s63, 8192
    v_perm_b32 v4, v30, v30, s80
    v_perm_b32 v5, v46, v46, s80
    v_and_b32 v52, v4, v10
    v_and_b32 v53, v4, v11
    v_and_b32 v54, v4, v12
    v_and_b32 v55, v4, v13
    v_and_b32 v56, v5, v10
    v_and_b32 v57, v5, v11
    v_and_b32 v58, v5, v12
    v_and_b32 v59, v5, v13
    v_mfma_f32_16x16x32_bf16 v[60:63], a[208:211], v[52:55], v[60:63]
    s_nop 0
    v_mfma_f32_16x16x32_bf16 v[64:67], a[208:211], v[56:59], v[64:67]
    s_waitcnt vmcnt(7)
    buffer_load_dwordx4 a[244:247], v14, s[40:43], s63 offen nt
    s_add_u32 s63, s63, 8192
    v_perm_b32 v4, v30, v30, s81
    v_perm_b32 v5, v46, v46, s81
    v_and_b32 v52, v4, v10
    v_and_b32 v53, v4, v11
    v_and_b32 v54, v4, v12
    v_and_b32 v55, v4, v13
    v_and_b32 v56, v5, v10
    v_and_b32 v57, v5, v11
    v_and_b32 v58, v5, v12
    v_and_b32 v59, v5, v13
    v_mfma_f32_16x16x32_bf16 v[60:63], a[212:215], v[52:55], v[60:63]
    s_nop 0
    v_mfma_f32_16x16x32_bf16 v[64:67], a[212:215], v[56:59], v[64:67]
    s_waitcnt vmcnt(7)
    buffer_load_dwordx4 a[248:251], v14, s[40:43], s63 offen nt
    s_add_u32 s63, s63, 8192
    v_perm_b32 v4, v31, v31, s80
    v_perm_b32 v5, v47, v47, s80
    v_and_b32 v52, v4, v10
    v_and_b32 v53, v4, v11
    v_and_b32 v54, v4, v12
    v_and_b32 v55, v4, v13
    v_and_b32 v56, v5, v10
    v_and_b32 v57, v5, v11
    v_and_b32 v58, v5, v12
    v_and_b32 v59, v5, v13
    v_mfma_f32_16x16x32_bf16 v[60:63], a[216:219], v[52:55], v[60:63]
    s_nop 0
    v_mfma_f32_16x16x32_bf16 v[64:67], a[216:219], v[56:59], v[64:67]
    s_waitcnt vmcnt(7)
    buffer_load_dwordx4 a[252:255], v14, s[40:43], s63 offen nt
    s_add_u32 s63, s63, 8192
    v_perm_b32 v4, v31, v31, s81
    v_perm_b32 v5, v47, v47, s81
    v_and_b32 v52, v4, v10
    v_and_b32 v53, v4, v11
    v_and_b32 v54, v4, v12
    v_and_b32 v55, v4, v13
    v_and_b32 v56, v5, v10
    v_and_b32 v57, v5, v11
    v_and_b32 v58, v5, v12
    v_and_b32 v59, v5, v13
    v_mfma_f32_16x16x32_bf16 v[60:63], a[220:223], v[52:55], v[60:63]
    s_nop 0
    v_mfma_f32_16x16x32_bf16 v[64:67], a[220:223], v[56:59], v[64:67]
    s_waitcnt vmcnt(7)
    buffer_load_dwordx4 a[0:3], v19, s[64:67], s95 offen nt
    s_add_u32 s95, s95, 8192
    v_perm_b32 v4, v32, v32, s80
    v_perm_b32 v5, v48, v48, s80
    v_and_b32 v52, v4, v10
    v_and_b32 v53, v4, v11
    v_and_b32 v54, v4, v12
    v_and_b32 v55, v4, v13
    v_and_b32 v56, v5, v10
    v_and_b32 v57, v5, v11
    v_and_b32 v58, v5, v12
    v_and_b32 v59, v5, v13
    v_mfma_f32_16x16x32_bf16 v[60:63], a[224:227], v[52:55], v[60:63]
    s_nop 0
    v_mfma_f32_16x16x32_bf16 v[64:67], a[224:227], v[56:59], v[64:67]
    s_waitcnt vmcnt(7)
    buffer_load_dwordx4 a[4:7], v19, s[64:67], s95 offen nt
    s_add_u32 s95, s95, 8192
    v_perm_b32 v4, v32, v32, s81
    v_perm_b32 v5, v48, v48, s81
    v_and_b32 v52, v4, v10
    v_and_b32 v53, v4, v11
    v_and_b32 v54, v4, v12
    v_and_b32 v55, v4, v13
    v_and_b32 v56, v5, v10
    v_and_b32 v57, v5, v11
    v_and_b32 v58, v5, v12
    v_and_b32 v59, v5, v13
    v_mfma_f32_16x16x32_bf16 v[60:63], a[228:231], v[52:55], v[60:63]
    s_nop 0
    v_mfma_f32_16x16x32_bf16 v[64:67], a[228:231], v[56:59], v[64:67]
    s_waitcnt vmcnt(7)
    buffer_load_dwordx4 a[8:11], v19, s[64:67], s95 offen nt
    s_add_u32 s95, s95, 8192
    v_perm_b32 v4, v33, v33, s80
    v_perm_b32 v5, v49, v49, s80
    v_and_b32 v52, v4, v10
    v_and_b32 v53, v4, v11
    v_and_b32 v54, v4, v12
    v_and_b32 v55, v4, v13
    v_and_b32 v56, v5, v10
    v_and_b32 v57, v5, v11
    v_and_b32 v58, v5, v12
    v_and_b32 v59, v5, v13
    v_mfma_f32_16x16x32_bf16 v[60:63], a[232:235], v[52:55], v[60:63]
    s_nop 0
    v_mfma_f32_16x16x32_bf16 v[64:67], a[232:235], v[56:59], v[64:67]
    s_waitcnt vmcnt(7)
    buffer_load_dwordx4 a[12:15], v19, s[64:67], s95 offen nt
    s_add_u32 s95, s95, 8192
    v_perm_b32 v4, v33, v33, s81
    v_perm_b32 v5, v49, v49, s81
    v_and_b32 v52, v4, v10
    v_and_b32 v53, v4, v11
    v_and_b32 v54, v4, v12
    v_and_b32 v55, v4, v13
    v_and_b32 v56, v5, v10
    v_and_b32 v57, v5, v11
    v_and_b32 v58, v5, v12
    v_and_b32 v59, v5, v13
    v_mfma_f32_16x16x32_bf16 v[60:63], a[236:239], v[52:55], v[60:63]
    s_nop 0
    v_mfma_f32_16x16x32_bf16 v[64:67], a[236:239], v[56:59], v[64:67]
    s_waitcnt vmcnt(7)
    buffer_load_dwordx4 a[16:19], v19, s[64:67], s95 offen nt
    s_add_u32 s95, s95, 8192
    v_perm_b32 v4, v34, v34, s80
    v_perm_b32 v5, v50, v50, s80
    v_and_b32 v52, v4, v10
    v_and_b32 v53, v4, v11
    v_and_b32 v54, v4, v12
    v_and_b32 v55, v4, v13
    v_and_b32 v56, v5, v10
    v_and_b32 v57, v5, v11
    v_and_b32 v58, v5, v12
    v_and_b32 v59, v5, v13
    v_mfma_f32_16x16x32_bf16 v[60:63], a[240:243], v[52:55], v[60:63]
    s_nop 0
    v_mfma_f32_16x16x32_bf16 v[64:67], a[240:243], v[56:59], v[64:67]
    s_waitcnt vmcnt(7)
    buffer_load_dwordx4 a[20:23], v19, s[64:67], s95 offen nt
    s_add_u32 s95, s95, 8192
    v_perm_b32 v4, v34, v34, s81
    v_perm_b32 v5, v50, v50, s81
    v_and_b32 v52, v4, v10
    v_and_b32 v53, v4, v11
    v_and_b32 v54, v4, v12
    v_and_b32 v55, v4, v13
    v_and_b32 v56, v5, v10
    v_and_b32 v57, v5, v11
    v_and_b32 v58, v5, v12
    v_and_b32 v59, v5, v13
    v_mfma_f32_16x16x32_bf16 v[60:63], a[244:247], v[52:55], v[60:63]
    s_nop 0
    v_mfma_f32_16x16x32_bf16 v[64:67], a[244:247], v[56:59], v[64:67]
    s_waitcnt vmcnt(7)
    buffer_load_dwordx4 a[24:27], v19, s[64:67], s95 offen nt
    s_add_u32 s95, s95, 8192
    v_perm_b32 v4, v35, v35, s80
    v_perm_b32 v5, v51, v51, s80
    v_and_b32 v52, v4, v10
    v_and_b32 v53, v4, v11
    v_and_b32 v54, v4, v12
    v_and_b32 v55, v4, v13
    v_and_b32 v56, v5, v10
    v_and_b32 v57, v5, v11
    v_and_b32 v58, v5, v12
    v_and_b32 v59, v5, v13
    v_mfma_f32_16x16x32_bf16 v[60:63], a[248:251], v[52:55], v[60:63]
    s_nop 0
    v_mfma_f32_16x16x32_bf16 v[64:67], a[248:251], v[56:59], v[64:67]
    s_waitcnt vmcnt(7)
    buffer_load_dwordx4 a[28:31], v19, s[64:67], s95 offen nt
    s_add_u32 s95, s95, 8192
    v_perm_b32 v4, v35, v35, s81
    v_perm_b32 v5, v51, v51, s81
    v_and_b32 v52, v4, v10
    v_and_b32 v53, v4, v11
    v_and_b32 v54, v4, v12
    v_and_b32 v55, v4, v13
    v_and_b32 v56, v5, v10
    v_and_b32 v57, v5, v11
    v_and_b32 v58, v5, v12
    v_and_b32 v59, v5, v13
    v_mfma_f32_16x16x32_bf16 v[60:63], a[252:255], v[52:55], v[60:63]
    s_nop 0
    v_mfma_f32_16x16x32_bf16 v[64:67], a[252:255], v[56:59], v[64:67]
    s_lshl_b32 s38, s34, 11
    v_lshrrev_b32 v4, 3, v3
    v_lshlrev_b32 v4, 9, v4
    v_lshl_add_u32 v4, v2, 7, v4
    v_and_b32 v5, 7, v3
    v_lshl_add_u32 v4, v5, 2, v4
    v_add_u32 v4, s38, v4
    ds_write_b32 v4, v60 offset:0
    ds_write_b32 v4, v61 offset:32
    ds_write_b32 v4, v62 offset:64
    ds_write_b32 v4, v63 offset:96
    ds_write_b32 v4, v64 offset:1024
    ds_write_b32 v4, v65 offset:1056
    ds_write_b32 v4, v66 offset:1088
    ds_write_b32 v4, v67 offset:1120
    v_lshrrev_b32 v4, 2, v3
    v_and_b32 v5, 3, v3
    v_lshlrev_b32 v6, 9, v4
    v_lshl_add_u32 v6, v2, 7, v6
    v_lshl_add_u32 v6, v5, 5, v6
    buffer_load_dwordx4 a[32:35], v19, s[64:67], s95 offen nt
    s_add_u32 s95, s95, 8192
    s_waitcnt lgkmcnt(0)
    s_add_u32 s35, s35, 0x5b
    s_and_b32 s35, s35, 0xff
    v_mov_b32 v8, s35
    s_or_b32 s68, s35, 0x6b3ac500
    s_barrier
    ds_read_b128 v[20:23], v6 offset:0
    ds_read_b128 v[24:27], v6 offset:16
    ds_read_b128 v[28:31], v6 offset:2048
    ds_read_b128 v[32:35], v6 offset:2064
    ds_read_b128 v[36:39], v6 offset:4096
    ds_read_b128 v[40:43], v6 offset:4112
    ds_read_b128 v[44:47], v6 offset:6144
    ds_read_b128 v[48:51], v6 offset:6160
    buffer_load_dwordx4 a[36:39], v19, s[64:67], s95 offen nt
    s_add_u32 s95, s95, 8192
    v_lshlrev_b32 v6, 15, v4
    v_lshl_add_u32 v6, v2, 6, v6
    v_lshl_add_u32 v6, v5, 4, v6
    s_lshl_b32 s36, s32, 10
    s_lshl_b32 s38, s34, 8
    s_add_u32 s36, s36, s38
    s_add_u32 s36, s36, 2097152
    s_waitcnt lgkmcnt(0)
    v_add_f32 v20, v20, v36
    v_add_f32 v28, v28, v44
    v_add_f32 v21, v21, v37
    v_add_f32 v29, v29, v45
    v_add_f32 v22, v22, v38
    v_add_f32 v30, v30, v46
    v_add_f32 v23, v23, v39
    v_add_f32 v31, v31, v47
    v_add_f32 v24, v24, v40
    v_add_f32 v32, v32, v48
    v_add_f32 v25, v25, v41
    v_add_f32 v33, v33, v49
    v_add_f32 v26, v26, v42
    v_add_f32 v34, v34, v50
    v_add_f32 v27, v27, v43
    v_add_f32 v35, v35, v51
    v_add_f32 v20, v20, v28
    v_add_f32 v21, v21, v29
    v_add_f32 v22, v22, v30
    v_add_f32 v23, v23, v31
    v_add_f32 v24, v24, v32
    v_add_f32 v25, v25, v33
    v_add_f32 v26, v26, v34
    v_add_f32 v27, v27, v35
    v_cvt_pk_bf16_f32 v52, v20, v21
    v_cvt_pk_bf16_f32 v53, v22, v23
    v_cvt_pk_bf16_f32 v54, v24, v25
    v_cvt_pk_bf16_f32 v55, v26, v27
    s_waitcnt vmcnt(9)
    buffer_load_dwordx4 a[40:43], v19, s[64:67], s95 offen nt
    s_add_u32 s95, s95, 8192
    v_mfma_f32_16x16x32_bf16 v[192:195], a[0:3], v[52:55], 0
    s_waitcnt vmcnt(9)
    buffer_load_dwordx4 a[44:47], v19, s[64:67], s95 offen nt
    s_add_u32 s95, s95, 8192
    v_mfma_f32_16x16x32_bf16 v[196:199], a[4:7], v[52:55], 0
    s_waitcnt vmcnt(9)
    buffer_load_dwordx4 a[48:51], v19, s[64:67], s95 offen nt
    s_add_u32 s95, s95, 8192
    v_mfma_f32_16x16x32_bf16 v[200:203], a[8:11], v[52:55], 0
    v_mov_b32_dpp v208, v192 quad_perm:[0,0,0,0] row_mask:0xf bank_mask:0xf
    v_mov_b32_dpp v4, v194 quad_perm:[2,2,2,2] row_mask:0xf bank_mask:0xf
    s_nop 0
    v_add_f32_dpp v208, v193, v208 quad_perm:[1,1,1,1] row_mask:0xf bank_mask:0xf
    v_add_f32_dpp v4, v195, v4 quad_perm:[3,3,3,3] row_mask:0xf bank_mask:0xf
    v_add_f32 v208, v208, v4
    s_waitcnt vmcnt(9)
    buffer_load_dwordx4 a[52:55], v19, s[64:67], s95 offen nt
    s_add_u32 s95, s95, 8192
    v_mfma_f32_16x16x32_bf16 v[204:207], a[12:15], v[52:55], 0
    v_mov_b32_dpp v209, v196 quad_perm:[0,0,0,0] row_mask:0xf bank_mask:0xf
    v_mov_b32_dpp v4, v198 quad_perm:[2,2,2,2] row_mask:0xf bank_mask:0xf
    s_nop 0
    v_add_f32_dpp v209, v197, v209 quad_perm:[1,1,1,1] row_mask:0xf bank_mask:0xf
    v_add_f32_dpp v4, v199, v4 quad_perm:[3,3,3,3] row_mask:0xf bank_mask:0xf
    v_add_f32 v209, v209, v4
    s_waitcnt vmcnt(9)
    buffer_load_dwordx4 a[56:59], v19, s[64:67], s95 offen nt
    s_add_u32 s95, s95, 8192
    v_mfma_f32_16x16x32_bf16 v[192:195], a[16:19], v[52:55], 0
    v_mov_b32_dpp v210, v200 quad_perm:[0,0,0,0] row_mask:0xf bank_mask:0xf
    v_mov_b32_dpp v4, v202 quad_perm:[2,2,2,2] row_mask:0xf bank_mask:0xf
    s_nop 0
    v_add_f32_dpp v210, v201, v210 quad_perm:[1,1,1,1] row_mask:0xf bank_mask:0xf
    v_add_f32_dpp v4, v203, v4 quad_perm:[3,3,3,3] row_mask:0xf bank_mask:0xf
    v_add_f32 v210, v210, v4
    s_waitcnt vmcnt(9)
    buffer_load_dwordx4 a[60:63], v19, s[64:67], s95 offen nt
    s_add_u32 s95, s95, 8192
    v_mfma_f32_16x16x32_bf16 v[196:199], a[20:23], v[52:55], 0
    v_mov_b32_dpp v211, v204 quad_perm:[0,0,0,0] row_mask:0xf bank_mask:0xf
    v_mov_b32_dpp v4, v206 quad_perm:[2,2,2,2] row_mask:0xf bank_mask:0xf
    s_nop 0
    v_add_f32_dpp v211, v205, v211 quad_perm:[1,1,1,1] row_mask:0xf bank_mask:0xf
    v_add_f32_dpp v4, v207, v4 quad_perm:[3,3,3,3] row_mask:0xf bank_mask:0xf
    v_add_f32 v211, v211, v4
    s_waitcnt vmcnt(9)
    buffer_load_dwordx4 a[64:67], v19, s[64:67], s95 offen nt
    s_add_u32 s95, s95, 8192
    v_mfma_f32_16x16x32_bf16 v[200:203], a[24:27], v[52:55], 0
    v_mov_b32_dpp v212, v192 quad_perm:[0,0,0,0] row_mask:0xf bank_mask:0xf
    v_mov_b32_dpp v4, v194 quad_perm:[2,2,2,2] row_mask:0xf bank_mask:0xf
    s_nop 0
    v_add_f32_dpp v212, v193, v212 quad_perm:[1,1,1,1] row_mask:0xf bank_mask:0xf
    v_add_f32_dpp v4, v195, v4 quad_perm:[3,3,3,3] row_mask:0xf bank_mask:0xf
    v_add_f32 v212, v212, v4
    s_waitcnt vmcnt(9)
    buffer_load_dwordx4 a[68:71], v19, s[64:67], s95 offen nt
    s_add_u32 s95, s95, 8192
    v_mfma_f32_16x16x32_bf16 v[204:207], a[28:31], v[52:55], 0
    v_mov_b32_dpp v213, v196 quad_perm:[0,0,0,0] row_mask:0xf bank_mask:0xf
    v_mov_b32_dpp v4, v198 quad_perm:[2,2,2,2] row_mask:0xf bank_mask:0xf
    s_nop 0
    v_add_f32_dpp v213, v197, v213 quad_perm:[1,1,1,1] row_mask:0xf bank_mask:0xf
    v_add_f32_dpp v4, v199, v4 quad_perm:[3,3,3,3] row_mask:0xf bank_mask:0xf
    v_add_f32 v213, v213, v4
    s_waitcnt vmcnt(9)
    buffer_load_dwordx4 a[72:75], v19, s[64:67], s95 offen nt
    s_add_u32 s95, s95, 8192
    v_mfma_f32_16x16x32_bf16 v[192:195], a[32:35], v[52:55], 0
    v_mov_b32_dpp v214, v200 quad_perm:[0,0,0,0] row_mask:0xf bank_mask:0xf
    v_mov_b32_dpp v4, v202 quad_perm:[2,2,2,2] row_mask:0xf bank_mask:0xf
    s_nop 0
    v_add_f32_dpp v214, v201, v214 quad_perm:[1,1,1,1] row_mask:0xf bank_mask:0xf
    v_add_f32_dpp v4, v203, v4 quad_perm:[3,3,3,3] row_mask:0xf bank_mask:0xf
    v_add_f32 v214, v214, v4
    s_waitcnt vmcnt(9)
    buffer_load_dwordx4 a[76:79], v19, s[64:67], s95 offen nt
    s_add_u32 s95, s95, 8192
    v_mfma_f32_16x16x32_bf16 v[196:199], a[36:39], v[52:55], 0
    v_mov_b32_dpp v215, v204 quad_perm:[0,0,0,0] row_mask:0xf bank_mask:0xf
    v_mov_b32_dpp v4, v206 quad_perm:[2,2,2,2] row_mask:0xf bank_mask:0xf
    s_nop 0
    v_add_f32_dpp v215, v205, v215 quad_perm:[1,1,1,1] row_mask:0xf bank_mask:0xf
    v_add_f32_dpp v4, v207, v4 quad_perm:[3,3,3,3] row_mask:0xf bank_mask:0xf
    v_add_f32 v215, v215, v4
    s_waitcnt vmcnt(9)
    buffer_load_dwordx4 a[80:83], v19, s[64:67], s95 offen nt
    s_add_u32 s95, s95, 8192
    v_mfma_f32_16x16x32_bf16 v[200:203], a[40:43], v[52:55], 0
    v_mov_b32_dpp v216, v192 quad_perm:[0,0,0,0] row_mask:0xf bank_mask:0xf
    v_mov_b32_dpp v4, v194 quad_perm:[2,2,2,2] row_mask:0xf bank_mask:0xf
    s_nop 0
    v_add_f32_dpp v216, v193, v216 quad_perm:[1,1,1,1] row_mask:0xf bank_mask:0xf
    v_add_f32_dpp v4, v195, v4 quad_perm:[3,3,3,3] row_mask:0xf bank_mask:0xf
    v_add_f32 v216, v216, v4
    s_waitcnt vmcnt(9)
    buffer_load_dwordx4 a[84:87], v19, s[64:67], s95 offen nt
    s_add_u32 s95, s95, 8192
    v_mfma_f32_16x16x32_bf16 v[204:207], a[44:47], v[52:55], 0
    v_mov_b32_dpp v217, v196 quad_perm:[0,0,0,0] row_mask:0xf bank_mask:0xf
    v_mov_b32_dpp v4, v198 quad_perm:[2,2,2,2] row_mask:0xf bank_mask:0xf
    s_nop 0
    v_add_f32_dpp v217, v197, v217 quad_perm:[1,1,1,1] row_mask:0xf bank_mask:0xf
    v_add_f32_dpp v4, v199, v4 quad_perm:[3,3,3,3] row_mask:0xf bank_mask:0xf
    v_add_f32 v217, v217, v4
    s_waitcnt vmcnt(9)
    buffer_load_dwordx4 a[88:91], v19, s[64:67], s95 offen nt
    s_add_u32 s95, s95, 8192
    v_mfma_f32_16x16x32_bf16 v[192:195], a[48:51], v[52:55], 0
    v_mov_b32_dpp v218, v200 quad_perm:[0,0,0,0] row_mask:0xf bank_mask:0xf
    v_mov_b32_dpp v4, v202 quad_perm:[2,2,2,2] row_mask:0xf bank_mask:0xf
    s_nop 0
    v_add_f32_dpp v218, v201, v218 quad_perm:[1,1,1,1] row_mask:0xf bank_mask:0xf
    v_add_f32_dpp v4, v203, v4 quad_perm:[3,3,3,3] row_mask:0xf bank_mask:0xf
    v_add_f32 v218, v218, v4
    s_waitcnt vmcnt(9)
    buffer_load_dwordx4 a[92:95], v19, s[64:67], s95 offen nt
    s_add_u32 s95, s95, 8192
    v_mfma_f32_16x16x32_bf16 v[196:199], a[52:55], v[52:55], 0
    v_mov_b32_dpp v219, v204 quad_perm:[0,0,0,0] row_mask:0xf bank_mask:0xf
    v_mov_b32_dpp v4, v206 quad_perm:[2,2,2,2] row_mask:0xf bank_mask:0xf
    s_nop 0
    v_add_f32_dpp v219, v205, v219 quad_perm:[1,1,1,1] row_mask:0xf bank_mask:0xf
    v_add_f32_dpp v4, v207, v4 quad_perm:[3,3,3,3] row_mask:0xf bank_mask:0xf
    v_add_f32 v219, v219, v4
    s_waitcnt vmcnt(9)
    buffer_load_dwordx4 a[96:99], v19, s[64:67], s95 offen nt
    s_add_u32 s95, s95, 8192
    v_mfma_f32_16x16x32_bf16 v[200:203], a[56:59], v[52:55], 0
    v_mov_b32_dpp v220, v192 quad_perm:[0,0,0,0] row_mask:0xf bank_mask:0xf
    v_mov_b32_dpp v4, v194 quad_perm:[2,2,2,2] row_mask:0xf bank_mask:0xf
    s_nop 0
    v_add_f32_dpp v220, v193, v220 quad_perm:[1,1,1,1] row_mask:0xf bank_mask:0xf
    v_add_f32_dpp v4, v195, v4 quad_perm:[3,3,3,3] row_mask:0xf bank_mask:0xf
    v_add_f32 v220, v220, v4
    s_waitcnt vmcnt(9)
    buffer_load_dwordx4 a[100:103], v19, s[64:67], s95 offen nt
    s_add_u32 s95, s95, 8192
    v_mfma_f32_16x16x32_bf16 v[204:207], a[60:63], v[52:55], 0
    v_mov_b32_dpp v221, v196 quad_perm:[0,0,0,0] row_mask:0xf bank_mask:0xf
    v_mov_b32_dpp v4, v198 quad_perm:[2,2,2,2] row_mask:0xf bank_mask:0xf
    s_nop 0
    v_add_f32_dpp v221, v197, v221 quad_perm:[1,1,1,1] row_mask:0xf bank_mask:0xf
    v_add_f32_dpp v4, v199, v4 quad_perm:[3,3,3,3] row_mask:0xf bank_mask:0xf
    v_add_f32 v221, v221, v4
    s_waitcnt vmcnt(9)
    buffer_load_dwordx4 a[104:107], v19, s[64:67], s95 offen nt
    s_add_u32 s95, s95, 8192
    v_mfma_f32_16x16x32_bf16 v[192:195], a[64:67], v[52:55], 0
    v_mov_b32_dpp v222, v200 quad_perm:[0,0,0,0] row_mask:0xf bank_mask:0xf
    v_mov_b32_dpp v4, v202 quad_perm:[2,2,2,2] row_mask:0xf bank_mask:0xf
    s_nop 0
    v_add_f32_dpp v222, v201, v222 quad_perm:[1,1,1,1] row_mask:0xf bank_mask:0xf
    v_add_f32_dpp v4, v203, v4 quad_perm:[3,3,3,3] row_mask:0xf bank_mask:0xf
    v_add_f32 v222, v222, v4
    s_waitcnt vmcnt(9)
    buffer_load_dwordx4 a[108:111], v19, s[64:67], s95 offen nt
    s_add_u32 s95, s95, 8192
    v_mfma_f32_16x16x32_bf16 v[196:199], a[68:71], v[52:55], 0
    v_mov_b32_dpp v223, v204 quad_perm:[0,0,0,0] row_mask:0xf bank_mask:0xf
    v_mov_b32_dpp v4, v206 quad_perm:[2,2,2,2] row_mask:0xf bank_mask:0xf
    s_nop 0
    v_add_f32_dpp v223, v205, v223 quad_perm:[1,1,1,1] row_mask:0xf bank_mask:0xf
    v_add_f32_dpp v4, v207, v4 quad_perm:[3,3,3,3] row_mask:0xf bank_mask:0xf
    v_add_f32 v223, v223, v4
    s_waitcnt vmcnt(9)
    buffer_load_dwordx4 a[112:115], v19, s[64:67], s95 offen nt
    s_add_u32 s95, s95, 8192
    v_mfma_f32_16x16x32_bf16 v[200:203], a[72:75], v[52:55], 0
    v_mov_b32_dpp v224, v192 quad_perm:[0,0,0,0] row_mask:0xf bank_mask:0xf
    v_mov_b32_dpp v4, v194 quad_perm:[2,2,2,2] row_mask:0xf bank_mask:0xf
    s_nop 0
    v_add_f32_dpp v224, v193, v224 quad_perm:[1,1,1,1] row_mask:0xf bank_mask:0xf
    v_add_f32_dpp v4, v195, v4 quad_perm:[3,3,3,3] row_mask:0xf bank_mask:0xf
    v_add_f32 v224, v224, v4
    s_waitcnt vmcnt(9)
    buffer_load_dwordx4 a[116:119], v19, s[64:67], s95 offen nt
    s_add_u32 s95, s95, 8192
    v_mfma_f32_16x16x32_bf16 v[204:207], a[76:79], v[52:55], 0
    v_mov_b32_dpp v225, v196 quad_perm:[0,0,0,0] row_mask:0xf bank_mask:0xf
    v_mov_b32_dpp v4, v198 quad_perm:[2,2,2,2] row_mask:0xf bank_mask:0xf
    s_nop 0
    v_add_f32_dpp v225, v197, v225 quad_perm:[1,1,1,1] row_mask:0xf bank_mask:0xf
    v_add_f32_dpp v4, v199, v4 quad_perm:[3,3,3,3] row_mask:0xf bank_mask:0xf
    v_add_f32 v225, v225, v4
    s_waitcnt vmcnt(9)
    buffer_load_dwordx4 a[120:123], v19, s[64:67], s95 offen nt
    s_add_u32 s95, s95, 8192
    v_mfma_f32_16x16x32_bf16 v[192:195], a[80:83], v[52:55], 0
    v_mov_b32_dpp v226, v200 quad_perm:[0,0,0,0] row_mask:0xf bank_mask:0xf
    v_mov_b32_dpp v4, v202 quad_perm:[2,2,2,2] row_mask:0xf bank_mask:0xf
    s_nop 0
    v_add_f32_dpp v226, v201, v226 quad_perm:[1,1,1,1] row_mask:0xf bank_mask:0xf
    v_add_f32_dpp v4, v203, v4 quad_perm:[3,3,3,3] row_mask:0xf bank_mask:0xf
    v_add_f32 v226, v226, v4
    s_waitcnt vmcnt(9)
    buffer_load_dwordx4 a[124:127], v19, s[64:67], s95 offen nt
    s_add_u32 s95, s95, 8192
    v_mfma_f32_16x16x32_bf16 v[196:199], a[84:87], v[52:55], 0
    v_mov_b32_dpp v227, v204 quad_perm:[0,0,0,0] row_mask:0xf bank_mask:0xf
    v_mov_b32_dpp v4, v206 quad_perm:[2,2,2,2] row_mask:0xf bank_mask:0xf
    s_nop 0
    v_add_f32_dpp v227, v205, v227 quad_perm:[1,1,1,1] row_mask:0xf bank_mask:0xf
    v_add_f32_dpp v4, v207, v4 quad_perm:[3,3,3,3] row_mask:0xf bank_mask:0xf
    v_add_f32 v227, v227, v4
    s_waitcnt vmcnt(9)
    buffer_load_dwordx4 v[68:71], v78, s[48:51], s91 offen offset:0 sc1
    buffer_load_dwordx4 v[72:75], v78, s[48:51], s91 offen offset:16 sc1
    v_mfma_f32_16x16x32_bf16 v[200:203], a[88:91], v[52:55], 0
    v_mov_b32_dpp v228, v192 quad_perm:[0,0,0,0] row_mask:0xf bank_mask:0xf
    v_mov_b32_dpp v4, v194 quad_perm:[2,2,2,2] row_mask:0xf bank_mask:0xf
    s_nop 0
    v_add_f32_dpp v228, v193, v228 quad_perm:[1,1,1,1] row_mask:0xf bank_mask:0xf
    v_add_f32_dpp v4, v195, v4 quad_perm:[3,3,3,3] row_mask:0xf bank_mask:0xf
    v_add_f32 v228, v228, v4
    s_waitcnt vmcnt(10)
    s_add_u32 s39, s87, s88
    s_bfe_u32 s37, s39, 0x30000
    s_lshl_b32 s37, s37, 12
    s_add_u32 s85, s37, s89
    s_bfe_u32 s37, s39, 0x10003
    s_lshl_b32 s37, s37, 11
    s_add_u32 s85, s37, s85
    s_bfe_u32 s37, s39, 0x40004
    s_lshl_b32 s37, s37, 16
    s_add_u32 s85, s37, s85
    buffer_load_dwordx4 v[128:131], v76, s[52:55], s85 offen offset:0 nt
    v_mfma_f32_16x16x32_bf16 v[204:207], a[92:95], v[52:55], 0
    v_mov_b32_dpp v229, v196 quad_perm:[0,0,0,0] row_mask:0xf bank_mask:0xf
    v_mov_b32_dpp v4, v198 quad_perm:[2,2,2,2] row_mask:0xf bank_mask:0xf
    s_nop 0
    v_add_f32_dpp v229, v197, v229 quad_perm:[1,1,1,1] row_mask:0xf bank_mask:0xf
    v_add_f32_dpp v4, v199, v4 quad_perm:[3,3,3,3] row_mask:0xf bank_mask:0xf
    v_add_f32 v229, v229, v4
    s_waitcnt vmcnt(10)
    buffer_load_dwordx4 v[132:135], v77, s[52:55], s85 offen offset:0 nt
    v_mfma_f32_16x16x32_bf16 v[192:195], a[96:99], v[52:55], 0
    v_mov_b32_dpp v230, v200 quad_perm:[0,0,0,0] row_mask:0xf bank_mask:0xf
    v_mov_b32_dpp v4, v202 quad_perm:[2,2,2,2] row_mask:0xf bank_mask:0xf
    s_nop 0
    v_add_f32_dpp v230, v201, v230 quad_perm:[1,1,1,1] row_mask:0xf bank_mask:0xf
    v_add_f32_dpp v4, v203, v4 quad_perm:[3,3,3,3] row_mask:0xf bank_mask:0xf
    v_add_f32 v230, v230, v4
    s_waitcnt vmcnt(10)
    buffer_load_dwordx4 v[136:139], v76, s[52:55], s85 offen offset:1024 nt
    v_mfma_f32_16x16x32_bf16 v[196:199], a[100:103], v[52:55], 0
    v_mov_b32_dpp v231, v204 quad_perm:[0,0,0,0] row_mask:0xf bank_mask:0xf
    v_mov_b32_dpp v4, v206 quad_perm:[2,2,2,2] row_mask:0xf bank_mask:0xf
    s_nop 0
    v_add_f32_dpp v231, v205, v231 quad_perm:[1,1,1,1] row_mask:0xf bank_mask:0xf
    v_add_f32_dpp v4, v207, v4 quad_perm:[3,3,3,3] row_mask:0xf bank_mask:0xf
    v_add_f32 v231, v231, v4
    s_waitcnt vmcnt(10)
    buffer_load_dwordx4 v[140:143], v77, s[52:55], s85 offen offset:1024 nt
    v_mfma_f32_16x16x32_bf16 v[200:203], a[104:107], v[52:55], 0
    v_mov_b32_dpp v232, v192 quad_perm:[0,0,0,0] row_mask:0xf bank_mask:0xf
    v_mov_b32_dpp v4, v194 quad_perm:[2,2,2,2] row_mask:0xf bank_mask:0xf
    s_nop 0
    v_add_f32_dpp v232, v193, v232 quad_perm:[1,1,1,1] row_mask:0xf bank_mask:0xf
    v_add_f32_dpp v4, v195, v4 quad_perm:[3,3,3,3] row_mask:0xf bank_mask:0xf
    v_add_f32 v232, v232, v4
    s_waitcnt vmcnt(10)
    buffer_load_dwordx4 v[144:147], v126, s[56:59], s85 offen offset:0 nt
    v_mfma_f32_16x16x32_bf16 v[204:207], a[108:111], v[52:55], 0
    v_mov_b32_dpp v233, v196 quad_perm:[0,0,0,0] row_mask:0xf bank_mask:0xf
    v_mov_b32_dpp v4, v198 quad_perm:[2,2,2,2] row_mask:0xf bank_mask:0xf
    s_nop 0
    v_add_f32_dpp v233, v197, v233 quad_perm:[1,1,1,1] row_mask:0xf bank_mask:0xf
    v_add_f32_dpp v4, v199, v4 quad_perm:[3,3,3,3] row_mask:0xf bank_mask:0xf
    v_add_f32 v233, v233, v4
    s_waitcnt vmcnt(10)
    buffer_load_dwordx4 v[148:151], v127, s[56:59], s85 offen offset:0 nt
    v_mfma_f32_16x16x32_bf16 v[192:195], a[112:115], v[52:55], 0
    v_mov_b32_dpp v234, v200 quad_perm:[0,0,0,0] row_mask:0xf bank_mask:0xf
    v_mov_b32_dpp v4, v202 quad_perm:[2,2,2,2] row_mask:0xf bank_mask:0xf
    s_nop 0
    v_add_f32_dpp v234, v201, v234 quad_perm:[1,1,1,1] row_mask:0xf bank_mask:0xf
    v_add_f32_dpp v4, v203, v4 quad_perm:[3,3,3,3] row_mask:0xf bank_mask:0xf
    v_add_f32 v234, v234, v4
    s_waitcnt vmcnt(10)
    buffer_load_dwordx4 v[152:155], v126, s[56:59], s85 offen offset:1024 nt
    v_mfma_f32_16x16x32_bf16 v[196:199], a[116:119], v[52:55], 0
    v_mov_b32_dpp v235, v204 quad_perm:[0,0,0,0] row_mask:0xf bank_mask:0xf
    v_mov_b32_dpp v4, v206 quad_perm:[2,2,2,2] row_mask:0xf bank_mask:0xf
    s_nop 0
    v_add_f32_dpp v235, v205, v235 quad_perm:[1,1,1,1] row_mask:0xf bank_mask:0xf
    v_add_f32_dpp v4, v207, v4 quad_perm:[3,3,3,3] row_mask:0xf bank_mask:0xf
    v_add_f32 v235, v235, v4
    s_waitcnt vmcnt(10)
    buffer_load_dwordx4 v[156:159], v127, s[56:59], s85 offen offset:1024 nt
    v_mfma_f32_16x16x32_bf16 v[200:203], a[120:123], v[52:55], 0
    v_mov_b32_dpp v236, v192 quad_perm:[0,0,0,0] row_mask:0xf bank_mask:0xf
    v_mov_b32_dpp v4, v194 quad_perm:[2,2,2,2] row_mask:0xf bank_mask:0xf
    s_nop 0
    v_add_f32_dpp v236, v193, v236 quad_perm:[1,1,1,1] row_mask:0xf bank_mask:0xf
    v_add_f32_dpp v4, v195, v4 quad_perm:[3,3,3,3] row_mask:0xf bank_mask:0xf
    v_add_f32 v236, v236, v4
    s_waitcnt vmcnt(10)
    s_add_u32 s87, s87, 7
    s_add_u32 s39, s87, s88
    s_bfe_u32 s37, s39, 0x30000
    s_lshl_b32 s37, s37, 12
    s_add_u32 s85, s37, s89
    s_bfe_u32 s37, s39, 0x10003
    s_lshl_b32 s37, s37, 11
    s_add_u32 s85, s37, s85
    s_bfe_u32 s37, s39, 0x40004
    s_lshl_b32 s37, s37, 16
    s_add_u32 s85, s37, s85
    buffer_load_dwordx4 v[160:163], v76, s[52:55], s85 offen offset:0 nt
    v_mfma_f32_16x16x32_bf16 v[204:207], a[124:127], v[52:55], 0
    v_mov_b32_dpp v237, v196 quad_perm:[0,0,0,0] row_mask:0xf bank_mask:0xf
    v_mov_b32_dpp v4, v198 quad_perm:[2,2,2,2] row_mask:0xf bank_mask:0xf
    s_nop 0
    v_add_f32_dpp v237, v197, v237 quad_perm:[1,1,1,1] row_mask:0xf bank_mask:0xf
    v_add_f32_dpp v4, v199, v4 quad_perm:[3,3,3,3] row_mask:0xf bank_mask:0xf
    v_add_f32 v237, v237, v4
    v_mov_b32_dpp v238, v200 quad_perm:[0,0,0,0] row_mask:0xf bank_mask:0xf
    v_mov_b32_dpp v4, v202 quad_perm:[2,2,2,2] row_mask:0xf bank_mask:0xf
    s_nop 0
    v_add_f32_dpp v238, v201, v238 quad_perm:[1,1,1,1] row_mask:0xf bank_mask:0xf
    v_add_f32_dpp v4, v203, v4 quad_perm:[3,3,3,3] row_mask:0xf bank_mask:0xf
    v_add_f32 v238, v238, v4
    v_mov_b32_dpp v239, v204 quad_perm:[0,0,0,0] row_mask:0xf bank_mask:0xf
    v_mov_b32_dpp v4, v206 quad_perm:[2,2,2,2] row_mask:0xf bank_mask:0xf
    s_nop 0
    v_add_f32_dpp v239, v205, v239 quad_perm:[1,1,1,1] row_mask:0xf bank_mask:0xf
    v_add_f32_dpp v4, v207, v4 quad_perm:[3,3,3,3] row_mask:0xf bank_mask:0xf
    v_add_f32 v239, v239, v4
    v_cvt_pk_bf16_f32 v240, v208, v209
    v_cvt_pk_bf16_f32 v241, v210, v211
    v_cvt_pk_bf16_f32 v242, v212, v213
    v_cvt_pk_bf16_f32 v243, v214, v215
    v_cvt_pk_bf16_f32 v244, v216, v217
    v_cvt_pk_bf16_f32 v245, v218, v219
    v_cvt_pk_bf16_f32 v246, v220, v221
    v_cvt_pk_bf16_f32 v247, v222, v223
    v_cvt_pk_bf16_f32 v248, v224, v225
    v_cvt_pk_bf16_f32 v249, v226, v227
    v_cvt_pk_bf16_f32 v250, v228, v229
    v_cvt_pk_bf16_f32 v251, v230, v231
    v_cvt_pk_bf16_f32 v252, v232, v233
    v_cvt_pk_bf16_f32 v253, v234, v235
    v_cvt_pk_bf16_f32 v254, v236, v237
    v_cvt_pk_bf16_f32 v255, v238, v239
    s_mov_b32 exec_lo, 0x22222222
    s_mov_b32 exec_hi, 0x22222222
    v_mov_b32 v240, v244
    v_mov_b32 v241, v245
    v_mov_b32 v242, v246
    v_mov_b32 v243, v247
    s_mov_b32 exec_lo, 0x44444444
    s_mov_b32 exec_hi, 0x44444444
    v_mov_b32 v240, v248
    v_mov_b32 v241, v249
    v_mov_b32 v242, v250
    v_mov_b32 v243, v251
    s_mov_b32 exec_lo, 0x88888888
    s_mov_b32 exec_hi, 0x88888888
    v_mov_b32 v240, v252
    v_mov_b32 v241, v253
    v_mov_b32 v242, v254
    v_mov_b32 v243, v255
    s_mov_b64 exec, -1
    buffer_store_dwordx4 v[240:243], v6, s[48:51], s36 offen sc1
    s_waitcnt vmcnt(7)
    buffer_load_dwordx4 v[164:167], v77, s[52:55], s85 offen offset:0 nt
    s_waitcnt vmcnt(7)
    buffer_load_dwordx4 v[168:171], v76, s[52:55], s85 offen offset:1024 nt
    s_waitcnt vmcnt(7)
    buffer_load_dwordx4 v[172:175], v77, s[52:55], s85 offen offset:1024 nt
    s_waitcnt vmcnt(7)
    buffer_load_dwordx4 v[176:179], v126, s[56:59], s85 offen offset:0 nt
    s_waitcnt vmcnt(7)
    buffer_load_dwordx4 v[180:183], v127, s[56:59], s85 offen offset:0 nt
    s_waitcnt vmcnt(7)
    buffer_load_dwordx4 v[184:187], v126, s[56:59], s85 offen offset:1024 nt
    s_waitcnt vmcnt(7)
    buffer_load_dwordx4 v[188:191], v127, s[56:59], s85 offen offset:1024 nt
    s_lshl_b32 s38, s34, 5
    s_add_u32 s38, s38, s32
    s_lshl_b32 s38, s38, 8
    s_add_u32 s38, s38, 131072
    v_mov_b32 v192, s38
    v_mov_b32 v193, s68
    s_waitcnt vmcnt(7)
    s_mov_b64 exec, 1
    buffer_store_dword v193, v192, s[48:51], 0 offen sc1
    s_mov_b64 exec, -1
L_qcheck_21:
    v_xor_b32 v68, s35, v68
    v_xor_b32 v69, s35, v69
    v_xor_b32 v70, s35, v70
    v_xor_b32 v71, s35, v71
    v_xor_b32 v72, s35, v72
    v_xor_b32 v73, s35, v73
    v_xor_b32 v74, s35, v74
    v_xor_b32 v75, s35, v75
    v_or_b32 v4, v68, v69
    v_or3_b32 v4, v4, v70, v71
    v_or3_b32 v4, v4, v72, v73
    v_or3_b32 v4, v4, v74, v75
    v_and_b32 v4, 0xff, v4
    v_cmp_ne_u32 vcc, 0, v4
    s_cbranch_vccz L_qok_22
    buffer_load_dwordx4 v[68:71], v78, s[48:51], s91 offen offset:0 sc1
    buffer_load_dwordx4 v[72:75], v78, s[48:51], s91 offen offset:16 sc1
    s_waitcnt vmcnt(0)
    s_sub_u32 s84, s84, 1
    s_cmp_lg_u32 s84, 0
    s_cbranch_scc1 L_qcheck_21
    s_branch L_end
L_qok_22:
    v_add_f32_dpp v68, v68, v68 row_ror:4 row_mask:0xf bank_mask:0xf
    v_add_f32_dpp v69, v69, v69 row_ror:4 row_mask:0xf bank_mask:0xf
    v_add_f32_dpp v70, v70, v70 row_ror:4 row_mask:0xf bank_mask:0xf
    v_add_f32_dpp v71, v71, v71 row_ror:4 row_mask:0xf bank_mask:0xf
    v_add_f32_dpp v72, v72, v72 row_ror:4 row_mask:0xf bank_mask:0xf
    v_add_f32_dpp v73, v73, v73 row_ror:4 row_mask:0xf bank_mask:0xf
    v_add_f32_dpp v74, v74, v74 row_ror:4 row_mask:0xf bank_mask:0xf
    v_add_f32_dpp v75, v75, v75 row_ror:4 row_mask:0xf bank_mask:0xf
    v_cvt_pk_bf16_f32 v68, v68, v69
    v_cvt_pk_bf16_f32 v69, v70, v71
    v_cvt_pk_bf16_f32 v70, v72, v73
    v_cvt_pk_bf16_f32 v71, v74, v75
    s_mov_b32 vcc_lo, 0xf000f
    s_mov_b32 vcc_hi, 0xf000f
    v_cndmask_b32 v80, 0, v68, vcc
    v_cndmask_b32 v81, 0, v69, vcc
    v_cndmask_b32 v82, 0, v70, vcc
    v_cndmask_b32 v83, 0, v71, vcc
    s_mov_b32 vcc_lo, 0xf000f0
    s_mov_b32 vcc_hi, 0xf000f0
    v_cndmask_b32 v84, 0, v68, vcc
    v_cndmask_b32 v85, 0, v69, vcc
    v_cndmask_b32 v86, 0, v70, vcc
    v_cndmask_b32 v87, 0, v71, vcc
    s_mov_b32 vcc_lo, 0xf000f00
    s_mov_b32 vcc_hi, 0xf000f00
    v_cndmask_b32 v88, 0, v68, vcc
    v_cndmask_b32 v89, 0, v69, vcc
    v_cndmask_b32 v90, 0, v70, vcc
    v_cndmask_b32 v91, 0, v71, vcc
    s_mov_b32 vcc_lo, 0xf000f000
    s_mov_b32 vcc_hi, 0xf000f000
    v_cndmask_b32 v92, 0, v68, vcc
    v_cndmask_b32 v93, 0, v69, vcc
    v_cndmask_b32 v94, 0, v70, vcc
    v_cndmask_b32 v95, 0, v71, vcc
    v_mfma_f32_16x16x32_bf16 v[112:115], v[128:131], v[80:83], 0
    s_waitcnt vmcnt(6)
    s_add_u32 s87, s87, 7
    s_add_u32 s39, s87, s88
    s_bfe_u32 s37, s39, 0x30000
    s_lshl_b32 s37, s37, 12
    s_add_u32 s85, s37, s89
    s_bfe_u32 s37, s39, 0x10003
    s_lshl_b32 s37, s37, 11
    s_add_u32 s85, s37, s85
    s_bfe_u32 s37, s39, 0x40004
    s_lshl_b32 s37, s37, 16
    s_add_u32 s85, s37, s85
    buffer_load_dwordx4 v[128:131], v76, s[52:55], s85 offen offset:0 nt
    v_mfma_f32_16x16x32_bf16 v[112:115], v[132:135], v[84:87], v[112:115]
    v_mfma_f32_16x16x32_bf16 v[112:115], v[136:139], v[88:91], v[112:115]
    s_waitcnt vmcnt(6)
    buffer_load_dwordx4 v[132:135], v77, s[52:55], s85 offen offset:0 nt
    v_mfma_f32_16x16x32_bf16 v[112:115], v[140:143], v[92:95], v[112:115]
    s_nop 7
    v_mov_b32_dpp v122, v112 quad_perm:[0,0,0,0] row_mask:0xf bank_mask:0xf
    v_mov_b32_dpp v124, v114 quad_perm:[2,2,2,2] row_mask:0xf bank_mask:0xf
    s_nop 0
    v_add_f32_dpp v122, v113, v122 quad_perm:[1,1,1,1] row_mask:0xf bank_mask:0xf
    v_add_f32_dpp v124, v115, v124 quad_perm:[3,3,3,3] row_mask:0xf bank_mask:0xf
    v_add_f32 v122, v122, v124
    v_fma_f32 v123, v122, s83, -v120
    v_cmp_lt_f32 vcc, 0, v123
    s_cbranch_vccz L_nomax_23
    v_mul_f32 v122, s83, v122
    s_nop 1
    v_max_f32_dpp v124, v122, v122 row_ror:4 row_mask:0xf bank_mask:0xf
    s_nop 1
    v_max_f32_dpp v124, v124, v124 row_ror:8 row_mask:0xf bank_mask:0xf
    v_mov_b32 v125, v124
    s_nop 1
    v_permlane16_swap_b32 v124, v125
    v_max_f32 v124, v124, v125
    v_mov_b32 v125, v124
    s_nop 1
    v_permlane32_swap_b32 v124, v125
    v_max_f32 v124, v124, v125
    v_and_b32 v124, s82, v124
    v_max_f32 v124, v124, v120
    v_sub_f32 v125, v120, v124
    v_exp_f32 v125, v125
    v_mov_b32 v120, v124
    v_sub_f32 v123, v122, v124
    v_mul_f32 v121, v121, v125
    v_mul_f32 v116, v116, v125
    v_mul_f32 v117, v117, v125
    v_mul_f32 v118, v118, v125
    v_mul_f32 v119, v119, v125
L_nomax_23:
    v_exp_f32 v123, v123
    s_nop 0
    v_cvt_pk_bf16_f32 v124, v123, v123
    v_add_f32 v121, v121, v123
    s_nop 0
    v_and_b32_dpp v96, v124, v10 row_newbcast:0 row_mask:0xf bank_mask:0xf
    v_and_b32_dpp v97, v124, v11 row_newbcast:0 row_mask:0xf bank_mask:0xf
    v_and_b32_dpp v98, v124, v12 row_newbcast:0 row_mask:0xf bank_mask:0xf
    v_and_b32_dpp v99, v124, v13 row_newbcast:0 row_mask:0xf bank_mask:0xf
    v_and_b32_dpp v100, v124, v10 row_newbcast:4 row_mask:0xf bank_mask:0xf
    v_and_b32_dpp v101, v124, v11 row_newbcast:4 row_mask:0xf bank_mask:0xf
    v_and_b32_dpp v102, v124, v12 row_newbcast:4 row_mask:0xf bank_mask:0xf
    v_and_b32_dpp v103, v124, v13 row_newbcast:4 row_mask:0xf bank_mask:0xf
    v_and_b32_dpp v104, v124, v10 row_newbcast:8 row_mask:0xf bank_mask:0xf
    v_and_b32_dpp v105, v124, v11 row_newbcast:8 row_mask:0xf bank_mask:0xf
    v_and_b32_dpp v106, v124, v12 row_newbcast:8 row_mask:0xf bank_mask:0xf
    v_and_b32_dpp v107, v124, v13 row_newbcast:8 row_mask:0xf bank_mask:0xf
    v_and_b32_dpp v108, v124, v10 row_newbcast:12 row_mask:0xf bank_mask:0xf
    v_and_b32_dpp v109, v124, v11 row_newbcast:12 row_mask:0xf bank_mask:0xf
    v_and_b32_dpp v110, v124, v12 row_newbcast:12 row_mask:0xf bank_mask:0xf
    v_and_b32_dpp v111, v124, v13 row_newbcast:12 row_mask:0xf bank_mask:0xf
    v_mfma_f32_16x16x32_bf16 v[116:119], v[144:147], v[96:99], v[116:119]
    v_mfma_f32_16x16x32_bf16 v[116:119], v[148:151], v[100:103], v[116:119]
    s_waitcnt vmcnt(6)
    buffer_load_dwordx4 v[136:139], v76, s[52:55], s85 offen offset:1024 nt
    v_mfma_f32_16x16x32_bf16 v[116:119], v[152:155], v[104:107], v[116:119]
    v_mfma_f32_16x16x32_bf16 v[116:119], v[156:159], v[108:111], v[116:119]
    v_mfma_f32_16x16x32_bf16 v[112:115], v[160:163], v[80:83], 0
    s_waitcnt vmcnt(6)
    buffer_load_dwordx4 v[140:143], v77, s[52:55], s85 offen offset:1024 nt
    v_mfma_f32_16x16x32_bf16 v[112:115], v[164:167], v[84:87], v[112:115]
    v_mfma_f32_16x16x32_bf16 v[112:115], v[168:171], v[88:91], v[112:115]
    v_mfma_f32_16x16x32_bf16 v[112:115], v[172:175], v[92:95], v[112:115]
    s_nop 7
    v_mov_b32_dpp v122, v112 quad_perm:[0,0,0,0] row_mask:0xf bank_mask:0xf
    v_mov_b32_dpp v124, v114 quad_perm:[2,2,2,2] row_mask:0xf bank_mask:0xf
    s_nop 0
    v_add_f32_dpp v122, v113, v122 quad_perm:[1,1,1,1] row_mask:0xf bank_mask:0xf
    v_add_f32_dpp v124, v115, v124 quad_perm:[3,3,3,3] row_mask:0xf bank_mask:0xf
    v_add_f32 v122, v122, v124
    v_fma_f32 v123, v122, s83, -v120
    v_cmp_lt_f32 vcc, 0, v123
    s_cbranch_vccz L_nomax_24
    v_mul_f32 v122, s83, v122
    s_nop 1
    v_max_f32_dpp v124, v122, v122 row_ror:4 row_mask:0xf bank_mask:0xf
    s_nop 1
    v_max_f32_dpp v124, v124, v124 row_ror:8 row_mask:0xf bank_mask:0xf
    v_mov_b32 v125, v124
    s_nop 1
    v_permlane16_swap_b32 v124, v125
    v_max_f32 v124, v124, v125
    v_mov_b32 v125, v124
    s_nop 1
    v_permlane32_swap_b32 v124, v125
    v_max_f32 v124, v124, v125
    v_and_b32 v124, s82, v124
    v_max_f32 v124, v124, v120
    v_sub_f32 v125, v120, v124
    v_exp_f32 v125, v125
    v_mov_b32 v120, v124
    v_sub_f32 v123, v122, v124
    v_mul_f32 v121, v121, v125
    v_mul_f32 v116, v116, v125
    v_mul_f32 v117, v117, v125
    v_mul_f32 v118, v118, v125
    v_mul_f32 v119, v119, v125
L_nomax_24:
    v_exp_f32 v123, v123
    s_nop 0
    v_cvt_pk_bf16_f32 v124, v123, v123
    v_add_f32 v121, v121, v123
    s_nop 0
    v_and_b32_dpp v96, v124, v10 row_newbcast:0 row_mask:0xf bank_mask:0xf
    v_and_b32_dpp v97, v124, v11 row_newbcast:0 row_mask:0xf bank_mask:0xf
    v_and_b32_dpp v98, v124, v12 row_newbcast:0 row_mask:0xf bank_mask:0xf
    v_and_b32_dpp v99, v124, v13 row_newbcast:0 row_mask:0xf bank_mask:0xf
    v_and_b32_dpp v100, v124, v10 row_newbcast:4 row_mask:0xf bank_mask:0xf
    v_and_b32_dpp v101, v124, v11 row_newbcast:4 row_mask:0xf bank_mask:0xf
    v_and_b32_dpp v102, v124, v12 row_newbcast:4 row_mask:0xf bank_mask:0xf
    v_and_b32_dpp v103, v124, v13 row_newbcast:4 row_mask:0xf bank_mask:0xf
    v_and_b32_dpp v104, v124, v10 row_newbcast:8 row_mask:0xf bank_mask:0xf
    v_and_b32_dpp v105, v124, v11 row_newbcast:8 row_mask:0xf bank_mask:0xf
    v_and_b32_dpp v106, v124, v12 row_newbcast:8 row_mask:0xf bank_mask:0xf
    v_and_b32_dpp v107, v124, v13 row_newbcast:8 row_mask:0xf bank_mask:0xf
    v_and_b32_dpp v108, v124, v10 row_newbcast:12 row_mask:0xf bank_mask:0xf
    v_and_b32_dpp v109, v124, v11 row_newbcast:12 row_mask:0xf bank_mask:0xf
    v_and_b32_dpp v110, v124, v12 row_newbcast:12 row_mask:0xf bank_mask:0xf
    v_and_b32_dpp v111, v124, v13 row_newbcast:12 row_mask:0xf bank_mask:0xf
    s_waitcnt vmcnt(6)
    buffer_load_dwordx4 v[144:147], v126, s[56:59], s85 offen offset:0 nt
    v_mfma_f32_16x16x32_bf16 v[116:119], v[176:179], v[96:99], v[116:119]
    v_mfma_f32_16x16x32_bf16 v[116:119], v[180:183], v[100:103], v[116:119]
    v_mfma_f32_16x16x32_bf16 v[116:119], v[184:187], v[104:107], v[116:119]
    s_waitcnt vmcnt(6)
    v_mfma_f32_16x16x32_bf16 v[116:119], v[188:191], v[108:111], v[116:119]
    s_add_u32 s87, s87, 7
    s_add_u32 s39, s87, s88
    s_bfe_u32 s37, s39, 0x30000
    s_lshl_b32 s37, s37, 12
    s_add_u32 s86, s37, s89
    s_bfe_u32 s37, s39, 0x10003
    s_lshl_b32 s37, s37, 11
    s_add_u32 s86, s37, s86
    s_bfe_u32 s37, s39, 0x40004
    s_lshl_b32 s37, s37, 16
    s_add_u32 s86, s37, s86
    s_branch L_bloop
L_aux:
    v_lshlrev_b32 v4, 2, v2
    v_xor_b32 v4, v4, v3
    v_xor_b32 v96, 0, v4
    v_lshlrev_b32 v96, 4, v96
    v_lshl_add_u32 v10, v2, 13, v96
    v_xor_b32 v97, 1, v4
    v_lshlrev_b32 v97, 4, v97
    v_lshl_add_u32 v11, v2, 13, v97
    v_add_u32 v11, 31744, v11
    v_xor_b32 v98, 2, v4
    v_lshlrev_b32 v98, 4, v98
    v_lshl_add_u32 v12, v2, 13, v98
    v_add_u32 v12, 63488, v12
    v_xor_b32 v99, 3, v4
    v_lshlrev_b32 v99, 4, v99
    v_lshl_add_u32 v13, v2, 13, v99
    v_add_u32 v13, 95232, v13
    s_lshl_b32 s90, s34, 15
    s_mov_b32 s62, 0
    s_mov_b32 s94, 0
    s_lshl_b32 s95, s34, 20
    s_lshl_b32 s38, s32, 8
    s_add_u32 s95, s95, s38
    s_waitcnt lgkmcnt(0)
    s_mov_b32 s52, s12
    s_and_b32 s53, s13, 0xffff
    s_mov_b32 s54, 4194304
    s_mov_b32 s55, 0x20000
    s_add_u32 s39, s90, s62
    s_mov_b32 m0, s39
    s_add_u32 s62, s62, 4096
    s_and_b32 s62, s62, 0x7fff
    buffer_load_dwordx4 v10, s[52:55], s95 offen offset:0 nt lds
    buffer_load_dwordx4 v11, s[52:55], s95 offen offset:1024 nt lds
    buffer_load_dwordx4 v12, s[52:55], s95 offen offset:2048 nt lds
    buffer_load_dwordx4 v13, s[52:55], s95 offen offset:3072 nt lds
    s_add_u32 s95, s95, 131072
    s_add_u32 s39, s90, s62
    s_mov_b32 m0, s39
    s_add_u32 s62, s62, 4096
    s_and_b32 s62, s62, 0x7fff
    buffer_load_dwordx4 v10, s[52:55], s95 offen offset:0 nt lds
    buffer_load_dwordx4 v11, s[52:55], s95 offen offset:1024 nt lds
    buffer_load_dwordx4 v12, s[52:55], s95 offen offset:2048 nt lds
    buffer_load_dwordx4 v13, s[52:55], s95 offen offset:3072 nt lds
    s_add_u32 s95, s95, 131072
    s_load_dword s35, s[30:31], 0
    s_mov_b32 s48, s30
    s_and_b32 s49, s31, 0xffff
    s_mov_b32 s50, 8388608
    s_mov_b32 s51, 0x20000
    s_mov_b32 s82, 0xffffff00
    s_mov_b32 s83, 0x3e0293ee
    s_mov_b32 s84, 1048576
    s_mov_b32 s72, s26
    s_and_b32 s73, s27, 0xffff
    s_mov_b32 s74, 8192
    s_mov_b32 s75, 0x20000
    v_lshl_add_u32 v76, v2, 10, v96
    v_lshl_add_u32 v96, v2, 8, v96
    v_lshl_add_u32 v77, v2, 10, v97
    v_lshl_add_u32 v97, v2, 8, v97
    v_add_u32 v77, 3072, v77
    v_lshl_add_u32 v78, v2, 10, v98
    v_lshl_add_u32 v98, v2, 8, v98
    v_add_u32 v78, 6144, v78
    v_lshl_add_u32 v79, v2, 10, v99
    v_lshl_add_u32 v99, v2, 8, v99
    v_add_u32 v79, 9216, v79
    v_mov_b32 v100, 0
    v_and_b32 v101, 31, v1
    s_lshl_b32 s38, s34, 13
    v_lshl_add_u32 v101, v101, 8, s38
    v_lshlrev_b32 v4, 4, v3
    v_lshl_add_u32 v19, v2, 13, v4
    v_lshl_add_u32 v9, v2, 10, v4
    s_lshl_b32 s63, s32, 17
    s_lshl_b32 s38, s34, 8
    s_add_u32 s63, s63, s38
    v_and_b32 v4, 3, v1
    v_bfe_u32 v5, v1, 2, 2
    v_lshrrev_b32 v6, 5, v1
    v_lshl_add_u32 v7, v4, 2, v5
    v_xor_b32 v7, v7, v6
    v_lshlrev_b32 v7, 4, v7
    v_and_b32 v80, 31, v1
    v_lshl_add_u32 v80, v80, 8, v7
    v_lshl_add_u32 v81, v6, 2, v5
    v_lshlrev_b32 v81, 8, v81
    v_lshl_add_u32 v81, v5, 6, v81
    v_bfe_u32 v7, v1, 4, 1
    v_lshlrev_b32 v7, 1, v7
    v_bfe_u32 v82, v1, 1, 1
    v_add_u32 v7, v7, v82
    v_xor_b32 v7, v7, v6
    v_lshl_add_u32 v81, v7, 4, v81
    v_and_b32 v7, 1, v1
    v_lshl_add_u32 v81, v7, 3, v81
    v_lshl_add_u32 v95, v2, 3, v5
    v_lshlrev_b32 v95, 8, v95
    v_lshl_add_u32 v95, v5, 6, v95
    v_bfe_u32 v4, v1, 4, 1
    v_lshl_add_u32 v4, v4, 1, v82
    v_lshl_add_u32 v95, v4, 4, v95
    v_lshl_add_u32 v95, v7, 3, v95
    v_add_u32 v95, s90, v95
    v_xor_b32 v136, 0, v95
    v_xor_b32 v137, 16, v95
    v_xor_b32 v138, 32, v95
    v_xor_b32 v139, 48, v95
    v_xor_b32 v140, 64, v95
    v_xor_b32 v141, 80, v95
    v_xor_b32 v142, 96, v95
    v_xor_b32 v143, 112, v95
    v_xor_b32 v144, 128, v95
    v_xor_b32 v145, 144, v95
    v_xor_b32 v146, 160, v95
    v_xor_b32 v147, 176, v95
    v_xor_b32 v148, 192, v95
    v_xor_b32 v149, 208, v95
    v_xor_b32 v150, 224, v95
    v_xor_b32 v151, 240, v95
    s_lshl_b32 s85, s34, 13
    s_add_u32 s85, s85, 131072
    v_lshl_add_u32 v94, v1, 4, s85
    v_add_u32 v96, s85, v96
    v_add_u32 v97, s85, v97
    v_add_u32 v98, s85, v98
    v_add_u32 v99, s85, v99
    s_add_u32 s39, s90, s62
    s_mov_b32 m0, s39
    s_add_u32 s62, s62, 4096
    s_and_b32 s62, s62, 0x7fff
    buffer_load_dwordx4 v10, s[52:55], s95 offen offset:0 nt lds
    buffer_load_dwordx4 v11, s[52:55], s95 offen offset:1024 nt lds
    buffer_load_dwordx4 v12, s[52:55], s95 offen offset:2048 nt lds
    buffer_load_dwordx4 v13, s[52:55], s95 offen offset:3072 nt lds
    s_add_u32 s95, s95, 131072
    s_add_u32 s39, s90, s62
    s_mov_b32 m0, s39
    s_add_u32 s62, s62, 4096
    s_and_b32 s62, s62, 0x7fff
    buffer_load_dwordx4 v10, s[52:55], s95 offen offset:0 nt lds
    buffer_load_dwordx4 v11, s[52:55], s95 offen offset:1024 nt lds
    buffer_load_dwordx4 v12, s[52:55], s95 offen offset:2048 nt lds
    buffer_load_dwordx4 v13, s[52:55], s95 offen offset:3072 nt lds
    s_add_u32 s95, s95, 131072
    s_add_u32 s39, s90, s62
    s_mov_b32 m0, s39
    s_add_u32 s62, s62, 4096
    s_and_b32 s62, s62, 0x7fff
    buffer_load_dwordx4 v10, s[52:55], s95 offen offset:0 nt lds
    buffer_load_dwordx4 v11, s[52:55], s95 offen offset:1024 nt lds
    buffer_load_dwordx4 v12, s[52:55], s95 offen offset:2048 nt lds
    buffer_load_dwordx4 v13, s[52:55], s95 offen offset:3072 nt lds
    s_add_u32 s95, s95, 131072
    s_add_u32 s39, s90, s62
    s_mov_b32 m0, s39
    s_add_u32 s62, s62, 4096
    s_and_b32 s62, s62, 0x7fff
    buffer_load_dwordx4 v10, s[52:55], s95 offen offset:0 nt lds
    buffer_load_dwordx4 v11, s[52:55], s95 offen offset:1024 nt lds
    buffer_load_dwordx4 v12, s[52:55], s95 offen offset:2048 nt lds
    buffer_load_dwordx4 v13, s[52:55], s95 offen offset:3072 nt lds
    s_add_u32 s95, s95, 131072
    s_add_u32 s39, s90, s62
    s_mov_b32 m0, s39
    s_add_u32 s62, s62, 4096
    s_and_b32 s62, s62, 0x7fff
    buffer_load_dwordx4 v10, s[52:55], s95 offen offset:0 nt lds
    buffer_load_dwordx4 v11, s[52:55], s95 offen offset:1024 nt lds
    buffer_load_dwordx4 v12, s[52:55], s95 offen offset:2048 nt lds
    buffer_load_dwordx4 v13, s[52:55], s95 offen offset:3072 nt lds
    s_add_u32 s95, s95, 131072
    s_add_u32 s39, s90, s62
    s_mov_b32 m0, s39
    s_add_u32 s62, s62, 4096
    s_and_b32 s62, s62, 0x7fff
    buffer_load_dwordx4 v10, s[52:55], s95 offen offset:0 nt lds
    buffer_load_dwordx4 v11, s[52:55], s95 offen offset:1024 nt lds
    buffer_load_dwordx4 v12, s[52:55], s95 offen offset:2048 nt lds
    buffer_load_dwordx4 v13, s[52:55], s95 offen offset:3072 nt lds
    s_add_u32 s95, s95, 131072
    s_waitcnt lgkmcnt(0)
    s_add_u32 s35, s35, 0x5b
    s_and_b32 s35, s35, 0xff
    v_mov_b32 v8, s35
    s_or_b32 s68, s35, 0x6b3ac500
    s_mov_b32 s52, s14
    s_and_b32 s53, s15, 0xffff
    s_mov_b32 s54, 4194304
    s_mov_b32 s55, 0x20000
    s_mov_b32 s95, s63
    s_waitcnt vmcnt(24)
    ds_read_b64_tr_b16 a[128:129], v136 offset:0
    ds_read_b64_tr_b16 a[130:131], v137 offset:1024
    ds_read_b64_tr_b16 a[144:145], v138 offset:0
    ds_read_b64_tr_b16 a[146:147], v139 offset:1024
    ds_read_b64_tr_b16 a[160:161], v140 offset:0
    ds_read_b64_tr_b16 a[162:163], v141 offset:1024
    ds_read_b64_tr_b16 a[176:177], v142 offset:0
    ds_read_b64_tr_b16 a[178:179], v143 offset:1024
    ds_read_b64_tr_b16 a[192:193], v144 offset:0
    ds_read_b64_tr_b16 a[194:195], v145 offset:1024
    ds_read_b64_tr_b16 a[208:209], v146 offset:0
    ds_read_b64_tr_b16 a[210:211], v147 offset:1024
    ds_read_b64_tr_b16 a[224:225], v148 offset:0
    ds_read_b64_tr_b16 a[226:227], v149 offset:1024
    ds_read_b64_tr_b16 a[240:241], v150 offset:0
    ds_read_b64_tr_b16 a[242:243], v151 offset:1024
    s_waitcnt lgkmcnt(0)
    s_add_u32 s39, s90, s62
    s_mov_b32 m0, s39
    s_add_u32 s62, s62, 4096
    s_and_b32 s62, s62, 0x7fff
    buffer_load_dwordx4 v76, s[52:55], s95 offen offset:0 nt lds
    buffer_load_dwordx4 v77, s[52:55], s95 offen offset:1024 nt lds
    buffer_load_dwordx4 v78, s[52:55], s95 offen offset:2048 nt lds
    buffer_load_dwordx4 v79, s[52:55], s95 offen offset:3072 nt lds
    s_add_u32 s95, s95, 16384
    s_add_u32 s39, s90, s62
    s_mov_b32 m0, s39
    s_add_u32 s62, s62, 4096
    s_and_b32 s62, s62, 0x7fff
    buffer_load_dwordx4 v76, s[52:55], s95 offen offset:0 nt lds
    buffer_load_dwordx4 v77, s[52:55], s95 offen offset:1024 nt lds
    buffer_load_dwordx4 v78, s[52:55], s95 offen offset:2048 nt lds
    buffer_load_dwordx4 v79, s[52:55], s95 offen offset:3072 nt lds
    s_add_u32 s95, s95, 16384
    s_waitcnt vmcnt(24)
    ds_read_b64_tr_b16 a[132:133], v136 offset:8192
    ds_read_b64_tr_b16 a[134:135], v137 offset:9216
    ds_read_b64_tr_b16 a[148:149], v138 offset:8192
    ds_read_b64_tr_b16 a[150:151], v139 offset:9216
    ds_read_b64_tr_b16 a[164:165], v140 offset:8192
    ds_read_b64_tr_b16 a[166:167], v141 offset:9216
    ds_read_b64_tr_b16 a[180:181], v142 offset:8192
    ds_read_b64_tr_b16 a[182:183], v143 offset:9216
    ds_read_b64_tr_b16 a[196:197], v144 offset:8192
    ds_read_b64_tr_b16 a[198:199], v145 offset:9216
    ds_read_b64_tr_b16 a[212:213], v146 offset:8192
    ds_read_b64_tr_b16 a[214:215], v147 offset:9216
    ds_read_b64_tr_b16 a[228:229], v148 offset:8192
    ds_read_b64_tr_b16 a[230:231], v149 offset:9216
    ds_read_b64_tr_b16 a[244:245], v150 offset:8192
    ds_read_b64_tr_b16 a[246:247], v151 offset:9216
    s_waitcnt lgkmcnt(0)
    s_add_u32 s39, s90, s62
    s_mov_b32 m0, s39
    s_add_u32 s62, s62, 4096
    s_and_b32 s62, s62, 0x7fff
    buffer_load_dwordx4 v76, s[52:55], s95 offen offset:0 nt lds
    buffer_load_dwordx4 v77, s[52:55], s95 offen offset:1024 nt lds
    buffer_load_dwordx4 v78, s[52:55], s95 offen offset:2048 nt lds
    buffer_load_dwordx4 v79, s[52:55], s95 offen offset:3072 nt lds
    s_add_u32 s95, s95, 16384
    s_add_u32 s39, s90, s62
    s_mov_b32 m0, s39
    s_add_u32 s62, s62, 4096
    s_and_b32 s62, s62, 0x7fff
    buffer_load_dwordx4 v76, s[52:55], s95 offen offset:0 nt lds
    buffer_load_dwordx4 v77, s[52:55], s95 offen offset:1024 nt lds
    buffer_load_dwordx4 v78, s[52:55], s95 offen offset:2048 nt lds
    buffer_load_dwordx4 v79, s[52:55], s95 offen offset:3072 nt lds
    s_add_u32 s95, s95, 16384
    s_waitcnt vmcnt(24)
    ds_read_b64_tr_b16 a[136:137], v136 offset:16384
    ds_read_b64_tr_b16 a[138:139], v137 offset:17408
    ds_read_b64_tr_b16 a[152:153], v138 offset:16384
    ds_read_b64_tr_b16 a[154:155], v139 offset:17408
    ds_read_b64_tr_b16 a[168:169], v140 offset:16384
    ds_read_b64_tr_b16 a[170:171], v141 offset:17408
    ds_read_b64_tr_b16 a[184:185], v142 offset:16384
    ds_read_b64_tr_b16 a[186:187], v143 offset:17408
    ds_read_b64_tr_b16 a[200:201], v144 offset:16384
    ds_read_b64_tr_b16 a[202:203], v145 offset:17408
    ds_read_b64_tr_b16 a[216:217], v146 offset:16384
    ds_read_b64_tr_b16 a[218:219], v147 offset:17408
    ds_read_b64_tr_b16 a[232:233], v148 offset:16384
    ds_read_b64_tr_b16 a[234:235], v149 offset:17408
    ds_read_b64_tr_b16 a[248:249], v150 offset:16384
    ds_read_b64_tr_b16 a[250:251], v151 offset:17408
    s_waitcnt lgkmcnt(0)
    s_add_u32 s39, s90, s62
    s_mov_b32 m0, s39
    s_add_u32 s62, s62, 4096
    s_and_b32 s62, s62, 0x7fff
    buffer_load_dwordx4 v76, s[52:55], s95 offen offset:0 nt lds
    buffer_load_dwordx4 v77, s[52:55], s95 offen offset:1024 nt lds
    buffer_load_dwordx4 v78, s[52:55], s95 offen offset:2048 nt lds
    buffer_load_dwordx4 v79, s[52:55], s95 offen offset:3072 nt lds
    s_add_u32 s95, s95, 16384
    s_add_u32 s39, s90, s62
    s_mov_b32 m0, s39
    s_add_u32 s62, s62, 4096
    s_and_b32 s62, s62, 0x7fff
    buffer_load_dwordx4 v76, s[52:55], s95 offen offset:0 nt lds
    buffer_load_dwordx4 v77, s[52:55], s95 offen offset:1024 nt lds
    buffer_load_dwordx4 v78, s[52:55], s95 offen offset:2048 nt lds
    buffer_load_dwordx4 v79, s[52:55], s95 offen offset:3072 nt lds
    s_add_u32 s95, s95, 16384
    s_waitcnt vmcnt(24)
    ds_read_b64_tr_b16 a[140:141], v136 offset:24576
    ds_read_b64_tr_b16 a[142:143], v137 offset:25600
    ds_read_b64_tr_b16 a[156:157], v138 offset:24576
    ds_read_b64_tr_b16 a[158:159], v139 offset:25600
    ds_read_b64_tr_b16 a[172:173], v140 offset:24576
    ds_read_b64_tr_b16 a[174:175], v141 offset:25600
    ds_read_b64_tr_b16 a[188:189], v142 offset:24576
    ds_read_b64_tr_b16 a[190:191], v143 offset:25600
    ds_read_b64_tr_b16 a[204:205], v144 offset:24576
    ds_read_b64_tr_b16 a[206:207], v145 offset:25600
    ds_read_b64_tr_b16 a[220:221], v146 offset:24576
    ds_read_b64_tr_b16 a[222:223], v147 offset:25600
    ds_read_b64_tr_b16 a[236:237], v148 offset:24576
    ds_read_b64_tr_b16 a[238:239], v149 offset:25600
    ds_read_b64_tr_b16 a[252:253], v150 offset:24576
    ds_read_b64_tr_b16 a[254:255], v151 offset:25600
    s_waitcnt lgkmcnt(0)
    s_add_u32 s39, s90, s62
    s_mov_b32 m0, s39
    s_add_u32 s62, s62, 4096
    s_and_b32 s62, s62, 0x7fff
    buffer_load_dwordx4 v76, s[52:55], s95 offen offset:0 nt lds
    buffer_load_dwordx4 v77, s[52:55], s95 offen offset:1024 nt lds
    buffer_load_dwordx4 v78, s[52:55], s95 offen offset:2048 nt lds
    buffer_load_dwordx4 v79, s[52:55], s95 offen offset:3072 nt lds
    s_add_u32 s95, s95, 16384
    s_add_u32 s39, s90, s62
    s_mov_b32 m0, s39
    s_add_u32 s62, s62, 4096
    s_and_b32 s62, s62, 0x7fff
    buffer_load_dwordx4 v76, s[52:55], s95 offen offset:0 nt lds
    buffer_load_dwordx4 v77, s[52:55], s95 offen offset:1024 nt lds
    buffer_load_dwordx4 v78, s[52:55], s95 offen offset:2048 nt lds
    buffer_load_dwordx4 v79, s[52:55], s95 offen offset:3072 nt lds
    s_add_u32 s95, s95, 16384
    s_mov_b32 s52, s6
    s_and_b32 s53, s7, 0xffff
    s_mov_b32 s54, 16777216
    s_mov_b32 s55, 0x20000
    s_lshl_b32 s95, s32, 19
    s_lshl_b32 s38, s34, 8
    s_add_u32 s95, s95, s38
    s_waitcnt vmcnt(24)
    ds_read_b64_tr_b16 a[0:1], v136 offset:0
    ds_read_b64_tr_b16 a[2:3], v137 offset:1024
    ds_read_b64_tr_b16 a[16:17], v138 offset:0
    ds_read_b64_tr_b16 a[18:19], v139 offset:1024
    ds_read_b64_tr_b16 a[32:33], v140 offset:0
    ds_read_b64_tr_b16 a[34:35], v141 offset:1024
    ds_read_b64_tr_b16 a[48:49], v142 offset:0
    ds_read_b64_tr_b16 a[50:51], v143 offset:1024
    ds_read_b64_tr_b16 a[64:65], v144 offset:0
    ds_read_b64_tr_b16 a[66:67], v145 offset:1024
    ds_read_b64_tr_b16 a[80:81], v146 offset:0
    ds_read_b64_tr_b16 a[82:83], v147 offset:1024
    ds_read_b64_tr_b16 a[96:97], v148 offset:0
    ds_read_b64_tr_b16 a[98:99], v149 offset:1024
    ds_read_b64_tr_b16 a[112:113], v150 offset:0
    ds_read_b64_tr_b16 a[114:115], v151 offset:1024
    s_waitcnt lgkmcnt(0)
    s_add_u32 s39, s90, s62
    s_mov_b32 m0, s39
    s_add_u32 s62, s62, 4096
    s_and_b32 s62, s62, 0x7fff
    buffer_load_dwordx4 v76, s[52:55], s95 offen offset:0 nt lds
    buffer_load_dwordx4 v77, s[52:55], s95 offen offset:1024 nt lds
    buffer_load_dwordx4 v78, s[52:55], s95 offen offset:2048 nt lds
    buffer_load_dwordx4 v79, s[52:55], s95 offen offset:3072 nt lds
    s_add_u32 s95, s95, 16384
    s_add_u32 s39, s90, s62
    s_mov_b32 m0, s39
    s_add_u32 s62, s62, 4096
    s_and_b32 s62, s62, 0x7fff
    buffer_load_dwordx4 v76, s[52:55], s95 offen offset:0 nt lds
    buffer_load_dwordx4 v77, s[52:55], s95 offen offset:1024 nt lds
    buffer_load_dwordx4 v78, s[52:55], s95 offen offset:2048 nt lds
    buffer_load_dwordx4 v79, s[52:55], s95 offen offset:3072 nt lds
    s_add_u32 s95, s95, 16384
    s_waitcnt vmcnt(24)
    ds_read_b64_tr_b16 a[4:5], v136 offset:8192
    ds_read_b64_tr_b16 a[6:7], v137 offset:9216
    ds_read_b64_tr_b16 a[20:21], v138 offset:8192
    ds_read_b64_tr_b16 a[22:23], v139 offset:9216
    ds_read_b64_tr_b16 a[36:37], v140 offset:8192
    ds_read_b64_tr_b16 a[38:39], v141 offset:9216
    ds_read_b64_tr_b16 a[52:53], v142 offset:8192
    ds_read_b64_tr_b16 a[54:55], v143 offset:9216
    ds_read_b64_tr_b16 a[68:69], v144 offset:8192
    ds_read_b64_tr_b16 a[70:71], v145 offset:9216
    ds_read_b64_tr_b16 a[84:85], v146 offset:8192
    ds_read_b64_tr_b16 a[86:87], v147 offset:9216
    ds_read_b64_tr_b16 a[100:101], v148 offset:8192
    ds_read_b64_tr_b16 a[102:103], v149 offset:9216
    ds_read_b64_tr_b16 a[116:117], v150 offset:8192
    ds_read_b64_tr_b16 a[118:119], v151 offset:9216
    s_waitcnt lgkmcnt(0)
    s_add_u32 s39, s90, s62
    s_mov_b32 m0, s39
    s_add_u32 s62, s62, 4096
    s_and_b32 s62, s62, 0x7fff
    buffer_load_dwordx4 v76, s[52:55], s95 offen offset:0 nt lds
    buffer_load_dwordx4 v77, s[52:55], s95 offen offset:1024 nt lds
    buffer_load_dwordx4 v78, s[52:55], s95 offen offset:2048 nt lds
    buffer_load_dwordx4 v79, s[52:55], s95 offen offset:3072 nt lds
    s_add_u32 s95, s95, 16384
    s_add_u32 s39, s90, s62
    s_mov_b32 m0, s39
    s_add_u32 s62, s62, 4096
    s_and_b32 s62, s62, 0x7fff
    buffer_load_dwordx4 v76, s[52:55], s95 offen offset:0 nt lds
    buffer_load_dwordx4 v77, s[52:55], s95 offen offset:1024 nt lds
    buffer_load_dwordx4 v78, s[52:55], s95 offen offset:2048 nt lds
    buffer_load_dwordx4 v79, s[52:55], s95 offen offset:3072 nt lds
    s_add_u32 s95, s95, 16384
    s_waitcnt vmcnt(24)
    ds_read_b64_tr_b16 a[8:9], v136 offset:16384
    ds_read_b64_tr_b16 a[10:11], v137 offset:17408
    ds_read_b64_tr_b16 a[24:25], v138 offset:16384
    ds_read_b64_tr_b16 a[26:27], v139 offset:17408
    ds_read_b64_tr_b16 a[40:41], v140 offset:16384
    ds_read_b64_tr_b16 a[42:43], v141 offset:17408
    ds_read_b64_tr_b16 a[56:57], v142 offset:16384
    ds_read_b64_tr_b16 a[58:59], v143 offset:17408
    ds_read_b64_tr_b16 a[72:73], v144 offset:16384
    ds_read_b64_tr_b16 a[74:75], v145 offset:17408
    ds_read_b64_tr_b16 a[88:89], v146 offset:16384
    ds_read_b64_tr_b16 a[90:91], v147 offset:17408
    ds_read_b64_tr_b16 a[104:105], v148 offset:16384
    ds_read_b64_tr_b16 a[106:107], v149 offset:17408
    ds_read_b64_tr_b16 a[120:121], v150 offset:16384
    ds_read_b64_tr_b16 a[122:123], v151 offset:17408
    s_waitcnt lgkmcnt(0)
    s_add_u32 s39, s90, s62
    s_mov_b32 m0, s39
    s_add_u32 s62, s62, 4096
    s_and_b32 s62, s62, 0x7fff
    buffer_load_dwordx4 v76, s[52:55], s95 offen offset:0 nt lds
    buffer_load_dwordx4 v77, s[52:55], s95 offen offset:1024 nt lds
    buffer_load_dwordx4 v78, s[52:55], s95 offen offset:2048 nt lds
    buffer_load_dwordx4 v79, s[52:55], s95 offen offset:3072 nt lds
    s_add_u32 s95, s95, 16384
    s_add_u32 s39, s90, s62
    s_mov_b32 m0, s39
    s_add_u32 s62, s62, 4096
    s_and_b32 s62, s62, 0x7fff
    buffer_load_dwordx4 v76, s[52:55], s95 offen offset:0 nt lds
    buffer_load_dwordx4 v77, s[52:55], s95 offen offset:1024 nt lds
    buffer_load_dwordx4 v78, s[52:55], s95 offen offset:2048 nt lds
    buffer_load_dwordx4 v79, s[52:55], s95 offen offset:3072 nt lds
    s_add_u32 s95, s95, 16384
    s_waitcnt vmcnt(24)
    ds_read_b64_tr_b16 a[12:13], v136 offset:24576
    ds_read_b64_tr_b16 a[14:15], v137 offset:25600
    ds_read_b64_tr_b16 a[28:29], v138 offset:24576
    ds_read_b64_tr_b16 a[30:31], v139 offset:25600
    ds_read_b64_tr_b16 a[44:45], v140 offset:24576
    ds_read_b64_tr_b16 a[46:47], v141 offset:25600
    ds_read_b64_tr_b16 a[60:61], v142 offset:24576
    ds_read_b64_tr_b16 a[62:63], v143 offset:25600
    ds_read_b64_tr_b16 a[76:77], v144 offset:24576
    ds_read_b64_tr_b16 a[78:79], v145 offset:25600
    ds_read_b64_tr_b16 a[92:93], v146 offset:24576
    ds_read_b64_tr_b16 a[94:95], v147 offset:25600
    ds_read_b64_tr_b16 a[108:109], v148 offset:24576
    ds_read_b64_tr_b16 a[110:111], v149 offset:25600
    ds_read_b64_tr_b16 a[124:125], v150 offset:24576
    ds_read_b64_tr_b16 a[126:127], v151 offset:25600
    s_waitcnt lgkmcnt(0)
    s_mov_b32 s86, 131072
    buffer_load_dword v7, v101, s[48:51], s86 offen sc1
    s_add_u32 s39, s90, s62
    s_mov_b32 m0, s39
    s_add_u32 s62, s62, 4096
    s_and_b32 s62, s62, 0x7fff
    buffer_load_dwordx4 v76, s[52:55], s95 offen offset:0 nt lds
    buffer_load_dwordx4 v77, s[52:55], s95 offen offset:1024 nt lds
    buffer_load_dwordx4 v78, s[52:55], s95 offen offset:2048 nt lds
    buffer_load_dwordx4 v79, s[52:55], s95 offen offset:3072 nt lds
    s_add_u32 s95, s95, 16384
    s_add_u32 s39, s90, s62
    s_mov_b32 m0, s39
    s_add_u32 s62, s62, 4096
    s_and_b32 s62, s62, 0x7fff
    buffer_load_dwordx4 v76, s[52:55], s95 offen offset:0 nt lds
    v_mov_b32 v136, 0
    v_mov_b32 v137, 0
    v_mov_b32 v138, 0
    v_mov_b32 v139, 0
    v_mov_b32 v140, 0
    v_mov_b32 v141, 0
    v_mov_b32 v142, 0
    v_mov_b32 v143, 0
    v_mov_b32 v144, 0
    v_mov_b32 v145, 0
    v_mov_b32 v146, 0
    v_mov_b32 v147, 0
    v_mov_b32 v148, 0
    v_mov_b32 v149, 0
    v_mov_b32 v150, 0
    v_mov_b32 v151, 0
    v_mov_b32 v152, 0
    v_mov_b32 v153, 0
    v_mov_b32 v154, 0
    v_mov_b32 v155, 0
    v_mov_b32 v156, 0
    v_mov_b32 v157, 0
    v_mov_b32 v158, 0
    v_mov_b32 v159, 0
    v_mov_b32 v160, 0
    v_mov_b32 v161, 0
    v_mov_b32 v162, 0
    v_mov_b32 v163, 0
    v_mov_b32 v164, 0
    v_mov_b32 v165, 0
    v_mov_b32 v166, 0
    v_mov_b32 v167, 0
    v_mov_b32 v168, 0
    v_mov_b32 v169, 0
    v_mov_b32 v170, 0
    v_mov_b32 v171, 0
    v_mov_b32 v172, 0
    v_mov_b32 v173, 0
    v_mov_b32 v174, 0
    v_mov_b32 v175, 0
    v_mov_b32 v176, 0
    v_mov_b32 v177, 0
    v_mov_b32 v178, 0
    v_mov_b32 v179, 0
    v_mov_b32 v180, 0
    v_mov_b32 v181, 0
    v_mov_b32 v182, 0
    v_mov_b32 v183, 0
    v_mov_b32 v184, 0
    v_mov_b32 v185, 0
    v_mov_b32 v186, 0
    v_mov_b32 v187, 0
    v_mov_b32 v188, 0
    v_mov_b32 v189, 0
    v_mov_b32 v190, 0
    v_mov_b32 v191, 0
    v_mov_b32 v192, 0
    v_mov_b32 v193, 0
    v_mov_b32 v194, 0
    v_mov_b32 v195, 0
    v_mov_b32 v196, 0
    v_mov_b32 v197, 0
    v_mov_b32 v198, 0
    v_mov_b32 v199, 0
    v_mov_b32 v90, 0xff7f0000
    s_mov_b32 s93, 0
    v_mov_b32 v102, 0
    v_mov_b32 v103, 0
    s_mov_b32 s60, s83
    s_mov_b32 s61, s83
    v_add_u32 v4, s85, v80
    v_xor_b32 v82, 0, v4
    v_xor_b32 v83, 32, v4
    v_xor_b32 v84, 64, v4
    v_xor_b32 v85, 96, v4
    v_xor_b32 v86, 128, v4
    v_xor_b32 v87, 160, v4
    v_xor_b32 v88, 192, v4
    v_xor_b32 v89, 224, v4
    v_add_u32 v80, s90, v80
    v_add_u32 v81, s90, v81
    s_lshr_b32 s36, s32, 3
    s_lshl_b32 s36, s36, 15
    s_lshl_b32 s38, s34, 8
    s_add_u32 s36, s36, s38
    s_add_u32 s36, s36, 2097152
    s_waitcnt vmcnt(5)
L_fcheck_25:
    v_cmp_ne_u32 vcc, s68, v7
    s_cbranch_vccz L_fok_26
    s_sleep 2
    s_mov_b32 s86, 131072
    buffer_load_dword v7, v101, s[48:51], s86 offen sc1
    s_waitcnt vmcnt(0)
    s_sub_u32 s84, s84, 1
    s_cmp_lg_u32 s84, 0
    s_cbranch_scc1 L_fcheck_25
    s_branch L_end
L_fok_26:
    buffer_load_dwordx4 v[20:23], v9, s[48:51], s36 offen sc1
    s_add_u32 s36, s36, 4096
    buffer_load_dwordx4 v[24:27], v9, s[48:51], s36 offen sc1
    s_add_u32 s36, s36, 4096
    buffer_load_dwordx4 v[28:31], v9, s[48:51], s36 offen sc1
    s_add_u32 s36, s36, 4096
    buffer_load_dwordx4 v[32:35], v9, s[48:51], s36 offen sc1
    s_add_u32 s36, s36, 4096
    buffer_load_dwordx4 v[36:39], v9, s[48:51], s36 offen sc1
    s_add_u32 s36, s36, 4096
    buffer_load_dwordx4 v[40:43], v9, s[48:51], s36 offen sc1
    s_add_u32 s36, s36, 4096
    buffer_load_dwordx4 v[44:47], v9, s[48:51], s36 offen sc1
    s_add_u32 s36, s36, 4096
    buffer_load_dwordx4 v[48:51], v9, s[48:51], s36 offen sc1
    s_waitcnt vmcnt(7)
    ds_write_b128 v96, v[20:23] offset:0
    s_waitcnt vmcnt(6)
    ds_write_b128 v97, v[24:27] offset:1024
    s_waitcnt vmcnt(5)
    ds_write_b128 v98, v[28:31] offset:2048
    s_waitcnt vmcnt(4)
    ds_write_b128 v99, v[32:35] offset:3072
    s_waitcnt vmcnt(3)
    ds_write_b128 v96, v[36:39] offset:4096
    s_waitcnt vmcnt(2)
    ds_write_b128 v97, v[40:43] offset:5120
    s_waitcnt vmcnt(1)
    ds_write_b128 v98, v[44:47] offset:6144
    s_waitcnt vmcnt(0)
    ds_write_b128 v99, v[48:51] offset:7168
    s_waitcnt lgkmcnt(0)
    ds_read_b128 v[104:107], v82
    ds_read_b128 v[108:111], v83
    ds_read_b128 v[112:115], v84
    ds_read_b128 v[116:119], v85
    ds_read_b128 v[120:123], v86
    ds_read_b128 v[124:127], v87
    ds_read_b128 v[128:131], v88
    ds_read_b128 v[132:135], v89
    v_xor_b32 v82, 0, v80
    ds_read_b128 v[216:219], v82
    v_xor_b32 v83, 32, v80
    ds_read_b128 v[220:223], v83
    v_xor_b32 v84, 64, v80
    ds_read_b128 v[224:227], v84
    v_xor_b32 v85, 96, v80
    ds_read_b128 v[228:231], v85
    v_xor_b32 v86, 128, v80
    ds_read_b128 v[232:235], v86
    v_xor_b32 v87, 160, v80
    ds_read_b128 v[236:239], v87
    v_xor_b32 v88, 192, v80
    ds_read_b128 v[240:243], v88
    v_xor_b32 v89, 224, v80
    ds_read_b128 v[244:247], v89
L_att:
    v_add_u32 v4, s94, v81
    s_waitcnt lgkmcnt(0)
    v_mfma_f32_32x32x16_bf16 v[200:215], v[216:219], v[104:107], 0
    v_xor_b32 v82, 0, v4
    ds_read_b64_tr_b16 v[20:21], v82 offset:0
    ds_read_b64_tr_b16 v[24:25], v82 offset:4096
    buffer_load_dwordx4 v77, s[52:55], s95 offen offset:1024 nt lds
    v_mfma_f32_32x32x16_bf16 v[200:215], v[220:223], v[108:111], v[200:215]
    v_xor_b32 v83, 32, v4
    ds_read_b64_tr_b16 v[22:23], v83 offset:2048
    ds_read_b64_tr_b16 v[26:27], v83 offset:6144
    v_mfma_f32_32x32x16_bf16 v[200:215], v[224:227], v[112:115], v[200:215]
    v_xor_b32 v84, 64, v4
    ds_read_b64_tr_b16 v[28:29], v84 offset:0
    ds_read_b64_tr_b16 v[32:33], v84 offset:4096
    v_mfma_f32_32x32x16_bf16 v[200:215], v[228:231], v[116:119], v[200:215]
    v_xor_b32 v85, 96, v4
    ds_read_b64_tr_b16 v[30:31], v85 offset:2048
    ds_read_b64_tr_b16 v[34:35], v85 offset:6144
    v_mfma_f32_32x32x16_bf16 v[200:215], v[232:235], v[120:123], v[200:215]
    v_xor_b32 v86, 128, v4
    ds_read_b64_tr_b16 v[36:37], v86 offset:0
    ds_read_b64_tr_b16 v[40:41], v86 offset:4096
    buffer_load_dwordx4 v78, s[52:55], s95 offen offset:2048 nt lds
    v_mfma_f32_32x32x16_bf16 v[200:215], v[236:239], v[124:127], v[200:215]
    v_xor_b32 v87, 160, v4
    ds_read_b64_tr_b16 v[38:39], v87 offset:2048
    ds_read_b64_tr_b16 v[42:43], v87 offset:6144
    v_mfma_f32_32x32x16_bf16 v[200:215], v[240:243], v[128:131], v[200:215]
    v_xor_b32 v88, 192, v4
    ds_read_b64_tr_b16 v[44:45], v88 offset:0
    ds_read_b64_tr_b16 v[48:49], v88 offset:4096
    v_mfma_f32_32x32x16_bf16 v[200:215], v[244:247], v[132:135], v[200:215]
    v_xor_b32 v89, 224, v4
    ds_read_b64_tr_b16 v[46:47], v89 offset:2048
    ds_read_b64_tr_b16 v[50:51], v89 offset:6144
    buffer_load_dwordx4 v79, s[52:55], s95 offen offset:3072 nt lds
    s_add_u32 s95, s95, 16384
    v_xor_b32 v5, 0x2000, v94
    v_xor_b32 v6, 0x4000, v94
    v_xor_b32 v7, 0x6000, v94
    s_cmp_lg_u32 s93, 12
    s_cbranch_scc1 L_noswitch_27
    s_mov_b32 s52, s24
    s_and_b32 s53, s25, 0xffff
    s_mov_b32 s54, 4194304
    s_mov_b32 s55, 0x20000
    s_mov_b32 s95, s63
L_noswitch_27:
    s_nop 1
    ds_write_b128 v94, v[200:203] offset:0
    ds_write_b128 v94, v[204:207] offset:1024
    ds_write_b128 v94, v[208:211] offset:2048
    ds_write_b128 v94, v[212:215] offset:3072
    s_waitcnt lgkmcnt(0)
    s_barrier
    ds_read_b128 v[60:63], v5 offset:0
    ds_read_b128 v[216:219], v6 offset:0
    ds_read_b128 v[232:235], v7 offset:0
    ds_read_b128 v[64:67], v5 offset:1024
    ds_read_b128 v[220:223], v6 offset:1024
    ds_read_b128 v[236:239], v7 offset:1024
    ds_read_b128 v[68:71], v5 offset:2048
    ds_read_b128 v[224:227], v6 offset:2048
    ds_read_b128 v[240:243], v7 offset:2048
    ds_read_b128 v[72:75], v5 offset:3072
    ds_read_b128 v[228:231], v6 offset:3072
    ds_read_b128 v[244:247], v7 offset:3072
    v_xor_b32 v94, 0x1000, v94
    s_add_u32 s39, s90, s62
    s_mov_b32 m0, s39
    s_add_u32 s62, s62, 4096
    s_and_b32 s62, s62, 0x7fff
    buffer_load_dwordx4 v76, s[52:55], s95 offen offset:0 nt lds
    s_add_u32 s94, s94, 8192
    s_and_b32 s94, s94, 0x7fff
    s_waitcnt lgkmcnt(9)
    v_pk_add_f32 v[200:201], v[200:201], v[60:61]
    v_pk_add_f32 v[216:217], v[216:217], v[232:233]
    v_pk_add_f32 v[202:203], v[202:203], v[62:63]
    v_pk_add_f32 v[218:219], v[218:219], v[234:235]
    v_pk_add_f32 v[200:201], v[200:201], v[216:217]
    v_pk_add_f32 v[202:203], v[202:203], v[218:219]
    s_waitcnt lgkmcnt(6)
    v_pk_add_f32 v[204:205], v[204:205], v[64:65]
    v_pk_add_f32 v[220:221], v[220:221], v[236:237]
    v_pk_add_f32 v[206:207], v[206:207], v[66:67]
    v_pk_add_f32 v[222:223], v[222:223], v[238:239]
    v_pk_add_f32 v[204:205], v[204:205], v[220:221]
    v_pk_add_f32 v[206:207], v[206:207], v[222:223]
    s_waitcnt lgkmcnt(3)
    v_pk_add_f32 v[208:209], v[208:209], v[68:69]
    v_pk_add_f32 v[224:225], v[224:225], v[240:241]
    v_pk_add_f32 v[210:211], v[210:211], v[70:71]
    v_pk_add_f32 v[226:227], v[226:227], v[242:243]
    v_pk_add_f32 v[208:209], v[208:209], v[224:225]
    v_pk_add_f32 v[210:211], v[210:211], v[226:227]
    s_waitcnt lgkmcnt(0)
    v_pk_add_f32 v[212:213], v[212:213], v[72:73]
    v_pk_add_f32 v[228:229], v[228:229], v[244:245]
    v_pk_add_f32 v[214:215], v[214:215], v[74:75]
    v_pk_add_f32 v[230:231], v[230:231], v[246:247]
    v_pk_add_f32 v[212:213], v[212:213], v[228:229]
    v_pk_add_f32 v[214:215], v[214:215], v[230:231]
    buffer_load_dwordx4 v77, s[52:55], s95 offen offset:1024 nt lds
    v_max_f32 v4, v200, v201
    v_max3_f32 v4, v4, v202, v203
    v_max3_f32 v4, v4, v204, v205
    v_max3_f32 v4, v4, v206, v207
    v_max3_f32 v4, v4, v208, v209
    v_max3_f32 v4, v4, v210, v211
    v_max3_f32 v4, v4, v212, v213
    v_max3_f32 v4, v4, v214, v215
    v_mov_b32 v5, v4
    s_nop 1
    v_permlane32_swap_b32 v4, v5
    v_max_f32 v4, v4, v5
    v_mul_f32 v4, s83, v4
    v_max_f32 v4, v4, v90
    v_sub_f32 v92, v90, v4
    v_exp_f32 v92, v92
    v_mov_b32 v90, v4
    v_pk_fma_f32 v[200:201], v[200:201], s[60:61], v[90:91] op_sel_hi:[1,1,0] neg_lo:[0,0,1] neg_hi:[0,0,1]
    v_pk_fma_f32 v[202:203], v[202:203], s[60:61], v[90:91] op_sel_hi:[1,1,0] neg_lo:[0,0,1] neg_hi:[0,0,1]
    v_pk_fma_f32 v[204:205], v[204:205], s[60:61], v[90:91] op_sel_hi:[1,1,0] neg_lo:[0,0,1] neg_hi:[0,0,1]
    v_pk_fma_f32 v[206:207], v[206:207], s[60:61], v[90:91] op_sel_hi:[1,1,0] neg_lo:[0,0,1] neg_hi:[0,0,1]
    v_pk_fma_f32 v[208:209], v[208:209], s[60:61], v[90:91] op_sel_hi:[1,1,0] neg_lo:[0,0,1] neg_hi:[0,0,1]
    v_pk_fma_f32 v[210:211], v[210:211], s[60:61], v[90:91] op_sel_hi:[1,1,0] neg_lo:[0,0,1] neg_hi:[0,0,1]
    v_pk_fma_f32 v[212:213], v[212:213], s[60:61], v[90:91] op_sel_hi:[1,1,0] neg_lo:[0,0,1] neg_hi:[0,0,1]
    v_pk_fma_f32 v[214:215], v[214:215], s[60:61], v[90:91] op_sel_hi:[1,1,0] neg_lo:[0,0,1] neg_hi:[0,0,1]
    v_exp_f32 v200, v200
    v_exp_f32 v201, v201
    v_exp_f32 v202, v202
    v_exp_f32 v203, v203
    v_exp_f32 v204, v204
    buffer_load_dwordx4 v78, s[52:55], s95 offen offset:2048 nt lds
    v_exp_f32 v205, v205
    v_exp_f32 v206, v206
    v_exp_f32 v207, v207
    v_exp_f32 v208, v208
    v_exp_f32 v209, v209
    v_exp_f32 v210, v210
    v_exp_f32 v211, v211
    v_exp_f32 v212, v212
    v_exp_f32 v213, v213
    v_exp_f32 v214, v214
    v_exp_f32 v215, v215
    v_add_u32 v4, s94, v80
    v_pk_mul_f32 v[102:103], v[102:103], v[92:93] op_sel_hi:[1,0]
    v_pk_mul_f32 v[136:137], v[136:137], v[92:93] op_sel_hi:[1,0]
    v_pk_mul_f32 v[138:139], v[138:139], v[92:93] op_sel_hi:[1,0]
    v_pk_mul_f32 v[140:141], v[140:141], v[92:93] op_sel_hi:[1,0]
    v_pk_mul_f32 v[142:143], v[142:143], v[92:93] op_sel_hi:[1,0]
    v_pk_mul_f32 v[144:145], v[144:145], v[92:93] op_sel_hi:[1,0]
    v_pk_mul_f32 v[146:147], v[146:147], v[92:93] op_sel_hi:[1,0]
    v_pk_mul_f32 v[148:149], v[148:149], v[92:93] op_sel_hi:[1,0]
    v_pk_mul_f32 v[150:151], v[150:151], v[92:93] op_sel_hi:[1,0]
    v_pk_mul_f32 v[152:153], v[152:153], v[92:93] op_sel_hi:[1,0]
    v_pk_mul_f32 v[154:155], v[154:155], v[92:93] op_sel_hi:[1,0]
    v_pk_mul_f32 v[156:157], v[156:157], v[92:93] op_sel_hi:[1,0]
    v_pk_mul_f32 v[158:159], v[158:159], v[92:93] op_sel_hi:[1,0]
    v_pk_mul_f32 v[160:161], v[160:161], v[92:93] op_sel_hi:[1,0]
    v_pk_mul_f32 v[162:163], v[162:163], v[92:93] op_sel_hi:[1,0]
    v_pk_mul_f32 v[164:165], v[164:165], v[92:93] op_sel_hi:[1,0]
    v_pk_mul_f32 v[166:167], v[166:167], v[92:93] op_sel_hi:[1,0]
    v_pk_mul_f32 v[168:169], v[168:169], v[92:93] op_sel_hi:[1,0]
    v_pk_mul_f32 v[170:171], v[170:171], v[92:93] op_sel_hi:[1,0]
    v_pk_mul_f32 v[172:173], v[172:173], v[92:93] op_sel_hi:[1,0]
    v_pk_mul_f32 v[174:175], v[174:175], v[92:93] op_sel_hi:[1,0]
    v_pk_mul_f32 v[176:177], v[176:177], v[92:93] op_sel_hi:[1,0]
    buffer_load_dwordx4 v79, s[52:55], s95 offen offset:3072 nt lds
    s_add_u32 s95, s95, 16384
    v_pk_mul_f32 v[178:179], v[178:179], v[92:93] op_sel_hi:[1,0]
    v_pk_mul_f32 v[180:181], v[180:181], v[92:93] op_sel_hi:[1,0]
    v_pk_mul_f32 v[182:183], v[182:183], v[92:93] op_sel_hi:[1,0]
    v_pk_mul_f32 v[184:185], v[184:185], v[92:93] op_sel_hi:[1,0]
    v_pk_mul_f32 v[186:187], v[186:187], v[92:93] op_sel_hi:[1,0]
    v_pk_mul_f32 v[188:189], v[188:189], v[92:93] op_sel_hi:[1,0]
    v_pk_mul_f32 v[190:191], v[190:191], v[92:93] op_sel_hi:[1,0]
    v_pk_mul_f32 v[192:193], v[192:193], v[92:93] op_sel_hi:[1,0]
    v_pk_mul_f32 v[194:195], v[194:195], v[92:93] op_sel_hi:[1,0]
    v_pk_mul_f32 v[196:197], v[196:197], v[92:93] op_sel_hi:[1,0]
    v_pk_mul_f32 v[198:199], v[198:199], v[92:93] op_sel_hi:[1,0]
    v_cvt_pk_bf16_f32 v52, v200, v201
    v_pk_add_f32 v[102:103], v[102:103], v[200:201]
    v_cvt_pk_bf16_f32 v53, v202, v203
    v_pk_add_f32 v[102:103], v[102:103], v[202:203]
    v_cvt_pk_bf16_f32 v54, v204, v205
    v_pk_add_f32 v[102:103], v[102:103], v[204:205]
    v_cvt_pk_bf16_f32 v55, v206, v207
    v_pk_add_f32 v[102:103], v[102:103], v[206:207]
    v_cvt_pk_bf16_f32 v56, v208, v209
    v_pk_add_f32 v[102:103], v[102:103], v[208:209]
    v_cvt_pk_bf16_f32 v57, v210, v211
    v_pk_add_f32 v[102:103], v[102:103], v[210:211]
    v_cvt_pk_bf16_f32 v58, v212, v213
    v_pk_add_f32 v[102:103], v[102:103], v[212:213]
    v_cvt_pk_bf16_f32 v59, v214, v215
    v_pk_add_f32 v[102:103], v[102:103], v[214:215]
    s_waitcnt vmcnt(20)
    v_mfma_f32_32x32x16_bf16 v[136:151], v[20:23], v[52:55], v[136:151]
    v_xor_b32 v82, 0, v4
    ds_read_b128 v[216:219], v82
    v_xor_b32 v83, 32, v4
    ds_read_b128 v[220:223], v83
    v_mfma_f32_32x32x16_bf16 v[152:167], v[28:31], v[52:55], v[152:167]
    v_xor_b32 v84, 64, v4
    ds_read_b128 v[224:227], v84
    v_xor_b32 v85, 96, v4
    ds_read_b128 v[228:231], v85
    v_mfma_f32_32x32x16_bf16 v[168:183], v[36:39], v[52:55], v[168:183]
    v_xor_b32 v86, 128, v4
    ds_read_b128 v[232:235], v86
    v_xor_b32 v87, 160, v4
    ds_read_b128 v[236:239], v87
    v_mfma_f32_32x32x16_bf16 v[184:199], v[44:47], v[52:55], v[184:199]
    v_xor_b32 v88, 192, v4
    ds_read_b128 v[240:243], v88
    v_xor_b32 v89, 224, v4
    ds_read_b128 v[244:247], v89
    v_mfma_f32_32x32x16_bf16 v[136:151], v[24:27], v[56:59], v[136:151]
    s_add_u32 s39, s90, s62
    s_mov_b32 m0, s39
    s_add_u32 s62, s62, 4096
    s_and_b32 s62, s62, 0x7fff
    buffer_load_dwordx4 v76, s[52:55], s95 offen offset:0 nt lds
    v_mfma_f32_32x32x16_bf16 v[152:167], v[32:35], v[56:59], v[152:167]
    v_mfma_f32_32x32x16_bf16 v[168:183], v[40:43], v[56:59], v[168:183]
    v_mfma_f32_32x32x16_bf16 v[184:199], v[48:51], v[56:59], v[184:199]
    s_add_u32 s93, s93, 1
    s_cmp_lt_u32 s93, 16
    s_cbranch_scc1 L_att
    v_add_f32 v91, v102, v103
    v_mov_b32 v5, v91
    s_nop 1
    v_permlane32_swap_b32 v91, v5
    v_add_f32 v91, v91, v5
    v_and_b32 v4, 31, v1
    v_lshlrev_b32 v5, 8, v4
    v_lshl_add_u32 v5, v3, 4, v5
    v_lshrrev_b32 v6, 5, v1
    v_lshl_add_u32 v5, v6, 3, v5
    v_add_u32 v5, s85, v5
    s_waitcnt lgkmcnt(0)
    s_barrier
    v_cvt_pk_bf16_f32 v20, v136, v137
    v_cvt_pk_bf16_f32 v21, v138, v139
    v_xor_b32 v82, 0, v5
    ds_write_b64 v82, v[20:21]
    v_cvt_pk_bf16_f32 v22, v140, v141
    v_cvt_pk_bf16_f32 v23, v142, v143
    v_xor_b32 v83, 16, v5
    ds_write_b64 v83, v[22:23]
    v_cvt_pk_bf16_f32 v24, v144, v145
    v_cvt_pk_bf16_f32 v25, v146, v147
    v_xor_b32 v84, 32, v5
    ds_write_b64 v84, v[24:25]
    v_cvt_pk_bf16_f32 v26, v148, v149
    v_cvt_pk_bf16_f32 v27, v150, v151
    v_xor_b32 v85, 48, v5
    ds_write_b64 v85, v[26:27]
    v_cvt_pk_bf16_f32 v28, v152, v153
    v_cvt_pk_bf16_f32 v29, v154, v155
    v_xor_b32 v86, 64, v5
    ds_write_b64 v86, v[28:29]
    v_cvt_pk_bf16_f32 v30, v156, v157
    v_cvt_pk_bf16_f32 v31, v158, v159
    v_xor_b32 v87, 80, v5
    ds_write_b64 v87, v[30:31]
    v_cvt_pk_bf16_f32 v32, v160, v161
    v_cvt_pk_bf16_f32 v33, v162, v163
    v_xor_b32 v88, 96, v5
    ds_write_b64 v88, v[32:33]
    v_cvt_pk_bf16_f32 v34, v164, v165
    v_cvt_pk_bf16_f32 v35, v166, v167
    v_xor_b32 v89, 112, v5
    ds_write_b64 v89, v[34:35]
    v_cvt_pk_bf16_f32 v36, v168, v169
    v_cvt_pk_bf16_f32 v37, v170, v171
    v_xor_b32 v82, 128, v5
    ds_write_b64 v82, v[36:37]
    v_cvt_pk_bf16_f32 v38, v172, v173
    v_cvt_pk_bf16_f32 v39, v174, v175
    v_xor_b32 v83, 144, v5
    ds_write_b64 v83, v[38:39]
    v_cvt_pk_bf16_f32 v40, v176, v177
    v_cvt_pk_bf16_f32 v41, v178, v179
    v_xor_b32 v84, 160, v5
    ds_write_b64 v84, v[40:41]
    v_cvt_pk_bf16_f32 v42, v180, v181
    v_cvt_pk_bf16_f32 v43, v182, v183
    v_xor_b32 v85, 176, v5
    ds_write_b64 v85, v[42:43]
    v_cvt_pk_bf16_f32 v44, v184, v185
    v_cvt_pk_bf16_f32 v45, v186, v187
    v_xor_b32 v86, 192, v5
    ds_write_b64 v86, v[44:45]
    v_cvt_pk_bf16_f32 v46, v188, v189
    v_cvt_pk_bf16_f32 v47, v190, v191
    v_xor_b32 v87, 208, v5
    ds_write_b64 v87, v[46:47]
    v_cvt_pk_bf16_f32 v48, v192, v193
    v_cvt_pk_bf16_f32 v49, v194, v195
    v_xor_b32 v88, 224, v5
    ds_write_b64 v88, v[48:49]
    v_cvt_pk_bf16_f32 v50, v196, v197
    v_cvt_pk_bf16_f32 v51, v198, v199
    v_xor_b32 v89, 240, v5
    ds_write_b64 v89, v[50:51]
    v_xor_b32 v6, v3, v2
    v_lshlrev_b32 v6, 4, v6
    v_lshl_add_u32 v6, v2, 8, v6
    v_add_u32 v6, s85, v6
    v_xor_b32 v82, 0, v6
    v_xor_b32 v83, 64, v6
    v_xor_b32 v84, 128, v6
    v_xor_b32 v85, 192, v6
    v_lshlrev_b32 v7, 4, v3
    v_lshl_add_u32 v7, v2, 15, v7
    s_lshl_b32 s36, s32, 10
    s_lshl_b32 s38, s34, 8
    s_add_u32 s36, s36, s38
    s_add_u32 s36, s36, 4194304
    s_waitcnt lgkmcnt(0)
    ds_read_b128 v[200:203], v82 offset:0
    ds_read_b128 v[204:207], v83 offset:1024
    ds_read_b128 v[208:211], v84 offset:2048
    ds_read_b128 v[212:215], v85 offset:3072
    ds_read_b128 v[216:219], v82 offset:4096
    ds_read_b128 v[220:223], v83 offset:5120
    ds_read_b128 v[224:227], v84 offset:6144
    ds_read_b128 v[228:231], v85 offset:7168
    v_lshlrev_b32 v4, 3, v4
    s_lshl_b32 s37, s32, 8
    s_lshl_b32 s38, s34, 13
    s_add_u32 s37, s37, s38
    s_add_u32 s37, s37, 2621440
    s_mov_b32 exec_lo, 0xffffffff
    s_mov_b32 exec_hi, 0x0
    buffer_store_dwordx2 v[90:91], v4, s[48:51], s37 offen sc1
    s_mov_b64 exec, -1
    s_waitcnt lgkmcnt(7)
    buffer_store_dwordx4 v[200:203], v7, s[48:51], s36 offen sc1
    s_add_u32 s36, s36, 131072
    s_waitcnt lgkmcnt(6)
    buffer_store_dwordx4 v[204:207], v7, s[48:51], s36 offen sc1
    s_add_u32 s36, s36, 131072
    s_waitcnt lgkmcnt(5)
    buffer_store_dwordx4 v[208:211], v7, s[48:51], s36 offen sc1
    s_add_u32 s36, s36, 131072
    s_waitcnt lgkmcnt(4)
    buffer_store_dwordx4 v[212:215], v7, s[48:51], s36 offen sc1
    s_add_u32 s36, s36, 131072
    s_waitcnt lgkmcnt(3)
    buffer_store_dwordx4 v[216:219], v7, s[48:51], s36 offen sc1
    s_add_u32 s36, s36, 131072
    s_waitcnt lgkmcnt(2)
    buffer_store_dwordx4 v[220:223], v7, s[48:51], s36 offen sc1
    s_add_u32 s36, s36, 131072
    s_waitcnt lgkmcnt(1)
    buffer_store_dwordx4 v[224:227], v7, s[48:51], s36 offen sc1
    s_add_u32 s36, s36, 131072
    s_waitcnt lgkmcnt(0)
    buffer_store_dwordx4 v[228:231], v7, s[48:51], s36 offen sc1
    buffer_load_dwordx4 v77, s[52:55], s95 offen offset:1024 nt lds
    buffer_load_dwordx4 v78, s[52:55], s95 offen offset:2048 nt lds
    buffer_load_dwordx4 v79, s[52:55], s95 offen offset:3072 nt lds
    s_add_u32 s95, s95, 16384
    v_mov_b32 v136, 0
    v_mov_b32 v137, 0
    v_mov_b32 v138, 0
    v_mov_b32 v139, 0
    v_mov_b32 v140, 0
    v_mov_b32 v141, 0
    v_mov_b32 v142, 0
    v_mov_b32 v143, 0
    v_mov_b32 v144, 0
    v_mov_b32 v145, 0
    v_mov_b32 v146, 0
    v_mov_b32 v147, 0
    v_mov_b32 v148, 0
    v_mov_b32 v149, 0
    v_mov_b32 v150, 0
    v_mov_b32 v151, 0
    v_mov_b32 v152, 0
    v_mov_b32 v153, 0
    v_mov_b32 v154, 0
    v_mov_b32 v155, 0
    v_mov_b32 v156, 0
    v_mov_b32 v157, 0
    v_mov_b32 v158, 0
    v_mov_b32 v159, 0
    v_mov_b32 v160, 0
    v_mov_b32 v161, 0
    v_mov_b32 v162, 0
    v_mov_b32 v163, 0
    v_mov_b32 v164, 0
    v_mov_b32 v165, 0
    v_mov_b32 v166, 0
    v_mov_b32 v167, 0
    v_mov_b32 v168, 0
    v_mov_b32 v169, 0
    v_mov_b32 v170, 0
    v_mov_b32 v171, 0
    v_mov_b32 v172, 0
    v_mov_b32 v173, 0
    v_mov_b32 v174, 0
    v_mov_b32 v175, 0
    v_mov_b32 v176, 0
    v_mov_b32 v177, 0
    v_mov_b32 v178, 0
    v_mov_b32 v179, 0
    v_mov_b32 v180, 0
    v_mov_b32 v181, 0
    v_mov_b32 v182, 0
    v_mov_b32 v183, 0
    v_mov_b32 v184, 0
    v_mov_b32 v185, 0
    v_mov_b32 v186, 0
    v_mov_b32 v187, 0
    v_mov_b32 v188, 0
    v_mov_b32 v189, 0
    v_mov_b32 v190, 0
    v_mov_b32 v191, 0
    v_mov_b32 v192, 0
    v_mov_b32 v193, 0
    v_mov_b32 v194, 0
    v_mov_b32 v195, 0
    v_mov_b32 v196, 0
    v_mov_b32 v197, 0
    v_mov_b32 v198, 0
    v_mov_b32 v199, 0
    v_and_b32 v4, 3, v3
    v_mul_u32_u24 v76, 320, v4
    v_lshl_add_u32 v76, v2, 4, v76
    v_add_u32 v76, 147456, v76
    s_lshl_b32 s36, s34, 16
    s_lshl_b32 s38, s32, 8
    s_add_u32 s36, s36, s38
    v_add_u32 v77, s36, v19
    s_lshl_b32 s36, s32, 13
    s_lshl_b32 s38, s34, 6
    s_add_u32 s36, s36, s38
    v_lshrrev_b32 v5, 2, v1
    v_lshlrev_b32 v5, 8, v5
    v_lshl_add_u32 v5, v4, 4, v5
    v_add_u32 v78, s36, v5
    s_lshr_b32 s36, s32, 2
    s_lshl_b32 s36, s36, 7
    s_lshl_b32 s38, s34, 5
    s_add_u32 s36, s36, s38
    s_and_b32 s38, s32, 3
    s_lshl_b32 s38, s38, 3
    s_add_u32 s36, s36, s38
    v_lshlrev_b32 v5, 11, v4
    v_lshl_add_u32 v5, v2, 1, v5
    v_add_u32 v79, s36, v5
    v_lshrrev_b32 v5, 2, v3
    v_lshl_add_u32 v6, v4, 3, v5
    v_lshlrev_b32 v81, 8, v6
    v_lshlrev_b32 v6, 10, v6
    v_lshl_add_u32 v80, v2, 4, v6
    s_lshl_b32 s38, s34, 11
    s_add_u32 s38, s38, 131072
    v_lshlrev_b32 v4, 9, v4
    v_lshl_add_u32 v4, v2, 4, v4
    v_add_u32 v94, s38, v4
    s_lshl_b32 s38, s34, 9
    s_add_u32 s38, s38, 131072
    v_and_b32 v5, 31, v1
    v_lshl_add_u32 v96, v5, 4, s38
    s_mul_i32 s38, s34, 320
    s_add_u32 s38, s38, 147456
    v_lshl_add_u32 v97, v5, 3, s38
    v_lshlrev_b32 v4, 6, v2
    v_lshl_add_u32 v4, v3, 1, v4
    v_add_u32 v93, s38, v4
    v_lshlrev_b32 v4, 7, v2
    v_lshl_add_u32 v4, v3, 4, v4
    v_mov_b32 v5, 512
    v_cmp_gt_u32 vcc, 8, v3
    s_nop 1
    v_cndmask_b32 v92, v5, v4, vcc
    s_mov_b32 s92, 0
    s_mov_b32 s96, 3145728
    s_mov_b32 s97, 0
    s_lshl_b32 s36, s32, 15
    s_lshl_b32 s38, s34, 8
    s_add_u32 s36, s36, s38
    s_add_u32 s36, s36, 4194304
    s_lshl_b32 s37, s32, 3
    s_lshl_b32 s38, s34, 13
    s_add_u32 s37, s37, s38
    s_add_u32 s37, s37, 2621440
    s_barrier
    s_lshl_b32 s38, s34, 5
    s_add_u32 s38, s38, s32
    s_lshl_b32 s38, s38, 8
    s_add_u32 s38, s38, 196608
    v_mov_b32 v4, s38
    v_mov_b32 v5, s68
    s_waitcnt vmcnt(3)
    s_mov_b64 exec, 1
    buffer_store_dword v5, v4, s[48:51], 0 offen sc1
    s_mov_b64 exec, -1
    s_mov_b32 s86, 196608
    buffer_load_dword v7, v101, s[48:51], s86 offen sc1
    s_waitcnt vmcnt(0)
L_fcheck_28:
    v_cmp_ne_u32 vcc, s68, v7
    s_cbranch_vccz L_fok_29
    s_sleep 2
    s_mov_b32 s86, 196608
    buffer_load_dword v7, v101, s[48:51], s86 offen sc1
    s_waitcnt vmcnt(0)
    s_sub_u32 s84, s84, 1
    s_cmp_lg_u32 s84, 0
    s_cbranch_scc1 L_fcheck_28
    s_branch L_end
L_fok_29:
    buffer_load_dwordx2 v[52:53], v81, s[48:51], s37 offen offset:0 sc1
    buffer_load_dwordx2 v[54:55], v81, s[48:51], s37 offen offset:1024 sc1
    buffer_load_dwordx4 v[20:23], v80, s[48:51], s36 offen offset:0 sc1
    buffer_load_dwordx4 v[24:27], v80, s[48:51], s36 offen offset:64 sc1
    buffer_load_dwordx4 v[28:31], v80, s[48:51], s36 offen offset:128 sc1
    buffer_load_dwordx4 v[32:35], v80, s[48:51], s36 offen offset:192 sc1
    s_add_u32 s36, s36, 4096
    buffer_load_dwordx4 v[36:39], v80, s[48:51], s36 offen offset:0 sc1
    buffer_load_dwordx4 v[40:43], v80, s[48:51], s36 offen offset:64 sc1
    buffer_load_dwordx4 v[44:47], v80, s[48:51], s36 offen offset:128 sc1
    buffer_load_dwordx4 v[48:51], v80, s[48:51], s36 offen offset:192 sc1
    s_add_u32 s36, s36, 4096
    s_waitcnt vmcnt(8)
    v_max_f32 v4, v52, v54
    s_nop 1
    v_max_f32_dpp v4, v4, v4 row_ror:8 row_mask:0xf bank_mask:0xf
    s_nop 1
    v_max_f32_dpp v4, v4, v4 row_ror:4 row_mask:0xf bank_mask:0xf
    v_sub_f32 v52, v52, v4
    v_sub_f32 v54, v54, v4
    v_exp_f32 v52, v52
    v_exp_f32 v54, v54
    v_mul_f32 v5, v52, v53
    v_fmac_f32 v5, v54, v55
    s_nop 1
    v_add_f32_dpp v5, v5, v5 row_ror:8 row_mask:0xf bank_mask:0xf
    s_nop 1
    v_add_f32_dpp v5, v5, v5 row_ror:4 row_mask:0xf bank_mask:0xf
    v_rcp_f32 v5, v5
    s_nop 0
    v_mul_f32 v52, v52, v5
    v_mul_f32 v54, v54, v5
    s_waitcnt vmcnt(0)
    v_mfma_f32_16x16x32_bf16 v[60:63], a[128:131], v[20:23], 0
    v_mfma_f32_16x16x32_bf16 v[64:67], a[128:131], v[36:39], 0
    v_mfma_f32_16x16x32_bf16 v[60:63], a[132:135], v[24:27], v[60:63]
    v_mfma_f32_16x16x32_bf16 v[64:67], a[132:135], v[40:43], v[64:67]
    v_mfma_f32_16x16x32_bf16 v[60:63], a[136:139], v[28:31], v[60:63]
    v_mfma_f32_16x16x32_bf16 v[64:67], a[136:139], v[44:47], v[64:67]
    v_mfma_f32_16x16x32_bf16 v[60:63], a[140:143], v[32:35], v[60:63]
    v_mfma_f32_16x16x32_bf16 v[64:67], a[140:143], v[48:51], v[64:67]
    v_mfma_f32_16x16x32_bf16 v[68:71], a[144:147], v[20:23], 0
    v_mfma_f32_16x16x32_bf16 v[72:75], a[144:147], v[36:39], 0
    v_mfma_f32_16x16x32_bf16 v[68:71], a[148:151], v[24:27], v[68:71]
    v_mfma_f32_16x16x32_bf16 v[72:75], a[148:151], v[40:43], v[72:75]
    v_mfma_f32_16x16x32_bf16 v[68:71], a[152:155], v[28:31], v[68:71]
    v_mfma_f32_16x16x32_bf16 v[72:75], a[152:155], v[44:47], v[72:75]
    v_mfma_f32_16x16x32_bf16 v[68:71], a[156:159], v[32:35], v[68:71]
    v_mfma_f32_16x16x32_bf16 v[72:75], a[156:159], v[48:51], v[72:75]
    v_mul_f32 v104, v60, v52
    v_mul_f32 v105, v61, v52
    v_mul_f32 v106, v62, v52
    v_mul_f32 v107, v63, v52
    v_fmac_f32 v104, v64, v54
    v_fmac_f32 v105, v65, v54
    v_fmac_f32 v106, v66, v54
    v_fmac_f32 v107, v67, v54
    v_add_f32_dpp v104, v104, v104 row_ror:8 row_mask:0xf bank_mask:0xf
    v_add_f32_dpp v105, v105, v105 row_ror:8 row_mask:0xf bank_mask:0xf
    v_add_f32_dpp v106, v106, v106 row_ror:8 row_mask:0xf bank_mask:0xf
    v_add_f32_dpp v107, v107, v107 row_ror:8 row_mask:0xf bank_mask:0xf
    v_add_f32_dpp v104, v104, v104 row_ror:4 row_mask:0xf bank_mask:0xf
    v_add_f32_dpp v105, v105, v105 row_ror:4 row_mask:0xf bank_mask:0xf
    v_add_f32_dpp v106, v106, v106 row_ror:4 row_mask:0xf bank_mask:0xf
    v_add_f32_dpp v107, v107, v107 row_ror:4 row_mask:0xf bank_mask:0xf
    ds_write_b128 v94, v[104:107] offset:0
    v_mfma_f32_16x16x32_bf16 v[60:63], a[160:163], v[20:23], 0
    v_mfma_f32_16x16x32_bf16 v[64:67], a[160:163], v[36:39], 0
    v_mfma_f32_16x16x32_bf16 v[60:63], a[164:167], v[24:27], v[60:63]
    v_mfma_f32_16x16x32_bf16 v[64:67], a[164:167], v[40:43], v[64:67]
    v_mfma_f32_16x16x32_bf16 v[60:63], a[168:171], v[28:31], v[60:63]
    v_mfma_f32_16x16x32_bf16 v[64:67], a[168:171], v[44:47], v[64:67]
    v_mfma_f32_16x16x32_bf16 v[60:63], a[172:175], v[32:35], v[60:63]
    v_mfma_f32_16x16x32_bf16 v[64:67], a[172:175], v[48:51], v[64:67]
    v_mul_f32 v108, v68, v52
    v_mul_f32 v109, v69, v52
    v_mul_f32 v110, v70, v52
    v_mul_f32 v111, v71, v52
    v_fmac_f32 v108, v72, v54
    v_fmac_f32 v109, v73, v54
    v_fmac_f32 v110, v74, v54
    v_fmac_f32 v111, v75, v54
    v_add_f32_dpp v108, v108, v108 row_ror:8 row_mask:0xf bank_mask:0xf
    v_add_f32_dpp v109, v109, v109 row_ror:8 row_mask:0xf bank_mask:0xf
    v_add_f32_dpp v110, v110, v110 row_ror:8 row_mask:0xf bank_mask:0xf
    v_add_f32_dpp v111, v111, v111 row_ror:8 row_mask:0xf bank_mask:0xf
    v_add_f32_dpp v108, v108, v108 row_ror:4 row_mask:0xf bank_mask:0xf
    v_add_f32_dpp v109, v109, v109 row_ror:4 row_mask:0xf bank_mask:0xf
    v_add_f32_dpp v110, v110, v110 row_ror:4 row_mask:0xf bank_mask:0xf
    v_add_f32_dpp v111, v111, v111 row_ror:4 row_mask:0xf bank_mask:0xf
    ds_write_b128 v94, v[108:111] offset:64
    v_mfma_f32_16x16x32_bf16 v[68:71], a[176:179], v[20:23], 0
    v_mfma_f32_16x16x32_bf16 v[72:75], a[176:179], v[36:39], 0
    v_mfma_f32_16x16x32_bf16 v[68:71], a[180:183], v[24:27], v[68:71]
    v_mfma_f32_16x16x32_bf16 v[72:75], a[180:183], v[40:43], v[72:75]
    v_mfma_f32_16x16x32_bf16 v[68:71], a[184:187], v[28:31], v[68:71]
    v_mfma_f32_16x16x32_bf16 v[72:75], a[184:187], v[44:47], v[72:75]
    v_mfma_f32_16x16x32_bf16 v[68:71], a[188:191], v[32:35], v[68:71]
    v_mfma_f32_16x16x32_bf16 v[72:75], a[188:191], v[48:51], v[72:75]
    v_mul_f32 v104, v60, v52
    v_mul_f32 v105, v61, v52
    v_mul_f32 v106, v62, v52
    v_mul_f32 v107, v63, v52
    v_fmac_f32 v104, v64, v54
    v_fmac_f32 v105, v65, v54
    v_fmac_f32 v106, v66, v54
    v_fmac_f32 v107, v67, v54
    v_add_f32_dpp v104, v104, v104 row_ror:8 row_mask:0xf bank_mask:0xf
    v_add_f32_dpp v105, v105, v105 row_ror:8 row_mask:0xf bank_mask:0xf
    v_add_f32_dpp v106, v106, v106 row_ror:8 row_mask:0xf bank_mask:0xf
    v_add_f32_dpp v107, v107, v107 row_ror:8 row_mask:0xf bank_mask:0xf
    v_add_f32_dpp v104, v104, v104 row_ror:4 row_mask:0xf bank_mask:0xf
    v_add_f32_dpp v105, v105, v105 row_ror:4 row_mask:0xf bank_mask:0xf
    v_add_f32_dpp v106, v106, v106 row_ror:4 row_mask:0xf bank_mask:0xf
    v_add_f32_dpp v107, v107, v107 row_ror:4 row_mask:0xf bank_mask:0xf
    ds_write_b128 v94, v[104:107] offset:128
    v_mfma_f32_16x16x32_bf16 v[60:63], a[192:195], v[20:23], 0
    v_mfma_f32_16x16x32_bf16 v[64:67], a[192:195], v[36:39], 0
    v_mfma_f32_16x16x32_bf16 v[60:63], a[196:199], v[24:27], v[60:63]
    v_mfma_f32_16x16x32_bf16 v[64:67], a[196:199], v[40:43], v[64:67]
    v_mfma_f32_16x16x32_bf16 v[60:63], a[200:203], v[28:31], v[60:63]
    v_mfma_f32_16x16x32_bf16 v[64:67], a[200:203], v[44:47], v[64:67]
    v_mfma_f32_16x16x32_bf16 v[60:63], a[204:207], v[32:35], v[60:63]
    v_mfma_f32_16x16x32_bf16 v[64:67], a[204:207], v[48:51], v[64:67]
    v_mul_f32 v108, v68, v52
    v_mul_f32 v109, v69, v52
    v_mul_f32 v110, v70, v52
    v_mul_f32 v111, v71, v52
    v_fmac_f32 v108, v72, v54
    v_fmac_f32 v109, v73, v54
    v_fmac_f32 v110, v74, v54
    v_fmac_f32 v111, v75, v54
    v_add_f32_dpp v108, v108, v108 row_ror:8 row_mask:0xf bank_mask:0xf
    v_add_f32_dpp v109, v109, v109 row_ror:8 row_mask:0xf bank_mask:0xf
    v_add_f32_dpp v110, v110, v110 row_ror:8 row_mask:0xf bank_mask:0xf
    v_add_f32_dpp v111, v111, v111 row_ror:8 row_mask:0xf bank_mask:0xf
    v_add_f32_dpp v108, v108, v108 row_ror:4 row_mask:0xf bank_mask:0xf
    v_add_f32_dpp v109, v109, v109 row_ror:4 row_mask:0xf bank_mask:0xf
    v_add_f32_dpp v110, v110, v110 row_ror:4 row_mask:0xf bank_mask:0xf
    v_add_f32_dpp v111, v111, v111 row_ror:4 row_mask:0xf bank_mask:0xf
    ds_write_b128 v94, v[108:111] offset:192
    v_mfma_f32_16x16x32_bf16 v[68:71], a[208:211], v[20:23], 0
    v_mfma_f32_16x16x32_bf16 v[72:75], a[208:211], v[36:39], 0
    v_mfma_f32_16x16x32_bf16 v[68:71], a[212:215], v[24:27], v[68:71]
    v_mfma_f32_16x16x32_bf16 v[72:75], a[212:215], v[40:43], v[72:75]
    v_mfma_f32_16x16x32_bf16 v[68:71], a[216:219], v[28:31], v[68:71]
    v_mfma_f32_16x16x32_bf16 v[72:75], a[216:219], v[44:47], v[72:75]
    v_mfma_f32_16x16x32_bf16 v[68:71], a[220:223], v[32:35], v[68:71]
    v_mfma_f32_16x16x32_bf16 v[72:75], a[220:223], v[48:51], v[72:75]
    v_mul_f32 v104, v60, v52
    v_mul_f32 v105, v61, v52
    v_mul_f32 v106, v62, v52
    v_mul_f32 v107, v63, v52
    v_fmac_f32 v104, v64, v54
    v_fmac_f32 v105, v65, v54
    v_fmac_f32 v106, v66, v54
    v_fmac_f32 v107, v67, v54
    v_add_f32_dpp v104, v104, v104 row_ror:8 row_mask:0xf bank_mask:0xf
    v_add_f32_dpp v105, v105, v105 row_ror:8 row_mask:0xf bank_mask:0xf
    v_add_f32_dpp v106, v106, v106 row_ror:8 row_mask:0xf bank_mask:0xf
    v_add_f32_dpp v107, v107, v107 row_ror:8 row_mask:0xf bank_mask:0xf
    v_add_f32_dpp v104, v104, v104 row_ror:4 row_mask:0xf bank_mask:0xf
    v_add_f32_dpp v105, v105, v105 row_ror:4 row_mask:0xf bank_mask:0xf
    v_add_f32_dpp v106, v106, v106 row_ror:4 row_mask:0xf bank_mask:0xf
    v_add_f32_dpp v107, v107, v107 row_ror:4 row_mask:0xf bank_mask:0xf
    ds_write_b128 v94, v[104:107] offset:256
    v_mfma_f32_16x16x32_bf16 v[60:63], a[224:227], v[20:23], 0
    v_mfma_f32_16x16x32_bf16 v[64:67], a[224:227], v[36:39], 0
    v_mfma_f32_16x16x32_bf16 v[60:63], a[228:231], v[24:27], v[60:63]
    v_mfma_f32_16x16x32_bf16 v[64:67], a[228:231], v[40:43], v[64:67]
    v_mfma_f32_16x16x32_bf16 v[60:63], a[232:235], v[28:31], v[60:63]
    v_mfma_f32_16x16x32_bf16 v[64:67], a[232:235], v[44:47], v[64:67]
    v_mfma_f32_16x16x32_bf16 v[60:63], a[236:239], v[32:35], v[60:63]
    v_mfma_f32_16x16x32_bf16 v[64:67], a[236:239], v[48:51], v[64:67]
    v_mul_f32 v108, v68, v52
    v_mul_f32 v109, v69, v52
    v_mul_f32 v110, v70, v52
    v_mul_f32 v111, v71, v52
    v_fmac_f32 v108, v72, v54
    v_fmac_f32 v109, v73, v54
    v_fmac_f32 v110, v74, v54
    v_fmac_f32 v111, v75, v54
    v_add_f32_dpp v108, v108, v108 row_ror:8 row_mask:0xf bank_mask:0xf
    v_add_f32_dpp v109, v109, v109 row_ror:8 row_mask:0xf bank_mask:0xf
    v_add_f32_dpp v110, v110, v110 row_ror:8 row_mask:0xf bank_mask:0xf
    v_add_f32_dpp v111, v111, v111 row_ror:8 row_mask:0xf bank_mask:0xf
    v_add_f32_dpp v108, v108, v108 row_ror:4 row_mask:0xf bank_mask:0xf
    v_add_f32_dpp v109, v109, v109 row_ror:4 row_mask:0xf bank_mask:0xf
    v_add_f32_dpp v110, v110, v110 row_ror:4 row_mask:0xf bank_mask:0xf
    v_add_f32_dpp v111, v111, v111 row_ror:4 row_mask:0xf bank_mask:0xf
    ds_write_b128 v94, v[108:111] offset:320
    v_mfma_f32_16x16x32_bf16 v[68:71], a[240:243], v[20:23], 0
    v_mfma_f32_16x16x32_bf16 v[72:75], a[240:243], v[36:39], 0
    v_mfma_f32_16x16x32_bf16 v[68:71], a[244:247], v[24:27], v[68:71]
    v_mfma_f32_16x16x32_bf16 v[72:75], a[244:247], v[40:43], v[72:75]
    v_mfma_f32_16x16x32_bf16 v[68:71], a[248:251], v[28:31], v[68:71]
    v_mfma_f32_16x16x32_bf16 v[72:75], a[248:251], v[44:47], v[72:75]
    v_mfma_f32_16x16x32_bf16 v[68:71], a[252:255], v[32:35], v[68:71]
    v_mfma_f32_16x16x32_bf16 v[72:75], a[252:255], v[48:51], v[72:75]
    v_mul_f32 v104, v60, v52
    v_mul_f32 v105, v61, v52
    v_mul_f32 v106, v62, v52
    v_mul_f32 v107, v63, v52
    v_fmac_f32 v104, v64, v54
    v_fmac_f32 v105, v65, v54
    v_fmac_f32 v106, v66, v54
    v_fmac_f32 v107, v67, v54
    v_add_f32_dpp v104, v104, v104 row_ror:8 row_mask:0xf bank_mask:0xf
    v_add_f32_dpp v105, v105, v105 row_ror:8 row_mask:0xf bank_mask:0xf
    v_add_f32_dpp v106, v106, v106 row_ror:8 row_mask:0xf bank_mask:0xf
    v_add_f32_dpp v107, v107, v107 row_ror:8 row_mask:0xf bank_mask:0xf
    v_add_f32_dpp v104, v104, v104 row_ror:4 row_mask:0xf bank_mask:0xf
    v_add_f32_dpp v105, v105, v105 row_ror:4 row_mask:0xf bank_mask:0xf
    v_add_f32_dpp v106, v106, v106 row_ror:4 row_mask:0xf bank_mask:0xf
    v_add_f32_dpp v107, v107, v107 row_ror:4 row_mask:0xf bank_mask:0xf
    ds_write_b128 v94, v[104:107] offset:384
    v_mul_f32 v108, v68, v52
    v_mul_f32 v109, v69, v52
    v_mul_f32 v110, v70, v52
    v_mul_f32 v111, v71, v52
    v_fmac_f32 v108, v72, v54
    v_fmac_f32 v109, v73, v54
    v_fmac_f32 v110, v74, v54
    v_fmac_f32 v111, v75, v54
    v_add_f32_dpp v108, v108, v108 row_ror:8 row_mask:0xf bank_mask:0xf
    v_add_f32_dpp v109, v109, v109 row_ror:8 row_mask:0xf bank_mask:0xf
    v_add_f32_dpp v110, v110, v110 row_ror:8 row_mask:0xf bank_mask:0xf
    v_add_f32_dpp v111, v111, v111 row_ror:8 row_mask:0xf bank_mask:0xf
    v_add_f32_dpp v108, v108, v108 row_ror:4 row_mask:0xf bank_mask:0xf
    v_add_f32_dpp v109, v109, v109 row_ror:4 row_mask:0xf bank_mask:0xf
    v_add_f32_dpp v110, v110, v110 row_ror:4 row_mask:0xf bank_mask:0xf
    v_add_f32_dpp v111, v111, v111 row_ror:4 row_mask:0xf bank_mask:0xf
    ds_write_b128 v94, v[108:111] offset:448
    s_waitcnt lgkmcnt(0)
    s_barrier
    ds_read_b128 v[20:23], v96 offset:0
    ds_read_b128 v[24:27], v96 offset:2048
    ds_read_b128 v[28:31], v96 offset:4096
    ds_read_b128 v[32:35], v96 offset:6144
    s_waitcnt lgkmcnt(0)
    v_add_f32 v20, v20, v24
    v_add_f32 v28, v28, v32
    v_add_f32 v21, v21, v25
    v_add_f32 v29, v29, v33
    v_add_f32 v22, v22, v26
    v_add_f32 v30, v30, v34
    v_add_f32 v23, v23, v27
    v_add_f32 v31, v31, v35
    v_add_f32 v20, v20, v28
    v_add_f32 v21, v21, v29
    v_add_f32 v22, v22, v30
    v_add_f32 v23, v23, v31
    v_cvt_pk_bf16_f32 v20, v20, v21
    v_cvt_pk_bf16_f32 v21, v22, v23
    ds_write_b64 v97, v[20:21]
L_final:
    s_waitcnt lgkmcnt(0)
    s_barrier
    s_mov_b32 exec_lo, 0xf000f
    s_mov_b32 exec_hi, 0xf000f
    ds_read_b128 v[136:139], v76 offset:0
    ds_read_b128 v[140:143], v76 offset:64
    ds_read_b128 v[144:147], v76 offset:128
    ds_read_b128 v[148:151], v76 offset:192
    s_mov_b32 exec_lo, 0xf000f0
    s_mov_b32 exec_hi, 0xf000f0
    ds_read_b128 v[152:155], v76 offset:0
    ds_read_b128 v[156:159], v76 offset:64
    ds_read_b128 v[160:163], v76 offset:128
    ds_read_b128 v[164:167], v76 offset:192
    s_mov_b32 exec_lo, 0xf000f00
    s_mov_b32 exec_hi, 0xf000f00
    ds_read_b128 v[168:171], v76 offset:0
    ds_read_b128 v[172:175], v76 offset:64
    ds_read_b128 v[176:179], v76 offset:128
    ds_read_b128 v[180:183], v76 offset:192
    s_mov_b32 exec_lo, 0xf000f000
    s_mov_b32 exec_hi, 0xf000f000
    ds_read_b128 v[184:187], v76 offset:0
    ds_read_b128 v[188:191], v76 offset:64
    ds_read_b128 v[192:195], v76 offset:128
    ds_read_b128 v[196:199], v76 offset:192
    s_mov_b64 exec, -1
    s_add_u32 s36, s96, 32768
    s_waitcnt lgkmcnt(12)
    v_mfma_f32_16x16x32_bf16 v[84:87], a[0:3], v[136:139], 0
    v_mfma_f32_16x16x32_bf16 v[88:91], a[64:67], v[136:139], 0
    v_mfma_f32_16x16x32_bf16 v[84:87], a[4:7], v[140:143], v[84:87]
    v_mfma_f32_16x16x32_bf16 v[88:91], a[68:71], v[140:143], v[88:91]
    v_mfma_f32_16x16x32_bf16 v[84:87], a[8:11], v[144:147], v[84:87]
    v_mfma_f32_16x16x32_bf16 v[88:91], a[72:75], v[144:147], v[88:91]
    v_mfma_f32_16x16x32_bf16 v[84:87], a[12:15], v[148:151], v[84:87]
    v_mfma_f32_16x16x32_bf16 v[88:91], a[76:79], v[148:151], v[88:91]
    s_waitcnt lgkmcnt(8)
    v_mfma_f32_16x16x32_bf16 v[84:87], a[16:19], v[152:155], v[84:87]
    v_mfma_f32_16x16x32_bf16 v[88:91], a[80:83], v[152:155], v[88:91]
    v_mfma_f32_16x16x32_bf16 v[84:87], a[20:23], v[156:159], v[84:87]
    v_mfma_f32_16x16x32_bf16 v[88:91], a[84:87], v[156:159], v[88:91]
    v_mfma_f32_16x16x32_bf16 v[84:87], a[24:27], v[160:163], v[84:87]
    v_mfma_f32_16x16x32_bf16 v[88:91], a[88:91], v[160:163], v[88:91]
    v_mfma_f32_16x16x32_bf16 v[84:87], a[28:31], v[164:167], v[84:87]
    v_mfma_f32_16x16x32_bf16 v[88:91], a[92:95], v[164:167], v[88:91]
    s_waitcnt lgkmcnt(4)
    v_mfma_f32_16x16x32_bf16 v[84:87], a[32:35], v[168:171], v[84:87]
    v_mfma_f32_16x16x32_bf16 v[88:91], a[96:99], v[168:171], v[88:91]
    v_mfma_f32_16x16x32_bf16 v[84:87], a[36:39], v[172:175], v[84:87]
    v_mfma_f32_16x16x32_bf16 v[88:91], a[100:103], v[172:175], v[88:91]
    v_mfma_f32_16x16x32_bf16 v[84:87], a[40:43], v[176:179], v[84:87]
    v_mfma_f32_16x16x32_bf16 v[88:91], a[104:107], v[176:179], v[88:91]
    v_mfma_f32_16x16x32_bf16 v[84:87], a[44:47], v[180:183], v[84:87]
    v_mfma_f32_16x16x32_bf16 v[88:91], a[108:111], v[180:183], v[88:91]
    s_waitcnt lgkmcnt(0)
    v_mfma_f32_16x16x32_bf16 v[84:87], a[48:51], v[184:187], v[84:87]
    v_mfma_f32_16x16x32_bf16 v[88:91], a[112:115], v[184:187], v[88:91]
    v_mfma_f32_16x16x32_bf16 v[84:87], a[52:55], v[188:191], v[84:87]
    v_mfma_f32_16x16x32_bf16 v[88:91], a[116:119], v[188:191], v[88:91]
    v_mfma_f32_16x16x32_bf16 v[84:87], a[56:59], v[192:195], v[84:87]
    v_mfma_f32_16x16x32_bf16 v[88:91], a[120:123], v[192:195], v[88:91]
    v_mfma_f32_16x16x32_bf16 v[84:87], a[60:63], v[196:199], v[84:87]
    v_mfma_f32_16x16x32_bf16 v[88:91], a[124:127], v[196:199], v[88:91]
    s_nop 6
    v_and_or_b32 v84, v84, s82, v8
    v_and_or_b32 v85, v85, s82, v8
    v_and_or_b32 v86, v86, s82, v8
    v_and_or_b32 v87, v87, s82, v8
    buffer_store_dwordx4 v[84:87], v77, s[48:51], s96 offen sc1
    v_and_or_b32 v88, v88, s82, v8
    v_and_or_b32 v89, v89, s82, v8
    v_and_or_b32 v90, v90, s82, v8
    v_and_or_b32 v91, v91, s82, v8
    buffer_store_dwordx4 v[88:91], v77, s[48:51], s36 offen sc1
    s_cmp_eq_u32 s92, 0
    s_cbranch_scc1 L_prepb
L_hop2:
    s_add_u32 s36, s96, 4096
    buffer_load_dwordx4 v[104:107], v78, s[48:51], s96 offen sc1
    buffer_load_dwordx4 v[108:111], v78, s[48:51], s36 offen sc1
    s_waitcnt vmcnt(0)
    v_xor_b32 v104, s35, v104
    v_xor_b32 v105, s35, v105
    v_xor_b32 v106, s35, v106
    v_xor_b32 v107, s35, v107
    v_xor_b32 v108, s35, v108
    v_xor_b32 v109, s35, v109
    v_xor_b32 v110, s35, v110
    v_xor_b32 v111, s35, v111
    v_or_b32 v4, v104, v105
    v_or3_b32 v4, v4, v106, v107
    v_or3_b32 v4, v4, v108, v109
    v_or3_b32 v4, v4, v110, v111
    v_and_b32 v4, 0xff, v4
    v_cmp_ne_u32 vcc, 0, v4
    s_cbranch_vccz L_hop2ok
    s_sub_u32 s84, s84, 1
    s_cmp_lg_u32 s84, 0
    s_cbranch_scc1 L_hop2
    s_branch L_end
L_hop2ok:
    v_add_f32 v104, v104, v108
    v_add_f32 v105, v105, v109
    v_add_f32 v106, v106, v110
    v_add_f32 v107, v107, v111
    v_permlane16_swap_b32 v104, v105
    s_nop 0
    v_permlane16_swap_b32 v106, v107
    v_add_f32 v104, v104, v105
    v_add_f32 v106, v106, v107
    s_nop 1
    v_permlane32_swap_b32 v104, v106
    v_add_f32 v104, v104, v106
    s_nop 1
    v_add_f32_dpp v104, v104, v104 row_ror:8 row_mask:0xf bank_mask:0xf
    s_nop 1
    v_add_f32_dpp v104, v104, v104 row_ror:4 row_mask:0xf bank_mask:0xf
    v_cvt_pk_bf16_f32 v104, v104, v104
    s_mov_b32 exec_lo, 0xf000f
    s_mov_b32 exec_hi, 0xf000f
    buffer_store_short v104, v79, s[72:75], s97 offen
    s_mov_b64 exec, -1
    s_cmp_lg_u32 s92, 0
    s_cbranch_scc1 L_fin
    s_mov_b32 s92, 1
    s_mov_b32 s96, 3670016
    s_mov_b32 s97, 1024
    s_lshl_b32 s85, s32, 2
    s_add_u32 s85, s85, s34
    s_lshl_b32 s85, s85, 13
    s_add_u32 s85, s85, 5242880
    s_add_u32 s86, s85, 4096
    v_min_u32 v5, 6, v1
    v_lshlrev_b32 v5, 10, v5
L_light:
    buffer_load_dword v6, v5, s[48:51], s85 offen offset:512 sc1
    s_waitcnt vmcnt(0)
    v_xor_b32 v6, s35, v6
    v_and_b32 v6, 0xff, v6
    v_cmp_ne_u32 vcc, 0, v6
    s_nop 0
    s_and_b32 s36, vcc_lo, 0x7f
    s_bcnt1_i32_b32 s36, s36
    s_cmp_le_u32 s36, 2
    s_cbranch_scc1 L_hop1
    s_sleep 2
    s_sub_u32 s84, s84, 1
    s_cmp_lg_u32 s84, 0
    s_cbranch_scc1 L_light
    s_branch L_end
L_hop1:
    buffer_load_dwordx4 v[20:23], v92, s[48:51], s85 offen offset:0 sc1
    buffer_load_dwordx4 v[24:27], v92, s[48:51], s85 offen offset:1024 sc1
    buffer_load_dwordx4 v[28:31], v92, s[48:51], s85 offen offset:2048 sc1
    buffer_load_dwordx4 v[32:35], v92, s[48:51], s85 offen offset:3072 sc1
    buffer_load_dwordx4 v[36:39], v92, s[48:51], s86 offen offset:0 sc1
    buffer_load_dwordx4 v[40:43], v92, s[48:51], s86 offen offset:1024 sc1
    buffer_load_dwordx4 v[44:47], v92, s[48:51], s86 offen offset:2048 sc1
    s_waitcnt vmcnt(0)
    v_xor_b32 v20, s35, v20
    v_xor_b32 v21, s35, v21
    v_xor_b32 v22, s35, v22
    v_xor_b32 v23, s35, v23
    v_xor_b32 v24, s35, v24
    v_xor_b32 v25, s35, v25
    v_xor_b32 v26, s35, v26
    v_xor_b32 v27, s35, v27
    v_xor_b32 v28, s35, v28
    v_xor_b32 v29, s35, v29
    v_xor_b32 v30, s35, v30
    v_xor_b32 v31, s35, v31
    v_xor_b32 v32, s35, v32
    v_xor_b32 v33, s35, v33
    v_xor_b32 v34, s35, v34
    v_xor_b32 v35, s35, v35
    v_xor_b32 v36, s35, v36
    v_xor_b32 v37, s35, v37
    v_xor_b32 v38, s35, v38
    v_xor_b32 v39, s35, v39
    v_xor_b32 v40, s35, v40
    v_xor_b32 v41, s35, v41
    v_xor_b32 v42, s35, v42
    v_xor_b32 v43, s35, v43
    v_xor_b32 v44, s35, v44
    v_xor_b32 v45, s35, v45
    v_xor_b32 v46, s35, v46
    v_xor_b32 v47, s35, v47
    v_or_b32 v4, v20, v21
    v_or3_b32 v4, v4, v22, v23
    v_or3_b32 v4, v4, v24, v25
    v_or3_b32 v4, v4, v26, v27
    v_or3_b32 v4, v4, v28, v29
    v_or3_b32 v4, v4, v30, v31
    v_or3_b32 v4, v4, v32, v33
    v_or3_b32 v4, v4, v34, v35
    v_or3_b32 v4, v4, v36, v37
    v_or3_b32 v4, v4, v38, v39
    v_or3_b32 v4, v4, v40, v41
    v_or3_b32 v4, v4, v42, v43
    v_or3_b32 v4, v4, v44, v45
    v_or3_b32 v4, v4, v46, v47
    v_and_b32 v4, 0xff, v4
    v_cmp_ne_u32 vcc, 0, v4
    s_cbranch_vccz L_hop1ok
    s_sub_u32 s84, s84, 1
    s_cmp_lg_u32 s84, 0
    s_cbranch_scc1 L_hop1
    s_branch L_end
L_hop1ok:
    v_max3_f32 v55, v20, v24, v28
    v_max3_f32 v55, v55, v32, v36
    v_max3_f32 v55, v55, v40, v44
    v_sub_f32 v48, v20, v55
    v_sub_f32 v49, v24, v55
    v_sub_f32 v50, v28, v55
    v_sub_f32 v51, v32, v55
    v_sub_f32 v52, v36, v55
    v_sub_f32 v53, v40, v55
    v_sub_f32 v54, v44, v55
    v_exp_f32 v48, v48
    v_exp_f32 v49, v49
    v_exp_f32 v50, v50
    v_exp_f32 v51, v51
    v_exp_f32 v52, v52
    v_exp_f32 v53, v53
    v_exp_f32 v54, v54
    v_mul_f32_dpp v57, v48, v21 row_newbcast:8 row_mask:0xf bank_mask:0xf
    v_mul_f32_dpp v56, v48, v20 row_newbcast:8 row_mask:0xf bank_mask:0xf
    v_mul_f32_dpp v58, v48, v22 row_newbcast:8 row_mask:0xf bank_mask:0xf
    v_mul_f32_dpp v59, v48, v23 row_newbcast:8 row_mask:0xf bank_mask:0xf
    v_fmac_f32_dpp v57, v49, v25 row_newbcast:8 row_mask:0xf bank_mask:0xf
    v_fmac_f32_dpp v56, v49, v24 row_newbcast:8 row_mask:0xf bank_mask:0xf
    v_fmac_f32_dpp v58, v49, v26 row_newbcast:8 row_mask:0xf bank_mask:0xf
    v_fmac_f32_dpp v59, v49, v27 row_newbcast:8 row_mask:0xf bank_mask:0xf
    v_fmac_f32_dpp v57, v50, v29 row_newbcast:8 row_mask:0xf bank_mask:0xf
    v_fmac_f32_dpp v56, v50, v28 row_newbcast:8 row_mask:0xf bank_mask:0xf
    v_fmac_f32_dpp v58, v50, v30 row_newbcast:8 row_mask:0xf bank_mask:0xf
    v_fmac_f32_dpp v59, v50, v31 row_newbcast:8 row_mask:0xf bank_mask:0xf
    v_fmac_f32_dpp v57, v51, v33 row_newbcast:8 row_mask:0xf bank_mask:0xf
    v_fmac_f32_dpp v56, v51, v32 row_newbcast:8 row_mask:0xf bank_mask:0xf
    v_fmac_f32_dpp v58, v51, v34 row_newbcast:8 row_mask:0xf bank_mask:0xf
    v_fmac_f32_dpp v59, v51, v35 row_newbcast:8 row_mask:0xf bank_mask:0xf
    v_fmac_f32_dpp v57, v52, v37 row_newbcast:8 row_mask:0xf bank_mask:0xf
    v_fmac_f32_dpp v56, v52, v36 row_newbcast:8 row_mask:0xf bank_mask:0xf
    v_fmac_f32_dpp v58, v52, v38 row_newbcast:8 row_mask:0xf bank_mask:0xf
    v_fmac_f32_dpp v59, v52, v39 row_newbcast:8 row_mask:0xf bank_mask:0xf
    v_fmac_f32_dpp v57, v53, v41 row_newbcast:8 row_mask:0xf bank_mask:0xf
    v_fmac_f32_dpp v56, v53, v40 row_newbcast:8 row_mask:0xf bank_mask:0xf
    v_fmac_f32_dpp v58, v53, v42 row_newbcast:8 row_mask:0xf bank_mask:0xf
    v_fmac_f32_dpp v59, v53, v43 row_newbcast:8 row_mask:0xf bank_mask:0xf
    v_fmac_f32_dpp v57, v54, v45 row_newbcast:8 row_mask:0xf bank_mask:0xf
    v_fmac_f32_dpp v56, v54, v44 row_newbcast:8 row_mask:0xf bank_mask:0xf
    v_fmac_f32_dpp v58, v54, v46 row_newbcast:8 row_mask:0xf bank_mask:0xf
    v_fmac_f32_dpp v59, v54, v47 row_newbcast:8 row_mask:0xf bank_mask:0xf
    v_rcp_f32 v55, v57
    s_nop 1
    v_mul_f32_dpp v56, v55, v56 row_newbcast:8 row_mask:0xf bank_mask:0xf
    v_mul_f32_dpp v57, v55, v57 row_newbcast:8 row_mask:0xf bank_mask:0xf
    v_mul_f32_dpp v58, v55, v58 row_newbcast:8 row_mask:0xf bank_mask:0xf
    v_mul_f32_dpp v59, v55, v59 row_newbcast:8 row_mask:0xf bank_mask:0xf
    v_cvt_pk_bf16_f32 v56, v56, v57
    v_cvt_pk_bf16_f32 v58, v58, v59
    s_mov_b32 exec_lo, 0xff00ff
    s_mov_b32 exec_hi, 0xff00ff
    ds_write_b16 v93, v56
    ds_write_b16_d16_hi v93, v56 offset:16
    ds_write_b16 v93, v58 offset:32
    ds_write_b16_d16_hi v93, v58 offset:48
    s_mov_b64 exec, -1
    s_branch L_final
L_prepb:
    v_xor_b32 v4, 0, v95
    ds_read_b64_tr_b16 a[0:1], v4 offset:0
    ds_read_b64_tr_b16 a[4:5], v4 offset:8192
    ds_read_b64_tr_b16 a[8:9], v4 offset:16384
    ds_read_b64_tr_b16 a[12:13], v4 offset:24576
    v_xor_b32 v5, 16, v95
    ds_read_b64_tr_b16 a[2:3], v5 offset:1024
    ds_read_b64_tr_b16 a[6:7], v5 offset:9216
    ds_read_b64_tr_b16 a[10:11], v5 offset:17408
    ds_read_b64_tr_b16 a[14:15], v5 offset:25600
    v_xor_b32 v4, 32, v95
    ds_read_b64_tr_b16 a[16:17], v4 offset:0
    ds_read_b64_tr_b16 a[20:21], v4 offset:8192
    ds_read_b64_tr_b16 a[24:25], v4 offset:16384
    ds_read_b64_tr_b16 a[28:29], v4 offset:24576
    v_xor_b32 v5, 48, v95
    ds_read_b64_tr_b16 a[18:19], v5 offset:1024
    ds_read_b64_tr_b16 a[22:23], v5 offset:9216
    ds_read_b64_tr_b16 a[26:27], v5 offset:17408
    ds_read_b64_tr_b16 a[30:31], v5 offset:25600
    v_xor_b32 v4, 64, v95
    ds_read_b64_tr_b16 a[32:33], v4 offset:0
    ds_read_b64_tr_b16 a[36:37], v4 offset:8192
    ds_read_b64_tr_b16 a[40:41], v4 offset:16384
    ds_read_b64_tr_b16 a[44:45], v4 offset:24576
    v_xor_b32 v5, 80, v95
    ds_read_b64_tr_b16 a[34:35], v5 offset:1024
    ds_read_b64_tr_b16 a[38:39], v5 offset:9216
    ds_read_b64_tr_b16 a[42:43], v5 offset:17408
    ds_read_b64_tr_b16 a[46:47], v5 offset:25600
    v_xor_b32 v4, 96, v95
    ds_read_b64_tr_b16 a[48:49], v4 offset:0
    ds_read_b64_tr_b16 a[52:53], v4 offset:8192
    ds_read_b64_tr_b16 a[56:57], v4 offset:16384
    ds_read_b64_tr_b16 a[60:61], v4 offset:24576
    v_xor_b32 v5, 112, v95
    ds_read_b64_tr_b16 a[50:51], v5 offset:1024
    ds_read_b64_tr_b16 a[54:55], v5 offset:9216
    ds_read_b64_tr_b16 a[58:59], v5 offset:17408
    ds_read_b64_tr_b16 a[62:63], v5 offset:25600
    v_xor_b32 v4, 128, v95
    ds_read_b64_tr_b16 a[64:65], v4 offset:0
    ds_read_b64_tr_b16 a[68:69], v4 offset:8192
    ds_read_b64_tr_b16 a[72:73], v4 offset:16384
    ds_read_b64_tr_b16 a[76:77], v4 offset:24576
    v_xor_b32 v5, 144, v95
    ds_read_b64_tr_b16 a[66:67], v5 offset:1024
    ds_read_b64_tr_b16 a[70:71], v5 offset:9216
    ds_read_b64_tr_b16 a[74:75], v5 offset:17408
    ds_read_b64_tr_b16 a[78:79], v5 offset:25600
    v_xor_b32 v4, 160, v95
    ds_read_b64_tr_b16 a[80:81], v4 offset:0
    ds_read_b64_tr_b16 a[84:85], v4 offset:8192
    ds_read_b64_tr_b16 a[88:89], v4 offset:16384
    ds_read_b64_tr_b16 a[92:93], v4 offset:24576
    v_xor_b32 v5, 176, v95
    ds_read_b64_tr_b16 a[82:83], v5 offset:1024
    ds_read_b64_tr_b16 a[86:87], v5 offset:9216
    ds_read_b64_tr_b16 a[90:91], v5 offset:17408
    ds_read_b64_tr_b16 a[94:95], v5 offset:25600
    v_xor_b32 v4, 192, v95
    ds_read_b64_tr_b16 a[96:97], v4 offset:0
    ds_read_b64_tr_b16 a[100:101], v4 offset:8192
    ds_read_b64_tr_b16 a[104:105], v4 offset:16384
    ds_read_b64_tr_b16 a[108:109], v4 offset:24576
    v_xor_b32 v5, 208, v95
    ds_read_b64_tr_b16 a[98:99], v5 offset:1024
    ds_read_b64_tr_b16 a[102:103], v5 offset:9216
    ds_read_b64_tr_b16 a[106:107], v5 offset:17408
    ds_read_b64_tr_b16 a[110:111], v5 offset:25600
    v_xor_b32 v4, 224, v95
    ds_read_b64_tr_b16 a[112:113], v4 offset:0
    ds_read_b64_tr_b16 a[116:117], v4 offset:8192
    ds_read_b64_tr_b16 a[120:121], v4 offset:16384
    ds_read_b64_tr_b16 a[124:125], v4 offset:24576
    v_xor_b32 v5, 240, v95
    ds_read_b64_tr_b16 a[114:115], v5 offset:1024
    ds_read_b64_tr_b16 a[118:119], v5 offset:9216
    ds_read_b64_tr_b16 a[122:123], v5 offset:17408
    ds_read_b64_tr_b16 a[126:127], v5 offset:25600
    s_waitcnt lgkmcnt(0)
    s_barrier
    s_branch L_hop2
L_fin:
    s_or_b32 s36, s32, s34
    s_cmp_lg_u32 s36, 0
    s_cbranch_scc1 L_end
    s_mov_b64 exec, 1
    buffer_store_dword v8, v100, s[48:51], 0 offen
L_end:
    s_endpgm
    .fill (32768 - (. - L_pc)) / 4 + 1, 4, 0xbf810000
.section .rodata,"a"
.p2align 6
.amdhsa_kernel concat_heads__compressed_kv_cla__mha_block_cached__decode_kernel
  .amdhsa_next_free_vgpr 512
  .amdhsa_next_free_sgpr 102
  .amdhsa_accum_offset 256
  .amdhsa_group_segment_fixed_size 0
  .amdhsa_kernarg_size 112
  .amdhsa_user_sgpr_count 2
  .amdhsa_user_sgpr_kernarg_segment_ptr 1
  .amdhsa_system_sgpr_workgroup_id_x 1
.end_amdhsa_kernel
```

```asm
; @launch grid=(256,1,1) block=(256,1,1) lds=163840
    .amdgcn_target "amdgcn-amd-amdhsa--gfx950"
    .text
    .globl concat_heads__compressed_kv_cla__mha_block_cached__decode_kernel
    .p2align 8
    .type concat_heads__compressed_kv_cla__mha_block_cached__decode_kernel,@function
concat_heads__compressed_kv_cla__mha_block_cached__decode_kernel:
    s_cmp_ge_u32 s2, 256
    s_cbranch_scc1 L_end
    s_load_dwordx16 s[4:19], s[0:1], 0
    s_load_dwordx8 s[20:27], s[0:1], 64
    s_load_dwordx4 s[28:31], s[0:1], 96
    v_lshrrev_b32 v4, 6, v0
    v_and_b32 v1, 63, v0
    v_readfirstlane_b32 s34, v4
    s_lshr_b32 s32, s2, 3
    s_sub_u32 s33, s2, s32
    s_sub_u32 s33, s33, 1
    s_and_b32 s33, s33, 7
    v_lshrrev_b32 v2, 4, v1
    v_and_b32 v3, 15, v1
    s_cmp_lt_u32 s33, 2
    s_cbranch_scc1 L_qp
    s_cmp_eq_u32 s33, 2
    s_cbranch_scc1 L_ql
    s_cmp_eq_u32 s33, 7
    s_cbranch_scc1 L_aux
    v_lshrrev_b32 v4, 2, v3
    v_and_b32 v5, 3, v3
    v_lshlrev_b32 v76, 8, v4
    v_lshlrev_b32 v126, 8, v2
    v_lshl_add_u32 v76, v2, 6, v76
    v_lshl_add_u32 v76, v5, 4, v76
    v_lshl_add_u32 v126, v3, 4, v126
    v_xor_b32 v77, 32768, v76
    v_xor_b32 v127, 32768, v126
    s_add_u32 s3, s34, s33
    s_and_b32 s3, s3, 3
    s_lshl_b32 s89, s3, 5
    s_add_u32 s89, s89, s32
    s_lshl_b32 s89, s89, 20
    s_mul_i32 s88, s32, 8
    s_add_u32 s88, s88, s3
    s_add_u32 s87, s33, 0
    s_mov_b32 s54, 134217728
    s_mov_b32 s55, 0x20000
    s_mov_b32 s58, 134217728
    s_mov_b32 s59, 0x20000
    s_add_u32 s39, s87, s88
    s_bfe_u32 s37, s39, 0x30000
    s_lshl_b32 s37, s37, 12
    s_add_u32 s85, s37, s89
    s_bfe_u32 s37, s39, 0x10003
    s_lshl_b32 s37, s37, 11
    s_add_u32 s85, s37, s85
    s_bfe_u32 s37, s39, 0x40004
    s_lshl_b32 s37, s37, 16
    s_add_u32 s85, s37, s85
    s_waitcnt lgkmcnt(0)
    s_mov_b64 s[52:53], s[18:19]
    s_mov_b64 s[56:57], s[20:21]
    buffer_load_dwordx4 v[128:131], v76, s[52:55], s85 offen offset:0 nt
    buffer_load_dwordx4 v[132:135], v77, s[52:55], s85 offen offset:0 nt
    buffer_load_dwordx4 v[136:139], v76, s[52:55], s85 offen offset:1024 nt
    buffer_load_dwordx4 v[140:143], v77, s[52:55], s85 offen offset:1024 nt
    buffer_load_dwordx4 v[144:147], v126, s[56:59], s85 offen offset:0 nt
    buffer_load_dwordx4 v[148:151], v127, s[56:59], s85 offen offset:0 nt
    buffer_load_dwordx4 v[152:155], v126, s[56:59], s85 offen offset:1024 nt
    s_getpc_b64 s[36:37]
L_pc_1:
    s_sub_u32 s36, s36, L_pc_1 - concat_heads__compressed_kv_cla__mha_block_cached__decode_kernel
    s_subb_u32 s37, s37, 0
    s_lshl_b32 s38, s32, 10
    v_lshl_add_u32 v6, v0, 2, s38
    v_mov_b32 v7, s37
    v_add_co_u32 v6, vcc, s36, v6
    s_nop 1
    v_addc_co_u32 v7, vcc, 0, v7, vcc
    global_load_dword v0, v[6:7], off
    s_load_dword s35, s[30:31], 0
    s_mov_b32 s48, s30
    s_and_b32 s49, s31, 0xffff
    s_mov_b32 s50, 8388608
    s_mov_b32 s51, 0x20000
    s_mov_b32 s82, 0xffffff00
    s_mov_b32 s83, 0x3e0293ee
    s_mov_b32 s84, 2097152
    s_waitcnt vmcnt(7)
    buffer_load_dwordx4 v[156:159], v127, s[56:59], s85 offen offset:1024 nt
    s_waitcnt vmcnt(7)
    s_add_u32 s87, s87, 7
    s_add_u32 s39, s87, s88
    s_bfe_u32 s37, s39, 0x30000
    s_lshl_b32 s37, s37, 12
    s_add_u32 s85, s37, s89
    s_bfe_u32 s37, s39, 0x10003
    s_lshl_b32 s37, s37, 11
    s_add_u32 s85, s37, s85
    s_bfe_u32 s37, s39, 0x40004
    s_lshl_b32 s37, s37, 16
    s_add_u32 s85, s37, s85
    buffer_load_dwordx4 v[160:163], v76, s[52:55], s85 offen offset:0 nt
    s_waitcnt vmcnt(7)
    buffer_load_dwordx4 v[164:167], v77, s[52:55], s85 offen offset:0 nt
    s_waitcnt vmcnt(7)
    buffer_load_dwordx4 v[168:171], v76, s[52:55], s85 offen offset:1024 nt
    v_and_b32 v4, 1, v1
    v_lshlrev_b32 v4, 4, v4
    v_mov_b32 v5, 0xffff
    v_lshlrev_b32 v4, v4, v5
    v_bfe_u32 v5, v1, 1, 2
    v_cmp_eq_u32 vcc, 0, v5
    s_nop 1
    v_cndmask_b32 v10, 0, v4, vcc
    v_cmp_eq_u32 vcc, 1, v5
    s_nop 1
    v_cndmask_b32 v11, 0, v4, vcc
    v_cmp_eq_u32 vcc, 2, v5
    s_nop 1
    v_cndmask_b32 v12, 0, v4, vcc
    v_cmp_eq_u32 vcc, 3, v5
    s_nop 1
    v_cndmask_b32 v13, 0, v4, vcc
    s_waitcnt vmcnt(7)
    buffer_load_dwordx4 v[172:175], v77, s[52:55], s85 offen offset:1024 nt
    s_waitcnt vmcnt(7)
    buffer_load_dwordx4 v[176:179], v126, s[56:59], s85 offen offset:0 nt
    s_waitcnt vmcnt(7)
    buffer_load_dwordx4 v[180:183], v127, s[56:59], s85 offen offset:0 nt
    s_waitcnt vmcnt(6)
    buffer_load_dwordx4 v[184:187], v126, s[56:59], s85 offen offset:1024 nt
    v_mov_b32 v120, 0xff7f0000
    v_mov_b32 v121, 0
    v_mov_b32 v18, 1
    v_mov_b32 v116, 0
    v_mov_b32 v117, 0
    v_mov_b32 v118, 0
    v_mov_b32 v119, 0
    s_lshl_b32 s38, s32, 2
    s_add_u32 s38, s38, s3
    s_lshl_b32 s96, s38, 3
    s_lshl_b32 s38, s38, 8
    s_add_u32 s38, s38, 65536
    v_mov_b32 v9, s38
    s_add_u32 s96, s96, s33
    s_lshl_b32 s96, s96, 10
    s_add_u32 s96, s96, 5242880
    v_and_b32 v5, 3, v3
    v_lshlrev_b32 v78, 7, v2
    v_lshl_add_u32 v78, v5, 5, v78
    s_lshl_b32 s91, s32, 12
    s_lshl_b32 s38, s3, 9
    s_add_u32 s91, s91, s38
    s_add_u32 s91, s91, 1048576
    v_lshlrev_b32 v4, 7, v2
    v_lshl_add_u32 v4, v3, 4, v4
    v_mov_b32 v5, 512
    v_cmp_gt_u32 vcc, 8, v3
    s_nop 1
    v_cndmask_b32 v79, v5, v4, vcc
    s_waitcnt vmcnt(6)
    buffer_load_dwordx4 v[188:191], v127, s[56:59], s85 offen offset:1024 nt
    s_waitcnt vmcnt(6)
    s_add_u32 s87, s87, 7
    s_add_u32 s39, s87, s88
    s_bfe_u32 s37, s39, 0x30000
    s_lshl_b32 s37, s37, 12
    s_add_u32 s85, s37, s89
    s_bfe_u32 s37, s39, 0x10003
    s_lshl_b32 s37, s37, 11
    s_add_u32 s85, s37, s85
    s_bfe_u32 s37, s39, 0x40004
    s_lshl_b32 s37, s37, 16
    s_add_u32 s85, s37, s85
    buffer_load_dwordx4 v[192:195], v76, s[52:55], s85 offen offset:0 nt
    s_waitcnt vmcnt(6)
    buffer_load_dwordx4 v[196:199], v77, s[52:55], s85 offen offset:0 nt
    s_waitcnt vmcnt(6)
    buffer_load_dwordx4 v[200:203], v76, s[52:55], s85 offen offset:1024 nt
    s_waitcnt vmcnt(6)
    buffer_load_dwordx4 v[204:207], v77, s[52:55], s85 offen offset:1024 nt
    s_waitcnt vmcnt(6)
    buffer_load_dwordx4 v[208:211], v126, s[56:59], s85 offen offset:0 nt
    s_waitcnt vmcnt(6)
    buffer_load_dwordx4 v[212:215], v127, s[56:59], s85 offen offset:0 nt
    s_waitcnt vmcnt(6)
    buffer_load_dwordx4 v[216:219], v126, s[56:59], s85 offen offset:1024 nt
    s_waitcnt vmcnt(6)
    buffer_load_dwordx4 v[220:223], v127, s[56:59], s85 offen offset:1024 nt
    s_waitcnt vmcnt(6)
    s_add_u32 s87, s87, 7
    s_add_u32 s39, s87, s88
    s_bfe_u32 s37, s39, 0x30000
    s_lshl_b32 s37, s37, 12
    s_add_u32 s85, s37, s89
    s_bfe_u32 s37, s39, 0x10003
    s_lshl_b32 s37, s37, 11
    s_add_u32 s85, s37, s85
    s_bfe_u32 s37, s39, 0x40004
    s_lshl_b32 s37, s37, 16
    s_add_u32 s85, s37, s85
    buffer_load_dwordx4 v[224:227], v76, s[52:55], s85 offen offset:0 nt
    s_waitcnt vmcnt(6)
    buffer_load_dwordx4 v[228:231], v77, s[52:55], s85 offen offset:0 nt
    s_waitcnt vmcnt(6)
    buffer_load_dwordx4 v[232:235], v76, s[52:55], s85 offen offset:1024 nt
    s_waitcnt vmcnt(6)
    buffer_load_dwordx4 v[236:239], v77, s[52:55], s85 offen offset:1024 nt
    s_waitcnt vmcnt(6)
    buffer_load_dwordx4 v[240:243], v126, s[56:59], s85 offen offset:0 nt
    s_waitcnt vmcnt(6)
    buffer_load_dwordx4 v[244:247], v127, s[56:59], s85 offen offset:0 nt
    s_waitcnt vmcnt(6)
    buffer_load_dwordx4 v[248:251], v126, s[56:59], s85 offen offset:1024 nt
    s_waitcnt vmcnt(6)
    buffer_load_dwordx4 v[252:255], v127, s[56:59], s85 offen offset:1024 nt
    s_waitcnt vmcnt(6)
    s_add_u32 s87, s87, 7
    s_add_u32 s39, s87, s88
    s_bfe_u32 s37, s39, 0x30000
    s_lshl_b32 s37, s37, 12
    s_add_u32 s85, s37, s89
    s_bfe_u32 s37, s39, 0x10003
    s_lshl_b32 s37, s37, 11
    s_add_u32 s85, s37, s85
    s_bfe_u32 s37, s39, 0x40004
    s_lshl_b32 s37, s37, 16
    s_add_u32 s85, s37, s85
    buffer_load_dwordx4 a[0:3], v76, s[52:55], s85 offen offset:0 nt
    s_waitcnt vmcnt(6)
    buffer_load_dwordx4 a[4:7], v77, s[52:55], s85 offen offset:0 nt
    s_waitcnt vmcnt(6)
    buffer_load_dwordx4 a[8:11], v76, s[52:55], s85 offen offset:1024 nt
    s_waitcnt vmcnt(6)
    buffer_load_dwordx4 a[12:15], v77, s[52:55], s85 offen offset:1024 nt
    s_waitcnt vmcnt(6)
    buffer_load_dwordx4 a[16:19], v126, s[56:59], s85 offen offset:0 nt
    s_waitcnt vmcnt(6)
    buffer_load_dwordx4 a[20:23], v127, s[56:59], s85 offen offset:0 nt
    s_waitcnt vmcnt(6)
    buffer_load_dwordx4 a[24:27], v126, s[56:59], s85 offen offset:1024 nt
    s_waitcnt vmcnt(6)
    buffer_load_dwordx4 a[28:31], v127, s[56:59], s85 offen offset:1024 nt
    s_waitcnt vmcnt(6)
    s_add_u32 s87, s87, 7
    s_add_u32 s39, s87, s88
    s_bfe_u32 s37, s39, 0x30000
    s_lshl_b32 s37, s37, 12
    s_add_u32 s85, s37, s89
    s_bfe_u32 s37, s39, 0x10003
    s_lshl_b32 s37, s37, 11
    s_add_u32 s85, s37, s85
    s_bfe_u32 s37, s39, 0x40004
    s_lshl_b32 s37, s37, 16
    s_add_u32 s85, s37, s85
    buffer_load_dwordx4 a[32:35], v76, s[52:55], s85 offen offset:0 nt
    s_waitcnt vmcnt(6)
    buffer_load_dwordx4 a[36:39], v77, s[52:55], s85 offen offset:0 nt
    s_waitcnt vmcnt(6)
    buffer_load_dwordx4 a[40:43], v76, s[52:55], s85 offen offset:1024 nt
    s_waitcnt vmcnt(6)
    buffer_load_dwordx4 a[44:47], v77, s[52:55], s85 offen offset:1024 nt
    s_waitcnt vmcnt(6)
    buffer_load_dwordx4 a[48:51], v126, s[56:59], s85 offen offset:0 nt
    s_waitcnt vmcnt(6)
    buffer_load_dwordx4 a[52:55], v127, s[56:59], s85 offen offset:0 nt
    s_waitcnt vmcnt(6)
    buffer_load_dwordx4 a[56:59], v126, s[56:59], s85 offen offset:1024 nt
    s_waitcnt vmcnt(6)
    buffer_load_dwordx4 a[60:63], v127, s[56:59], s85 offen offset:1024 nt
    s_waitcnt vmcnt(6)
    s_add_u32 s87, s87, 7
    s_add_u32 s39, s87, s88
    s_bfe_u32 s37, s39, 0x30000
    s_lshl_b32 s37, s37, 12
    s_add_u32 s85, s37, s89
    s_bfe_u32 s37, s39, 0x10003
    s_lshl_b32 s37, s37, 11
    s_add_u32 s85, s37, s85
    s_bfe_u32 s37, s39, 0x40004
    s_lshl_b32 s37, s37, 16
    s_add_u32 s85, s37, s85
    buffer_load_dwordx4 a[64:67], v76, s[52:55], s85 offen offset:0 nt
    s_waitcnt vmcnt(6)
    buffer_load_dwordx4 a[68:71], v77, s[52:55], s85 offen offset:0 nt
    s_waitcnt vmcnt(6)
    buffer_load_dwordx4 a[72:75], v76, s[52:55], s85 offen offset:1024 nt
    s_waitcnt vmcnt(6)
    buffer_load_dwordx4 a[76:79], v77, s[52:55], s85 offen offset:1024 nt
    buffer_load_dwordx4 v[68:71], v78, s[48:51], s91 offen offset:0 sc1
    buffer_load_dwordx4 v[72:75], v78, s[48:51], s91 offen offset:16 sc1
    s_waitcnt vmcnt(8)
    buffer_load_dwordx4 a[80:83], v126, s[56:59], s85 offen offset:0 nt
    s_waitcnt vmcnt(8)
    buffer_load_dwordx4 a[84:87], v127, s[56:59], s85 offen offset:0 nt
    s_waitcnt vmcnt(8)
    buffer_load_dwordx4 a[88:91], v126, s[56:59], s85 offen offset:1024 nt
    s_waitcnt vmcnt(8)
    buffer_load_dwordx4 a[92:95], v127, s[56:59], s85 offen offset:1024 nt
    s_waitcnt vmcnt(8)
    s_add_u32 s87, s87, 7
    s_add_u32 s39, s87, s88
    s_bfe_u32 s37, s39, 0x30000
    s_lshl_b32 s37, s37, 12
    s_add_u32 s85, s37, s89
    s_bfe_u32 s37, s39, 0x10003
    s_lshl_b32 s37, s37, 11
    s_add_u32 s85, s37, s85
    s_bfe_u32 s37, s39, 0x40004
    s_lshl_b32 s37, s37, 16
    s_add_u32 s85, s37, s85
    buffer_load_dwordx4 a[96:99], v76, s[52:55], s85 offen offset:0 nt
    s_waitcnt vmcnt(8)
    buffer_load_dwordx4 a[100:103], v77, s[52:55], s85 offen offset:0 nt
    s_waitcnt lgkmcnt(0)
    s_add_u32 s35, s35, 0x5b
    s_and_b32 s35, s35, 0xff
    v_mov_b32 v8, s35
    s_waitcnt vmcnt(6)
L_qcheck_2:
    v_xor_b32 v68, s35, v68
    v_xor_b32 v69, s35, v69
    v_xor_b32 v70, s35, v70
    v_xor_b32 v71, s35, v71
    v_xor_b32 v72, s35, v72
    v_xor_b32 v73, s35, v73
    v_xor_b32 v74, s35, v74
    v_xor_b32 v75, s35, v75
    v_or_b32 v4, v68, v69
    v_or3_b32 v4, v4, v70, v71
    v_or3_b32 v4, v4, v72, v73
    v_or3_b32 v4, v4, v74, v75
    v_and_b32 v4, 0xff, v4
    v_cmp_ne_u32 vcc, 0, v4
    s_cbranch_vccz L_qok_3
    buffer_load_dwordx4 v[68:71], v78, s[48:51], s91 offen offset:0 sc1
    buffer_load_dwordx4 v[72:75], v78, s[48:51], s91 offen offset:16 sc1
    s_waitcnt vmcnt(0)
    s_sub_u32 s84, s84, 1
    s_cmp_lg_u32 s84, 0
    s_cbranch_scc1 L_qcheck_2
    s_branch L_end
L_qok_3:
    v_cvt_pk_bf16_f32 v68, v68, v69
    v_cvt_pk_bf16_f32 v69, v70, v71
    v_cvt_pk_bf16_f32 v70, v72, v73
    v_cvt_pk_bf16_f32 v71, v74, v75
    s_mov_b32 vcc_lo, 0xf000f
    s_mov_b32 vcc_hi, 0xf000f
    v_cndmask_b32 v80, 0, v68, vcc
    v_cndmask_b32 v81, 0, v69, vcc
    v_cndmask_b32 v82, 0, v70, vcc
    v_cndmask_b32 v83, 0, v71, vcc
    s_mov_b32 vcc_lo, 0xf000f0
    s_mov_b32 vcc_hi, 0xf000f0
    v_cndmask_b32 v84, 0, v68, vcc
    v_cndmask_b32 v85, 0, v69, vcc
    v_cndmask_b32 v86, 0, v70, vcc
    v_cndmask_b32 v87, 0, v71, vcc
    s_mov_b32 vcc_lo, 0xf000f00
    s_mov_b32 vcc_hi, 0xf000f00
    v_cndmask_b32 v88, 0, v68, vcc
    v_cndmask_b32 v89, 0, v69, vcc
    v_cndmask_b32 v90, 0, v70, vcc
    v_cndmask_b32 v91, 0, v71, vcc
    s_mov_b32 vcc_lo, 0xf000f000
    s_mov_b32 vcc_hi, 0xf000f000
    v_cndmask_b32 v92, 0, v68, vcc
    v_cndmask_b32 v93, 0, v69, vcc
    v_cndmask_b32 v94, 0, v70, vcc
    v_cndmask_b32 v95, 0, v71, vcc
    buffer_load_dwordx4 a[104:107], v76, s[52:55], s85 offen offset:1024 nt
    v_mfma_f32_16x16x32_bf16 v[112:115], v[128:131], v[80:83], 0
    v_mfma_f32_16x16x32_bf16 v[112:115], v[132:135], v[84:87], v[112:115]
    v_mfma_f32_16x16x32_bf16 v[112:115], v[136:139], v[88:91], v[112:115]
    v_mfma_f32_16x16x32_bf16 v[112:115], v[140:143], v[92:95], v[112:115]
    s_nop 7
    v_mov_b32_dpp v122, v112 quad_perm:[0,0,0,0] row_mask:0xf bank_mask:0xf
    v_mov_b32_dpp v124, v114 quad_perm:[2,2,2,2] row_mask:0xf bank_mask:0xf
    s_nop 0
    v_add_f32_dpp v122, v113, v122 quad_perm:[1,1,1,1] row_mask:0xf bank_mask:0xf
    v_add_f32_dpp v124, v115, v124 quad_perm:[3,3,3,3] row_mask:0xf bank_mask:0xf
    v_add_f32 v122, v122, v124
    v_fma_f32 v123, v122, s83, -v120
    v_cmp_lt_f32 vcc, 0, v123
    s_cbranch_vccz L_nomax_4
    v_mul_f32 v122, s83, v122
    s_nop 1
    v_max_f32_dpp v124, v122, v122 row_ror:4 row_mask:0xf bank_mask:0xf
    s_nop 1
    v_max_f32_dpp v124, v124, v124 row_ror:8 row_mask:0xf bank_mask:0xf
    v_mov_b32 v125, v124
    s_nop 1
    v_permlane16_swap_b32 v124, v125
    v_max_f32 v124, v124, v125
    v_mov_b32 v125, v124
    s_nop 1
    v_permlane32_swap_b32 v124, v125
    v_max_f32 v124, v124, v125
    v_and_b32 v124, s82, v124
    v_max_f32 v124, v124, v120
    v_sub_f32 v125, v120, v124
    v_exp_f32 v125, v125
    v_mov_b32 v120, v124
    v_sub_f32 v123, v122, v124
    v_mul_f32 v121, v121, v125
    v_mul_f32 v116, v116, v125
    v_mul_f32 v117, v117, v125
    v_mul_f32 v118, v118, v125
    v_mul_f32 v119, v119, v125
L_nomax_4:
    v_exp_f32 v123, v123
    s_nop 0
    v_cvt_pk_bf16_f32 v124, v123, v123
    v_add_f32 v121, v121, v123
    s_nop 0
    v_and_b32_dpp v96, v124, v10 row_newbcast:0 row_mask:0xf bank_mask:0xf
    v_and_b32_dpp v97, v124, v11 row_newbcast:0 row_mask:0xf bank_mask:0xf
    v_and_b32_dpp v98, v124, v12 row_newbcast:0 row_mask:0xf bank_mask:0xf
    v_and_b32_dpp v99, v124, v13 row_newbcast:0 row_mask:0xf bank_mask:0xf
    v_and_b32_dpp v100, v124, v10 row_newbcast:4 row_mask:0xf bank_mask:0xf
    v_and_b32_dpp v101, v124, v11 row_newbcast:4 row_mask:0xf bank_mask:0xf
    v_and_b32_dpp v102, v124, v12 row_newbcast:4 row_mask:0xf bank_mask:0xf
    v_and_b32_dpp v103, v124, v13 row_newbcast:4 row_mask:0xf bank_mask:0xf
    v_and_b32_dpp v104, v124, v10 row_newbcast:8 row_mask:0xf bank_mask:0xf
    v_and_b32_dpp v105, v124, v11 row_newbcast:8 row_mask:0xf bank_mask:0xf
    v_and_b32_dpp v106, v124, v12 row_newbcast:8 row_mask:0xf bank_mask:0xf
    v_and_b32_dpp v107, v124, v13 row_newbcast:8 row_mask:0xf bank_mask:0xf
    v_and_b32_dpp v108, v124, v10 row_newbcast:12 row_mask:0xf bank_mask:0xf
    v_and_b32_dpp v109, v124, v11 row_newbcast:12 row_mask:0xf bank_mask:0xf
    v_and_b32_dpp v110, v124, v12 row_newbcast:12 row_mask:0xf bank_mask:0xf
    v_and_b32_dpp v111, v124, v13 row_newbcast:12 row_mask:0xf bank_mask:0xf
    v_mfma_f32_16x16x32_bf16 v[116:119], v[144:147], v[96:99], v[116:119]
    s_waitcnt vmcnt(6)
    buffer_load_dwordx4 a[108:111], v77, s[52:55], s85 offen offset:1024 nt
    v_mfma_f32_16x16x32_bf16 v[116:119], v[148:151], v[100:103], v[116:119]
    v_mfma_f32_16x16x32_bf16 v[116:119], v[152:155], v[104:107], v[116:119]
    v_mfma_f32_16x16x32_bf16 v[116:119], v[156:159], v[108:111], v[116:119]
    v_mfma_f32_16x16x32_bf16 v[112:115], v[160:163], v[80:83], 0
    v_mfma_f32_16x16x32_bf16 v[112:115], v[164:167], v[84:87], v[112:115]
    v_mfma_f32_16x16x32_bf16 v[112:115], v[168:171], v[88:91], v[112:115]
    s_waitcnt vmcnt(6)
    buffer_load_dwordx4 a[112:115], v126, s[56:59], s85 offen offset:0 nt
    v_mfma_f32_16x16x32_bf16 v[112:115], v[172:175], v[92:95], v[112:115]
    s_nop 7
    v_mov_b32_dpp v122, v112 quad_perm:[0,0,0,0] row_mask:0xf bank_mask:0xf
    v_mov_b32_dpp v124, v114 quad_perm:[2,2,2,2] row_mask:0xf bank_mask:0xf
    s_nop 0
    v_add_f32_dpp v122, v113, v122 quad_perm:[1,1,1,1] row_mask:0xf bank_mask:0xf
    v_add_f32_dpp v124, v115, v124 quad_perm:[3,3,3,3] row_mask:0xf bank_mask:0xf
    v_add_f32 v122, v122, v124
    v_fma_f32 v123, v122, s83, -v120
    v_cmp_lt_f32 vcc, 0, v123
    s_cbranch_vccz L_nomax_5
    v_mul_f32 v122, s83, v122
    s_nop 1
    v_max_f32_dpp v124, v122, v122 row_ror:4 row_mask:0xf bank_mask:0xf
    s_nop 1
    v_max_f32_dpp v124, v124, v124 row_ror:8 row_mask:0xf bank_mask:0xf
    v_mov_b32 v125, v124
    s_nop 1
    v_permlane16_swap_b32 v124, v125
    v_max_f32 v124, v124, v125
    v_mov_b32 v125, v124
    s_nop 1
    v_permlane32_swap_b32 v124, v125
    v_max_f32 v124, v124, v125
    v_and_b32 v124, s82, v124
    v_max_f32 v124, v124, v120
    v_sub_f32 v125, v120, v124
    v_exp_f32 v125, v125
    v_mov_b32 v120, v124
    v_sub_f32 v123, v122, v124
    v_mul_f32 v121, v121, v125
    v_mul_f32 v116, v116, v125
    v_mul_f32 v117, v117, v125
    v_mul_f32 v118, v118, v125
    v_mul_f32 v119, v119, v125
L_nomax_5:
    v_exp_f32 v123, v123
    s_nop 0
    v_cvt_pk_bf16_f32 v124, v123, v123
    v_add_f32 v121, v121, v123
    s_nop 0
    v_and_b32_dpp v96, v124, v10 row_newbcast:0 row_mask:0xf bank_mask:0xf
    v_and_b32_dpp v97, v124, v11 row_newbcast:0 row_mask:0xf bank_mask:0xf
    v_and_b32_dpp v98, v124, v12 row_newbcast:0 row_mask:0xf bank_mask:0xf
    v_and_b32_dpp v99, v124, v13 row_newbcast:0 row_mask:0xf bank_mask:0xf
    v_and_b32_dpp v100, v124, v10 row_newbcast:4 row_mask:0xf bank_mask:0xf
    v_and_b32_dpp v101, v124, v11 row_newbcast:4 row_mask:0xf bank_mask:0xf
    v_and_b32_dpp v102, v124, v12 row_newbcast:4 row_mask:0xf bank_mask:0xf
    v_and_b32_dpp v103, v124, v13 row_newbcast:4 row_mask:0xf bank_mask:0xf
    v_and_b32_dpp v104, v124, v10 row_newbcast:8 row_mask:0xf bank_mask:0xf
    v_and_b32_dpp v105, v124, v11 row_newbcast:8 row_mask:0xf bank_mask:0xf
    v_and_b32_dpp v106, v124, v12 row_newbcast:8 row_mask:0xf bank_mask:0xf
    v_and_b32_dpp v107, v124, v13 row_newbcast:8 row_mask:0xf bank_mask:0xf
    v_and_b32_dpp v108, v124, v10 row_newbcast:12 row_mask:0xf bank_mask:0xf
    v_and_b32_dpp v109, v124, v11 row_newbcast:12 row_mask:0xf bank_mask:0xf
    v_and_b32_dpp v110, v124, v12 row_newbcast:12 row_mask:0xf bank_mask:0xf
    v_and_b32_dpp v111, v124, v13 row_newbcast:12 row_mask:0xf bank_mask:0xf
    v_mfma_f32_16x16x32_bf16 v[116:119], v[176:179], v[96:99], v[116:119]
    v_mfma_f32_16x16x32_bf16 v[116:119], v[180:183], v[100:103], v[116:119]
    v_mfma_f32_16x16x32_bf16 v[116:119], v[184:187], v[104:107], v[116:119]
    v_mfma_f32_16x16x32_bf16 v[116:119], v[188:191], v[108:111], v[116:119]
    v_mfma_f32_16x16x32_bf16 v[112:115], v[192:195], v[80:83], 0
    s_waitcnt vmcnt(6)
    buffer_load_dwordx4 a[116:119], v127, s[56:59], s85 offen offset:0 nt
    v_mfma_f32_16x16x32_bf16 v[112:115], v[196:199], v[84:87], v[112:115]
    v_mfma_f32_16x16x32_bf16 v[112:115], v[200:203], v[88:91], v[112:115]
    v_mfma_f32_16x16x32_bf16 v[112:115], v[204:207], v[92:95], v[112:115]
    s_nop 7
    v_mov_b32_dpp v122, v112 quad_perm:[0,0,0,0] row_mask:0xf bank_mask:0xf
    v_mov_b32_dpp v124, v114 quad_perm:[2,2,2,2] row_mask:0xf bank_mask:0xf
    s_nop 0
    v_add_f32_dpp v122, v113, v122 quad_perm:[1,1,1,1] row_mask:0xf bank_mask:0xf
    v_add_f32_dpp v124, v115, v124 quad_perm:[3,3,3,3] row_mask:0xf bank_mask:0xf
    v_add_f32 v122, v122, v124
    v_fma_f32 v123, v122, s83, -v120
    v_cmp_lt_f32 vcc, 0, v123
    s_cbranch_vccz L_nomax_6
    v_mul_f32 v122, s83, v122
    s_nop 1
    v_max_f32_dpp v124, v122, v122 row_ror:4 row_mask:0xf bank_mask:0xf
    s_nop 1
    v_max_f32_dpp v124, v124, v124 row_ror:8 row_mask:0xf bank_mask:0xf
    v_mov_b32 v125, v124
    s_nop 1
    v_permlane16_swap_b32 v124, v125
    v_max_f32 v124, v124, v125
    v_mov_b32 v125, v124
    s_nop 1
    v_permlane32_swap_b32 v124, v125
    v_max_f32 v124, v124, v125
    v_and_b32 v124, s82, v124
    v_max_f32 v124, v124, v120
    v_sub_f32 v125, v120, v124
    v_exp_f32 v125, v125
    v_mov_b32 v120, v124
    v_sub_f32 v123, v122, v124
    v_mul_f32 v121, v121, v125
    v_mul_f32 v116, v116, v125
    v_mul_f32 v117, v117, v125
    v_mul_f32 v118, v118, v125
    v_mul_f32 v119, v119, v125
L_nomax_6:
    v_exp_f32 v123, v123
    s_nop 0
    v_cvt_pk_bf16_f32 v124, v123, v123
    v_add_f32 v121, v121, v123
    s_nop 0
    v_and_b32_dpp v96, v124, v10 row_newbcast:0 row_mask:0xf bank_mask:0xf
    v_and_b32_dpp v97, v124, v11 row_newbcast:0 row_mask:0xf bank_mask:0xf
    v_and_b32_dpp v98, v124, v12 row_newbcast:0 row_mask:0xf bank_mask:0xf
    v_and_b32_dpp v99, v124, v13 row_newbcast:0 row_mask:0xf bank_mask:0xf
    v_and_b32_dpp v100, v124, v10 row_newbcast:4 row_mask:0xf bank_mask:0xf
    v_and_b32_dpp v101, v124, v11 row_newbcast:4 row_mask:0xf bank_mask:0xf
    v_and_b32_dpp v102, v124, v12 row_newbcast:4 row_mask:0xf bank_mask:0xf
    v_and_b32_dpp v103, v124, v13 row_newbcast:4 row_mask:0xf bank_mask:0xf
    v_and_b32_dpp v104, v124, v10 row_newbcast:8 row_mask:0xf bank_mask:0xf
    v_and_b32_dpp v105, v124, v11 row_newbcast:8 row_mask:0xf bank_mask:0xf
    v_and_b32_dpp v106, v124, v12 row_newbcast:8 row_mask:0xf bank_mask:0xf
    v_and_b32_dpp v107, v124, v13 row_newbcast:8 row_mask:0xf bank_mask:0xf
    v_and_b32_dpp v108, v124, v10 row_newbcast:12 row_mask:0xf bank_mask:0xf
    v_and_b32_dpp v109, v124, v11 row_newbcast:12 row_mask:0xf bank_mask:0xf
    v_and_b32_dpp v110, v124, v12 row_newbcast:12 row_mask:0xf bank_mask:0xf
    v_and_b32_dpp v111, v124, v13 row_newbcast:12 row_mask:0xf bank_mask:0xf
    v_mfma_f32_16x16x32_bf16 v[116:119], v[208:211], v[96:99], v[116:119]
    v_mfma_f32_16x16x32_bf16 v[116:119], v[212:215], v[100:103], v[116:119]
    v_mfma_f32_16x16x32_bf16 v[116:119], v[216:219], v[104:107], v[116:119]
    s_waitcnt vmcnt(6)
    buffer_load_dwordx4 a[120:123], v126, s[56:59], s85 offen offset:1024 nt
    v_mfma_f32_16x16x32_bf16 v[116:119], v[220:223], v[108:111], v[116:119]
    v_mfma_f32_16x16x32_bf16 v[112:115], v[224:227], v[80:83], 0
    v_mfma_f32_16x16x32_bf16 v[112:115], v[228:231], v[84:87], v[112:115]
    v_mfma_f32_16x16x32_bf16 v[112:115], v[232:235], v[88:91], v[112:115]
    v_mfma_f32_16x16x32_bf16 v[112:115], v[236:239], v[92:95], v[112:115]
    s_nop 7
    v_mov_b32_dpp v122, v112 quad_perm:[0,0,0,0] row_mask:0xf bank_mask:0xf
    v_mov_b32_dpp v124, v114 quad_perm:[2,2,2,2] row_mask:0xf bank_mask:0xf
    s_nop 0
    v_add_f32_dpp v122, v113, v122 quad_perm:[1,1,1,1] row_mask:0xf bank_mask:0xf
    v_add_f32_dpp v124, v115, v124 quad_perm:[3,3,3,3] row_mask:0xf bank_mask:0xf
    v_add_f32 v122, v122, v124
    v_fma_f32 v123, v122, s83, -v120
    v_cmp_lt_f32 vcc, 0, v123
    s_cbranch_vccz L_nomax_7
    v_mul_f32 v122, s83, v122
    s_nop 1
    v_max_f32_dpp v124, v122, v122 row_ror:4 row_mask:0xf bank_mask:0xf
    s_nop 1
    v_max_f32_dpp v124, v124, v124 row_ror:8 row_mask:0xf bank_mask:0xf
    v_mov_b32 v125, v124
    s_nop 1
    v_permlane16_swap_b32 v124, v125
    v_max_f32 v124, v124, v125
    v_mov_b32 v125, v124
    s_nop 1
    v_permlane32_swap_b32 v124, v125
    v_max_f32 v124, v124, v125
    v_and_b32 v124, s82, v124
    v_max_f32 v124, v124, v120
    v_sub_f32 v125, v120, v124
    v_exp_f32 v125, v125
    v_mov_b32 v120, v124
    v_sub_f32 v123, v122, v124
    v_mul_f32 v121, v121, v125
    v_mul_f32 v116, v116, v125
    v_mul_f32 v117, v117, v125
    v_mul_f32 v118, v118, v125
    v_mul_f32 v119, v119, v125
L_nomax_7:
    v_exp_f32 v123, v123
    s_nop 0
    v_cvt_pk_bf16_f32 v124, v123, v123
    v_add_f32 v121, v121, v123
    s_nop 0
    v_and_b32_dpp v96, v124, v10 row_newbcast:0 row_mask:0xf bank_mask:0xf
    v_and_b32_dpp v97, v124, v11 row_newbcast:0 row_mask:0xf bank_mask:0xf
    v_and_b32_dpp v98, v124, v12 row_newbcast:0 row_mask:0xf bank_mask:0xf
    v_and_b32_dpp v99, v124, v13 row_newbcast:0 row_mask:0xf bank_mask:0xf
    v_and_b32_dpp v100, v124, v10 row_newbcast:4 row_mask:0xf bank_mask:0xf
    v_and_b32_dpp v101, v124, v11 row_newbcast:4 row_mask:0xf bank_mask:0xf
    v_and_b32_dpp v102, v124, v12 row_newbcast:4 row_mask:0xf bank_mask:0xf
    v_and_b32_dpp v103, v124, v13 row_newbcast:4 row_mask:0xf bank_mask:0xf
    v_and_b32_dpp v104, v124, v10 row_newbcast:8 row_mask:0xf bank_mask:0xf
    v_and_b32_dpp v105, v124, v11 row_newbcast:8 row_mask:0xf bank_mask:0xf
    v_and_b32_dpp v106, v124, v12 row_newbcast:8 row_mask:0xf bank_mask:0xf
    v_and_b32_dpp v107, v124, v13 row_newbcast:8 row_mask:0xf bank_mask:0xf
    v_and_b32_dpp v108, v124, v10 row_newbcast:12 row_mask:0xf bank_mask:0xf
    v_and_b32_dpp v109, v124, v11 row_newbcast:12 row_mask:0xf bank_mask:0xf
    v_and_b32_dpp v110, v124, v12 row_newbcast:12 row_mask:0xf bank_mask:0xf
    v_and_b32_dpp v111, v124, v13 row_newbcast:12 row_mask:0xf bank_mask:0xf
    v_mfma_f32_16x16x32_bf16 v[116:119], v[240:243], v[96:99], v[116:119]
    s_waitcnt vmcnt(6)
    buffer_load_dwordx4 a[124:127], v127, s[56:59], s85 offen offset:1024 nt
    v_mfma_f32_16x16x32_bf16 v[116:119], v[244:247], v[100:103], v[116:119]
    v_mfma_f32_16x16x32_bf16 v[116:119], v[248:251], v[104:107], v[116:119]
    v_mfma_f32_16x16x32_bf16 v[116:119], v[252:255], v[108:111], v[116:119]
    v_mfma_f32_16x16x32_bf16 v[112:115], a[0:3], v[80:83], 0
    v_mfma_f32_16x16x32_bf16 v[112:115], a[4:7], v[84:87], v[112:115]
    s_waitcnt vmcnt(5)
    s_add_u32 s87, s87, 7
    s_add_u32 s39, s87, s88
    s_bfe_u32 s37, s39, 0x30000
    s_lshl_b32 s37, s37, 12
    s_add_u32 s85, s37, s89
    s_bfe_u32 s37, s39, 0x10003
    s_lshl_b32 s37, s37, 11
    s_add_u32 s85, s37, s85
    s_bfe_u32 s37, s39, 0x40004
    s_lshl_b32 s37, s37, 16
    s_add_u32 s85, s37, s85
    buffer_load_dwordx4 v[128:131], v76, s[52:55], s85 offen offset:0 nt
    v_mfma_f32_16x16x32_bf16 v[112:115], a[8:11], v[88:91], v[112:115]
    v_mfma_f32_16x16x32_bf16 v[112:115], a[12:15], v[92:95], v[112:115]
    s_nop 7
    v_mov_b32_dpp v122, v112 quad_perm:[0,0,0,0] row_mask:0xf bank_mask:0xf
    v_mov_b32_dpp v124, v114 quad_perm:[2,2,2,2] row_mask:0xf bank_mask:0xf
    s_nop 0
    v_add_f32_dpp v122, v113, v122 quad_perm:[1,1,1,1] row_mask:0xf bank_mask:0xf
    v_add_f32_dpp v124, v115, v124 quad_perm:[3,3,3,3] row_mask:0xf bank_mask:0xf
    v_add_f32 v122, v122, v124
    v_fma_f32 v123, v122, s83, -v120
    v_cmp_lt_f32 vcc, 0, v123
    s_cbranch_vccz L_nomax_8
    v_mul_f32 v122, s83, v122
    s_nop 1
    v_max_f32_dpp v124, v122, v122 row_ror:4 row_mask:0xf bank_mask:0xf
    s_nop 1
    v_max_f32_dpp v124, v124, v124 row_ror:8 row_mask:0xf bank_mask:0xf
    v_mov_b32 v125, v124
    s_nop 1
    v_permlane16_swap_b32 v124, v125
    v_max_f32 v124, v124, v125
    v_mov_b32 v125, v124
    s_nop 1
    v_permlane32_swap_b32 v124, v125
    v_max_f32 v124, v124, v125
    v_and_b32 v124, s82, v124
    v_max_f32 v124, v124, v120
    v_sub_f32 v125, v120, v124
    v_exp_f32 v125, v125
    v_mov_b32 v120, v124
    v_sub_f32 v123, v122, v124
    v_mul_f32 v121, v121, v125
    v_mul_f32 v116, v116, v125
    v_mul_f32 v117, v117, v125
    v_mul_f32 v118, v118, v125
    v_mul_f32 v119, v119, v125
L_nomax_8:
    v_exp_f32 v123, v123
    s_nop 0
    v_cvt_pk_bf16_f32 v124, v123, v123
    v_add_f32 v121, v121, v123
    s_nop 0
    v_and_b32_dpp v96, v124, v10 row_newbcast:0 row_mask:0xf bank_mask:0xf
    v_and_b32_dpp v97, v124, v11 row_newbcast:0 row_mask:0xf bank_mask:0xf
    v_and_b32_dpp v98, v124, v12 row_newbcast:0 row_mask:0xf bank_mask:0xf
    v_and_b32_dpp v99, v124, v13 row_newbcast:0 row_mask:0xf bank_mask:0xf
    v_and_b32_dpp v100, v124, v10 row_newbcast:4 row_mask:0xf bank_mask:0xf
    v_and_b32_dpp v101, v124, v11 row_newbcast:4 row_mask:0xf bank_mask:0xf
    v_and_b32_dpp v102, v124, v12 row_newbcast:4 row_mask:0xf bank_mask:0xf
    v_and_b32_dpp v103, v124, v13 row_newbcast:4 row_mask:0xf bank_mask:0xf
    v_and_b32_dpp v104, v124, v10 row_newbcast:8 row_mask:0xf bank_mask:0xf
    v_and_b32_dpp v105, v124, v11 row_newbcast:8 row_mask:0xf bank_mask:0xf
    v_and_b32_dpp v106, v124, v12 row_newbcast:8 row_mask:0xf bank_mask:0xf
    v_and_b32_dpp v107, v124, v13 row_newbcast:8 row_mask:0xf bank_mask:0xf
    v_and_b32_dpp v108, v124, v10 row_newbcast:12 row_mask:0xf bank_mask:0xf
    v_and_b32_dpp v109, v124, v11 row_newbcast:12 row_mask:0xf bank_mask:0xf
    v_and_b32_dpp v110, v124, v12 row_newbcast:12 row_mask:0xf bank_mask:0xf
    v_and_b32_dpp v111, v124, v13 row_newbcast:12 row_mask:0xf bank_mask:0xf
    v_mfma_f32_16x16x32_bf16 v[116:119], a[16:19], v[96:99], v[116:119]
    v_mfma_f32_16x16x32_bf16 v[116:119], a[20:23], v[100:103], v[116:119]
    v_mfma_f32_16x16x32_bf16 v[116:119], a[24:27], v[104:107], v[116:119]
    v_mfma_f32_16x16x32_bf16 v[116:119], a[28:31], v[108:111], v[116:119]
    s_waitcnt vmcnt(5)
    buffer_load_dwordx4 v[132:135], v77, s[52:55], s85 offen offset:0 nt
    v_mfma_f32_16x16x32_bf16 v[112:115], a[32:35], v[80:83], 0
    v_mfma_f32_16x16x32_bf16 v[112:115], a[36:39], v[84:87], v[112:115]
    v_mfma_f32_16x16x32_bf16 v[112:115], a[40:43], v[88:91], v[112:115]
    v_mfma_f32_16x16x32_bf16 v[112:115], a[44:47], v[92:95], v[112:115]
    s_nop 7
    v_mov_b32_dpp v122, v112 quad_perm:[0,0,0,0] row_mask:0xf bank_mask:0xf
    v_mov_b32_dpp v124, v114 quad_perm:[2,2,2,2] row_mask:0xf bank_mask:0xf
    s_nop 0
    v_add_f32_dpp v122, v113, v122 quad_perm:[1,1,1,1] row_mask:0xf bank_mask:0xf
    v_add_f32_dpp v124, v115, v124 quad_perm:[3,3,3,3] row_mask:0xf bank_mask:0xf
    v_add_f32 v122, v122, v124
    v_fma_f32 v123, v122, s83, -v120
    v_cmp_lt_f32 vcc, 0, v123
    s_cbranch_vccz L_nomax_9
    v_mul_f32 v122, s83, v122
    s_nop 1
    v_max_f32_dpp v124, v122, v122 row_ror:4 row_mask:0xf bank_mask:0xf
    s_nop 1
    v_max_f32_dpp v124, v124, v124 row_ror:8 row_mask:0xf bank_mask:0xf
    v_mov_b32 v125, v124
    s_nop 1
    v_permlane16_swap_b32 v124, v125
    v_max_f32 v124, v124, v125
    v_mov_b32 v125, v124
    s_nop 1
    v_permlane32_swap_b32 v124, v125
    v_max_f32 v124, v124, v125
    v_and_b32 v124, s82, v124
    v_max_f32 v124, v124, v120
    v_sub_f32 v125, v120, v124
    v_exp_f32 v125, v125
    v_mov_b32 v120, v124
    v_sub_f32 v123, v122, v124
    v_mul_f32 v121, v121, v125
    v_mul_f32 v116, v116, v125
    v_mul_f32 v117, v117, v125
    v_mul_f32 v118, v118, v125
    v_mul_f32 v119, v119, v125
L_nomax_9:
    v_exp_f32 v123, v123
    s_nop 0
    v_cvt_pk_bf16_f32 v124, v123, v123
    v_add_f32 v121, v121, v123
    s_nop 0
    v_and_b32_dpp v96, v124, v10 row_newbcast:0 row_mask:0xf bank_mask:0xf
    v_and_b32_dpp v97, v124, v11 row_newbcast:0 row_mask:0xf bank_mask:0xf
    v_and_b32_dpp v98, v124, v12 row_newbcast:0 row_mask:0xf bank_mask:0xf
    v_and_b32_dpp v99, v124, v13 row_newbcast:0 row_mask:0xf bank_mask:0xf
    v_and_b32_dpp v100, v124, v10 row_newbcast:4 row_mask:0xf bank_mask:0xf
    v_and_b32_dpp v101, v124, v11 row_newbcast:4 row_mask:0xf bank_mask:0xf
    v_and_b32_dpp v102, v124, v12 row_newbcast:4 row_mask:0xf bank_mask:0xf
    v_and_b32_dpp v103, v124, v13 row_newbcast:4 row_mask:0xf bank_mask:0xf
    v_and_b32_dpp v104, v124, v10 row_newbcast:8 row_mask:0xf bank_mask:0xf
    v_and_b32_dpp v105, v124, v11 row_newbcast:8 row_mask:0xf bank_mask:0xf
    v_and_b32_dpp v106, v124, v12 row_newbcast:8 row_mask:0xf bank_mask:0xf
    v_and_b32_dpp v107, v124, v13 row_newbcast:8 row_mask:0xf bank_mask:0xf
    v_and_b32_dpp v108, v124, v10 row_newbcast:12 row_mask:0xf bank_mask:0xf
    v_and_b32_dpp v109, v124, v11 row_newbcast:12 row_mask:0xf bank_mask:0xf
    v_and_b32_dpp v110, v124, v12 row_newbcast:12 row_mask:0xf bank_mask:0xf
    v_and_b32_dpp v111, v124, v13 row_newbcast:12 row_mask:0xf bank_mask:0xf
    v_mfma_f32_16x16x32_bf16 v[116:119], a[48:51], v[96:99], v[116:119]
    v_mfma_f32_16x16x32_bf16 v[116:119], a[52:55], v[100:103], v[116:119]
    s_waitcnt vmcnt(5)
    buffer_load_dwordx4 v[136:139], v76, s[52:55], s85 offen offset:1024 nt
    v_mfma_f32_16x16x32_bf16 v[116:119], a[56:59], v[104:107], v[116:119]
    v_mfma_f32_16x16x32_bf16 v[116:119], a[60:63], v[108:111], v[116:119]
    v_mfma_f32_16x16x32_bf16 v[112:115], a[64:67], v[80:83], 0
    v_mfma_f32_16x16x32_bf16 v[112:115], a[68:71], v[84:87], v[112:115]
    v_mfma_f32_16x16x32_bf16 v[112:115], a[72:75], v[88:91], v[112:115]
    v_mfma_f32_16x16x32_bf16 v[112:115], a[76:79], v[92:95], v[112:115]
    s_nop 7
    v_mov_b32_dpp v122, v112 quad_perm:[0,0,0,0] row_mask:0xf bank_mask:0xf
    v_mov_b32_dpp v124, v114 quad_perm:[2,2,2,2] row_mask:0xf bank_mask:0xf
    s_nop 0
    v_add_f32_dpp v122, v113, v122 quad_perm:[1,1,1,1] row_mask:0xf bank_mask:0xf
    v_add_f32_dpp v124, v115, v124 quad_perm:[3,3,3,3] row_mask:0xf bank_mask:0xf
    v_add_f32 v122, v122, v124
    v_fma_f32 v123, v122, s83, -v120
    v_cmp_lt_f32 vcc, 0, v123
    s_cbranch_vccz L_nomax_10
    v_mul_f32 v122, s83, v122
    s_nop 1
    v_max_f32_dpp v124, v122, v122 row_ror:4 row_mask:0xf bank_mask:0xf
    s_nop 1
    v_max_f32_dpp v124, v124, v124 row_ror:8 row_mask:0xf bank_mask:0xf
    v_mov_b32 v125, v124
    s_nop 1
    v_permlane16_swap_b32 v124, v125
    v_max_f32 v124, v124, v125
    v_mov_b32 v125, v124
    s_nop 1
    v_permlane32_swap_b32 v124, v125
    v_max_f32 v124, v124, v125
    v_and_b32 v124, s82, v124
    v_max_f32 v124, v124, v120
    v_sub_f32 v125, v120, v124
    v_exp_f32 v125, v125
    v_mov_b32 v120, v124
    v_sub_f32 v123, v122, v124
    v_mul_f32 v121, v121, v125
    v_mul_f32 v116, v116, v125
    v_mul_f32 v117, v117, v125
    v_mul_f32 v118, v118, v125
    v_mul_f32 v119, v119, v125
L_nomax_10:
    v_exp_f32 v123, v123
    s_nop 0
    v_cvt_pk_bf16_f32 v124, v123, v123
    v_add_f32 v121, v121, v123
    s_nop 0
    v_and_b32_dpp v96, v124, v10 row_newbcast:0 row_mask:0xf bank_mask:0xf
    v_and_b32_dpp v97, v124, v11 row_newbcast:0 row_mask:0xf bank_mask:0xf
    v_and_b32_dpp v98, v124, v12 row_newbcast:0 row_mask:0xf bank_mask:0xf
    v_and_b32_dpp v99, v124, v13 row_newbcast:0 row_mask:0xf bank_mask:0xf
    v_and_b32_dpp v100, v124, v10 row_newbcast:4 row_mask:0xf bank_mask:0xf
    v_and_b32_dpp v101, v124, v11 row_newbcast:4 row_mask:0xf bank_mask:0xf
    v_and_b32_dpp v102, v124, v12 row_newbcast:4 row_mask:0xf bank_mask:0xf
    v_and_b32_dpp v103, v124, v13 row_newbcast:4 row_mask:0xf bank_mask:0xf
    v_and_b32_dpp v104, v124, v10 row_newbcast:8 row_mask:0xf bank_mask:0xf
    v_and_b32_dpp v105, v124, v11 row_newbcast:8 row_mask:0xf bank_mask:0xf
    v_and_b32_dpp v106, v124, v12 row_newbcast:8 row_mask:0xf bank_mask:0xf
    v_and_b32_dpp v107, v124, v13 row_newbcast:8 row_mask:0xf bank_mask:0xf
    v_and_b32_dpp v108, v124, v10 row_newbcast:12 row_mask:0xf bank_mask:0xf
    v_and_b32_dpp v109, v124, v11 row_newbcast:12 row_mask:0xf bank_mask:0xf
    v_and_b32_dpp v110, v124, v12 row_newbcast:12 row_mask:0xf bank_mask:0xf
    v_and_b32_dpp v111, v124, v13 row_newbcast:12 row_mask:0xf bank_mask:0xf
    s_waitcnt vmcnt(5)
    buffer_load_dwordx4 v[140:143], v77, s[52:55], s85 offen offset:1024 nt
    v_mfma_f32_16x16x32_bf16 v[116:119], a[80:83], v[96:99], v[116:119]
    v_mfma_f32_16x16x32_bf16 v[116:119], a[84:87], v[100:103], v[116:119]
    v_mfma_f32_16x16x32_bf16 v[116:119], a[88:91], v[104:107], v[116:119]
    v_mfma_f32_16x16x32_bf16 v[116:119], a[92:95], v[108:111], v[116:119]
    v_mfma_f32_16x16x32_bf16 v[112:115], a[96:99], v[80:83], 0
    v_mfma_f32_16x16x32_bf16 v[112:115], a[100:103], v[84:87], v[112:115]
    s_waitcnt vmcnt(5)
    buffer_load_dwordx4 v[144:147], v126, s[56:59], s85 offen offset:0 nt
    v_mfma_f32_16x16x32_bf16 v[112:115], a[104:107], v[88:91], v[112:115]
    v_mfma_f32_16x16x32_bf16 v[112:115], a[108:111], v[92:95], v[112:115]
    s_nop 7
    v_mov_b32_dpp v122, v112 quad_perm:[0,0,0,0] row_mask:0xf bank_mask:0xf
    v_mov_b32_dpp v124, v114 quad_perm:[2,2,2,2] row_mask:0xf bank_mask:0xf
    s_nop 0
    v_add_f32_dpp v122, v113, v122 quad_perm:[1,1,1,1] row_mask:0xf bank_mask:0xf
    v_add_f32_dpp v124, v115, v124 quad_perm:[3,3,3,3] row_mask:0xf bank_mask:0xf
    v_add_f32 v122, v122, v124
    v_fma_f32 v123, v122, s83, -v120
    v_cmp_lt_f32 vcc, 0, v123
    s_cbranch_vccz L_nomax_11
    v_mul_f32 v122, s83, v122
    s_nop 1
    v_max_f32_dpp v124, v122, v122 row_ror:4 row_mask:0xf bank_mask:0xf
    s_nop 1
    v_max_f32_dpp v124, v124, v124 row_ror:8 row_mask:0xf bank_mask:0xf
    v_mov_b32 v125, v124
    s_nop 1
    v_permlane16_swap_b32 v124, v125
    v_max_f32 v124, v124, v125
    v_mov_b32 v125, v124
    s_nop 1
    v_permlane32_swap_b32 v124, v125
    v_max_f32 v124, v124, v125
    v_and_b32 v124, s82, v124
    v_max_f32 v124, v124, v120
    v_sub_f32 v125, v120, v124
    v_exp_f32 v125, v125
    v_mov_b32 v120, v124
    v_sub_f32 v123, v122, v124
    v_mul_f32 v121, v121, v125
    v_mul_f32 v116, v116, v125
    v_mul_f32 v117, v117, v125
    v_mul_f32 v118, v118, v125
    v_mul_f32 v119, v119, v125
L_nomax_11:
    v_exp_f32 v123, v123
    s_nop 0
    v_cvt_pk_bf16_f32 v124, v123, v123
    v_add_f32 v121, v121, v123
    s_nop 0
    v_and_b32_dpp v96, v124, v10 row_newbcast:0 row_mask:0xf bank_mask:0xf
    v_and_b32_dpp v97, v124, v11 row_newbcast:0 row_mask:0xf bank_mask:0xf
    v_and_b32_dpp v98, v124, v12 row_newbcast:0 row_mask:0xf bank_mask:0xf
    v_and_b32_dpp v99, v124, v13 row_newbcast:0 row_mask:0xf bank_mask:0xf
    v_and_b32_dpp v100, v124, v10 row_newbcast:4 row_mask:0xf bank_mask:0xf
    v_and_b32_dpp v101, v124, v11 row_newbcast:4 row_mask:0xf bank_mask:0xf
    v_and_b32_dpp v102, v124, v12 row_newbcast:4 row_mask:0xf bank_mask:0xf
    v_and_b32_dpp v103, v124, v13 row_newbcast:4 row_mask:0xf bank_mask:0xf
    v_and_b32_dpp v104, v124, v10 row_newbcast:8 row_mask:0xf bank_mask:0xf
    v_and_b32_dpp v105, v124, v11 row_newbcast:8 row_mask:0xf bank_mask:0xf
    v_and_b32_dpp v106, v124, v12 row_newbcast:8 row_mask:0xf bank_mask:0xf
    v_and_b32_dpp v107, v124, v13 row_newbcast:8 row_mask:0xf bank_mask:0xf
    v_and_b32_dpp v108, v124, v10 row_newbcast:12 row_mask:0xf bank_mask:0xf
    v_and_b32_dpp v109, v124, v11 row_newbcast:12 row_mask:0xf bank_mask:0xf
    v_and_b32_dpp v110, v124, v12 row_newbcast:12 row_mask:0xf bank_mask:0xf
    v_and_b32_dpp v111, v124, v13 row_newbcast:12 row_mask:0xf bank_mask:0xf
    v_mfma_f32_16x16x32_bf16 v[116:119], a[112:115], v[96:99], v[116:119]
    v_mfma_f32_16x16x32_bf16 v[116:119], a[116:119], v[100:103], v[116:119]
    v_mfma_f32_16x16x32_bf16 v[116:119], a[120:123], v[104:107], v[116:119]
    s_waitcnt vmcnt(5)
    v_mfma_f32_16x16x32_bf16 v[116:119], a[124:127], v[108:111], v[116:119]
    s_add_u32 s87, s87, 7
    s_add_u32 s39, s87, s88
    s_bfe_u32 s37, s39, 0x30000
    s_lshl_b32 s37, s37, 12
    s_add_u32 s86, s37, s89
    s_bfe_u32 s37, s39, 0x10003
    s_lshl_b32 s37, s37, 11
    s_add_u32 s86, s37, s86
    s_bfe_u32 s37, s39, 0x40004
    s_lshl_b32 s37, s37, 16
    s_add_u32 s86, s37, s86
L_bloop:
    s_waitcnt vmcnt(4)
    buffer_load_dwordx4 v[148:151], v127, s[56:59], s85 offen offset:0 nt
    v_mfma_f32_16x16x32_bf16 v[112:115], v[128:131], v[80:83], 0
    s_waitcnt vmcnt(4)
    buffer_load_dwordx4 v[152:155], v126, s[56:59], s85 offen offset:1024 nt
    v_mfma_f32_16x16x32_bf16 v[112:115], v[132:135], v[84:87], v[112:115]
    s_waitcnt vmcnt(4)
    buffer_load_dwordx4 v[156:159], v127, s[56:59], s85 offen offset:1024 nt
    v_mfma_f32_16x16x32_bf16 v[112:115], v[136:139], v[88:91], v[112:115]
    s_waitcnt vmcnt(4)
    buffer_load_dwordx4 v[160:163], v76, s[52:55], s86 offen offset:0 nt
    buffer_load_dwordx4 v[164:167], v77, s[52:55], s86 offen offset:0 nt
    v_mfma_f32_16x16x32_bf16 v[112:115], v[140:143], v[92:95], v[112:115]
    s_add_u32 s87, s87, 7
    s_add_u32 s39, s87, s88
    s_bfe_u32 s37, s39, 0x30000
    s_lshl_b32 s37, s37, 12
    s_add_u32 s85, s37, s89
    s_bfe_u32 s37, s39, 0x10003
    s_lshl_b32 s37, s37, 11
    s_add_u32 s85, s37, s85
    s_bfe_u32 s37, s39, 0x40004
    s_lshl_b32 s37, s37, 16
    s_add_u32 s85, s37, s85
    v_mov_b32_dpp v122, v112 quad_perm:[0,0,0,0] row_mask:0xf bank_mask:0xf
    v_mov_b32_dpp v124, v114 quad_perm:[2,2,2,2] row_mask:0xf bank_mask:0xf
    s_nop 0
    v_add_f32_dpp v122, v113, v122 quad_perm:[1,1,1,1] row_mask:0xf bank_mask:0xf
    v_add_f32_dpp v124, v115, v124 quad_perm:[3,3,3,3] row_mask:0xf bank_mask:0xf
    v_add_f32 v122, v122, v124
    v_fma_f32 v123, v122, s83, -v120
    v_cmp_lt_f32 vcc, 0, v123
    s_cbranch_vccz L_nomax_12
    v_mul_f32 v122, s83, v122
    s_nop 1
    v_max_f32_dpp v124, v122, v122 row_ror:4 row_mask:0xf bank_mask:0xf
    s_nop 1
    v_max_f32_dpp v124, v124, v124 row_ror:8 row_mask:0xf bank_mask:0xf
    v_mov_b32 v125, v124
    s_nop 1
    v_permlane16_swap_b32 v124, v125
    v_max_f32 v124, v124, v125
    v_mov_b32 v125, v124
    s_nop 1
    v_permlane32_swap_b32 v124, v125
    v_max_f32 v124, v124, v125
    v_and_b32 v124, s82, v124
    v_max_f32 v124, v124, v120
    v_sub_f32 v125, v120, v124
    v_exp_f32 v125, v125
    v_mov_b32 v120, v124
    v_sub_f32 v123, v122, v124
    v_mul_f32 v121, v121, v125
    v_mul_f32 v116, v116, v125
    v_mul_f32 v117, v117, v125
    v_mul_f32 v118, v118, v125
    v_mul_f32 v119, v119, v125
L_nomax_12:
    v_exp_f32 v123, v123
    s_nop 0
    v_cvt_pk_bf16_f32 v124, v123, v123
    v_add_f32 v121, v121, v123
    s_nop 0
    v_and_b32_dpp v96, v124, v10 row_newbcast:0 row_mask:0xf bank_mask:0xf
    v_and_b32_dpp v97, v124, v11 row_newbcast:0 row_mask:0xf bank_mask:0xf
    v_and_b32_dpp v98, v124, v12 row_newbcast:0 row_mask:0xf bank_mask:0xf
    v_and_b32_dpp v99, v124, v13 row_newbcast:0 row_mask:0xf bank_mask:0xf
    v_and_b32_dpp v100, v124, v10 row_newbcast:4 row_mask:0xf bank_mask:0xf
    v_and_b32_dpp v101, v124, v11 row_newbcast:4 row_mask:0xf bank_mask:0xf
    v_and_b32_dpp v102, v124, v12 row_newbcast:4 row_mask:0xf bank_mask:0xf
    v_and_b32_dpp v103, v124, v13 row_newbcast:4 row_mask:0xf bank_mask:0xf
    v_and_b32_dpp v104, v124, v10 row_newbcast:8 row_mask:0xf bank_mask:0xf
    v_and_b32_dpp v105, v124, v11 row_newbcast:8 row_mask:0xf bank_mask:0xf
    v_and_b32_dpp v106, v124, v12 row_newbcast:8 row_mask:0xf bank_mask:0xf
    v_and_b32_dpp v107, v124, v13 row_newbcast:8 row_mask:0xf bank_mask:0xf
    v_and_b32_dpp v108, v124, v10 row_newbcast:12 row_mask:0xf bank_mask:0xf
    v_and_b32_dpp v109, v124, v11 row_newbcast:12 row_mask:0xf bank_mask:0xf
    v_and_b32_dpp v110, v124, v12 row_newbcast:12 row_mask:0xf bank_mask:0xf
    v_and_b32_dpp v111, v124, v13 row_newbcast:12 row_mask:0xf bank_mask:0xf
    s_waitcnt vmcnt(5)
    v_mfma_f32_16x16x32_bf16 v[116:119], v[144:147], v[96:99], v[116:119]
    s_waitcnt vmcnt(4)
    buffer_load_dwordx4 v[168:171], v76, s[52:55], s86 offen offset:1024 nt
    v_mfma_f32_16x16x32_bf16 v[116:119], v[148:151], v[100:103], v[116:119]
    s_waitcnt vmcnt(4)
    buffer_load_dwordx4 v[172:175], v77, s[52:55], s86 offen offset:1024 nt
    v_mfma_f32_16x16x32_bf16 v[116:119], v[152:155], v[104:107], v[116:119]
    s_waitcnt vmcnt(4)
    buffer_load_dwordx4 v[176:179], v126, s[56:59], s86 offen offset:0 nt
    v_mfma_f32_16x16x32_bf16 v[116:119], v[156:159], v[108:111], v[116:119]
    s_waitcnt vmcnt(4)
    buffer_load_dwordx4 v[180:183], v127, s[56:59], s86 offen offset:0 nt
    v_mfma_f32_16x16x32_bf16 v[112:115], v[160:163], v[80:83], 0
    s_waitcnt vmcnt(4)
    buffer_load_dwordx4 v[184:187], v126, s[56:59], s86 offen offset:1024 nt
    v_mfma_f32_16x16x32_bf16 v[112:115], v[164:167], v[84:87], v[112:115]
    s_waitcnt vmcnt(4)
    buffer_load_dwordx4 v[188:191], v127, s[56:59], s86 offen offset:1024 nt
    v_mfma_f32_16x16x32_bf16 v[112:115], v[168:171], v[88:91], v[112:115]
    s_waitcnt vmcnt(4)
    buffer_load_dwordx4 v[128:131], v76, s[52:55], s85 offen offset:0 nt
    buffer_load_dwordx4 v[132:135], v77, s[52:55], s85 offen offset:0 nt
    v_mfma_f32_16x16x32_bf16 v[112:115], v[172:175], v[92:95], v[112:115]
    s_add_u32 s87, s87, 7
    s_add_u32 s39, s87, s88
    s_bfe_u32 s37, s39, 0x30000
    s_lshl_b32 s37, s37, 12
    s_add_u32 s86, s37, s89
    s_bfe_u32 s37, s39, 0x10003
    s_lshl_b32 s37, s37, 11
    s_add_u32 s86, s37, s86
    s_bfe_u32 s37, s39, 0x40004
    s_lshl_b32 s37, s37, 16
    s_add_u32 s86, s37, s86
    v_mov_b32_dpp v122, v112 quad_perm:[0,0,0,0] row_mask:0xf bank_mask:0xf
    v_mov_b32_dpp v124, v114 quad_perm:[2,2,2,2] row_mask:0xf bank_mask:0xf
    s_nop 0
    v_add_f32_dpp v122, v113, v122 quad_perm:[1,1,1,1] row_mask:0xf bank_mask:0xf
    v_add_f32_dpp v124, v115, v124 quad_perm:[3,3,3,3] row_mask:0xf bank_mask:0xf
    v_add_f32 v122, v122, v124
    v_fma_f32 v123, v122, s83, -v120
    v_cmp_lt_f32 vcc, 0, v123
    s_cbranch_vccz L_nomax_13
    v_mul_f32 v122, s83, v122
    s_nop 1
    v_max_f32_dpp v124, v122, v122 row_ror:4 row_mask:0xf bank_mask:0xf
    s_nop 1
    v_max_f32_dpp v124, v124, v124 row_ror:8 row_mask:0xf bank_mask:0xf
    v_mov_b32 v125, v124
    s_nop 1
    v_permlane16_swap_b32 v124, v125
    v_max_f32 v124, v124, v125
    v_mov_b32 v125, v124
    s_nop 1
    v_permlane32_swap_b32 v124, v125
    v_max_f32 v124, v124, v125
    v_and_b32 v124, s82, v124
    v_max_f32 v124, v124, v120
    v_sub_f32 v125, v120, v124
    v_exp_f32 v125, v125
    v_mov_b32 v120, v124
    v_sub_f32 v123, v122, v124
    v_mul_f32 v121, v121, v125
    v_mul_f32 v116, v116, v125
    v_mul_f32 v117, v117, v125
    v_mul_f32 v118, v118, v125
    v_mul_f32 v119, v119, v125
L_nomax_13:
    v_exp_f32 v123, v123
    s_nop 0
    v_cvt_pk_bf16_f32 v124, v123, v123
    v_add_f32 v121, v121, v123
    s_nop 0
    v_and_b32_dpp v96, v124, v10 row_newbcast:0 row_mask:0xf bank_mask:0xf
    v_and_b32_dpp v97, v124, v11 row_newbcast:0 row_mask:0xf bank_mask:0xf
    v_and_b32_dpp v98, v124, v12 row_newbcast:0 row_mask:0xf bank_mask:0xf
    v_and_b32_dpp v99, v124, v13 row_newbcast:0 row_mask:0xf bank_mask:0xf
    v_and_b32_dpp v100, v124, v10 row_newbcast:4 row_mask:0xf bank_mask:0xf
    v_and_b32_dpp v101, v124, v11 row_newbcast:4 row_mask:0xf bank_mask:0xf
    v_and_b32_dpp v102, v124, v12 row_newbcast:4 row_mask:0xf bank_mask:0xf
    v_and_b32_dpp v103, v124, v13 row_newbcast:4 row_mask:0xf bank_mask:0xf
    v_and_b32_dpp v104, v124, v10 row_newbcast:8 row_mask:0xf bank_mask:0xf
    v_and_b32_dpp v105, v124, v11 row_newbcast:8 row_mask:0xf bank_mask:0xf
    v_and_b32_dpp v106, v124, v12 row_newbcast:8 row_mask:0xf bank_mask:0xf
    v_and_b32_dpp v107, v124, v13 row_newbcast:8 row_mask:0xf bank_mask:0xf
    v_and_b32_dpp v108, v124, v10 row_newbcast:12 row_mask:0xf bank_mask:0xf
    v_and_b32_dpp v109, v124, v11 row_newbcast:12 row_mask:0xf bank_mask:0xf
    v_and_b32_dpp v110, v124, v12 row_newbcast:12 row_mask:0xf bank_mask:0xf
    v_and_b32_dpp v111, v124, v13 row_newbcast:12 row_mask:0xf bank_mask:0xf
    s_waitcnt vmcnt(5)
    v_mfma_f32_16x16x32_bf16 v[116:119], v[176:179], v[96:99], v[116:119]
    s_waitcnt vmcnt(4)
    buffer_load_dwordx4 v[136:139], v76, s[52:55], s85 offen offset:1024 nt
    v_mfma_f32_16x16x32_bf16 v[116:119], v[180:183], v[100:103], v[116:119]
    s_waitcnt vmcnt(4)
    buffer_load_dwordx4 v[140:143], v77, s[52:55], s85 offen offset:1024 nt
    v_mfma_f32_16x16x32_bf16 v[116:119], v[184:187], v[104:107], v[116:119]
    s_waitcnt vmcnt(4)
    buffer_load_dwordx4 v[144:147], v126, s[56:59], s85 offen offset:0 nt
    v_mfma_f32_16x16x32_bf16 v[116:119], v[188:191], v[108:111], v[116:119]
    s_cmp_lt_u32 s87, 231
    s_cbranch_scc1 L_bloop
    buffer_load_dwordx4 v[148:151], v127, s[56:59], s85 offen offset:0 nt
    buffer_load_dwordx4 v[152:155], v126, s[56:59], s85 offen offset:1024 nt
    buffer_load_dwordx4 v[156:159], v127, s[56:59], s85 offen offset:1024 nt
    s_sub_u32 s37, s87, 238
    v_mov_b32 v19, s37
L_dloop:
    s_waitcnt vmcnt(7)
    v_readfirstlane_b32 s93, v19
    s_nop 0
    s_sub_u32 s36, s93, 18
    s_and_b32 s38, s36, 3
    s_mul_i32 s38, s38, 7
    s_lshr_b32 s36, s36, 2
    s_add_u32 s87, s38, s36
    s_add_u32 s38, s93, 238
    s_cmp_lt_i32 s93, 18
    s_cselect_b32 s87, s38, s87
    s_add_u32 s93, s93, 8
    s_add_u32 s39, s87, s88
    s_bfe_u32 s37, s39, 0x30000
    s_lshl_b32 s37, s37, 12
    s_add_u32 s86, s37, s89
    s_bfe_u32 s37, s39, 0x10003
    s_lshl_b32 s37, s37, 11
    s_add_u32 s86, s37, s86
    s_bfe_u32 s37, s39, 0x40004
    s_lshl_b32 s37, s37, 16
    s_add_u32 s86, s37, s86
    s_cmp_ge_u32 s93, 38
    s_cselect_b32 s86, 134217728, s86
    v_mov_b32 v19, 30
    s_cmp_ge_u32 s93, 37
    s_cbranch_scc1 L_noclaim_14
    s_mov_b64 exec, 1
    global_atomic_add v19, v9, v18, s[30:31] sc0 sc1
    s_mov_b64 exec, -1
L_noclaim_14:
    buffer_load_dwordx4 v[160:163], v76, s[52:55], s86 offen offset:0 nt
    v_mfma_f32_16x16x32_bf16 v[112:115], v[128:131], v[80:83], 0
    s_waitcnt vmcnt(7)
    buffer_load_dwordx4 v[164:167], v77, s[52:55], s86 offen offset:0 nt
    v_mfma_f32_16x16x32_bf16 v[112:115], v[132:135], v[84:87], v[112:115]
    s_waitcnt vmcnt(7)
    buffer_load_dwordx4 v[168:171], v76, s[52:55], s86 offen offset:1024 nt
    v_mfma_f32_16x16x32_bf16 v[112:115], v[136:139], v[88:91], v[112:115]
    s_waitcnt vmcnt(7)
    buffer_load_dwordx4 v[172:175], v77, s[52:55], s86 offen offset:1024 nt
    v_mfma_f32_16x16x32_bf16 v[112:115], v[140:143], v[92:95], v[112:115]
    s_nop 7
    v_mov_b32_dpp v122, v112 quad_perm:[0,0,0,0] row_mask:0xf bank_mask:0xf
    v_mov_b32_dpp v124, v114 quad_perm:[2,2,2,2] row_mask:0xf bank_mask:0xf
    s_nop 0
    v_add_f32_dpp v122, v113, v122 quad_perm:[1,1,1,1] row_mask:0xf bank_mask:0xf
    v_add_f32_dpp v124, v115, v124 quad_perm:[3,3,3,3] row_mask:0xf bank_mask:0xf
    v_add_f32 v122, v122, v124
    v_fma_f32 v123, v122, s83, -v120
    v_cmp_lt_f32 vcc, 0, v123
    s_cbranch_vccz L_nomax_15
    v_mul_f32 v122, s83, v122
    s_nop 1
    v_max_f32_dpp v124, v122, v122 row_ror:4 row_mask:0xf bank_mask:0xf
    s_nop 1
    v_max_f32_dpp v124, v124, v124 row_ror:8 row_mask:0xf bank_mask:0xf
    v_mov_b32 v125, v124
    s_nop 1
    v_permlane16_swap_b32 v124, v125
    v_max_f32 v124, v124, v125
    v_mov_b32 v125, v124
    s_nop 1
    v_permlane32_swap_b32 v124, v125
    v_max_f32 v124, v124, v125
    v_and_b32 v124, s82, v124
    v_max_f32 v124, v124, v120
    v_sub_f32 v125, v120, v124
    v_exp_f32 v125, v125
    v_mov_b32 v120, v124
    v_sub_f32 v123, v122, v124
    v_mul_f32 v121, v121, v125
    v_mul_f32 v116, v116, v125
    v_mul_f32 v117, v117, v125
    v_mul_f32 v118, v118, v125
    v_mul_f32 v119, v119, v125
L_nomax_15:
    v_exp_f32 v123, v123
    s_nop 0
    v_cvt_pk_bf16_f32 v124, v123, v123
    v_add_f32 v121, v121, v123
    s_nop 0
    v_and_b32_dpp v96, v124, v10 row_newbcast:0 row_mask:0xf bank_mask:0xf
    v_and_b32_dpp v97, v124, v11 row_newbcast:0 row_mask:0xf bank_mask:0xf
    v_and_b32_dpp v98, v124, v12 row_newbcast:0 row_mask:0xf bank_mask:0xf
    v_and_b32_dpp v99, v124, v13 row_newbcast:0 row_mask:0xf bank_mask:0xf
    v_and_b32_dpp v100, v124, v10 row_newbcast:4 row_mask:0xf bank_mask:0xf
    v_and_b32_dpp v101, v124, v11 row_newbcast:4 row_mask:0xf bank_mask:0xf
    v_and_b32_dpp v102, v124, v12 row_newbcast:4 row_mask:0xf bank_mask:0xf
    v_and_b32_dpp v103, v124, v13 row_newbcast:4 row_mask:0xf bank_mask:0xf
    v_and_b32_dpp v104, v124, v10 row_newbcast:8 row_mask:0xf bank_mask:0xf
    v_and_b32_dpp v105, v124, v11 row_newbcast:8 row_mask:0xf bank_mask:0xf
    v_and_b32_dpp v106, v124, v12 row_newbcast:8 row_mask:0xf bank_mask:0xf
    v_and_b32_dpp v107, v124, v13 row_newbcast:8 row_mask:0xf bank_mask:0xf
    v_and_b32_dpp v108, v124, v10 row_newbcast:12 row_mask:0xf bank_mask:0xf
    v_and_b32_dpp v109, v124, v11 row_newbcast:12 row_mask:0xf bank_mask:0xf
    v_and_b32_dpp v110, v124, v12 row_newbcast:12 row_mask:0xf bank_mask:0xf
    v_and_b32_dpp v111, v124, v13 row_newbcast:12 row_mask:0xf bank_mask:0xf
    s_waitcnt vmcnt(7)
    buffer_load_dwordx4 v[176:179], v126, s[56:59], s86 offen offset:0 nt
    v_mfma_f32_16x16x32_bf16 v[116:119], v[144:147], v[96:99], v[116:119]
    s_waitcnt vmcnt(7)
    buffer_load_dwordx4 v[180:183], v127, s[56:59], s86 offen offset:0 nt
    v_mfma_f32_16x16x32_bf16 v[116:119], v[148:151], v[100:103], v[116:119]
    s_waitcnt vmcnt(7)
    buffer_load_dwordx4 v[184:187], v126, s[56:59], s86 offen offset:1024 nt
    v_mfma_f32_16x16x32_bf16 v[116:119], v[152:155], v[104:107], v[116:119]
    s_waitcnt vmcnt(7)
    buffer_load_dwordx4 v[188:191], v127, s[56:59], s86 offen offset:1024 nt
    v_mfma_f32_16x16x32_bf16 v[116:119], v[156:159], v[108:111], v[116:119]
    s_cmp_ge_u32 s93, 38
    s_cbranch_scc1 L_bdone
    s_waitcnt vmcnt(7)
    v_readfirstlane_b32 s93, v19
    s_nop 0
    s_sub_u32 s36, s93, 18
    s_and_b32 s38, s36, 3
    s_mul_i32 s38, s38, 7
    s_lshr_b32 s36, s36, 2
    s_add_u32 s87, s38, s36
    s_add_u32 s38, s93, 238
    s_cmp_lt_i32 s93, 18
    s_cselect_b32 s87, s38, s87
    s_add_u32 s93, s93, 8
    s_add_u32 s39, s87, s88
    s_bfe_u32 s37, s39, 0x30000
    s_lshl_b32 s37, s37, 12
    s_add_u32 s85, s37, s89
    s_bfe_u32 s37, s39, 0x10003
    s_lshl_b32 s37, s37, 11
    s_add_u32 s85, s37, s85
    s_bfe_u32 s37, s39, 0x40004
    s_lshl_b32 s37, s37, 16
    s_add_u32 s85, s37, s85
    s_cmp_ge_u32 s93, 38
    s_cselect_b32 s85, 134217728, s85
    v_mov_b32 v19, 30
    s_cmp_ge_u32 s93, 37
    s_cbranch_scc1 L_noclaim_16
    s_mov_b64 exec, 1
    global_atomic_add v19, v9, v18, s[30:31] sc0 sc1
    s_mov_b64 exec, -1
L_noclaim_16:
    buffer_load_dwordx4 v[128:131], v76, s[52:55], s85 offen offset:0 nt
    v_mfma_f32_16x16x32_bf16 v[112:115], v[160:163], v[80:83], 0
    s_waitcnt vmcnt(7)
    buffer_load_dwordx4 v[132:135], v77, s[52:55], s85 offen offset:0 nt
    v_mfma_f32_16x16x32_bf16 v[112:115], v[164:167], v[84:87], v[112:115]
    s_waitcnt vmcnt(7)
    buffer_load_dwordx4 v[136:139], v76, s[52:55], s85 offen offset:1024 nt
    v_mfma_f32_16x16x32_bf16 v[112:115], v[168:171], v[88:91], v[112:115]
    s_waitcnt vmcnt(7)
    buffer_load_dwordx4 v[140:143], v77, s[52:55], s85 offen offset:1024 nt
    v_mfma_f32_16x16x32_bf16 v[112:115], v[172:175], v[92:95], v[112:115]
    s_nop 7
    v_mov_b32_dpp v122, v112 quad_perm:[0,0,0,0] row_mask:0xf bank_mask:0xf
    v_mov_b32_dpp v124, v114 quad_perm:[2,2,2,2] row_mask:0xf bank_mask:0xf
    s_nop 0
    v_add_f32_dpp v122, v113, v122 quad_perm:[1,1,1,1] row_mask:0xf bank_mask:0xf
    v_add_f32_dpp v124, v115, v124 quad_perm:[3,3,3,3] row_mask:0xf bank_mask:0xf
    v_add_f32 v122, v122, v124
    v_fma_f32 v123, v122, s83, -v120
    v_cmp_lt_f32 vcc, 0, v123
    s_cbranch_vccz L_nomax_17
    v_mul_f32 v122, s83, v122
    s_nop 1
    v_max_f32_dpp v124, v122, v122 row_ror:4 row_mask:0xf bank_mask:0xf
    s_nop 1
    v_max_f32_dpp v124, v124, v124 row_ror:8 row_mask:0xf bank_mask:0xf
    v_mov_b32 v125, v124
    s_nop 1
    v_permlane16_swap_b32 v124, v125
    v_max_f32 v124, v124, v125
    v_mov_b32 v125, v124
    s_nop 1
    v_permlane32_swap_b32 v124, v125
    v_max_f32 v124, v124, v125
    v_and_b32 v124, s82, v124
    v_max_f32 v124, v124, v120
    v_sub_f32 v125, v120, v124
    v_exp_f32 v125, v125
    v_mov_b32 v120, v124
    v_sub_f32 v123, v122, v124
    v_mul_f32 v121, v121, v125
    v_mul_f32 v116, v116, v125
    v_mul_f32 v117, v117, v125
    v_mul_f32 v118, v118, v125
    v_mul_f32 v119, v119, v125
L_nomax_17:
    v_exp_f32 v123, v123
    s_nop 0
    v_cvt_pk_bf16_f32 v124, v123, v123
    v_add_f32 v121, v121, v123
    s_nop 0
    v_and_b32_dpp v96, v124, v10 row_newbcast:0 row_mask:0xf bank_mask:0xf
    v_and_b32_dpp v97, v124, v11 row_newbcast:0 row_mask:0xf bank_mask:0xf
    v_and_b32_dpp v98, v124, v12 row_newbcast:0 row_mask:0xf bank_mask:0xf
    v_and_b32_dpp v99, v124, v13 row_newbcast:0 row_mask:0xf bank_mask:0xf
    v_and_b32_dpp v100, v124, v10 row_newbcast:4 row_mask:0xf bank_mask:0xf
    v_and_b32_dpp v101, v124, v11 row_newbcast:4 row_mask:0xf bank_mask:0xf
    v_and_b32_dpp v102, v124, v12 row_newbcast:4 row_mask:0xf bank_mask:0xf
    v_and_b32_dpp v103, v124, v13 row_newbcast:4 row_mask:0xf bank_mask:0xf
    v_and_b32_dpp v104, v124, v10 row_newbcast:8 row_mask:0xf bank_mask:0xf
    v_and_b32_dpp v105, v124, v11 row_newbcast:8 row_mask:0xf bank_mask:0xf
    v_and_b32_dpp v106, v124, v12 row_newbcast:8 row_mask:0xf bank_mask:0xf
    v_and_b32_dpp v107, v124, v13 row_newbcast:8 row_mask:0xf bank_mask:0xf
    v_and_b32_dpp v108, v124, v10 row_newbcast:12 row_mask:0xf bank_mask:0xf
    v_and_b32_dpp v109, v124, v11 row_newbcast:12 row_mask:0xf bank_mask:0xf
    v_and_b32_dpp v110, v124, v12 row_newbcast:12 row_mask:0xf bank_mask:0xf
    v_and_b32_dpp v111, v124, v13 row_newbcast:12 row_mask:0xf bank_mask:0xf
    s_waitcnt vmcnt(7)
    buffer_load_dwordx4 v[144:147], v126, s[56:59], s85 offen offset:0 nt
    v_mfma_f32_16x16x32_bf16 v[116:119], v[176:179], v[96:99], v[116:119]
    s_waitcnt vmcnt(7)
    buffer_load_dwordx4 v[148:151], v127, s[56:59], s85 offen offset:0 nt
    v_mfma_f32_16x16x32_bf16 v[116:119], v[180:183], v[100:103], v[116:119]
    s_waitcnt vmcnt(7)
    buffer_load_dwordx4 v[152:155], v126, s[56:59], s85 offen offset:1024 nt
    v_mfma_f32_16x16x32_bf16 v[116:119], v[184:187], v[104:107], v[116:119]
    s_waitcnt vmcnt(7)
    buffer_load_dwordx4 v[156:159], v127, s[56:59], s85 offen offset:1024 nt
    v_mfma_f32_16x16x32_bf16 v[116:119], v[188:191], v[108:111], v[116:119]
    s_cmp_ge_u32 s93, 38
    s_cbranch_scc0 L_dloop
L_bdone:
    v_add_f32_dpp v121, v121, v121 row_ror:8 row_mask:0xf bank_mask:0xf
    s_nop 1
    v_add_f32_dpp v121, v121, v121 row_ror:4 row_mask:0xf bank_mask:0xf
    v_mov_b32 v125, v121
    s_nop 1
    v_permlane16_swap_b32 v121, v125
    v_add_f32 v121, v121, v125
    v_mov_b32 v125, v121
    v_and_or_b32 v118, v118, s82, v8
    v_and_or_b32 v119, v119, s82, v8
    v_permlane32_swap_b32 v121, v125
    s_mov_b32 exec_lo, 0x100
    s_mov_b32 exec_hi, 0x0
    v_add_f32 v117, v121, v125
    v_mov_b32 v116, v120
    s_mov_b32 exec_lo, 0xff01ff
    s_mov_b32 exec_hi, 0xff00ff
    v_and_or_b32 v116, v116, s82, v8
    v_and_or_b32 v117, v117, s82, v8
    buffer_store_dwordx4 v[116:119], v79, s[48:51], s96 offen sc1
    s_endpgm
L_qp:
    v_lshlrev_b32 v4, 18, v2
    v_lshl_add_u32 v14, v3, 4, v4
    v_lshrrev_b32 v5, 3, v3
    v_lshlrev_b32 v5, 10, v5
    v_lshl_add_u32 v15, v2, 6, v5
    s_cmp_eq_u32 s33, 0
    s_cselect_b32 s61, 3, 2
    s_xor_b32 s61, s61, s32
    s_lshl_b32 s86, s34, 8
    s_lshl_b32 s63, s34, 20
    s_lshl_b32 s38, s61, 8
    s_add_u32 s63, s63, s38
    s_mov_b32 s42, 4194304
    s_mov_b32 s43, 0x20000
    s_mov_b32 s46, 4096
    s_mov_b32 s47, 0x20000
    s_cmp_eq_u32 s33, 0
    s_waitcnt lgkmcnt(0)
    s_cselect_b64 s[40:41], s[22:23], s[8:9]
    s_cselect_b64 s[44:45], s[16:17], s[4:5]
    buffer_load_dwordx4 a[128:131], v14, s[40:43], s63 offen nt
    s_add_u32 s63, s63, 8192
    buffer_load_dwordx4 a[132:135], v14, s[40:43], s63 offen nt
    s_add_u32 s63, s63, 8192
    buffer_load_dwordx4 v[20:23], v15, s[44:47], s86 offen offset:0
    buffer_load_dwordx4 v[36:39], v15, s[44:47], s86 offen offset:2048
    buffer_load_dwordx4 a[136:139], v14, s[40:43], s63 offen nt
    s_add_u32 s63, s63, 8192
    buffer_load_dwordx4 a[140:143], v14, s[40:43], s63 offen nt
    s_add_u32 s63, s63, 8192
    buffer_load_dwordx4 a[144:147], v14, s[40:43], s63 offen nt
    s_add_u32 s63, s63, 8192
    buffer_load_dwordx4 a[148:151], v14, s[40:43], s63 offen nt
    s_add_u32 s63, s63, 8192
    buffer_load_dwordx4 a[152:155], v14, s[40:43], s63 offen nt
    s_add_u32 s63, s63, 8192
    buffer_load_dwordx4 a[156:159], v14, s[40:43], s63 offen nt
    s_add_u32 s63, s63, 8192
    s_getpc_b64 s[36:37]
L_pc_18:
    s_sub_u32 s36, s36, L_pc_18 - concat_heads__compressed_kv_cla__mha_block_cached__decode_kernel
    s_subb_u32 s37, s37, 0
    s_lshl_b32 s38, s32, 10
    v_lshl_add_u32 v6, v0, 2, s38
    v_mov_b32 v7, s37
    v_add_co_u32 v6, vcc, s36, v6
    s_nop 1
    v_addc_co_u32 v7, vcc, 0, v7, vcc
    global_load_dword v0, v[6:7], off
    s_load_dword s35, s[30:31], 0
    s_mov_b32 s48, s30
    s_and_b32 s49, s31, 0xffff
    s_mov_b32 s50, 8388608
    s_mov_b32 s51, 0x20000
    s_mov_b32 s82, 0xffffff00
    s_mov_b32 s83, 0x3e0293ee
    s_mov_b32 s84, 2097152
    v_and_b32 v4, 1, v1
    v_lshlrev_b32 v4, 4, v4
    v_mov_b32 v5, 0xffff
    v_lshlrev_b32 v4, v4, v5
    v_bfe_u32 v5, v1, 1, 2
    v_cmp_eq_u32 vcc, 0, v5
    s_nop 1
    v_cndmask_b32 v10, 0, v4, vcc
    v_cmp_eq_u32 vcc, 1, v5
    s_nop 1
    v_cndmask_b32 v11, 0, v4, vcc
    v_cmp_eq_u32 vcc, 2, v5
    s_nop 1
    v_cndmask_b32 v12, 0, v4, vcc
    v_cmp_eq_u32 vcc, 3, v5
    s_nop 1
    v_cndmask_b32 v13, 0, v4, vcc
    buffer_load_dwordx4 v[24:27], v15, s[44:47], s86 offen offset:16
    buffer_load_dwordx4 v[40:43], v15, s[44:47], s86 offen offset:2064
    buffer_load_dwordx4 v[28:31], v15, s[44:47], s86 offen offset:32
    buffer_load_dwordx4 v[44:47], v15, s[44:47], s86 offen offset:2080
    buffer_load_dwordx4 v[32:35], v15, s[44:47], s86 offen offset:48
    buffer_load_dwordx4 v[48:51], v15, s[44:47], s86 offen offset:2096
    s_lshl_b32 s38, s61, 2
    s_add_u32 s38, s38, s34
    s_lshl_b32 s38, s38, 8
    s_add_u32 s38, s38, 65536
    v_mov_b32 v19, 0
    s_cmp_eq_u32 s33, 0
    s_cselect_b32 s38, s38, 8388608
    s_mov_b64 exec, 1
    buffer_store_dword v19, v19, s[48:51], s38 offen sc1
    s_mov_b64 exec, -1
    s_mov_b32 s80, 0x01000100
    s_mov_b32 s81, 0x03020302
    s_waitcnt vmcnt(14)
    buffer_load_dwordx4 a[160:163], v14, s[40:43], s63 offen nt
    s_add_u32 s63, s63, 8192
    v_perm_b32 v4, v20, v20, s80
    v_perm_b32 v5, v36, v36, s80
    v_and_b32 v52, v4, v10
    v_and_b32 v53, v4, v11
    v_and_b32 v54, v4, v12
    v_and_b32 v55, v4, v13
    v_and_b32 v56, v5, v10
    v_and_b32 v57, v5, v11
    v_and_b32 v58, v5, v12
    v_and_b32 v59, v5, v13
    v_mfma_f32_16x16x32_bf16 v[60:63], a[128:131], v[52:55], 0
    s_nop 0
    v_mfma_f32_16x16x32_bf16 v[64:67], a[128:131], v[56:59], 0
    buffer_load_dwordx4 a[164:167], v14, s[40:43], s63 offen nt
    s_add_u32 s63, s63, 8192
    v_perm_b32 v4, v20, v20, s81
    v_perm_b32 v5, v36, v36, s81
    v_and_b32 v52, v4, v10
    v_and_b32 v53, v4, v11
    v_and_b32 v54, v4, v12
    v_and_b32 v55, v4, v13
    v_and_b32 v56, v5, v10
    v_and_b32 v57, v5, v11
    v_and_b32 v58, v5, v12
    v_and_b32 v59, v5, v13
    v_mfma_f32_16x16x32_bf16 v[60:63], a[132:135], v[52:55], v[60:63]
    s_nop 0
    v_mfma_f32_16x16x32_bf16 v[64:67], a[132:135], v[56:59], v[64:67]
    s_waitcnt vmcnt(15)
    buffer_load_dwordx4 a[168:171], v14, s[40:43], s63 offen nt
    s_add_u32 s63, s63, 8192
    v_perm_b32 v4, v21, v21, s80
    v_perm_b32 v5, v37, v37, s80
    v_and_b32 v52, v4, v10
    v_and_b32 v53, v4, v11
    v_and_b32 v54, v4, v12
    v_and_b32 v55, v4, v13
    v_and_b32 v56, v5, v10
    v_and_b32 v57, v5, v11
    v_and_b32 v58, v5, v12
    v_and_b32 v59, v5, v13
    v_mfma_f32_16x16x32_bf16 v[60:63], a[136:139], v[52:55], v[60:63]
    s_nop 0
    v_mfma_f32_16x16x32_bf16 v[64:67], a[136:139], v[56:59], v[64:67]
    s_waitcnt vmcnt(15)
    buffer_load_dwordx4 a[172:175], v14, s[40:43], s63 offen nt
    s_add_u32 s63, s63, 8192
    v_perm_b32 v4, v21, v21, s81
    v_perm_b32 v5, v37, v37, s81
    v_and_b32 v52, v4, v10
    v_and_b32 v53, v4, v11
    v_and_b32 v54, v4, v12
    v_and_b32 v55, v4, v13
    v_and_b32 v56, v5, v10
    v_and_b32 v57, v5, v11
    v_and_b32 v58, v5, v12
    v_and_b32 v59, v5, v13
    v_mfma_f32_16x16x32_bf16 v[60:63], a[140:143], v[52:55], v[60:63]
    s_nop 0
    v_mfma_f32_16x16x32_bf16 v[64:67], a[140:143], v[56:59], v[64:67]
    s_waitcnt vmcnt(15)
    buffer_load_dwordx4 a[176:179], v14, s[40:43], s63 offen nt
    s_add_u32 s63, s63, 8192
    v_lshrrev_b32 v4, 2, v3
    v_and_b32 v5, 3, v3
    v_lshlrev_b32 v76, 8, v4
    v_lshlrev_b32 v126, 8, v2
    v_lshl_add_u32 v76, v2, 6, v76
    v_lshl_add_u32 v76, v5, 4, v76
    v_lshl_add_u32 v126, v3, 4, v126
    v_xor_b32 v77, 32768, v76
    v_xor_b32 v127, 32768, v126
    s_add_u32 s3, s34, s33
    s_and_b32 s3, s3, 3
    s_lshl_b32 s89, s3, 5
    s_add_u32 s89, s89, s32
    s_lshl_b32 s89, s89, 20
    s_mul_i32 s88, s32, 8
    s_add_u32 s88, s88, s3
    s_add_u32 s87, s33, 28
    v_perm_b32 v4, v22, v22, s80
    v_perm_b32 v5, v38, v38, s80
    v_and_b32 v52, v4, v10
    v_and_b32 v53, v4, v11
    v_and_b32 v54, v4, v12
    v_and_b32 v55, v4, v13
    v_and_b32 v56, v5, v10
    v_and_b32 v57, v5, v11
    v_and_b32 v58, v5, v12
    v_and_b32 v59, v5, v13
    v_mfma_f32_16x16x32_bf16 v[60:63], a[144:147], v[52:55], v[60:63]
    s_nop 0
    v_mfma_f32_16x16x32_bf16 v[64:67], a[144:147], v[56:59], v[64:67]
    s_waitcnt vmcnt(15)
    buffer_load_dwordx4 a[180:183], v14, s[40:43], s63 offen nt
    s_add_u32 s63, s63, 8192
    v_perm_b32 v4, v22, v22, s81
    v_perm_b32 v5, v38, v38, s81
    v_and_b32 v52, v4, v10
    v_and_b32 v53, v4, v11
    v_and_b32 v54, v4, v12
    v_and_b32 v55, v4, v13
    v_and_b32 v56, v5, v10
    v_and_b32 v57, v5, v11
    v_and_b32 v58, v5, v12
    v_and_b32 v59, v5, v13
    v_mfma_f32_16x16x32_bf16 v[60:63], a[148:151], v[52:55], v[60:63]
    s_nop 0
    v_mfma_f32_16x16x32_bf16 v[64:67], a[148:151], v[56:59], v[64:67]
    s_waitcnt vmcnt(15)
    buffer_load_dwordx4 a[184:187], v14, s[40:43], s63 offen nt
    s_add_u32 s63, s63, 8192
    v_perm_b32 v4, v23, v23, s80
    v_perm_b32 v5, v39, v39, s80
    v_and_b32 v52, v4, v10
    v_and_b32 v53, v4, v11
    v_and_b32 v54, v4, v12
    v_and_b32 v55, v4, v13
    v_and_b32 v56, v5, v10
    v_and_b32 v57, v5, v11
    v_and_b32 v58, v5, v12
    v_and_b32 v59, v5, v13
    v_mfma_f32_16x16x32_bf16 v[60:63], a[152:155], v[52:55], v[60:63]
    s_nop 0
    v_mfma_f32_16x16x32_bf16 v[64:67], a[152:155], v[56:59], v[64:67]
    s_waitcnt vmcnt(15)
    buffer_load_dwordx4 a[188:191], v14, s[40:43], s63 offen nt
    s_add_u32 s63, s63, 8192
    v_perm_b32 v4, v23, v23, s81
    v_perm_b32 v5, v39, v39, s81
    v_and_b32 v52, v4, v10
    v_and_b32 v53, v4, v11
    v_and_b32 v54, v4, v12
    v_and_b32 v55, v4, v13
    v_and_b32 v56, v5, v10
    v_and_b32 v57, v5, v11
    v_and_b32 v58, v5, v12
    v_and_b32 v59, v5, v13
    v_mfma_f32_16x16x32_bf16 v[60:63], a[156:159], v[52:55], v[60:63]
    s_nop 0
    v_mfma_f32_16x16x32_bf16 v[64:67], a[156:159], v[56:59], v[64:67]
    s_waitcnt vmcnt(13)
    s_waitcnt vmcnt(7)
    buffer_load_dwordx4 a[192:195], v14, s[40:43], s63 offen nt
    s_add_u32 s63, s63, 8192
    s_mov_b32 s52, s18
    s_and_b32 s53, s19, 0xffff
    s_mov_b32 s54, 134217728
    s_mov_b32 s55, 0x20000
    s_mov_b32 s56, s20
    s_and_b32 s57, s21, 0xffff
    s_mov_b32 s58, 134217728
    s_mov_b32 s59, 0x20000
    v_perm_b32 v4, v24, v24, s80
    v_perm_b32 v5, v40, v40, s80
    v_and_b32 v52, v4, v10
    v_and_b32 v53, v4, v11
    v_and_b32 v54, v4, v12
    v_and_b32 v55, v4, v13
    v_and_b32 v56, v5, v10
    v_and_b32 v57, v5, v11
    v_and_b32 v58, v5, v12
    v_and_b32 v59, v5, v13
    v_mfma_f32_16x16x32_bf16 v[60:63], a[160:163], v[52:55], v[60:63]
    s_nop 0
    v_mfma_f32_16x16x32_bf16 v[64:67], a[160:163], v[56:59], v[64:67]
    s_waitcnt vmcnt(7)
    buffer_load_dwordx4 a[196:199], v14, s[40:43], s63 offen nt
    s_add_u32 s63, s63, 8192
    v_perm_b32 v4, v24, v24, s81
    v_perm_b32 v5, v40, v40, s81
    v_and_b32 v52, v4, v10
    v_and_b32 v53, v4, v11
    v_and_b32 v54, v4, v12
    v_and_b32 v55, v4, v13
    v_and_b32 v56, v5, v10
    v_and_b32 v57, v5, v11
    v_and_b32 v58, v5, v12
    v_and_b32 v59, v5, v13
    v_mfma_f32_16x16x32_bf16 v[60:63], a[164:167], v[52:55], v[60:63]
    s_nop 0
    v_mfma_f32_16x16x32_bf16 v[64:67], a[164:167], v[56:59], v[64:67]
    s_waitcnt vmcnt(7)
    buffer_load_dwordx4 a[200:203], v14, s[40:43], s63 offen nt
    s_add_u32 s63, s63, 8192
    v_perm_b32 v4, v25, v25, s80
    v_perm_b32 v5, v41, v41, s80
    v_and_b32 v52, v4, v10
    v_and_b32 v53, v4, v11
    v_and_b32 v54, v4, v12
    v_and_b32 v55, v4, v13
    v_and_b32 v56, v5, v10
    v_and_b32 v57, v5, v11
    v_and_b32 v58, v5, v12
    v_and_b32 v59, v5, v13
    v_mfma_f32_16x16x32_bf16 v[60:63], a[168:171], v[52:55], v[60:63]
    s_nop 0
    v_mfma_f32_16x16x32_bf16 v[64:67], a[168:171], v[56:59], v[64:67]
    s_waitcnt vmcnt(7)
    buffer_load_dwordx4 a[204:207], v14, s[40:43], s63 offen nt
    s_add_u32 s63, s63, 8192
    v_perm_b32 v4, v25, v25, s81
    v_perm_b32 v5, v41, v41, s81
    v_and_b32 v52, v4, v10
    v_and_b32 v53, v4, v11
    v_and_b32 v54, v4, v12
    v_and_b32 v55, v4, v13
    v_and_b32 v56, v5, v10
    v_and_b32 v57, v5, v11
    v_and_b32 v58, v5, v12
    v_and_b32 v59, v5, v13
    v_mfma_f32_16x16x32_bf16 v[60:63], a[172:175], v[52:55], v[60:63]
    s_nop 0
    v_mfma_f32_16x16x32_bf16 v[64:67], a[172:175], v[56:59], v[64:67]
    s_waitcnt vmcnt(7)
    buffer_load_dwordx4 a[208:211], v14, s[40:43], s63 offen nt
    s_add_u32 s63, s63, 8192
    v_mov_b32 v120, 0xff7f0000
    v_mov_b32 v121, 0
    v_mov_b32 v18, 1
    v_mov_b32 v116, 0
    v_mov_b32 v117, 0
    v_mov_b32 v118, 0
    v_mov_b32 v119, 0
    s_lshl_b32 s38, s32, 2
    s_add_u32 s38, s38, s3
    s_lshl_b32 s96, s38, 3
    s_lshl_b32 s38, s38, 8
    s_add_u32 s38, s38, 65536
    v_mov_b32 v9, s38
    s_add_u32 s96, s96, s33
    s_lshl_b32 s96, s96, 10
    s_add_u32 s96, s96, 5242880
    v_and_b32 v5, 3, v3
    v_lshlrev_b32 v78, 7, v2
    v_lshl_add_u32 v78, v5, 5, v78
    s_lshl_b32 s91, s32, 12
    s_lshl_b32 s38, s3, 9
    s_add_u32 s91, s91, s38
    s_add_u32 s91, s91, 1048576
    v_lshlrev_b32 v4, 7, v2
    v_lshl_add_u32 v4, v3, 4, v4
    v_mov_b32 v5, 512
    v_cmp_gt_u32 vcc, 8, v3
    s_nop 1
    v_cndmask_b32 v79, v5, v4, vcc
    v_perm_b32 v4, v26, v26, s80
    v_perm_b32 v5, v42, v42, s80
    v_and_b32 v52, v4, v10
    v_and_b32 v53, v4, v11
    v_and_b32 v54, v4, v12
    v_and_b32 v55, v4, v13
    v_and_b32 v56, v5, v10
    v_and_b32 v57, v5, v11
    v_and_b32 v58, v5, v12
    v_and_b32 v59, v5, v13
    v_mfma_f32_16x16x32_bf16 v[60:63], a[176:179], v[52:55], v[60:63]
    s_nop 0
    v_mfma_f32_16x16x32_bf16 v[64:67], a[176:179], v[56:59], v[64:67]
    s_waitcnt vmcnt(7)
    buffer_load_dwordx4 a[212:215], v14, s[40:43], s63 offen nt
    s_add_u32 s63, s63, 8192
    v_perm_b32 v4, v26, v26, s81
    v_perm_b32 v5, v42, v42, s81
    v_and_b32 v52, v4, v10
    v_and_b32 v53, v4, v11
    v_and_b32 v54, v4, v12
    v_and_b32 v55, v4, v13
    v_and_b32 v56, v5, v10
    v_and_b32 v57, v5, v11
    v_and_b32 v58, v5, v12
    v_and_b32 v59, v5, v13
    v_mfma_f32_16x16x32_bf16 v[60:63], a[180:183], v[52:55], v[60:63]
    s_nop 0
    v_mfma_f32_16x16x32_bf16 v[64:67], a[180:183], v[56:59], v[64:67]
    s_waitcnt vmcnt(7)
    buffer_load_dwordx4 a[216:219], v14, s[40:43], s63 offen nt
    s_add_u32 s63, s63, 8192
    v_perm_b32 v4, v27, v27, s80
    v_perm_b32 v5, v43, v43, s80
    v_and_b32 v52, v4, v10
    v_and_b32 v53, v4, v11
    v_and_b32 v54, v4, v12
    v_and_b32 v55, v4, v13
    v_and_b32 v56, v5, v10
    v_and_b32 v57, v5, v11
    v_and_b32 v58, v5, v12
    v_and_b32 v59, v5, v13
    v_mfma_f32_16x16x32_bf16 v[60:63], a[184:187], v[52:55], v[60:63]
    s_nop 0
    v_mfma_f32_16x16x32_bf16 v[64:67], a[184:187], v[56:59], v[64:67]
    s_waitcnt vmcnt(7)
    buffer_load_dwordx4 a[220:223], v14, s[40:43], s63 offen nt
    s_add_u32 s63, s63, 8192
    v_perm_b32 v4, v27, v27, s81
    v_perm_b32 v5, v43, v43, s81
    v_and_b32 v52, v4, v10
    v_and_b32 v53, v4, v11
    v_and_b32 v54, v4, v12
    v_and_b32 v55, v4, v13
    v_and_b32 v56, v5, v10
    v_and_b32 v57, v5, v11
    v_and_b32 v58, v5, v12
    v_and_b32 v59, v5, v13
    v_mfma_f32_16x16x32_bf16 v[60:63], a[188:191], v[52:55], v[60:63]
    s_nop 0
    v_mfma_f32_16x16x32_bf16 v[64:67], a[188:191], v[56:59], v[64:67]
    s_waitcnt vmcnt(7)
    buffer_load_dwordx4 a[224:227], v14, s[40:43], s63 offen nt
    s_add_u32 s63, s63, 8192
    v_perm_b32 v4, v28, v28, s80
    v_perm_b32 v5, v44, v44, s80
    v_and_b32 v52, v4, v10
    v_and_b32 v53, v4, v11
    v_and_b32 v54, v4, v12
    v_and_b32 v55, v4, v13
    v_and_b32 v56, v5, v10
    v_and_b32 v57, v5, v11
    v_and_b32 v58, v5, v12
    v_and_b32 v59, v5, v13
    v_mfma_f32_16x16x32_bf16 v[60:63], a[192:195], v[52:55], v[60:63]
    s_nop 0
    v_mfma_f32_16x16x32_bf16 v[64:67], a[192:195], v[56:59], v[64:67]
    s_waitcnt vmcnt(7)
    buffer_load_dwordx4 a[228:231], v14, s[40:43], s63 offen nt
    s_add_u32 s63, s63, 8192
    v_perm_b32 v4, v28, v28, s81
    v_perm_b32 v5, v44, v44, s81
    v_and_b32 v52, v4, v10
    v_and_b32 v53, v4, v11
    v_and_b32 v54, v4, v12
    v_and_b32 v55, v4, v13
    v_and_b32 v56, v5, v10
    v_and_b32 v57, v5, v11
    v_and_b32 v58, v5, v12
    v_and_b32 v59, v5, v13
    v_mfma_f32_16x16x32_bf16 v[60:63], a[196:199], v[52:55], v[60:63]
    s_nop 0
    v_mfma_f32_16x16x32_bf16 v[64:67], a[196:199], v[56:59], v[64:67]
    s_waitcnt vmcnt(7)
    buffer_load_dwordx4 a[232:235], v14, s[40:43], s63 offen nt
    s_add_u32 s63, s63, 8192
    v_perm_b32 v4, v29, v29, s80
    v_perm_b32 v5, v45, v45, s80
    v_and_b32 v52, v4, v10
    v_and_b32 v53, v4, v11
    v_and_b32 v54, v4, v12
    v_and_b32 v55, v4, v13
    v_and_b32 v56, v5, v10
    v_and_b32 v57, v5, v11
    v_and_b32 v58, v5, v12
    v_and_b32 v59, v5, v13
    v_mfma_f32_16x16x32_bf16 v[60:63], a[200:203], v[52:55], v[60:63]
    s_nop 0
    v_mfma_f32_16x16x32_bf16 v[64:67], a[200:203], v[56:59], v[64:67]
    s_waitcnt vmcnt(7)
    buffer_load_dwordx4 a[236:239], v14, s[40:43], s63 offen nt
    s_add_u32 s63, s63, 8192
    v_perm_b32 v4, v29, v29, s81
    v_perm_b32 v5, v45, v45, s81
    v_and_b32 v52, v4, v10
    v_and_b32 v53, v4, v11
    v_and_b32 v54, v4, v12
    v_and_b32 v55, v4, v13
    v_and_b32 v56, v5, v10
    v_and_b32 v57, v5, v11
    v_and_b32 v58, v5, v12
    v_and_b32 v59, v5, v13
    v_mfma_f32_16x16x32_bf16 v[60:63], a[204:207], v[52:55], v[60:63]
    s_nop 0
    v_mfma_f32_16x16x32_bf16 v[64:67], a[204:207], v[56:59], v[64:67]
    s_waitcnt vmcnt(7)
    buffer_load_dwordx4 a[240:243], v14, s[40:43], s63 offen nt
    s_add_u32 s63, s63, 8192
    v_perm_b32 v4, v30, v30, s80
    v_perm_b32 v5, v46, v46, s80
    v_and_b32 v52, v4, v10
    v_and_b32 v53, v4, v11
    v_and_b32 v54, v4, v12
    v_and_b32 v55, v4, v13
    v_and_b32 v56, v5, v10
    v_and_b32 v57, v5, v11
    v_and_b32 v58, v5, v12
    v_and_b32 v59, v5, v13
    v_mfma_f32_16x16x32_bf16 v[60:63], a[208:211], v[52:55], v[60:63]
    s_nop 0
    v_mfma_f32_16x16x32_bf16 v[64:67], a[208:211], v[56:59], v[64:67]
    s_waitcnt vmcnt(7)
    buffer_load_dwordx4 a[244:247], v14, s[40:43], s63 offen nt
    s_add_u32 s63, s63, 8192
    v_perm_b32 v4, v30, v30, s81
    v_perm_b32 v5, v46, v46, s81
    v_and_b32 v52, v4, v10
    v_and_b32 v53, v4, v11
    v_and_b32 v54, v4, v12
    v_and_b32 v55, v4, v13
    v_and_b32 v56, v5, v10
    v_and_b32 v57, v5, v11
    v_and_b32 v58, v5, v12
    v_and_b32 v59, v5, v13
    v_mfma_f32_16x16x32_bf16 v[60:63], a[212:215], v[52:55], v[60:63]
    s_nop 0
    v_mfma_f32_16x16x32_bf16 v[64:67], a[212:215], v[56:59], v[64:67]
    s_waitcnt vmcnt(7)
    buffer_load_dwordx4 a[248:251], v14, s[40:43], s63 offen nt
    s_add_u32 s63, s63, 8192
    v_perm_b32 v4, v31, v31, s80
    v_perm_b32 v5, v47, v47, s80
    v_and_b32 v52, v4, v10
    v_and_b32 v53, v4, v11
    v_and_b32 v54, v4, v12
    v_and_b32 v55, v4, v13
    v_and_b32 v56, v5, v10
    v_and_b32 v57, v5, v11
    v_and_b32 v58, v5, v12
    v_and_b32 v59, v5, v13
    v_mfma_f32_16x16x32_bf16 v[60:63], a[216:219], v[52:55], v[60:63]
    s_nop 0
    v_mfma_f32_16x16x32_bf16 v[64:67], a[216:219], v[56:59], v[64:67]
    s_waitcnt vmcnt(7)
    buffer_load_dwordx4 a[252:255], v14, s[40:43], s63 offen nt
    s_add_u32 s63, s63, 8192
    v_perm_b32 v4, v31, v31, s81
    v_perm_b32 v5, v47, v47, s81
    v_and_b32 v52, v4, v10
    v_and_b32 v53, v4, v11
    v_and_b32 v54, v4, v12
    v_and_b32 v55, v4, v13
    v_and_b32 v56, v5, v10
    v_and_b32 v57, v5, v11
    v_and_b32 v58, v5, v12
    v_and_b32 v59, v5, v13
    v_mfma_f32_16x16x32_bf16 v[60:63], a[220:223], v[52:55], v[60:63]
    s_nop 0
    v_mfma_f32_16x16x32_bf16 v[64:67], a[220:223], v[56:59], v[64:67]
    s_waitcnt vmcnt(7)
    v_perm_b32 v4, v32, v32, s80
    v_perm_b32 v5, v48, v48, s80
    v_and_b32 v52, v4, v10
    v_and_b32 v53, v4, v11
    v_and_b32 v54, v4, v12
    v_and_b32 v55, v4, v13
    v_and_b32 v56, v5, v10
    v_and_b32 v57, v5, v11
    v_and_b32 v58, v5, v12
    v_and_b32 v59, v5, v13
    v_mfma_f32_16x16x32_bf16 v[60:63], a[224:227], v[52:55], v[60:63]
    s_nop 0
    v_mfma_f32_16x16x32_bf16 v[64:67], a[224:227], v[56:59], v[64:67]
    s_waitcnt vmcnt(6)
    s_add_u32 s39, s87, s88
    s_bfe_u32 s37, s39, 0x30000
    s_lshl_b32 s37, s37, 12
    s_add_u32 s85, s37, s89
    s_bfe_u32 s37, s39, 0x10003
    s_lshl_b32 s37, s37, 11
    s_add_u32 s85, s37, s85
    s_bfe_u32 s37, s39, 0x40004
    s_lshl_b32 s37, s37, 16
    s_add_u32 s85, s37, s85
    buffer_load_dwordx4 v[128:131], v76, s[52:55], s85 offen offset:0 nt
    v_perm_b32 v4, v32, v32, s81
    v_perm_b32 v5, v48, v48, s81
    v_and_b32 v52, v4, v10
    v_and_b32 v53, v4, v11
    v_and_b32 v54, v4, v12
    v_and_b32 v55, v4, v13
    v_and_b32 v56, v5, v10
    v_and_b32 v57, v5, v11
    v_and_b32 v58, v5, v12
    v_and_b32 v59, v5, v13
    v_mfma_f32_16x16x32_bf16 v[60:63], a[228:231], v[52:55], v[60:63]
    s_nop 0
    v_mfma_f32_16x16x32_bf16 v[64:67], a[228:231], v[56:59], v[64:67]
    s_waitcnt vmcnt(6)
    buffer_load_dwordx4 v[132:135], v77, s[52:55], s85 offen offset:0 nt
    v_perm_b32 v4, v33, v33, s80
    v_perm_b32 v5, v49, v49, s80
    v_and_b32 v52, v4, v10
    v_and_b32 v53, v4, v11
    v_and_b32 v54, v4, v12
    v_and_b32 v55, v4, v13
    v_and_b32 v56, v5, v10
    v_and_b32 v57, v5, v11
    v_and_b32 v58, v5, v12
    v_and_b32 v59, v5, v13
    v_mfma_f32_16x16x32_bf16 v[60:63], a[232:235], v[52:55], v[60:63]
    s_nop 0
    v_mfma_f32_16x16x32_bf16 v[64:67], a[232:235], v[56:59], v[64:67]
    s_waitcnt vmcnt(6)
    buffer_load_dwordx4 v[136:139], v76, s[52:55], s85 offen offset:1024 nt
    v_perm_b32 v4, v33, v33, s81
    v_perm_b32 v5, v49, v49, s81
    v_and_b32 v52, v4, v10
    v_and_b32 v53, v4, v11
    v_and_b32 v54, v4, v12
    v_and_b32 v55, v4, v13
    v_and_b32 v56, v5, v10
    v_and_b32 v57, v5, v11
    v_and_b32 v58, v5, v12
    v_and_b32 v59, v5, v13
    v_mfma_f32_16x16x32_bf16 v[60:63], a[236:239], v[52:55], v[60:63]
    s_nop 0
    v_mfma_f32_16x16x32_bf16 v[64:67], a[236:239], v[56:59], v[64:67]
    s_waitcnt vmcnt(6)
    buffer_load_dwordx4 v[140:143], v77, s[52:55], s85 offen offset:1024 nt
    v_perm_b32 v4, v34, v34, s80
    v_perm_b32 v5, v50, v50, s80
    v_and_b32 v52, v4, v10
    v_and_b32 v53, v4, v11
    v_and_b32 v54, v4, v12
    v_and_b32 v55, v4, v13
    v_and_b32 v56, v5, v10
    v_and_b32 v57, v5, v11
    v_and_b32 v58, v5, v12
    v_and_b32 v59, v5, v13
    v_mfma_f32_16x16x32_bf16 v[60:63], a[240:243], v[52:55], v[60:63]
    s_nop 0
    v_mfma_f32_16x16x32_bf16 v[64:67], a[240:243], v[56:59], v[64:67]
    s_waitcnt vmcnt(6)
    buffer_load_dwordx4 v[144:147], v126, s[56:59], s85 offen offset:0 nt
    v_perm_b32 v4, v34, v34, s81
    v_perm_b32 v5, v50, v50, s81
    v_and_b32 v52, v4, v10
    v_and_b32 v53, v4, v11
    v_and_b32 v54, v4, v12
    v_and_b32 v55, v4, v13
    v_and_b32 v56, v5, v10
    v_and_b32 v57, v5, v11
    v_and_b32 v58, v5, v12
    v_and_b32 v59, v5, v13
    v_mfma_f32_16x16x32_bf16 v[60:63], a[244:247], v[52:55], v[60:63]
    s_nop 0
    v_mfma_f32_16x16x32_bf16 v[64:67], a[244:247], v[56:59], v[64:67]
    s_waitcnt vmcnt(6)
    buffer_load_dwordx4 v[148:151], v127, s[56:59], s85 offen offset:0 nt
    v_perm_b32 v4, v35, v35, s80
    v_perm_b32 v5, v51, v51, s80
    v_and_b32 v52, v4, v10
    v_and_b32 v53, v4, v11
    v_and_b32 v54, v4, v12
    v_and_b32 v55, v4, v13
    v_and_b32 v56, v5, v10
    v_and_b32 v57, v5, v11
    v_and_b32 v58, v5, v12
    v_and_b32 v59, v5, v13
    v_mfma_f32_16x16x32_bf16 v[60:63], a[248:251], v[52:55], v[60:63]
    s_nop 0
    v_mfma_f32_16x16x32_bf16 v[64:67], a[248:251], v[56:59], v[64:67]
    s_waitcnt vmcnt(6)
    buffer_load_dwordx4 v[152:155], v126, s[56:59], s85 offen offset:1024 nt
    v_perm_b32 v4, v35, v35, s81
    v_perm_b32 v5, v51, v51, s81
    v_and_b32 v52, v4, v10
    v_and_b32 v53, v4, v11
    v_and_b32 v54, v4, v12
    v_and_b32 v55, v4, v13
    v_and_b32 v56, v5, v10
    v_and_b32 v57, v5, v11
    v_and_b32 v58, v5, v12
    v_and_b32 v59, v5, v13
    v_mfma_f32_16x16x32_bf16 v[60:63], a[252:255], v[52:55], v[60:63]
    s_nop 0
    v_mfma_f32_16x16x32_bf16 v[64:67], a[252:255], v[56:59], v[64:67]
    s_lshl_b32 s38, s34, 11
    v_lshrrev_b32 v4, 3, v3
    v_lshlrev_b32 v4, 9, v4
    v_lshl_add_u32 v4, v2, 7, v4
    v_and_b32 v5, 7, v3
    v_lshl_add_u32 v4, v5, 2, v4
    v_add_u32 v4, s38, v4
    ds_write_b32 v4, v60 offset:0
    ds_write_b32 v4, v61 offset:32
    ds_write_b32 v4, v62 offset:64
    ds_write_b32 v4, v63 offset:96
    ds_write_b32 v4, v64 offset:1024
    ds_write_b32 v4, v65 offset:1056
    ds_write_b32 v4, v66 offset:1088
    ds_write_b32 v4, v67 offset:1120
    s_lshl_b32 s38, s34, 9
    v_and_b32 v5, 31, v1
    v_lshl_add_u32 v5, v5, 4, s38
    s_waitcnt lgkmcnt(0)
    s_add_u32 s35, s35, 0x5b
    s_and_b32 s35, s35, 0xff
    v_mov_b32 v8, s35
    s_barrier
    ds_read_b128 v[20:23], v5 offset:0
    ds_read_b128 v[24:27], v5 offset:2048
    ds_read_b128 v[28:31], v5 offset:4096
    ds_read_b128 v[32:35], v5 offset:6144
    s_lshl_b32 s38, s61, 1
    s_add_u32 s38, s38, s33
    s_lshl_b32 s38, s38, 11
    s_add_u32 s38, s38, 1048576
    s_waitcnt lgkmcnt(0)
    v_add_f32 v20, v20, v24
    v_add_f32 v28, v28, v32
    v_add_f32 v21, v21, v25
    v_add_f32 v29, v29, v33
    v_add_f32 v22, v22, v26
    v_add_f32 v30, v30, v34
    v_add_f32 v23, v23, v27
    v_add_f32 v31, v31, v35
    v_add_f32 v20, v20, v28
    v_add_f32 v21, v21, v29
    v_add_f32 v22, v22, v30
    v_add_f32 v23, v23, v31
    v_and_or_b32 v20, v20, s82, v8
    v_and_or_b32 v21, v21, s82, v8
    v_and_or_b32 v22, v22, s82, v8
    v_and_or_b32 v23, v23, s82, v8
    s_mov_b32 exec_lo, 0xffffffff
    s_mov_b32 exec_hi, 0x0
    buffer_store_dwordx4 v[20:23], v5, s[48:51], s38 offen sc1
    s_mov_b64 exec, -1
    s_waitcnt vmcnt(7)
    buffer_load_dwordx4 v[156:159], v127, s[56:59], s85 offen offset:1024 nt
    s_waitcnt vmcnt(7)
    s_add_u32 s87, s87, 7
    s_add_u32 s39, s87, s88
    s_bfe_u32 s37, s39, 0x30000
    s_lshl_b32 s37, s37, 12
    s_add_u32 s85, s37, s89
    s_bfe_u32 s37, s39, 0x10003
    s_lshl_b32 s37, s37, 11
    s_add_u32 s85, s37, s85
    s_bfe_u32 s37, s39, 0x40004
    s_lshl_b32 s37, s37, 16
    s_add_u32 s85, s37, s85
    buffer_load_dwordx4 v[160:163], v76, s[52:55], s85 offen offset:0 nt
    s_waitcnt vmcnt(7)
    buffer_load_dwordx4 v[164:167], v77, s[52:55], s85 offen offset:0 nt
    s_waitcnt vmcnt(7)
    buffer_load_dwordx4 v[168:171], v76, s[52:55], s85 offen offset:1024 nt
    s_waitcnt vmcnt(7)
    buffer_load_dwordx4 v[172:175], v77, s[52:55], s85 offen offset:1024 nt
    s_waitcnt vmcnt(7)
    buffer_load_dwordx4 v[176:179], v126, s[56:59], s85 offen offset:0 nt
    s_waitcnt vmcnt(7)
    buffer_load_dwordx4 v[180:183], v127, s[56:59], s85 offen offset:0 nt
    s_waitcnt vmcnt(6)
    buffer_load_dwordx4 v[184:187], v126, s[56:59], s85 offen offset:1024 nt
    s_waitcnt vmcnt(6)
    buffer_load_dwordx4 v[188:191], v127, s[56:59], s85 offen offset:1024 nt
    s_waitcnt vmcnt(6)
    s_add_u32 s87, s87, 7
    s_add_u32 s39, s87, s88
    s_bfe_u32 s37, s39, 0x30000
    s_lshl_b32 s37, s37, 12
    s_add_u32 s85, s37, s89
    s_bfe_u32 s37, s39, 0x10003
    s_lshl_b32 s37, s37, 11
    s_add_u32 s85, s37, s85
    s_bfe_u32 s37, s39, 0x40004
    s_lshl_b32 s37, s37, 16
    s_add_u32 s85, s37, s85
    buffer_load_dwordx4 v[192:195], v76, s[52:55], s85 offen offset:0 nt
    s_waitcnt vmcnt(6)
    buffer_load_dwordx4 v[196:199], v77, s[52:55], s85 offen offset:0 nt
    s_waitcnt vmcnt(6)
    buffer_load_dwordx4 v[200:203], v76, s[52:55], s85 offen offset:1024 nt
    s_waitcnt vmcnt(6)
    buffer_load_dwordx4 v[204:207], v77, s[52:55], s85 offen offset:1024 nt
    buffer_load_dwordx4 v[68:71], v78, s[48:51], s91 offen offset:0 sc1
    buffer_load_dwordx4 v[72:75], v78, s[48:51], s91 offen offset:16 sc1
    s_waitcnt vmcnt(8)
    buffer_load_dwordx4 v[208:211], v126, s[56:59], s85 offen offset:0 nt
    s_waitcnt vmcnt(8)
    buffer_load_dwordx4 v[212:215], v127, s[56:59], s85 offen offset:0 nt
    s_waitcnt vmcnt(8)
    buffer_load_dwordx4 v[216:219], v126, s[56:59], s85 offen offset:1024 nt
    s_waitcnt vmcnt(8)
    buffer_load_dwordx4 v[220:223], v127, s[56:59], s85 offen offset:1024 nt
    s_waitcnt vmcnt(8)
    s_add_u32 s87, s87, 7
    s_add_u32 s39, s87, s88
    s_bfe_u32 s37, s39, 0x30000
    s_lshl_b32 s37, s37, 12
    s_add_u32 s85, s37, s89
    s_bfe_u32 s37, s39, 0x10003
    s_lshl_b32 s37, s37, 11
    s_add_u32 s85, s37, s85
    s_bfe_u32 s37, s39, 0x40004
    s_lshl_b32 s37, s37, 16
    s_add_u32 s85, s37, s85
    buffer_load_dwordx4 v[224:227], v76, s[52:55], s85 offen offset:0 nt
    s_waitcnt vmcnt(8)
    buffer_load_dwordx4 v[228:231], v77, s[52:55], s85 offen offset:0 nt
    s_waitcnt vmcnt(6)
L_qcheck_19:
    v_xor_b32 v68, s35, v68
    v_xor_b32 v69, s35, v69
    v_xor_b32 v70, s35, v70
    v_xor_b32 v71, s35, v71
    v_xor_b32 v72, s35, v72
    v_xor_b32 v73, s35, v73
    v_xor_b32 v74, s35, v74
    v_xor_b32 v75, s35, v75
    v_or_b32 v4, v68, v69
    v_or3_b32 v4, v4, v70, v71
    v_or3_b32 v4, v4, v72, v73
    v_or3_b32 v4, v4, v74, v75
    v_and_b32 v4, 0xff, v4
    v_cmp_ne_u32 vcc, 0, v4
    s_cbranch_vccz L_qok_20
    buffer_load_dwordx4 v[68:71], v78, s[48:51], s91 offen offset:0 sc1
    buffer_load_dwordx4 v[72:75], v78, s[48:51], s91 offen offset:16 sc1
    s_waitcnt vmcnt(0)
    s_sub_u32 s84, s84, 1
    s_cmp_lg_u32 s84, 0
    s_cbranch_scc1 L_qcheck_19
    s_branch L_end
L_qok_20:
    v_cvt_pk_bf16_f32 v68, v68, v69
    v_cvt_pk_bf16_f32 v69, v70, v71
    v_cvt_pk_bf16_f32 v70, v72, v73
    v_cvt_pk_bf16_f32 v71, v74, v75
    s_mov_b32 vcc_lo, 0xf000f
    s_mov_b32 vcc_hi, 0xf000f
    v_cndmask_b32 v80, 0, v68, vcc
    v_cndmask_b32 v81, 0, v69, vcc
    v_cndmask_b32 v82, 0, v70, vcc
    v_cndmask_b32 v83, 0, v71, vcc
    s_mov_b32 vcc_lo, 0xf000f0
    s_mov_b32 vcc_hi, 0xf000f0
    v_cndmask_b32 v84, 0, v68, vcc
    v_cndmask_b32 v85, 0, v69, vcc
    v_cndmask_b32 v86, 0, v70, vcc
    v_cndmask_b32 v87, 0, v71, vcc
    s_mov_b32 vcc_lo, 0xf000f00
    s_mov_b32 vcc_hi, 0xf000f00
    v_cndmask_b32 v88, 0, v68, vcc
    v_cndmask_b32 v89, 0, v69, vcc
    v_cndmask_b32 v90, 0, v70, vcc
    v_cndmask_b32 v91, 0, v71, vcc
    s_mov_b32 vcc_lo, 0xf000f000
    s_mov_b32 vcc_hi, 0xf000f000
    v_cndmask_b32 v92, 0, v68, vcc
    v_cndmask_b32 v93, 0, v69, vcc
    v_cndmask_b32 v94, 0, v70, vcc
    v_cndmask_b32 v95, 0, v71, vcc
    buffer_load_dwordx4 v[232:235], v76, s[52:55], s85 offen offset:1024 nt
    v_mfma_f32_16x16x32_bf16 v[112:115], v[128:131], v[80:83], 0
    v_mfma_f32_16x16x32_bf16 v[112:115], v[132:135], v[84:87], v[112:115]
    s_waitcnt vmcnt(6)
    buffer_load_dwordx4 v[236:239], v77, s[52:55], s85 offen offset:1024 nt
    v_mfma_f32_16x16x32_bf16 v[112:115], v[136:139], v[88:91], v[112:115]
    v_mfma_f32_16x16x32_bf16 v[112:115], v[140:143], v[92:95], v[112:115]
    s_nop 7
    v_mov_b32_dpp v122, v112 quad_perm:[0,0,0,0] row_mask:0xf bank_mask:0xf
    v_mov_b32_dpp v124, v114 quad_perm:[2,2,2,2] row_mask:0xf bank_mask:0xf
    s_nop 0
    v_add_f32_dpp v122, v113, v122 quad_perm:[1,1,1,1] row_mask:0xf bank_mask:0xf
    v_add_f32_dpp v124, v115, v124 quad_perm:[3,3,3,3] row_mask:0xf bank_mask:0xf
    v_add_f32 v122, v122, v124
    v_fma_f32 v123, v122, s83, -v120
    v_cmp_lt_f32 vcc, 0, v123
    s_cbranch_vccz L_nomax_21
    v_mul_f32 v122, s83, v122
    s_nop 1
    v_max_f32_dpp v124, v122, v122 row_ror:4 row_mask:0xf bank_mask:0xf
    s_nop 1
    v_max_f32_dpp v124, v124, v124 row_ror:8 row_mask:0xf bank_mask:0xf
    v_mov_b32 v125, v124
    s_nop 1
    v_permlane16_swap_b32 v124, v125
    v_max_f32 v124, v124, v125
    v_mov_b32 v125, v124
    s_nop 1
    v_permlane32_swap_b32 v124, v125
    v_max_f32 v124, v124, v125
    v_and_b32 v124, s82, v124
    v_max_f32 v124, v124, v120
    v_sub_f32 v125, v120, v124
    v_exp_f32 v125, v125
    v_mov_b32 v120, v124
    v_sub_f32 v123, v122, v124
    v_mul_f32 v121, v121, v125
    v_mul_f32 v116, v116, v125
    v_mul_f32 v117, v117, v125
    v_mul_f32 v118, v118, v125
    v_mul_f32 v119, v119, v125
L_nomax_21:
    v_exp_f32 v123, v123
    s_nop 0
    v_cvt_pk_bf16_f32 v124, v123, v123
    v_add_f32 v121, v121, v123
    s_nop 0
    v_and_b32_dpp v96, v124, v10 row_newbcast:0 row_mask:0xf bank_mask:0xf
    v_and_b32_dpp v97, v124, v11 row_newbcast:0 row_mask:0xf bank_mask:0xf
    v_and_b32_dpp v98, v124, v12 row_newbcast:0 row_mask:0xf bank_mask:0xf
    v_and_b32_dpp v99, v124, v13 row_newbcast:0 row_mask:0xf bank_mask:0xf
    v_and_b32_dpp v100, v124, v10 row_newbcast:4 row_mask:0xf bank_mask:0xf
    v_and_b32_dpp v101, v124, v11 row_newbcast:4 row_mask:0xf bank_mask:0xf
    v_and_b32_dpp v102, v124, v12 row_newbcast:4 row_mask:0xf bank_mask:0xf
    v_and_b32_dpp v103, v124, v13 row_newbcast:4 row_mask:0xf bank_mask:0xf
    v_and_b32_dpp v104, v124, v10 row_newbcast:8 row_mask:0xf bank_mask:0xf
    v_and_b32_dpp v105, v124, v11 row_newbcast:8 row_mask:0xf bank_mask:0xf
    v_and_b32_dpp v106, v124, v12 row_newbcast:8 row_mask:0xf bank_mask:0xf
    v_and_b32_dpp v107, v124, v13 row_newbcast:8 row_mask:0xf bank_mask:0xf
    v_and_b32_dpp v108, v124, v10 row_newbcast:12 row_mask:0xf bank_mask:0xf
    v_and_b32_dpp v109, v124, v11 row_newbcast:12 row_mask:0xf bank_mask:0xf
    v_and_b32_dpp v110, v124, v12 row_newbcast:12 row_mask:0xf bank_mask:0xf
    v_and_b32_dpp v111, v124, v13 row_newbcast:12 row_mask:0xf bank_mask:0xf
    v_mfma_f32_16x16x32_bf16 v[116:119], v[144:147], v[96:99], v[116:119]
    s_waitcnt vmcnt(6)
    buffer_load_dwordx4 v[240:243], v126, s[56:59], s85 offen offset:0 nt
    v_mfma_f32_16x16x32_bf16 v[116:119], v[148:151], v[100:103], v[116:119]
    v_mfma_f32_16x16x32_bf16 v[116:119], v[152:155], v[104:107], v[116:119]
    v_mfma_f32_16x16x32_bf16 v[116:119], v[156:159], v[108:111], v[116:119]
    s_waitcnt vmcnt(6)
    buffer_load_dwordx4 v[244:247], v127, s[56:59], s85 offen offset:0 nt
    v_mfma_f32_16x16x32_bf16 v[112:115], v[160:163], v[80:83], 0
    v_mfma_f32_16x16x32_bf16 v[112:115], v[164:167], v[84:87], v[112:115]
    v_mfma_f32_16x16x32_bf16 v[112:115], v[168:171], v[88:91], v[112:115]
    s_waitcnt vmcnt(6)
    buffer_load_dwordx4 v[248:251], v126, s[56:59], s85 offen offset:1024 nt
    v_mfma_f32_16x16x32_bf16 v[112:115], v[172:175], v[92:95], v[112:115]
    s_nop 7
    v_mov_b32_dpp v122, v112 quad_perm:[0,0,0,0] row_mask:0xf bank_mask:0xf
    v_mov_b32_dpp v124, v114 quad_perm:[2,2,2,2] row_mask:0xf bank_mask:0xf
    s_nop 0
    v_add_f32_dpp v122, v113, v122 quad_perm:[1,1,1,1] row_mask:0xf bank_mask:0xf
    v_add_f32_dpp v124, v115, v124 quad_perm:[3,3,3,3] row_mask:0xf bank_mask:0xf
    v_add_f32 v122, v122, v124
    v_fma_f32 v123, v122, s83, -v120
    v_cmp_lt_f32 vcc, 0, v123
    s_cbranch_vccz L_nomax_22
    v_mul_f32 v122, s83, v122
    s_nop 1
    v_max_f32_dpp v124, v122, v122 row_ror:4 row_mask:0xf bank_mask:0xf
    s_nop 1
    v_max_f32_dpp v124, v124, v124 row_ror:8 row_mask:0xf bank_mask:0xf
    v_mov_b32 v125, v124
    s_nop 1
    v_permlane16_swap_b32 v124, v125
    v_max_f32 v124, v124, v125
    v_mov_b32 v125, v124
    s_nop 1
    v_permlane32_swap_b32 v124, v125
    v_max_f32 v124, v124, v125
    v_and_b32 v124, s82, v124
    v_max_f32 v124, v124, v120
    v_sub_f32 v125, v120, v124
    v_exp_f32 v125, v125
    v_mov_b32 v120, v124
    v_sub_f32 v123, v122, v124
    v_mul_f32 v121, v121, v125
    v_mul_f32 v116, v116, v125
    v_mul_f32 v117, v117, v125
    v_mul_f32 v118, v118, v125
    v_mul_f32 v119, v119, v125
L_nomax_22:
    v_exp_f32 v123, v123
    s_nop 0
    v_cvt_pk_bf16_f32 v124, v123, v123
    v_add_f32 v121, v121, v123
    s_nop 0
    v_and_b32_dpp v96, v124, v10 row_newbcast:0 row_mask:0xf bank_mask:0xf
    v_and_b32_dpp v97, v124, v11 row_newbcast:0 row_mask:0xf bank_mask:0xf
    v_and_b32_dpp v98, v124, v12 row_newbcast:0 row_mask:0xf bank_mask:0xf
    v_and_b32_dpp v99, v124, v13 row_newbcast:0 row_mask:0xf bank_mask:0xf
    v_and_b32_dpp v100, v124, v10 row_newbcast:4 row_mask:0xf bank_mask:0xf
    v_and_b32_dpp v101, v124, v11 row_newbcast:4 row_mask:0xf bank_mask:0xf
    v_and_b32_dpp v102, v124, v12 row_newbcast:4 row_mask:0xf bank_mask:0xf
    v_and_b32_dpp v103, v124, v13 row_newbcast:4 row_mask:0xf bank_mask:0xf
    v_and_b32_dpp v104, v124, v10 row_newbcast:8 row_mask:0xf bank_mask:0xf
    v_and_b32_dpp v105, v124, v11 row_newbcast:8 row_mask:0xf bank_mask:0xf
    v_and_b32_dpp v106, v124, v12 row_newbcast:8 row_mask:0xf bank_mask:0xf
    v_and_b32_dpp v107, v124, v13 row_newbcast:8 row_mask:0xf bank_mask:0xf
    v_and_b32_dpp v108, v124, v10 row_newbcast:12 row_mask:0xf bank_mask:0xf
    v_and_b32_dpp v109, v124, v11 row_newbcast:12 row_mask:0xf bank_mask:0xf
    v_and_b32_dpp v110, v124, v12 row_newbcast:12 row_mask:0xf bank_mask:0xf
    v_and_b32_dpp v111, v124, v13 row_newbcast:12 row_mask:0xf bank_mask:0xf
    v_mfma_f32_16x16x32_bf16 v[116:119], v[176:179], v[96:99], v[116:119]
    v_mfma_f32_16x16x32_bf16 v[116:119], v[180:183], v[100:103], v[116:119]
    s_waitcnt vmcnt(6)
    buffer_load_dwordx4 v[252:255], v127, s[56:59], s85 offen offset:1024 nt
    v_mfma_f32_16x16x32_bf16 v[116:119], v[184:187], v[104:107], v[116:119]
    v_mfma_f32_16x16x32_bf16 v[116:119], v[188:191], v[108:111], v[116:119]
    v_mfma_f32_16x16x32_bf16 v[112:115], v[192:195], v[80:83], 0
    s_waitcnt vmcnt(5)
    s_add_u32 s87, s87, 7
    s_add_u32 s39, s87, s88
    s_bfe_u32 s37, s39, 0x30000
    s_lshl_b32 s37, s37, 12
    s_add_u32 s85, s37, s89
    s_bfe_u32 s37, s39, 0x10003
    s_lshl_b32 s37, s37, 11
    s_add_u32 s85, s37, s85
    s_bfe_u32 s37, s39, 0x40004
    s_lshl_b32 s37, s37, 16
    s_add_u32 s85, s37, s85
    buffer_load_dwordx4 v[128:131], v76, s[52:55], s85 offen offset:0 nt
    v_mfma_f32_16x16x32_bf16 v[112:115], v[196:199], v[84:87], v[112:115]
    v_mfma_f32_16x16x32_bf16 v[112:115], v[200:203], v[88:91], v[112:115]
    v_mfma_f32_16x16x32_bf16 v[112:115], v[204:207], v[92:95], v[112:115]
    s_nop 7
    v_mov_b32_dpp v122, v112 quad_perm:[0,0,0,0] row_mask:0xf bank_mask:0xf
    v_mov_b32_dpp v124, v114 quad_perm:[2,2,2,2] row_mask:0xf bank_mask:0xf
    s_nop 0
    v_add_f32_dpp v122, v113, v122 quad_perm:[1,1,1,1] row_mask:0xf bank_mask:0xf
    v_add_f32_dpp v124, v115, v124 quad_perm:[3,3,3,3] row_mask:0xf bank_mask:0xf
    v_add_f32 v122, v122, v124
    v_fma_f32 v123, v122, s83, -v120
    v_cmp_lt_f32 vcc, 0, v123
    s_cbranch_vccz L_nomax_23
    v_mul_f32 v122, s83, v122
    s_nop 1
    v_max_f32_dpp v124, v122, v122 row_ror:4 row_mask:0xf bank_mask:0xf
    s_nop 1
    v_max_f32_dpp v124, v124, v124 row_ror:8 row_mask:0xf bank_mask:0xf
    v_mov_b32 v125, v124
    s_nop 1
    v_permlane16_swap_b32 v124, v125
    v_max_f32 v124, v124, v125
    v_mov_b32 v125, v124
    s_nop 1
    v_permlane32_swap_b32 v124, v125
    v_max_f32 v124, v124, v125
    v_and_b32 v124, s82, v124
    v_max_f32 v124, v124, v120
    v_sub_f32 v125, v120, v124
    v_exp_f32 v125, v125
    v_mov_b32 v120, v124
    v_sub_f32 v123, v122, v124
    v_mul_f32 v121, v121, v125
    v_mul_f32 v116, v116, v125
    v_mul_f32 v117, v117, v125
    v_mul_f32 v118, v118, v125
    v_mul_f32 v119, v119, v125
L_nomax_23:
    v_exp_f32 v123, v123
    s_nop 0
    v_cvt_pk_bf16_f32 v124, v123, v123
    v_add_f32 v121, v121, v123
    s_nop 0
    v_and_b32_dpp v96, v124, v10 row_newbcast:0 row_mask:0xf bank_mask:0xf
    v_and_b32_dpp v97, v124, v11 row_newbcast:0 row_mask:0xf bank_mask:0xf
    v_and_b32_dpp v98, v124, v12 row_newbcast:0 row_mask:0xf bank_mask:0xf
    v_and_b32_dpp v99, v124, v13 row_newbcast:0 row_mask:0xf bank_mask:0xf
    v_and_b32_dpp v100, v124, v10 row_newbcast:4 row_mask:0xf bank_mask:0xf
    v_and_b32_dpp v101, v124, v11 row_newbcast:4 row_mask:0xf bank_mask:0xf
    v_and_b32_dpp v102, v124, v12 row_newbcast:4 row_mask:0xf bank_mask:0xf
    v_and_b32_dpp v103, v124, v13 row_newbcast:4 row_mask:0xf bank_mask:0xf
    v_and_b32_dpp v104, v124, v10 row_newbcast:8 row_mask:0xf bank_mask:0xf
    v_and_b32_dpp v105, v124, v11 row_newbcast:8 row_mask:0xf bank_mask:0xf
    v_and_b32_dpp v106, v124, v12 row_newbcast:8 row_mask:0xf bank_mask:0xf
    v_and_b32_dpp v107, v124, v13 row_newbcast:8 row_mask:0xf bank_mask:0xf
    v_and_b32_dpp v108, v124, v10 row_newbcast:12 row_mask:0xf bank_mask:0xf
    v_and_b32_dpp v109, v124, v11 row_newbcast:12 row_mask:0xf bank_mask:0xf
    v_and_b32_dpp v110, v124, v12 row_newbcast:12 row_mask:0xf bank_mask:0xf
    v_and_b32_dpp v111, v124, v13 row_newbcast:12 row_mask:0xf bank_mask:0xf
    s_waitcnt vmcnt(5)
    buffer_load_dwordx4 v[132:135], v77, s[52:55], s85 offen offset:0 nt
    v_mfma_f32_16x16x32_bf16 v[116:119], v[208:211], v[96:99], v[116:119]
    v_mfma_f32_16x16x32_bf16 v[116:119], v[212:215], v[100:103], v[116:119]
    v_mfma_f32_16x16x32_bf16 v[116:119], v[216:219], v[104:107], v[116:119]
    s_waitcnt vmcnt(5)
    buffer_load_dwordx4 v[136:139], v76, s[52:55], s85 offen offset:1024 nt
    v_mfma_f32_16x16x32_bf16 v[116:119], v[220:223], v[108:111], v[116:119]
    v_mfma_f32_16x16x32_bf16 v[112:115], v[224:227], v[80:83], 0
    v_mfma_f32_16x16x32_bf16 v[112:115], v[228:231], v[84:87], v[112:115]
    s_waitcnt vmcnt(5)
    buffer_load_dwordx4 v[140:143], v77, s[52:55], s85 offen offset:1024 nt
    v_mfma_f32_16x16x32_bf16 v[112:115], v[232:235], v[88:91], v[112:115]
    v_mfma_f32_16x16x32_bf16 v[112:115], v[236:239], v[92:95], v[112:115]
    s_nop 7
    v_mov_b32_dpp v122, v112 quad_perm:[0,0,0,0] row_mask:0xf bank_mask:0xf
    v_mov_b32_dpp v124, v114 quad_perm:[2,2,2,2] row_mask:0xf bank_mask:0xf
    s_nop 0
    v_add_f32_dpp v122, v113, v122 quad_perm:[1,1,1,1] row_mask:0xf bank_mask:0xf
    v_add_f32_dpp v124, v115, v124 quad_perm:[3,3,3,3] row_mask:0xf bank_mask:0xf
    v_add_f32 v122, v122, v124
    v_fma_f32 v123, v122, s83, -v120
    v_cmp_lt_f32 vcc, 0, v123
    s_cbranch_vccz L_nomax_24
    v_mul_f32 v122, s83, v122
    s_nop 1
    v_max_f32_dpp v124, v122, v122 row_ror:4 row_mask:0xf bank_mask:0xf
    s_nop 1
    v_max_f32_dpp v124, v124, v124 row_ror:8 row_mask:0xf bank_mask:0xf
    v_mov_b32 v125, v124
    s_nop 1
    v_permlane16_swap_b32 v124, v125
    v_max_f32 v124, v124, v125
    v_mov_b32 v125, v124
    s_nop 1
    v_permlane32_swap_b32 v124, v125
    v_max_f32 v124, v124, v125
    v_and_b32 v124, s82, v124
    v_max_f32 v124, v124, v120
    v_sub_f32 v125, v120, v124
    v_exp_f32 v125, v125
    v_mov_b32 v120, v124
    v_sub_f32 v123, v122, v124
    v_mul_f32 v121, v121, v125
    v_mul_f32 v116, v116, v125
    v_mul_f32 v117, v117, v125
    v_mul_f32 v118, v118, v125
    v_mul_f32 v119, v119, v125
L_nomax_24:
    v_exp_f32 v123, v123
    s_nop 0
    v_cvt_pk_bf16_f32 v124, v123, v123
    v_add_f32 v121, v121, v123
    s_nop 0
    v_and_b32_dpp v96, v124, v10 row_newbcast:0 row_mask:0xf bank_mask:0xf
    v_and_b32_dpp v97, v124, v11 row_newbcast:0 row_mask:0xf bank_mask:0xf
    v_and_b32_dpp v98, v124, v12 row_newbcast:0 row_mask:0xf bank_mask:0xf
    v_and_b32_dpp v99, v124, v13 row_newbcast:0 row_mask:0xf bank_mask:0xf
    v_and_b32_dpp v100, v124, v10 row_newbcast:4 row_mask:0xf bank_mask:0xf
    v_and_b32_dpp v101, v124, v11 row_newbcast:4 row_mask:0xf bank_mask:0xf
    v_and_b32_dpp v102, v124, v12 row_newbcast:4 row_mask:0xf bank_mask:0xf
    v_and_b32_dpp v103, v124, v13 row_newbcast:4 row_mask:0xf bank_mask:0xf
    v_and_b32_dpp v104, v124, v10 row_newbcast:8 row_mask:0xf bank_mask:0xf
    v_and_b32_dpp v105, v124, v11 row_newbcast:8 row_mask:0xf bank_mask:0xf
    v_and_b32_dpp v106, v124, v12 row_newbcast:8 row_mask:0xf bank_mask:0xf
    v_and_b32_dpp v107, v124, v13 row_newbcast:8 row_mask:0xf bank_mask:0xf
    v_and_b32_dpp v108, v124, v10 row_newbcast:12 row_mask:0xf bank_mask:0xf
    v_and_b32_dpp v109, v124, v11 row_newbcast:12 row_mask:0xf bank_mask:0xf
    v_and_b32_dpp v110, v124, v12 row_newbcast:12 row_mask:0xf bank_mask:0xf
    v_and_b32_dpp v111, v124, v13 row_newbcast:12 row_mask:0xf bank_mask:0xf
    v_mfma_f32_16x16x32_bf16 v[116:119], v[240:243], v[96:99], v[116:119]
    s_waitcnt vmcnt(5)
    buffer_load_dwordx4 v[144:147], v126, s[56:59], s85 offen offset:0 nt
    v_mfma_f32_16x16x32_bf16 v[116:119], v[244:247], v[100:103], v[116:119]
    v_mfma_f32_16x16x32_bf16 v[116:119], v[248:251], v[104:107], v[116:119]
    s_waitcnt vmcnt(5)
    v_mfma_f32_16x16x32_bf16 v[116:119], v[252:255], v[108:111], v[116:119]
    s_add_u32 s87, s87, 7
    s_add_u32 s39, s87, s88
    s_bfe_u32 s37, s39, 0x30000
    s_lshl_b32 s37, s37, 12
    s_add_u32 s86, s37, s89
    s_bfe_u32 s37, s39, 0x10003
    s_lshl_b32 s37, s37, 11
    s_add_u32 s86, s37, s86
    s_bfe_u32 s37, s39, 0x40004
    s_lshl_b32 s37, s37, 16
    s_add_u32 s86, s37, s86
    s_branch L_bloop
L_ql:
    v_lshrrev_b32 v4, 2, v3
    v_and_b32 v5, 3, v3
    v_lshlrev_b32 v19, 6, v2
    v_lshl_add_u32 v19, v5, 4, v19
    v_lshl_add_u32 v14, v4, 18, v19
    s_lshl_b32 s63, s34, 20
    s_lshl_b32 s38, s32, 8
    s_add_u32 s63, s63, s38
    s_mov_b32 s74, 4194304
    s_mov_b32 s75, 0x20000
    s_waitcnt lgkmcnt(0)
    s_mov_b64 s[72:73], s[10:11]
    buffer_load_dwordx4 a[0:3], v14, s[72:75], s63 offen nt
    s_add_u32 s63, s63, 8192
    buffer_load_dwordx4 a[4:7], v14, s[72:75], s63 offen nt
    s_add_u32 s63, s63, 8192
    buffer_load_dwordx4 a[8:11], v14, s[72:75], s63 offen nt
    s_add_u32 s63, s63, 8192
    buffer_load_dwordx4 a[12:15], v14, s[72:75], s63 offen nt
    s_add_u32 s63, s63, 8192
    buffer_load_dwordx4 a[16:19], v14, s[72:75], s63 offen nt
    s_add_u32 s63, s63, 8192
    buffer_load_dwordx4 a[20:23], v14, s[72:75], s63 offen nt
    s_add_u32 s63, s63, 8192
    buffer_load_dwordx4 a[24:27], v14, s[72:75], s63 offen nt
    s_add_u32 s63, s63, 8192
    buffer_load_dwordx4 a[28:31], v14, s[72:75], s63 offen nt
    s_add_u32 s63, s63, 8192
    v_lshlrev_b32 v15, 1, v19
    v_lshl_add_u32 v15, v4, 9, v15
    v_lshl_add_u32 v19, v4, 15, v19
    s_getpc_b64 s[36:37]
L_pc_25:
    s_sub_u32 s36, s36, L_pc_25 - concat_heads__compressed_kv_cla__mha_block_cached__decode_kernel
    s_subb_u32 s37, s37, 0
    s_lshl_b32 s38, s32, 10
    v_lshl_add_u32 v6, v0, 2, s38
    v_mov_b32 v7, s37
    v_add_co_u32 v6, vcc, s36, v6
    s_nop 1
    v_addc_co_u32 v7, vcc, 0, v7, vcc
    global_load_dword v0, v[6:7], off
    s_load_dword s35, s[30:31], 0
    s_mov_b32 s48, s30
    s_and_b32 s49, s31, 0xffff
    s_mov_b32 s50, 8388608
    s_mov_b32 s51, 0x20000
    s_mov_b32 s82, 0xffffff00
    s_mov_b32 s83, 0x3e0293ee
    s_mov_b32 s84, 2097152
    s_lshl_b32 s95, s32, 12
    s_add_u32 s95, s95, 1050624
    s_lshl_b32 s94, s32, 10
    s_lshl_b32 s38, s34, 8
    s_add_u32 s94, s94, s38
    s_add_u32 s94, s94, 2097152
    s_waitcnt vmcnt(8)
    buffer_load_dwordx4 a[32:35], v14, s[72:75], s63 offen nt
    s_add_u32 s63, s63, 8192
    s_waitcnt vmcnt(8)
    buffer_load_dwordx4 a[36:39], v14, s[72:75], s63 offen nt
    s_add_u32 s63, s63, 8192
    s_waitcnt vmcnt(8)
    buffer_load_dwordx4 a[40:43], v14, s[72:75], s63 offen nt
    s_add_u32 s63, s63, 8192
    s_waitcnt vmcnt(8)
    buffer_load_dwordx4 a[44:47], v14, s[72:75], s63 offen nt
    s_add_u32 s63, s63, 8192
    s_waitcnt vmcnt(8)
    buffer_load_dwordx4 a[48:51], v14, s[72:75], s63 offen nt
    s_add_u32 s63, s63, 8192
    v_and_b32 v4, 1, v1
    v_lshlrev_b32 v4, 4, v4
    v_mov_b32 v5, 0xffff
    v_lshlrev_b32 v4, v4, v5
    v_bfe_u32 v5, v1, 1, 2
    v_cmp_eq_u32 vcc, 0, v5
    s_nop 1
    v_cndmask_b32 v10, 0, v4, vcc
    v_cmp_eq_u32 vcc, 1, v5
    s_nop 1
    v_cndmask_b32 v11, 0, v4, vcc
    v_cmp_eq_u32 vcc, 2, v5
    s_nop 1
    v_cndmask_b32 v12, 0, v4, vcc
    v_cmp_eq_u32 vcc, 3, v5
    s_nop 1
    v_cndmask_b32 v13, 0, v4, vcc
    s_waitcnt vmcnt(8)
    buffer_load_dwordx4 a[52:55], v14, s[72:75], s63 offen nt
    s_add_u32 s63, s63, 8192
    s_waitcnt vmcnt(8)
    buffer_load_dwordx4 a[56:59], v14, s[72:75], s63 offen nt
    s_add_u32 s63, s63, 8192
    s_waitcnt vmcnt(8)
    buffer_load_dwordx4 a[60:63], v14, s[72:75], s63 offen nt
    s_add_u32 s63, s63, 8192
    s_waitcnt vmcnt(7)
    buffer_load_dwordx4 a[64:67], v14, s[72:75], s63 offen nt
    s_add_u32 s63, s63, 8192
    v_lshrrev_b32 v4, 2, v3
    v_and_b32 v5, 3, v3
    v_lshlrev_b32 v76, 8, v4
    v_lshlrev_b32 v126, 8, v2
    v_lshl_add_u32 v76, v2, 6, v76
    v_lshl_add_u32 v76, v5, 4, v76
    v_lshl_add_u32 v126, v3, 4, v126
    v_xor_b32 v77, 32768, v76
    v_xor_b32 v127, 32768, v126
    s_add_u32 s3, s34, s33
    s_and_b32 s3, s3, 3
    s_lshl_b32 s89, s3, 5
    s_add_u32 s89, s89, s32
    s_lshl_b32 s89, s89, 20
    s_mul_i32 s88, s32, 8
    s_add_u32 s88, s88, s3
    s_add_u32 s87, s33, 28
    s_waitcnt vmcnt(7)
    buffer_load_dwordx4 a[68:71], v14, s[72:75], s63 offen nt
    s_add_u32 s63, s63, 8192
    s_waitcnt vmcnt(7)
    buffer_load_dwordx4 a[72:75], v14, s[72:75], s63 offen nt
    s_add_u32 s63, s63, 8192
    s_waitcnt vmcnt(7)
    buffer_load_dwordx4 a[76:79], v14, s[72:75], s63 offen nt
    s_add_u32 s63, s63, 8192
    s_waitcnt vmcnt(7)
    buffer_load_dwordx4 a[80:83], v14, s[72:75], s63 offen nt
    s_add_u32 s63, s63, 8192
    s_mov_b32 s52, s18
    s_and_b32 s53, s19, 0xffff
    s_mov_b32 s54, 134217728
    s_mov_b32 s55, 0x20000
    s_mov_b32 s56, s20
    s_and_b32 s57, s21, 0xffff
    s_mov_b32 s58, 134217728
    s_mov_b32 s59, 0x20000
    s_waitcnt vmcnt(7)
    buffer_load_dwordx4 a[84:87], v14, s[72:75], s63 offen nt
    s_add_u32 s63, s63, 8192
    s_waitcnt vmcnt(7)
    buffer_load_dwordx4 a[88:91], v14, s[72:75], s63 offen nt
    s_add_u32 s63, s63, 8192
    s_waitcnt vmcnt(7)
    buffer_load_dwordx4 a[92:95], v14, s[72:75], s63 offen nt
    s_add_u32 s63, s63, 8192
    s_waitcnt vmcnt(7)
    buffer_load_dwordx4 a[96:99], v14, s[72:75], s63 offen nt
    s_add_u32 s63, s63, 8192
    v_mov_b32 v120, 0xff7f0000
    v_mov_b32 v121, 0
    v_mov_b32 v18, 1
    v_mov_b32 v116, 0
    v_mov_b32 v117, 0
    v_mov_b32 v118, 0
    v_mov_b32 v119, 0
    s_lshl_b32 s38, s32, 2
    s_add_u32 s38, s38, s3
    s_lshl_b32 s96, s38, 3
    s_lshl_b32 s38, s38, 8
    s_add_u32 s38, s38, 65536
    v_mov_b32 v9, s38
    s_add_u32 s96, s96, s33
    s_lshl_b32 s96, s96, 10
    s_add_u32 s96, s96, 5242880
    v_and_b32 v5, 3, v3
    v_lshlrev_b32 v78, 7, v2
    v_lshl_add_u32 v78, v5, 5, v78
    s_lshl_b32 s91, s32, 12
    s_lshl_b32 s38, s3, 9
    s_add_u32 s91, s91, s38
    s_add_u32 s91, s91, 1048576
    v_lshlrev_b32 v4, 7, v2
    v_lshl_add_u32 v4, v3, 4, v4
    v_mov_b32 v5, 512
    v_cmp_gt_u32 vcc, 8, v3
    s_nop 1
    v_cndmask_b32 v79, v5, v4, vcc
    s_waitcnt vmcnt(7)
    buffer_load_dwordx4 a[100:103], v14, s[72:75], s63 offen nt
    s_add_u32 s63, s63, 8192
    s_waitcnt vmcnt(7)
    buffer_load_dwordx4 a[104:107], v14, s[72:75], s63 offen nt
    s_add_u32 s63, s63, 8192
    s_waitcnt vmcnt(7)
    buffer_load_dwordx4 a[108:111], v14, s[72:75], s63 offen nt
    s_add_u32 s63, s63, 8192
    s_waitcnt vmcnt(7)
    buffer_load_dwordx4 a[112:115], v14, s[72:75], s63 offen nt
    s_add_u32 s63, s63, 8192
    s_waitcnt vmcnt(7)
    buffer_load_dwordx4 a[116:119], v14, s[72:75], s63 offen nt
    s_add_u32 s63, s63, 8192
    s_waitcnt vmcnt(7)
    buffer_load_dwordx4 a[120:123], v14, s[72:75], s63 offen nt
    s_add_u32 s63, s63, 8192
    s_waitcnt vmcnt(7)
    buffer_load_dwordx4 a[124:127], v14, s[72:75], s63 offen nt
    s_add_u32 s63, s63, 8192
    s_waitcnt lgkmcnt(0)
    s_add_u32 s35, s35, 0x5b
    s_and_b32 s35, s35, 0xff
    v_mov_b32 v8, s35
    s_or_b32 s68, s35, 0x6b3ac500
    s_waitcnt vmcnt(6)
    s_add_u32 s39, s87, s88
    s_bfe_u32 s37, s39, 0x30000
    s_lshl_b32 s37, s37, 12
    s_add_u32 s85, s37, s89
    s_bfe_u32 s37, s39, 0x10003
    s_lshl_b32 s37, s37, 11
    s_add_u32 s85, s37, s85
    s_bfe_u32 s37, s39, 0x40004
    s_lshl_b32 s37, s37, 16
    s_add_u32 s85, s37, s85
    buffer_load_dwordx4 v[128:131], v76, s[52:55], s85 offen offset:0 nt
    s_waitcnt vmcnt(6)
    buffer_load_dwordx4 v[132:135], v77, s[52:55], s85 offen offset:0 nt
    s_waitcnt vmcnt(6)
    buffer_load_dwordx4 v[136:139], v76, s[52:55], s85 offen offset:1024 nt
    s_waitcnt vmcnt(6)
    buffer_load_dwordx4 v[140:143], v77, s[52:55], s85 offen offset:1024 nt
    s_waitcnt vmcnt(6)
    buffer_load_dwordx4 v[144:147], v126, s[56:59], s85 offen offset:0 nt
    s_waitcnt vmcnt(6)
    buffer_load_dwordx4 v[148:151], v127, s[56:59], s85 offen offset:0 nt
    s_waitcnt vmcnt(6)
    buffer_load_dwordx4 v[152:155], v126, s[56:59], s85 offen offset:1024 nt
    s_waitcnt vmcnt(6)
    buffer_load_dwordx4 v[156:159], v127, s[56:59], s85 offen offset:1024 nt
    s_waitcnt vmcnt(6)
    s_add_u32 s87, s87, 7
    s_add_u32 s39, s87, s88
    s_bfe_u32 s37, s39, 0x30000
    s_lshl_b32 s37, s37, 12
    s_add_u32 s85, s37, s89
    s_bfe_u32 s37, s39, 0x10003
    s_lshl_b32 s37, s37, 11
    s_add_u32 s85, s37, s85
    s_bfe_u32 s37, s39, 0x40004
    s_lshl_b32 s37, s37, 16
    s_add_u32 s85, s37, s85
    buffer_load_dwordx4 v[160:163], v76, s[52:55], s85 offen offset:0 nt
    s_waitcnt vmcnt(6)
    buffer_load_dwordx4 v[164:167], v77, s[52:55], s85 offen offset:0 nt
    s_waitcnt vmcnt(6)
    buffer_load_dwordx4 v[168:171], v76, s[52:55], s85 offen offset:1024 nt
    s_waitcnt vmcnt(6)
    buffer_load_dwordx4 v[172:175], v77, s[52:55], s85 offen offset:1024 nt
    s_waitcnt vmcnt(6)
    buffer_load_dwordx4 v[176:179], v126, s[56:59], s85 offen offset:0 nt
    s_waitcnt vmcnt(6)
    buffer_load_dwordx4 v[180:183], v127, s[56:59], s85 offen offset:0 nt
    s_waitcnt vmcnt(6)
    buffer_load_dwordx4 v[184:187], v126, s[56:59], s85 offen offset:1024 nt
    s_waitcnt vmcnt(6)
    buffer_load_dwordx4 v[188:191], v127, s[56:59], s85 offen offset:1024 nt
    buffer_load_dwordx4 v[20:23], v15, s[48:51], s95 offen offset:0 sc1
    buffer_load_dwordx4 v[24:27], v15, s[48:51], s95 offen offset:16 sc1
    s_waitcnt vmcnt(8)
    s_add_u32 s87, s87, 7
    s_add_u32 s39, s87, s88
    s_bfe_u32 s37, s39, 0x30000
    s_lshl_b32 s37, s37, 12
    s_add_u32 s85, s37, s89
    s_bfe_u32 s37, s39, 0x10003
    s_lshl_b32 s37, s37, 11
    s_add_u32 s85, s37, s85
    s_bfe_u32 s37, s39, 0x40004
    s_lshl_b32 s37, s37, 16
    s_add_u32 s85, s37, s85
    buffer_load_dwordx4 v[192:195], v76, s[52:55], s85 offen offset:0 nt
    s_waitcnt vmcnt(8)
    buffer_load_dwordx4 v[196:199], v77, s[52:55], s85 offen offset:0 nt
    s_waitcnt vmcnt(8)
    buffer_load_dwordx4 v[200:203], v76, s[52:55], s85 offen offset:1024 nt
    s_waitcnt vmcnt(8)
    buffer_load_dwordx4 v[204:207], v77, s[52:55], s85 offen offset:1024 nt
    s_waitcnt vmcnt(8)
    buffer_load_dwordx4 v[208:211], v126, s[56:59], s85 offen offset:0 nt
    s_waitcnt vmcnt(8)
    buffer_load_dwordx4 v[212:215], v127, s[56:59], s85 offen offset:0 nt
    s_waitcnt vmcnt(6)
L_qacheck_26:
    v_xor_b32 v20, s35, v20
    v_xor_b32 v21, s35, v21
    v_xor_b32 v22, s35, v22
    v_xor_b32 v23, s35, v23
    v_xor_b32 v24, s35, v24
    v_xor_b32 v25, s35, v25
    v_xor_b32 v26, s35, v26
    v_xor_b32 v27, s35, v27
    v_or_b32 v4, v20, v21
    v_or3_b32 v4, v4, v22, v23
    v_or3_b32 v4, v4, v24, v25
    v_or3_b32 v4, v4, v26, v27
    v_and_b32 v4, 0xff, v4
    v_cmp_ne_u32 vcc, 0, v4
    s_cbranch_vccz L_qaok_27
    buffer_load_dwordx4 v[20:23], v15, s[48:51], s95 offen offset:0 sc1
    buffer_load_dwordx4 v[24:27], v15, s[48:51], s95 offen offset:16 sc1
    s_waitcnt vmcnt(0)
    s_sub_u32 s84, s84, 1
    s_cmp_lg_u32 s84, 0
    s_cbranch_scc1 L_qacheck_26
    s_branch L_end
L_qaok_27:
    buffer_load_dwordx4 v[68:71], v78, s[48:51], s91 offen offset:0 sc1
    buffer_load_dwordx4 v[72:75], v78, s[48:51], s91 offen offset:16 sc1
    v_cvt_pk_bf16_f32 v20, v20, v21
    v_cvt_pk_bf16_f32 v21, v22, v23
    v_cvt_pk_bf16_f32 v22, v24, v25
    v_cvt_pk_bf16_f32 v23, v26, v27
    s_nop 1
    v_mfma_f32_16x16x32_bf16 v[28:31], a[0:3], v[20:23], 0
    v_mfma_f32_16x16x32_bf16 v[32:35], a[4:7], v[20:23], 0
    v_mfma_f32_16x16x32_bf16 v[36:39], a[8:11], v[20:23], 0
    s_nop 5
    v_mov_b32_dpp v60, v28 quad_perm:[0,0,0,0] row_mask:0xf bank_mask:0xf
    v_mov_b32_dpp v4, v30 quad_perm:[2,2,2,2] row_mask:0xf bank_mask:0xf
    s_nop 0
    v_add_f32_dpp v60, v29, v60 quad_perm:[1,1,1,1] row_mask:0xf bank_mask:0xf
    v_add_f32_dpp v4, v31, v4 quad_perm:[3,3,3,3] row_mask:0xf bank_mask:0xf
    v_add_f32 v60, v60, v4
    v_mfma_f32_16x16x32_bf16 v[40:43], a[12:15], v[20:23], 0
    v_mov_b32_dpp v61, v32 quad_perm:[0,0,0,0] row_mask:0xf bank_mask:0xf
    v_mov_b32_dpp v4, v34 quad_perm:[2,2,2,2] row_mask:0xf bank_mask:0xf
    s_nop 0
    v_add_f32_dpp v61, v33, v61 quad_perm:[1,1,1,1] row_mask:0xf bank_mask:0xf
    v_add_f32_dpp v4, v35, v4 quad_perm:[3,3,3,3] row_mask:0xf bank_mask:0xf
    v_add_f32 v61, v61, v4
    v_cvt_pk_bf16_f32 v44, v60, v61
    v_mfma_f32_16x16x32_bf16 v[28:31], a[16:19], v[20:23], 0
    v_mov_b32_dpp v60, v36 quad_perm:[0,0,0,0] row_mask:0xf bank_mask:0xf
    v_mov_b32_dpp v4, v38 quad_perm:[2,2,2,2] row_mask:0xf bank_mask:0xf
    s_nop 0
    v_add_f32_dpp v60, v37, v60 quad_perm:[1,1,1,1] row_mask:0xf bank_mask:0xf
    v_add_f32_dpp v4, v39, v4 quad_perm:[3,3,3,3] row_mask:0xf bank_mask:0xf
    v_add_f32 v60, v60, v4
    buffer_load_dwordx4 v[216:219], v126, s[56:59], s85 offen offset:1024 nt
    v_mfma_f32_16x16x32_bf16 v[32:35], a[20:23], v[20:23], 0
    v_mov_b32_dpp v61, v40 quad_perm:[0,0,0,0] row_mask:0xf bank_mask:0xf
    v_mov_b32_dpp v4, v42 quad_perm:[2,2,2,2] row_mask:0xf bank_mask:0xf
    s_nop 0
    v_add_f32_dpp v61, v41, v61 quad_perm:[1,1,1,1] row_mask:0xf bank_mask:0xf
    v_add_f32_dpp v4, v43, v4 quad_perm:[3,3,3,3] row_mask:0xf bank_mask:0xf
    v_add_f32 v61, v61, v4
    v_cvt_pk_bf16_f32 v45, v60, v61
    v_mfma_f32_16x16x32_bf16 v[36:39], a[24:27], v[20:23], 0
    v_mov_b32_dpp v60, v28 quad_perm:[0,0,0,0] row_mask:0xf bank_mask:0xf
    v_mov_b32_dpp v4, v30 quad_perm:[2,2,2,2] row_mask:0xf bank_mask:0xf
    s_nop 0
    v_add_f32_dpp v60, v29, v60 quad_perm:[1,1,1,1] row_mask:0xf bank_mask:0xf
    v_add_f32_dpp v4, v31, v4 quad_perm:[3,3,3,3] row_mask:0xf bank_mask:0xf
    v_add_f32 v60, v60, v4
    v_mfma_f32_16x16x32_bf16 v[40:43], a[28:31], v[20:23], 0
    v_mov_b32_dpp v61, v32 quad_perm:[0,0,0,0] row_mask:0xf bank_mask:0xf
    v_mov_b32_dpp v4, v34 quad_perm:[2,2,2,2] row_mask:0xf bank_mask:0xf
    s_nop 0
    v_add_f32_dpp v61, v33, v61 quad_perm:[1,1,1,1] row_mask:0xf bank_mask:0xf
    v_add_f32_dpp v4, v35, v4 quad_perm:[3,3,3,3] row_mask:0xf bank_mask:0xf
    v_add_f32 v61, v61, v4
    v_cvt_pk_bf16_f32 v46, v60, v61
    v_mfma_f32_16x16x32_bf16 v[28:31], a[32:35], v[20:23], 0
    v_mov_b32_dpp v60, v36 quad_perm:[0,0,0,0] row_mask:0xf bank_mask:0xf
    v_mov_b32_dpp v4, v38 quad_perm:[2,2,2,2] row_mask:0xf bank_mask:0xf
    s_nop 0
    v_add_f32_dpp v60, v37, v60 quad_perm:[1,1,1,1] row_mask:0xf bank_mask:0xf
    v_add_f32_dpp v4, v39, v4 quad_perm:[3,3,3,3] row_mask:0xf bank_mask:0xf
    v_add_f32 v60, v60, v4
    v_mfma_f32_16x16x32_bf16 v[32:35], a[36:39], v[20:23], 0
    v_mov_b32_dpp v61, v40 quad_perm:[0,0,0,0] row_mask:0xf bank_mask:0xf
    v_mov_b32_dpp v4, v42 quad_perm:[2,2,2,2] row_mask:0xf bank_mask:0xf
    s_nop 0
    v_add_f32_dpp v61, v41, v61 quad_perm:[1,1,1,1] row_mask:0xf bank_mask:0xf
    v_add_f32_dpp v4, v43, v4 quad_perm:[3,3,3,3] row_mask:0xf bank_mask:0xf
    v_add_f32 v61, v61, v4
    v_cvt_pk_bf16_f32 v47, v60, v61
    v_mfma_f32_16x16x32_bf16 v[36:39], a[40:43], v[20:23], 0
    v_mov_b32_dpp v60, v28 quad_perm:[0,0,0,0] row_mask:0xf bank_mask:0xf
    v_mov_b32_dpp v4, v30 quad_perm:[2,2,2,2] row_mask:0xf bank_mask:0xf
    s_nop 0
    v_add_f32_dpp v60, v29, v60 quad_perm:[1,1,1,1] row_mask:0xf bank_mask:0xf
    v_add_f32_dpp v4, v31, v4 quad_perm:[3,3,3,3] row_mask:0xf bank_mask:0xf
    v_add_f32 v60, v60, v4
    v_mfma_f32_16x16x32_bf16 v[40:43], a[44:47], v[20:23], 0
    v_mov_b32_dpp v61, v32 quad_perm:[0,0,0,0] row_mask:0xf bank_mask:0xf
    v_mov_b32_dpp v4, v34 quad_perm:[2,2,2,2] row_mask:0xf bank_mask:0xf
    s_nop 0
    v_add_f32_dpp v61, v33, v61 quad_perm:[1,1,1,1] row_mask:0xf bank_mask:0xf
    v_add_f32_dpp v4, v35, v4 quad_perm:[3,3,3,3] row_mask:0xf bank_mask:0xf
    v_add_f32 v61, v61, v4
    v_cvt_pk_bf16_f32 v48, v60, v61
    v_mfma_f32_16x16x32_bf16 v[28:31], a[48:51], v[20:23], 0
    v_mov_b32_dpp v60, v36 quad_perm:[0,0,0,0] row_mask:0xf bank_mask:0xf
    v_mov_b32_dpp v4, v38 quad_perm:[2,2,2,2] row_mask:0xf bank_mask:0xf
    s_nop 0
    v_add_f32_dpp v60, v37, v60 quad_perm:[1,1,1,1] row_mask:0xf bank_mask:0xf
    v_add_f32_dpp v4, v39, v4 quad_perm:[3,3,3,3] row_mask:0xf bank_mask:0xf
    v_add_f32 v60, v60, v4
    buffer_load_dwordx4 v[220:223], v127, s[56:59], s85 offen offset:1024 nt
    v_mfma_f32_16x16x32_bf16 v[32:35], a[52:55], v[20:23], 0
    v_mov_b32_dpp v61, v40 quad_perm:[0,0,0,0] row_mask:0xf bank_mask:0xf
    v_mov_b32_dpp v4, v42 quad_perm:[2,2,2,2] row_mask:0xf bank_mask:0xf
    s_nop 0
    v_add_f32_dpp v61, v41, v61 quad_perm:[1,1,1,1] row_mask:0xf bank_mask:0xf
    v_add_f32_dpp v4, v43, v4 quad_perm:[3,3,3,3] row_mask:0xf bank_mask:0xf
    v_add_f32 v61, v61, v4
    v_cvt_pk_bf16_f32 v49, v60, v61
    v_mfma_f32_16x16x32_bf16 v[36:39], a[56:59], v[20:23], 0
    v_mov_b32_dpp v60, v28 quad_perm:[0,0,0,0] row_mask:0xf bank_mask:0xf
    v_mov_b32_dpp v4, v30 quad_perm:[2,2,2,2] row_mask:0xf bank_mask:0xf
    s_nop 0
    v_add_f32_dpp v60, v29, v60 quad_perm:[1,1,1,1] row_mask:0xf bank_mask:0xf
    v_add_f32_dpp v4, v31, v4 quad_perm:[3,3,3,3] row_mask:0xf bank_mask:0xf
    v_add_f32 v60, v60, v4
    v_mfma_f32_16x16x32_bf16 v[40:43], a[60:63], v[20:23], 0
    v_mov_b32_dpp v61, v32 quad_perm:[0,0,0,0] row_mask:0xf bank_mask:0xf
    v_mov_b32_dpp v4, v34 quad_perm:[2,2,2,2] row_mask:0xf bank_mask:0xf
    s_nop 0
    v_add_f32_dpp v61, v33, v61 quad_perm:[1,1,1,1] row_mask:0xf bank_mask:0xf
    v_add_f32_dpp v4, v35, v4 quad_perm:[3,3,3,3] row_mask:0xf bank_mask:0xf
    v_add_f32 v61, v61, v4
    v_cvt_pk_bf16_f32 v50, v60, v61
    v_mfma_f32_16x16x32_bf16 v[28:31], a[64:67], v[20:23], 0
    v_mov_b32_dpp v60, v36 quad_perm:[0,0,0,0] row_mask:0xf bank_mask:0xf
    v_mov_b32_dpp v4, v38 quad_perm:[2,2,2,2] row_mask:0xf bank_mask:0xf
    s_nop 0
    v_add_f32_dpp v60, v37, v60 quad_perm:[1,1,1,1] row_mask:0xf bank_mask:0xf
    v_add_f32_dpp v4, v39, v4 quad_perm:[3,3,3,3] row_mask:0xf bank_mask:0xf
    v_add_f32 v60, v60, v4
    v_mfma_f32_16x16x32_bf16 v[32:35], a[68:71], v[20:23], 0
    v_mov_b32_dpp v61, v40 quad_perm:[0,0,0,0] row_mask:0xf bank_mask:0xf
    v_mov_b32_dpp v4, v42 quad_perm:[2,2,2,2] row_mask:0xf bank_mask:0xf
    s_nop 0
    v_add_f32_dpp v61, v41, v61 quad_perm:[1,1,1,1] row_mask:0xf bank_mask:0xf
    v_add_f32_dpp v4, v43, v4 quad_perm:[3,3,3,3] row_mask:0xf bank_mask:0xf
    v_add_f32 v61, v61, v4
    v_cvt_pk_bf16_f32 v51, v60, v61
    v_mfma_f32_16x16x32_bf16 v[36:39], a[72:75], v[20:23], 0
    v_mov_b32_dpp v60, v28 quad_perm:[0,0,0,0] row_mask:0xf bank_mask:0xf
    v_mov_b32_dpp v4, v30 quad_perm:[2,2,2,2] row_mask:0xf bank_mask:0xf
    s_nop 0
    v_add_f32_dpp v60, v29, v60 quad_perm:[1,1,1,1] row_mask:0xf bank_mask:0xf
    v_add_f32_dpp v4, v31, v4 quad_perm:[3,3,3,3] row_mask:0xf bank_mask:0xf
    v_add_f32 v60, v60, v4
    v_mfma_f32_16x16x32_bf16 v[40:43], a[76:79], v[20:23], 0
    v_mov_b32_dpp v61, v32 quad_perm:[0,0,0,0] row_mask:0xf bank_mask:0xf
    v_mov_b32_dpp v4, v34 quad_perm:[2,2,2,2] row_mask:0xf bank_mask:0xf
    s_nop 0
    v_add_f32_dpp v61, v33, v61 quad_perm:[1,1,1,1] row_mask:0xf bank_mask:0xf
    v_add_f32_dpp v4, v35, v4 quad_perm:[3,3,3,3] row_mask:0xf bank_mask:0xf
    v_add_f32 v61, v61, v4
    v_cvt_pk_bf16_f32 v52, v60, v61
    v_mfma_f32_16x16x32_bf16 v[28:31], a[80:83], v[20:23], 0
    v_mov_b32_dpp v60, v36 quad_perm:[0,0,0,0] row_mask:0xf bank_mask:0xf
    v_mov_b32_dpp v4, v38 quad_perm:[2,2,2,2] row_mask:0xf bank_mask:0xf
    s_nop 0
    v_add_f32_dpp v60, v37, v60 quad_perm:[1,1,1,1] row_mask:0xf bank_mask:0xf
    v_add_f32_dpp v4, v39, v4 quad_perm:[3,3,3,3] row_mask:0xf bank_mask:0xf
    v_add_f32 v60, v60, v4
    s_add_u32 s87, s87, 7
    s_add_u32 s39, s87, s88
    s_bfe_u32 s37, s39, 0x30000
    s_lshl_b32 s37, s37, 12
    s_add_u32 s85, s37, s89
    s_bfe_u32 s37, s39, 0x10003
    s_lshl_b32 s37, s37, 11
    s_add_u32 s85, s37, s85
    s_bfe_u32 s37, s39, 0x40004
    s_lshl_b32 s37, s37, 16
    s_add_u32 s85, s37, s85
    buffer_load_dwordx4 v[224:227], v76, s[52:55], s85 offen offset:0 nt
    v_mfma_f32_16x16x32_bf16 v[32:35], a[84:87], v[20:23], 0
    v_mov_b32_dpp v61, v40 quad_perm:[0,0,0,0] row_mask:0xf bank_mask:0xf
    v_mov_b32_dpp v4, v42 quad_perm:[2,2,2,2] row_mask:0xf bank_mask:0xf
    s_nop 0
    v_add_f32_dpp v61, v41, v61 quad_perm:[1,1,1,1] row_mask:0xf bank_mask:0xf
    v_add_f32_dpp v4, v43, v4 quad_perm:[3,3,3,3] row_mask:0xf bank_mask:0xf
    v_add_f32 v61, v61, v4
    v_cvt_pk_bf16_f32 v53, v60, v61
    v_mfma_f32_16x16x32_bf16 v[36:39], a[88:91], v[20:23], 0
    v_mov_b32_dpp v60, v28 quad_perm:[0,0,0,0] row_mask:0xf bank_mask:0xf
    v_mov_b32_dpp v4, v30 quad_perm:[2,2,2,2] row_mask:0xf bank_mask:0xf
    s_nop 0
    v_add_f32_dpp v60, v29, v60 quad_perm:[1,1,1,1] row_mask:0xf bank_mask:0xf
    v_add_f32_dpp v4, v31, v4 quad_perm:[3,3,3,3] row_mask:0xf bank_mask:0xf
    v_add_f32 v60, v60, v4
    v_mfma_f32_16x16x32_bf16 v[40:43], a[92:95], v[20:23], 0
    v_mov_b32_dpp v61, v32 quad_perm:[0,0,0,0] row_mask:0xf bank_mask:0xf
    v_mov_b32_dpp v4, v34 quad_perm:[2,2,2,2] row_mask:0xf bank_mask:0xf
    s_nop 0
    v_add_f32_dpp v61, v33, v61 quad_perm:[1,1,1,1] row_mask:0xf bank_mask:0xf
    v_add_f32_dpp v4, v35, v4 quad_perm:[3,3,3,3] row_mask:0xf bank_mask:0xf
    v_add_f32 v61, v61, v4
    v_cvt_pk_bf16_f32 v54, v60, v61
    v_mfma_f32_16x16x32_bf16 v[28:31], a[96:99], v[20:23], 0
    v_mov_b32_dpp v60, v36 quad_perm:[0,0,0,0] row_mask:0xf bank_mask:0xf
    v_mov_b32_dpp v4, v38 quad_perm:[2,2,2,2] row_mask:0xf bank_mask:0xf
    s_nop 0
    v_add_f32_dpp v60, v37, v60 quad_perm:[1,1,1,1] row_mask:0xf bank_mask:0xf
    v_add_f32_dpp v4, v39, v4 quad_perm:[3,3,3,3] row_mask:0xf bank_mask:0xf
    v_add_f32 v60, v60, v4
    v_mfma_f32_16x16x32_bf16 v[32:35], a[100:103], v[20:23], 0
    v_mov_b32_dpp v61, v40 quad_perm:[0,0,0,0] row_mask:0xf bank_mask:0xf
    v_mov_b32_dpp v4, v42 quad_perm:[2,2,2,2] row_mask:0xf bank_mask:0xf
    s_nop 0
    v_add_f32_dpp v61, v41, v61 quad_perm:[1,1,1,1] row_mask:0xf bank_mask:0xf
    v_add_f32_dpp v4, v43, v4 quad_perm:[3,3,3,3] row_mask:0xf bank_mask:0xf
    v_add_f32 v61, v61, v4
    v_cvt_pk_bf16_f32 v55, v60, v61
    v_mfma_f32_16x16x32_bf16 v[36:39], a[104:107], v[20:23], 0
    v_mov_b32_dpp v60, v28 quad_perm:[0,0,0,0] row_mask:0xf bank_mask:0xf
    v_mov_b32_dpp v4, v30 quad_perm:[2,2,2,2] row_mask:0xf bank_mask:0xf
    s_nop 0
    v_add_f32_dpp v60, v29, v60 quad_perm:[1,1,1,1] row_mask:0xf bank_mask:0xf
    v_add_f32_dpp v4, v31, v4 quad_perm:[3,3,3,3] row_mask:0xf bank_mask:0xf
    v_add_f32 v60, v60, v4
    v_mfma_f32_16x16x32_bf16 v[40:43], a[108:111], v[20:23], 0
    v_mov_b32_dpp v61, v32 quad_perm:[0,0,0,0] row_mask:0xf bank_mask:0xf
    v_mov_b32_dpp v4, v34 quad_perm:[2,2,2,2] row_mask:0xf bank_mask:0xf
    s_nop 0
    v_add_f32_dpp v61, v33, v61 quad_perm:[1,1,1,1] row_mask:0xf bank_mask:0xf
    v_add_f32_dpp v4, v35, v4 quad_perm:[3,3,3,3] row_mask:0xf bank_mask:0xf
    v_add_f32 v61, v61, v4
    v_cvt_pk_bf16_f32 v56, v60, v61
    v_mfma_f32_16x16x32_bf16 v[28:31], a[112:115], v[20:23], 0
    v_mov_b32_dpp v60, v36 quad_perm:[0,0,0,0] row_mask:0xf bank_mask:0xf
    v_mov_b32_dpp v4, v38 quad_perm:[2,2,2,2] row_mask:0xf bank_mask:0xf
    s_nop 0
    v_add_f32_dpp v60, v37, v60 quad_perm:[1,1,1,1] row_mask:0xf bank_mask:0xf
    v_add_f32_dpp v4, v39, v4 quad_perm:[3,3,3,3] row_mask:0xf bank_mask:0xf
    v_add_f32 v60, v60, v4
    buffer_load_dwordx4 v[228:231], v77, s[52:55], s85 offen offset:0 nt
    v_mfma_f32_16x16x32_bf16 v[32:35], a[116:119], v[20:23], 0
    v_mov_b32_dpp v61, v40 quad_perm:[0,0,0,0] row_mask:0xf bank_mask:0xf
    v_mov_b32_dpp v4, v42 quad_perm:[2,2,2,2] row_mask:0xf bank_mask:0xf
    s_nop 0
    v_add_f32_dpp v61, v41, v61 quad_perm:[1,1,1,1] row_mask:0xf bank_mask:0xf
    v_add_f32_dpp v4, v43, v4 quad_perm:[3,3,3,3] row_mask:0xf bank_mask:0xf
    v_add_f32 v61, v61, v4
    v_cvt_pk_bf16_f32 v57, v60, v61
    v_mfma_f32_16x16x32_bf16 v[36:39], a[120:123], v[20:23], 0
    v_mov_b32_dpp v60, v28 quad_perm:[0,0,0,0] row_mask:0xf bank_mask:0xf
    v_mov_b32_dpp v4, v30 quad_perm:[2,2,2,2] row_mask:0xf bank_mask:0xf
    s_nop 0
    v_add_f32_dpp v60, v29, v60 quad_perm:[1,1,1,1] row_mask:0xf bank_mask:0xf
    v_add_f32_dpp v4, v31, v4 quad_perm:[3,3,3,3] row_mask:0xf bank_mask:0xf
    v_add_f32 v60, v60, v4
    v_mfma_f32_16x16x32_bf16 v[40:43], a[124:127], v[20:23], 0
    v_mov_b32_dpp v61, v32 quad_perm:[0,0,0,0] row_mask:0xf bank_mask:0xf
    v_mov_b32_dpp v4, v34 quad_perm:[2,2,2,2] row_mask:0xf bank_mask:0xf
    s_nop 0
    v_add_f32_dpp v61, v33, v61 quad_perm:[1,1,1,1] row_mask:0xf bank_mask:0xf
    v_add_f32_dpp v4, v35, v4 quad_perm:[3,3,3,3] row_mask:0xf bank_mask:0xf
    v_add_f32 v61, v61, v4
    v_cvt_pk_bf16_f32 v58, v60, v61
    v_mov_b32_dpp v60, v36 quad_perm:[0,0,0,0] row_mask:0xf bank_mask:0xf
    v_mov_b32_dpp v4, v38 quad_perm:[2,2,2,2] row_mask:0xf bank_mask:0xf
    s_nop 0
    v_add_f32_dpp v60, v37, v60 quad_perm:[1,1,1,1] row_mask:0xf bank_mask:0xf
    v_add_f32_dpp v4, v39, v4 quad_perm:[3,3,3,3] row_mask:0xf bank_mask:0xf
    v_add_f32 v60, v60, v4
    v_mov_b32_dpp v61, v40 quad_perm:[0,0,0,0] row_mask:0xf bank_mask:0xf
    v_mov_b32_dpp v4, v42 quad_perm:[2,2,2,2] row_mask:0xf bank_mask:0xf
    s_nop 0
    v_add_f32_dpp v61, v41, v61 quad_perm:[1,1,1,1] row_mask:0xf bank_mask:0xf
    v_add_f32_dpp v4, v43, v4 quad_perm:[3,3,3,3] row_mask:0xf bank_mask:0xf
    v_add_f32 v61, v61, v4
    v_cvt_pk_bf16_f32 v59, v60, v61
    s_mov_b32 exec_lo, 0x22222222
    s_mov_b32 exec_hi, 0x22222222
    v_mov_b32 v44, v48
    v_mov_b32 v45, v49
    v_mov_b32 v46, v50
    v_mov_b32 v47, v51
    s_mov_b32 exec_lo, 0x44444444
    s_mov_b32 exec_hi, 0x44444444
    v_mov_b32 v44, v52
    v_mov_b32 v45, v53
    v_mov_b32 v46, v54
    v_mov_b32 v47, v55
    s_mov_b32 exec_lo, 0x88888888
    s_mov_b32 exec_hi, 0x88888888
    v_mov_b32 v44, v56
    v_mov_b32 v45, v57
    v_mov_b32 v46, v58
    v_mov_b32 v47, v59
    s_mov_b64 exec, -1
    buffer_store_dwordx4 v[44:47], v19, s[48:51], s94 offen sc1
    s_waitcnt vmcnt(5)
L_qcheck_28:
    v_xor_b32 v68, s35, v68
    v_xor_b32 v69, s35, v69
    v_xor_b32 v70, s35, v70
    v_xor_b32 v71, s35, v71
    v_xor_b32 v72, s35, v72
    v_xor_b32 v73, s35, v73
    v_xor_b32 v74, s35, v74
    v_xor_b32 v75, s35, v75
    v_or_b32 v4, v68, v69
    v_or3_b32 v4, v4, v70, v71
    v_or3_b32 v4, v4, v72, v73
    v_or3_b32 v4, v4, v74, v75
    v_and_b32 v4, 0xff, v4
    v_cmp_ne_u32 vcc, 0, v4
    s_cbranch_vccz L_qok_29
    buffer_load_dwordx4 v[68:71], v78, s[48:51], s91 offen offset:0 sc1
    buffer_load_dwordx4 v[72:75], v78, s[48:51], s91 offen offset:16 sc1
    s_waitcnt vmcnt(0)
    s_sub_u32 s84, s84, 1
    s_cmp_lg_u32 s84, 0
    s_cbranch_scc1 L_qcheck_28
    s_branch L_end
L_qok_29:
    v_cvt_pk_bf16_f32 v68, v68, v69
    v_cvt_pk_bf16_f32 v69, v70, v71
    v_cvt_pk_bf16_f32 v70, v72, v73
    v_cvt_pk_bf16_f32 v71, v74, v75
    s_mov_b32 vcc_lo, 0xf000f
    s_mov_b32 vcc_hi, 0xf000f
    v_cndmask_b32 v80, 0, v68, vcc
    v_cndmask_b32 v81, 0, v69, vcc
    v_cndmask_b32 v82, 0, v70, vcc
    v_cndmask_b32 v83, 0, v71, vcc
    s_mov_b32 vcc_lo, 0xf000f0
    s_mov_b32 vcc_hi, 0xf000f0
    v_cndmask_b32 v84, 0, v68, vcc
    v_cndmask_b32 v85, 0, v69, vcc
    v_cndmask_b32 v86, 0, v70, vcc
    v_cndmask_b32 v87, 0, v71, vcc
    s_mov_b32 vcc_lo, 0xf000f00
    s_mov_b32 vcc_hi, 0xf000f00
    v_cndmask_b32 v88, 0, v68, vcc
    v_cndmask_b32 v89, 0, v69, vcc
    v_cndmask_b32 v90, 0, v70, vcc
    v_cndmask_b32 v91, 0, v71, vcc
    s_mov_b32 vcc_lo, 0xf000f000
    s_mov_b32 vcc_hi, 0xf000f000
    v_cndmask_b32 v92, 0, v68, vcc
    v_cndmask_b32 v93, 0, v69, vcc
    v_cndmask_b32 v94, 0, v70, vcc
    v_cndmask_b32 v95, 0, v71, vcc
    buffer_load_dwordx4 v[232:235], v76, s[52:55], s85 offen offset:1024 nt
    v_mfma_f32_16x16x32_bf16 v[112:115], v[128:131], v[80:83], 0
    v_mfma_f32_16x16x32_bf16 v[112:115], v[132:135], v[84:87], v[112:115]
    buffer_load_dwordx4 v[236:239], v77, s[52:55], s85 offen offset:1024 nt
    v_mfma_f32_16x16x32_bf16 v[112:115], v[136:139], v[88:91], v[112:115]
    v_mfma_f32_16x16x32_bf16 v[112:115], v[140:143], v[92:95], v[112:115]
    s_nop 7
    v_mov_b32_dpp v122, v112 quad_perm:[0,0,0,0] row_mask:0xf bank_mask:0xf
    v_mov_b32_dpp v124, v114 quad_perm:[2,2,2,2] row_mask:0xf bank_mask:0xf
    s_nop 0
    v_add_f32_dpp v122, v113, v122 quad_perm:[1,1,1,1] row_mask:0xf bank_mask:0xf
    v_add_f32_dpp v124, v115, v124 quad_perm:[3,3,3,3] row_mask:0xf bank_mask:0xf
    v_add_f32 v122, v122, v124
    v_fma_f32 v123, v122, s83, -v120
    v_cmp_lt_f32 vcc, 0, v123
    s_cbranch_vccz L_nomax_30
    v_mul_f32 v122, s83, v122
    s_nop 1
    v_max_f32_dpp v124, v122, v122 row_ror:4 row_mask:0xf bank_mask:0xf
    s_nop 1
    v_max_f32_dpp v124, v124, v124 row_ror:8 row_mask:0xf bank_mask:0xf
    v_mov_b32 v125, v124
    s_nop 1
    v_permlane16_swap_b32 v124, v125
    v_max_f32 v124, v124, v125
    v_mov_b32 v125, v124
    s_nop 1
    v_permlane32_swap_b32 v124, v125
    v_max_f32 v124, v124, v125
    v_and_b32 v124, s82, v124
    v_max_f32 v124, v124, v120
    v_sub_f32 v125, v120, v124
    v_exp_f32 v125, v125
    v_mov_b32 v120, v124
    v_sub_f32 v123, v122, v124
    v_mul_f32 v121, v121, v125
    v_mul_f32 v116, v116, v125
    v_mul_f32 v117, v117, v125
    v_mul_f32 v118, v118, v125
    v_mul_f32 v119, v119, v125
L_nomax_30:
    v_exp_f32 v123, v123
    s_nop 0
    v_cvt_pk_bf16_f32 v124, v123, v123
    v_add_f32 v121, v121, v123
    s_nop 0
    v_and_b32_dpp v96, v124, v10 row_newbcast:0 row_mask:0xf bank_mask:0xf
    v_and_b32_dpp v97, v124, v11 row_newbcast:0 row_mask:0xf bank_mask:0xf
    v_and_b32_dpp v98, v124, v12 row_newbcast:0 row_mask:0xf bank_mask:0xf
    v_and_b32_dpp v99, v124, v13 row_newbcast:0 row_mask:0xf bank_mask:0xf
    v_and_b32_dpp v100, v124, v10 row_newbcast:4 row_mask:0xf bank_mask:0xf
    v_and_b32_dpp v101, v124, v11 row_newbcast:4 row_mask:0xf bank_mask:0xf
    v_and_b32_dpp v102, v124, v12 row_newbcast:4 row_mask:0xf bank_mask:0xf
    v_and_b32_dpp v103, v124, v13 row_newbcast:4 row_mask:0xf bank_mask:0xf
    v_and_b32_dpp v104, v124, v10 row_newbcast:8 row_mask:0xf bank_mask:0xf
    v_and_b32_dpp v105, v124, v11 row_newbcast:8 row_mask:0xf bank_mask:0xf
    v_and_b32_dpp v106, v124, v12 row_newbcast:8 row_mask:0xf bank_mask:0xf
    v_and_b32_dpp v107, v124, v13 row_newbcast:8 row_mask:0xf bank_mask:0xf
    v_and_b32_dpp v108, v124, v10 row_newbcast:12 row_mask:0xf bank_mask:0xf
    v_and_b32_dpp v109, v124, v11 row_newbcast:12 row_mask:0xf bank_mask:0xf
    v_and_b32_dpp v110, v124, v12 row_newbcast:12 row_mask:0xf bank_mask:0xf
    v_and_b32_dpp v111, v124, v13 row_newbcast:12 row_mask:0xf bank_mask:0xf
    v_mfma_f32_16x16x32_bf16 v[116:119], v[144:147], v[96:99], v[116:119]
    buffer_load_dwordx4 v[240:243], v126, s[56:59], s85 offen offset:0 nt
    v_mfma_f32_16x16x32_bf16 v[116:119], v[148:151], v[100:103], v[116:119]
    v_mfma_f32_16x16x32_bf16 v[116:119], v[152:155], v[104:107], v[116:119]
    v_mfma_f32_16x16x32_bf16 v[116:119], v[156:159], v[108:111], v[116:119]
    s_waitcnt vmcnt(7)
    buffer_load_dwordx4 v[244:247], v127, s[56:59], s85 offen offset:0 nt
    v_mfma_f32_16x16x32_bf16 v[112:115], v[160:163], v[80:83], 0
    v_mfma_f32_16x16x32_bf16 v[112:115], v[164:167], v[84:87], v[112:115]
    v_mfma_f32_16x16x32_bf16 v[112:115], v[168:171], v[88:91], v[112:115]
    s_waitcnt vmcnt(7)
    buffer_load_dwordx4 v[248:251], v126, s[56:59], s85 offen offset:1024 nt
    v_mfma_f32_16x16x32_bf16 v[112:115], v[172:175], v[92:95], v[112:115]
    s_nop 7
    v_mov_b32_dpp v122, v112 quad_perm:[0,0,0,0] row_mask:0xf bank_mask:0xf
    v_mov_b32_dpp v124, v114 quad_perm:[2,2,2,2] row_mask:0xf bank_mask:0xf
    s_nop 0
    v_add_f32_dpp v122, v113, v122 quad_perm:[1,1,1,1] row_mask:0xf bank_mask:0xf
    v_add_f32_dpp v124, v115, v124 quad_perm:[3,3,3,3] row_mask:0xf bank_mask:0xf
    v_add_f32 v122, v122, v124
    v_fma_f32 v123, v122, s83, -v120
    v_cmp_lt_f32 vcc, 0, v123
    s_cbranch_vccz L_nomax_31
    v_mul_f32 v122, s83, v122
    s_nop 1
    v_max_f32_dpp v124, v122, v122 row_ror:4 row_mask:0xf bank_mask:0xf
    s_nop 1
    v_max_f32_dpp v124, v124, v124 row_ror:8 row_mask:0xf bank_mask:0xf
    v_mov_b32 v125, v124
    s_nop 1
    v_permlane16_swap_b32 v124, v125
    v_max_f32 v124, v124, v125
    v_mov_b32 v125, v124
    s_nop 1
    v_permlane32_swap_b32 v124, v125
    v_max_f32 v124, v124, v125
    v_and_b32 v124, s82, v124
    v_max_f32 v124, v124, v120
    v_sub_f32 v125, v120, v124
    v_exp_f32 v125, v125
    v_mov_b32 v120, v124
    v_sub_f32 v123, v122, v124
    v_mul_f32 v121, v121, v125
    v_mul_f32 v116, v116, v125
    v_mul_f32 v117, v117, v125
    v_mul_f32 v118, v118, v125
    v_mul_f32 v119, v119, v125
L_nomax_31:
    v_exp_f32 v123, v123
    s_nop 0
    v_cvt_pk_bf16_f32 v124, v123, v123
    v_add_f32 v121, v121, v123
    s_nop 0
    v_and_b32_dpp v96, v124, v10 row_newbcast:0 row_mask:0xf bank_mask:0xf
    v_and_b32_dpp v97, v124, v11 row_newbcast:0 row_mask:0xf bank_mask:0xf
    v_and_b32_dpp v98, v124, v12 row_newbcast:0 row_mask:0xf bank_mask:0xf
    v_and_b32_dpp v99, v124, v13 row_newbcast:0 row_mask:0xf bank_mask:0xf
    v_and_b32_dpp v100, v124, v10 row_newbcast:4 row_mask:0xf bank_mask:0xf
    v_and_b32_dpp v101, v124, v11 row_newbcast:4 row_mask:0xf bank_mask:0xf
    v_and_b32_dpp v102, v124, v12 row_newbcast:4 row_mask:0xf bank_mask:0xf
    v_and_b32_dpp v103, v124, v13 row_newbcast:4 row_mask:0xf bank_mask:0xf
    v_and_b32_dpp v104, v124, v10 row_newbcast:8 row_mask:0xf bank_mask:0xf
    v_and_b32_dpp v105, v124, v11 row_newbcast:8 row_mask:0xf bank_mask:0xf
    v_and_b32_dpp v106, v124, v12 row_newbcast:8 row_mask:0xf bank_mask:0xf
    v_and_b32_dpp v107, v124, v13 row_newbcast:8 row_mask:0xf bank_mask:0xf
    v_and_b32_dpp v108, v124, v10 row_newbcast:12 row_mask:0xf bank_mask:0xf
    v_and_b32_dpp v109, v124, v11 row_newbcast:12 row_mask:0xf bank_mask:0xf
    v_and_b32_dpp v110, v124, v12 row_newbcast:12 row_mask:0xf bank_mask:0xf
    v_and_b32_dpp v111, v124, v13 row_newbcast:12 row_mask:0xf bank_mask:0xf
    v_mfma_f32_16x16x32_bf16 v[116:119], v[176:179], v[96:99], v[116:119]
    v_mfma_f32_16x16x32_bf16 v[116:119], v[180:183], v[100:103], v[116:119]
    s_waitcnt vmcnt(7)
    buffer_load_dwordx4 v[252:255], v127, s[56:59], s85 offen offset:1024 nt
    v_mfma_f32_16x16x32_bf16 v[116:119], v[184:187], v[104:107], v[116:119]
    v_mfma_f32_16x16x32_bf16 v[116:119], v[188:191], v[108:111], v[116:119]
    s_lshl_b32 s38, s34, 5
    s_add_u32 s38, s38, s32
    s_lshl_b32 s38, s38, 8
    s_add_u32 s38, s38, 131072
    v_mov_b32 v28, s38
    v_mov_b32 v29, s68
    s_waitcnt vmcnt(6)
    s_mov_b64 exec, 1
    buffer_store_dword v29, v28, s[48:51], 0 offen sc1
    s_mov_b64 exec, -1
    v_mfma_f32_16x16x32_bf16 v[112:115], v[192:195], v[80:83], 0
    s_waitcnt vmcnt(6)
    s_add_u32 s87, s87, 7
    s_add_u32 s39, s87, s88
    s_bfe_u32 s37, s39, 0x30000
    s_lshl_b32 s37, s37, 12
    s_add_u32 s85, s37, s89
    s_bfe_u32 s37, s39, 0x10003
    s_lshl_b32 s37, s37, 11
    s_add_u32 s85, s37, s85
    s_bfe_u32 s37, s39, 0x40004
    s_lshl_b32 s37, s37, 16
    s_add_u32 s85, s37, s85
    buffer_load_dwordx4 v[128:131], v76, s[52:55], s85 offen offset:0 nt
    v_mfma_f32_16x16x32_bf16 v[112:115], v[196:199], v[84:87], v[112:115]
    v_mfma_f32_16x16x32_bf16 v[112:115], v[200:203], v[88:91], v[112:115]
    v_mfma_f32_16x16x32_bf16 v[112:115], v[204:207], v[92:95], v[112:115]
    s_nop 7
    v_mov_b32_dpp v122, v112 quad_perm:[0,0,0,0] row_mask:0xf bank_mask:0xf
    v_mov_b32_dpp v124, v114 quad_perm:[2,2,2,2] row_mask:0xf bank_mask:0xf
    s_nop 0
    v_add_f32_dpp v122, v113, v122 quad_perm:[1,1,1,1] row_mask:0xf bank_mask:0xf
    v_add_f32_dpp v124, v115, v124 quad_perm:[3,3,3,3] row_mask:0xf bank_mask:0xf
    v_add_f32 v122, v122, v124
    v_fma_f32 v123, v122, s83, -v120
    v_cmp_lt_f32 vcc, 0, v123
    s_cbranch_vccz L_nomax_32
    v_mul_f32 v122, s83, v122
    s_nop 1
    v_max_f32_dpp v124, v122, v122 row_ror:4 row_mask:0xf bank_mask:0xf
    s_nop 1
    v_max_f32_dpp v124, v124, v124 row_ror:8 row_mask:0xf bank_mask:0xf
    v_mov_b32 v125, v124
    s_nop 1
    v_permlane16_swap_b32 v124, v125
    v_max_f32 v124, v124, v125
    v_mov_b32 v125, v124
    s_nop 1
    v_permlane32_swap_b32 v124, v125
    v_max_f32 v124, v124, v125
    v_and_b32 v124, s82, v124
    v_max_f32 v124, v124, v120
    v_sub_f32 v125, v120, v124
    v_exp_f32 v125, v125
    v_mov_b32 v120, v124
    v_sub_f32 v123, v122, v124
    v_mul_f32 v121, v121, v125
    v_mul_f32 v116, v116, v125
    v_mul_f32 v117, v117, v125
    v_mul_f32 v118, v118, v125
    v_mul_f32 v119, v119, v125
L_nomax_32:
    v_exp_f32 v123, v123
    s_nop 0
    v_cvt_pk_bf16_f32 v124, v123, v123
    v_add_f32 v121, v121, v123
    s_nop 0
    v_and_b32_dpp v96, v124, v10 row_newbcast:0 row_mask:0xf bank_mask:0xf
    v_and_b32_dpp v97, v124, v11 row_newbcast:0 row_mask:0xf bank_mask:0xf
    v_and_b32_dpp v98, v124, v12 row_newbcast:0 row_mask:0xf bank_mask:0xf
    v_and_b32_dpp v99, v124, v13 row_newbcast:0 row_mask:0xf bank_mask:0xf
    v_and_b32_dpp v100, v124, v10 row_newbcast:4 row_mask:0xf bank_mask:0xf
    v_and_b32_dpp v101, v124, v11 row_newbcast:4 row_mask:0xf bank_mask:0xf
    v_and_b32_dpp v102, v124, v12 row_newbcast:4 row_mask:0xf bank_mask:0xf
    v_and_b32_dpp v103, v124, v13 row_newbcast:4 row_mask:0xf bank_mask:0xf
    v_and_b32_dpp v104, v124, v10 row_newbcast:8 row_mask:0xf bank_mask:0xf
    v_and_b32_dpp v105, v124, v11 row_newbcast:8 row_mask:0xf bank_mask:0xf
    v_and_b32_dpp v106, v124, v12 row_newbcast:8 row_mask:0xf bank_mask:0xf
    v_and_b32_dpp v107, v124, v13 row_newbcast:8 row_mask:0xf bank_mask:0xf
    v_and_b32_dpp v108, v124, v10 row_newbcast:12 row_mask:0xf bank_mask:0xf
    v_and_b32_dpp v109, v124, v11 row_newbcast:12 row_mask:0xf bank_mask:0xf
    v_and_b32_dpp v110, v124, v12 row_newbcast:12 row_mask:0xf bank_mask:0xf
    v_and_b32_dpp v111, v124, v13 row_newbcast:12 row_mask:0xf bank_mask:0xf
    s_waitcnt vmcnt(6)
    buffer_load_dwordx4 v[132:135], v77, s[52:55], s85 offen offset:0 nt
    v_mfma_f32_16x16x32_bf16 v[116:119], v[208:211], v[96:99], v[116:119]
    v_mfma_f32_16x16x32_bf16 v[116:119], v[212:215], v[100:103], v[116:119]
    v_mfma_f32_16x16x32_bf16 v[116:119], v[216:219], v[104:107], v[116:119]
    s_waitcnt vmcnt(6)
    buffer_load_dwordx4 v[136:139], v76, s[52:55], s85 offen offset:1024 nt
    v_mfma_f32_16x16x32_bf16 v[116:119], v[220:223], v[108:111], v[116:119]
    v_mfma_f32_16x16x32_bf16 v[112:115], v[224:227], v[80:83], 0
    v_mfma_f32_16x16x32_bf16 v[112:115], v[228:231], v[84:87], v[112:115]
    s_waitcnt vmcnt(6)
    buffer_load_dwordx4 v[140:143], v77, s[52:55], s85 offen offset:1024 nt
    v_mfma_f32_16x16x32_bf16 v[112:115], v[232:235], v[88:91], v[112:115]
    v_mfma_f32_16x16x32_bf16 v[112:115], v[236:239], v[92:95], v[112:115]
    s_nop 7
    v_mov_b32_dpp v122, v112 quad_perm:[0,0,0,0] row_mask:0xf bank_mask:0xf
    v_mov_b32_dpp v124, v114 quad_perm:[2,2,2,2] row_mask:0xf bank_mask:0xf
    s_nop 0
    v_add_f32_dpp v122, v113, v122 quad_perm:[1,1,1,1] row_mask:0xf bank_mask:0xf
    v_add_f32_dpp v124, v115, v124 quad_perm:[3,3,3,3] row_mask:0xf bank_mask:0xf
    v_add_f32 v122, v122, v124
    v_fma_f32 v123, v122, s83, -v120
    v_cmp_lt_f32 vcc, 0, v123
    s_cbranch_vccz L_nomax_33
    v_mul_f32 v122, s83, v122
    s_nop 1
    v_max_f32_dpp v124, v122, v122 row_ror:4 row_mask:0xf bank_mask:0xf
    s_nop 1
    v_max_f32_dpp v124, v124, v124 row_ror:8 row_mask:0xf bank_mask:0xf
    v_mov_b32 v125, v124
    s_nop 1
    v_permlane16_swap_b32 v124, v125
    v_max_f32 v124, v124, v125
    v_mov_b32 v125, v124
    s_nop 1
    v_permlane32_swap_b32 v124, v125
    v_max_f32 v124, v124, v125
    v_and_b32 v124, s82, v124
    v_max_f32 v124, v124, v120
    v_sub_f32 v125, v120, v124
    v_exp_f32 v125, v125
    v_mov_b32 v120, v124
    v_sub_f32 v123, v122, v124
    v_mul_f32 v121, v121, v125
    v_mul_f32 v116, v116, v125
    v_mul_f32 v117, v117, v125
    v_mul_f32 v118, v118, v125
    v_mul_f32 v119, v119, v125
L_nomax_33:
    v_exp_f32 v123, v123
    s_nop 0
    v_cvt_pk_bf16_f32 v124, v123, v123
    v_add_f32 v121, v121, v123
    s_nop 0
    v_and_b32_dpp v96, v124, v10 row_newbcast:0 row_mask:0xf bank_mask:0xf
    v_and_b32_dpp v97, v124, v11 row_newbcast:0 row_mask:0xf bank_mask:0xf
    v_and_b32_dpp v98, v124, v12 row_newbcast:0 row_mask:0xf bank_mask:0xf
    v_and_b32_dpp v99, v124, v13 row_newbcast:0 row_mask:0xf bank_mask:0xf
    v_and_b32_dpp v100, v124, v10 row_newbcast:4 row_mask:0xf bank_mask:0xf
    v_and_b32_dpp v101, v124, v11 row_newbcast:4 row_mask:0xf bank_mask:0xf
    v_and_b32_dpp v102, v124, v12 row_newbcast:4 row_mask:0xf bank_mask:0xf
    v_and_b32_dpp v103, v124, v13 row_newbcast:4 row_mask:0xf bank_mask:0xf
    v_and_b32_dpp v104, v124, v10 row_newbcast:8 row_mask:0xf bank_mask:0xf
    v_and_b32_dpp v105, v124, v11 row_newbcast:8 row_mask:0xf bank_mask:0xf
    v_and_b32_dpp v106, v124, v12 row_newbcast:8 row_mask:0xf bank_mask:0xf
    v_and_b32_dpp v107, v124, v13 row_newbcast:8 row_mask:0xf bank_mask:0xf
    v_and_b32_dpp v108, v124, v10 row_newbcast:12 row_mask:0xf bank_mask:0xf
    v_and_b32_dpp v109, v124, v11 row_newbcast:12 row_mask:0xf bank_mask:0xf
    v_and_b32_dpp v110, v124, v12 row_newbcast:12 row_mask:0xf bank_mask:0xf
    v_and_b32_dpp v111, v124, v13 row_newbcast:12 row_mask:0xf bank_mask:0xf
    v_mfma_f32_16x16x32_bf16 v[116:119], v[240:243], v[96:99], v[116:119]
    s_waitcnt vmcnt(6)
    buffer_load_dwordx4 v[144:147], v126, s[56:59], s85 offen offset:0 nt
    v_mfma_f32_16x16x32_bf16 v[116:119], v[244:247], v[100:103], v[116:119]
    v_mfma_f32_16x16x32_bf16 v[116:119], v[248:251], v[104:107], v[116:119]
    s_waitcnt vmcnt(6)
    v_mfma_f32_16x16x32_bf16 v[116:119], v[252:255], v[108:111], v[116:119]
    s_add_u32 s87, s87, 7
    s_add_u32 s39, s87, s88
    s_bfe_u32 s37, s39, 0x30000
    s_lshl_b32 s37, s37, 12
    s_add_u32 s86, s37, s89
    s_bfe_u32 s37, s39, 0x10003
    s_lshl_b32 s37, s37, 11
    s_add_u32 s86, s37, s86
    s_bfe_u32 s37, s39, 0x40004
    s_lshl_b32 s37, s37, 16
    s_add_u32 s86, s37, s86
    s_branch L_bloop
L_aux:
    v_lshlrev_b32 v4, 2, v2
    v_xor_b32 v4, v4, v3
    v_xor_b32 v96, 0, v4
    v_lshlrev_b32 v96, 4, v96
    v_lshl_add_u32 v10, v2, 13, v96
    v_xor_b32 v97, 1, v4
    v_lshlrev_b32 v97, 4, v97
    v_lshl_add_u32 v11, v2, 13, v97
    v_add_u32 v11, 31744, v11
    v_xor_b32 v98, 2, v4
    v_lshlrev_b32 v98, 4, v98
    v_lshl_add_u32 v12, v2, 13, v98
    v_add_u32 v12, 63488, v12
    v_xor_b32 v99, 3, v4
    v_lshlrev_b32 v99, 4, v99
    v_lshl_add_u32 v13, v2, 13, v99
    v_add_u32 v13, 95232, v13
    s_lshl_b32 s90, s34, 15
    s_mov_b32 s62, 0
    s_mov_b32 s94, 0
    s_lshl_b32 s95, s34, 20
    s_lshl_b32 s38, s32, 8
    s_add_u32 s95, s95, s38
    s_waitcnt lgkmcnt(0)
    s_mov_b32 s52, s12
    s_and_b32 s53, s13, 0xffff
    s_mov_b32 s54, 4194304
    s_mov_b32 s55, 0x20000
    s_add_u32 s39, s90, s62
    s_mov_b32 m0, s39
    s_add_u32 s62, s62, 4096
    s_and_b32 s62, s62, 0x7fff
    buffer_load_dwordx4 v10, s[52:55], s95 offen offset:0 nt lds
    buffer_load_dwordx4 v11, s[52:55], s95 offen offset:1024 nt lds
    buffer_load_dwordx4 v12, s[52:55], s95 offen offset:2048 nt lds
    buffer_load_dwordx4 v13, s[52:55], s95 offen offset:3072 nt lds
    s_add_u32 s95, s95, 131072
    s_add_u32 s39, s90, s62
    s_mov_b32 m0, s39
    s_add_u32 s62, s62, 4096
    s_and_b32 s62, s62, 0x7fff
    buffer_load_dwordx4 v10, s[52:55], s95 offen offset:0 nt lds
    buffer_load_dwordx4 v11, s[52:55], s95 offen offset:1024 nt lds
    buffer_load_dwordx4 v12, s[52:55], s95 offen offset:2048 nt lds
    buffer_load_dwordx4 v13, s[52:55], s95 offen offset:3072 nt lds
    s_add_u32 s95, s95, 131072
    s_getpc_b64 s[36:37]
L_pc_34:
    s_sub_u32 s36, s36, L_pc_34 - concat_heads__compressed_kv_cla__mha_block_cached__decode_kernel
    s_subb_u32 s37, s37, 0
    s_lshl_b32 s38, s32, 10
    v_lshl_add_u32 v6, v0, 2, s38
    v_mov_b32 v7, s37
    v_add_co_u32 v6, vcc, s36, v6
    s_nop 1
    v_addc_co_u32 v7, vcc, 0, v7, vcc
    global_load_dword v0, v[6:7], off
    s_load_dword s35, s[30:31], 0
    s_mov_b32 s48, s30
    s_and_b32 s49, s31, 0xffff
    s_mov_b32 s50, 8388608
    s_mov_b32 s51, 0x20000
    s_mov_b32 s82, 0xffffff00
    s_mov_b32 s83, 0x3e0293ee
    s_mov_b32 s84, 2097152
    s_mov_b32 s72, s26
    s_and_b32 s73, s27, 0xffff
    s_mov_b32 s74, 8192
    s_mov_b32 s75, 0x20000
    v_lshl_add_u32 v76, v2, 10, v96
    v_lshl_add_u32 v96, v2, 8, v96
    v_lshl_add_u32 v77, v2, 10, v97
    v_lshl_add_u32 v97, v2, 8, v97
    v_add_u32 v77, 3072, v77
    v_lshl_add_u32 v78, v2, 10, v98
    v_lshl_add_u32 v98, v2, 8, v98
    v_add_u32 v78, 6144, v78
    v_lshl_add_u32 v79, v2, 10, v99
    v_lshl_add_u32 v99, v2, 8, v99
    v_add_u32 v79, 9216, v79
    v_mov_b32 v100, 0
    v_and_b32 v101, 31, v1
    s_lshl_b32 s38, s34, 13
    v_lshl_add_u32 v101, v101, 8, s38
    v_lshlrev_b32 v4, 4, v3
    v_lshl_add_u32 v19, v2, 13, v4
    v_lshl_add_u32 v9, v2, 10, v4
    s_lshl_b32 s63, s32, 17
    s_lshl_b32 s38, s34, 8
    s_add_u32 s63, s63, s38
    v_and_b32 v4, 3, v1
    v_bfe_u32 v5, v1, 2, 2
    v_lshrrev_b32 v6, 5, v1
    v_lshl_add_u32 v7, v4, 2, v5
    v_xor_b32 v7, v7, v6
    v_lshlrev_b32 v7, 4, v7
    v_and_b32 v80, 31, v1
    v_lshl_add_u32 v80, v80, 8, v7
    v_lshl_add_u32 v81, v6, 2, v5
    v_lshlrev_b32 v81, 8, v81
    v_lshl_add_u32 v81, v5, 6, v81
    v_bfe_u32 v7, v1, 4, 1
    v_lshlrev_b32 v7, 1, v7
    v_bfe_u32 v82, v1, 1, 1
    v_add_u32 v7, v7, v82
    v_xor_b32 v7, v7, v6
    v_lshl_add_u32 v81, v7, 4, v81
    v_and_b32 v7, 1, v1
    v_lshl_add_u32 v81, v7, 3, v81
    v_lshl_add_u32 v95, v2, 3, v5
    v_lshlrev_b32 v95, 8, v95
    v_lshl_add_u32 v95, v5, 6, v95
    v_bfe_u32 v4, v1, 4, 1
    v_lshl_add_u32 v4, v4, 1, v82
    v_lshl_add_u32 v95, v4, 4, v95
    v_lshl_add_u32 v95, v7, 3, v95
    v_add_u32 v95, s90, v95
    v_xor_b32 v136, 0, v95
    v_xor_b32 v137, 16, v95
    v_xor_b32 v138, 32, v95
    v_xor_b32 v139, 48, v95
    v_xor_b32 v140, 64, v95
    v_xor_b32 v141, 80, v95
    v_xor_b32 v142, 96, v95
    v_xor_b32 v143, 112, v95
    v_xor_b32 v144, 128, v95
    v_xor_b32 v145, 144, v95
    v_xor_b32 v146, 160, v95
    v_xor_b32 v147, 176, v95
    v_xor_b32 v148, 192, v95
    v_xor_b32 v149, 208, v95
    v_xor_b32 v150, 224, v95
    v_xor_b32 v151, 240, v95
    s_lshl_b32 s85, s34, 13
    s_add_u32 s85, s85, 131072
    v_lshl_add_u32 v94, v1, 4, s85
    v_add_u32 v96, s85, v96
    v_add_u32 v97, s85, v97
    v_add_u32 v98, s85, v98
    v_add_u32 v99, s85, v99
    s_add_u32 s39, s90, s62
    s_mov_b32 m0, s39
    s_add_u32 s62, s62, 4096
    s_and_b32 s62, s62, 0x7fff
    buffer_load_dwordx4 v10, s[52:55], s95 offen offset:0 nt lds
    buffer_load_dwordx4 v11, s[52:55], s95 offen offset:1024 nt lds
    buffer_load_dwordx4 v12, s[52:55], s95 offen offset:2048 nt lds
    buffer_load_dwordx4 v13, s[52:55], s95 offen offset:3072 nt lds
    s_add_u32 s95, s95, 131072
    s_add_u32 s39, s90, s62
    s_mov_b32 m0, s39
    s_add_u32 s62, s62, 4096
    s_and_b32 s62, s62, 0x7fff
    buffer_load_dwordx4 v10, s[52:55], s95 offen offset:0 nt lds
    buffer_load_dwordx4 v11, s[52:55], s95 offen offset:1024 nt lds
    buffer_load_dwordx4 v12, s[52:55], s95 offen offset:2048 nt lds
    buffer_load_dwordx4 v13, s[52:55], s95 offen offset:3072 nt lds
    s_add_u32 s95, s95, 131072
    s_add_u32 s39, s90, s62
    s_mov_b32 m0, s39
    s_add_u32 s62, s62, 4096
    s_and_b32 s62, s62, 0x7fff
    buffer_load_dwordx4 v10, s[52:55], s95 offen offset:0 nt lds
    buffer_load_dwordx4 v11, s[52:55], s95 offen offset:1024 nt lds
    buffer_load_dwordx4 v12, s[52:55], s95 offen offset:2048 nt lds
    buffer_load_dwordx4 v13, s[52:55], s95 offen offset:3072 nt lds
    s_add_u32 s95, s95, 131072
    s_add_u32 s39, s90, s62
    s_mov_b32 m0, s39
    s_add_u32 s62, s62, 4096
    s_and_b32 s62, s62, 0x7fff
    buffer_load_dwordx4 v10, s[52:55], s95 offen offset:0 nt lds
    buffer_load_dwordx4 v11, s[52:55], s95 offen offset:1024 nt lds
    buffer_load_dwordx4 v12, s[52:55], s95 offen offset:2048 nt lds
    buffer_load_dwordx4 v13, s[52:55], s95 offen offset:3072 nt lds
    s_add_u32 s95, s95, 131072
    s_add_u32 s39, s90, s62
    s_mov_b32 m0, s39
    s_add_u32 s62, s62, 4096
    s_and_b32 s62, s62, 0x7fff
    buffer_load_dwordx4 v10, s[52:55], s95 offen offset:0 nt lds
    buffer_load_dwordx4 v11, s[52:55], s95 offen offset:1024 nt lds
    buffer_load_dwordx4 v12, s[52:55], s95 offen offset:2048 nt lds
    buffer_load_dwordx4 v13, s[52:55], s95 offen offset:3072 nt lds
    s_add_u32 s95, s95, 131072
    s_add_u32 s39, s90, s62
    s_mov_b32 m0, s39
    s_add_u32 s62, s62, 4096
    s_and_b32 s62, s62, 0x7fff
    buffer_load_dwordx4 v10, s[52:55], s95 offen offset:0 nt lds
    buffer_load_dwordx4 v11, s[52:55], s95 offen offset:1024 nt lds
    buffer_load_dwordx4 v12, s[52:55], s95 offen offset:2048 nt lds
    buffer_load_dwordx4 v13, s[52:55], s95 offen offset:3072 nt lds
    s_add_u32 s95, s95, 131072
    s_waitcnt lgkmcnt(0)
    s_add_u32 s35, s35, 0x5b
    s_and_b32 s35, s35, 0xff
    v_mov_b32 v8, s35
    s_or_b32 s68, s35, 0x6b3ac500
    s_mov_b32 s52, s14
    s_and_b32 s53, s15, 0xffff
    s_mov_b32 s54, 4194304
    s_mov_b32 s55, 0x20000
    s_mov_b32 s95, s63
    s_waitcnt vmcnt(25)
    ds_read_b64_tr_b16 a[128:129], v136 offset:0
    ds_read_b64_tr_b16 a[130:131], v137 offset:1024
    ds_read_b64_tr_b16 a[144:145], v138 offset:0
    ds_read_b64_tr_b16 a[146:147], v139 offset:1024
    ds_read_b64_tr_b16 a[160:161], v140 offset:0
    ds_read_b64_tr_b16 a[162:163], v141 offset:1024
    ds_read_b64_tr_b16 a[176:177], v142 offset:0
    ds_read_b64_tr_b16 a[178:179], v143 offset:1024
    ds_read_b64_tr_b16 a[192:193], v144 offset:0
    ds_read_b64_tr_b16 a[194:195], v145 offset:1024
    ds_read_b64_tr_b16 a[208:209], v146 offset:0
    ds_read_b64_tr_b16 a[210:211], v147 offset:1024
    ds_read_b64_tr_b16 a[224:225], v148 offset:0
    ds_read_b64_tr_b16 a[226:227], v149 offset:1024
    ds_read_b64_tr_b16 a[240:241], v150 offset:0
    ds_read_b64_tr_b16 a[242:243], v151 offset:1024
    s_waitcnt lgkmcnt(0)
    s_add_u32 s39, s90, s62
    s_mov_b32 m0, s39
    s_add_u32 s62, s62, 4096
    s_and_b32 s62, s62, 0x7fff
    buffer_load_dwordx4 v76, s[52:55], s95 offen offset:0 nt lds
    buffer_load_dwordx4 v77, s[52:55], s95 offen offset:1024 nt lds
    buffer_load_dwordx4 v78, s[52:55], s95 offen offset:2048 nt lds
    buffer_load_dwordx4 v79, s[52:55], s95 offen offset:3072 nt lds
    s_add_u32 s95, s95, 16384
    s_add_u32 s39, s90, s62
    s_mov_b32 m0, s39
    s_add_u32 s62, s62, 4096
    s_and_b32 s62, s62, 0x7fff
    buffer_load_dwordx4 v76, s[52:55], s95 offen offset:0 nt lds
    buffer_load_dwordx4 v77, s[52:55], s95 offen offset:1024 nt lds
    buffer_load_dwordx4 v78, s[52:55], s95 offen offset:2048 nt lds
    buffer_load_dwordx4 v79, s[52:55], s95 offen offset:3072 nt lds
    s_add_u32 s95, s95, 16384
    s_waitcnt vmcnt(24)
    ds_read_b64_tr_b16 a[132:133], v136 offset:8192
    ds_read_b64_tr_b16 a[134:135], v137 offset:9216
    ds_read_b64_tr_b16 a[148:149], v138 offset:8192
    ds_read_b64_tr_b16 a[150:151], v139 offset:9216
    ds_read_b64_tr_b16 a[164:165], v140 offset:8192
    ds_read_b64_tr_b16 a[166:167], v141 offset:9216
    ds_read_b64_tr_b16 a[180:181], v142 offset:8192
    ds_read_b64_tr_b16 a[182:183], v143 offset:9216
    ds_read_b64_tr_b16 a[196:197], v144 offset:8192
    ds_read_b64_tr_b16 a[198:199], v145 offset:9216
    ds_read_b64_tr_b16 a[212:213], v146 offset:8192
    ds_read_b64_tr_b16 a[214:215], v147 offset:9216
    ds_read_b64_tr_b16 a[228:229], v148 offset:8192
    ds_read_b64_tr_b16 a[230:231], v149 offset:9216
    ds_read_b64_tr_b16 a[244:245], v150 offset:8192
    ds_read_b64_tr_b16 a[246:247], v151 offset:9216
    s_waitcnt lgkmcnt(0)
    s_add_u32 s39, s90, s62
    s_mov_b32 m0, s39
    s_add_u32 s62, s62, 4096
    s_and_b32 s62, s62, 0x7fff
    buffer_load_dwordx4 v76, s[52:55], s95 offen offset:0 nt lds
    buffer_load_dwordx4 v77, s[52:55], s95 offen offset:1024 nt lds
    buffer_load_dwordx4 v78, s[52:55], s95 offen offset:2048 nt lds
    buffer_load_dwordx4 v79, s[52:55], s95 offen offset:3072 nt lds
    s_add_u32 s95, s95, 16384
    s_add_u32 s39, s90, s62
    s_mov_b32 m0, s39
    s_add_u32 s62, s62, 4096
    s_and_b32 s62, s62, 0x7fff
    buffer_load_dwordx4 v76, s[52:55], s95 offen offset:0 nt lds
    buffer_load_dwordx4 v77, s[52:55], s95 offen offset:1024 nt lds
    buffer_load_dwordx4 v78, s[52:55], s95 offen offset:2048 nt lds
    buffer_load_dwordx4 v79, s[52:55], s95 offen offset:3072 nt lds
    s_add_u32 s95, s95, 16384
    s_waitcnt vmcnt(24)
    ds_read_b64_tr_b16 a[136:137], v136 offset:16384
    ds_read_b64_tr_b16 a[138:139], v137 offset:17408
    ds_read_b64_tr_b16 a[152:153], v138 offset:16384
    ds_read_b64_tr_b16 a[154:155], v139 offset:17408
    ds_read_b64_tr_b16 a[168:169], v140 offset:16384
    ds_read_b64_tr_b16 a[170:171], v141 offset:17408
    ds_read_b64_tr_b16 a[184:185], v142 offset:16384
    ds_read_b64_tr_b16 a[186:187], v143 offset:17408
    ds_read_b64_tr_b16 a[200:201], v144 offset:16384
    ds_read_b64_tr_b16 a[202:203], v145 offset:17408
    ds_read_b64_tr_b16 a[216:217], v146 offset:16384
    ds_read_b64_tr_b16 a[218:219], v147 offset:17408
    ds_read_b64_tr_b16 a[232:233], v148 offset:16384
    ds_read_b64_tr_b16 a[234:235], v149 offset:17408
    ds_read_b64_tr_b16 a[248:249], v150 offset:16384
    ds_read_b64_tr_b16 a[250:251], v151 offset:17408
    s_waitcnt lgkmcnt(0)
    s_add_u32 s39, s90, s62
    s_mov_b32 m0, s39
    s_add_u32 s62, s62, 4096
    s_and_b32 s62, s62, 0x7fff
    buffer_load_dwordx4 v76, s[52:55], s95 offen offset:0 nt lds
    buffer_load_dwordx4 v77, s[52:55], s95 offen offset:1024 nt lds
    buffer_load_dwordx4 v78, s[52:55], s95 offen offset:2048 nt lds
    buffer_load_dwordx4 v79, s[52:55], s95 offen offset:3072 nt lds
    s_add_u32 s95, s95, 16384
    s_add_u32 s39, s90, s62
    s_mov_b32 m0, s39
    s_add_u32 s62, s62, 4096
    s_and_b32 s62, s62, 0x7fff
    buffer_load_dwordx4 v76, s[52:55], s95 offen offset:0 nt lds
    buffer_load_dwordx4 v77, s[52:55], s95 offen offset:1024 nt lds
    buffer_load_dwordx4 v78, s[52:55], s95 offen offset:2048 nt lds
    buffer_load_dwordx4 v79, s[52:55], s95 offen offset:3072 nt lds
    s_add_u32 s95, s95, 16384
    s_waitcnt vmcnt(24)
    ds_read_b64_tr_b16 a[140:141], v136 offset:24576
    ds_read_b64_tr_b16 a[142:143], v137 offset:25600
    ds_read_b64_tr_b16 a[156:157], v138 offset:24576
    ds_read_b64_tr_b16 a[158:159], v139 offset:25600
    ds_read_b64_tr_b16 a[172:173], v140 offset:24576
    ds_read_b64_tr_b16 a[174:175], v141 offset:25600
    ds_read_b64_tr_b16 a[188:189], v142 offset:24576
    ds_read_b64_tr_b16 a[190:191], v143 offset:25600
    ds_read_b64_tr_b16 a[204:205], v144 offset:24576
    ds_read_b64_tr_b16 a[206:207], v145 offset:25600
    ds_read_b64_tr_b16 a[220:221], v146 offset:24576
    ds_read_b64_tr_b16 a[222:223], v147 offset:25600
    ds_read_b64_tr_b16 a[236:237], v148 offset:24576
    ds_read_b64_tr_b16 a[238:239], v149 offset:25600
    ds_read_b64_tr_b16 a[252:253], v150 offset:24576
    ds_read_b64_tr_b16 a[254:255], v151 offset:25600
    s_waitcnt lgkmcnt(0)
    s_add_u32 s39, s90, s62
    s_mov_b32 m0, s39
    s_add_u32 s62, s62, 4096
    s_and_b32 s62, s62, 0x7fff
    buffer_load_dwordx4 v76, s[52:55], s95 offen offset:0 nt lds
    buffer_load_dwordx4 v77, s[52:55], s95 offen offset:1024 nt lds
    buffer_load_dwordx4 v78, s[52:55], s95 offen offset:2048 nt lds
    buffer_load_dwordx4 v79, s[52:55], s95 offen offset:3072 nt lds
    s_add_u32 s95, s95, 16384
    s_add_u32 s39, s90, s62
    s_mov_b32 m0, s39
    s_add_u32 s62, s62, 4096
    s_and_b32 s62, s62, 0x7fff
    buffer_load_dwordx4 v76, s[52:55], s95 offen offset:0 nt lds
    buffer_load_dwordx4 v77, s[52:55], s95 offen offset:1024 nt lds
    buffer_load_dwordx4 v78, s[52:55], s95 offen offset:2048 nt lds
    buffer_load_dwordx4 v79, s[52:55], s95 offen offset:3072 nt lds
    s_add_u32 s95, s95, 16384
    s_mov_b32 s52, s6
    s_and_b32 s53, s7, 0xffff
    s_mov_b32 s54, 16777216
    s_mov_b32 s55, 0x20000
    s_lshl_b32 s95, s32, 19
    s_lshl_b32 s38, s34, 8
    s_add_u32 s95, s95, s38
    s_waitcnt vmcnt(24)
    ds_read_b64_tr_b16 a[0:1], v136 offset:0
    ds_read_b64_tr_b16 a[2:3], v137 offset:1024
    ds_read_b64_tr_b16 a[16:17], v138 offset:0
    ds_read_b64_tr_b16 a[18:19], v139 offset:1024
    ds_read_b64_tr_b16 a[32:33], v140 offset:0
    ds_read_b64_tr_b16 a[34:35], v141 offset:1024
    ds_read_b64_tr_b16 a[48:49], v142 offset:0
    ds_read_b64_tr_b16 a[50:51], v143 offset:1024
    ds_read_b64_tr_b16 a[64:65], v144 offset:0
    ds_read_b64_tr_b16 a[66:67], v145 offset:1024
    ds_read_b64_tr_b16 a[80:81], v146 offset:0
    ds_read_b64_tr_b16 a[82:83], v147 offset:1024
    ds_read_b64_tr_b16 a[96:97], v148 offset:0
    ds_read_b64_tr_b16 a[98:99], v149 offset:1024
    ds_read_b64_tr_b16 a[112:113], v150 offset:0
    ds_read_b64_tr_b16 a[114:115], v151 offset:1024
    s_waitcnt lgkmcnt(0)
    s_add_u32 s39, s90, s62
    s_mov_b32 m0, s39
    s_add_u32 s62, s62, 4096
    s_and_b32 s62, s62, 0x7fff
    buffer_load_dwordx4 v76, s[52:55], s95 offen offset:0 nt lds
    buffer_load_dwordx4 v77, s[52:55], s95 offen offset:1024 nt lds
    buffer_load_dwordx4 v78, s[52:55], s95 offen offset:2048 nt lds
    buffer_load_dwordx4 v79, s[52:55], s95 offen offset:3072 nt lds
    s_add_u32 s95, s95, 16384
    s_add_u32 s39, s90, s62
    s_mov_b32 m0, s39
    s_add_u32 s62, s62, 4096
    s_and_b32 s62, s62, 0x7fff
    buffer_load_dwordx4 v76, s[52:55], s95 offen offset:0 nt lds
    buffer_load_dwordx4 v77, s[52:55], s95 offen offset:1024 nt lds
    buffer_load_dwordx4 v78, s[52:55], s95 offen offset:2048 nt lds
    buffer_load_dwordx4 v79, s[52:55], s95 offen offset:3072 nt lds
    s_add_u32 s95, s95, 16384
    s_waitcnt vmcnt(24)
    ds_read_b64_tr_b16 a[4:5], v136 offset:8192
    ds_read_b64_tr_b16 a[6:7], v137 offset:9216
    ds_read_b64_tr_b16 a[20:21], v138 offset:8192
    ds_read_b64_tr_b16 a[22:23], v139 offset:9216
    ds_read_b64_tr_b16 a[36:37], v140 offset:8192
    ds_read_b64_tr_b16 a[38:39], v141 offset:9216
    ds_read_b64_tr_b16 a[52:53], v142 offset:8192
    ds_read_b64_tr_b16 a[54:55], v143 offset:9216
    ds_read_b64_tr_b16 a[68:69], v144 offset:8192
    ds_read_b64_tr_b16 a[70:71], v145 offset:9216
    ds_read_b64_tr_b16 a[84:85], v146 offset:8192
    ds_read_b64_tr_b16 a[86:87], v147 offset:9216
    ds_read_b64_tr_b16 a[100:101], v148 offset:8192
    ds_read_b64_tr_b16 a[102:103], v149 offset:9216
    ds_read_b64_tr_b16 a[116:117], v150 offset:8192
    ds_read_b64_tr_b16 a[118:119], v151 offset:9216
    s_waitcnt lgkmcnt(0)
    s_add_u32 s39, s90, s62
    s_mov_b32 m0, s39
    s_add_u32 s62, s62, 4096
    s_and_b32 s62, s62, 0x7fff
    buffer_load_dwordx4 v76, s[52:55], s95 offen offset:0 nt lds
    buffer_load_dwordx4 v77, s[52:55], s95 offen offset:1024 nt lds
    buffer_load_dwordx4 v78, s[52:55], s95 offen offset:2048 nt lds
    buffer_load_dwordx4 v79, s[52:55], s95 offen offset:3072 nt lds
    s_add_u32 s95, s95, 16384
    s_add_u32 s39, s90, s62
    s_mov_b32 m0, s39
    s_add_u32 s62, s62, 4096
    s_and_b32 s62, s62, 0x7fff
    buffer_load_dwordx4 v76, s[52:55], s95 offen offset:0 nt lds
    buffer_load_dwordx4 v77, s[52:55], s95 offen offset:1024 nt lds
    buffer_load_dwordx4 v78, s[52:55], s95 offen offset:2048 nt lds
    buffer_load_dwordx4 v79, s[52:55], s95 offen offset:3072 nt lds
    s_add_u32 s95, s95, 16384
    s_waitcnt vmcnt(24)
    ds_read_b64_tr_b16 a[8:9], v136 offset:16384
    ds_read_b64_tr_b16 a[10:11], v137 offset:17408
    ds_read_b64_tr_b16 a[24:25], v138 offset:16384
    ds_read_b64_tr_b16 a[26:27], v139 offset:17408
    ds_read_b64_tr_b16 a[40:41], v140 offset:16384
    ds_read_b64_tr_b16 a[42:43], v141 offset:17408
    ds_read_b64_tr_b16 a[56:57], v142 offset:16384
    ds_read_b64_tr_b16 a[58:59], v143 offset:17408
    ds_read_b64_tr_b16 a[72:73], v144 offset:16384
    ds_read_b64_tr_b16 a[74:75], v145 offset:17408
    ds_read_b64_tr_b16 a[88:89], v146 offset:16384
    ds_read_b64_tr_b16 a[90:91], v147 offset:17408
    ds_read_b64_tr_b16 a[104:105], v148 offset:16384
    ds_read_b64_tr_b16 a[106:107], v149 offset:17408
    ds_read_b64_tr_b16 a[120:121], v150 offset:16384
    ds_read_b64_tr_b16 a[122:123], v151 offset:17408
    s_waitcnt lgkmcnt(0)
    s_add_u32 s39, s90, s62
    s_mov_b32 m0, s39
    s_add_u32 s62, s62, 4096
    s_and_b32 s62, s62, 0x7fff
    buffer_load_dwordx4 v76, s[52:55], s95 offen offset:0 nt lds
    buffer_load_dwordx4 v77, s[52:55], s95 offen offset:1024 nt lds
    buffer_load_dwordx4 v78, s[52:55], s95 offen offset:2048 nt lds
    buffer_load_dwordx4 v79, s[52:55], s95 offen offset:3072 nt lds
    s_add_u32 s95, s95, 16384
    s_add_u32 s39, s90, s62
    s_mov_b32 m0, s39
    s_add_u32 s62, s62, 4096
    s_and_b32 s62, s62, 0x7fff
    buffer_load_dwordx4 v76, s[52:55], s95 offen offset:0 nt lds
    buffer_load_dwordx4 v77, s[52:55], s95 offen offset:1024 nt lds
    buffer_load_dwordx4 v78, s[52:55], s95 offen offset:2048 nt lds
    buffer_load_dwordx4 v79, s[52:55], s95 offen offset:3072 nt lds
    s_add_u32 s95, s95, 16384
    s_waitcnt vmcnt(24)
    ds_read_b64_tr_b16 a[12:13], v136 offset:24576
    ds_read_b64_tr_b16 a[14:15], v137 offset:25600
    ds_read_b64_tr_b16 a[28:29], v138 offset:24576
    ds_read_b64_tr_b16 a[30:31], v139 offset:25600
    ds_read_b64_tr_b16 a[44:45], v140 offset:24576
    ds_read_b64_tr_b16 a[46:47], v141 offset:25600
    ds_read_b64_tr_b16 a[60:61], v142 offset:24576
    ds_read_b64_tr_b16 a[62:63], v143 offset:25600
    ds_read_b64_tr_b16 a[76:77], v144 offset:24576
    ds_read_b64_tr_b16 a[78:79], v145 offset:25600
    ds_read_b64_tr_b16 a[92:93], v146 offset:24576
    ds_read_b64_tr_b16 a[94:95], v147 offset:25600
    ds_read_b64_tr_b16 a[108:109], v148 offset:24576
    ds_read_b64_tr_b16 a[110:111], v149 offset:25600
    ds_read_b64_tr_b16 a[124:125], v150 offset:24576
    ds_read_b64_tr_b16 a[126:127], v151 offset:25600
    s_waitcnt lgkmcnt(0)
    s_mov_b32 s86, 131072
    buffer_load_dword v7, v101, s[48:51], s86 offen sc1
    s_add_u32 s39, s90, s62
    s_mov_b32 m0, s39
    s_add_u32 s62, s62, 4096
    s_and_b32 s62, s62, 0x7fff
    buffer_load_dwordx4 v76, s[52:55], s95 offen offset:0 nt lds
    buffer_load_dwordx4 v77, s[52:55], s95 offen offset:1024 nt lds
    buffer_load_dwordx4 v78, s[52:55], s95 offen offset:2048 nt lds
    buffer_load_dwordx4 v79, s[52:55], s95 offen offset:3072 nt lds
    s_add_u32 s95, s95, 16384
    s_add_u32 s39, s90, s62
    s_mov_b32 m0, s39
    s_add_u32 s62, s62, 4096
    s_and_b32 s62, s62, 0x7fff
    buffer_load_dwordx4 v76, s[52:55], s95 offen offset:0 nt lds
    v_mov_b32 v136, 0
    v_mov_b32 v137, 0
    v_mov_b32 v138, 0
    v_mov_b32 v139, 0
    v_mov_b32 v140, 0
    v_mov_b32 v141, 0
    v_mov_b32 v142, 0
    v_mov_b32 v143, 0
    v_mov_b32 v144, 0
    v_mov_b32 v145, 0
    v_mov_b32 v146, 0
    v_mov_b32 v147, 0
    v_mov_b32 v148, 0
    v_mov_b32 v149, 0
    v_mov_b32 v150, 0
    v_mov_b32 v151, 0
    v_mov_b32 v152, 0
    v_mov_b32 v153, 0
    v_mov_b32 v154, 0
    v_mov_b32 v155, 0
    v_mov_b32 v156, 0
    v_mov_b32 v157, 0
    v_mov_b32 v158, 0
    v_mov_b32 v159, 0
    v_mov_b32 v160, 0
    v_mov_b32 v161, 0
    v_mov_b32 v162, 0
    v_mov_b32 v163, 0
    v_mov_b32 v164, 0
    v_mov_b32 v165, 0
    v_mov_b32 v166, 0
    v_mov_b32 v167, 0
    v_mov_b32 v168, 0
    v_mov_b32 v169, 0
    v_mov_b32 v170, 0
    v_mov_b32 v171, 0
    v_mov_b32 v172, 0
    v_mov_b32 v173, 0
    v_mov_b32 v174, 0
    v_mov_b32 v175, 0
    v_mov_b32 v176, 0
    v_mov_b32 v177, 0
    v_mov_b32 v178, 0
    v_mov_b32 v179, 0
    v_mov_b32 v180, 0
    v_mov_b32 v181, 0
    v_mov_b32 v182, 0
    v_mov_b32 v183, 0
    v_mov_b32 v184, 0
    v_mov_b32 v185, 0
    v_mov_b32 v186, 0
    v_mov_b32 v187, 0
    v_mov_b32 v188, 0
    v_mov_b32 v189, 0
    v_mov_b32 v190, 0
    v_mov_b32 v191, 0
    v_mov_b32 v192, 0
    v_mov_b32 v193, 0
    v_mov_b32 v194, 0
    v_mov_b32 v195, 0
    v_mov_b32 v196, 0
    v_mov_b32 v197, 0
    v_mov_b32 v198, 0
    v_mov_b32 v199, 0
    v_mov_b32 v90, 0xff7f0000
    s_mov_b32 s93, 0
    v_mov_b32 v102, 0
    v_mov_b32 v103, 0
    s_mov_b32 s60, s83
    s_mov_b32 s61, s83
    v_add_u32 v4, s85, v80
    v_xor_b32 v82, 0, v4
    v_xor_b32 v83, 32, v4
    v_xor_b32 v84, 64, v4
    v_xor_b32 v85, 96, v4
    v_xor_b32 v86, 128, v4
    v_xor_b32 v87, 160, v4
    v_xor_b32 v88, 192, v4
    v_xor_b32 v89, 224, v4
    v_add_u32 v80, s90, v80
    v_add_u32 v81, s90, v81
    s_lshr_b32 s36, s32, 3
    s_lshl_b32 s36, s36, 15
    s_lshl_b32 s38, s34, 8
    s_add_u32 s36, s36, s38
    s_add_u32 s36, s36, 2097152
    s_waitcnt vmcnt(5)
L_fcheck_35:
    v_cmp_ne_u32 vcc, s68, v7
    s_cbranch_vccz L_fok_36
    s_sleep 2
    s_mov_b32 s86, 131072
    buffer_load_dword v7, v101, s[48:51], s86 offen sc1
    s_waitcnt vmcnt(0)
    s_sub_u32 s84, s84, 1
    s_cmp_lg_u32 s84, 0
    s_cbranch_scc1 L_fcheck_35
    s_branch L_end
L_fok_36:
    buffer_load_dwordx4 v[20:23], v9, s[48:51], s36 offen sc1
    s_add_u32 s36, s36, 4096
    buffer_load_dwordx4 v[24:27], v9, s[48:51], s36 offen sc1
    s_add_u32 s36, s36, 4096
    buffer_load_dwordx4 v[28:31], v9, s[48:51], s36 offen sc1
    s_add_u32 s36, s36, 4096
    buffer_load_dwordx4 v[32:35], v9, s[48:51], s36 offen sc1
    s_add_u32 s36, s36, 4096
    buffer_load_dwordx4 v[36:39], v9, s[48:51], s36 offen sc1
    s_add_u32 s36, s36, 4096
    buffer_load_dwordx4 v[40:43], v9, s[48:51], s36 offen sc1
    s_add_u32 s36, s36, 4096
    buffer_load_dwordx4 v[44:47], v9, s[48:51], s36 offen sc1
    s_add_u32 s36, s36, 4096
    buffer_load_dwordx4 v[48:51], v9, s[48:51], s36 offen sc1
    s_waitcnt vmcnt(7)
    ds_write_b128 v96, v[20:23] offset:0
    s_waitcnt vmcnt(6)
    ds_write_b128 v97, v[24:27] offset:1024
    s_waitcnt vmcnt(5)
    ds_write_b128 v98, v[28:31] offset:2048
    s_waitcnt vmcnt(4)
    ds_write_b128 v99, v[32:35] offset:3072
    s_waitcnt vmcnt(3)
    ds_write_b128 v96, v[36:39] offset:4096
    s_waitcnt vmcnt(2)
    ds_write_b128 v97, v[40:43] offset:5120
    s_waitcnt vmcnt(1)
    ds_write_b128 v98, v[44:47] offset:6144
    s_waitcnt vmcnt(0)
    ds_write_b128 v99, v[48:51] offset:7168
    s_waitcnt lgkmcnt(0)
    ds_read_b128 v[104:107], v82
    ds_read_b128 v[108:111], v83
    ds_read_b128 v[112:115], v84
    ds_read_b128 v[116:119], v85
    ds_read_b128 v[120:123], v86
    ds_read_b128 v[124:127], v87
    ds_read_b128 v[128:131], v88
    ds_read_b128 v[132:135], v89
    v_xor_b32 v82, 0, v80
    ds_read_b128 v[216:219], v82
    v_xor_b32 v83, 32, v80
    ds_read_b128 v[220:223], v83
    v_xor_b32 v84, 64, v80
    ds_read_b128 v[224:227], v84
    v_xor_b32 v85, 96, v80
    ds_read_b128 v[228:231], v85
    v_xor_b32 v86, 128, v80
    ds_read_b128 v[232:235], v86
    v_xor_b32 v87, 160, v80
    ds_read_b128 v[236:239], v87
    v_xor_b32 v88, 192, v80
    ds_read_b128 v[240:243], v88
    v_xor_b32 v89, 224, v80
    ds_read_b128 v[244:247], v89
L_att:
    v_add_u32 v4, s94, v81
    s_waitcnt lgkmcnt(0)
    v_mfma_f32_32x32x16_bf16 v[200:215], v[216:219], v[104:107], 0
    v_xor_b32 v82, 0, v4
    ds_read_b64_tr_b16 v[20:21], v82 offset:0
    ds_read_b64_tr_b16 v[24:25], v82 offset:4096
    buffer_load_dwordx4 v77, s[52:55], s95 offen offset:1024 nt lds
    v_mfma_f32_32x32x16_bf16 v[200:215], v[220:223], v[108:111], v[200:215]
    v_xor_b32 v83, 32, v4
    ds_read_b64_tr_b16 v[22:23], v83 offset:2048
    ds_read_b64_tr_b16 v[26:27], v83 offset:6144
    v_mfma_f32_32x32x16_bf16 v[200:215], v[224:227], v[112:115], v[200:215]
    v_xor_b32 v84, 64, v4
    ds_read_b64_tr_b16 v[28:29], v84 offset:0
    ds_read_b64_tr_b16 v[32:33], v84 offset:4096
    v_mfma_f32_32x32x16_bf16 v[200:215], v[228:231], v[116:119], v[200:215]
    v_xor_b32 v85, 96, v4
    ds_read_b64_tr_b16 v[30:31], v85 offset:2048
    ds_read_b64_tr_b16 v[34:35], v85 offset:6144
    v_mfma_f32_32x32x16_bf16 v[200:215], v[232:235], v[120:123], v[200:215]
    v_xor_b32 v86, 128, v4
    ds_read_b64_tr_b16 v[36:37], v86 offset:0
    ds_read_b64_tr_b16 v[40:41], v86 offset:4096
    buffer_load_dwordx4 v78, s[52:55], s95 offen offset:2048 nt lds
    v_mfma_f32_32x32x16_bf16 v[200:215], v[236:239], v[124:127], v[200:215]
    v_xor_b32 v87, 160, v4
    ds_read_b64_tr_b16 v[38:39], v87 offset:2048
    ds_read_b64_tr_b16 v[42:43], v87 offset:6144
    v_mfma_f32_32x32x16_bf16 v[200:215], v[240:243], v[128:131], v[200:215]
    v_xor_b32 v88, 192, v4
    ds_read_b64_tr_b16 v[44:45], v88 offset:0
    ds_read_b64_tr_b16 v[48:49], v88 offset:4096
    v_mfma_f32_32x32x16_bf16 v[200:215], v[244:247], v[132:135], v[200:215]
    v_xor_b32 v89, 224, v4
    ds_read_b64_tr_b16 v[46:47], v89 offset:2048
    ds_read_b64_tr_b16 v[50:51], v89 offset:6144
    buffer_load_dwordx4 v79, s[52:55], s95 offen offset:3072 nt lds
    s_add_u32 s95, s95, 16384
    v_xor_b32 v5, 0x2000, v94
    v_xor_b32 v6, 0x4000, v94
    v_xor_b32 v7, 0x6000, v94
    s_cmp_lg_u32 s93, 12
    s_cbranch_scc1 L_noswitch_37
    s_mov_b32 s52, s24
    s_and_b32 s53, s25, 0xffff
    s_mov_b32 s54, 4194304
    s_mov_b32 s55, 0x20000
    s_mov_b32 s95, s63
L_noswitch_37:
    s_nop 1
    ds_write_b128 v94, v[200:203] offset:0
    ds_write_b128 v94, v[204:207] offset:1024
    ds_write_b128 v94, v[208:211] offset:2048
    ds_write_b128 v94, v[212:215] offset:3072
    s_waitcnt lgkmcnt(0)
    s_barrier
    ds_read_b128 v[60:63], v5 offset:0
    ds_read_b128 v[216:219], v6 offset:0
    ds_read_b128 v[232:235], v7 offset:0
    ds_read_b128 v[64:67], v5 offset:1024
    ds_read_b128 v[220:223], v6 offset:1024
    ds_read_b128 v[236:239], v7 offset:1024
    ds_read_b128 v[68:71], v5 offset:2048
    ds_read_b128 v[224:227], v6 offset:2048
    ds_read_b128 v[240:243], v7 offset:2048
    ds_read_b128 v[72:75], v5 offset:3072
    ds_read_b128 v[228:231], v6 offset:3072
    ds_read_b128 v[244:247], v7 offset:3072
    v_xor_b32 v94, 0x1000, v94
    s_add_u32 s39, s90, s62
    s_mov_b32 m0, s39
    s_add_u32 s62, s62, 4096
    s_and_b32 s62, s62, 0x7fff
    buffer_load_dwordx4 v76, s[52:55], s95 offen offset:0 nt lds
    s_add_u32 s94, s94, 8192
    s_and_b32 s94, s94, 0x7fff
    s_waitcnt lgkmcnt(9)
    v_pk_add_f32 v[200:201], v[200:201], v[60:61]
    v_pk_add_f32 v[216:217], v[216:217], v[232:233]
    v_pk_add_f32 v[202:203], v[202:203], v[62:63]
    v_pk_add_f32 v[218:219], v[218:219], v[234:235]
    v_pk_add_f32 v[200:201], v[200:201], v[216:217]
    v_pk_add_f32 v[202:203], v[202:203], v[218:219]
    s_waitcnt lgkmcnt(6)
    v_pk_add_f32 v[204:205], v[204:205], v[64:65]
    v_pk_add_f32 v[220:221], v[220:221], v[236:237]
    v_pk_add_f32 v[206:207], v[206:207], v[66:67]
    v_pk_add_f32 v[222:223], v[222:223], v[238:239]
    v_pk_add_f32 v[204:205], v[204:205], v[220:221]
    v_pk_add_f32 v[206:207], v[206:207], v[222:223]
    s_waitcnt lgkmcnt(3)
    v_pk_add_f32 v[208:209], v[208:209], v[68:69]
    v_pk_add_f32 v[224:225], v[224:225], v[240:241]
    v_pk_add_f32 v[210:211], v[210:211], v[70:71]
    v_pk_add_f32 v[226:227], v[226:227], v[242:243]
    v_pk_add_f32 v[208:209], v[208:209], v[224:225]
    v_pk_add_f32 v[210:211], v[210:211], v[226:227]
    s_waitcnt lgkmcnt(0)
    v_pk_add_f32 v[212:213], v[212:213], v[72:73]
    v_pk_add_f32 v[228:229], v[228:229], v[244:245]
    v_pk_add_f32 v[214:215], v[214:215], v[74:75]
    v_pk_add_f32 v[230:231], v[230:231], v[246:247]
    v_pk_add_f32 v[212:213], v[212:213], v[228:229]
    v_pk_add_f32 v[214:215], v[214:215], v[230:231]
    buffer_load_dwordx4 v77, s[52:55], s95 offen offset:1024 nt lds
    v_max_f32 v4, v200, v201
    v_max3_f32 v4, v4, v202, v203
    v_max3_f32 v4, v4, v204, v205
    v_max3_f32 v4, v4, v206, v207
    v_max3_f32 v4, v4, v208, v209
    v_max3_f32 v4, v4, v210, v211
    v_max3_f32 v4, v4, v212, v213
    v_max3_f32 v4, v4, v214, v215
    v_mov_b32 v5, v4
    s_nop 1
    v_permlane32_swap_b32 v4, v5
    v_max_f32 v4, v4, v5
    v_mul_f32 v4, s83, v4
    v_max_f32 v4, v4, v90
    v_sub_f32 v92, v90, v4
    v_exp_f32 v92, v92
    v_mov_b32 v90, v4
    v_pk_fma_f32 v[200:201], v[200:201], s[60:61], v[90:91] op_sel_hi:[1,1,0] neg_lo:[0,0,1] neg_hi:[0,0,1]
    v_pk_fma_f32 v[202:203], v[202:203], s[60:61], v[90:91] op_sel_hi:[1,1,0] neg_lo:[0,0,1] neg_hi:[0,0,1]
    v_pk_fma_f32 v[204:205], v[204:205], s[60:61], v[90:91] op_sel_hi:[1,1,0] neg_lo:[0,0,1] neg_hi:[0,0,1]
    v_pk_fma_f32 v[206:207], v[206:207], s[60:61], v[90:91] op_sel_hi:[1,1,0] neg_lo:[0,0,1] neg_hi:[0,0,1]
    v_pk_fma_f32 v[208:209], v[208:209], s[60:61], v[90:91] op_sel_hi:[1,1,0] neg_lo:[0,0,1] neg_hi:[0,0,1]
    v_pk_fma_f32 v[210:211], v[210:211], s[60:61], v[90:91] op_sel_hi:[1,1,0] neg_lo:[0,0,1] neg_hi:[0,0,1]
    v_pk_fma_f32 v[212:213], v[212:213], s[60:61], v[90:91] op_sel_hi:[1,1,0] neg_lo:[0,0,1] neg_hi:[0,0,1]
    v_pk_fma_f32 v[214:215], v[214:215], s[60:61], v[90:91] op_sel_hi:[1,1,0] neg_lo:[0,0,1] neg_hi:[0,0,1]
    v_exp_f32 v200, v200
    v_exp_f32 v201, v201
    v_exp_f32 v202, v202
    v_exp_f32 v203, v203
    v_exp_f32 v204, v204
    buffer_load_dwordx4 v78, s[52:55], s95 offen offset:2048 nt lds
    v_exp_f32 v205, v205
    v_exp_f32 v206, v206
    v_exp_f32 v207, v207
    v_exp_f32 v208, v208
    v_exp_f32 v209, v209
    v_exp_f32 v210, v210
    v_exp_f32 v211, v211
    v_exp_f32 v212, v212
    v_exp_f32 v213, v213
    v_exp_f32 v214, v214
    v_exp_f32 v215, v215
    v_add_u32 v4, s94, v80
    v_pk_mul_f32 v[102:103], v[102:103], v[92:93] op_sel_hi:[1,0]
    v_pk_mul_f32 v[136:137], v[136:137], v[92:93] op_sel_hi:[1,0]
    v_pk_mul_f32 v[138:139], v[138:139], v[92:93] op_sel_hi:[1,0]
    v_pk_mul_f32 v[140:141], v[140:141], v[92:93] op_sel_hi:[1,0]
    v_pk_mul_f32 v[142:143], v[142:143], v[92:93] op_sel_hi:[1,0]
    v_pk_mul_f32 v[144:145], v[144:145], v[92:93] op_sel_hi:[1,0]
    v_pk_mul_f32 v[146:147], v[146:147], v[92:93] op_sel_hi:[1,0]
    v_pk_mul_f32 v[148:149], v[148:149], v[92:93] op_sel_hi:[1,0]
    v_pk_mul_f32 v[150:151], v[150:151], v[92:93] op_sel_hi:[1,0]
    v_pk_mul_f32 v[152:153], v[152:153], v[92:93] op_sel_hi:[1,0]
    v_pk_mul_f32 v[154:155], v[154:155], v[92:93] op_sel_hi:[1,0]
    v_pk_mul_f32 v[156:157], v[156:157], v[92:93] op_sel_hi:[1,0]
    v_pk_mul_f32 v[158:159], v[158:159], v[92:93] op_sel_hi:[1,0]
    v_pk_mul_f32 v[160:161], v[160:161], v[92:93] op_sel_hi:[1,0]
    v_pk_mul_f32 v[162:163], v[162:163], v[92:93] op_sel_hi:[1,0]
    v_pk_mul_f32 v[164:165], v[164:165], v[92:93] op_sel_hi:[1,0]
    v_pk_mul_f32 v[166:167], v[166:167], v[92:93] op_sel_hi:[1,0]
    v_pk_mul_f32 v[168:169], v[168:169], v[92:93] op_sel_hi:[1,0]
    v_pk_mul_f32 v[170:171], v[170:171], v[92:93] op_sel_hi:[1,0]
    v_pk_mul_f32 v[172:173], v[172:173], v[92:93] op_sel_hi:[1,0]
    v_pk_mul_f32 v[174:175], v[174:175], v[92:93] op_sel_hi:[1,0]
    v_pk_mul_f32 v[176:177], v[176:177], v[92:93] op_sel_hi:[1,0]
    buffer_load_dwordx4 v79, s[52:55], s95 offen offset:3072 nt lds
    s_add_u32 s95, s95, 16384
    v_pk_mul_f32 v[178:179], v[178:179], v[92:93] op_sel_hi:[1,0]
    v_pk_mul_f32 v[180:181], v[180:181], v[92:93] op_sel_hi:[1,0]
    v_pk_mul_f32 v[182:183], v[182:183], v[92:93] op_sel_hi:[1,0]
    v_pk_mul_f32 v[184:185], v[184:185], v[92:93] op_sel_hi:[1,0]
    v_pk_mul_f32 v[186:187], v[186:187], v[92:93] op_sel_hi:[1,0]
    v_pk_mul_f32 v[188:189], v[188:189], v[92:93] op_sel_hi:[1,0]
    v_pk_mul_f32 v[190:191], v[190:191], v[92:93] op_sel_hi:[1,0]
    v_pk_mul_f32 v[192:193], v[192:193], v[92:93] op_sel_hi:[1,0]
    v_pk_mul_f32 v[194:195], v[194:195], v[92:93] op_sel_hi:[1,0]
    v_pk_mul_f32 v[196:197], v[196:197], v[92:93] op_sel_hi:[1,0]
    v_pk_mul_f32 v[198:199], v[198:199], v[92:93] op_sel_hi:[1,0]
    v_cvt_pk_bf16_f32 v52, v200, v201
    v_pk_add_f32 v[102:103], v[102:103], v[200:201]
    v_cvt_pk_bf16_f32 v53, v202, v203
    v_pk_add_f32 v[102:103], v[102:103], v[202:203]
    v_cvt_pk_bf16_f32 v54, v204, v205
    v_pk_add_f32 v[102:103], v[102:103], v[204:205]
    v_cvt_pk_bf16_f32 v55, v206, v207
    v_pk_add_f32 v[102:103], v[102:103], v[206:207]
    v_cvt_pk_bf16_f32 v56, v208, v209
    v_pk_add_f32 v[102:103], v[102:103], v[208:209]
    v_cvt_pk_bf16_f32 v57, v210, v211
    v_pk_add_f32 v[102:103], v[102:103], v[210:211]
    v_cvt_pk_bf16_f32 v58, v212, v213
    v_pk_add_f32 v[102:103], v[102:103], v[212:213]
    v_cvt_pk_bf16_f32 v59, v214, v215
    v_pk_add_f32 v[102:103], v[102:103], v[214:215]
    s_waitcnt vmcnt(20)
    v_mfma_f32_32x32x16_bf16 v[136:151], v[20:23], v[52:55], v[136:151]
    v_xor_b32 v82, 0, v4
    ds_read_b128 v[216:219], v82
    v_xor_b32 v83, 32, v4
    ds_read_b128 v[220:223], v83
    v_mfma_f32_32x32x16_bf16 v[152:167], v[28:31], v[52:55], v[152:167]
    v_xor_b32 v84, 64, v4
    ds_read_b128 v[224:227], v84
    v_xor_b32 v85, 96, v4
    ds_read_b128 v[228:231], v85
    v_mfma_f32_32x32x16_bf16 v[168:183], v[36:39], v[52:55], v[168:183]
    v_xor_b32 v86, 128, v4
    ds_read_b128 v[232:235], v86
    v_xor_b32 v87, 160, v4
    ds_read_b128 v[236:239], v87
    v_mfma_f32_32x32x16_bf16 v[184:199], v[44:47], v[52:55], v[184:199]
    v_xor_b32 v88, 192, v4
    ds_read_b128 v[240:243], v88
    v_xor_b32 v89, 224, v4
    ds_read_b128 v[244:247], v89
    v_mfma_f32_32x32x16_bf16 v[136:151], v[24:27], v[56:59], v[136:151]
    s_add_u32 s39, s90, s62
    s_mov_b32 m0, s39
    s_add_u32 s62, s62, 4096
    s_and_b32 s62, s62, 0x7fff
    buffer_load_dwordx4 v76, s[52:55], s95 offen offset:0 nt lds
    v_mfma_f32_32x32x16_bf16 v[152:167], v[32:35], v[56:59], v[152:167]
    v_mfma_f32_32x32x16_bf16 v[168:183], v[40:43], v[56:59], v[168:183]
    v_mfma_f32_32x32x16_bf16 v[184:199], v[48:51], v[56:59], v[184:199]
    s_add_u32 s93, s93, 1
    s_cmp_lt_u32 s93, 16
    s_cbranch_scc1 L_att
    v_add_f32 v91, v102, v103
    v_mov_b32 v5, v91
    s_nop 1
    v_permlane32_swap_b32 v91, v5
    v_add_f32 v91, v91, v5
    v_and_b32 v4, 31, v1
    v_lshlrev_b32 v5, 8, v4
    v_lshl_add_u32 v5, v3, 4, v5
    v_lshrrev_b32 v6, 5, v1
    v_lshl_add_u32 v5, v6, 3, v5
    v_add_u32 v5, s85, v5
    s_waitcnt lgkmcnt(0)
    s_barrier
    v_cvt_pk_bf16_f32 v20, v136, v137
    v_cvt_pk_bf16_f32 v21, v138, v139
    v_xor_b32 v82, 0, v5
    ds_write_b64 v82, v[20:21]
    v_cvt_pk_bf16_f32 v22, v140, v141
    v_cvt_pk_bf16_f32 v23, v142, v143
    v_xor_b32 v83, 16, v5
    ds_write_b64 v83, v[22:23]
    v_cvt_pk_bf16_f32 v24, v144, v145
    v_cvt_pk_bf16_f32 v25, v146, v147
    v_xor_b32 v84, 32, v5
    ds_write_b64 v84, v[24:25]
    v_cvt_pk_bf16_f32 v26, v148, v149
    v_cvt_pk_bf16_f32 v27, v150, v151
    v_xor_b32 v85, 48, v5
    ds_write_b64 v85, v[26:27]
    v_cvt_pk_bf16_f32 v28, v152, v153
    v_cvt_pk_bf16_f32 v29, v154, v155
    v_xor_b32 v86, 64, v5
    ds_write_b64 v86, v[28:29]
    v_cvt_pk_bf16_f32 v30, v156, v157
    v_cvt_pk_bf16_f32 v31, v158, v159
    v_xor_b32 v87, 80, v5
    ds_write_b64 v87, v[30:31]
    v_cvt_pk_bf16_f32 v32, v160, v161
    v_cvt_pk_bf16_f32 v33, v162, v163
    v_xor_b32 v88, 96, v5
    ds_write_b64 v88, v[32:33]
    v_cvt_pk_bf16_f32 v34, v164, v165
    v_cvt_pk_bf16_f32 v35, v166, v167
    v_xor_b32 v89, 112, v5
    ds_write_b64 v89, v[34:35]
    v_cvt_pk_bf16_f32 v36, v168, v169
    v_cvt_pk_bf16_f32 v37, v170, v171
    v_xor_b32 v82, 128, v5
    ds_write_b64 v82, v[36:37]
    v_cvt_pk_bf16_f32 v38, v172, v173
    v_cvt_pk_bf16_f32 v39, v174, v175
    v_xor_b32 v83, 144, v5
    ds_write_b64 v83, v[38:39]
    v_cvt_pk_bf16_f32 v40, v176, v177
    v_cvt_pk_bf16_f32 v41, v178, v179
    v_xor_b32 v84, 160, v5
    ds_write_b64 v84, v[40:41]
    v_cvt_pk_bf16_f32 v42, v180, v181
    v_cvt_pk_bf16_f32 v43, v182, v183
    v_xor_b32 v85, 176, v5
    ds_write_b64 v85, v[42:43]
    v_cvt_pk_bf16_f32 v44, v184, v185
    v_cvt_pk_bf16_f32 v45, v186, v187
    v_xor_b32 v86, 192, v5
    ds_write_b64 v86, v[44:45]
    v_cvt_pk_bf16_f32 v46, v188, v189
    v_cvt_pk_bf16_f32 v47, v190, v191
    v_xor_b32 v87, 208, v5
    ds_write_b64 v87, v[46:47]
    v_cvt_pk_bf16_f32 v48, v192, v193
    v_cvt_pk_bf16_f32 v49, v194, v195
    v_xor_b32 v88, 224, v5
    ds_write_b64 v88, v[48:49]
    v_cvt_pk_bf16_f32 v50, v196, v197
    v_cvt_pk_bf16_f32 v51, v198, v199
    v_xor_b32 v89, 240, v5
    ds_write_b64 v89, v[50:51]
    v_xor_b32 v6, v3, v2
    v_lshlrev_b32 v6, 4, v6
    v_lshl_add_u32 v6, v2, 8, v6
    v_add_u32 v6, s85, v6
    v_xor_b32 v82, 0, v6
    v_xor_b32 v83, 64, v6
    v_xor_b32 v84, 128, v6
    v_xor_b32 v85, 192, v6
    v_lshlrev_b32 v7, 4, v3
    v_lshl_add_u32 v7, v2, 15, v7
    s_lshl_b32 s36, s32, 10
    s_lshl_b32 s38, s34, 8
    s_add_u32 s36, s36, s38
    s_add_u32 s36, s36, 4194304
    s_waitcnt lgkmcnt(0)
    ds_read_b128 v[200:203], v82 offset:0
    ds_read_b128 v[204:207], v83 offset:1024
    ds_read_b128 v[208:211], v84 offset:2048
    ds_read_b128 v[212:215], v85 offset:3072
    ds_read_b128 v[216:219], v82 offset:4096
    ds_read_b128 v[220:223], v83 offset:5120
    ds_read_b128 v[224:227], v84 offset:6144
    ds_read_b128 v[228:231], v85 offset:7168
    v_lshlrev_b32 v4, 3, v4
    s_lshl_b32 s37, s32, 8
    s_lshl_b32 s38, s34, 13
    s_add_u32 s37, s37, s38
    s_add_u32 s37, s37, 2621440
    s_mov_b32 exec_lo, 0xffffffff
    s_mov_b32 exec_hi, 0x0
    buffer_store_dwordx2 v[90:91], v4, s[48:51], s37 offen sc1
    s_mov_b64 exec, -1
    s_waitcnt lgkmcnt(7)
    buffer_store_dwordx4 v[200:203], v7, s[48:51], s36 offen sc1
    s_add_u32 s36, s36, 131072
    s_waitcnt lgkmcnt(6)
    buffer_store_dwordx4 v[204:207], v7, s[48:51], s36 offen sc1
    s_add_u32 s36, s36, 131072
    s_waitcnt lgkmcnt(5)
    buffer_store_dwordx4 v[208:211], v7, s[48:51], s36 offen sc1
    s_add_u32 s36, s36, 131072
    s_waitcnt lgkmcnt(4)
    buffer_store_dwordx4 v[212:215], v7, s[48:51], s36 offen sc1
    s_add_u32 s36, s36, 131072
    s_waitcnt lgkmcnt(3)
    buffer_store_dwordx4 v[216:219], v7, s[48:51], s36 offen sc1
    s_add_u32 s36, s36, 131072
    s_waitcnt lgkmcnt(2)
    buffer_store_dwordx4 v[220:223], v7, s[48:51], s36 offen sc1
    s_add_u32 s36, s36, 131072
    s_waitcnt lgkmcnt(1)
    buffer_store_dwordx4 v[224:227], v7, s[48:51], s36 offen sc1
    s_add_u32 s36, s36, 131072
    s_waitcnt lgkmcnt(0)
    buffer_store_dwordx4 v[228:231], v7, s[48:51], s36 offen sc1
    buffer_load_dwordx4 v77, s[52:55], s95 offen offset:1024 nt lds
    buffer_load_dwordx4 v78, s[52:55], s95 offen offset:2048 nt lds
    buffer_load_dwordx4 v79, s[52:55], s95 offen offset:3072 nt lds
    s_add_u32 s95, s95, 16384
    v_and_b32 v4, 3, v3
    v_lshrrev_b32 v5, 2, v3
    v_lshlrev_b32 v6, 4, v2
    v_add_u32 v6, 147456, v6
    s_movk_i32 s36, 320
    v_cmp_eq_u32 vcc, 0, v5
    s_nop 1
    v_cndmask_b32 v112, 4, v4, vcc
    v_mad_u32_u24 v112, v112, s36, v6
    v_cmp_eq_u32 vcc, 1, v5
    s_nop 1
    v_cndmask_b32 v113, 4, v4, vcc
    v_mad_u32_u24 v113, v113, s36, v6
    v_cmp_eq_u32 vcc, 2, v5
    s_nop 1
    v_cndmask_b32 v114, 4, v4, vcc
    v_mad_u32_u24 v114, v114, s36, v6
    v_cmp_eq_u32 vcc, 3, v5
    s_nop 1
    v_cndmask_b32 v115, 4, v4, vcc
    v_mad_u32_u24 v115, v115, s36, v6
    s_lshl_b32 s36, s34, 16
    s_lshl_b32 s38, s32, 8
    s_add_u32 s36, s36, s38
    v_add_u32 v77, s36, v19
    s_lshl_b32 s36, s32, 13
    s_lshl_b32 s38, s34, 6
    s_add_u32 s36, s36, s38
    v_lshrrev_b32 v5, 2, v1
    v_lshlrev_b32 v5, 8, v5
    v_lshl_add_u32 v5, v4, 4, v5
    v_add_u32 v78, s36, v5
    s_lshr_b32 s36, s32, 2
    s_lshl_b32 s36, s36, 7
    s_lshl_b32 s38, s34, 5
    s_add_u32 s36, s36, s38
    s_and_b32 s38, s32, 3
    s_lshl_b32 s38, s38, 3
    s_add_u32 s36, s36, s38
    v_lshlrev_b32 v5, 11, v4
    v_lshl_add_u32 v5, v2, 1, v5
    v_add_u32 v79, s36, v5
    v_lshrrev_b32 v5, 2, v3
    v_lshl_add_u32 v6, v4, 3, v5
    v_lshlrev_b32 v81, 8, v6
    v_lshlrev_b32 v6, 10, v6
    v_lshl_add_u32 v80, v2, 4, v6
    s_lshl_b32 s38, s34, 11
    s_add_u32 s38, s38, 131072
    v_lshlrev_b32 v4, 9, v4
    v_lshl_add_u32 v4, v2, 4, v4
    v_add_u32 v94, s38, v4
    s_lshl_b32 s38, s34, 9
    s_add_u32 s38, s38, 131072
    v_and_b32 v5, 31, v1
    v_lshl_add_u32 v96, v5, 4, s38
    s_mul_i32 s38, s34, 320
    s_add_u32 s38, s38, 147456
    v_lshl_add_u32 v97, v5, 3, s38
    v_lshlrev_b32 v4, 6, v2
    v_lshl_add_u32 v4, v3, 1, v4
    v_add_u32 v93, s38, v4
    v_lshlrev_b32 v4, 7, v2
    v_lshl_add_u32 v4, v3, 4, v4
    v_mov_b32 v5, 512
    v_cmp_gt_u32 vcc, 8, v3
    s_nop 1
    v_cndmask_b32 v92, v5, v4, vcc
    s_mov_b32 s92, 0
    s_mov_b32 s96, 3145728
    s_mov_b32 s97, 0
    s_lshl_b32 s36, s32, 15
    s_lshl_b32 s38, s34, 8
    s_add_u32 s36, s36, s38
    s_add_u32 s36, s36, 4194304
    s_lshl_b32 s37, s32, 3
    s_lshl_b32 s38, s34, 13
    s_add_u32 s37, s37, s38
    s_add_u32 s37, s37, 2621440
    s_barrier
    s_lshl_b32 s38, s34, 5
    s_add_u32 s38, s38, s32
    s_lshl_b32 s38, s38, 8
    s_add_u32 s38, s38, 196608
    v_mov_b32 v4, s38
    v_mov_b32 v5, s68
    s_waitcnt vmcnt(3)
    s_mov_b64 exec, 1
    buffer_store_dword v5, v4, s[48:51], 0 offen sc1
    s_mov_b64 exec, -1
    s_mov_b32 s86, 196608
    buffer_load_dword v7, v101, s[48:51], s86 offen sc1
    s_waitcnt vmcnt(0)
L_fcheck_38:
    v_cmp_ne_u32 vcc, s68, v7
    s_cbranch_vccz L_fok_39
    s_sleep 2
    s_mov_b32 s86, 196608
    buffer_load_dword v7, v101, s[48:51], s86 offen sc1
    s_waitcnt vmcnt(0)
    s_sub_u32 s84, s84, 1
    s_cmp_lg_u32 s84, 0
    s_cbranch_scc1 L_fcheck_38
    s_branch L_end
L_fok_39:
    buffer_load_dwordx2 v[52:53], v81, s[48:51], s37 offen offset:0 sc1
    buffer_load_dwordx2 v[54:55], v81, s[48:51], s37 offen offset:1024 sc1
    buffer_load_dwordx4 v[20:23], v80, s[48:51], s36 offen offset:0 sc1
    buffer_load_dwordx4 v[24:27], v80, s[48:51], s36 offen offset:64 sc1
    buffer_load_dwordx4 v[28:31], v80, s[48:51], s36 offen offset:128 sc1
    buffer_load_dwordx4 v[32:35], v80, s[48:51], s36 offen offset:192 sc1
    s_add_u32 s36, s36, 4096
    buffer_load_dwordx4 v[36:39], v80, s[48:51], s36 offen offset:0 sc1
    buffer_load_dwordx4 v[40:43], v80, s[48:51], s36 offen offset:64 sc1
    buffer_load_dwordx4 v[44:47], v80, s[48:51], s36 offen offset:128 sc1
    buffer_load_dwordx4 v[48:51], v80, s[48:51], s36 offen offset:192 sc1
    s_add_u32 s36, s36, 4096
    s_waitcnt vmcnt(8)
    v_max_f32 v4, v52, v54
    s_nop 1
    v_max_f32_dpp v4, v4, v4 row_ror:8 row_mask:0xf bank_mask:0xf
    s_nop 1
    v_max_f32_dpp v4, v4, v4 row_ror:4 row_mask:0xf bank_mask:0xf
    v_sub_f32 v52, v52, v4
    v_sub_f32 v54, v54, v4
    v_exp_f32 v52, v52
    v_exp_f32 v54, v54
    v_mul_f32 v5, v52, v53
    v_fmac_f32 v5, v54, v55
    s_nop 1
    v_add_f32_dpp v5, v5, v5 row_ror:8 row_mask:0xf bank_mask:0xf
    s_nop 1
    v_add_f32_dpp v5, v5, v5 row_ror:4 row_mask:0xf bank_mask:0xf
    v_rcp_f32 v5, v5
    s_nop 0
    v_mul_f32 v52, v52, v5
    v_mul_f32 v54, v54, v5
    s_waitcnt vmcnt(0)
    v_mfma_f32_16x16x32_bf16 v[60:63], a[128:131], v[20:23], 0
    v_mfma_f32_16x16x32_bf16 v[64:67], a[128:131], v[36:39], 0
    v_mfma_f32_16x16x32_bf16 v[60:63], a[132:135], v[24:27], v[60:63]
    v_mfma_f32_16x16x32_bf16 v[64:67], a[132:135], v[40:43], v[64:67]
    v_mfma_f32_16x16x32_bf16 v[60:63], a[136:139], v[28:31], v[60:63]
    v_mfma_f32_16x16x32_bf16 v[64:67], a[136:139], v[44:47], v[64:67]
    v_mfma_f32_16x16x32_bf16 v[60:63], a[140:143], v[32:35], v[60:63]
    v_mfma_f32_16x16x32_bf16 v[64:67], a[140:143], v[48:51], v[64:67]
    v_mfma_f32_16x16x32_bf16 v[68:71], a[144:147], v[20:23], 0
    v_mfma_f32_16x16x32_bf16 v[72:75], a[144:147], v[36:39], 0
    v_mfma_f32_16x16x32_bf16 v[68:71], a[148:151], v[24:27], v[68:71]
    v_mfma_f32_16x16x32_bf16 v[72:75], a[148:151], v[40:43], v[72:75]
    v_mfma_f32_16x16x32_bf16 v[68:71], a[152:155], v[28:31], v[68:71]
    v_mfma_f32_16x16x32_bf16 v[72:75], a[152:155], v[44:47], v[72:75]
    v_mfma_f32_16x16x32_bf16 v[68:71], a[156:159], v[32:35], v[68:71]
    v_mfma_f32_16x16x32_bf16 v[72:75], a[156:159], v[48:51], v[72:75]
    v_mul_f32 v104, v60, v52
    v_mul_f32 v105, v61, v52
    v_mul_f32 v106, v62, v52
    v_mul_f32 v107, v63, v52
    v_fmac_f32 v104, v64, v54
    v_fmac_f32 v105, v65, v54
    v_fmac_f32 v106, v66, v54
    v_fmac_f32 v107, v67, v54
    v_add_f32_dpp v104, v104, v104 row_ror:8 row_mask:0xf bank_mask:0xf
    v_add_f32_dpp v105, v105, v105 row_ror:8 row_mask:0xf bank_mask:0xf
    v_add_f32_dpp v106, v106, v106 row_ror:8 row_mask:0xf bank_mask:0xf
    v_add_f32_dpp v107, v107, v107 row_ror:8 row_mask:0xf bank_mask:0xf
    v_add_f32_dpp v104, v104, v104 row_ror:4 row_mask:0xf bank_mask:0xf
    v_add_f32_dpp v105, v105, v105 row_ror:4 row_mask:0xf bank_mask:0xf
    v_add_f32_dpp v106, v106, v106 row_ror:4 row_mask:0xf bank_mask:0xf
    v_add_f32_dpp v107, v107, v107 row_ror:4 row_mask:0xf bank_mask:0xf
    ds_write_b128 v94, v[104:107] offset:0
    v_mfma_f32_16x16x32_bf16 v[60:63], a[160:163], v[20:23], 0
    v_mfma_f32_16x16x32_bf16 v[64:67], a[160:163], v[36:39], 0
    v_mfma_f32_16x16x32_bf16 v[60:63], a[164:167], v[24:27], v[60:63]
    v_mfma_f32_16x16x32_bf16 v[64:67], a[164:167], v[40:43], v[64:67]
    v_mfma_f32_16x16x32_bf16 v[60:63], a[168:171], v[28:31], v[60:63]
    v_mfma_f32_16x16x32_bf16 v[64:67], a[168:171], v[44:47], v[64:67]
    v_mfma_f32_16x16x32_bf16 v[60:63], a[172:175], v[32:35], v[60:63]
    v_mfma_f32_16x16x32_bf16 v[64:67], a[172:175], v[48:51], v[64:67]
    v_mul_f32 v108, v68, v52
    v_mul_f32 v109, v69, v52
    v_mul_f32 v110, v70, v52
    v_mul_f32 v111, v71, v52
    v_fmac_f32 v108, v72, v54
    v_fmac_f32 v109, v73, v54
    v_fmac_f32 v110, v74, v54
    v_fmac_f32 v111, v75, v54
    v_add_f32_dpp v108, v108, v108 row_ror:8 row_mask:0xf bank_mask:0xf
    v_add_f32_dpp v109, v109, v109 row_ror:8 row_mask:0xf bank_mask:0xf
    v_add_f32_dpp v110, v110, v110 row_ror:8 row_mask:0xf bank_mask:0xf
    v_add_f32_dpp v111, v111, v111 row_ror:8 row_mask:0xf bank_mask:0xf
    v_add_f32_dpp v108, v108, v108 row_ror:4 row_mask:0xf bank_mask:0xf
    v_add_f32_dpp v109, v109, v109 row_ror:4 row_mask:0xf bank_mask:0xf
    v_add_f32_dpp v110, v110, v110 row_ror:4 row_mask:0xf bank_mask:0xf
    v_add_f32_dpp v111, v111, v111 row_ror:4 row_mask:0xf bank_mask:0xf
    ds_write_b128 v94, v[108:111] offset:64
    v_mfma_f32_16x16x32_bf16 v[68:71], a[176:179], v[20:23], 0
    v_mfma_f32_16x16x32_bf16 v[72:75], a[176:179], v[36:39], 0
    v_mfma_f32_16x16x32_bf16 v[68:71], a[180:183], v[24:27], v[68:71]
    v_mfma_f32_16x16x32_bf16 v[72:75], a[180:183], v[40:43], v[72:75]
    v_mfma_f32_16x16x32_bf16 v[68:71], a[184:187], v[28:31], v[68:71]
    v_mfma_f32_16x16x32_bf16 v[72:75], a[184:187], v[44:47], v[72:75]
    v_mfma_f32_16x16x32_bf16 v[68:71], a[188:191], v[32:35], v[68:71]
    v_mfma_f32_16x16x32_bf16 v[72:75], a[188:191], v[48:51], v[72:75]
    v_mul_f32 v104, v60, v52
    v_mul_f32 v105, v61, v52
    v_mul_f32 v106, v62, v52
    v_mul_f32 v107, v63, v52
    v_fmac_f32 v104, v64, v54
    v_fmac_f32 v105, v65, v54
    v_fmac_f32 v106, v66, v54
    v_fmac_f32 v107, v67, v54
    v_add_f32_dpp v104, v104, v104 row_ror:8 row_mask:0xf bank_mask:0xf
    v_add_f32_dpp v105, v105, v105 row_ror:8 row_mask:0xf bank_mask:0xf
    v_add_f32_dpp v106, v106, v106 row_ror:8 row_mask:0xf bank_mask:0xf
    v_add_f32_dpp v107, v107, v107 row_ror:8 row_mask:0xf bank_mask:0xf
    v_add_f32_dpp v104, v104, v104 row_ror:4 row_mask:0xf bank_mask:0xf
    v_add_f32_dpp v105, v105, v105 row_ror:4 row_mask:0xf bank_mask:0xf
    v_add_f32_dpp v106, v106, v106 row_ror:4 row_mask:0xf bank_mask:0xf
    v_add_f32_dpp v107, v107, v107 row_ror:4 row_mask:0xf bank_mask:0xf
    ds_write_b128 v94, v[104:107] offset:128
    v_mfma_f32_16x16x32_bf16 v[60:63], a[192:195], v[20:23], 0
    v_mfma_f32_16x16x32_bf16 v[64:67], a[192:195], v[36:39], 0
    v_mfma_f32_16x16x32_bf16 v[60:63], a[196:199], v[24:27], v[60:63]
    v_mfma_f32_16x16x32_bf16 v[64:67], a[196:199], v[40:43], v[64:67]
    v_mfma_f32_16x16x32_bf16 v[60:63], a[200:203], v[28:31], v[60:63]
    v_mfma_f32_16x16x32_bf16 v[64:67], a[200:203], v[44:47], v[64:67]
    v_mfma_f32_16x16x32_bf16 v[60:63], a[204:207], v[32:35], v[60:63]
    v_mfma_f32_16x16x32_bf16 v[64:67], a[204:207], v[48:51], v[64:67]
    v_mul_f32 v108, v68, v52
    v_mul_f32 v109, v69, v52
    v_mul_f32 v110, v70, v52
    v_mul_f32 v111, v71, v52
    v_fmac_f32 v108, v72, v54
    v_fmac_f32 v109, v73, v54
    v_fmac_f32 v110, v74, v54
    v_fmac_f32 v111, v75, v54
    v_add_f32_dpp v108, v108, v108 row_ror:8 row_mask:0xf bank_mask:0xf
    v_add_f32_dpp v109, v109, v109 row_ror:8 row_mask:0xf bank_mask:0xf
    v_add_f32_dpp v110, v110, v110 row_ror:8 row_mask:0xf bank_mask:0xf
    v_add_f32_dpp v111, v111, v111 row_ror:8 row_mask:0xf bank_mask:0xf
    v_add_f32_dpp v108, v108, v108 row_ror:4 row_mask:0xf bank_mask:0xf
    v_add_f32_dpp v109, v109, v109 row_ror:4 row_mask:0xf bank_mask:0xf
    v_add_f32_dpp v110, v110, v110 row_ror:4 row_mask:0xf bank_mask:0xf
    v_add_f32_dpp v111, v111, v111 row_ror:4 row_mask:0xf bank_mask:0xf
    ds_write_b128 v94, v[108:111] offset:192
    v_mfma_f32_16x16x32_bf16 v[68:71], a[208:211], v[20:23], 0
    v_mfma_f32_16x16x32_bf16 v[72:75], a[208:211], v[36:39], 0
    v_mfma_f32_16x16x32_bf16 v[68:71], a[212:215], v[24:27], v[68:71]
    v_mfma_f32_16x16x32_bf16 v[72:75], a[212:215], v[40:43], v[72:75]
    v_mfma_f32_16x16x32_bf16 v[68:71], a[216:219], v[28:31], v[68:71]
    v_mfma_f32_16x16x32_bf16 v[72:75], a[216:219], v[44:47], v[72:75]
    v_mfma_f32_16x16x32_bf16 v[68:71], a[220:223], v[32:35], v[68:71]
    v_mfma_f32_16x16x32_bf16 v[72:75], a[220:223], v[48:51], v[72:75]
    v_mul_f32 v104, v60, v52
    v_mul_f32 v105, v61, v52
    v_mul_f32 v106, v62, v52
    v_mul_f32 v107, v63, v52
    v_fmac_f32 v104, v64, v54
    v_fmac_f32 v105, v65, v54
    v_fmac_f32 v106, v66, v54
    v_fmac_f32 v107, v67, v54
    v_add_f32_dpp v104, v104, v104 row_ror:8 row_mask:0xf bank_mask:0xf
    v_add_f32_dpp v105, v105, v105 row_ror:8 row_mask:0xf bank_mask:0xf
    v_add_f32_dpp v106, v106, v106 row_ror:8 row_mask:0xf bank_mask:0xf
    v_add_f32_dpp v107, v107, v107 row_ror:8 row_mask:0xf bank_mask:0xf
    v_add_f32_dpp v104, v104, v104 row_ror:4 row_mask:0xf bank_mask:0xf
    v_add_f32_dpp v105, v105, v105 row_ror:4 row_mask:0xf bank_mask:0xf
    v_add_f32_dpp v106, v106, v106 row_ror:4 row_mask:0xf bank_mask:0xf
    v_add_f32_dpp v107, v107, v107 row_ror:4 row_mask:0xf bank_mask:0xf
    ds_write_b128 v94, v[104:107] offset:256
    v_mfma_f32_16x16x32_bf16 v[60:63], a[224:227], v[20:23], 0
    v_mfma_f32_16x16x32_bf16 v[64:67], a[224:227], v[36:39], 0
    v_mfma_f32_16x16x32_bf16 v[60:63], a[228:231], v[24:27], v[60:63]
    v_mfma_f32_16x16x32_bf16 v[64:67], a[228:231], v[40:43], v[64:67]
    v_mfma_f32_16x16x32_bf16 v[60:63], a[232:235], v[28:31], v[60:63]
    v_mfma_f32_16x16x32_bf16 v[64:67], a[232:235], v[44:47], v[64:67]
    v_mfma_f32_16x16x32_bf16 v[60:63], a[236:239], v[32:35], v[60:63]
    v_mfma_f32_16x16x32_bf16 v[64:67], a[236:239], v[48:51], v[64:67]
    v_mul_f32 v108, v68, v52
    v_mul_f32 v109, v69, v52
    v_mul_f32 v110, v70, v52
    v_mul_f32 v111, v71, v52
    v_fmac_f32 v108, v72, v54
    v_fmac_f32 v109, v73, v54
    v_fmac_f32 v110, v74, v54
    v_fmac_f32 v111, v75, v54
    v_add_f32_dpp v108, v108, v108 row_ror:8 row_mask:0xf bank_mask:0xf
    v_add_f32_dpp v109, v109, v109 row_ror:8 row_mask:0xf bank_mask:0xf
    v_add_f32_dpp v110, v110, v110 row_ror:8 row_mask:0xf bank_mask:0xf
    v_add_f32_dpp v111, v111, v111 row_ror:8 row_mask:0xf bank_mask:0xf
    v_add_f32_dpp v108, v108, v108 row_ror:4 row_mask:0xf bank_mask:0xf
    v_add_f32_dpp v109, v109, v109 row_ror:4 row_mask:0xf bank_mask:0xf
    v_add_f32_dpp v110, v110, v110 row_ror:4 row_mask:0xf bank_mask:0xf
    v_add_f32_dpp v111, v111, v111 row_ror:4 row_mask:0xf bank_mask:0xf
    ds_write_b128 v94, v[108:111] offset:320
    v_mfma_f32_16x16x32_bf16 v[68:71], a[240:243], v[20:23], 0
    v_mfma_f32_16x16x32_bf16 v[72:75], a[240:243], v[36:39], 0
    v_mfma_f32_16x16x32_bf16 v[68:71], a[244:247], v[24:27], v[68:71]
    v_mfma_f32_16x16x32_bf16 v[72:75], a[244:247], v[40:43], v[72:75]
    v_mfma_f32_16x16x32_bf16 v[68:71], a[248:251], v[28:31], v[68:71]
    v_mfma_f32_16x16x32_bf16 v[72:75], a[248:251], v[44:47], v[72:75]
    v_mfma_f32_16x16x32_bf16 v[68:71], a[252:255], v[32:35], v[68:71]
    v_mfma_f32_16x16x32_bf16 v[72:75], a[252:255], v[48:51], v[72:75]
    v_mul_f32 v104, v60, v52
    v_mul_f32 v105, v61, v52
    v_mul_f32 v106, v62, v52
    v_mul_f32 v107, v63, v52
    v_fmac_f32 v104, v64, v54
    v_fmac_f32 v105, v65, v54
    v_fmac_f32 v106, v66, v54
    v_fmac_f32 v107, v67, v54
    v_add_f32_dpp v104, v104, v104 row_ror:8 row_mask:0xf bank_mask:0xf
    v_add_f32_dpp v105, v105, v105 row_ror:8 row_mask:0xf bank_mask:0xf
    v_add_f32_dpp v106, v106, v106 row_ror:8 row_mask:0xf bank_mask:0xf
    v_add_f32_dpp v107, v107, v107 row_ror:8 row_mask:0xf bank_mask:0xf
    v_add_f32_dpp v104, v104, v104 row_ror:4 row_mask:0xf bank_mask:0xf
    v_add_f32_dpp v105, v105, v105 row_ror:4 row_mask:0xf bank_mask:0xf
    v_add_f32_dpp v106, v106, v106 row_ror:4 row_mask:0xf bank_mask:0xf
    v_add_f32_dpp v107, v107, v107 row_ror:4 row_mask:0xf bank_mask:0xf
    ds_write_b128 v94, v[104:107] offset:384
    v_mul_f32 v108, v68, v52
    v_mul_f32 v109, v69, v52
    v_mul_f32 v110, v70, v52
    v_mul_f32 v111, v71, v52
    v_fmac_f32 v108, v72, v54
    v_fmac_f32 v109, v73, v54
    v_fmac_f32 v110, v74, v54
    v_fmac_f32 v111, v75, v54
    v_add_f32_dpp v108, v108, v108 row_ror:8 row_mask:0xf bank_mask:0xf
    v_add_f32_dpp v109, v109, v109 row_ror:8 row_mask:0xf bank_mask:0xf
    v_add_f32_dpp v110, v110, v110 row_ror:8 row_mask:0xf bank_mask:0xf
    v_add_f32_dpp v111, v111, v111 row_ror:8 row_mask:0xf bank_mask:0xf
    v_add_f32_dpp v108, v108, v108 row_ror:4 row_mask:0xf bank_mask:0xf
    v_add_f32_dpp v109, v109, v109 row_ror:4 row_mask:0xf bank_mask:0xf
    v_add_f32_dpp v110, v110, v110 row_ror:4 row_mask:0xf bank_mask:0xf
    v_add_f32_dpp v111, v111, v111 row_ror:4 row_mask:0xf bank_mask:0xf
    ds_write_b128 v94, v[108:111] offset:448
    s_waitcnt lgkmcnt(0)
    s_barrier
    ds_read_b128 v[20:23], v96 offset:0
    ds_read_b128 v[24:27], v96 offset:2048
    ds_read_b128 v[28:31], v96 offset:4096
    ds_read_b128 v[32:35], v96 offset:6144
    s_waitcnt lgkmcnt(0)
    v_add_f32 v20, v20, v24
    v_add_f32 v28, v28, v32
    v_add_f32 v21, v21, v25
    v_add_f32 v29, v29, v33
    v_add_f32 v22, v22, v26
    v_add_f32 v30, v30, v34
    v_add_f32 v23, v23, v27
    v_add_f32 v31, v31, v35
    v_add_f32 v20, v20, v28
    v_add_f32 v21, v21, v29
    v_add_f32 v22, v22, v30
    v_add_f32 v23, v23, v31
    v_cvt_pk_bf16_f32 v20, v20, v21
    v_cvt_pk_bf16_f32 v21, v22, v23
    ds_write_b64 v97, v[20:21]
    v_lshlrev_b32 v4, 2, v1
    v_add_u32 v4, 148736, v4
    ds_write_b32 v4, v100
L_final:
    s_waitcnt lgkmcnt(0)
    s_barrier
    ds_read_b128 v[136:139], v112 offset:0
    ds_read_b128 v[140:143], v112 offset:64
    ds_read_b128 v[144:147], v112 offset:128
    ds_read_b128 v[148:151], v112 offset:192
    ds_read_b128 v[152:155], v113 offset:0
    ds_read_b128 v[156:159], v113 offset:64
    s_add_u32 s36, s96, 32768
    s_add_u32 s37, s96, 4096
    s_waitcnt lgkmcnt(5)
    v_mfma_f32_16x16x32_bf16 v[84:87], a[0:3], v[136:139], 0
    ds_read_b128 v[160:163], v113 offset:128
    v_mfma_f32_16x16x32_bf16 v[88:91], a[64:67], v[136:139], 0
    s_waitcnt lgkmcnt(5)
    v_mfma_f32_16x16x32_bf16 v[84:87], a[4:7], v[140:143], v[84:87]
    ds_read_b128 v[164:167], v113 offset:192
    v_mfma_f32_16x16x32_bf16 v[88:91], a[68:71], v[140:143], v[88:91]
    s_waitcnt lgkmcnt(5)
    v_mfma_f32_16x16x32_bf16 v[84:87], a[8:11], v[144:147], v[84:87]
    ds_read_b128 v[168:171], v114 offset:0
    v_mfma_f32_16x16x32_bf16 v[88:91], a[72:75], v[144:147], v[88:91]
    s_waitcnt lgkmcnt(5)
    v_mfma_f32_16x16x32_bf16 v[84:87], a[12:15], v[148:151], v[84:87]
    ds_read_b128 v[172:175], v114 offset:64
    v_mfma_f32_16x16x32_bf16 v[88:91], a[76:79], v[148:151], v[88:91]
    s_waitcnt lgkmcnt(5)
    v_mfma_f32_16x16x32_bf16 v[84:87], a[16:19], v[152:155], v[84:87]
    ds_read_b128 v[176:179], v114 offset:128
    v_mfma_f32_16x16x32_bf16 v[88:91], a[80:83], v[152:155], v[88:91]
    s_waitcnt lgkmcnt(5)
    v_mfma_f32_16x16x32_bf16 v[84:87], a[20:23], v[156:159], v[84:87]
    ds_read_b128 v[180:183], v114 offset:192
    v_mfma_f32_16x16x32_bf16 v[88:91], a[84:87], v[156:159], v[88:91]
    s_waitcnt lgkmcnt(5)
    v_mfma_f32_16x16x32_bf16 v[84:87], a[24:27], v[160:163], v[84:87]
    ds_read_b128 v[184:187], v115 offset:0
    v_mfma_f32_16x16x32_bf16 v[88:91], a[88:91], v[160:163], v[88:91]
    s_waitcnt lgkmcnt(5)
    v_mfma_f32_16x16x32_bf16 v[84:87], a[28:31], v[164:167], v[84:87]
    ds_read_b128 v[188:191], v115 offset:64
    v_mfma_f32_16x16x32_bf16 v[88:91], a[92:95], v[164:167], v[88:91]
    s_waitcnt lgkmcnt(5)
    v_mfma_f32_16x16x32_bf16 v[84:87], a[32:35], v[168:171], v[84:87]
    ds_read_b128 v[192:195], v115 offset:128
    v_mfma_f32_16x16x32_bf16 v[88:91], a[96:99], v[168:171], v[88:91]
    s_waitcnt lgkmcnt(5)
    v_mfma_f32_16x16x32_bf16 v[84:87], a[36:39], v[172:175], v[84:87]
    ds_read_b128 v[196:199], v115 offset:192
    v_mfma_f32_16x16x32_bf16 v[88:91], a[100:103], v[172:175], v[88:91]
    s_waitcnt lgkmcnt(5)
    v_mfma_f32_16x16x32_bf16 v[84:87], a[40:43], v[176:179], v[84:87]
    v_mfma_f32_16x16x32_bf16 v[88:91], a[104:107], v[176:179], v[88:91]
    s_waitcnt lgkmcnt(4)
    v_mfma_f32_16x16x32_bf16 v[84:87], a[44:47], v[180:183], v[84:87]
    v_mfma_f32_16x16x32_bf16 v[88:91], a[108:111], v[180:183], v[88:91]
    s_waitcnt lgkmcnt(3)
    v_mfma_f32_16x16x32_bf16 v[84:87], a[48:51], v[184:187], v[84:87]
    v_mfma_f32_16x16x32_bf16 v[88:91], a[112:115], v[184:187], v[88:91]
    s_waitcnt lgkmcnt(2)
    v_mfma_f32_16x16x32_bf16 v[84:87], a[52:55], v[188:191], v[84:87]
    v_mfma_f32_16x16x32_bf16 v[88:91], a[116:119], v[188:191], v[88:91]
    s_waitcnt lgkmcnt(1)
    v_mfma_f32_16x16x32_bf16 v[84:87], a[56:59], v[192:195], v[84:87]
    v_mfma_f32_16x16x32_bf16 v[88:91], a[120:123], v[192:195], v[88:91]
    s_waitcnt lgkmcnt(0)
    v_mfma_f32_16x16x32_bf16 v[84:87], a[60:63], v[196:199], v[84:87]
    v_mfma_f32_16x16x32_bf16 v[88:91], a[124:127], v[196:199], v[88:91]
    s_nop 6
    v_and_or_b32 v84, v84, s82, v8
    v_and_or_b32 v85, v85, s82, v8
    v_and_or_b32 v86, v86, s82, v8
    v_and_or_b32 v87, v87, s82, v8
    buffer_store_dwordx4 v[84:87], v77, s[48:51], s96 offen sc1
    v_and_or_b32 v88, v88, s82, v8
    v_and_or_b32 v89, v89, s82, v8
    v_and_or_b32 v90, v90, s82, v8
    v_and_or_b32 v91, v91, s82, v8
    buffer_store_dwordx4 v[88:91], v77, s[48:51], s36 offen sc1
    s_cmp_eq_u32 s92, 0
    s_cbranch_scc1 L_prepb
L_hop2:
L_hop2poll:
    buffer_load_dwordx4 v[200:203], v78, s[48:51], s96 offen sc1
    buffer_load_dwordx4 v[204:207], v78, s[48:51], s37 offen sc1
    s_waitcnt vmcnt(0)
    v_xor_b32 v200, s35, v200
    v_xor_b32 v201, s35, v201
    v_xor_b32 v202, s35, v202
    v_xor_b32 v203, s35, v203
    v_xor_b32 v204, s35, v204
    v_xor_b32 v205, s35, v205
    v_xor_b32 v206, s35, v206
    v_xor_b32 v207, s35, v207
    v_or_b32 v4, v200, v201
    v_or3_b32 v4, v4, v202, v203
    v_or3_b32 v4, v4, v204, v205
    v_or3_b32 v4, v4, v206, v207
    v_and_b32 v4, 0xff, v4
    v_cmp_ne_u32 vcc, 0, v4
    v_add_f32 v104, v200, v204
    v_add_f32 v105, v201, v205
    v_add_f32 v106, v202, v206
    v_add_f32 v107, v203, v207
    s_cbranch_vccz L_hop2ok
    s_sub_u32 s84, s84, 1
    s_cmp_lg_u32 s84, 0
    s_cbranch_scc1 L_hop2poll
    s_branch L_end
L_hop2ok:
    v_permlane16_swap_b32 v104, v105
    v_permlane16_swap_b32 v106, v107
    v_add_f32 v104, v104, v105
    v_add_f32 v106, v106, v107
    s_nop 1
    v_permlane32_swap_b32 v104, v106
    v_add_f32 v104, v104, v106
    s_nop 1
    v_add_f32_dpp v104, v104, v104 row_ror:8 row_mask:0xf bank_mask:0xf
    s_nop 1
    v_add_f32_dpp v104, v104, v104 row_ror:4 row_mask:0xf bank_mask:0xf
    v_cvt_pk_bf16_f32 v104, v104, v104
    s_mov_b32 exec_lo, 0xf000f
    s_mov_b32 exec_hi, 0xf000f
    buffer_store_short v104, v79, s[72:75], s97 offen
    s_mov_b64 exec, -1
    s_cmp_lg_u32 s92, 0
    s_cbranch_scc1 L_fin
    s_mov_b32 s92, 1
    s_mov_b32 s96, 3670016
    s_mov_b32 s97, 1024
    s_lshl_b32 s85, s32, 2
    s_add_u32 s85, s85, s34
    s_lshl_b32 s85, s85, 13
    s_add_u32 s85, s85, 5242880
    s_branch L_hop1
    v_min_u32 v5, 6, v1
    v_lshlrev_b32 v5, 10, v5
L_light:
    buffer_load_dword v6, v5, s[48:51], s85 offen offset:512 sc1
    s_waitcnt vmcnt(0)
    v_xor_b32 v6, s35, v6
    v_and_b32 v6, 0xff, v6
    v_cmp_ne_u32 vcc, 0, v6
    s_nop 0
    s_and_b32 s36, vcc_lo, 0x7f
    s_bcnt1_i32_b32 s36, s36
    s_cmp_le_u32 s36, 7
    s_cbranch_scc1 L_hop1
    s_sleep 2
    s_sub_u32 s84, s84, 1
    s_cmp_lg_u32 s84, 0
    s_cbranch_scc1 L_light
    s_branch L_end
L_hop1:
    s_mov_b32 s93, 0x7f
    s_mov_b32 s94, 0
    v_mov_b32 v55, 0xff7f0000
    v_mov_b32 v56, 0
    v_mov_b32 v57, 0
    v_mov_b32 v58, 0
    v_mov_b32 v59, 0
    s_and_b32 s94, s94, s93
    s_cselect_b32 s94, s94, s93
    s_ff1_i32_b32 s4, s94
    s_bitset0_b32 s94, s4
    s_lshl_b32 s36, s4, 10
    s_add_u32 s36, s36, s85
    buffer_load_dwordx4 v[20:23], v92, s[48:51], s36 offen sc1
    s_and_b32 s94, s94, s93
    s_cselect_b32 s94, s94, s93
    s_ff1_i32_b32 s5, s94
    s_bitset0_b32 s94, s5
    s_lshl_b32 s36, s5, 10
    s_add_u32 s36, s36, s85
    buffer_load_dwordx4 v[24:27], v92, s[48:51], s36 offen sc1
    s_and_b32 s94, s94, s93
    s_cselect_b32 s94, s94, s93
    s_ff1_i32_b32 s6, s94
    s_bitset0_b32 s94, s6
    s_lshl_b32 s36, s6, 10
    s_add_u32 s36, s36, s85
    buffer_load_dwordx4 v[28:31], v92, s[48:51], s36 offen sc1
L_hop1poll:
    s_and_b32 s94, s94, s93
    s_cselect_b32 s94, s94, s93
    s_ff1_i32_b32 s7, s94
    s_bitset0_b32 s94, s7
    s_lshl_b32 s36, s7, 10
    s_add_u32 s36, s36, s85
    buffer_load_dwordx4 v[32:35], v92, s[48:51], s36 offen sc1
    s_waitcnt vmcnt(3)
    v_xor_b32 v20, s35, v20
    v_xor_b32 v21, s35, v21
    v_xor_b32 v22, s35, v22
    v_xor_b32 v23, s35, v23
    v_or_b32 v4, v20, v21
    v_or3_b32 v4, v4, v22, v23
    v_and_b32 v4, 0xff, v4
    v_cmp_ne_u32 vcc, 0, v4
    v_max_f32 v5, v55, v20
    s_cbranch_vccnz L_mnext_40
    s_bitcmp1_b32 s93, s4
    s_cbranch_scc0 L_mnext_40
    v_sub_f32 v52, v55, v5
    v_sub_f32 v53, v20, v5
    v_exp_f32 v52, v52
    v_exp_f32 v53, v53
    v_mov_b32 v55, v5
    s_bitset0_b32 s93, s4
    v_mul_f32_dpp v57, v52, v57 row_newbcast:8 row_mask:0xf bank_mask:0xf
    v_mul_f32_dpp v56, v52, v56 row_newbcast:8 row_mask:0xf bank_mask:0xf
    v_mul_f32_dpp v58, v52, v58 row_newbcast:8 row_mask:0xf bank_mask:0xf
    v_mul_f32_dpp v59, v52, v59 row_newbcast:8 row_mask:0xf bank_mask:0xf
    v_fmac_f32_dpp v57, v53, v21 row_newbcast:8 row_mask:0xf bank_mask:0xf
    v_fmac_f32_dpp v56, v53, v20 row_newbcast:8 row_mask:0xf bank_mask:0xf
    v_fmac_f32_dpp v58, v53, v22 row_newbcast:8 row_mask:0xf bank_mask:0xf
    v_fmac_f32_dpp v59, v53, v23 row_newbcast:8 row_mask:0xf bank_mask:0xf
    s_cmp_eq_u32 s93, 0
    s_cbranch_scc1 L_hop1ok
L_mnext_40:
    s_and_b32 s94, s94, s93
    s_cselect_b32 s94, s94, s93
    s_ff1_i32_b32 s4, s94
    s_bitset0_b32 s94, s4
    s_lshl_b32 s36, s4, 10
    s_add_u32 s36, s36, s85
    buffer_load_dwordx4 v[20:23], v92, s[48:51], s36 offen sc1
    s_waitcnt vmcnt(3)
    v_xor_b32 v24, s35, v24
    v_xor_b32 v25, s35, v25
    v_xor_b32 v26, s35, v26
    v_xor_b32 v27, s35, v27
    v_or_b32 v4, v24, v25
    v_or3_b32 v4, v4, v26, v27
    v_and_b32 v4, 0xff, v4
    v_cmp_ne_u32 vcc, 0, v4
    v_max_f32 v5, v55, v24
    s_cbranch_vccnz L_mnext_41
    s_bitcmp1_b32 s93, s5
    s_cbranch_scc0 L_mnext_41
    v_sub_f32 v52, v55, v5
    v_sub_f32 v53, v24, v5
    v_exp_f32 v52, v52
    v_exp_f32 v53, v53
    v_mov_b32 v55, v5
    s_bitset0_b32 s93, s5
    v_mul_f32_dpp v57, v52, v57 row_newbcast:8 row_mask:0xf bank_mask:0xf
    v_mul_f32_dpp v56, v52, v56 row_newbcast:8 row_mask:0xf bank_mask:0xf
    v_mul_f32_dpp v58, v52, v58 row_newbcast:8 row_mask:0xf bank_mask:0xf
    v_mul_f32_dpp v59, v52, v59 row_newbcast:8 row_mask:0xf bank_mask:0xf
    v_fmac_f32_dpp v57, v53, v25 row_newbcast:8 row_mask:0xf bank_mask:0xf
    v_fmac_f32_dpp v56, v53, v24 row_newbcast:8 row_mask:0xf bank_mask:0xf
    v_fmac_f32_dpp v58, v53, v26 row_newbcast:8 row_mask:0xf bank_mask:0xf
    v_fmac_f32_dpp v59, v53, v27 row_newbcast:8 row_mask:0xf bank_mask:0xf
    s_cmp_eq_u32 s93, 0
    s_cbranch_scc1 L_hop1ok
L_mnext_41:
    s_and_b32 s94, s94, s93
    s_cselect_b32 s94, s94, s93
    s_ff1_i32_b32 s5, s94
    s_bitset0_b32 s94, s5
    s_lshl_b32 s36, s5, 10
    s_add_u32 s36, s36, s85
    buffer_load_dwordx4 v[24:27], v92, s[48:51], s36 offen sc1
    s_waitcnt vmcnt(3)
    v_xor_b32 v28, s35, v28
    v_xor_b32 v29, s35, v29
    v_xor_b32 v30, s35, v30
    v_xor_b32 v31, s35, v31
    v_or_b32 v4, v28, v29
    v_or3_b32 v4, v4, v30, v31
    v_and_b32 v4, 0xff, v4
    v_cmp_ne_u32 vcc, 0, v4
    v_max_f32 v5, v55, v28
    s_cbranch_vccnz L_mnext_42
    s_bitcmp1_b32 s93, s6
    s_cbranch_scc0 L_mnext_42
    v_sub_f32 v52, v55, v5
    v_sub_f32 v53, v28, v5
    v_exp_f32 v52, v52
    v_exp_f32 v53, v53
    v_mov_b32 v55, v5
    s_bitset0_b32 s93, s6
    v_mul_f32_dpp v57, v52, v57 row_newbcast:8 row_mask:0xf bank_mask:0xf
    v_mul_f32_dpp v56, v52, v56 row_newbcast:8 row_mask:0xf bank_mask:0xf
    v_mul_f32_dpp v58, v52, v58 row_newbcast:8 row_mask:0xf bank_mask:0xf
    v_mul_f32_dpp v59, v52, v59 row_newbcast:8 row_mask:0xf bank_mask:0xf
    v_fmac_f32_dpp v57, v53, v29 row_newbcast:8 row_mask:0xf bank_mask:0xf
    v_fmac_f32_dpp v56, v53, v28 row_newbcast:8 row_mask:0xf bank_mask:0xf
    v_fmac_f32_dpp v58, v53, v30 row_newbcast:8 row_mask:0xf bank_mask:0xf
    v_fmac_f32_dpp v59, v53, v31 row_newbcast:8 row_mask:0xf bank_mask:0xf
    s_cmp_eq_u32 s93, 0
    s_cbranch_scc1 L_hop1ok
L_mnext_42:
    s_and_b32 s94, s94, s93
    s_cselect_b32 s94, s94, s93
    s_ff1_i32_b32 s6, s94
    s_bitset0_b32 s94, s6
    s_lshl_b32 s36, s6, 10
    s_add_u32 s36, s36, s85
    buffer_load_dwordx4 v[28:31], v92, s[48:51], s36 offen sc1
    s_waitcnt vmcnt(3)
    v_xor_b32 v32, s35, v32
    v_xor_b32 v33, s35, v33
    v_xor_b32 v34, s35, v34
    v_xor_b32 v35, s35, v35
    v_or_b32 v4, v32, v33
    v_or3_b32 v4, v4, v34, v35
    v_and_b32 v4, 0xff, v4
    v_cmp_ne_u32 vcc, 0, v4
    v_max_f32 v5, v55, v32
    s_cbranch_vccnz L_mnext_43
    s_bitcmp1_b32 s93, s7
    s_cbranch_scc0 L_mnext_43
    v_sub_f32 v52, v55, v5
    v_sub_f32 v53, v32, v5
    v_exp_f32 v52, v52
    v_exp_f32 v53, v53
    v_mov_b32 v55, v5
    s_bitset0_b32 s93, s7
    v_mul_f32_dpp v57, v52, v57 row_newbcast:8 row_mask:0xf bank_mask:0xf
    v_mul_f32_dpp v56, v52, v56 row_newbcast:8 row_mask:0xf bank_mask:0xf
    v_mul_f32_dpp v58, v52, v58 row_newbcast:8 row_mask:0xf bank_mask:0xf
    v_mul_f32_dpp v59, v52, v59 row_newbcast:8 row_mask:0xf bank_mask:0xf
    v_fmac_f32_dpp v57, v53, v33 row_newbcast:8 row_mask:0xf bank_mask:0xf
    v_fmac_f32_dpp v56, v53, v32 row_newbcast:8 row_mask:0xf bank_mask:0xf
    v_fmac_f32_dpp v58, v53, v34 row_newbcast:8 row_mask:0xf bank_mask:0xf
    v_fmac_f32_dpp v59, v53, v35 row_newbcast:8 row_mask:0xf bank_mask:0xf
    s_cmp_eq_u32 s93, 0
    s_cbranch_scc1 L_hop1ok
L_mnext_43:
    s_sub_u32 s84, s84, 1
    s_cmp_lg_u32 s84, 0
    s_cbranch_scc1 L_hop1poll
    s_branch L_end
L_hop1ok:
    v_rcp_f32 v55, v57
    s_nop 1
    v_mul_f32_dpp v56, v55, v56 row_newbcast:8 row_mask:0xf bank_mask:0xf
    v_mul_f32_dpp v57, v55, v57 row_newbcast:8 row_mask:0xf bank_mask:0xf
    v_mul_f32_dpp v58, v55, v58 row_newbcast:8 row_mask:0xf bank_mask:0xf
    v_mul_f32_dpp v59, v55, v59 row_newbcast:8 row_mask:0xf bank_mask:0xf
    v_cvt_pk_bf16_f32 v56, v56, v57
    v_cvt_pk_bf16_f32 v58, v58, v59
    s_mov_b32 exec_lo, 0xff00ff
    s_mov_b32 exec_hi, 0xff00ff
    ds_write_b16 v93, v56
    ds_write_b16_d16_hi v93, v56 offset:16
    ds_write_b16 v93, v58 offset:32
    ds_write_b16_d16_hi v93, v58 offset:48
    s_mov_b64 exec, -1
    s_branch L_final
L_prepb:
    v_xor_b32 v4, 0, v95
    ds_read_b64_tr_b16 a[0:1], v4 offset:0
    ds_read_b64_tr_b16 a[4:5], v4 offset:8192
    ds_read_b64_tr_b16 a[8:9], v4 offset:16384
    ds_read_b64_tr_b16 a[12:13], v4 offset:24576
    v_xor_b32 v5, 16, v95
    ds_read_b64_tr_b16 a[2:3], v5 offset:1024
    ds_read_b64_tr_b16 a[6:7], v5 offset:9216
    ds_read_b64_tr_b16 a[10:11], v5 offset:17408
    ds_read_b64_tr_b16 a[14:15], v5 offset:25600
    v_xor_b32 v4, 32, v95
    ds_read_b64_tr_b16 a[16:17], v4 offset:0
    ds_read_b64_tr_b16 a[20:21], v4 offset:8192
    ds_read_b64_tr_b16 a[24:25], v4 offset:16384
    ds_read_b64_tr_b16 a[28:29], v4 offset:24576
    v_xor_b32 v5, 48, v95
    ds_read_b64_tr_b16 a[18:19], v5 offset:1024
    ds_read_b64_tr_b16 a[22:23], v5 offset:9216
    ds_read_b64_tr_b16 a[26:27], v5 offset:17408
    ds_read_b64_tr_b16 a[30:31], v5 offset:25600
    v_xor_b32 v4, 64, v95
    ds_read_b64_tr_b16 a[32:33], v4 offset:0
    ds_read_b64_tr_b16 a[36:37], v4 offset:8192
    ds_read_b64_tr_b16 a[40:41], v4 offset:16384
    ds_read_b64_tr_b16 a[44:45], v4 offset:24576
    v_xor_b32 v5, 80, v95
    ds_read_b64_tr_b16 a[34:35], v5 offset:1024
    ds_read_b64_tr_b16 a[38:39], v5 offset:9216
    ds_read_b64_tr_b16 a[42:43], v5 offset:17408
    ds_read_b64_tr_b16 a[46:47], v5 offset:25600
    v_xor_b32 v4, 96, v95
    ds_read_b64_tr_b16 a[48:49], v4 offset:0
    ds_read_b64_tr_b16 a[52:53], v4 offset:8192
    ds_read_b64_tr_b16 a[56:57], v4 offset:16384
    ds_read_b64_tr_b16 a[60:61], v4 offset:24576
    v_xor_b32 v5, 112, v95
    ds_read_b64_tr_b16 a[50:51], v5 offset:1024
    ds_read_b64_tr_b16 a[54:55], v5 offset:9216
    ds_read_b64_tr_b16 a[58:59], v5 offset:17408
    ds_read_b64_tr_b16 a[62:63], v5 offset:25600
    v_xor_b32 v4, 128, v95
    ds_read_b64_tr_b16 a[64:65], v4 offset:0
    ds_read_b64_tr_b16 a[68:69], v4 offset:8192
    ds_read_b64_tr_b16 a[72:73], v4 offset:16384
    ds_read_b64_tr_b16 a[76:77], v4 offset:24576
    v_xor_b32 v5, 144, v95
    ds_read_b64_tr_b16 a[66:67], v5 offset:1024
    ds_read_b64_tr_b16 a[70:71], v5 offset:9216
    ds_read_b64_tr_b16 a[74:75], v5 offset:17408
    ds_read_b64_tr_b16 a[78:79], v5 offset:25600
    v_xor_b32 v4, 160, v95
    ds_read_b64_tr_b16 a[80:81], v4 offset:0
    ds_read_b64_tr_b16 a[84:85], v4 offset:8192
    ds_read_b64_tr_b16 a[88:89], v4 offset:16384
    ds_read_b64_tr_b16 a[92:93], v4 offset:24576
    v_xor_b32 v5, 176, v95
    ds_read_b64_tr_b16 a[82:83], v5 offset:1024
    ds_read_b64_tr_b16 a[86:87], v5 offset:9216
    ds_read_b64_tr_b16 a[90:91], v5 offset:17408
    ds_read_b64_tr_b16 a[94:95], v5 offset:25600
    v_xor_b32 v4, 192, v95
    ds_read_b64_tr_b16 a[96:97], v4 offset:0
    ds_read_b64_tr_b16 a[100:101], v4 offset:8192
    ds_read_b64_tr_b16 a[104:105], v4 offset:16384
    ds_read_b64_tr_b16 a[108:109], v4 offset:24576
    v_xor_b32 v5, 208, v95
    ds_read_b64_tr_b16 a[98:99], v5 offset:1024
    ds_read_b64_tr_b16 a[102:103], v5 offset:9216
    ds_read_b64_tr_b16 a[106:107], v5 offset:17408
    ds_read_b64_tr_b16 a[110:111], v5 offset:25600
    v_xor_b32 v4, 224, v95
    ds_read_b64_tr_b16 a[112:113], v4 offset:0
    ds_read_b64_tr_b16 a[116:117], v4 offset:8192
    ds_read_b64_tr_b16 a[120:121], v4 offset:16384
    ds_read_b64_tr_b16 a[124:125], v4 offset:24576
    v_xor_b32 v5, 240, v95
    ds_read_b64_tr_b16 a[114:115], v5 offset:1024
    ds_read_b64_tr_b16 a[118:119], v5 offset:9216
    ds_read_b64_tr_b16 a[122:123], v5 offset:17408
    ds_read_b64_tr_b16 a[126:127], v5 offset:25600
    s_waitcnt lgkmcnt(0)
    s_barrier
    s_branch L_hop2
L_fin:
    s_or_b32 s36, s32, s34
    s_cmp_lg_u32 s36, 0
    s_cbranch_scc1 L_end
    s_mov_b64 exec, 1
    buffer_store_dword v8, v100, s[48:51], 0 offen
L_end:
    s_endpgm
    .fill (32768 - (. - concat_heads__compressed_kv_cla__mha_block_cached__decode_kernel)) / 4 + 1, 4, 0xbf810000
.section .rodata,"a"
.p2align 6
.amdhsa_kernel concat_heads__compressed_kv_cla__mha_block_cached__decode_kernel
  .amdhsa_next_free_vgpr 512
  .amdhsa_next_free_sgpr 102
  .amdhsa_accum_offset 256
  .amdhsa_group_segment_fixed_size 0
  .amdhsa_kernarg_size 112
  .amdhsa_user_sgpr_count 2
  .amdhsa_user_sgpr_kernarg_segment_ptr 1
  .amdhsa_system_sgpr_workgroup_id_x 1
.end_amdhsa_kernel
```

```asm
; @launch grid=(256,1,1) block=(256,1,1) lds=163840
    .amdgcn_target "amdgcn-amd-amdhsa--gfx950"
    .text
    .globl concat_heads__compressed_kv_cla__mha_block_cached__decode_kernel
    .p2align 8
    .type concat_heads__compressed_kv_cla__mha_block_cached__decode_kernel,@function
concat_heads__compressed_kv_cla__mha_block_cached__decode_kernel:
    s_cmp_ge_u32 s2, 256
    s_cbranch_scc1 L_end
    s_load_dwordx16 s[4:19], s[0:1], 0
    s_load_dwordx8 s[20:27], s[0:1], 64
    s_load_dwordx4 s[28:31], s[0:1], 96
    v_lshrrev_b32 v4, 6, v0
    v_and_b32 v1, 63, v0
    v_readfirstlane_b32 s34, v4
    s_lshr_b32 s32, s2, 3
    s_sub_u32 s33, s2, s32
    s_sub_u32 s33, s33, 1
    s_and_b32 s33, s33, 7
    v_lshrrev_b32 v2, 4, v1
    v_and_b32 v3, 15, v1
    s_cmp_lt_u32 s33, 2
    s_cbranch_scc1 L_qp
    s_cmp_eq_u32 s33, 2
    s_cbranch_scc1 L_ql
    s_cmp_eq_u32 s33, 7
    s_cbranch_scc1 L_aux
    v_lshrrev_b32 v4, 2, v3
    v_and_b32 v5, 3, v3
    v_lshlrev_b32 v76, 8, v4
    v_lshlrev_b32 v126, 8, v2
    v_lshl_add_u32 v76, v2, 6, v76
    v_lshl_add_u32 v76, v5, 4, v76
    v_lshl_add_u32 v126, v3, 4, v126
    v_xor_b32 v77, 32768, v76
    v_xor_b32 v127, 32768, v126
    s_add_u32 s3, s34, s33
    s_and_b32 s3, s3, 3
    s_lshl_b32 s89, s3, 5
    s_add_u32 s89, s89, s32
    s_lshl_b32 s89, s89, 20
    s_mul_i32 s88, s32, 8
    s_add_u32 s88, s88, s3
    s_add_u32 s87, s33, 0
    s_mov_b32 s54, 134217728
    s_mov_b32 s55, 0x20000
    s_mov_b32 s58, 134217728
    s_mov_b32 s59, 0x20000
    s_add_u32 s39, s87, s88
    s_bfe_u32 s37, s39, 0x30000
    s_lshl_b32 s37, s37, 12
    s_add_u32 s85, s37, s89
    s_bfe_u32 s37, s39, 0x10003
    s_lshl_b32 s37, s37, 11
    s_add_u32 s85, s37, s85
    s_bfe_u32 s37, s39, 0x40004
    s_lshl_b32 s37, s37, 16
    s_add_u32 s85, s37, s85
    s_waitcnt lgkmcnt(0)
    s_mov_b64 s[52:53], s[18:19]
    s_mov_b64 s[56:57], s[20:21]
    buffer_load_dwordx4 v[128:131], v76, s[52:55], s85 offen offset:0 nt
    buffer_load_dwordx4 v[132:135], v77, s[52:55], s85 offen offset:0 nt
    buffer_load_dwordx4 v[136:139], v76, s[52:55], s85 offen offset:1024 nt
    buffer_load_dwordx4 v[140:143], v77, s[52:55], s85 offen offset:1024 nt
    s_add_u32 s87, s87, 7
    s_add_u32 s39, s87, s88
    s_bfe_u32 s37, s39, 0x30000
    s_lshl_b32 s37, s37, 12
    s_add_u32 s85, s37, s89
    s_bfe_u32 s37, s39, 0x10003
    s_lshl_b32 s37, s37, 11
    s_add_u32 s85, s37, s85
    s_bfe_u32 s37, s39, 0x40004
    s_lshl_b32 s37, s37, 16
    s_add_u32 s85, s37, s85
    buffer_load_dwordx4 v[144:147], v76, s[52:55], s85 offen offset:0 nt
    buffer_load_dwordx4 v[148:151], v77, s[52:55], s85 offen offset:0 nt
    buffer_load_dwordx4 v[152:155], v76, s[52:55], s85 offen offset:1024 nt
    s_getpc_b64 s[36:37]
L_pc_1:
    s_sub_u32 s36, s36, L_pc_1 - concat_heads__compressed_kv_cla__mha_block_cached__decode_kernel
    s_subb_u32 s37, s37, 0
    s_lshl_b32 s38, s32, 10
    v_lshl_add_u32 v6, v0, 2, s38
    v_mov_b32 v7, s37
    v_add_co_u32 v6, vcc, s36, v6
    s_nop 1
    v_addc_co_u32 v7, vcc, 0, v7, vcc
    global_load_dword v0, v[6:7], off
    s_load_dword s35, s[30:31], 0
    s_mov_b32 s48, s30
    s_and_b32 s49, s31, 0xffff
    s_mov_b32 s50, 8388608
    s_mov_b32 s51, 0x20000
    s_mov_b32 s82, 0xffffff00
    s_mov_b32 s83, 0x3e0293ee
    s_mov_b32 s84, 2097152
    s_waitcnt vmcnt(7)
    buffer_load_dwordx4 v[156:159], v77, s[52:55], s85 offen offset:1024 nt
    s_add_u32 s87, s87, 7
    s_add_u32 s39, s87, s88
    s_bfe_u32 s37, s39, 0x30000
    s_lshl_b32 s37, s37, 12
    s_add_u32 s85, s37, s89
    s_bfe_u32 s37, s39, 0x10003
    s_lshl_b32 s37, s37, 11
    s_add_u32 s85, s37, s85
    s_bfe_u32 s37, s39, 0x40004
    s_lshl_b32 s37, s37, 16
    s_add_u32 s85, s37, s85
    s_waitcnt vmcnt(7)
    buffer_load_dwordx4 v[160:163], v76, s[52:55], s85 offen offset:0 nt
    s_waitcnt vmcnt(7)
    buffer_load_dwordx4 v[164:167], v77, s[52:55], s85 offen offset:0 nt
    s_waitcnt vmcnt(7)
    buffer_load_dwordx4 v[168:171], v76, s[52:55], s85 offen offset:1024 nt
    v_and_b32 v4, 1, v1
    v_lshlrev_b32 v4, 4, v4
    v_mov_b32 v5, 0xffff
    v_lshlrev_b32 v4, v4, v5
    v_bfe_u32 v5, v1, 1, 2
    v_cmp_eq_u32 vcc, 0, v5
    s_nop 1
    v_cndmask_b32 v10, 0, v4, vcc
    v_cmp_eq_u32 vcc, 1, v5
    s_nop 1
    v_cndmask_b32 v11, 0, v4, vcc
    v_cmp_eq_u32 vcc, 2, v5
    s_nop 1
    v_cndmask_b32 v12, 0, v4, vcc
    v_cmp_eq_u32 vcc, 3, v5
    s_nop 1
    v_cndmask_b32 v13, 0, v4, vcc
    s_waitcnt vmcnt(7)
    buffer_load_dwordx4 v[172:175], v77, s[52:55], s85 offen offset:1024 nt
    s_add_u32 s87, s87, 7
    s_add_u32 s39, s87, s88
    s_bfe_u32 s37, s39, 0x30000
    s_lshl_b32 s37, s37, 12
    s_add_u32 s85, s37, s89
    s_bfe_u32 s37, s39, 0x10003
    s_lshl_b32 s37, s37, 11
    s_add_u32 s85, s37, s85
    s_bfe_u32 s37, s39, 0x40004
    s_lshl_b32 s37, s37, 16
    s_add_u32 s85, s37, s85
    s_waitcnt vmcnt(7)
    buffer_load_dwordx4 v[176:179], v76, s[52:55], s85 offen offset:0 nt
    s_waitcnt vmcnt(7)
    buffer_load_dwordx4 v[180:183], v77, s[52:55], s85 offen offset:0 nt
    s_waitcnt vmcnt(6)
    buffer_load_dwordx4 v[184:187], v76, s[52:55], s85 offen offset:1024 nt
    v_mov_b32 v120, 0xff7f0000
    v_mov_b32 v121, 0
    v_mov_b32 v18, 1
    v_mov_b32 v116, 0
    v_mov_b32 v117, 0
    v_mov_b32 v118, 0
    v_mov_b32 v119, 0
    s_lshl_b32 s38, s32, 2
    s_add_u32 s38, s38, s3
    s_lshl_b32 s96, s38, 3
    s_lshl_b32 s38, s38, 8
    s_add_u32 s38, s38, 65536
    v_mov_b32 v9, s38
    s_add_u32 s96, s96, s33
    s_lshl_b32 s96, s96, 10
    s_add_u32 s96, s96, 5242880
    v_and_b32 v5, 3, v3
    v_lshlrev_b32 v78, 7, v2
    v_lshl_add_u32 v78, v5, 5, v78
    s_lshl_b32 s91, s32, 12
    s_lshl_b32 s38, s3, 9
    s_add_u32 s91, s91, s38
    s_add_u32 s91, s91, 1048576
    v_lshlrev_b32 v4, 7, v2
    v_lshl_add_u32 v4, v3, 4, v4
    v_mov_b32 v5, 512
    v_cmp_gt_u32 vcc, 8, v3
    s_nop 1
    v_cndmask_b32 v79, v5, v4, vcc
    s_waitcnt vmcnt(6)
    buffer_load_dwordx4 v[188:191], v77, s[52:55], s85 offen offset:1024 nt
    s_add_u32 s87, s87, 7
    s_add_u32 s39, s87, s88
    s_bfe_u32 s37, s39, 0x30000
    s_lshl_b32 s37, s37, 12
    s_add_u32 s85, s37, s89
    s_bfe_u32 s37, s39, 0x10003
    s_lshl_b32 s37, s37, 11
    s_add_u32 s85, s37, s85
    s_bfe_u32 s37, s39, 0x40004
    s_lshl_b32 s37, s37, 16
    s_add_u32 s85, s37, s85
    s_waitcnt vmcnt(6)
    buffer_load_dwordx4 v[192:195], v76, s[52:55], s85 offen offset:0 nt
    s_waitcnt vmcnt(6)
    buffer_load_dwordx4 v[196:199], v77, s[52:55], s85 offen offset:0 nt
    s_waitcnt vmcnt(6)
    buffer_load_dwordx4 v[200:203], v76, s[52:55], s85 offen offset:1024 nt
    s_waitcnt vmcnt(6)
    buffer_load_dwordx4 v[204:207], v77, s[52:55], s85 offen offset:1024 nt
    s_add_u32 s87, s87, 7
    s_add_u32 s39, s87, s88
    s_bfe_u32 s37, s39, 0x30000
    s_lshl_b32 s37, s37, 12
    s_add_u32 s85, s37, s89
    s_bfe_u32 s37, s39, 0x10003
    s_lshl_b32 s37, s37, 11
    s_add_u32 s85, s37, s85
    s_bfe_u32 s37, s39, 0x40004
    s_lshl_b32 s37, s37, 16
    s_add_u32 s85, s37, s85
    s_waitcnt vmcnt(6)
    buffer_load_dwordx4 v[208:211], v76, s[52:55], s85 offen offset:0 nt
    s_waitcnt vmcnt(6)
    buffer_load_dwordx4 v[212:215], v77, s[52:55], s85 offen offset:0 nt
    s_waitcnt vmcnt(6)
    buffer_load_dwordx4 v[216:219], v76, s[52:55], s85 offen offset:1024 nt
    s_waitcnt vmcnt(6)
    buffer_load_dwordx4 v[220:223], v77, s[52:55], s85 offen offset:1024 nt
    s_add_u32 s87, s87, 7
    s_add_u32 s39, s87, s88
    s_bfe_u32 s37, s39, 0x30000
    s_lshl_b32 s37, s37, 12
    s_add_u32 s85, s37, s89
    s_bfe_u32 s37, s39, 0x10003
    s_lshl_b32 s37, s37, 11
    s_add_u32 s85, s37, s85
    s_bfe_u32 s37, s39, 0x40004
    s_lshl_b32 s37, s37, 16
    s_add_u32 s85, s37, s85
    s_waitcnt vmcnt(6)
    buffer_load_dwordx4 v[224:227], v76, s[52:55], s85 offen offset:0 nt
    s_waitcnt vmcnt(6)
    buffer_load_dwordx4 v[228:231], v77, s[52:55], s85 offen offset:0 nt
    s_waitcnt vmcnt(6)
    buffer_load_dwordx4 v[232:235], v76, s[52:55], s85 offen offset:1024 nt
    s_waitcnt vmcnt(6)
    buffer_load_dwordx4 v[236:239], v77, s[52:55], s85 offen offset:1024 nt
    s_add_u32 s87, s87, 7
    s_add_u32 s39, s87, s88
    s_bfe_u32 s37, s39, 0x30000
    s_lshl_b32 s37, s37, 12
    s_add_u32 s85, s37, s89
    s_bfe_u32 s37, s39, 0x10003
    s_lshl_b32 s37, s37, 11
    s_add_u32 s85, s37, s85
    s_bfe_u32 s37, s39, 0x40004
    s_lshl_b32 s37, s37, 16
    s_add_u32 s85, s37, s85
    s_waitcnt vmcnt(6)
    buffer_load_dwordx4 v[240:243], v76, s[52:55], s85 offen offset:0 nt
    s_waitcnt vmcnt(6)
    buffer_load_dwordx4 v[244:247], v77, s[52:55], s85 offen offset:0 nt
    s_waitcnt vmcnt(6)
    buffer_load_dwordx4 v[248:251], v76, s[52:55], s85 offen offset:1024 nt
    s_waitcnt vmcnt(6)
    buffer_load_dwordx4 v[252:255], v77, s[52:55], s85 offen offset:1024 nt
    s_add_u32 s87, s87, 7
    s_add_u32 s39, s87, s88
    s_bfe_u32 s37, s39, 0x30000
    s_lshl_b32 s37, s37, 12
    s_add_u32 s85, s37, s89
    s_bfe_u32 s37, s39, 0x10003
    s_lshl_b32 s37, s37, 11
    s_add_u32 s85, s37, s85
    s_bfe_u32 s37, s39, 0x40004
    s_lshl_b32 s37, s37, 16
    s_add_u32 s85, s37, s85
    s_waitcnt vmcnt(6)
    buffer_load_dwordx4 a[0:3], v76, s[52:55], s85 offen offset:0 nt
    s_waitcnt vmcnt(6)
    buffer_load_dwordx4 a[4:7], v77, s[52:55], s85 offen offset:0 nt
    s_waitcnt vmcnt(6)
    buffer_load_dwordx4 a[8:11], v76, s[52:55], s85 offen offset:1024 nt
    s_waitcnt vmcnt(6)
    buffer_load_dwordx4 a[12:15], v77, s[52:55], s85 offen offset:1024 nt
    s_add_u32 s87, s87, 7
    s_add_u32 s39, s87, s88
    s_bfe_u32 s37, s39, 0x30000
    s_lshl_b32 s37, s37, 12
    s_add_u32 s85, s37, s89
    s_bfe_u32 s37, s39, 0x10003
    s_lshl_b32 s37, s37, 11
    s_add_u32 s85, s37, s85
    s_bfe_u32 s37, s39, 0x40004
    s_lshl_b32 s37, s37, 16
    s_add_u32 s85, s37, s85
    s_waitcnt vmcnt(6)
    buffer_load_dwordx4 a[16:19], v76, s[52:55], s85 offen offset:0 nt
    s_waitcnt vmcnt(6)
    buffer_load_dwordx4 a[20:23], v77, s[52:55], s85 offen offset:0 nt
    s_waitcnt vmcnt(6)
    buffer_load_dwordx4 a[24:27], v76, s[52:55], s85 offen offset:1024 nt
    s_waitcnt vmcnt(6)
    buffer_load_dwordx4 a[28:31], v77, s[52:55], s85 offen offset:1024 nt
    s_add_u32 s87, s87, 7
    s_add_u32 s39, s87, s88
    s_bfe_u32 s37, s39, 0x30000
    s_lshl_b32 s37, s37, 12
    s_add_u32 s85, s37, s89
    s_bfe_u32 s37, s39, 0x10003
    s_lshl_b32 s37, s37, 11
    s_add_u32 s85, s37, s85
    s_bfe_u32 s37, s39, 0x40004
    s_lshl_b32 s37, s37, 16
    s_add_u32 s85, s37, s85
    s_waitcnt vmcnt(6)
    buffer_load_dwordx4 a[32:35], v76, s[52:55], s85 offen offset:0 nt
    s_waitcnt vmcnt(6)
    buffer_load_dwordx4 a[36:39], v77, s[52:55], s85 offen offset:0 nt
    s_waitcnt vmcnt(6)
    buffer_load_dwordx4 a[40:43], v76, s[52:55], s85 offen offset:1024 nt
    s_waitcnt vmcnt(6)
    buffer_load_dwordx4 a[44:47], v77, s[52:55], s85 offen offset:1024 nt
    s_add_u32 s87, s87, 7
    s_add_u32 s39, s87, s88
    s_bfe_u32 s37, s39, 0x30000
    s_lshl_b32 s37, s37, 12
    s_add_u32 s85, s37, s89
    s_bfe_u32 s37, s39, 0x10003
    s_lshl_b32 s37, s37, 11
    s_add_u32 s85, s37, s85
    s_bfe_u32 s37, s39, 0x40004
    s_lshl_b32 s37, s37, 16
    s_add_u32 s85, s37, s85
    s_waitcnt vmcnt(6)
    buffer_load_dwordx4 a[48:51], v76, s[52:55], s85 offen offset:0 nt
    s_waitcnt vmcnt(6)
    buffer_load_dwordx4 a[52:55], v77, s[52:55], s85 offen offset:0 nt
    s_waitcnt vmcnt(6)
    buffer_load_dwordx4 a[56:59], v76, s[52:55], s85 offen offset:1024 nt
    s_waitcnt vmcnt(6)
    buffer_load_dwordx4 a[60:63], v77, s[52:55], s85 offen offset:1024 nt
    s_add_u32 s87, s87, 7
    s_add_u32 s39, s87, s88
    s_bfe_u32 s37, s39, 0x30000
    s_lshl_b32 s37, s37, 12
    s_add_u32 s85, s37, s89
    s_bfe_u32 s37, s39, 0x10003
    s_lshl_b32 s37, s37, 11
    s_add_u32 s85, s37, s85
    s_bfe_u32 s37, s39, 0x40004
    s_lshl_b32 s37, s37, 16
    s_add_u32 s85, s37, s85
    s_waitcnt vmcnt(6)
    buffer_load_dwordx4 a[64:67], v76, s[52:55], s85 offen offset:0 nt
    s_waitcnt vmcnt(6)
    buffer_load_dwordx4 a[68:71], v77, s[52:55], s85 offen offset:0 nt
    s_waitcnt vmcnt(6)
    buffer_load_dwordx4 a[72:75], v76, s[52:55], s85 offen offset:1024 nt
    s_waitcnt vmcnt(6)
    buffer_load_dwordx4 a[76:79], v77, s[52:55], s85 offen offset:1024 nt
    s_add_u32 s87, s87, 7
    s_add_u32 s39, s87, s88
    s_bfe_u32 s37, s39, 0x30000
    s_lshl_b32 s37, s37, 12
    s_add_u32 s85, s37, s89
    s_bfe_u32 s37, s39, 0x10003
    s_lshl_b32 s37, s37, 11
    s_add_u32 s85, s37, s85
    s_bfe_u32 s37, s39, 0x40004
    s_lshl_b32 s37, s37, 16
    s_add_u32 s85, s37, s85
    buffer_load_dwordx4 v[68:71], v78, s[48:51], s91 offen offset:0 sc1
    buffer_load_dwordx4 v[72:75], v78, s[48:51], s91 offen offset:16 sc1
    s_waitcnt vmcnt(8)
    buffer_load_dwordx4 a[80:83], v76, s[52:55], s85 offen offset:0 nt
    s_waitcnt vmcnt(8)
    buffer_load_dwordx4 a[84:87], v77, s[52:55], s85 offen offset:0 nt
    s_waitcnt vmcnt(8)
    buffer_load_dwordx4 a[88:91], v76, s[52:55], s85 offen offset:1024 nt
    s_waitcnt vmcnt(8)
    buffer_load_dwordx4 a[92:95], v77, s[52:55], s85 offen offset:1024 nt
    s_add_u32 s87, s87, 7
    s_add_u32 s39, s87, s88
    s_bfe_u32 s37, s39, 0x30000
    s_lshl_b32 s37, s37, 12
    s_add_u32 s85, s37, s89
    s_bfe_u32 s37, s39, 0x10003
    s_lshl_b32 s37, s37, 11
    s_add_u32 s85, s37, s85
    s_bfe_u32 s37, s39, 0x40004
    s_lshl_b32 s37, s37, 16
    s_add_u32 s85, s37, s85
    s_waitcnt vmcnt(8)
    buffer_load_dwordx4 a[96:99], v76, s[52:55], s85 offen offset:0 nt
    s_waitcnt vmcnt(8)
    buffer_load_dwordx4 a[100:103], v77, s[52:55], s85 offen offset:0 nt
    s_waitcnt lgkmcnt(0)
    s_add_u32 s35, s35, 0x5b
    s_and_b32 s35, s35, 0xff
    v_mov_b32 v8, s35
    s_waitcnt vmcnt(6)
L_qcheck_2:
    v_xor_b32 v68, s35, v68
    v_xor_b32 v69, s35, v69
    v_xor_b32 v70, s35, v70
    v_xor_b32 v71, s35, v71
    v_xor_b32 v72, s35, v72
    v_xor_b32 v73, s35, v73
    v_xor_b32 v74, s35, v74
    v_xor_b32 v75, s35, v75
    v_or_b32 v4, v68, v69
    v_or3_b32 v4, v4, v70, v71
    v_or3_b32 v4, v4, v72, v73
    v_or3_b32 v4, v4, v74, v75
    v_and_b32 v4, 0xff, v4
    v_cmp_ne_u32 vcc, 0, v4
    s_cbranch_vccz L_qok_3
    buffer_load_dwordx4 v[68:71], v78, s[48:51], s91 offen offset:0 sc1
    buffer_load_dwordx4 v[72:75], v78, s[48:51], s91 offen offset:16 sc1
    s_waitcnt vmcnt(0)
    s_sub_u32 s84, s84, 1
    s_cmp_lg_u32 s84, 0
    s_cbranch_scc1 L_qcheck_2
    s_branch L_end
L_qok_3:
    v_cvt_pk_bf16_f32 v68, v68, v69
    v_cvt_pk_bf16_f32 v69, v70, v71
    v_cvt_pk_bf16_f32 v70, v72, v73
    v_cvt_pk_bf16_f32 v71, v74, v75
    s_mov_b32 vcc_lo, 0xf000f
    s_mov_b32 vcc_hi, 0xf000f
    v_cndmask_b32 v80, 0, v68, vcc
    v_cndmask_b32 v81, 0, v69, vcc
    v_cndmask_b32 v82, 0, v70, vcc
    v_cndmask_b32 v83, 0, v71, vcc
    s_mov_b32 vcc_lo, 0xf000f0
    s_mov_b32 vcc_hi, 0xf000f0
    v_cndmask_b32 v84, 0, v68, vcc
    v_cndmask_b32 v85, 0, v69, vcc
    v_cndmask_b32 v86, 0, v70, vcc
    v_cndmask_b32 v87, 0, v71, vcc
    s_mov_b32 vcc_lo, 0xf000f00
    s_mov_b32 vcc_hi, 0xf000f00
    v_cndmask_b32 v88, 0, v68, vcc
    v_cndmask_b32 v89, 0, v69, vcc
    v_cndmask_b32 v90, 0, v70, vcc
    v_cndmask_b32 v91, 0, v71, vcc
    s_mov_b32 vcc_lo, 0xf000f000
    s_mov_b32 vcc_hi, 0xf000f000
    v_cndmask_b32 v92, 0, v68, vcc
    v_cndmask_b32 v93, 0, v69, vcc
    v_cndmask_b32 v94, 0, v70, vcc
    v_cndmask_b32 v95, 0, v71, vcc
    v_mov_b32 v65, 0xff7f0000
    s_lshl_b32 s38, s34, 14
    s_add_u32 s38, s38, 16384
    v_lshl_add_u32 v64, v1, 2, s38
    buffer_load_dwordx4 a[104:107], v76, s[52:55], s85 offen offset:1024 nt
    v_mfma_f32_16x16x32_bf16 v[112:115], v[128:131], v[80:83], 0
    v_mfma_f32_16x16x32_bf16 v[112:115], v[132:135], v[84:87], v[112:115]
    v_mfma_f32_16x16x32_bf16 v[112:115], v[136:139], v[88:91], v[112:115]
    v_mfma_f32_16x16x32_bf16 v[112:115], v[140:143], v[92:95], v[112:115]
    v_mfma_f32_16x16x32_bf16 v[96:99], v[144:147], v[80:83], 0
    s_waitcnt vmcnt(6)
    buffer_load_dwordx4 a[108:111], v77, s[52:55], s85 offen offset:1024 nt
    s_add_u32 s87, s87, 7
    s_add_u32 s39, s87, s88
    s_bfe_u32 s37, s39, 0x30000
    s_lshl_b32 s37, s37, 12
    s_add_u32 s85, s37, s89
    s_bfe_u32 s37, s39, 0x10003
    s_lshl_b32 s37, s37, 11
    s_add_u32 s85, s37, s85
    s_bfe_u32 s37, s39, 0x40004
    s_lshl_b32 s37, s37, 16
    s_add_u32 s85, s37, s85
    v_mfma_f32_16x16x32_bf16 v[96:99], v[148:151], v[84:87], v[96:99]
    v_mfma_f32_16x16x32_bf16 v[96:99], v[152:155], v[88:91], v[96:99]
    v_mov_b32_dpp v122, v112 quad_perm:[0,0,0,0] row_mask:0xf bank_mask:0xf
    v_mov_b32_dpp v124, v114 quad_perm:[2,2,2,2] row_mask:0xf bank_mask:0xf
    s_nop 0
    v_add_f32_dpp v122, v113, v122 quad_perm:[1,1,1,1] row_mask:0xf bank_mask:0xf
    v_add_f32_dpp v124, v115, v124 quad_perm:[3,3,3,3] row_mask:0xf bank_mask:0xf
    v_add_f32 v122, v122, v124
    v_max_f32 v65, v65, v122
    ds_write_b32 v64, v122 offset:0
    v_mfma_f32_16x16x32_bf16 v[96:99], v[156:159], v[92:95], v[96:99]
    v_mfma_f32_16x16x32_bf16 v[112:115], v[160:163], v[80:83], 0
    v_mfma_f32_16x16x32_bf16 v[112:115], v[164:167], v[84:87], v[112:115]
    v_mfma_f32_16x16x32_bf16 v[112:115], v[168:171], v[88:91], v[112:115]
    s_nop 4
    v_mov_b32_dpp v122, v96 quad_perm:[0,0,0,0] row_mask:0xf bank_mask:0xf
    v_mov_b32_dpp v124, v98 quad_perm:[2,2,2,2] row_mask:0xf bank_mask:0xf
    s_nop 0
    v_add_f32_dpp v122, v97, v122 quad_perm:[1,1,1,1] row_mask:0xf bank_mask:0xf
    v_add_f32_dpp v124, v99, v124 quad_perm:[3,3,3,3] row_mask:0xf bank_mask:0xf
    v_add_f32 v122, v122, v124
    v_max_f32 v65, v65, v122
    ds_write_b32 v64, v122 offset:256
    s_waitcnt vmcnt(6)
    buffer_load_dwordx4 a[112:115], v76, s[52:55], s85 offen offset:0 nt
    v_mfma_f32_16x16x32_bf16 v[112:115], v[172:175], v[92:95], v[112:115]
    v_mfma_f32_16x16x32_bf16 v[96:99], v[176:179], v[80:83], 0
    v_mfma_f32_16x16x32_bf16 v[96:99], v[180:183], v[84:87], v[96:99]
    v_mfma_f32_16x16x32_bf16 v[96:99], v[184:187], v[88:91], v[96:99]
    s_nop 4
    v_mov_b32_dpp v122, v112 quad_perm:[0,0,0,0] row_mask:0xf bank_mask:0xf
    v_mov_b32_dpp v124, v114 quad_perm:[2,2,2,2] row_mask:0xf bank_mask:0xf
    s_nop 0
    v_add_f32_dpp v122, v113, v122 quad_perm:[1,1,1,1] row_mask:0xf bank_mask:0xf
    v_add_f32_dpp v124, v115, v124 quad_perm:[3,3,3,3] row_mask:0xf bank_mask:0xf
    v_add_f32 v122, v122, v124
    v_max_f32 v65, v65, v122
    ds_write_b32 v64, v122 offset:512
    v_mfma_f32_16x16x32_bf16 v[96:99], v[188:191], v[92:95], v[96:99]
    v_mfma_f32_16x16x32_bf16 v[112:115], v[192:195], v[80:83], 0
    s_waitcnt vmcnt(6)
    buffer_load_dwordx4 a[116:119], v77, s[52:55], s85 offen offset:0 nt
    v_mfma_f32_16x16x32_bf16 v[112:115], v[196:199], v[84:87], v[112:115]
    v_mfma_f32_16x16x32_bf16 v[112:115], v[200:203], v[88:91], v[112:115]
    s_nop 2
    v_mov_b32_dpp v122, v96 quad_perm:[0,0,0,0] row_mask:0xf bank_mask:0xf
    v_mov_b32_dpp v124, v98 quad_perm:[2,2,2,2] row_mask:0xf bank_mask:0xf
    s_nop 0
    v_add_f32_dpp v122, v97, v122 quad_perm:[1,1,1,1] row_mask:0xf bank_mask:0xf
    v_add_f32_dpp v124, v99, v124 quad_perm:[3,3,3,3] row_mask:0xf bank_mask:0xf
    v_add_f32 v122, v122, v124
    v_max_f32 v65, v65, v122
    ds_write_b32 v64, v122 offset:768
    v_mfma_f32_16x16x32_bf16 v[112:115], v[204:207], v[92:95], v[112:115]
    v_mfma_f32_16x16x32_bf16 v[96:99], v[208:211], v[80:83], 0
    v_mfma_f32_16x16x32_bf16 v[96:99], v[212:215], v[84:87], v[96:99]
    v_mfma_f32_16x16x32_bf16 v[96:99], v[216:219], v[88:91], v[96:99]
    s_nop 4
    v_mov_b32_dpp v122, v112 quad_perm:[0,0,0,0] row_mask:0xf bank_mask:0xf
    v_mov_b32_dpp v124, v114 quad_perm:[2,2,2,2] row_mask:0xf bank_mask:0xf
    s_nop 0
    v_add_f32_dpp v122, v113, v122 quad_perm:[1,1,1,1] row_mask:0xf bank_mask:0xf
    v_add_f32_dpp v124, v115, v124 quad_perm:[3,3,3,3] row_mask:0xf bank_mask:0xf
    v_add_f32 v122, v122, v124
    v_max_f32 v65, v65, v122
    ds_write_b32 v64, v122 offset:1024
    s_waitcnt vmcnt(6)
    buffer_load_dwordx4 a[120:123], v76, s[52:55], s85 offen offset:1024 nt
    v_mfma_f32_16x16x32_bf16 v[96:99], v[220:223], v[92:95], v[96:99]
    v_mfma_f32_16x16x32_bf16 v[112:115], v[224:227], v[80:83], 0
    v_mfma_f32_16x16x32_bf16 v[112:115], v[228:231], v[84:87], v[112:115]
    v_mfma_f32_16x16x32_bf16 v[112:115], v[232:235], v[88:91], v[112:115]
    s_nop 4
    v_mov_b32_dpp v122, v96 quad_perm:[0,0,0,0] row_mask:0xf bank_mask:0xf
    v_mov_b32_dpp v124, v98 quad_perm:[2,2,2,2] row_mask:0xf bank_mask:0xf
    s_nop 0
    v_add_f32_dpp v122, v97, v122 quad_perm:[1,1,1,1] row_mask:0xf bank_mask:0xf
    v_add_f32_dpp v124, v99, v124 quad_perm:[3,3,3,3] row_mask:0xf bank_mask:0xf
    v_add_f32 v122, v122, v124
    v_max_f32 v65, v65, v122
    ds_write_b32 v64, v122 offset:1280
    v_mfma_f32_16x16x32_bf16 v[112:115], v[236:239], v[92:95], v[112:115]
    v_mfma_f32_16x16x32_bf16 v[96:99], v[240:243], v[80:83], 0
    s_waitcnt vmcnt(6)
    buffer_load_dwordx4 a[124:127], v77, s[52:55], s85 offen offset:1024 nt
    s_add_u32 s87, s87, 7
    s_add_u32 s39, s87, s88
    s_bfe_u32 s37, s39, 0x30000
    s_lshl_b32 s37, s37, 12
    s_add_u32 s85, s37, s89
    s_bfe_u32 s37, s39, 0x10003
    s_lshl_b32 s37, s37, 11
    s_add_u32 s85, s37, s85
    s_bfe_u32 s37, s39, 0x40004
    s_lshl_b32 s37, s37, 16
    s_add_u32 s85, s37, s85
    v_mfma_f32_16x16x32_bf16 v[96:99], v[244:247], v[84:87], v[96:99]
    v_mfma_f32_16x16x32_bf16 v[96:99], v[248:251], v[88:91], v[96:99]
    v_mov_b32_dpp v122, v112 quad_perm:[0,0,0,0] row_mask:0xf bank_mask:0xf
    v_mov_b32_dpp v124, v114 quad_perm:[2,2,2,2] row_mask:0xf bank_mask:0xf
    s_nop 0
    v_add_f32_dpp v122, v113, v122 quad_perm:[1,1,1,1] row_mask:0xf bank_mask:0xf
    v_add_f32_dpp v124, v115, v124 quad_perm:[3,3,3,3] row_mask:0xf bank_mask:0xf
    v_add_f32 v122, v122, v124
    v_max_f32 v65, v65, v122
    ds_write_b32 v64, v122 offset:1536
    v_mfma_f32_16x16x32_bf16 v[96:99], v[252:255], v[92:95], v[96:99]
    v_mfma_f32_16x16x32_bf16 v[112:115], a[0:3], v[80:83], 0
    v_mfma_f32_16x16x32_bf16 v[112:115], a[4:7], v[84:87], v[112:115]
    s_waitcnt vmcnt(5)
    buffer_load_dwordx4 v[128:131], v76, s[52:55], s85 offen offset:0 nt
    v_mfma_f32_16x16x32_bf16 v[112:115], a[8:11], v[88:91], v[112:115]
    s_nop 2
    v_mov_b32_dpp v122, v96 quad_perm:[0,0,0,0] row_mask:0xf bank_mask:0xf
    v_mov_b32_dpp v124, v98 quad_perm:[2,2,2,2] row_mask:0xf bank_mask:0xf
    s_nop 0
    v_add_f32_dpp v122, v97, v122 quad_perm:[1,1,1,1] row_mask:0xf bank_mask:0xf
    v_add_f32_dpp v124, v99, v124 quad_perm:[3,3,3,3] row_mask:0xf bank_mask:0xf
    v_add_f32 v122, v122, v124
    v_max_f32 v65, v65, v122
    ds_write_b32 v64, v122 offset:1792
    v_mfma_f32_16x16x32_bf16 v[112:115], a[12:15], v[92:95], v[112:115]
    v_mfma_f32_16x16x32_bf16 v[96:99], a[16:19], v[80:83], 0
    v_mfma_f32_16x16x32_bf16 v[96:99], a[20:23], v[84:87], v[96:99]
    v_mfma_f32_16x16x32_bf16 v[96:99], a[24:27], v[88:91], v[96:99]
    s_nop 4
    v_mov_b32_dpp v122, v112 quad_perm:[0,0,0,0] row_mask:0xf bank_mask:0xf
    v_mov_b32_dpp v124, v114 quad_perm:[2,2,2,2] row_mask:0xf bank_mask:0xf
    s_nop 0
    v_add_f32_dpp v122, v113, v122 quad_perm:[1,1,1,1] row_mask:0xf bank_mask:0xf
    v_add_f32_dpp v124, v115, v124 quad_perm:[3,3,3,3] row_mask:0xf bank_mask:0xf
    v_add_f32 v122, v122, v124
    v_max_f32 v65, v65, v122
    ds_write_b32 v64, v122 offset:2048
    v_mfma_f32_16x16x32_bf16 v[96:99], a[28:31], v[92:95], v[96:99]
    s_waitcnt vmcnt(5)
    buffer_load_dwordx4 v[132:135], v77, s[52:55], s85 offen offset:0 nt
    v_mfma_f32_16x16x32_bf16 v[112:115], a[32:35], v[80:83], 0
    v_mfma_f32_16x16x32_bf16 v[112:115], a[36:39], v[84:87], v[112:115]
    v_mfma_f32_16x16x32_bf16 v[112:115], a[40:43], v[88:91], v[112:115]
    s_nop 2
    v_mov_b32_dpp v122, v96 quad_perm:[0,0,0,0] row_mask:0xf bank_mask:0xf
    v_mov_b32_dpp v124, v98 quad_perm:[2,2,2,2] row_mask:0xf bank_mask:0xf
    s_nop 0
    v_add_f32_dpp v122, v97, v122 quad_perm:[1,1,1,1] row_mask:0xf bank_mask:0xf
    v_add_f32_dpp v124, v99, v124 quad_perm:[3,3,3,3] row_mask:0xf bank_mask:0xf
    v_add_f32 v122, v122, v124
    v_max_f32 v65, v65, v122
    ds_write_b32 v64, v122 offset:2304
    v_mfma_f32_16x16x32_bf16 v[112:115], a[44:47], v[92:95], v[112:115]
    v_mfma_f32_16x16x32_bf16 v[96:99], a[48:51], v[80:83], 0
    v_mfma_f32_16x16x32_bf16 v[96:99], a[52:55], v[84:87], v[96:99]
    s_waitcnt vmcnt(5)
    buffer_load_dwordx4 v[136:139], v76, s[52:55], s85 offen offset:1024 nt
    v_mfma_f32_16x16x32_bf16 v[96:99], a[56:59], v[88:91], v[96:99]
    s_nop 2
    v_mov_b32_dpp v122, v112 quad_perm:[0,0,0,0] row_mask:0xf bank_mask:0xf
    v_mov_b32_dpp v124, v114 quad_perm:[2,2,2,2] row_mask:0xf bank_mask:0xf
    s_nop 0
    v_add_f32_dpp v122, v113, v122 quad_perm:[1,1,1,1] row_mask:0xf bank_mask:0xf
    v_add_f32_dpp v124, v115, v124 quad_perm:[3,3,3,3] row_mask:0xf bank_mask:0xf
    v_add_f32 v122, v122, v124
    v_max_f32 v65, v65, v122
    ds_write_b32 v64, v122 offset:2560
    v_mfma_f32_16x16x32_bf16 v[96:99], a[60:63], v[92:95], v[96:99]
    v_mfma_f32_16x16x32_bf16 v[112:115], a[64:67], v[80:83], 0
    v_mfma_f32_16x16x32_bf16 v[112:115], a[68:71], v[84:87], v[112:115]
    v_mfma_f32_16x16x32_bf16 v[112:115], a[72:75], v[88:91], v[112:115]
    s_nop 4
    v_mov_b32_dpp v122, v96 quad_perm:[0,0,0,0] row_mask:0xf bank_mask:0xf
    v_mov_b32_dpp v124, v98 quad_perm:[2,2,2,2] row_mask:0xf bank_mask:0xf
    s_nop 0
    v_add_f32_dpp v122, v97, v122 quad_perm:[1,1,1,1] row_mask:0xf bank_mask:0xf
    v_add_f32_dpp v124, v99, v124 quad_perm:[3,3,3,3] row_mask:0xf bank_mask:0xf
    v_add_f32 v122, v122, v124
    v_max_f32 v65, v65, v122
    ds_write_b32 v64, v122 offset:2816
    v_mfma_f32_16x16x32_bf16 v[112:115], a[76:79], v[92:95], v[112:115]
    s_waitcnt vmcnt(5)
    buffer_load_dwordx4 v[140:143], v77, s[52:55], s85 offen offset:1024 nt
    s_add_u32 s87, s87, 7
    s_add_u32 s39, s87, s88
    s_bfe_u32 s37, s39, 0x30000
    s_lshl_b32 s37, s37, 12
    s_add_u32 s85, s37, s89
    s_bfe_u32 s37, s39, 0x10003
    s_lshl_b32 s37, s37, 11
    s_add_u32 s85, s37, s85
    s_bfe_u32 s37, s39, 0x40004
    s_lshl_b32 s37, s37, 16
    s_add_u32 s85, s37, s85
    v_mfma_f32_16x16x32_bf16 v[96:99], a[80:83], v[80:83], 0
    v_mfma_f32_16x16x32_bf16 v[96:99], a[84:87], v[84:87], v[96:99]
    v_mfma_f32_16x16x32_bf16 v[96:99], a[88:91], v[88:91], v[96:99]
    v_mov_b32_dpp v122, v112 quad_perm:[0,0,0,0] row_mask:0xf bank_mask:0xf
    v_mov_b32_dpp v124, v114 quad_perm:[2,2,2,2] row_mask:0xf bank_mask:0xf
    s_nop 0
    v_add_f32_dpp v122, v113, v122 quad_perm:[1,1,1,1] row_mask:0xf bank_mask:0xf
    v_add_f32_dpp v124, v115, v124 quad_perm:[3,3,3,3] row_mask:0xf bank_mask:0xf
    v_add_f32 v122, v122, v124
    v_max_f32 v65, v65, v122
    ds_write_b32 v64, v122 offset:3072
    v_mfma_f32_16x16x32_bf16 v[96:99], a[92:95], v[92:95], v[96:99]
    v_mfma_f32_16x16x32_bf16 v[112:115], a[96:99], v[80:83], 0
    v_mfma_f32_16x16x32_bf16 v[112:115], a[100:103], v[84:87], v[112:115]
    s_waitcnt vmcnt(5)
    buffer_load_dwordx4 v[144:147], v76, s[52:55], s85 offen offset:0 nt
    v_mfma_f32_16x16x32_bf16 v[112:115], a[104:107], v[88:91], v[112:115]
    s_nop 2
    v_mov_b32_dpp v122, v96 quad_perm:[0,0,0,0] row_mask:0xf bank_mask:0xf
    v_mov_b32_dpp v124, v98 quad_perm:[2,2,2,2] row_mask:0xf bank_mask:0xf
    s_nop 0
    v_add_f32_dpp v122, v97, v122 quad_perm:[1,1,1,1] row_mask:0xf bank_mask:0xf
    v_add_f32_dpp v124, v99, v124 quad_perm:[3,3,3,3] row_mask:0xf bank_mask:0xf
    v_add_f32 v122, v122, v124
    v_max_f32 v65, v65, v122
    ds_write_b32 v64, v122 offset:3328
    v_mfma_f32_16x16x32_bf16 v[112:115], a[108:111], v[92:95], v[112:115]
    v_mfma_f32_16x16x32_bf16 v[96:99], a[112:115], v[80:83], 0
    v_mfma_f32_16x16x32_bf16 v[96:99], a[116:119], v[84:87], v[96:99]
    v_mfma_f32_16x16x32_bf16 v[96:99], a[120:123], v[88:91], v[96:99]
    s_nop 4
    v_mov_b32_dpp v122, v112 quad_perm:[0,0,0,0] row_mask:0xf bank_mask:0xf
    v_mov_b32_dpp v124, v114 quad_perm:[2,2,2,2] row_mask:0xf bank_mask:0xf
    s_nop 0
    v_add_f32_dpp v122, v113, v122 quad_perm:[1,1,1,1] row_mask:0xf bank_mask:0xf
    v_add_f32_dpp v124, v115, v124 quad_perm:[3,3,3,3] row_mask:0xf bank_mask:0xf
    v_add_f32 v122, v122, v124
    v_max_f32 v65, v65, v122
    ds_write_b32 v64, v122 offset:3584
    s_waitcnt vmcnt(5)
    v_mfma_f32_16x16x32_bf16 v[96:99], a[124:127], v[92:95], v[96:99]
    v_add_u32 v64, 3840, v64
    s_mov_b32 s97, 9
    s_mov_b32 s86, 34
    s_add_u32 s92, s33, 238
    s_mov_b32 s66, 134217728
    s_mov_b32 s67, 0x20000
    s_mov_b64 s[64:65], s[52:53]
    v_mov_b32 v62, v76
    v_mov_b32 v63, v77
L_bloop:
    s_waitcnt vmcnt(4)
    buffer_load_dwordx4 v[148:151], v63, s[64:67], s85 offen offset:0 nt
    v_mfma_f32_16x16x32_bf16 v[112:115], v[128:131], v[80:83], 0
    s_waitcnt vmcnt(4)
    buffer_load_dwordx4 v[152:155], v62, s[64:67], s85 offen offset:1024 nt
    v_mfma_f32_16x16x32_bf16 v[112:115], v[132:135], v[84:87], v[112:115]
    v_mov_b32_dpp v122, v96 quad_perm:[0,0,0,0] row_mask:0xf bank_mask:0xf
    v_mov_b32_dpp v124, v98 quad_perm:[2,2,2,2] row_mask:0xf bank_mask:0xf
    s_nop 0
    v_add_f32_dpp v122, v97, v122 quad_perm:[1,1,1,1] row_mask:0xf bank_mask:0xf
    v_add_f32_dpp v124, v99, v124 quad_perm:[3,3,3,3] row_mask:0xf bank_mask:0xf
    v_add_f32 v122, v122, v124
    v_max_f32 v65, v65, v122
    ds_write_b32 v64, v122 offset:0
    s_waitcnt vmcnt(4)
    buffer_load_dwordx4 v[156:159], v63, s[64:67], s85 offen offset:1024 nt
    v_mfma_f32_16x16x32_bf16 v[112:115], v[136:139], v[88:91], v[112:115]
    s_add_u32 s87, s87, 7
    s_cmp_lg_u32 s87, s92
    s_cbranch_scc1 L_stayk_4
    s_mov_b64 s[64:65], s[56:57]
    v_mov_b32 v62, v126
    v_mov_b32 v63, v127
    s_mul_i32 s37, s86, 7
    s_sub_u32 s87, s87, s37
L_stayk_4:
    s_add_u32 s39, s87, s88
    s_bfe_u32 s37, s39, 0x30000
    s_lshl_b32 s37, s37, 12
    s_add_u32 s85, s37, s89
    s_bfe_u32 s37, s39, 0x10003
    s_lshl_b32 s37, s37, 11
    s_add_u32 s85, s37, s85
    s_bfe_u32 s37, s39, 0x40004
    s_lshl_b32 s37, s37, 16
    s_add_u32 s85, s37, s85
    s_waitcnt vmcnt(4)
    buffer_load_dwordx4 v[128:131], v62, s[64:67], s85 offen offset:0 nt
    v_mfma_f32_16x16x32_bf16 v[112:115], v[140:143], v[92:95], v[112:115]
    s_waitcnt vmcnt(4)
    buffer_load_dwordx4 v[132:135], v63, s[64:67], s85 offen offset:0 nt
    v_mfma_f32_16x16x32_bf16 v[96:99], v[144:147], v[80:83], 0
    s_waitcnt vmcnt(4)
    buffer_load_dwordx4 v[136:139], v62, s[64:67], s85 offen offset:1024 nt
    v_mfma_f32_16x16x32_bf16 v[96:99], v[148:151], v[84:87], v[96:99]
    s_nop 1
    v_mov_b32_dpp v122, v112 quad_perm:[0,0,0,0] row_mask:0xf bank_mask:0xf
    v_mov_b32_dpp v124, v114 quad_perm:[2,2,2,2] row_mask:0xf bank_mask:0xf
    s_nop 0
    v_add_f32_dpp v122, v113, v122 quad_perm:[1,1,1,1] row_mask:0xf bank_mask:0xf
    v_add_f32_dpp v124, v115, v124 quad_perm:[3,3,3,3] row_mask:0xf bank_mask:0xf
    v_add_f32 v122, v122, v124
    v_max_f32 v65, v65, v122
    ds_write_b32 v64, v122 offset:256
    s_waitcnt vmcnt(4)
    buffer_load_dwordx4 v[140:143], v63, s[64:67], s85 offen offset:1024 nt
    v_mfma_f32_16x16x32_bf16 v[96:99], v[152:155], v[88:91], v[96:99]
    s_add_u32 s87, s87, 7
    s_cmp_lg_u32 s87, s92
    s_cbranch_scc1 L_stayk_5
    s_mov_b64 s[64:65], s[56:57]
    v_mov_b32 v62, v126
    v_mov_b32 v63, v127
    s_mul_i32 s37, s86, 7
    s_sub_u32 s87, s87, s37
L_stayk_5:
    s_add_u32 s39, s87, s88
    s_bfe_u32 s37, s39, 0x30000
    s_lshl_b32 s37, s37, 12
    s_add_u32 s85, s37, s89
    s_bfe_u32 s37, s39, 0x10003
    s_lshl_b32 s37, s37, 11
    s_add_u32 s85, s37, s85
    s_bfe_u32 s37, s39, 0x40004
    s_lshl_b32 s37, s37, 16
    s_add_u32 s85, s37, s85
    s_waitcnt vmcnt(4)
    buffer_load_dwordx4 v[144:147], v62, s[64:67], s85 offen offset:0 nt
    v_mfma_f32_16x16x32_bf16 v[96:99], v[156:159], v[92:95], v[96:99]
    v_add_u32 v64, 512, v64
    s_sub_u32 s97, s97, 1
    s_cmp_lg_u32 s97, 0
    s_cbranch_scc1 L_bloop
    buffer_load_dwordx4 v[148:151], v63, s[64:67], s85 offen offset:0 nt
    s_nop 2
    v_mov_b32_dpp v122, v96 quad_perm:[0,0,0,0] row_mask:0xf bank_mask:0xf
    v_mov_b32_dpp v124, v98 quad_perm:[2,2,2,2] row_mask:0xf bank_mask:0xf
    s_nop 0
    v_add_f32_dpp v122, v97, v122 quad_perm:[1,1,1,1] row_mask:0xf bank_mask:0xf
    v_add_f32_dpp v124, v99, v124 quad_perm:[3,3,3,3] row_mask:0xf bank_mask:0xf
    v_add_f32 v122, v122, v124
    v_max_f32 v65, v65, v122
    ds_write_b32 v64, v122 offset:0
    v_mov_b32 v123, 0xff7f0000
    ds_write_b32 v64, v123 offset:256
    s_lshl_b32 s38, s34, 14
    s_add_u32 s38, s38, 16384
    v_lshl_add_u32 v64, v1, 2, s38
    ds_read_b32 v66, v64
    ds_read_b32 v67, v64 offset:256
    v_mul_f32 v65, s83, v65
    s_nop 1
    v_max_f32_dpp v124, v65, v65 row_ror:4 row_mask:0xf bank_mask:0xf
    s_nop 1
    v_max_f32_dpp v124, v124, v124 row_ror:8 row_mask:0xf bank_mask:0xf
    v_mov_b32 v125, v124
    s_nop 1
    v_permlane16_swap_b32 v124, v125
    v_max_f32 v124, v124, v125
    v_mov_b32 v125, v124
    s_nop 1
    v_permlane32_swap_b32 v124, v125
    v_max_f32 v124, v124, v125
    v_and_b32 v120, s82, v124
    s_lshr_b32 s97, s86, 1
    s_waitcnt lgkmcnt(1)
    v_fma_f32 v123, v66, s83, -v120
    v_exp_f32 v123, v123
    ds_read_b32 v66, v64 offset:512
    v_cvt_pk_bf16_f32 v100, v123, v123
    v_add_f32 v121, v121, v123
L_vloop:
    s_nop 0
    v_and_b32_dpp v104, v100, v10 row_newbcast:0 row_mask:0xf bank_mask:0xf
    v_and_b32_dpp v105, v100, v11 row_newbcast:0 row_mask:0xf bank_mask:0xf
    v_and_b32_dpp v106, v100, v12 row_newbcast:0 row_mask:0xf bank_mask:0xf
    v_and_b32_dpp v107, v100, v13 row_newbcast:0 row_mask:0xf bank_mask:0xf
    s_waitcnt vmcnt(5)
    buffer_load_dwordx4 v[152:155], v62, s[64:67], s85 offen offset:1024 nt
    v_mfma_f32_16x16x32_bf16 v[116:119], v[128:131], v[104:107], v[116:119]
    v_and_b32_dpp v108, v100, v10 row_newbcast:4 row_mask:0xf bank_mask:0xf
    v_and_b32_dpp v109, v100, v11 row_newbcast:4 row_mask:0xf bank_mask:0xf
    v_and_b32_dpp v110, v100, v12 row_newbcast:4 row_mask:0xf bank_mask:0xf
    v_and_b32_dpp v111, v100, v13 row_newbcast:4 row_mask:0xf bank_mask:0xf
    s_waitcnt vmcnt(5)
    buffer_load_dwordx4 v[156:159], v63, s[64:67], s85 offen offset:1024 nt
    v_mfma_f32_16x16x32_bf16 v[116:119], v[132:135], v[108:111], v[116:119]
    s_add_u32 s87, s87, 7
    s_cmp_lt_u32 s87, s92
    s_cbranch_scc1 L_stayv_6
    s_cmp_lg_u32 s87, s92
    s_cbranch_scc1 L_second_7
    s_mov_b64 s[64:65], s[52:53]
    v_mov_b32 v62, v76
    v_mov_b32 v63, v77
    s_mov_b64 exec, 1
    global_atomic_add v19, v9, v18, s[30:31] sc0 sc1
    s_mov_b64 exec, -1
    s_branch L_stayv_6
L_second_7:
    s_mov_b64 s[64:65], s[56:57]
    v_mov_b32 v62, v126
    v_mov_b32 v63, v127
    s_mov_b32 s87, s92
L_stayv_6:
    s_add_u32 s39, s87, s88
    s_bfe_u32 s37, s39, 0x30000
    s_lshl_b32 s37, s37, 12
    s_add_u32 s85, s37, s89
    s_bfe_u32 s37, s39, 0x10003
    s_lshl_b32 s37, s37, 11
    s_add_u32 s85, s37, s85
    s_bfe_u32 s37, s39, 0x40004
    s_lshl_b32 s37, s37, 16
    s_add_u32 s85, s37, s85
    s_waitcnt lgkmcnt(1)
    v_fma_f32 v123, v67, s83, -v120
    v_exp_f32 v123, v123
    ds_read_b32 v67, v64 offset:768
    v_cvt_pk_bf16_f32 v101, v123, v123
    v_add_f32 v121, v121, v123
    v_and_b32_dpp v104, v100, v10 row_newbcast:8 row_mask:0xf bank_mask:0xf
    v_and_b32_dpp v105, v100, v11 row_newbcast:8 row_mask:0xf bank_mask:0xf
    v_and_b32_dpp v106, v100, v12 row_newbcast:8 row_mask:0xf bank_mask:0xf
    v_and_b32_dpp v107, v100, v13 row_newbcast:8 row_mask:0xf bank_mask:0xf
    s_waitcnt vmcnt(5)
    buffer_load_dwordx4 v[128:131], v62, s[64:67], s85 offen offset:0 nt
    v_mfma_f32_16x16x32_bf16 v[116:119], v[136:139], v[104:107], v[116:119]
    v_and_b32_dpp v108, v100, v10 row_newbcast:12 row_mask:0xf bank_mask:0xf
    v_and_b32_dpp v109, v100, v11 row_newbcast:12 row_mask:0xf bank_mask:0xf
    v_and_b32_dpp v110, v100, v12 row_newbcast:12 row_mask:0xf bank_mask:0xf
    v_and_b32_dpp v111, v100, v13 row_newbcast:12 row_mask:0xf bank_mask:0xf
    s_waitcnt vmcnt(5)
    buffer_load_dwordx4 v[132:135], v63, s[64:67], s85 offen offset:0 nt
    v_mfma_f32_16x16x32_bf16 v[116:119], v[140:143], v[108:111], v[116:119]
    v_and_b32_dpp v104, v101, v10 row_newbcast:0 row_mask:0xf bank_mask:0xf
    v_and_b32_dpp v105, v101, v11 row_newbcast:0 row_mask:0xf bank_mask:0xf
    v_and_b32_dpp v106, v101, v12 row_newbcast:0 row_mask:0xf bank_mask:0xf
    v_and_b32_dpp v107, v101, v13 row_newbcast:0 row_mask:0xf bank_mask:0xf
    s_waitcnt vmcnt(5)
    buffer_load_dwordx4 v[136:139], v62, s[64:67], s85 offen offset:1024 nt
    v_mfma_f32_16x16x32_bf16 v[116:119], v[144:147], v[104:107], v[116:119]
    v_and_b32_dpp v108, v101, v10 row_newbcast:4 row_mask:0xf bank_mask:0xf
    v_and_b32_dpp v109, v101, v11 row_newbcast:4 row_mask:0xf bank_mask:0xf
    v_and_b32_dpp v110, v101, v12 row_newbcast:4 row_mask:0xf bank_mask:0xf
    v_and_b32_dpp v111, v101, v13 row_newbcast:4 row_mask:0xf bank_mask:0xf
    s_waitcnt vmcnt(5)
    buffer_load_dwordx4 v[140:143], v63, s[64:67], s85 offen offset:1024 nt
    v_mfma_f32_16x16x32_bf16 v[116:119], v[148:151], v[108:111], v[116:119]
    s_add_u32 s87, s87, 7
    s_cmp_lt_u32 s87, s92
    s_cbranch_scc1 L_stayv_8
    s_cmp_lg_u32 s87, s92
    s_cbranch_scc1 L_second_9
    s_mov_b64 s[64:65], s[52:53]
    v_mov_b32 v62, v76
    v_mov_b32 v63, v77
    s_mov_b64 exec, 1
    global_atomic_add v19, v9, v18, s[30:31] sc0 sc1
    s_mov_b64 exec, -1
    s_branch L_stayv_8
L_second_9:
    s_mov_b64 s[64:65], s[56:57]
    v_mov_b32 v62, v126
    v_mov_b32 v63, v127
    s_mov_b32 s87, s92
L_stayv_8:
    s_add_u32 s39, s87, s88
    s_bfe_u32 s37, s39, 0x30000
    s_lshl_b32 s37, s37, 12
    s_add_u32 s85, s37, s89
    s_bfe_u32 s37, s39, 0x10003
    s_lshl_b32 s37, s37, 11
    s_add_u32 s85, s37, s85
    s_bfe_u32 s37, s39, 0x40004
    s_lshl_b32 s37, s37, 16
    s_add_u32 s85, s37, s85
    v_add_u32 v64, 512, v64
    s_waitcnt lgkmcnt(1)
    v_fma_f32 v123, v66, s83, -v120
    v_exp_f32 v123, v123
    ds_read_b32 v66, v64 offset:512
    v_cvt_pk_bf16_f32 v100, v123, v123
    v_add_f32 v121, v121, v123
    v_and_b32_dpp v104, v101, v10 row_newbcast:8 row_mask:0xf bank_mask:0xf
    v_and_b32_dpp v105, v101, v11 row_newbcast:8 row_mask:0xf bank_mask:0xf
    v_and_b32_dpp v106, v101, v12 row_newbcast:8 row_mask:0xf bank_mask:0xf
    v_and_b32_dpp v107, v101, v13 row_newbcast:8 row_mask:0xf bank_mask:0xf
    s_waitcnt vmcnt(5)
    buffer_load_dwordx4 v[144:147], v62, s[64:67], s85 offen offset:0 nt
    v_mfma_f32_16x16x32_bf16 v[116:119], v[152:155], v[104:107], v[116:119]
    v_and_b32_dpp v108, v101, v10 row_newbcast:12 row_mask:0xf bank_mask:0xf
    v_and_b32_dpp v109, v101, v11 row_newbcast:12 row_mask:0xf bank_mask:0xf
    v_and_b32_dpp v110, v101, v12 row_newbcast:12 row_mask:0xf bank_mask:0xf
    v_and_b32_dpp v111, v101, v13 row_newbcast:12 row_mask:0xf bank_mask:0xf
    s_waitcnt vmcnt(5)
    buffer_load_dwordx4 v[148:151], v63, s[64:67], s85 offen offset:0 nt
    v_mfma_f32_16x16x32_bf16 v[116:119], v[156:159], v[108:111], v[116:119]
    s_sub_u32 s97, s97, 1
    s_cmp_lg_u32 s97, 0
    s_cbranch_scc1 L_vloop
    buffer_load_dwordx4 v[152:155], v126, s[56:59], s85 offen offset:1024 nt
    buffer_load_dwordx4 v[156:159], v127, s[56:59], s85 offen offset:1024 nt
L_dloop:
    s_waitcnt vmcnt(7)
    v_readfirstlane_b32 s93, v19
    s_nop 0
    s_sub_u32 s36, s93, 11
    s_and_b32 s38, s36, 3
    s_mul_i32 s38, s38, 7
    s_lshr_b32 s36, s36, 2
    s_add_u32 s87, s38, s36
    s_add_u32 s38, s93, 245
    s_cmp_lt_i32 s93, 11
    s_cselect_b32 s87, s38, s87
    s_add_u32 s93, s93, 8
    s_add_u32 s39, s87, s88
    s_bfe_u32 s37, s39, 0x30000
    s_lshl_b32 s37, s37, 12
    s_add_u32 s86, s37, s89
    s_bfe_u32 s37, s39, 0x10003
    s_lshl_b32 s37, s37, 11
    s_add_u32 s86, s37, s86
    s_bfe_u32 s37, s39, 0x40004
    s_lshl_b32 s37, s37, 16
    s_add_u32 s86, s37, s86
    s_cmp_ge_u32 s93, 31
    s_cselect_b32 s86, 134217728, s86
    v_mov_b32 v19, 23
    s_cmp_ge_u32 s93, 30
    s_cbranch_scc1 L_noclaim_10
    s_mov_b64 exec, 1
    global_atomic_add v19, v9, v18, s[30:31] sc0 sc1
    s_mov_b64 exec, -1
L_noclaim_10:
    buffer_load_dwordx4 v[160:163], v76, s[52:55], s86 offen offset:0 nt
    v_mfma_f32_16x16x32_bf16 v[112:115], v[128:131], v[80:83], 0
    s_waitcnt vmcnt(7)
    buffer_load_dwordx4 v[164:167], v77, s[52:55], s86 offen offset:0 nt
    v_mfma_f32_16x16x32_bf16 v[112:115], v[132:135], v[84:87], v[112:115]
    s_waitcnt vmcnt(7)
    buffer_load_dwordx4 v[168:171], v76, s[52:55], s86 offen offset:1024 nt
    v_mfma_f32_16x16x32_bf16 v[112:115], v[136:139], v[88:91], v[112:115]
    s_waitcnt vmcnt(7)
    buffer_load_dwordx4 v[172:175], v77, s[52:55], s86 offen offset:1024 nt
    v_mfma_f32_16x16x32_bf16 v[112:115], v[140:143], v[92:95], v[112:115]
    s_nop 7
    v_mov_b32_dpp v122, v112 quad_perm:[0,0,0,0] row_mask:0xf bank_mask:0xf
    v_mov_b32_dpp v124, v114 quad_perm:[2,2,2,2] row_mask:0xf bank_mask:0xf
    s_nop 0
    v_add_f32_dpp v122, v113, v122 quad_perm:[1,1,1,1] row_mask:0xf bank_mask:0xf
    v_add_f32_dpp v124, v115, v124 quad_perm:[3,3,3,3] row_mask:0xf bank_mask:0xf
    v_add_f32 v122, v122, v124
    v_fma_f32 v123, v122, s83, -v120
    v_cmp_lt_f32 vcc, 0, v123
    s_cbranch_vccz L_nomax_11
    v_mul_f32 v122, s83, v122
    s_nop 1
    v_max_f32_dpp v124, v122, v122 row_ror:4 row_mask:0xf bank_mask:0xf
    s_nop 1
    v_max_f32_dpp v124, v124, v124 row_ror:8 row_mask:0xf bank_mask:0xf
    v_mov_b32 v125, v124
    s_nop 1
    v_permlane16_swap_b32 v124, v125
    v_max_f32 v124, v124, v125
    v_mov_b32 v125, v124
    s_nop 1
    v_permlane32_swap_b32 v124, v125
    v_max_f32 v124, v124, v125
    v_and_b32 v124, s82, v124
    v_max_f32 v124, v124, v120
    v_sub_f32 v125, v120, v124
    v_exp_f32 v125, v125
    v_mov_b32 v120, v124
    v_sub_f32 v123, v122, v124
    v_mul_f32 v121, v121, v125
    v_mul_f32 v116, v116, v125
    v_mul_f32 v117, v117, v125
    v_mul_f32 v118, v118, v125
    v_mul_f32 v119, v119, v125
L_nomax_11:
    v_exp_f32 v123, v123
    s_nop 0
    v_cvt_pk_bf16_f32 v124, v123, v123
    v_add_f32 v121, v121, v123
    s_nop 0
    v_and_b32_dpp v96, v124, v10 row_newbcast:0 row_mask:0xf bank_mask:0xf
    v_and_b32_dpp v97, v124, v11 row_newbcast:0 row_mask:0xf bank_mask:0xf
    v_and_b32_dpp v98, v124, v12 row_newbcast:0 row_mask:0xf bank_mask:0xf
    v_and_b32_dpp v99, v124, v13 row_newbcast:0 row_mask:0xf bank_mask:0xf
    v_and_b32_dpp v100, v124, v10 row_newbcast:4 row_mask:0xf bank_mask:0xf
    v_and_b32_dpp v101, v124, v11 row_newbcast:4 row_mask:0xf bank_mask:0xf
    v_and_b32_dpp v102, v124, v12 row_newbcast:4 row_mask:0xf bank_mask:0xf
    v_and_b32_dpp v103, v124, v13 row_newbcast:4 row_mask:0xf bank_mask:0xf
    v_and_b32_dpp v104, v124, v10 row_newbcast:8 row_mask:0xf bank_mask:0xf
    v_and_b32_dpp v105, v124, v11 row_newbcast:8 row_mask:0xf bank_mask:0xf
    v_and_b32_dpp v106, v124, v12 row_newbcast:8 row_mask:0xf bank_mask:0xf
    v_and_b32_dpp v107, v124, v13 row_newbcast:8 row_mask:0xf bank_mask:0xf
    v_and_b32_dpp v108, v124, v10 row_newbcast:12 row_mask:0xf bank_mask:0xf
    v_and_b32_dpp v109, v124, v11 row_newbcast:12 row_mask:0xf bank_mask:0xf
    v_and_b32_dpp v110, v124, v12 row_newbcast:12 row_mask:0xf bank_mask:0xf
    v_and_b32_dpp v111, v124, v13 row_newbcast:12 row_mask:0xf bank_mask:0xf
    s_waitcnt vmcnt(7)
    buffer_load_dwordx4 v[176:179], v126, s[56:59], s86 offen offset:0 nt
    v_mfma_f32_16x16x32_bf16 v[116:119], v[144:147], v[96:99], v[116:119]
    s_waitcnt vmcnt(7)
    buffer_load_dwordx4 v[180:183], v127, s[56:59], s86 offen offset:0 nt
    v_mfma_f32_16x16x32_bf16 v[116:119], v[148:151], v[100:103], v[116:119]
    s_waitcnt vmcnt(7)
    buffer_load_dwordx4 v[184:187], v126, s[56:59], s86 offen offset:1024 nt
    v_mfma_f32_16x16x32_bf16 v[116:119], v[152:155], v[104:107], v[116:119]
    s_waitcnt vmcnt(7)
    buffer_load_dwordx4 v[188:191], v127, s[56:59], s86 offen offset:1024 nt
    v_mfma_f32_16x16x32_bf16 v[116:119], v[156:159], v[108:111], v[116:119]
    s_cmp_ge_u32 s93, 31
    s_cbranch_scc1 L_bdone
    s_waitcnt vmcnt(7)
    v_readfirstlane_b32 s93, v19
    s_nop 0
    s_sub_u32 s36, s93, 11
    s_and_b32 s38, s36, 3
    s_mul_i32 s38, s38, 7
    s_lshr_b32 s36, s36, 2
    s_add_u32 s87, s38, s36
    s_add_u32 s38, s93, 245
    s_cmp_lt_i32 s93, 11
    s_cselect_b32 s87, s38, s87
    s_add_u32 s93, s93, 8
    s_add_u32 s39, s87, s88
    s_bfe_u32 s37, s39, 0x30000
    s_lshl_b32 s37, s37, 12
    s_add_u32 s85, s37, s89
    s_bfe_u32 s37, s39, 0x10003
    s_lshl_b32 s37, s37, 11
    s_add_u32 s85, s37, s85
    s_bfe_u32 s37, s39, 0x40004
    s_lshl_b32 s37, s37, 16
    s_add_u32 s85, s37, s85
    s_cmp_ge_u32 s93, 31
    s_cselect_b32 s85, 134217728, s85
    v_mov_b32 v19, 23
    s_cmp_ge_u32 s93, 30
    s_cbranch_scc1 L_noclaim_12
    s_mov_b64 exec, 1
    global_atomic_add v19, v9, v18, s[30:31] sc0 sc1
    s_mov_b64 exec, -1
L_noclaim_12:
    buffer_load_dwordx4 v[128:131], v76, s[52:55], s85 offen offset:0 nt
    v_mfma_f32_16x16x32_bf16 v[112:115], v[160:163], v[80:83], 0
    s_waitcnt vmcnt(7)
    buffer_load_dwordx4 v[132:135], v77, s[52:55], s85 offen offset:0 nt
    v_mfma_f32_16x16x32_bf16 v[112:115], v[164:167], v[84:87], v[112:115]
    s_waitcnt vmcnt(7)
    buffer_load_dwordx4 v[136:139], v76, s[52:55], s85 offen offset:1024 nt
    v_mfma_f32_16x16x32_bf16 v[112:115], v[168:171], v[88:91], v[112:115]
    s_waitcnt vmcnt(7)
    buffer_load_dwordx4 v[140:143], v77, s[52:55], s85 offen offset:1024 nt
    v_mfma_f32_16x16x32_bf16 v[112:115], v[172:175], v[92:95], v[112:115]
    s_nop 7
    v_mov_b32_dpp v122, v112 quad_perm:[0,0,0,0] row_mask:0xf bank_mask:0xf
    v_mov_b32_dpp v124, v114 quad_perm:[2,2,2,2] row_mask:0xf bank_mask:0xf
    s_nop 0
    v_add_f32_dpp v122, v113, v122 quad_perm:[1,1,1,1] row_mask:0xf bank_mask:0xf
    v_add_f32_dpp v124, v115, v124 quad_perm:[3,3,3,3] row_mask:0xf bank_mask:0xf
    v_add_f32 v122, v122, v124
    v_fma_f32 v123, v122, s83, -v120
    v_cmp_lt_f32 vcc, 0, v123
    s_cbranch_vccz L_nomax_13
    v_mul_f32 v122, s83, v122
    s_nop 1
    v_max_f32_dpp v124, v122, v122 row_ror:4 row_mask:0xf bank_mask:0xf
    s_nop 1
    v_max_f32_dpp v124, v124, v124 row_ror:8 row_mask:0xf bank_mask:0xf
    v_mov_b32 v125, v124
    s_nop 1
    v_permlane16_swap_b32 v124, v125
    v_max_f32 v124, v124, v125
    v_mov_b32 v125, v124
    s_nop 1
    v_permlane32_swap_b32 v124, v125
    v_max_f32 v124, v124, v125
    v_and_b32 v124, s82, v124
    v_max_f32 v124, v124, v120
    v_sub_f32 v125, v120, v124
    v_exp_f32 v125, v125
    v_mov_b32 v120, v124
    v_sub_f32 v123, v122, v124
    v_mul_f32 v121, v121, v125
    v_mul_f32 v116, v116, v125
    v_mul_f32 v117, v117, v125
    v_mul_f32 v118, v118, v125
    v_mul_f32 v119, v119, v125
L_nomax_13:
    v_exp_f32 v123, v123
    s_nop 0
    v_cvt_pk_bf16_f32 v124, v123, v123
    v_add_f32 v121, v121, v123
    s_nop 0
    v_and_b32_dpp v96, v124, v10 row_newbcast:0 row_mask:0xf bank_mask:0xf
    v_and_b32_dpp v97, v124, v11 row_newbcast:0 row_mask:0xf bank_mask:0xf
    v_and_b32_dpp v98, v124, v12 row_newbcast:0 row_mask:0xf bank_mask:0xf
    v_and_b32_dpp v99, v124, v13 row_newbcast:0 row_mask:0xf bank_mask:0xf
    v_and_b32_dpp v100, v124, v10 row_newbcast:4 row_mask:0xf bank_mask:0xf
    v_and_b32_dpp v101, v124, v11 row_newbcast:4 row_mask:0xf bank_mask:0xf
    v_and_b32_dpp v102, v124, v12 row_newbcast:4 row_mask:0xf bank_mask:0xf
    v_and_b32_dpp v103, v124, v13 row_newbcast:4 row_mask:0xf bank_mask:0xf
    v_and_b32_dpp v104, v124, v10 row_newbcast:8 row_mask:0xf bank_mask:0xf
    v_and_b32_dpp v105, v124, v11 row_newbcast:8 row_mask:0xf bank_mask:0xf
    v_and_b32_dpp v106, v124, v12 row_newbcast:8 row_mask:0xf bank_mask:0xf
    v_and_b32_dpp v107, v124, v13 row_newbcast:8 row_mask:0xf bank_mask:0xf
    v_and_b32_dpp v108, v124, v10 row_newbcast:12 row_mask:0xf bank_mask:0xf
    v_and_b32_dpp v109, v124, v11 row_newbcast:12 row_mask:0xf bank_mask:0xf
    v_and_b32_dpp v110, v124, v12 row_newbcast:12 row_mask:0xf bank_mask:0xf
    v_and_b32_dpp v111, v124, v13 row_newbcast:12 row_mask:0xf bank_mask:0xf
    s_waitcnt vmcnt(7)
    buffer_load_dwordx4 v[144:147], v126, s[56:59], s85 offen offset:0 nt
    v_mfma_f32_16x16x32_bf16 v[116:119], v[176:179], v[96:99], v[116:119]
    s_waitcnt vmcnt(7)
    buffer_load_dwordx4 v[148:151], v127, s[56:59], s85 offen offset:0 nt
    v_mfma_f32_16x16x32_bf16 v[116:119], v[180:183], v[100:103], v[116:119]
    s_waitcnt vmcnt(7)
    buffer_load_dwordx4 v[152:155], v126, s[56:59], s85 offen offset:1024 nt
    v_mfma_f32_16x16x32_bf16 v[116:119], v[184:187], v[104:107], v[116:119]
    s_waitcnt vmcnt(7)
    buffer_load_dwordx4 v[156:159], v127, s[56:59], s85 offen offset:1024 nt
    v_mfma_f32_16x16x32_bf16 v[116:119], v[188:191], v[108:111], v[116:119]
    s_cmp_ge_u32 s93, 31
    s_cbranch_scc0 L_dloop
L_bdone:
    v_add_f32_dpp v121, v121, v121 row_ror:8 row_mask:0xf bank_mask:0xf
    s_nop 1
    v_add_f32_dpp v121, v121, v121 row_ror:4 row_mask:0xf bank_mask:0xf
    v_mov_b32 v125, v121
    s_nop 1
    v_permlane16_swap_b32 v121, v125
    v_add_f32 v121, v121, v125
    v_mov_b32 v125, v121
    v_and_or_b32 v118, v118, s82, v8
    v_and_or_b32 v119, v119, s82, v8
    v_permlane32_swap_b32 v121, v125
    s_mov_b32 exec_lo, 0x100
    s_mov_b32 exec_hi, 0x0
    v_add_f32 v117, v121, v125
    v_mov_b32 v116, v120
    s_mov_b32 exec_lo, 0xff01ff
    s_mov_b32 exec_hi, 0xff00ff
    v_and_or_b32 v116, v116, s82, v8
    v_and_or_b32 v117, v117, s82, v8
    buffer_store_dwordx4 v[116:119], v79, s[48:51], s96 offen sc1
    s_endpgm
L_qp:
    v_lshlrev_b32 v4, 18, v2
    v_lshl_add_u32 v14, v3, 4, v4
    v_lshrrev_b32 v5, 3, v3
    v_lshlrev_b32 v5, 10, v5
    v_lshl_add_u32 v15, v2, 6, v5
    s_cmp_eq_u32 s33, 0
    s_cselect_b32 s61, 3, 2
    s_xor_b32 s61, s61, s32
    s_lshl_b32 s86, s34, 8
    s_lshl_b32 s63, s34, 20
    s_lshl_b32 s38, s61, 8
    s_add_u32 s63, s63, s38
    s_mov_b32 s42, 4194304
    s_mov_b32 s43, 0x20000
    s_mov_b32 s46, 4096
    s_mov_b32 s47, 0x20000
    s_cmp_eq_u32 s33, 0
    s_waitcnt lgkmcnt(0)
    s_cselect_b64 s[40:41], s[22:23], s[8:9]
    s_cselect_b64 s[44:45], s[16:17], s[4:5]
    buffer_load_dwordx4 a[128:131], v14, s[40:43], s63 offen nt
    s_add_u32 s63, s63, 8192
    buffer_load_dwordx4 a[132:135], v14, s[40:43], s63 offen nt
    s_add_u32 s63, s63, 8192
    buffer_load_dwordx4 v[20:23], v15, s[44:47], s86 offen offset:0
    buffer_load_dwordx4 v[36:39], v15, s[44:47], s86 offen offset:2048
    buffer_load_dwordx4 a[136:139], v14, s[40:43], s63 offen nt
    s_add_u32 s63, s63, 8192
    buffer_load_dwordx4 a[140:143], v14, s[40:43], s63 offen nt
    s_add_u32 s63, s63, 8192
    buffer_load_dwordx4 a[144:147], v14, s[40:43], s63 offen nt
    s_add_u32 s63, s63, 8192
    buffer_load_dwordx4 a[148:151], v14, s[40:43], s63 offen nt
    s_add_u32 s63, s63, 8192
    buffer_load_dwordx4 a[152:155], v14, s[40:43], s63 offen nt
    s_add_u32 s63, s63, 8192
    buffer_load_dwordx4 a[156:159], v14, s[40:43], s63 offen nt
    s_add_u32 s63, s63, 8192
    s_getpc_b64 s[36:37]
L_pc_14:
    s_sub_u32 s36, s36, L_pc_14 - concat_heads__compressed_kv_cla__mha_block_cached__decode_kernel
    s_subb_u32 s37, s37, 0
    s_lshl_b32 s38, s32, 10
    v_lshl_add_u32 v6, v0, 2, s38
    v_mov_b32 v7, s37
    v_add_co_u32 v6, vcc, s36, v6
    s_nop 1
    v_addc_co_u32 v7, vcc, 0, v7, vcc
    global_load_dword v0, v[6:7], off
    s_load_dword s35, s[30:31], 0
    s_mov_b32 s48, s30
    s_and_b32 s49, s31, 0xffff
    s_mov_b32 s50, 8388608
    s_mov_b32 s51, 0x20000
    s_mov_b32 s82, 0xffffff00
    s_mov_b32 s83, 0x3e0293ee
    s_mov_b32 s84, 2097152
    v_and_b32 v4, 1, v1
    v_lshlrev_b32 v4, 4, v4
    v_mov_b32 v5, 0xffff
    v_lshlrev_b32 v4, v4, v5
    v_bfe_u32 v5, v1, 1, 2
    v_cmp_eq_u32 vcc, 0, v5
    s_nop 1
    v_cndmask_b32 v10, 0, v4, vcc
    v_cmp_eq_u32 vcc, 1, v5
    s_nop 1
    v_cndmask_b32 v11, 0, v4, vcc
    v_cmp_eq_u32 vcc, 2, v5
    s_nop 1
    v_cndmask_b32 v12, 0, v4, vcc
    v_cmp_eq_u32 vcc, 3, v5
    s_nop 1
    v_cndmask_b32 v13, 0, v4, vcc
    buffer_load_dwordx4 v[24:27], v15, s[44:47], s86 offen offset:16
    buffer_load_dwordx4 v[40:43], v15, s[44:47], s86 offen offset:2064
    buffer_load_dwordx4 v[28:31], v15, s[44:47], s86 offen offset:32
    buffer_load_dwordx4 v[44:47], v15, s[44:47], s86 offen offset:2080
    buffer_load_dwordx4 v[32:35], v15, s[44:47], s86 offen offset:48
    buffer_load_dwordx4 v[48:51], v15, s[44:47], s86 offen offset:2096
    s_lshl_b32 s38, s61, 2
    s_add_u32 s38, s38, s34
    s_lshl_b32 s38, s38, 8
    s_add_u32 s38, s38, 65536
    v_mov_b32 v19, 0
    s_cmp_eq_u32 s33, 0
    s_cselect_b32 s38, s38, 8388608
    s_mov_b64 exec, 1
    buffer_store_dword v19, v19, s[48:51], s38 offen sc1
    s_mov_b64 exec, -1
    s_mov_b32 s80, 0x01000100
    s_mov_b32 s81, 0x03020302
    s_waitcnt vmcnt(14)
    buffer_load_dwordx4 a[160:163], v14, s[40:43], s63 offen nt
    s_add_u32 s63, s63, 8192
    v_perm_b32 v4, v20, v20, s80
    v_perm_b32 v5, v36, v36, s80
    v_and_b32 v52, v4, v10
    v_and_b32 v53, v4, v11
    v_and_b32 v54, v4, v12
    v_and_b32 v55, v4, v13
    v_and_b32 v56, v5, v10
    v_and_b32 v57, v5, v11
    v_and_b32 v58, v5, v12
    v_and_b32 v59, v5, v13
    v_mfma_f32_16x16x32_bf16 v[60:63], a[128:131], v[52:55], 0
    s_nop 0
    v_mfma_f32_16x16x32_bf16 v[64:67], a[128:131], v[56:59], 0
    buffer_load_dwordx4 a[164:167], v14, s[40:43], s63 offen nt
    s_add_u32 s63, s63, 8192
    v_perm_b32 v4, v20, v20, s81
    v_perm_b32 v5, v36, v36, s81
    v_and_b32 v52, v4, v10
    v_and_b32 v53, v4, v11
    v_and_b32 v54, v4, v12
    v_and_b32 v55, v4, v13
    v_and_b32 v56, v5, v10
    v_and_b32 v57, v5, v11
    v_and_b32 v58, v5, v12
    v_and_b32 v59, v5, v13
    v_mfma_f32_16x16x32_bf16 v[60:63], a[132:135], v[52:55], v[60:63]
    s_nop 0
    v_mfma_f32_16x16x32_bf16 v[64:67], a[132:135], v[56:59], v[64:67]
    s_waitcnt vmcnt(15)
    buffer_load_dwordx4 a[168:171], v14, s[40:43], s63 offen nt
    s_add_u32 s63, s63, 8192
    v_perm_b32 v4, v21, v21, s80
    v_perm_b32 v5, v37, v37, s80
    v_and_b32 v52, v4, v10
    v_and_b32 v53, v4, v11
    v_and_b32 v54, v4, v12
    v_and_b32 v55, v4, v13
    v_and_b32 v56, v5, v10
    v_and_b32 v57, v5, v11
    v_and_b32 v58, v5, v12
    v_and_b32 v59, v5, v13
    v_mfma_f32_16x16x32_bf16 v[60:63], a[136:139], v[52:55], v[60:63]
    s_nop 0
    v_mfma_f32_16x16x32_bf16 v[64:67], a[136:139], v[56:59], v[64:67]
    s_waitcnt vmcnt(15)
    buffer_load_dwordx4 a[172:175], v14, s[40:43], s63 offen nt
    s_add_u32 s63, s63, 8192
    v_perm_b32 v4, v21, v21, s81
    v_perm_b32 v5, v37, v37, s81
    v_and_b32 v52, v4, v10
    v_and_b32 v53, v4, v11
    v_and_b32 v54, v4, v12
    v_and_b32 v55, v4, v13
    v_and_b32 v56, v5, v10
    v_and_b32 v57, v5, v11
    v_and_b32 v58, v5, v12
    v_and_b32 v59, v5, v13
    v_mfma_f32_16x16x32_bf16 v[60:63], a[140:143], v[52:55], v[60:63]
    s_nop 0
    v_mfma_f32_16x16x32_bf16 v[64:67], a[140:143], v[56:59], v[64:67]
    s_waitcnt vmcnt(15)
    buffer_load_dwordx4 a[176:179], v14, s[40:43], s63 offen nt
    s_add_u32 s63, s63, 8192
    v_lshrrev_b32 v4, 2, v3
    v_and_b32 v5, 3, v3
    v_lshlrev_b32 v76, 8, v4
    v_lshlrev_b32 v126, 8, v2
    v_lshl_add_u32 v76, v2, 6, v76
    v_lshl_add_u32 v76, v5, 4, v76
    v_lshl_add_u32 v126, v3, 4, v126
    v_xor_b32 v77, 32768, v76
    v_xor_b32 v127, 32768, v126
    s_add_u32 s3, s34, s33
    s_and_b32 s3, s3, 3
    s_lshl_b32 s89, s3, 5
    s_add_u32 s89, s89, s32
    s_lshl_b32 s89, s89, 20
    s_mul_i32 s88, s32, 8
    s_add_u32 s88, s88, s3
    s_add_u32 s87, s33, 28
    v_perm_b32 v4, v22, v22, s80
    v_perm_b32 v5, v38, v38, s80
    v_and_b32 v52, v4, v10
    v_and_b32 v53, v4, v11
    v_and_b32 v54, v4, v12
    v_and_b32 v55, v4, v13
    v_and_b32 v56, v5, v10
    v_and_b32 v57, v5, v11
    v_and_b32 v58, v5, v12
    v_and_b32 v59, v5, v13
    v_mfma_f32_16x16x32_bf16 v[60:63], a[144:147], v[52:55], v[60:63]
    s_nop 0
    v_mfma_f32_16x16x32_bf16 v[64:67], a[144:147], v[56:59], v[64:67]
    s_waitcnt vmcnt(15)
    buffer_load_dwordx4 a[180:183], v14, s[40:43], s63 offen nt
    s_add_u32 s63, s63, 8192
    v_perm_b32 v4, v22, v22, s81
    v_perm_b32 v5, v38, v38, s81
    v_and_b32 v52, v4, v10
    v_and_b32 v53, v4, v11
    v_and_b32 v54, v4, v12
    v_and_b32 v55, v4, v13
    v_and_b32 v56, v5, v10
    v_and_b32 v57, v5, v11
    v_and_b32 v58, v5, v12
    v_and_b32 v59, v5, v13
    v_mfma_f32_16x16x32_bf16 v[60:63], a[148:151], v[52:55], v[60:63]
    s_nop 0
    v_mfma_f32_16x16x32_bf16 v[64:67], a[148:151], v[56:59], v[64:67]
    s_waitcnt vmcnt(15)
    buffer_load_dwordx4 a[184:187], v14, s[40:43], s63 offen nt
    s_add_u32 s63, s63, 8192
    v_perm_b32 v4, v23, v23, s80
    v_perm_b32 v5, v39, v39, s80
    v_and_b32 v52, v4, v10
    v_and_b32 v53, v4, v11
    v_and_b32 v54, v4, v12
    v_and_b32 v55, v4, v13
    v_and_b32 v56, v5, v10
    v_and_b32 v57, v5, v11
    v_and_b32 v58, v5, v12
    v_and_b32 v59, v5, v13
    v_mfma_f32_16x16x32_bf16 v[60:63], a[152:155], v[52:55], v[60:63]
    s_nop 0
    v_mfma_f32_16x16x32_bf16 v[64:67], a[152:155], v[56:59], v[64:67]
    s_waitcnt vmcnt(15)
    buffer_load_dwordx4 a[188:191], v14, s[40:43], s63 offen nt
    s_add_u32 s63, s63, 8192
    v_perm_b32 v4, v23, v23, s81
    v_perm_b32 v5, v39, v39, s81
    v_and_b32 v52, v4, v10
    v_and_b32 v53, v4, v11
    v_and_b32 v54, v4, v12
    v_and_b32 v55, v4, v13
    v_and_b32 v56, v5, v10
    v_and_b32 v57, v5, v11
    v_and_b32 v58, v5, v12
    v_and_b32 v59, v5, v13
    v_mfma_f32_16x16x32_bf16 v[60:63], a[156:159], v[52:55], v[60:63]
    s_nop 0
    v_mfma_f32_16x16x32_bf16 v[64:67], a[156:159], v[56:59], v[64:67]
    s_waitcnt vmcnt(13)
    s_waitcnt vmcnt(7)
    buffer_load_dwordx4 a[192:195], v14, s[40:43], s63 offen nt
    s_add_u32 s63, s63, 8192
    s_mov_b32 s52, s18
    s_and_b32 s53, s19, 0xffff
    s_mov_b32 s54, 134217728
    s_mov_b32 s55, 0x20000
    s_mov_b32 s56, s20
    s_and_b32 s57, s21, 0xffff
    s_mov_b32 s58, 134217728
    s_mov_b32 s59, 0x20000
    v_perm_b32 v4, v24, v24, s80
    v_perm_b32 v5, v40, v40, s80
    v_and_b32 v52, v4, v10
    v_and_b32 v53, v4, v11
    v_and_b32 v54, v4, v12
    v_and_b32 v55, v4, v13
    v_and_b32 v56, v5, v10
    v_and_b32 v57, v5, v11
    v_and_b32 v58, v5, v12
    v_and_b32 v59, v5, v13
    v_mfma_f32_16x16x32_bf16 v[60:63], a[160:163], v[52:55], v[60:63]
    s_nop 0
    v_mfma_f32_16x16x32_bf16 v[64:67], a[160:163], v[56:59], v[64:67]
    s_waitcnt vmcnt(7)
    buffer_load_dwordx4 a[196:199], v14, s[40:43], s63 offen nt
    s_add_u32 s63, s63, 8192
    v_perm_b32 v4, v24, v24, s81
    v_perm_b32 v5, v40, v40, s81
    v_and_b32 v52, v4, v10
    v_and_b32 v53, v4, v11
    v_and_b32 v54, v4, v12
    v_and_b32 v55, v4, v13
    v_and_b32 v56, v5, v10
    v_and_b32 v57, v5, v11
    v_and_b32 v58, v5, v12
    v_and_b32 v59, v5, v13
    v_mfma_f32_16x16x32_bf16 v[60:63], a[164:167], v[52:55], v[60:63]
    s_nop 0
    v_mfma_f32_16x16x32_bf16 v[64:67], a[164:167], v[56:59], v[64:67]
    s_waitcnt vmcnt(7)
    buffer_load_dwordx4 a[200:203], v14, s[40:43], s63 offen nt
    s_add_u32 s63, s63, 8192
    v_perm_b32 v4, v25, v25, s80
    v_perm_b32 v5, v41, v41, s80
    v_and_b32 v52, v4, v10
    v_and_b32 v53, v4, v11
    v_and_b32 v54, v4, v12
    v_and_b32 v55, v4, v13
    v_and_b32 v56, v5, v10
    v_and_b32 v57, v5, v11
    v_and_b32 v58, v5, v12
    v_and_b32 v59, v5, v13
    v_mfma_f32_16x16x32_bf16 v[60:63], a[168:171], v[52:55], v[60:63]
    s_nop 0
    v_mfma_f32_16x16x32_bf16 v[64:67], a[168:171], v[56:59], v[64:67]
    s_waitcnt vmcnt(7)
    buffer_load_dwordx4 a[204:207], v14, s[40:43], s63 offen nt
    s_add_u32 s63, s63, 8192
    v_perm_b32 v4, v25, v25, s81
    v_perm_b32 v5, v41, v41, s81
    v_and_b32 v52, v4, v10
    v_and_b32 v53, v4, v11
    v_and_b32 v54, v4, v12
    v_and_b32 v55, v4, v13
    v_and_b32 v56, v5, v10
    v_and_b32 v57, v5, v11
    v_and_b32 v58, v5, v12
    v_and_b32 v59, v5, v13
    v_mfma_f32_16x16x32_bf16 v[60:63], a[172:175], v[52:55], v[60:63]
    s_nop 0
    v_mfma_f32_16x16x32_bf16 v[64:67], a[172:175], v[56:59], v[64:67]
    s_waitcnt vmcnt(7)
    buffer_load_dwordx4 a[208:211], v14, s[40:43], s63 offen nt
    s_add_u32 s63, s63, 8192
    v_mov_b32 v120, 0xff7f0000
    v_mov_b32 v121, 0
    v_mov_b32 v18, 1
    v_mov_b32 v116, 0
    v_mov_b32 v117, 0
    v_mov_b32 v118, 0
    v_mov_b32 v119, 0
    s_lshl_b32 s38, s32, 2
    s_add_u32 s38, s38, s3
    s_lshl_b32 s96, s38, 3
    s_lshl_b32 s38, s38, 8
    s_add_u32 s38, s38, 65536
    v_mov_b32 v9, s38
    s_add_u32 s96, s96, s33
    s_lshl_b32 s96, s96, 10
    s_add_u32 s96, s96, 5242880
    v_and_b32 v5, 3, v3
    v_lshlrev_b32 v78, 7, v2
    v_lshl_add_u32 v78, v5, 5, v78
    s_lshl_b32 s91, s32, 12
    s_lshl_b32 s38, s3, 9
    s_add_u32 s91, s91, s38
    s_add_u32 s91, s91, 1048576
    v_lshlrev_b32 v4, 7, v2
    v_lshl_add_u32 v4, v3, 4, v4
    v_mov_b32 v5, 512
    v_cmp_gt_u32 vcc, 8, v3
    s_nop 1
    v_cndmask_b32 v79, v5, v4, vcc
    v_perm_b32 v4, v26, v26, s80
    v_perm_b32 v5, v42, v42, s80
    v_and_b32 v52, v4, v10
    v_and_b32 v53, v4, v11
    v_and_b32 v54, v4, v12
    v_and_b32 v55, v4, v13
    v_and_b32 v56, v5, v10
    v_and_b32 v57, v5, v11
    v_and_b32 v58, v5, v12
    v_and_b32 v59, v5, v13
    v_mfma_f32_16x16x32_bf16 v[60:63], a[176:179], v[52:55], v[60:63]
    s_nop 0
    v_mfma_f32_16x16x32_bf16 v[64:67], a[176:179], v[56:59], v[64:67]
    s_waitcnt vmcnt(7)
    buffer_load_dwordx4 a[212:215], v14, s[40:43], s63 offen nt
    s_add_u32 s63, s63, 8192
    v_perm_b32 v4, v26, v26, s81
    v_perm_b32 v5, v42, v42, s81
    v_and_b32 v52, v4, v10
    v_and_b32 v53, v4, v11
    v_and_b32 v54, v4, v12
    v_and_b32 v55, v4, v13
    v_and_b32 v56, v5, v10
    v_and_b32 v57, v5, v11
    v_and_b32 v58, v5, v12
    v_and_b32 v59, v5, v13
    v_mfma_f32_16x16x32_bf16 v[60:63], a[180:183], v[52:55], v[60:63]
    s_nop 0
    v_mfma_f32_16x16x32_bf16 v[64:67], a[180:183], v[56:59], v[64:67]
    s_waitcnt vmcnt(7)
    buffer_load_dwordx4 a[216:219], v14, s[40:43], s63 offen nt
    s_add_u32 s63, s63, 8192
    v_perm_b32 v4, v27, v27, s80
    v_perm_b32 v5, v43, v43, s80
    v_and_b32 v52, v4, v10
    v_and_b32 v53, v4, v11
    v_and_b32 v54, v4, v12
    v_and_b32 v55, v4, v13
    v_and_b32 v56, v5, v10
    v_and_b32 v57, v5, v11
    v_and_b32 v58, v5, v12
    v_and_b32 v59, v5, v13
    v_mfma_f32_16x16x32_bf16 v[60:63], a[184:187], v[52:55], v[60:63]
    s_nop 0
    v_mfma_f32_16x16x32_bf16 v[64:67], a[184:187], v[56:59], v[64:67]
    s_waitcnt vmcnt(7)
    buffer_load_dwordx4 a[220:223], v14, s[40:43], s63 offen nt
    s_add_u32 s63, s63, 8192
    v_perm_b32 v4, v27, v27, s81
    v_perm_b32 v5, v43, v43, s81
    v_and_b32 v52, v4, v10
    v_and_b32 v53, v4, v11
    v_and_b32 v54, v4, v12
    v_and_b32 v55, v4, v13
    v_and_b32 v56, v5, v10
    v_and_b32 v57, v5, v11
    v_and_b32 v58, v5, v12
    v_and_b32 v59, v5, v13
    v_mfma_f32_16x16x32_bf16 v[60:63], a[188:191], v[52:55], v[60:63]
    s_nop 0
    v_mfma_f32_16x16x32_bf16 v[64:67], a[188:191], v[56:59], v[64:67]
    s_waitcnt vmcnt(7)
    buffer_load_dwordx4 a[224:227], v14, s[40:43], s63 offen nt
    s_add_u32 s63, s63, 8192
    v_perm_b32 v4, v28, v28, s80
    v_perm_b32 v5, v44, v44, s80
    v_and_b32 v52, v4, v10
    v_and_b32 v53, v4, v11
    v_and_b32 v54, v4, v12
    v_and_b32 v55, v4, v13
    v_and_b32 v56, v5, v10
    v_and_b32 v57, v5, v11
    v_and_b32 v58, v5, v12
    v_and_b32 v59, v5, v13
    v_mfma_f32_16x16x32_bf16 v[60:63], a[192:195], v[52:55], v[60:63]
    s_nop 0
    v_mfma_f32_16x16x32_bf16 v[64:67], a[192:195], v[56:59], v[64:67]
    s_waitcnt vmcnt(7)
    buffer_load_dwordx4 a[228:231], v14, s[40:43], s63 offen nt
    s_add_u32 s63, s63, 8192
    v_perm_b32 v4, v28, v28, s81
    v_perm_b32 v5, v44, v44, s81
    v_and_b32 v52, v4, v10
    v_and_b32 v53, v4, v11
    v_and_b32 v54, v4, v12
    v_and_b32 v55, v4, v13
    v_and_b32 v56, v5, v10
    v_and_b32 v57, v5, v11
    v_and_b32 v58, v5, v12
    v_and_b32 v59, v5, v13
    v_mfma_f32_16x16x32_bf16 v[60:63], a[196:199], v[52:55], v[60:63]
    s_nop 0
    v_mfma_f32_16x16x32_bf16 v[64:67], a[196:199], v[56:59], v[64:67]
    s_waitcnt vmcnt(7)
    buffer_load_dwordx4 a[232:235], v14, s[40:43], s63 offen nt
    s_add_u32 s63, s63, 8192
    v_perm_b32 v4, v29, v29, s80
    v_perm_b32 v5, v45, v45, s80
    v_and_b32 v52, v4, v10
    v_and_b32 v53, v4, v11
    v_and_b32 v54, v4, v12
    v_and_b32 v55, v4, v13
    v_and_b32 v56, v5, v10
    v_and_b32 v57, v5, v11
    v_and_b32 v58, v5, v12
    v_and_b32 v59, v5, v13
    v_mfma_f32_16x16x32_bf16 v[60:63], a[200:203], v[52:55], v[60:63]
    s_nop 0
    v_mfma_f32_16x16x32_bf16 v[64:67], a[200:203], v[56:59], v[64:67]
    s_waitcnt vmcnt(7)
    buffer_load_dwordx4 a[236:239], v14, s[40:43], s63 offen nt
    s_add_u32 s63, s63, 8192
    v_perm_b32 v4, v29, v29, s81
    v_perm_b32 v5, v45, v45, s81
    v_and_b32 v52, v4, v10
    v_and_b32 v53, v4, v11
    v_and_b32 v54, v4, v12
    v_and_b32 v55, v4, v13
    v_and_b32 v56, v5, v10
    v_and_b32 v57, v5, v11
    v_and_b32 v58, v5, v12
    v_and_b32 v59, v5, v13
    v_mfma_f32_16x16x32_bf16 v[60:63], a[204:207], v[52:55], v[60:63]
    s_nop 0
    v_mfma_f32_16x16x32_bf16 v[64:67], a[204:207], v[56:59], v[64:67]
    s_waitcnt vmcnt(7)
    buffer_load_dwordx4 a[240:243], v14, s[40:43], s63 offen nt
    s_add_u32 s63, s63, 8192
    v_perm_b32 v4, v30, v30, s80
    v_perm_b32 v5, v46, v46, s80
    v_and_b32 v52, v4, v10
    v_and_b32 v53, v4, v11
    v_and_b32 v54, v4, v12
    v_and_b32 v55, v4, v13
    v_and_b32 v56, v5, v10
    v_and_b32 v57, v5, v11
    v_and_b32 v58, v5, v12
    v_and_b32 v59, v5, v13
    v_mfma_f32_16x16x32_bf16 v[60:63], a[208:211], v[52:55], v[60:63]
    s_nop 0
    v_mfma_f32_16x16x32_bf16 v[64:67], a[208:211], v[56:59], v[64:67]
    s_waitcnt vmcnt(7)
    buffer_load_dwordx4 a[244:247], v14, s[40:43], s63 offen nt
    s_add_u32 s63, s63, 8192
    v_perm_b32 v4, v30, v30, s81
    v_perm_b32 v5, v46, v46, s81
    v_and_b32 v52, v4, v10
    v_and_b32 v53, v4, v11
    v_and_b32 v54, v4, v12
    v_and_b32 v55, v4, v13
    v_and_b32 v56, v5, v10
    v_and_b32 v57, v5, v11
    v_and_b32 v58, v5, v12
    v_and_b32 v59, v5, v13
    v_mfma_f32_16x16x32_bf16 v[60:63], a[212:215], v[52:55], v[60:63]
    s_nop 0
    v_mfma_f32_16x16x32_bf16 v[64:67], a[212:215], v[56:59], v[64:67]
    s_waitcnt vmcnt(7)
    buffer_load_dwordx4 a[248:251], v14, s[40:43], s63 offen nt
    s_add_u32 s63, s63, 8192
    v_perm_b32 v4, v31, v31, s80
    v_perm_b32 v5, v47, v47, s80
    v_and_b32 v52, v4, v10
    v_and_b32 v53, v4, v11
    v_and_b32 v54, v4, v12
    v_and_b32 v55, v4, v13
    v_and_b32 v56, v5, v10
    v_and_b32 v57, v5, v11
    v_and_b32 v58, v5, v12
    v_and_b32 v59, v5, v13
    v_mfma_f32_16x16x32_bf16 v[60:63], a[216:219], v[52:55], v[60:63]
    s_nop 0
    v_mfma_f32_16x16x32_bf16 v[64:67], a[216:219], v[56:59], v[64:67]
    s_waitcnt vmcnt(7)
    buffer_load_dwordx4 a[252:255], v14, s[40:43], s63 offen nt
    s_add_u32 s63, s63, 8192
    v_perm_b32 v4, v31, v31, s81
    v_perm_b32 v5, v47, v47, s81
    v_and_b32 v52, v4, v10
    v_and_b32 v53, v4, v11
    v_and_b32 v54, v4, v12
    v_and_b32 v55, v4, v13
    v_and_b32 v56, v5, v10
    v_and_b32 v57, v5, v11
    v_and_b32 v58, v5, v12
    v_and_b32 v59, v5, v13
    v_mfma_f32_16x16x32_bf16 v[60:63], a[220:223], v[52:55], v[60:63]
    s_nop 0
    v_mfma_f32_16x16x32_bf16 v[64:67], a[220:223], v[56:59], v[64:67]
    s_waitcnt vmcnt(7)
    v_perm_b32 v4, v32, v32, s80
    v_perm_b32 v5, v48, v48, s80
    v_and_b32 v52, v4, v10
    v_and_b32 v53, v4, v11
    v_and_b32 v54, v4, v12
    v_and_b32 v55, v4, v13
    v_and_b32 v56, v5, v10
    v_and_b32 v57, v5, v11
    v_and_b32 v58, v5, v12
    v_and_b32 v59, v5, v13
    v_mfma_f32_16x16x32_bf16 v[60:63], a[224:227], v[52:55], v[60:63]
    s_nop 0
    v_mfma_f32_16x16x32_bf16 v[64:67], a[224:227], v[56:59], v[64:67]
    s_waitcnt vmcnt(6)
    s_add_u32 s39, s87, s88
    s_bfe_u32 s37, s39, 0x30000
    s_lshl_b32 s37, s37, 12
    s_add_u32 s85, s37, s89
    s_bfe_u32 s37, s39, 0x10003
    s_lshl_b32 s37, s37, 11
    s_add_u32 s85, s37, s85
    s_bfe_u32 s37, s39, 0x40004
    s_lshl_b32 s37, s37, 16
    s_add_u32 s85, s37, s85
    buffer_load_dwordx4 v[128:131], v76, s[52:55], s85 offen offset:0 nt
    v_perm_b32 v4, v32, v32, s81
    v_perm_b32 v5, v48, v48, s81
    v_and_b32 v52, v4, v10
    v_and_b32 v53, v4, v11
    v_and_b32 v54, v4, v12
    v_and_b32 v55, v4, v13
    v_and_b32 v56, v5, v10
    v_and_b32 v57, v5, v11
    v_and_b32 v58, v5, v12
    v_and_b32 v59, v5, v13
    v_mfma_f32_16x16x32_bf16 v[60:63], a[228:231], v[52:55], v[60:63]
    s_nop 0
    v_mfma_f32_16x16x32_bf16 v[64:67], a[228:231], v[56:59], v[64:67]
    s_waitcnt vmcnt(6)
    buffer_load_dwordx4 v[132:135], v77, s[52:55], s85 offen offset:0 nt
    v_perm_b32 v4, v33, v33, s80
    v_perm_b32 v5, v49, v49, s80
    v_and_b32 v52, v4, v10
    v_and_b32 v53, v4, v11
    v_and_b32 v54, v4, v12
    v_and_b32 v55, v4, v13
    v_and_b32 v56, v5, v10
    v_and_b32 v57, v5, v11
    v_and_b32 v58, v5, v12
    v_and_b32 v59, v5, v13
    v_mfma_f32_16x16x32_bf16 v[60:63], a[232:235], v[52:55], v[60:63]
    s_nop 0
    v_mfma_f32_16x16x32_bf16 v[64:67], a[232:235], v[56:59], v[64:67]
    s_waitcnt vmcnt(6)
    buffer_load_dwordx4 v[136:139], v76, s[52:55], s85 offen offset:1024 nt
    v_perm_b32 v4, v33, v33, s81
    v_perm_b32 v5, v49, v49, s81
    v_and_b32 v52, v4, v10
    v_and_b32 v53, v4, v11
    v_and_b32 v54, v4, v12
    v_and_b32 v55, v4, v13
    v_and_b32 v56, v5, v10
    v_and_b32 v57, v5, v11
    v_and_b32 v58, v5, v12
    v_and_b32 v59, v5, v13
    v_mfma_f32_16x16x32_bf16 v[60:63], a[236:239], v[52:55], v[60:63]
    s_nop 0
    v_mfma_f32_16x16x32_bf16 v[64:67], a[236:239], v[56:59], v[64:67]
    s_waitcnt vmcnt(6)
    buffer_load_dwordx4 v[140:143], v77, s[52:55], s85 offen offset:1024 nt
    s_add_u32 s87, s87, 7
    s_add_u32 s39, s87, s88
    s_bfe_u32 s37, s39, 0x30000
    s_lshl_b32 s37, s37, 12
    s_add_u32 s85, s37, s89
    s_bfe_u32 s37, s39, 0x10003
    s_lshl_b32 s37, s37, 11
    s_add_u32 s85, s37, s85
    s_bfe_u32 s37, s39, 0x40004
    s_lshl_b32 s37, s37, 16
    s_add_u32 s85, s37, s85
    v_perm_b32 v4, v34, v34, s80
    v_perm_b32 v5, v50, v50, s80
    v_and_b32 v52, v4, v10
    v_and_b32 v53, v4, v11
    v_and_b32 v54, v4, v12
    v_and_b32 v55, v4, v13
    v_and_b32 v56, v5, v10
    v_and_b32 v57, v5, v11
    v_and_b32 v58, v5, v12
    v_and_b32 v59, v5, v13
    v_mfma_f32_16x16x32_bf16 v[60:63], a[240:243], v[52:55], v[60:63]
    s_nop 0
    v_mfma_f32_16x16x32_bf16 v[64:67], a[240:243], v[56:59], v[64:67]
    s_waitcnt vmcnt(6)
    buffer_load_dwordx4 v[144:147], v76, s[52:55], s85 offen offset:0 nt
    v_perm_b32 v4, v34, v34, s81
    v_perm_b32 v5, v50, v50, s81
    v_and_b32 v52, v4, v10
    v_and_b32 v53, v4, v11
    v_and_b32 v54, v4, v12
    v_and_b32 v55, v4, v13
    v_and_b32 v56, v5, v10
    v_and_b32 v57, v5, v11
    v_and_b32 v58, v5, v12
    v_and_b32 v59, v5, v13
    v_mfma_f32_16x16x32_bf16 v[60:63], a[244:247], v[52:55], v[60:63]
    s_nop 0
    v_mfma_f32_16x16x32_bf16 v[64:67], a[244:247], v[56:59], v[64:67]
    s_waitcnt vmcnt(6)
    buffer_load_dwordx4 v[148:151], v77, s[52:55], s85 offen offset:0 nt
    v_perm_b32 v4, v35, v35, s80
    v_perm_b32 v5, v51, v51, s80
    v_and_b32 v52, v4, v10
    v_and_b32 v53, v4, v11
    v_and_b32 v54, v4, v12
    v_and_b32 v55, v4, v13
    v_and_b32 v56, v5, v10
    v_and_b32 v57, v5, v11
    v_and_b32 v58, v5, v12
    v_and_b32 v59, v5, v13
    v_mfma_f32_16x16x32_bf16 v[60:63], a[248:251], v[52:55], v[60:63]
    s_nop 0
    v_mfma_f32_16x16x32_bf16 v[64:67], a[248:251], v[56:59], v[64:67]
    s_waitcnt vmcnt(6)
    buffer_load_dwordx4 v[152:155], v76, s[52:55], s85 offen offset:1024 nt
    v_perm_b32 v4, v35, v35, s81
    v_perm_b32 v5, v51, v51, s81
    v_and_b32 v52, v4, v10
    v_and_b32 v53, v4, v11
    v_and_b32 v54, v4, v12
    v_and_b32 v55, v4, v13
    v_and_b32 v56, v5, v10
    v_and_b32 v57, v5, v11
    v_and_b32 v58, v5, v12
    v_and_b32 v59, v5, v13
    v_mfma_f32_16x16x32_bf16 v[60:63], a[252:255], v[52:55], v[60:63]
    s_nop 0
    v_mfma_f32_16x16x32_bf16 v[64:67], a[252:255], v[56:59], v[64:67]
    s_lshl_b32 s38, s34, 11
    v_lshrrev_b32 v4, 3, v3
    v_lshlrev_b32 v4, 9, v4
    v_lshl_add_u32 v4, v2, 7, v4
    v_and_b32 v5, 7, v3
    v_lshl_add_u32 v4, v5, 2, v4
    v_add_u32 v4, s38, v4
    ds_write_b32 v4, v60 offset:0
    ds_write_b32 v4, v61 offset:32
    ds_write_b32 v4, v62 offset:64
    ds_write_b32 v4, v63 offset:96
    ds_write_b32 v4, v64 offset:1024
    ds_write_b32 v4, v65 offset:1056
    ds_write_b32 v4, v66 offset:1088
    ds_write_b32 v4, v67 offset:1120
    s_lshl_b32 s38, s34, 9
    v_and_b32 v5, 31, v1
    v_lshl_add_u32 v5, v5, 4, s38
    s_waitcnt lgkmcnt(0)
    s_add_u32 s35, s35, 0x5b
    s_and_b32 s35, s35, 0xff
    v_mov_b32 v8, s35
    s_barrier
    ds_read_b128 v[20:23], v5 offset:0
    ds_read_b128 v[24:27], v5 offset:2048
    ds_read_b128 v[28:31], v5 offset:4096
    ds_read_b128 v[32:35], v5 offset:6144
    s_lshl_b32 s38, s61, 1
    s_add_u32 s38, s38, s33
    s_lshl_b32 s38, s38, 11
    s_add_u32 s38, s38, 1048576
    s_waitcnt lgkmcnt(0)
    v_add_f32 v20, v20, v24
    v_add_f32 v28, v28, v32
    v_add_f32 v21, v21, v25
    v_add_f32 v29, v29, v33
    v_add_f32 v22, v22, v26
    v_add_f32 v30, v30, v34
    v_add_f32 v23, v23, v27
    v_add_f32 v31, v31, v35
    v_add_f32 v20, v20, v28
    v_add_f32 v21, v21, v29
    v_add_f32 v22, v22, v30
    v_add_f32 v23, v23, v31
    v_and_or_b32 v20, v20, s82, v8
    v_and_or_b32 v21, v21, s82, v8
    v_and_or_b32 v22, v22, s82, v8
    v_and_or_b32 v23, v23, s82, v8
    s_mov_b32 exec_lo, 0xffffffff
    s_mov_b32 exec_hi, 0x0
    buffer_store_dwordx4 v[20:23], v5, s[48:51], s38 offen sc1
    s_mov_b64 exec, -1
    s_waitcnt vmcnt(7)
    buffer_load_dwordx4 v[156:159], v77, s[52:55], s85 offen offset:1024 nt
    s_add_u32 s87, s87, 7
    s_add_u32 s39, s87, s88
    s_bfe_u32 s37, s39, 0x30000
    s_lshl_b32 s37, s37, 12
    s_add_u32 s85, s37, s89
    s_bfe_u32 s37, s39, 0x10003
    s_lshl_b32 s37, s37, 11
    s_add_u32 s85, s37, s85
    s_bfe_u32 s37, s39, 0x40004
    s_lshl_b32 s37, s37, 16
    s_add_u32 s85, s37, s85
    s_waitcnt vmcnt(7)
    buffer_load_dwordx4 v[160:163], v76, s[52:55], s85 offen offset:0 nt
    s_waitcnt vmcnt(7)
    buffer_load_dwordx4 v[164:167], v77, s[52:55], s85 offen offset:0 nt
    s_waitcnt vmcnt(7)
    buffer_load_dwordx4 v[168:171], v76, s[52:55], s85 offen offset:1024 nt
    s_waitcnt vmcnt(7)
    buffer_load_dwordx4 v[172:175], v77, s[52:55], s85 offen offset:1024 nt
    s_add_u32 s87, s87, 7
    s_add_u32 s39, s87, s88
    s_bfe_u32 s37, s39, 0x30000
    s_lshl_b32 s37, s37, 12
    s_add_u32 s85, s37, s89
    s_bfe_u32 s37, s39, 0x10003
    s_lshl_b32 s37, s37, 11
    s_add_u32 s85, s37, s85
    s_bfe_u32 s37, s39, 0x40004
    s_lshl_b32 s37, s37, 16
    s_add_u32 s85, s37, s85
    s_waitcnt vmcnt(7)
    buffer_load_dwordx4 v[176:179], v76, s[52:55], s85 offen offset:0 nt
    s_waitcnt vmcnt(7)
    buffer_load_dwordx4 v[180:183], v77, s[52:55], s85 offen offset:0 nt
    s_waitcnt vmcnt(6)
    buffer_load_dwordx4 v[184:187], v76, s[52:55], s85 offen offset:1024 nt
    s_waitcnt vmcnt(6)
    buffer_load_dwordx4 v[188:191], v77, s[52:55], s85 offen offset:1024 nt
    s_add_u32 s87, s87, 7
    s_add_u32 s39, s87, s88
    s_bfe_u32 s37, s39, 0x30000
    s_lshl_b32 s37, s37, 12
    s_add_u32 s85, s37, s89
    s_bfe_u32 s37, s39, 0x10003
    s_lshl_b32 s37, s37, 11
    s_add_u32 s85, s37, s85
    s_bfe_u32 s37, s39, 0x40004
    s_lshl_b32 s37, s37, 16
    s_add_u32 s85, s37, s85
    s_waitcnt vmcnt(6)
    buffer_load_dwordx4 v[192:195], v76, s[52:55], s85 offen offset:0 nt
    s_waitcnt vmcnt(6)
    buffer_load_dwordx4 v[196:199], v77, s[52:55], s85 offen offset:0 nt
    s_waitcnt vmcnt(6)
    buffer_load_dwordx4 v[200:203], v76, s[52:55], s85 offen offset:1024 nt
    s_waitcnt vmcnt(6)
    buffer_load_dwordx4 v[204:207], v77, s[52:55], s85 offen offset:1024 nt
    s_add_u32 s87, s87, 7
    s_add_u32 s39, s87, s88
    s_bfe_u32 s37, s39, 0x30000
    s_lshl_b32 s37, s37, 12
    s_add_u32 s85, s37, s89
    s_bfe_u32 s37, s39, 0x10003
    s_lshl_b32 s37, s37, 11
    s_add_u32 s85, s37, s85
    s_bfe_u32 s37, s39, 0x40004
    s_lshl_b32 s37, s37, 16
    s_add_u32 s85, s37, s85
    buffer_load_dwordx4 v[68:71], v78, s[48:51], s91 offen offset:0 sc1
    buffer_load_dwordx4 v[72:75], v78, s[48:51], s91 offen offset:16 sc1
    s_waitcnt vmcnt(8)
    buffer_load_dwordx4 v[208:211], v76, s[52:55], s85 offen offset:0 nt
    s_waitcnt vmcnt(8)
    buffer_load_dwordx4 v[212:215], v77, s[52:55], s85 offen offset:0 nt
    s_waitcnt vmcnt(8)
    buffer_load_dwordx4 v[216:219], v76, s[52:55], s85 offen offset:1024 nt
    s_waitcnt vmcnt(8)
    buffer_load_dwordx4 v[220:223], v77, s[52:55], s85 offen offset:1024 nt
    s_add_u32 s87, s87, 7
    s_add_u32 s39, s87, s88
    s_bfe_u32 s37, s39, 0x30000
    s_lshl_b32 s37, s37, 12
    s_add_u32 s85, s37, s89
    s_bfe_u32 s37, s39, 0x10003
    s_lshl_b32 s37, s37, 11
    s_add_u32 s85, s37, s85
    s_bfe_u32 s37, s39, 0x40004
    s_lshl_b32 s37, s37, 16
    s_add_u32 s85, s37, s85
    s_waitcnt vmcnt(8)
    buffer_load_dwordx4 v[224:227], v76, s[52:55], s85 offen offset:0 nt
    s_waitcnt vmcnt(8)
    buffer_load_dwordx4 v[228:231], v77, s[52:55], s85 offen offset:0 nt
    s_waitcnt vmcnt(6)
L_qcheck_15:
    v_xor_b32 v68, s35, v68
    v_xor_b32 v69, s35, v69
    v_xor_b32 v70, s35, v70
    v_xor_b32 v71, s35, v71
    v_xor_b32 v72, s35, v72
    v_xor_b32 v73, s35, v73
    v_xor_b32 v74, s35, v74
    v_xor_b32 v75, s35, v75
    v_or_b32 v4, v68, v69
    v_or3_b32 v4, v4, v70, v71
    v_or3_b32 v4, v4, v72, v73
    v_or3_b32 v4, v4, v74, v75
    v_and_b32 v4, 0xff, v4
    v_cmp_ne_u32 vcc, 0, v4
    s_cbranch_vccz L_qok_16
    buffer_load_dwordx4 v[68:71], v78, s[48:51], s91 offen offset:0 sc1
    buffer_load_dwordx4 v[72:75], v78, s[48:51], s91 offen offset:16 sc1
    s_waitcnt vmcnt(0)
    s_sub_u32 s84, s84, 1
    s_cmp_lg_u32 s84, 0
    s_cbranch_scc1 L_qcheck_15
    s_branch L_end
L_qok_16:
    v_cvt_pk_bf16_f32 v68, v68, v69
    v_cvt_pk_bf16_f32 v69, v70, v71
    v_cvt_pk_bf16_f32 v70, v72, v73
    v_cvt_pk_bf16_f32 v71, v74, v75
    s_mov_b32 vcc_lo, 0xf000f
    s_mov_b32 vcc_hi, 0xf000f
    v_cndmask_b32 v80, 0, v68, vcc
    v_cndmask_b32 v81, 0, v69, vcc
    v_cndmask_b32 v82, 0, v70, vcc
    v_cndmask_b32 v83, 0, v71, vcc
    s_mov_b32 vcc_lo, 0xf000f0
    s_mov_b32 vcc_hi, 0xf000f0
    v_cndmask_b32 v84, 0, v68, vcc
    v_cndmask_b32 v85, 0, v69, vcc
    v_cndmask_b32 v86, 0, v70, vcc
    v_cndmask_b32 v87, 0, v71, vcc
    s_mov_b32 vcc_lo, 0xf000f00
    s_mov_b32 vcc_hi, 0xf000f00
    v_cndmask_b32 v88, 0, v68, vcc
    v_cndmask_b32 v89, 0, v69, vcc
    v_cndmask_b32 v90, 0, v70, vcc
    v_cndmask_b32 v91, 0, v71, vcc
    s_mov_b32 vcc_lo, 0xf000f000
    s_mov_b32 vcc_hi, 0xf000f000
    v_cndmask_b32 v92, 0, v68, vcc
    v_cndmask_b32 v93, 0, v69, vcc
    v_cndmask_b32 v94, 0, v70, vcc
    v_cndmask_b32 v95, 0, v71, vcc
    v_mov_b32 v65, 0xff7f0000
    s_lshl_b32 s38, s34, 14
    s_add_u32 s38, s38, 16384
    v_lshl_add_u32 v64, v1, 2, s38
    buffer_load_dwordx4 v[232:235], v76, s[52:55], s85 offen offset:1024 nt
    v_mfma_f32_16x16x32_bf16 v[112:115], v[128:131], v[80:83], 0
    v_mfma_f32_16x16x32_bf16 v[112:115], v[132:135], v[84:87], v[112:115]
    s_waitcnt vmcnt(6)
    buffer_load_dwordx4 v[236:239], v77, s[52:55], s85 offen offset:1024 nt
    s_add_u32 s87, s87, 7
    s_add_u32 s39, s87, s88
    s_bfe_u32 s37, s39, 0x30000
    s_lshl_b32 s37, s37, 12
    s_add_u32 s85, s37, s89
    s_bfe_u32 s37, s39, 0x10003
    s_lshl_b32 s37, s37, 11
    s_add_u32 s85, s37, s85
    s_bfe_u32 s37, s39, 0x40004
    s_lshl_b32 s37, s37, 16
    s_add_u32 s85, s37, s85
    v_mfma_f32_16x16x32_bf16 v[112:115], v[136:139], v[88:91], v[112:115]
    v_mfma_f32_16x16x32_bf16 v[112:115], v[140:143], v[92:95], v[112:115]
    v_mfma_f32_16x16x32_bf16 v[96:99], v[144:147], v[80:83], 0
    s_waitcnt vmcnt(6)
    buffer_load_dwordx4 v[240:243], v76, s[52:55], s85 offen offset:0 nt
    v_mfma_f32_16x16x32_bf16 v[96:99], v[148:151], v[84:87], v[96:99]
    v_mfma_f32_16x16x32_bf16 v[96:99], v[152:155], v[88:91], v[96:99]
    s_nop 2
    v_mov_b32_dpp v122, v112 quad_perm:[0,0,0,0] row_mask:0xf bank_mask:0xf
    v_mov_b32_dpp v124, v114 quad_perm:[2,2,2,2] row_mask:0xf bank_mask:0xf
    s_nop 0
    v_add_f32_dpp v122, v113, v122 quad_perm:[1,1,1,1] row_mask:0xf bank_mask:0xf
    v_add_f32_dpp v124, v115, v124 quad_perm:[3,3,3,3] row_mask:0xf bank_mask:0xf
    v_add_f32 v122, v122, v124
    v_max_f32 v65, v65, v122
    ds_write_b32 v64, v122 offset:0
    v_mfma_f32_16x16x32_bf16 v[96:99], v[156:159], v[92:95], v[96:99]
    s_waitcnt vmcnt(6)
    buffer_load_dwordx4 v[244:247], v77, s[52:55], s85 offen offset:0 nt
    v_mfma_f32_16x16x32_bf16 v[112:115], v[160:163], v[80:83], 0
    v_mfma_f32_16x16x32_bf16 v[112:115], v[164:167], v[84:87], v[112:115]
    v_mfma_f32_16x16x32_bf16 v[112:115], v[168:171], v[88:91], v[112:115]
    s_nop 2
    v_mov_b32_dpp v122, v96 quad_perm:[0,0,0,0] row_mask:0xf bank_mask:0xf
    v_mov_b32_dpp v124, v98 quad_perm:[2,2,2,2] row_mask:0xf bank_mask:0xf
    s_nop 0
    v_add_f32_dpp v122, v97, v122 quad_perm:[1,1,1,1] row_mask:0xf bank_mask:0xf
    v_add_f32_dpp v124, v99, v124 quad_perm:[3,3,3,3] row_mask:0xf bank_mask:0xf
    v_add_f32 v122, v122, v124
    v_max_f32 v65, v65, v122
    ds_write_b32 v64, v122 offset:256
    s_waitcnt vmcnt(6)
    buffer_load_dwordx4 v[248:251], v76, s[52:55], s85 offen offset:1024 nt
    v_mfma_f32_16x16x32_bf16 v[112:115], v[172:175], v[92:95], v[112:115]
    v_mfma_f32_16x16x32_bf16 v[96:99], v[176:179], v[80:83], 0
    v_mfma_f32_16x16x32_bf16 v[96:99], v[180:183], v[84:87], v[96:99]
    s_waitcnt vmcnt(6)
    buffer_load_dwordx4 v[252:255], v77, s[52:55], s85 offen offset:1024 nt
    s_add_u32 s87, s87, 7
    s_add_u32 s39, s87, s88
    s_bfe_u32 s37, s39, 0x30000
    s_lshl_b32 s37, s37, 12
    s_add_u32 s85, s37, s89
    s_bfe_u32 s37, s39, 0x10003
    s_lshl_b32 s37, s37, 11
    s_add_u32 s85, s37, s85
    s_bfe_u32 s37, s39, 0x40004
    s_lshl_b32 s37, s37, 16
    s_add_u32 s85, s37, s85
    v_mfma_f32_16x16x32_bf16 v[96:99], v[184:187], v[88:91], v[96:99]
    v_mov_b32_dpp v122, v112 quad_perm:[0,0,0,0] row_mask:0xf bank_mask:0xf
    v_mov_b32_dpp v124, v114 quad_perm:[2,2,2,2] row_mask:0xf bank_mask:0xf
    s_nop 0
    v_add_f32_dpp v122, v113, v122 quad_perm:[1,1,1,1] row_mask:0xf bank_mask:0xf
    v_add_f32_dpp v124, v115, v124 quad_perm:[3,3,3,3] row_mask:0xf bank_mask:0xf
    v_add_f32 v122, v122, v124
    v_max_f32 v65, v65, v122
    ds_write_b32 v64, v122 offset:512
    v_mfma_f32_16x16x32_bf16 v[96:99], v[188:191], v[92:95], v[96:99]
    v_mfma_f32_16x16x32_bf16 v[112:115], v[192:195], v[80:83], 0
    s_waitcnt vmcnt(5)
    buffer_load_dwordx4 v[128:131], v76, s[52:55], s85 offen offset:0 nt
    v_mfma_f32_16x16x32_bf16 v[112:115], v[196:199], v[84:87], v[112:115]
    v_mfma_f32_16x16x32_bf16 v[112:115], v[200:203], v[88:91], v[112:115]
    s_nop 2
    v_mov_b32_dpp v122, v96 quad_perm:[0,0,0,0] row_mask:0xf bank_mask:0xf
    v_mov_b32_dpp v124, v98 quad_perm:[2,2,2,2] row_mask:0xf bank_mask:0xf
    s_nop 0
    v_add_f32_dpp v122, v97, v122 quad_perm:[1,1,1,1] row_mask:0xf bank_mask:0xf
    v_add_f32_dpp v124, v99, v124 quad_perm:[3,3,3,3] row_mask:0xf bank_mask:0xf
    v_add_f32 v122, v122, v124
    v_max_f32 v65, v65, v122
    ds_write_b32 v64, v122 offset:768
    v_mfma_f32_16x16x32_bf16 v[112:115], v[204:207], v[92:95], v[112:115]
    s_waitcnt vmcnt(5)
    buffer_load_dwordx4 v[132:135], v77, s[52:55], s85 offen offset:0 nt
    v_mfma_f32_16x16x32_bf16 v[96:99], v[208:211], v[80:83], 0
    v_mfma_f32_16x16x32_bf16 v[96:99], v[212:215], v[84:87], v[96:99]
    v_mfma_f32_16x16x32_bf16 v[96:99], v[216:219], v[88:91], v[96:99]
    s_nop 2
    v_mov_b32_dpp v122, v112 quad_perm:[0,0,0,0] row_mask:0xf bank_mask:0xf
    v_mov_b32_dpp v124, v114 quad_perm:[2,2,2,2] row_mask:0xf bank_mask:0xf
    s_nop 0
    v_add_f32_dpp v122, v113, v122 quad_perm:[1,1,1,1] row_mask:0xf bank_mask:0xf
    v_add_f32_dpp v124, v115, v124 quad_perm:[3,3,3,3] row_mask:0xf bank_mask:0xf
    v_add_f32 v122, v122, v124
    v_max_f32 v65, v65, v122
    ds_write_b32 v64, v122 offset:1024
    s_waitcnt vmcnt(5)
    buffer_load_dwordx4 v[136:139], v76, s[52:55], s85 offen offset:1024 nt
    v_mfma_f32_16x16x32_bf16 v[96:99], v[220:223], v[92:95], v[96:99]
    v_mfma_f32_16x16x32_bf16 v[112:115], v[224:227], v[80:83], 0
    v_mfma_f32_16x16x32_bf16 v[112:115], v[228:231], v[84:87], v[112:115]
    s_waitcnt vmcnt(5)
    buffer_load_dwordx4 v[140:143], v77, s[52:55], s85 offen offset:1024 nt
    s_add_u32 s87, s87, 7
    s_add_u32 s39, s87, s88
    s_bfe_u32 s37, s39, 0x30000
    s_lshl_b32 s37, s37, 12
    s_add_u32 s85, s37, s89
    s_bfe_u32 s37, s39, 0x10003
    s_lshl_b32 s37, s37, 11
    s_add_u32 s85, s37, s85
    s_bfe_u32 s37, s39, 0x40004
    s_lshl_b32 s37, s37, 16
    s_add_u32 s85, s37, s85
    v_mfma_f32_16x16x32_bf16 v[112:115], v[232:235], v[88:91], v[112:115]
    v_mov_b32_dpp v122, v96 quad_perm:[0,0,0,0] row_mask:0xf bank_mask:0xf
    v_mov_b32_dpp v124, v98 quad_perm:[2,2,2,2] row_mask:0xf bank_mask:0xf
    s_nop 0
    v_add_f32_dpp v122, v97, v122 quad_perm:[1,1,1,1] row_mask:0xf bank_mask:0xf
    v_add_f32_dpp v124, v99, v124 quad_perm:[3,3,3,3] row_mask:0xf bank_mask:0xf
    v_add_f32 v122, v122, v124
    v_max_f32 v65, v65, v122
    ds_write_b32 v64, v122 offset:1280
    v_mfma_f32_16x16x32_bf16 v[112:115], v[236:239], v[92:95], v[112:115]
    v_mfma_f32_16x16x32_bf16 v[96:99], v[240:243], v[80:83], 0
    s_waitcnt vmcnt(5)
    buffer_load_dwordx4 v[144:147], v76, s[52:55], s85 offen offset:0 nt
    v_mfma_f32_16x16x32_bf16 v[96:99], v[244:247], v[84:87], v[96:99]
    v_mfma_f32_16x16x32_bf16 v[96:99], v[248:251], v[88:91], v[96:99]
    s_nop 2
    v_mov_b32_dpp v122, v112 quad_perm:[0,0,0,0] row_mask:0xf bank_mask:0xf
    v_mov_b32_dpp v124, v114 quad_perm:[2,2,2,2] row_mask:0xf bank_mask:0xf
    s_nop 0
    v_add_f32_dpp v122, v113, v122 quad_perm:[1,1,1,1] row_mask:0xf bank_mask:0xf
    v_add_f32_dpp v124, v115, v124 quad_perm:[3,3,3,3] row_mask:0xf bank_mask:0xf
    v_add_f32 v122, v122, v124
    v_max_f32 v65, v65, v122
    ds_write_b32 v64, v122 offset:1536
    s_waitcnt vmcnt(5)
    v_mfma_f32_16x16x32_bf16 v[96:99], v[252:255], v[92:95], v[96:99]
    v_add_u32 v64, 1792, v64
    s_mov_b32 s97, 11
    s_mov_b32 s86, 30
    s_add_u32 s92, s33, 238
    s_mov_b32 s66, 134217728
    s_mov_b32 s67, 0x20000
    s_mov_b64 s[64:65], s[52:53]
    v_mov_b32 v62, v76
    v_mov_b32 v63, v77
    s_branch L_bloop
L_ql:
    v_lshrrev_b32 v4, 2, v3
    v_and_b32 v5, 3, v3
    v_lshlrev_b32 v19, 6, v2
    v_lshl_add_u32 v19, v5, 4, v19
    v_lshl_add_u32 v14, v4, 18, v19
    s_lshl_b32 s63, s34, 20
    s_lshl_b32 s38, s32, 8
    s_add_u32 s63, s63, s38
    s_mov_b32 s74, 4194304
    s_mov_b32 s75, 0x20000
    s_waitcnt lgkmcnt(0)
    s_mov_b64 s[72:73], s[10:11]
    buffer_load_dwordx4 a[0:3], v14, s[72:75], s63 offen nt
    s_add_u32 s63, s63, 8192
    buffer_load_dwordx4 a[4:7], v14, s[72:75], s63 offen nt
    s_add_u32 s63, s63, 8192
    buffer_load_dwordx4 a[8:11], v14, s[72:75], s63 offen nt
    s_add_u32 s63, s63, 8192
    buffer_load_dwordx4 a[12:15], v14, s[72:75], s63 offen nt
    s_add_u32 s63, s63, 8192
    buffer_load_dwordx4 a[16:19], v14, s[72:75], s63 offen nt
    s_add_u32 s63, s63, 8192
    buffer_load_dwordx4 a[20:23], v14, s[72:75], s63 offen nt
    s_add_u32 s63, s63, 8192
    buffer_load_dwordx4 a[24:27], v14, s[72:75], s63 offen nt
    s_add_u32 s63, s63, 8192
    buffer_load_dwordx4 a[28:31], v14, s[72:75], s63 offen nt
    s_add_u32 s63, s63, 8192
    v_lshlrev_b32 v15, 1, v19
    v_lshl_add_u32 v15, v4, 9, v15
    v_lshl_add_u32 v19, v4, 15, v19
    s_getpc_b64 s[36:37]
L_pc_17:
    s_sub_u32 s36, s36, L_pc_17 - concat_heads__compressed_kv_cla__mha_block_cached__decode_kernel
    s_subb_u32 s37, s37, 0
    s_lshl_b32 s38, s32, 10
    v_lshl_add_u32 v6, v0, 2, s38
    v_mov_b32 v7, s37
    v_add_co_u32 v6, vcc, s36, v6
    s_nop 1
    v_addc_co_u32 v7, vcc, 0, v7, vcc
    global_load_dword v0, v[6:7], off
    s_load_dword s35, s[30:31], 0
    s_mov_b32 s48, s30
    s_and_b32 s49, s31, 0xffff
    s_mov_b32 s50, 8388608
    s_mov_b32 s51, 0x20000
    s_mov_b32 s82, 0xffffff00
    s_mov_b32 s83, 0x3e0293ee
    s_mov_b32 s84, 2097152
    s_lshl_b32 s95, s32, 12
    s_add_u32 s95, s95, 1050624
    s_lshl_b32 s94, s32, 10
    s_lshl_b32 s38, s34, 8
    s_add_u32 s94, s94, s38
    s_add_u32 s94, s94, 2097152
    s_waitcnt vmcnt(8)
    buffer_load_dwordx4 a[32:35], v14, s[72:75], s63 offen nt
    s_add_u32 s63, s63, 8192
    s_waitcnt vmcnt(8)
    buffer_load_dwordx4 a[36:39], v14, s[72:75], s63 offen nt
    s_add_u32 s63, s63, 8192
    s_waitcnt vmcnt(8)
    buffer_load_dwordx4 a[40:43], v14, s[72:75], s63 offen nt
    s_add_u32 s63, s63, 8192
    s_waitcnt vmcnt(8)
    buffer_load_dwordx4 a[44:47], v14, s[72:75], s63 offen nt
    s_add_u32 s63, s63, 8192
    s_waitcnt vmcnt(8)
    buffer_load_dwordx4 a[48:51], v14, s[72:75], s63 offen nt
    s_add_u32 s63, s63, 8192
    v_and_b32 v4, 1, v1
    v_lshlrev_b32 v4, 4, v4
    v_mov_b32 v5, 0xffff
    v_lshlrev_b32 v4, v4, v5
    v_bfe_u32 v5, v1, 1, 2
    v_cmp_eq_u32 vcc, 0, v5
    s_nop 1
    v_cndmask_b32 v10, 0, v4, vcc
    v_cmp_eq_u32 vcc, 1, v5
    s_nop 1
    v_cndmask_b32 v11, 0, v4, vcc
    v_cmp_eq_u32 vcc, 2, v5
    s_nop 1
    v_cndmask_b32 v12, 0, v4, vcc
    v_cmp_eq_u32 vcc, 3, v5
    s_nop 1
    v_cndmask_b32 v13, 0, v4, vcc
    s_waitcnt vmcnt(8)
    buffer_load_dwordx4 a[52:55], v14, s[72:75], s63 offen nt
    s_add_u32 s63, s63, 8192
    s_waitcnt vmcnt(8)
    buffer_load_dwordx4 a[56:59], v14, s[72:75], s63 offen nt
    s_add_u32 s63, s63, 8192
    s_waitcnt vmcnt(8)
    buffer_load_dwordx4 a[60:63], v14, s[72:75], s63 offen nt
    s_add_u32 s63, s63, 8192
    s_waitcnt vmcnt(7)
    buffer_load_dwordx4 a[64:67], v14, s[72:75], s63 offen nt
    s_add_u32 s63, s63, 8192
    v_lshrrev_b32 v4, 2, v3
    v_and_b32 v5, 3, v3
    v_lshlrev_b32 v76, 8, v4
    v_lshlrev_b32 v126, 8, v2
    v_lshl_add_u32 v76, v2, 6, v76
    v_lshl_add_u32 v76, v5, 4, v76
    v_lshl_add_u32 v126, v3, 4, v126
    v_xor_b32 v77, 32768, v76
    v_xor_b32 v127, 32768, v126
    s_add_u32 s3, s34, s33
    s_and_b32 s3, s3, 3
    s_lshl_b32 s89, s3, 5
    s_add_u32 s89, s89, s32
    s_lshl_b32 s89, s89, 20
    s_mul_i32 s88, s32, 8
    s_add_u32 s88, s88, s3
    s_add_u32 s87, s33, 28
    s_waitcnt vmcnt(7)
    buffer_load_dwordx4 a[68:71], v14, s[72:75], s63 offen nt
    s_add_u32 s63, s63, 8192
    s_waitcnt vmcnt(7)
    buffer_load_dwordx4 a[72:75], v14, s[72:75], s63 offen nt
    s_add_u32 s63, s63, 8192
    s_waitcnt vmcnt(7)
    buffer_load_dwordx4 a[76:79], v14, s[72:75], s63 offen nt
    s_add_u32 s63, s63, 8192
    s_waitcnt vmcnt(7)
    buffer_load_dwordx4 a[80:83], v14, s[72:75], s63 offen nt
    s_add_u32 s63, s63, 8192
    s_mov_b32 s52, s18
    s_and_b32 s53, s19, 0xffff
    s_mov_b32 s54, 134217728
    s_mov_b32 s55, 0x20000
    s_mov_b32 s56, s20
    s_and_b32 s57, s21, 0xffff
    s_mov_b32 s58, 134217728
    s_mov_b32 s59, 0x20000
    s_waitcnt vmcnt(7)
    buffer_load_dwordx4 a[84:87], v14, s[72:75], s63 offen nt
    s_add_u32 s63, s63, 8192
    s_waitcnt vmcnt(7)
    buffer_load_dwordx4 a[88:91], v14, s[72:75], s63 offen nt
    s_add_u32 s63, s63, 8192
    s_waitcnt vmcnt(7)
    buffer_load_dwordx4 a[92:95], v14, s[72:75], s63 offen nt
    s_add_u32 s63, s63, 8192
    s_waitcnt vmcnt(7)
    buffer_load_dwordx4 a[96:99], v14, s[72:75], s63 offen nt
    s_add_u32 s63, s63, 8192
    v_mov_b32 v120, 0xff7f0000
    v_mov_b32 v121, 0
    v_mov_b32 v18, 1
    v_mov_b32 v116, 0
    v_mov_b32 v117, 0
    v_mov_b32 v118, 0
    v_mov_b32 v119, 0
    s_lshl_b32 s38, s32, 2
    s_add_u32 s38, s38, s3
    s_lshl_b32 s96, s38, 3
    s_lshl_b32 s38, s38, 8
    s_add_u32 s38, s38, 65536
    v_mov_b32 v9, s38
    s_add_u32 s96, s96, s33
    s_lshl_b32 s96, s96, 10
    s_add_u32 s96, s96, 5242880
    v_and_b32 v5, 3, v3
    v_lshlrev_b32 v78, 7, v2
    v_lshl_add_u32 v78, v5, 5, v78
    s_lshl_b32 s91, s32, 12
    s_lshl_b32 s38, s3, 9
    s_add_u32 s91, s91, s38
    s_add_u32 s91, s91, 1048576
    v_lshlrev_b32 v4, 7, v2
    v_lshl_add_u32 v4, v3, 4, v4
    v_mov_b32 v5, 512
    v_cmp_gt_u32 vcc, 8, v3
    s_nop 1
    v_cndmask_b32 v79, v5, v4, vcc
    s_waitcnt vmcnt(7)
    buffer_load_dwordx4 a[100:103], v14, s[72:75], s63 offen nt
    s_add_u32 s63, s63, 8192
    s_waitcnt vmcnt(7)
    buffer_load_dwordx4 a[104:107], v14, s[72:75], s63 offen nt
    s_add_u32 s63, s63, 8192
    s_waitcnt vmcnt(7)
    buffer_load_dwordx4 a[108:111], v14, s[72:75], s63 offen nt
    s_add_u32 s63, s63, 8192
    s_waitcnt vmcnt(7)
    buffer_load_dwordx4 a[112:115], v14, s[72:75], s63 offen nt
    s_add_u32 s63, s63, 8192
    s_waitcnt vmcnt(7)
    buffer_load_dwordx4 a[116:119], v14, s[72:75], s63 offen nt
    s_add_u32 s63, s63, 8192
    s_waitcnt vmcnt(7)
    buffer_load_dwordx4 a[120:123], v14, s[72:75], s63 offen nt
    s_add_u32 s63, s63, 8192
    s_waitcnt vmcnt(7)
    buffer_load_dwordx4 a[124:127], v14, s[72:75], s63 offen nt
    s_add_u32 s63, s63, 8192
    s_waitcnt lgkmcnt(0)
    s_add_u32 s35, s35, 0x5b
    s_and_b32 s35, s35, 0xff
    v_mov_b32 v8, s35
    s_or_b32 s68, s35, 0x6b3ac500
    s_waitcnt vmcnt(6)
    s_add_u32 s39, s87, s88
    s_bfe_u32 s37, s39, 0x30000
    s_lshl_b32 s37, s37, 12
    s_add_u32 s85, s37, s89
    s_bfe_u32 s37, s39, 0x10003
    s_lshl_b32 s37, s37, 11
    s_add_u32 s85, s37, s85
    s_bfe_u32 s37, s39, 0x40004
    s_lshl_b32 s37, s37, 16
    s_add_u32 s85, s37, s85
    buffer_load_dwordx4 v[128:131], v76, s[52:55], s85 offen offset:0 nt
    s_waitcnt vmcnt(6)
    buffer_load_dwordx4 v[132:135], v77, s[52:55], s85 offen offset:0 nt
    s_waitcnt vmcnt(6)
    buffer_load_dwordx4 v[136:139], v76, s[52:55], s85 offen offset:1024 nt
    s_waitcnt vmcnt(6)
    buffer_load_dwordx4 v[140:143], v77, s[52:55], s85 offen offset:1024 nt
    s_add_u32 s87, s87, 7
    s_add_u32 s39, s87, s88
    s_bfe_u32 s37, s39, 0x30000
    s_lshl_b32 s37, s37, 12
    s_add_u32 s85, s37, s89
    s_bfe_u32 s37, s39, 0x10003
    s_lshl_b32 s37, s37, 11
    s_add_u32 s85, s37, s85
    s_bfe_u32 s37, s39, 0x40004
    s_lshl_b32 s37, s37, 16
    s_add_u32 s85, s37, s85
    s_waitcnt vmcnt(6)
    buffer_load_dwordx4 v[144:147], v76, s[52:55], s85 offen offset:0 nt
    s_waitcnt vmcnt(6)
    buffer_load_dwordx4 v[148:151], v77, s[52:55], s85 offen offset:0 nt
    s_waitcnt vmcnt(6)
    buffer_load_dwordx4 v[152:155], v76, s[52:55], s85 offen offset:1024 nt
    s_waitcnt vmcnt(6)
    buffer_load_dwordx4 v[156:159], v77, s[52:55], s85 offen offset:1024 nt
    s_add_u32 s87, s87, 7
    s_add_u32 s39, s87, s88
    s_bfe_u32 s37, s39, 0x30000
    s_lshl_b32 s37, s37, 12
    s_add_u32 s85, s37, s89
    s_bfe_u32 s37, s39, 0x10003
    s_lshl_b32 s37, s37, 11
    s_add_u32 s85, s37, s85
    s_bfe_u32 s37, s39, 0x40004
    s_lshl_b32 s37, s37, 16
    s_add_u32 s85, s37, s85
    s_waitcnt vmcnt(6)
    buffer_load_dwordx4 v[160:163], v76, s[52:55], s85 offen offset:0 nt
    s_waitcnt vmcnt(6)
    buffer_load_dwordx4 v[164:167], v77, s[52:55], s85 offen offset:0 nt
    s_waitcnt vmcnt(6)
    buffer_load_dwordx4 v[168:171], v76, s[52:55], s85 offen offset:1024 nt
    s_waitcnt vmcnt(6)
    buffer_load_dwordx4 v[172:175], v77, s[52:55], s85 offen offset:1024 nt
    s_add_u32 s87, s87, 7
    s_add_u32 s39, s87, s88
    s_bfe_u32 s37, s39, 0x30000
    s_lshl_b32 s37, s37, 12
    s_add_u32 s85, s37, s89
    s_bfe_u32 s37, s39, 0x10003
    s_lshl_b32 s37, s37, 11
    s_add_u32 s85, s37, s85
    s_bfe_u32 s37, s39, 0x40004
    s_lshl_b32 s37, s37, 16
    s_add_u32 s85, s37, s85
    s_waitcnt vmcnt(6)
    buffer_load_dwordx4 v[176:179], v76, s[52:55], s85 offen offset:0 nt
    s_waitcnt vmcnt(6)
    buffer_load_dwordx4 v[180:183], v77, s[52:55], s85 offen offset:0 nt
    s_waitcnt vmcnt(6)
    buffer_load_dwordx4 v[184:187], v76, s[52:55], s85 offen offset:1024 nt
    s_waitcnt vmcnt(6)
    buffer_load_dwordx4 v[188:191], v77, s[52:55], s85 offen offset:1024 nt
    s_add_u32 s87, s87, 7
    s_add_u32 s39, s87, s88
    s_bfe_u32 s37, s39, 0x30000
    s_lshl_b32 s37, s37, 12
    s_add_u32 s85, s37, s89
    s_bfe_u32 s37, s39, 0x10003
    s_lshl_b32 s37, s37, 11
    s_add_u32 s85, s37, s85
    s_bfe_u32 s37, s39, 0x40004
    s_lshl_b32 s37, s37, 16
    s_add_u32 s85, s37, s85
    buffer_load_dwordx4 v[20:23], v15, s[48:51], s95 offen offset:0 sc1
    buffer_load_dwordx4 v[24:27], v15, s[48:51], s95 offen offset:16 sc1
    s_waitcnt vmcnt(8)
    buffer_load_dwordx4 v[192:195], v76, s[52:55], s85 offen offset:0 nt
    s_waitcnt vmcnt(8)
    buffer_load_dwordx4 v[196:199], v77, s[52:55], s85 offen offset:0 nt
    s_waitcnt vmcnt(8)
    buffer_load_dwordx4 v[200:203], v76, s[52:55], s85 offen offset:1024 nt
    s_waitcnt vmcnt(8)
    buffer_load_dwordx4 v[204:207], v77, s[52:55], s85 offen offset:1024 nt
    s_add_u32 s87, s87, 7
    s_add_u32 s39, s87, s88
    s_bfe_u32 s37, s39, 0x30000
    s_lshl_b32 s37, s37, 12
    s_add_u32 s85, s37, s89
    s_bfe_u32 s37, s39, 0x10003
    s_lshl_b32 s37, s37, 11
    s_add_u32 s85, s37, s85
    s_bfe_u32 s37, s39, 0x40004
    s_lshl_b32 s37, s37, 16
    s_add_u32 s85, s37, s85
    s_waitcnt vmcnt(8)
    buffer_load_dwordx4 v[208:211], v76, s[52:55], s85 offen offset:0 nt
    s_waitcnt vmcnt(8)
    buffer_load_dwordx4 v[212:215], v77, s[52:55], s85 offen offset:0 nt
    s_waitcnt vmcnt(6)
L_qacheck_18:
    v_xor_b32 v20, s35, v20
    v_xor_b32 v21, s35, v21
    v_xor_b32 v22, s35, v22
    v_xor_b32 v23, s35, v23
    v_xor_b32 v24, s35, v24
    v_xor_b32 v25, s35, v25
    v_xor_b32 v26, s35, v26
    v_xor_b32 v27, s35, v27
    v_or_b32 v4, v20, v21
    v_or3_b32 v4, v4, v22, v23
    v_or3_b32 v4, v4, v24, v25
    v_or3_b32 v4, v4, v26, v27
    v_and_b32 v4, 0xff, v4
    v_cmp_ne_u32 vcc, 0, v4
    s_cbranch_vccz L_qaok_19
    buffer_load_dwordx4 v[20:23], v15, s[48:51], s95 offen offset:0 sc1
    buffer_load_dwordx4 v[24:27], v15, s[48:51], s95 offen offset:16 sc1
    s_waitcnt vmcnt(0)
    s_sub_u32 s84, s84, 1
    s_cmp_lg_u32 s84, 0
    s_cbranch_scc1 L_qacheck_18
    s_branch L_end
L_qaok_19:
    buffer_load_dwordx4 v[68:71], v78, s[48:51], s91 offen offset:0 sc1
    buffer_load_dwordx4 v[72:75], v78, s[48:51], s91 offen offset:16 sc1
    v_cvt_pk_bf16_f32 v20, v20, v21
    v_cvt_pk_bf16_f32 v21, v22, v23
    v_cvt_pk_bf16_f32 v22, v24, v25
    v_cvt_pk_bf16_f32 v23, v26, v27
    s_nop 1
    v_mfma_f32_16x16x32_bf16 v[28:31], a[0:3], v[20:23], 0
    v_mfma_f32_16x16x32_bf16 v[32:35], a[4:7], v[20:23], 0
    v_mfma_f32_16x16x32_bf16 v[36:39], a[8:11], v[20:23], 0
    s_nop 5
    v_mov_b32_dpp v60, v28 quad_perm:[0,0,0,0] row_mask:0xf bank_mask:0xf
    v_mov_b32_dpp v4, v30 quad_perm:[2,2,2,2] row_mask:0xf bank_mask:0xf
    s_nop 0
    v_add_f32_dpp v60, v29, v60 quad_perm:[1,1,1,1] row_mask:0xf bank_mask:0xf
    v_add_f32_dpp v4, v31, v4 quad_perm:[3,3,3,3] row_mask:0xf bank_mask:0xf
    v_add_f32 v60, v60, v4
    v_mfma_f32_16x16x32_bf16 v[40:43], a[12:15], v[20:23], 0
    v_mov_b32_dpp v61, v32 quad_perm:[0,0,0,0] row_mask:0xf bank_mask:0xf
    v_mov_b32_dpp v4, v34 quad_perm:[2,2,2,2] row_mask:0xf bank_mask:0xf
    s_nop 0
    v_add_f32_dpp v61, v33, v61 quad_perm:[1,1,1,1] row_mask:0xf bank_mask:0xf
    v_add_f32_dpp v4, v35, v4 quad_perm:[3,3,3,3] row_mask:0xf bank_mask:0xf
    v_add_f32 v61, v61, v4
    v_cvt_pk_bf16_f32 v44, v60, v61
    v_mfma_f32_16x16x32_bf16 v[28:31], a[16:19], v[20:23], 0
    v_mov_b32_dpp v60, v36 quad_perm:[0,0,0,0] row_mask:0xf bank_mask:0xf
    v_mov_b32_dpp v4, v38 quad_perm:[2,2,2,2] row_mask:0xf bank_mask:0xf
    s_nop 0
    v_add_f32_dpp v60, v37, v60 quad_perm:[1,1,1,1] row_mask:0xf bank_mask:0xf
    v_add_f32_dpp v4, v39, v4 quad_perm:[3,3,3,3] row_mask:0xf bank_mask:0xf
    v_add_f32 v60, v60, v4
    buffer_load_dwordx4 v[216:219], v76, s[52:55], s85 offen offset:1024 nt
    v_mfma_f32_16x16x32_bf16 v[32:35], a[20:23], v[20:23], 0
    v_mov_b32_dpp v61, v40 quad_perm:[0,0,0,0] row_mask:0xf bank_mask:0xf
    v_mov_b32_dpp v4, v42 quad_perm:[2,2,2,2] row_mask:0xf bank_mask:0xf
    s_nop 0
    v_add_f32_dpp v61, v41, v61 quad_perm:[1,1,1,1] row_mask:0xf bank_mask:0xf
    v_add_f32_dpp v4, v43, v4 quad_perm:[3,3,3,3] row_mask:0xf bank_mask:0xf
    v_add_f32 v61, v61, v4
    v_cvt_pk_bf16_f32 v45, v60, v61
    v_mfma_f32_16x16x32_bf16 v[36:39], a[24:27], v[20:23], 0
    v_mov_b32_dpp v60, v28 quad_perm:[0,0,0,0] row_mask:0xf bank_mask:0xf
    v_mov_b32_dpp v4, v30 quad_perm:[2,2,2,2] row_mask:0xf bank_mask:0xf
    s_nop 0
    v_add_f32_dpp v60, v29, v60 quad_perm:[1,1,1,1] row_mask:0xf bank_mask:0xf
    v_add_f32_dpp v4, v31, v4 quad_perm:[3,3,3,3] row_mask:0xf bank_mask:0xf
    v_add_f32 v60, v60, v4
    v_mfma_f32_16x16x32_bf16 v[40:43], a[28:31], v[20:23], 0
    v_mov_b32_dpp v61, v32 quad_perm:[0,0,0,0] row_mask:0xf bank_mask:0xf
    v_mov_b32_dpp v4, v34 quad_perm:[2,2,2,2] row_mask:0xf bank_mask:0xf
    s_nop 0
    v_add_f32_dpp v61, v33, v61 quad_perm:[1,1,1,1] row_mask:0xf bank_mask:0xf
    v_add_f32_dpp v4, v35, v4 quad_perm:[3,3,3,3] row_mask:0xf bank_mask:0xf
    v_add_f32 v61, v61, v4
    v_cvt_pk_bf16_f32 v46, v60, v61
    v_mfma_f32_16x16x32_bf16 v[28:31], a[32:35], v[20:23], 0
    v_mov_b32_dpp v60, v36 quad_perm:[0,0,0,0] row_mask:0xf bank_mask:0xf
    v_mov_b32_dpp v4, v38 quad_perm:[2,2,2,2] row_mask:0xf bank_mask:0xf
    s_nop 0
    v_add_f32_dpp v60, v37, v60 quad_perm:[1,1,1,1] row_mask:0xf bank_mask:0xf
    v_add_f32_dpp v4, v39, v4 quad_perm:[3,3,3,3] row_mask:0xf bank_mask:0xf
    v_add_f32 v60, v60, v4
    v_mfma_f32_16x16x32_bf16 v[32:35], a[36:39], v[20:23], 0
    v_mov_b32_dpp v61, v40 quad_perm:[0,0,0,0] row_mask:0xf bank_mask:0xf
    v_mov_b32_dpp v4, v42 quad_perm:[2,2,2,2] row_mask:0xf bank_mask:0xf
    s_nop 0
    v_add_f32_dpp v61, v41, v61 quad_perm:[1,1,1,1] row_mask:0xf bank_mask:0xf
    v_add_f32_dpp v4, v43, v4 quad_perm:[3,3,3,3] row_mask:0xf bank_mask:0xf
    v_add_f32 v61, v61, v4
    v_cvt_pk_bf16_f32 v47, v60, v61
    v_mfma_f32_16x16x32_bf16 v[36:39], a[40:43], v[20:23], 0
    v_mov_b32_dpp v60, v28 quad_perm:[0,0,0,0] row_mask:0xf bank_mask:0xf
    v_mov_b32_dpp v4, v30 quad_perm:[2,2,2,2] row_mask:0xf bank_mask:0xf
    s_nop 0
    v_add_f32_dpp v60, v29, v60 quad_perm:[1,1,1,1] row_mask:0xf bank_mask:0xf
    v_add_f32_dpp v4, v31, v4 quad_perm:[3,3,3,3] row_mask:0xf bank_mask:0xf
    v_add_f32 v60, v60, v4
    v_mfma_f32_16x16x32_bf16 v[40:43], a[44:47], v[20:23], 0
    v_mov_b32_dpp v61, v32 quad_perm:[0,0,0,0] row_mask:0xf bank_mask:0xf
    v_mov_b32_dpp v4, v34 quad_perm:[2,2,2,2] row_mask:0xf bank_mask:0xf
    s_nop 0
    v_add_f32_dpp v61, v33, v61 quad_perm:[1,1,1,1] row_mask:0xf bank_mask:0xf
    v_add_f32_dpp v4, v35, v4 quad_perm:[3,3,3,3] row_mask:0xf bank_mask:0xf
    v_add_f32 v61, v61, v4
    v_cvt_pk_bf16_f32 v48, v60, v61
    v_mfma_f32_16x16x32_bf16 v[28:31], a[48:51], v[20:23], 0
    v_mov_b32_dpp v60, v36 quad_perm:[0,0,0,0] row_mask:0xf bank_mask:0xf
    v_mov_b32_dpp v4, v38 quad_perm:[2,2,2,2] row_mask:0xf bank_mask:0xf
    s_nop 0
    v_add_f32_dpp v60, v37, v60 quad_perm:[1,1,1,1] row_mask:0xf bank_mask:0xf
    v_add_f32_dpp v4, v39, v4 quad_perm:[3,3,3,3] row_mask:0xf bank_mask:0xf
    v_add_f32 v60, v60, v4
    buffer_load_dwordx4 v[220:223], v77, s[52:55], s85 offen offset:1024 nt
    s_add_u32 s87, s87, 7
    s_add_u32 s39, s87, s88
    s_bfe_u32 s37, s39, 0x30000
    s_lshl_b32 s37, s37, 12
    s_add_u32 s85, s37, s89
    s_bfe_u32 s37, s39, 0x10003
    s_lshl_b32 s37, s37, 11
    s_add_u32 s85, s37, s85
    s_bfe_u32 s37, s39, 0x40004
    s_lshl_b32 s37, s37, 16
    s_add_u32 s85, s37, s85
    v_mfma_f32_16x16x32_bf16 v[32:35], a[52:55], v[20:23], 0
    v_mov_b32_dpp v61, v40 quad_perm:[0,0,0,0] row_mask:0xf bank_mask:0xf
    v_mov_b32_dpp v4, v42 quad_perm:[2,2,2,2] row_mask:0xf bank_mask:0xf
    s_nop 0
    v_add_f32_dpp v61, v41, v61 quad_perm:[1,1,1,1] row_mask:0xf bank_mask:0xf
    v_add_f32_dpp v4, v43, v4 quad_perm:[3,3,3,3] row_mask:0xf bank_mask:0xf
    v_add_f32 v61, v61, v4
    v_cvt_pk_bf16_f32 v49, v60, v61
    v_mfma_f32_16x16x32_bf16 v[36:39], a[56:59], v[20:23], 0
    v_mov_b32_dpp v60, v28 quad_perm:[0,0,0,0] row_mask:0xf bank_mask:0xf
    v_mov_b32_dpp v4, v30 quad_perm:[2,2,2,2] row_mask:0xf bank_mask:0xf
    s_nop 0
    v_add_f32_dpp v60, v29, v60 quad_perm:[1,1,1,1] row_mask:0xf bank_mask:0xf
    v_add_f32_dpp v4, v31, v4 quad_perm:[3,3,3,3] row_mask:0xf bank_mask:0xf
    v_add_f32 v60, v60, v4
    v_mfma_f32_16x16x32_bf16 v[40:43], a[60:63], v[20:23], 0
    v_mov_b32_dpp v61, v32 quad_perm:[0,0,0,0] row_mask:0xf bank_mask:0xf
    v_mov_b32_dpp v4, v34 quad_perm:[2,2,2,2] row_mask:0xf bank_mask:0xf
    s_nop 0
    v_add_f32_dpp v61, v33, v61 quad_perm:[1,1,1,1] row_mask:0xf bank_mask:0xf
    v_add_f32_dpp v4, v35, v4 quad_perm:[3,3,3,3] row_mask:0xf bank_mask:0xf
    v_add_f32 v61, v61, v4
    v_cvt_pk_bf16_f32 v50, v60, v61
    v_mfma_f32_16x16x32_bf16 v[28:31], a[64:67], v[20:23], 0
    v_mov_b32_dpp v60, v36 quad_perm:[0,0,0,0] row_mask:0xf bank_mask:0xf
    v_mov_b32_dpp v4, v38 quad_perm:[2,2,2,2] row_mask:0xf bank_mask:0xf
    s_nop 0
    v_add_f32_dpp v60, v37, v60 quad_perm:[1,1,1,1] row_mask:0xf bank_mask:0xf
    v_add_f32_dpp v4, v39, v4 quad_perm:[3,3,3,3] row_mask:0xf bank_mask:0xf
    v_add_f32 v60, v60, v4
    v_mfma_f32_16x16x32_bf16 v[32:35], a[68:71], v[20:23], 0
    v_mov_b32_dpp v61, v40 quad_perm:[0,0,0,0] row_mask:0xf bank_mask:0xf
    v_mov_b32_dpp v4, v42 quad_perm:[2,2,2,2] row_mask:0xf bank_mask:0xf
    s_nop 0
    v_add_f32_dpp v61, v41, v61 quad_perm:[1,1,1,1] row_mask:0xf bank_mask:0xf
    v_add_f32_dpp v4, v43, v4 quad_perm:[3,3,3,3] row_mask:0xf bank_mask:0xf
    v_add_f32 v61, v61, v4
    v_cvt_pk_bf16_f32 v51, v60, v61
    v_mfma_f32_16x16x32_bf16 v[36:39], a[72:75], v[20:23], 0
    v_mov_b32_dpp v60, v28 quad_perm:[0,0,0,0] row_mask:0xf bank_mask:0xf
    v_mov_b32_dpp v4, v30 quad_perm:[2,2,2,2] row_mask:0xf bank_mask:0xf
    s_nop 0
    v_add_f32_dpp v60, v29, v60 quad_perm:[1,1,1,1] row_mask:0xf bank_mask:0xf
    v_add_f32_dpp v4, v31, v4 quad_perm:[3,3,3,3] row_mask:0xf bank_mask:0xf
    v_add_f32 v60, v60, v4
    v_mfma_f32_16x16x32_bf16 v[40:43], a[76:79], v[20:23], 0
    v_mov_b32_dpp v61, v32 quad_perm:[0,0,0,0] row_mask:0xf bank_mask:0xf
    v_mov_b32_dpp v4, v34 quad_perm:[2,2,2,2] row_mask:0xf bank_mask:0xf
    s_nop 0
    v_add_f32_dpp v61, v33, v61 quad_perm:[1,1,1,1] row_mask:0xf bank_mask:0xf
    v_add_f32_dpp v4, v35, v4 quad_perm:[3,3,3,3] row_mask:0xf bank_mask:0xf
    v_add_f32 v61, v61, v4
    v_cvt_pk_bf16_f32 v52, v60, v61
    v_mfma_f32_16x16x32_bf16 v[28:31], a[80:83], v[20:23], 0
    v_mov_b32_dpp v60, v36 quad_perm:[0,0,0,0] row_mask:0xf bank_mask:0xf
    v_mov_b32_dpp v4, v38 quad_perm:[2,2,2,2] row_mask:0xf bank_mask:0xf
    s_nop 0
    v_add_f32_dpp v60, v37, v60 quad_perm:[1,1,1,1] row_mask:0xf bank_mask:0xf
    v_add_f32_dpp v4, v39, v4 quad_perm:[3,3,3,3] row_mask:0xf bank_mask:0xf
    v_add_f32 v60, v60, v4
    buffer_load_dwordx4 v[224:227], v76, s[52:55], s85 offen offset:0 nt
    v_mfma_f32_16x16x32_bf16 v[32:35], a[84:87], v[20:23], 0
    v_mov_b32_dpp v61, v40 quad_perm:[0,0,0,0] row_mask:0xf bank_mask:0xf
    v_mov_b32_dpp v4, v42 quad_perm:[2,2,2,2] row_mask:0xf bank_mask:0xf
    s_nop 0
    v_add_f32_dpp v61, v41, v61 quad_perm:[1,1,1,1] row_mask:0xf bank_mask:0xf
    v_add_f32_dpp v4, v43, v4 quad_perm:[3,3,3,3] row_mask:0xf bank_mask:0xf
    v_add_f32 v61, v61, v4
    v_cvt_pk_bf16_f32 v53, v60, v61
    v_mfma_f32_16x16x32_bf16 v[36:39], a[88:91], v[20:23], 0
    v_mov_b32_dpp v60, v28 quad_perm:[0,0,0,0] row_mask:0xf bank_mask:0xf
    v_mov_b32_dpp v4, v30 quad_perm:[2,2,2,2] row_mask:0xf bank_mask:0xf
    s_nop 0
    v_add_f32_dpp v60, v29, v60 quad_perm:[1,1,1,1] row_mask:0xf bank_mask:0xf
    v_add_f32_dpp v4, v31, v4 quad_perm:[3,3,3,3] row_mask:0xf bank_mask:0xf
    v_add_f32 v60, v60, v4
    v_mfma_f32_16x16x32_bf16 v[40:43], a[92:95], v[20:23], 0
    v_mov_b32_dpp v61, v32 quad_perm:[0,0,0,0] row_mask:0xf bank_mask:0xf
    v_mov_b32_dpp v4, v34 quad_perm:[2,2,2,2] row_mask:0xf bank_mask:0xf
    s_nop 0
    v_add_f32_dpp v61, v33, v61 quad_perm:[1,1,1,1] row_mask:0xf bank_mask:0xf
    v_add_f32_dpp v4, v35, v4 quad_perm:[3,3,3,3] row_mask:0xf bank_mask:0xf
    v_add_f32 v61, v61, v4
    v_cvt_pk_bf16_f32 v54, v60, v61
    v_mfma_f32_16x16x32_bf16 v[28:31], a[96:99], v[20:23], 0
    v_mov_b32_dpp v60, v36 quad_perm:[0,0,0,0] row_mask:0xf bank_mask:0xf
    v_mov_b32_dpp v4, v38 quad_perm:[2,2,2,2] row_mask:0xf bank_mask:0xf
    s_nop 0
    v_add_f32_dpp v60, v37, v60 quad_perm:[1,1,1,1] row_mask:0xf bank_mask:0xf
    v_add_f32_dpp v4, v39, v4 quad_perm:[3,3,3,3] row_mask:0xf bank_mask:0xf
    v_add_f32 v60, v60, v4
    v_mfma_f32_16x16x32_bf16 v[32:35], a[100:103], v[20:23], 0
    v_mov_b32_dpp v61, v40 quad_perm:[0,0,0,0] row_mask:0xf bank_mask:0xf
    v_mov_b32_dpp v4, v42 quad_perm:[2,2,2,2] row_mask:0xf bank_mask:0xf
    s_nop 0
    v_add_f32_dpp v61, v41, v61 quad_perm:[1,1,1,1] row_mask:0xf bank_mask:0xf
    v_add_f32_dpp v4, v43, v4 quad_perm:[3,3,3,3] row_mask:0xf bank_mask:0xf
    v_add_f32 v61, v61, v4
    v_cvt_pk_bf16_f32 v55, v60, v61
    v_mfma_f32_16x16x32_bf16 v[36:39], a[104:107], v[20:23], 0
    v_mov_b32_dpp v60, v28 quad_perm:[0,0,0,0] row_mask:0xf bank_mask:0xf
    v_mov_b32_dpp v4, v30 quad_perm:[2,2,2,2] row_mask:0xf bank_mask:0xf
    s_nop 0
    v_add_f32_dpp v60, v29, v60 quad_perm:[1,1,1,1] row_mask:0xf bank_mask:0xf
    v_add_f32_dpp v4, v31, v4 quad_perm:[3,3,3,3] row_mask:0xf bank_mask:0xf
    v_add_f32 v60, v60, v4
    v_mfma_f32_16x16x32_bf16 v[40:43], a[108:111], v[20:23], 0
    v_mov_b32_dpp v61, v32 quad_perm:[0,0,0,0] row_mask:0xf bank_mask:0xf
    v_mov_b32_dpp v4, v34 quad_perm:[2,2,2,2] row_mask:0xf bank_mask:0xf
    s_nop 0
    v_add_f32_dpp v61, v33, v61 quad_perm:[1,1,1,1] row_mask:0xf bank_mask:0xf
    v_add_f32_dpp v4, v35, v4 quad_perm:[3,3,3,3] row_mask:0xf bank_mask:0xf
    v_add_f32 v61, v61, v4
    v_cvt_pk_bf16_f32 v56, v60, v61
    v_mfma_f32_16x16x32_bf16 v[28:31], a[112:115], v[20:23], 0
    v_mov_b32_dpp v60, v36 quad_perm:[0,0,0,0] row_mask:0xf bank_mask:0xf
    v_mov_b32_dpp v4, v38 quad_perm:[2,2,2,2] row_mask:0xf bank_mask:0xf
    s_nop 0
    v_add_f32_dpp v60, v37, v60 quad_perm:[1,1,1,1] row_mask:0xf bank_mask:0xf
    v_add_f32_dpp v4, v39, v4 quad_perm:[3,3,3,3] row_mask:0xf bank_mask:0xf
    v_add_f32 v60, v60, v4
    buffer_load_dwordx4 v[228:231], v77, s[52:55], s85 offen offset:0 nt
    v_mfma_f32_16x16x32_bf16 v[32:35], a[116:119], v[20:23], 0
    v_mov_b32_dpp v61, v40 quad_perm:[0,0,0,0] row_mask:0xf bank_mask:0xf
    v_mov_b32_dpp v4, v42 quad_perm:[2,2,2,2] row_mask:0xf bank_mask:0xf
    s_nop 0
    v_add_f32_dpp v61, v41, v61 quad_perm:[1,1,1,1] row_mask:0xf bank_mask:0xf
    v_add_f32_dpp v4, v43, v4 quad_perm:[3,3,3,3] row_mask:0xf bank_mask:0xf
    v_add_f32 v61, v61, v4
    v_cvt_pk_bf16_f32 v57, v60, v61
    v_mfma_f32_16x16x32_bf16 v[36:39], a[120:123], v[20:23], 0
    v_mov_b32_dpp v60, v28 quad_perm:[0,0,0,0] row_mask:0xf bank_mask:0xf
    v_mov_b32_dpp v4, v30 quad_perm:[2,2,2,2] row_mask:0xf bank_mask:0xf
    s_nop 0
    v_add_f32_dpp v60, v29, v60 quad_perm:[1,1,1,1] row_mask:0xf bank_mask:0xf
    v_add_f32_dpp v4, v31, v4 quad_perm:[3,3,3,3] row_mask:0xf bank_mask:0xf
    v_add_f32 v60, v60, v4
    v_mfma_f32_16x16x32_bf16 v[40:43], a[124:127], v[20:23], 0
    v_mov_b32_dpp v61, v32 quad_perm:[0,0,0,0] row_mask:0xf bank_mask:0xf
    v_mov_b32_dpp v4, v34 quad_perm:[2,2,2,2] row_mask:0xf bank_mask:0xf
    s_nop 0
    v_add_f32_dpp v61, v33, v61 quad_perm:[1,1,1,1] row_mask:0xf bank_mask:0xf
    v_add_f32_dpp v4, v35, v4 quad_perm:[3,3,3,3] row_mask:0xf bank_mask:0xf
    v_add_f32 v61, v61, v4
    v_cvt_pk_bf16_f32 v58, v60, v61
    v_mov_b32_dpp v60, v36 quad_perm:[0,0,0,0] row_mask:0xf bank_mask:0xf
    v_mov_b32_dpp v4, v38 quad_perm:[2,2,2,2] row_mask:0xf bank_mask:0xf
    s_nop 0
    v_add_f32_dpp v60, v37, v60 quad_perm:[1,1,1,1] row_mask:0xf bank_mask:0xf
    v_add_f32_dpp v4, v39, v4 quad_perm:[3,3,3,3] row_mask:0xf bank_mask:0xf
    v_add_f32 v60, v60, v4
    v_mov_b32_dpp v61, v40 quad_perm:[0,0,0,0] row_mask:0xf bank_mask:0xf
    v_mov_b32_dpp v4, v42 quad_perm:[2,2,2,2] row_mask:0xf bank_mask:0xf
    s_nop 0
    v_add_f32_dpp v61, v41, v61 quad_perm:[1,1,1,1] row_mask:0xf bank_mask:0xf
    v_add_f32_dpp v4, v43, v4 quad_perm:[3,3,3,3] row_mask:0xf bank_mask:0xf
    v_add_f32 v61, v61, v4
    v_cvt_pk_bf16_f32 v59, v60, v61
    s_mov_b32 exec_lo, 0x22222222
    s_mov_b32 exec_hi, 0x22222222
    v_mov_b32 v44, v48
    v_mov_b32 v45, v49
    v_mov_b32 v46, v50
    v_mov_b32 v47, v51
    s_mov_b32 exec_lo, 0x44444444
    s_mov_b32 exec_hi, 0x44444444
    v_mov_b32 v44, v52
    v_mov_b32 v45, v53
    v_mov_b32 v46, v54
    v_mov_b32 v47, v55
    s_mov_b32 exec_lo, 0x88888888
    s_mov_b32 exec_hi, 0x88888888
    v_mov_b32 v44, v56
    v_mov_b32 v45, v57
    v_mov_b32 v46, v58
    v_mov_b32 v47, v59
    s_mov_b64 exec, -1
    buffer_store_dwordx4 v[44:47], v19, s[48:51], s94 offen sc1
    s_waitcnt vmcnt(5)
L_qcheck_20:
    v_xor_b32 v68, s35, v68
    v_xor_b32 v69, s35, v69
    v_xor_b32 v70, s35, v70
    v_xor_b32 v71, s35, v71
    v_xor_b32 v72, s35, v72
    v_xor_b32 v73, s35, v73
    v_xor_b32 v74, s35, v74
    v_xor_b32 v75, s35, v75
    v_or_b32 v4, v68, v69
    v_or3_b32 v4, v4, v70, v71
    v_or3_b32 v4, v4, v72, v73
    v_or3_b32 v4, v4, v74, v75
    v_and_b32 v4, 0xff, v4
    v_cmp_ne_u32 vcc, 0, v4
    s_cbranch_vccz L_qok_21
    buffer_load_dwordx4 v[68:71], v78, s[48:51], s91 offen offset:0 sc1
    buffer_load_dwordx4 v[72:75], v78, s[48:51], s91 offen offset:16 sc1
    s_waitcnt vmcnt(0)
    s_sub_u32 s84, s84, 1
    s_cmp_lg_u32 s84, 0
    s_cbranch_scc1 L_qcheck_20
    s_branch L_end
L_qok_21:
    v_cvt_pk_bf16_f32 v68, v68, v69
    v_cvt_pk_bf16_f32 v69, v70, v71
    v_cvt_pk_bf16_f32 v70, v72, v73
    v_cvt_pk_bf16_f32 v71, v74, v75
    s_mov_b32 vcc_lo, 0xf000f
    s_mov_b32 vcc_hi, 0xf000f
    v_cndmask_b32 v80, 0, v68, vcc
    v_cndmask_b32 v81, 0, v69, vcc
    v_cndmask_b32 v82, 0, v70, vcc
    v_cndmask_b32 v83, 0, v71, vcc
    s_mov_b32 vcc_lo, 0xf000f0
    s_mov_b32 vcc_hi, 0xf000f0
    v_cndmask_b32 v84, 0, v68, vcc
    v_cndmask_b32 v85, 0, v69, vcc
    v_cndmask_b32 v86, 0, v70, vcc
    v_cndmask_b32 v87, 0, v71, vcc
    s_mov_b32 vcc_lo, 0xf000f00
    s_mov_b32 vcc_hi, 0xf000f00
    v_cndmask_b32 v88, 0, v68, vcc
    v_cndmask_b32 v89, 0, v69, vcc
    v_cndmask_b32 v90, 0, v70, vcc
    v_cndmask_b32 v91, 0, v71, vcc
    s_mov_b32 vcc_lo, 0xf000f000
    s_mov_b32 vcc_hi, 0xf000f000
    v_cndmask_b32 v92, 0, v68, vcc
    v_cndmask_b32 v93, 0, v69, vcc
    v_cndmask_b32 v94, 0, v70, vcc
    v_cndmask_b32 v95, 0, v71, vcc
    v_mov_b32 v65, 0xff7f0000
    s_lshl_b32 s38, s34, 14
    s_add_u32 s38, s38, 16384
    v_lshl_add_u32 v64, v1, 2, s38
    buffer_load_dwordx4 v[232:235], v76, s[52:55], s85 offen offset:1024 nt
    v_mfma_f32_16x16x32_bf16 v[112:115], v[128:131], v[80:83], 0
    v_mfma_f32_16x16x32_bf16 v[112:115], v[132:135], v[84:87], v[112:115]
    buffer_load_dwordx4 v[236:239], v77, s[52:55], s85 offen offset:1024 nt
    s_add_u32 s87, s87, 7
    s_add_u32 s39, s87, s88
    s_bfe_u32 s37, s39, 0x30000
    s_lshl_b32 s37, s37, 12
    s_add_u32 s85, s37, s89
    s_bfe_u32 s37, s39, 0x10003
    s_lshl_b32 s37, s37, 11
    s_add_u32 s85, s37, s85
    s_bfe_u32 s37, s39, 0x40004
    s_lshl_b32 s37, s37, 16
    s_add_u32 s85, s37, s85
    v_mfma_f32_16x16x32_bf16 v[112:115], v[136:139], v[88:91], v[112:115]
    v_mfma_f32_16x16x32_bf16 v[112:115], v[140:143], v[92:95], v[112:115]
    v_mfma_f32_16x16x32_bf16 v[96:99], v[144:147], v[80:83], 0
    buffer_load_dwordx4 v[240:243], v76, s[52:55], s85 offen offset:0 nt
    v_mfma_f32_16x16x32_bf16 v[96:99], v[148:151], v[84:87], v[96:99]
    v_mfma_f32_16x16x32_bf16 v[96:99], v[152:155], v[88:91], v[96:99]
    s_nop 3
    v_mov_b32_dpp v122, v112 quad_perm:[0,0,0,0] row_mask:0xf bank_mask:0xf
    v_mov_b32_dpp v124, v114 quad_perm:[2,2,2,2] row_mask:0xf bank_mask:0xf
    s_nop 0
    v_add_f32_dpp v122, v113, v122 quad_perm:[1,1,1,1] row_mask:0xf bank_mask:0xf
    v_add_f32_dpp v124, v115, v124 quad_perm:[3,3,3,3] row_mask:0xf bank_mask:0xf
    v_add_f32 v122, v122, v124
    v_max_f32 v65, v65, v122
    ds_write_b32 v64, v122 offset:0
    v_mfma_f32_16x16x32_bf16 v[96:99], v[156:159], v[92:95], v[96:99]
    s_waitcnt vmcnt(7)
    buffer_load_dwordx4 v[244:247], v77, s[52:55], s85 offen offset:0 nt
    v_mfma_f32_16x16x32_bf16 v[112:115], v[160:163], v[80:83], 0
    v_mfma_f32_16x16x32_bf16 v[112:115], v[164:167], v[84:87], v[112:115]
    v_mfma_f32_16x16x32_bf16 v[112:115], v[168:171], v[88:91], v[112:115]
    s_nop 2
    v_mov_b32_dpp v122, v96 quad_perm:[0,0,0,0] row_mask:0xf bank_mask:0xf
    v_mov_b32_dpp v124, v98 quad_perm:[2,2,2,2] row_mask:0xf bank_mask:0xf
    s_nop 0
    v_add_f32_dpp v122, v97, v122 quad_perm:[1,1,1,1] row_mask:0xf bank_mask:0xf
    v_add_f32_dpp v124, v99, v124 quad_perm:[3,3,3,3] row_mask:0xf bank_mask:0xf
    v_add_f32 v122, v122, v124
    v_max_f32 v65, v65, v122
    ds_write_b32 v64, v122 offset:256
    s_waitcnt vmcnt(7)
    buffer_load_dwordx4 v[248:251], v76, s[52:55], s85 offen offset:1024 nt
    v_mfma_f32_16x16x32_bf16 v[112:115], v[172:175], v[92:95], v[112:115]
    v_mfma_f32_16x16x32_bf16 v[96:99], v[176:179], v[80:83], 0
    v_mfma_f32_16x16x32_bf16 v[96:99], v[180:183], v[84:87], v[96:99]
    s_waitcnt vmcnt(7)
    buffer_load_dwordx4 v[252:255], v77, s[52:55], s85 offen offset:1024 nt
    s_add_u32 s87, s87, 7
    s_add_u32 s39, s87, s88
    s_bfe_u32 s37, s39, 0x30000
    s_lshl_b32 s37, s37, 12
    s_add_u32 s85, s37, s89
    s_bfe_u32 s37, s39, 0x10003
    s_lshl_b32 s37, s37, 11
    s_add_u32 s85, s37, s85
    s_bfe_u32 s37, s39, 0x40004
    s_lshl_b32 s37, s37, 16
    s_add_u32 s85, s37, s85
    v_mfma_f32_16x16x32_bf16 v[96:99], v[184:187], v[88:91], v[96:99]
    v_mov_b32_dpp v122, v112 quad_perm:[0,0,0,0] row_mask:0xf bank_mask:0xf
    v_mov_b32_dpp v124, v114 quad_perm:[2,2,2,2] row_mask:0xf bank_mask:0xf
    s_nop 0
    v_add_f32_dpp v122, v113, v122 quad_perm:[1,1,1,1] row_mask:0xf bank_mask:0xf
    v_add_f32_dpp v124, v115, v124 quad_perm:[3,3,3,3] row_mask:0xf bank_mask:0xf
    v_add_f32 v122, v122, v124
    v_max_f32 v65, v65, v122
    ds_write_b32 v64, v122 offset:512
    v_mfma_f32_16x16x32_bf16 v[96:99], v[188:191], v[92:95], v[96:99]
    s_lshl_b32 s38, s34, 5
    s_add_u32 s38, s38, s32
    s_lshl_b32 s38, s38, 8
    s_add_u32 s38, s38, 131072
    v_mov_b32 v28, s38
    v_mov_b32 v29, s68
    s_waitcnt vmcnt(6)
    s_mov_b64 exec, 1
    buffer_store_dword v29, v28, s[48:51], 0 offen sc1
    s_mov_b64 exec, -1
    v_mfma_f32_16x16x32_bf16 v[112:115], v[192:195], v[80:83], 0
    s_waitcnt vmcnt(6)
    buffer_load_dwordx4 v[128:131], v76, s[52:55], s85 offen offset:0 nt
    v_mfma_f32_16x16x32_bf16 v[112:115], v[196:199], v[84:87], v[112:115]
    v_mfma_f32_16x16x32_bf16 v[112:115], v[200:203], v[88:91], v[112:115]
    v_mov_b32_dpp v122, v96 quad_perm:[0,0,0,0] row_mask:0xf bank_mask:0xf
    v_mov_b32_dpp v124, v98 quad_perm:[2,2,2,2] row_mask:0xf bank_mask:0xf
    s_nop 0
    v_add_f32_dpp v122, v97, v122 quad_perm:[1,1,1,1] row_mask:0xf bank_mask:0xf
    v_add_f32_dpp v124, v99, v124 quad_perm:[3,3,3,3] row_mask:0xf bank_mask:0xf
    v_add_f32 v122, v122, v124
    v_max_f32 v65, v65, v122
    ds_write_b32 v64, v122 offset:768
    v_mfma_f32_16x16x32_bf16 v[112:115], v[204:207], v[92:95], v[112:115]
    s_waitcnt vmcnt(6)
    buffer_load_dwordx4 v[132:135], v77, s[52:55], s85 offen offset:0 nt
    v_mfma_f32_16x16x32_bf16 v[96:99], v[208:211], v[80:83], 0
    v_mfma_f32_16x16x32_bf16 v[96:99], v[212:215], v[84:87], v[96:99]
    v_mfma_f32_16x16x32_bf16 v[96:99], v[216:219], v[88:91], v[96:99]
    s_nop 2
    v_mov_b32_dpp v122, v112 quad_perm:[0,0,0,0] row_mask:0xf bank_mask:0xf
    v_mov_b32_dpp v124, v114 quad_perm:[2,2,2,2] row_mask:0xf bank_mask:0xf
    s_nop 0
    v_add_f32_dpp v122, v113, v122 quad_perm:[1,1,1,1] row_mask:0xf bank_mask:0xf
    v_add_f32_dpp v124, v115, v124 quad_perm:[3,3,3,3] row_mask:0xf bank_mask:0xf
    v_add_f32 v122, v122, v124
    v_max_f32 v65, v65, v122
    ds_write_b32 v64, v122 offset:1024
    s_waitcnt vmcnt(6)
    buffer_load_dwordx4 v[136:139], v76, s[52:55], s85 offen offset:1024 nt
    v_mfma_f32_16x16x32_bf16 v[96:99], v[220:223], v[92:95], v[96:99]
    v_mfma_f32_16x16x32_bf16 v[112:115], v[224:227], v[80:83], 0
    v_mfma_f32_16x16x32_bf16 v[112:115], v[228:231], v[84:87], v[112:115]
    s_waitcnt vmcnt(6)
    buffer_load_dwordx4 v[140:143], v77, s[52:55], s85 offen offset:1024 nt
    s_add_u32 s87, s87, 7
    s_add_u32 s39, s87, s88
    s_bfe_u32 s37, s39, 0x30000
    s_lshl_b32 s37, s37, 12
    s_add_u32 s85, s37, s89
    s_bfe_u32 s37, s39, 0x10003
    s_lshl_b32 s37, s37, 11
    s_add_u32 s85, s37, s85
    s_bfe_u32 s37, s39, 0x40004
    s_lshl_b32 s37, s37, 16
    s_add_u32 s85, s37, s85
    v_mfma_f32_16x16x32_bf16 v[112:115], v[232:235], v[88:91], v[112:115]
    v_mov_b32_dpp v122, v96 quad_perm:[0,0,0,0] row_mask:0xf bank_mask:0xf
    v_mov_b32_dpp v124, v98 quad_perm:[2,2,2,2] row_mask:0xf bank_mask:0xf
    s_nop 0
    v_add_f32_dpp v122, v97, v122 quad_perm:[1,1,1,1] row_mask:0xf bank_mask:0xf
    v_add_f32_dpp v124, v99, v124 quad_perm:[3,3,3,3] row_mask:0xf bank_mask:0xf
    v_add_f32 v122, v122, v124
    v_max_f32 v65, v65, v122
    ds_write_b32 v64, v122 offset:1280
    v_mfma_f32_16x16x32_bf16 v[112:115], v[236:239], v[92:95], v[112:115]
    v_mfma_f32_16x16x32_bf16 v[96:99], v[240:243], v[80:83], 0
    s_waitcnt vmcnt(6)
    buffer_load_dwordx4 v[144:147], v76, s[52:55], s85 offen offset:0 nt
    v_mfma_f32_16x16x32_bf16 v[96:99], v[244:247], v[84:87], v[96:99]
    v_mfma_f32_16x16x32_bf16 v[96:99], v[248:251], v[88:91], v[96:99]
    s_nop 2
    v_mov_b32_dpp v122, v112 quad_perm:[0,0,0,0] row_mask:0xf bank_mask:0xf
    v_mov_b32_dpp v124, v114 quad_perm:[2,2,2,2] row_mask:0xf bank_mask:0xf
    s_nop 0
    v_add_f32_dpp v122, v113, v122 quad_perm:[1,1,1,1] row_mask:0xf bank_mask:0xf
    v_add_f32_dpp v124, v115, v124 quad_perm:[3,3,3,3] row_mask:0xf bank_mask:0xf
    v_add_f32 v122, v122, v124
    v_max_f32 v65, v65, v122
    ds_write_b32 v64, v122 offset:1536
    s_waitcnt vmcnt(6)
    v_mfma_f32_16x16x32_bf16 v[96:99], v[252:255], v[92:95], v[96:99]
    v_add_u32 v64, 1792, v64
    s_mov_b32 s97, 11
    s_mov_b32 s86, 30
    s_add_u32 s92, s33, 238
    s_mov_b32 s66, 134217728
    s_mov_b32 s67, 0x20000
    s_mov_b64 s[64:65], s[52:53]
    v_mov_b32 v62, v76
    v_mov_b32 v63, v77
    s_branch L_bloop
L_aux:
    v_lshlrev_b32 v4, 2, v2
    v_xor_b32 v4, v4, v3
    v_xor_b32 v96, 0, v4
    v_lshlrev_b32 v96, 4, v96
    v_lshl_add_u32 v10, v2, 13, v96
    v_xor_b32 v97, 1, v4
    v_lshlrev_b32 v97, 4, v97
    v_lshl_add_u32 v11, v2, 13, v97
    v_add_u32 v11, 31744, v11
    v_xor_b32 v98, 2, v4
    v_lshlrev_b32 v98, 4, v98
    v_lshl_add_u32 v12, v2, 13, v98
    v_add_u32 v12, 63488, v12
    v_xor_b32 v99, 3, v4
    v_lshlrev_b32 v99, 4, v99
    v_lshl_add_u32 v13, v2, 13, v99
    v_add_u32 v13, 95232, v13
    s_lshl_b32 s90, s34, 15
    s_mov_b32 s62, 0
    s_mov_b32 s94, 0
    s_lshl_b32 s95, s34, 20
    s_lshl_b32 s38, s32, 8
    s_add_u32 s95, s95, s38
    s_waitcnt lgkmcnt(0)
    s_mov_b32 s52, s12
    s_and_b32 s53, s13, 0xffff
    s_mov_b32 s54, 4194304
    s_mov_b32 s55, 0x20000
    s_add_u32 s39, s90, s62
    s_mov_b32 m0, s39
    s_add_u32 s62, s62, 4096
    s_and_b32 s62, s62, 0x7fff
    buffer_load_dwordx4 v10, s[52:55], s95 offen offset:0 nt lds
    buffer_load_dwordx4 v11, s[52:55], s95 offen offset:1024 nt lds
    buffer_load_dwordx4 v12, s[52:55], s95 offen offset:2048 nt lds
    buffer_load_dwordx4 v13, s[52:55], s95 offen offset:3072 nt lds
    s_add_u32 s95, s95, 131072
    s_add_u32 s39, s90, s62
    s_mov_b32 m0, s39
    s_add_u32 s62, s62, 4096
    s_and_b32 s62, s62, 0x7fff
    buffer_load_dwordx4 v10, s[52:55], s95 offen offset:0 nt lds
    buffer_load_dwordx4 v11, s[52:55], s95 offen offset:1024 nt lds
    buffer_load_dwordx4 v12, s[52:55], s95 offen offset:2048 nt lds
    buffer_load_dwordx4 v13, s[52:55], s95 offen offset:3072 nt lds
    s_add_u32 s95, s95, 131072
    s_getpc_b64 s[36:37]
L_pc_22:
    s_sub_u32 s36, s36, L_pc_22 - concat_heads__compressed_kv_cla__mha_block_cached__decode_kernel
    s_subb_u32 s37, s37, 0
    s_lshl_b32 s38, s32, 10
    v_lshl_add_u32 v6, v0, 2, s38
    v_mov_b32 v7, s37
    v_add_co_u32 v6, vcc, s36, v6
    s_nop 1
    v_addc_co_u32 v7, vcc, 0, v7, vcc
    global_load_dword v0, v[6:7], off
    s_load_dword s35, s[30:31], 0
    s_mov_b32 s48, s30
    s_and_b32 s49, s31, 0xffff
    s_mov_b32 s50, 8388608
    s_mov_b32 s51, 0x20000
    s_mov_b32 s82, 0xffffff00
    s_mov_b32 s83, 0x3e0293ee
    s_mov_b32 s84, 2097152
    s_mov_b32 s72, s26
    s_and_b32 s73, s27, 0xffff
    s_mov_b32 s74, 8192
    s_mov_b32 s75, 0x20000
    v_lshl_add_u32 v76, v2, 10, v96
    v_lshl_add_u32 v96, v2, 8, v96
    v_lshl_add_u32 v77, v2, 10, v97
    v_lshl_add_u32 v97, v2, 8, v97
    v_add_u32 v77, 3072, v77
    v_lshl_add_u32 v78, v2, 10, v98
    v_lshl_add_u32 v98, v2, 8, v98
    v_add_u32 v78, 6144, v78
    v_lshl_add_u32 v79, v2, 10, v99
    v_lshl_add_u32 v99, v2, 8, v99
    v_add_u32 v79, 9216, v79
    v_mov_b32 v100, 0
    v_and_b32 v101, 31, v1
    s_lshl_b32 s38, s34, 13
    v_lshl_add_u32 v101, v101, 8, s38
    v_lshlrev_b32 v4, 4, v3
    v_lshl_add_u32 v19, v2, 13, v4
    v_lshl_add_u32 v9, v2, 10, v4
    s_lshl_b32 s63, s32, 17
    s_lshl_b32 s38, s34, 8
    s_add_u32 s63, s63, s38
    v_and_b32 v4, 3, v1
    v_bfe_u32 v5, v1, 2, 2
    v_lshrrev_b32 v6, 5, v1
    v_lshl_add_u32 v7, v4, 2, v5
    v_xor_b32 v7, v7, v6
    v_lshlrev_b32 v7, 4, v7
    v_and_b32 v80, 31, v1
    v_lshl_add_u32 v80, v80, 8, v7
    v_lshl_add_u32 v81, v6, 2, v5
    v_lshlrev_b32 v81, 8, v81
    v_lshl_add_u32 v81, v5, 6, v81
    v_bfe_u32 v7, v1, 4, 1
    v_lshlrev_b32 v7, 1, v7
    v_bfe_u32 v82, v1, 1, 1
    v_add_u32 v7, v7, v82
    v_xor_b32 v7, v7, v6
    v_lshl_add_u32 v81, v7, 4, v81
    v_and_b32 v7, 1, v1
    v_lshl_add_u32 v81, v7, 3, v81
    v_lshl_add_u32 v95, v2, 3, v5
    v_lshlrev_b32 v95, 8, v95
    v_lshl_add_u32 v95, v5, 6, v95
    v_bfe_u32 v4, v1, 4, 1
    v_lshl_add_u32 v4, v4, 1, v82
    v_lshl_add_u32 v95, v4, 4, v95
    v_lshl_add_u32 v95, v7, 3, v95
    v_add_u32 v95, s90, v95
    v_xor_b32 v136, 0, v95
    v_xor_b32 v137, 16, v95
    v_xor_b32 v138, 32, v95
    v_xor_b32 v139, 48, v95
    v_xor_b32 v140, 64, v95
    v_xor_b32 v141, 80, v95
    v_xor_b32 v142, 96, v95
    v_xor_b32 v143, 112, v95
    v_xor_b32 v144, 128, v95
    v_xor_b32 v145, 144, v95
    v_xor_b32 v146, 160, v95
    v_xor_b32 v147, 176, v95
    v_xor_b32 v148, 192, v95
    v_xor_b32 v149, 208, v95
    v_xor_b32 v150, 224, v95
    v_xor_b32 v151, 240, v95
    s_lshl_b32 s85, s34, 13
    s_add_u32 s85, s85, 131072
    v_lshl_add_u32 v94, v1, 4, s85
    v_add_u32 v96, s85, v96
    v_add_u32 v97, s85, v97
    v_add_u32 v98, s85, v98
    v_add_u32 v99, s85, v99
    s_add_u32 s39, s90, s62
    s_mov_b32 m0, s39
    s_add_u32 s62, s62, 4096
    s_and_b32 s62, s62, 0x7fff
    buffer_load_dwordx4 v10, s[52:55], s95 offen offset:0 nt lds
    buffer_load_dwordx4 v11, s[52:55], s95 offen offset:1024 nt lds
    buffer_load_dwordx4 v12, s[52:55], s95 offen offset:2048 nt lds
    buffer_load_dwordx4 v13, s[52:55], s95 offen offset:3072 nt lds
    s_add_u32 s95, s95, 131072
    s_add_u32 s39, s90, s62
    s_mov_b32 m0, s39
    s_add_u32 s62, s62, 4096
    s_and_b32 s62, s62, 0x7fff
    buffer_load_dwordx4 v10, s[52:55], s95 offen offset:0 nt lds
    buffer_load_dwordx4 v11, s[52:55], s95 offen offset:1024 nt lds
    buffer_load_dwordx4 v12, s[52:55], s95 offen offset:2048 nt lds
    buffer_load_dwordx4 v13, s[52:55], s95 offen offset:3072 nt lds
    s_add_u32 s95, s95, 131072
    s_add_u32 s39, s90, s62
    s_mov_b32 m0, s39
    s_add_u32 s62, s62, 4096
    s_and_b32 s62, s62, 0x7fff
    buffer_load_dwordx4 v10, s[52:55], s95 offen offset:0 nt lds
    buffer_load_dwordx4 v11, s[52:55], s95 offen offset:1024 nt lds
    buffer_load_dwordx4 v12, s[52:55], s95 offen offset:2048 nt lds
    buffer_load_dwordx4 v13, s[52:55], s95 offen offset:3072 nt lds
    s_add_u32 s95, s95, 131072
    s_add_u32 s39, s90, s62
    s_mov_b32 m0, s39
    s_add_u32 s62, s62, 4096
    s_and_b32 s62, s62, 0x7fff
    buffer_load_dwordx4 v10, s[52:55], s95 offen offset:0 nt lds
    buffer_load_dwordx4 v11, s[52:55], s95 offen offset:1024 nt lds
    buffer_load_dwordx4 v12, s[52:55], s95 offen offset:2048 nt lds
    buffer_load_dwordx4 v13, s[52:55], s95 offen offset:3072 nt lds
    s_add_u32 s95, s95, 131072
    s_add_u32 s39, s90, s62
    s_mov_b32 m0, s39
    s_add_u32 s62, s62, 4096
    s_and_b32 s62, s62, 0x7fff
    buffer_load_dwordx4 v10, s[52:55], s95 offen offset:0 nt lds
    buffer_load_dwordx4 v11, s[52:55], s95 offen offset:1024 nt lds
    buffer_load_dwordx4 v12, s[52:55], s95 offen offset:2048 nt lds
    buffer_load_dwordx4 v13, s[52:55], s95 offen offset:3072 nt lds
    s_add_u32 s95, s95, 131072
    s_add_u32 s39, s90, s62
    s_mov_b32 m0, s39
    s_add_u32 s62, s62, 4096
    s_and_b32 s62, s62, 0x7fff
    buffer_load_dwordx4 v10, s[52:55], s95 offen offset:0 nt lds
    buffer_load_dwordx4 v11, s[52:55], s95 offen offset:1024 nt lds
    buffer_load_dwordx4 v12, s[52:55], s95 offen offset:2048 nt lds
    buffer_load_dwordx4 v13, s[52:55], s95 offen offset:3072 nt lds
    s_add_u32 s95, s95, 131072
    s_waitcnt lgkmcnt(0)
    s_add_u32 s35, s35, 0x5b
    s_and_b32 s35, s35, 0xff
    v_mov_b32 v8, s35
    s_or_b32 s68, s35, 0x6b3ac500
    s_mov_b32 s52, s14
    s_and_b32 s53, s15, 0xffff
    s_mov_b32 s54, 4194304
    s_mov_b32 s55, 0x20000
    s_mov_b32 s95, s63
    s_waitcnt vmcnt(25)
    ds_read_b64_tr_b16 a[128:129], v136 offset:0
    ds_read_b64_tr_b16 a[130:131], v137 offset:1024
    ds_read_b64_tr_b16 a[144:145], v138 offset:0
    ds_read_b64_tr_b16 a[146:147], v139 offset:1024
    ds_read_b64_tr_b16 a[160:161], v140 offset:0
    ds_read_b64_tr_b16 a[162:163], v141 offset:1024
    ds_read_b64_tr_b16 a[176:177], v142 offset:0
    ds_read_b64_tr_b16 a[178:179], v143 offset:1024
    ds_read_b64_tr_b16 a[192:193], v144 offset:0
    ds_read_b64_tr_b16 a[194:195], v145 offset:1024
    ds_read_b64_tr_b16 a[208:209], v146 offset:0
    ds_read_b64_tr_b16 a[210:211], v147 offset:1024
    ds_read_b64_tr_b16 a[224:225], v148 offset:0
    ds_read_b64_tr_b16 a[226:227], v149 offset:1024
    ds_read_b64_tr_b16 a[240:241], v150 offset:0
    ds_read_b64_tr_b16 a[242:243], v151 offset:1024
    s_waitcnt lgkmcnt(0)
    s_add_u32 s39, s90, s62
    s_mov_b32 m0, s39
    s_add_u32 s62, s62, 4096
    s_and_b32 s62, s62, 0x7fff
    buffer_load_dwordx4 v76, s[52:55], s95 offen offset:0 nt lds
    buffer_load_dwordx4 v77, s[52:55], s95 offen offset:1024 nt lds
    buffer_load_dwordx4 v78, s[52:55], s95 offen offset:2048 nt lds
    buffer_load_dwordx4 v79, s[52:55], s95 offen offset:3072 nt lds
    s_add_u32 s95, s95, 16384
    s_add_u32 s39, s90, s62
    s_mov_b32 m0, s39
    s_add_u32 s62, s62, 4096
    s_and_b32 s62, s62, 0x7fff
    buffer_load_dwordx4 v76, s[52:55], s95 offen offset:0 nt lds
    buffer_load_dwordx4 v77, s[52:55], s95 offen offset:1024 nt lds
    buffer_load_dwordx4 v78, s[52:55], s95 offen offset:2048 nt lds
    buffer_load_dwordx4 v79, s[52:55], s95 offen offset:3072 nt lds
    s_add_u32 s95, s95, 16384
    s_waitcnt vmcnt(24)
    ds_read_b64_tr_b16 a[132:133], v136 offset:8192
    ds_read_b64_tr_b16 a[134:135], v137 offset:9216
    ds_read_b64_tr_b16 a[148:149], v138 offset:8192
    ds_read_b64_tr_b16 a[150:151], v139 offset:9216
    ds_read_b64_tr_b16 a[164:165], v140 offset:8192
    ds_read_b64_tr_b16 a[166:167], v141 offset:9216
    ds_read_b64_tr_b16 a[180:181], v142 offset:8192
    ds_read_b64_tr_b16 a[182:183], v143 offset:9216
    ds_read_b64_tr_b16 a[196:197], v144 offset:8192
    ds_read_b64_tr_b16 a[198:199], v145 offset:9216
    ds_read_b64_tr_b16 a[212:213], v146 offset:8192
    ds_read_b64_tr_b16 a[214:215], v147 offset:9216
    ds_read_b64_tr_b16 a[228:229], v148 offset:8192
    ds_read_b64_tr_b16 a[230:231], v149 offset:9216
    ds_read_b64_tr_b16 a[244:245], v150 offset:8192
    ds_read_b64_tr_b16 a[246:247], v151 offset:9216
    s_waitcnt lgkmcnt(0)
    s_add_u32 s39, s90, s62
    s_mov_b32 m0, s39
    s_add_u32 s62, s62, 4096
    s_and_b32 s62, s62, 0x7fff
    buffer_load_dwordx4 v76, s[52:55], s95 offen offset:0 nt lds
    buffer_load_dwordx4 v77, s[52:55], s95 offen offset:1024 nt lds
    buffer_load_dwordx4 v78, s[52:55], s95 offen offset:2048 nt lds
    buffer_load_dwordx4 v79, s[52:55], s95 offen offset:3072 nt lds
    s_add_u32 s95, s95, 16384
    s_add_u32 s39, s90, s62
    s_mov_b32 m0, s39
    s_add_u32 s62, s62, 4096
    s_and_b32 s62, s62, 0x7fff
    buffer_load_dwordx4 v76, s[52:55], s95 offen offset:0 nt lds
    buffer_load_dwordx4 v77, s[52:55], s95 offen offset:1024 nt lds
    buffer_load_dwordx4 v78, s[52:55], s95 offen offset:2048 nt lds
    buffer_load_dwordx4 v79, s[52:55], s95 offen offset:3072 nt lds
    s_add_u32 s95, s95, 16384
    s_waitcnt vmcnt(24)
    ds_read_b64_tr_b16 a[136:137], v136 offset:16384
    ds_read_b64_tr_b16 a[138:139], v137 offset:17408
    ds_read_b64_tr_b16 a[152:153], v138 offset:16384
    ds_read_b64_tr_b16 a[154:155], v139 offset:17408
    ds_read_b64_tr_b16 a[168:169], v140 offset:16384
    ds_read_b64_tr_b16 a[170:171], v141 offset:17408
    ds_read_b64_tr_b16 a[184:185], v142 offset:16384
    ds_read_b64_tr_b16 a[186:187], v143 offset:17408
    ds_read_b64_tr_b16 a[200:201], v144 offset:16384
    ds_read_b64_tr_b16 a[202:203], v145 offset:17408
    ds_read_b64_tr_b16 a[216:217], v146 offset:16384
    ds_read_b64_tr_b16 a[218:219], v147 offset:17408
    ds_read_b64_tr_b16 a[232:233], v148 offset:16384
    ds_read_b64_tr_b16 a[234:235], v149 offset:17408
    ds_read_b64_tr_b16 a[248:249], v150 offset:16384
    ds_read_b64_tr_b16 a[250:251], v151 offset:17408
    s_waitcnt lgkmcnt(0)
    s_add_u32 s39, s90, s62
    s_mov_b32 m0, s39
    s_add_u32 s62, s62, 4096
    s_and_b32 s62, s62, 0x7fff
    buffer_load_dwordx4 v76, s[52:55], s95 offen offset:0 nt lds
    buffer_load_dwordx4 v77, s[52:55], s95 offen offset:1024 nt lds
    buffer_load_dwordx4 v78, s[52:55], s95 offen offset:2048 nt lds
    buffer_load_dwordx4 v79, s[52:55], s95 offen offset:3072 nt lds
    s_add_u32 s95, s95, 16384
    s_add_u32 s39, s90, s62
    s_mov_b32 m0, s39
    s_add_u32 s62, s62, 4096
    s_and_b32 s62, s62, 0x7fff
    buffer_load_dwordx4 v76, s[52:55], s95 offen offset:0 nt lds
    buffer_load_dwordx4 v77, s[52:55], s95 offen offset:1024 nt lds
    buffer_load_dwordx4 v78, s[52:55], s95 offen offset:2048 nt lds
    buffer_load_dwordx4 v79, s[52:55], s95 offen offset:3072 nt lds
    s_add_u32 s95, s95, 16384
    s_waitcnt vmcnt(24)
    ds_read_b64_tr_b16 a[140:141], v136 offset:24576
    ds_read_b64_tr_b16 a[142:143], v137 offset:25600
    ds_read_b64_tr_b16 a[156:157], v138 offset:24576
    ds_read_b64_tr_b16 a[158:159], v139 offset:25600
    ds_read_b64_tr_b16 a[172:173], v140 offset:24576
    ds_read_b64_tr_b16 a[174:175], v141 offset:25600
    ds_read_b64_tr_b16 a[188:189], v142 offset:24576
    ds_read_b64_tr_b16 a[190:191], v143 offset:25600
    ds_read_b64_tr_b16 a[204:205], v144 offset:24576
    ds_read_b64_tr_b16 a[206:207], v145 offset:25600
    ds_read_b64_tr_b16 a[220:221], v146 offset:24576
    ds_read_b64_tr_b16 a[222:223], v147 offset:25600
    ds_read_b64_tr_b16 a[236:237], v148 offset:24576
    ds_read_b64_tr_b16 a[238:239], v149 offset:25600
    ds_read_b64_tr_b16 a[252:253], v150 offset:24576
    ds_read_b64_tr_b16 a[254:255], v151 offset:25600
    s_waitcnt lgkmcnt(0)
    s_add_u32 s39, s90, s62
    s_mov_b32 m0, s39
    s_add_u32 s62, s62, 4096
    s_and_b32 s62, s62, 0x7fff
    buffer_load_dwordx4 v76, s[52:55], s95 offen offset:0 nt lds
    buffer_load_dwordx4 v77, s[52:55], s95 offen offset:1024 nt lds
    buffer_load_dwordx4 v78, s[52:55], s95 offen offset:2048 nt lds
    buffer_load_dwordx4 v79, s[52:55], s95 offen offset:3072 nt lds
    s_add_u32 s95, s95, 16384
    s_add_u32 s39, s90, s62
    s_mov_b32 m0, s39
    s_add_u32 s62, s62, 4096
    s_and_b32 s62, s62, 0x7fff
    buffer_load_dwordx4 v76, s[52:55], s95 offen offset:0 nt lds
    buffer_load_dwordx4 v77, s[52:55], s95 offen offset:1024 nt lds
    buffer_load_dwordx4 v78, s[52:55], s95 offen offset:2048 nt lds
    buffer_load_dwordx4 v79, s[52:55], s95 offen offset:3072 nt lds
    s_add_u32 s95, s95, 16384
    s_mov_b32 s52, s6
    s_and_b32 s53, s7, 0xffff
    s_mov_b32 s54, 16777216
    s_mov_b32 s55, 0x20000
    s_lshl_b32 s95, s32, 19
    s_lshl_b32 s38, s34, 8
    s_add_u32 s95, s95, s38
    s_waitcnt vmcnt(24)
    ds_read_b64_tr_b16 a[0:1], v136 offset:0
    ds_read_b64_tr_b16 a[2:3], v137 offset:1024
    ds_read_b64_tr_b16 a[16:17], v138 offset:0
    ds_read_b64_tr_b16 a[18:19], v139 offset:1024
    ds_read_b64_tr_b16 a[32:33], v140 offset:0
    ds_read_b64_tr_b16 a[34:35], v141 offset:1024
    ds_read_b64_tr_b16 a[48:49], v142 offset:0
    ds_read_b64_tr_b16 a[50:51], v143 offset:1024
    ds_read_b64_tr_b16 a[64:65], v144 offset:0
    ds_read_b64_tr_b16 a[66:67], v145 offset:1024
    ds_read_b64_tr_b16 a[80:81], v146 offset:0
    ds_read_b64_tr_b16 a[82:83], v147 offset:1024
    ds_read_b64_tr_b16 a[96:97], v148 offset:0
    ds_read_b64_tr_b16 a[98:99], v149 offset:1024
    ds_read_b64_tr_b16 a[112:113], v150 offset:0
    ds_read_b64_tr_b16 a[114:115], v151 offset:1024
    s_waitcnt lgkmcnt(0)
    s_add_u32 s39, s90, s62
    s_mov_b32 m0, s39
    s_add_u32 s62, s62, 4096
    s_and_b32 s62, s62, 0x7fff
    buffer_load_dwordx4 v76, s[52:55], s95 offen offset:0 nt lds
    buffer_load_dwordx4 v77, s[52:55], s95 offen offset:1024 nt lds
    buffer_load_dwordx4 v78, s[52:55], s95 offen offset:2048 nt lds
    buffer_load_dwordx4 v79, s[52:55], s95 offen offset:3072 nt lds
    s_add_u32 s95, s95, 16384
    s_add_u32 s39, s90, s62
    s_mov_b32 m0, s39
    s_add_u32 s62, s62, 4096
    s_and_b32 s62, s62, 0x7fff
    buffer_load_dwordx4 v76, s[52:55], s95 offen offset:0 nt lds
    buffer_load_dwordx4 v77, s[52:55], s95 offen offset:1024 nt lds
    buffer_load_dwordx4 v78, s[52:55], s95 offen offset:2048 nt lds
    buffer_load_dwordx4 v79, s[52:55], s95 offen offset:3072 nt lds
    s_add_u32 s95, s95, 16384
    s_waitcnt vmcnt(24)
    ds_read_b64_tr_b16 a[4:5], v136 offset:8192
    ds_read_b64_tr_b16 a[6:7], v137 offset:9216
    ds_read_b64_tr_b16 a[20:21], v138 offset:8192
    ds_read_b64_tr_b16 a[22:23], v139 offset:9216
    ds_read_b64_tr_b16 a[36:37], v140 offset:8192
    ds_read_b64_tr_b16 a[38:39], v141 offset:9216
    ds_read_b64_tr_b16 a[52:53], v142 offset:8192
    ds_read_b64_tr_b16 a[54:55], v143 offset:9216
    ds_read_b64_tr_b16 a[68:69], v144 offset:8192
    ds_read_b64_tr_b16 a[70:71], v145 offset:9216
    ds_read_b64_tr_b16 a[84:85], v146 offset:8192
    ds_read_b64_tr_b16 a[86:87], v147 offset:9216
    ds_read_b64_tr_b16 a[100:101], v148 offset:8192
    ds_read_b64_tr_b16 a[102:103], v149 offset:9216
    ds_read_b64_tr_b16 a[116:117], v150 offset:8192
    ds_read_b64_tr_b16 a[118:119], v151 offset:9216
    s_waitcnt lgkmcnt(0)
    s_add_u32 s39, s90, s62
    s_mov_b32 m0, s39
    s_add_u32 s62, s62, 4096
    s_and_b32 s62, s62, 0x7fff
    buffer_load_dwordx4 v76, s[52:55], s95 offen offset:0 nt lds
    buffer_load_dwordx4 v77, s[52:55], s95 offen offset:1024 nt lds
    buffer_load_dwordx4 v78, s[52:55], s95 offen offset:2048 nt lds
    buffer_load_dwordx4 v79, s[52:55], s95 offen offset:3072 nt lds
    s_add_u32 s95, s95, 16384
    s_add_u32 s39, s90, s62
    s_mov_b32 m0, s39
    s_add_u32 s62, s62, 4096
    s_and_b32 s62, s62, 0x7fff
    buffer_load_dwordx4 v76, s[52:55], s95 offen offset:0 nt lds
    buffer_load_dwordx4 v77, s[52:55], s95 offen offset:1024 nt lds
    buffer_load_dwordx4 v78, s[52:55], s95 offen offset:2048 nt lds
    buffer_load_dwordx4 v79, s[52:55], s95 offen offset:3072 nt lds
    s_add_u32 s95, s95, 16384
    s_waitcnt vmcnt(24)
    ds_read_b64_tr_b16 a[8:9], v136 offset:16384
    ds_read_b64_tr_b16 a[10:11], v137 offset:17408
    ds_read_b64_tr_b16 a[24:25], v138 offset:16384
    ds_read_b64_tr_b16 a[26:27], v139 offset:17408
    ds_read_b64_tr_b16 a[40:41], v140 offset:16384
    ds_read_b64_tr_b16 a[42:43], v141 offset:17408
    ds_read_b64_tr_b16 a[56:57], v142 offset:16384
    ds_read_b64_tr_b16 a[58:59], v143 offset:17408
    ds_read_b64_tr_b16 a[72:73], v144 offset:16384
    ds_read_b64_tr_b16 a[74:75], v145 offset:17408
    ds_read_b64_tr_b16 a[88:89], v146 offset:16384
    ds_read_b64_tr_b16 a[90:91], v147 offset:17408
    ds_read_b64_tr_b16 a[104:105], v148 offset:16384
    ds_read_b64_tr_b16 a[106:107], v149 offset:17408
    ds_read_b64_tr_b16 a[120:121], v150 offset:16384
    ds_read_b64_tr_b16 a[122:123], v151 offset:17408
    s_waitcnt lgkmcnt(0)
    s_add_u32 s39, s90, s62
    s_mov_b32 m0, s39
    s_add_u32 s62, s62, 4096
    s_and_b32 s62, s62, 0x7fff
    buffer_load_dwordx4 v76, s[52:55], s95 offen offset:0 nt lds
    buffer_load_dwordx4 v77, s[52:55], s95 offen offset:1024 nt lds
    buffer_load_dwordx4 v78, s[52:55], s95 offen offset:2048 nt lds
    buffer_load_dwordx4 v79, s[52:55], s95 offen offset:3072 nt lds
    s_add_u32 s95, s95, 16384
    s_add_u32 s39, s90, s62
    s_mov_b32 m0, s39
    s_add_u32 s62, s62, 4096
    s_and_b32 s62, s62, 0x7fff
    buffer_load_dwordx4 v76, s[52:55], s95 offen offset:0 nt lds
    buffer_load_dwordx4 v77, s[52:55], s95 offen offset:1024 nt lds
    buffer_load_dwordx4 v78, s[52:55], s95 offen offset:2048 nt lds
    buffer_load_dwordx4 v79, s[52:55], s95 offen offset:3072 nt lds
    s_add_u32 s95, s95, 16384
    s_waitcnt vmcnt(24)
    ds_read_b64_tr_b16 a[12:13], v136 offset:24576
    ds_read_b64_tr_b16 a[14:15], v137 offset:25600
    ds_read_b64_tr_b16 a[28:29], v138 offset:24576
    ds_read_b64_tr_b16 a[30:31], v139 offset:25600
    ds_read_b64_tr_b16 a[44:45], v140 offset:24576
    ds_read_b64_tr_b16 a[46:47], v141 offset:25600
    ds_read_b64_tr_b16 a[60:61], v142 offset:24576
    ds_read_b64_tr_b16 a[62:63], v143 offset:25600
    ds_read_b64_tr_b16 a[76:77], v144 offset:24576
    ds_read_b64_tr_b16 a[78:79], v145 offset:25600
    ds_read_b64_tr_b16 a[92:93], v146 offset:24576
    ds_read_b64_tr_b16 a[94:95], v147 offset:25600
    ds_read_b64_tr_b16 a[108:109], v148 offset:24576
    ds_read_b64_tr_b16 a[110:111], v149 offset:25600
    ds_read_b64_tr_b16 a[124:125], v150 offset:24576
    ds_read_b64_tr_b16 a[126:127], v151 offset:25600
    s_waitcnt lgkmcnt(0)
    s_mov_b32 s86, 131072
    buffer_load_dword v7, v101, s[48:51], s86 offen sc1
    s_add_u32 s39, s90, s62
    s_mov_b32 m0, s39
    s_add_u32 s62, s62, 4096
    s_and_b32 s62, s62, 0x7fff
    buffer_load_dwordx4 v76, s[52:55], s95 offen offset:0 nt lds
    buffer_load_dwordx4 v77, s[52:55], s95 offen offset:1024 nt lds
    buffer_load_dwordx4 v78, s[52:55], s95 offen offset:2048 nt lds
    buffer_load_dwordx4 v79, s[52:55], s95 offen offset:3072 nt lds
    s_add_u32 s95, s95, 16384
    s_add_u32 s39, s90, s62
    s_mov_b32 m0, s39
    s_add_u32 s62, s62, 4096
    s_and_b32 s62, s62, 0x7fff
    buffer_load_dwordx4 v76, s[52:55], s95 offen offset:0 nt lds
    v_mov_b32 v136, 0
    v_mov_b32 v137, 0
    v_mov_b32 v138, 0
    v_mov_b32 v139, 0
    v_mov_b32 v140, 0
    v_mov_b32 v141, 0
    v_mov_b32 v142, 0
    v_mov_b32 v143, 0
    v_mov_b32 v144, 0
    v_mov_b32 v145, 0
    v_mov_b32 v146, 0
    v_mov_b32 v147, 0
    v_mov_b32 v148, 0
    v_mov_b32 v149, 0
    v_mov_b32 v150, 0
    v_mov_b32 v151, 0
    v_mov_b32 v152, 0
    v_mov_b32 v153, 0
    v_mov_b32 v154, 0
    v_mov_b32 v155, 0
    v_mov_b32 v156, 0
    v_mov_b32 v157, 0
    v_mov_b32 v158, 0
    v_mov_b32 v159, 0
    v_mov_b32 v160, 0
    v_mov_b32 v161, 0
    v_mov_b32 v162, 0
    v_mov_b32 v163, 0
    v_mov_b32 v164, 0
    v_mov_b32 v165, 0
    v_mov_b32 v166, 0
    v_mov_b32 v167, 0
    v_mov_b32 v168, 0
    v_mov_b32 v169, 0
    v_mov_b32 v170, 0
    v_mov_b32 v171, 0
    v_mov_b32 v172, 0
    v_mov_b32 v173, 0
    v_mov_b32 v174, 0
    v_mov_b32 v175, 0
    v_mov_b32 v176, 0
    v_mov_b32 v177, 0
    v_mov_b32 v178, 0
    v_mov_b32 v179, 0
    v_mov_b32 v180, 0
    v_mov_b32 v181, 0
    v_mov_b32 v182, 0
    v_mov_b32 v183, 0
    v_mov_b32 v184, 0
    v_mov_b32 v185, 0
    v_mov_b32 v186, 0
    v_mov_b32 v187, 0
    v_mov_b32 v188, 0
    v_mov_b32 v189, 0
    v_mov_b32 v190, 0
    v_mov_b32 v191, 0
    v_mov_b32 v192, 0
    v_mov_b32 v193, 0
    v_mov_b32 v194, 0
    v_mov_b32 v195, 0
    v_mov_b32 v196, 0
    v_mov_b32 v197, 0
    v_mov_b32 v198, 0
    v_mov_b32 v199, 0
    v_mov_b32 v90, 0xff7f0000
    s_mov_b32 s93, 0
    v_mov_b32 v102, 0
    v_mov_b32 v103, 0
    s_mov_b32 s60, s83
    s_mov_b32 s61, s83
    v_add_u32 v4, s85, v80
    v_xor_b32 v82, 0, v4
    v_xor_b32 v83, 32, v4
    v_xor_b32 v84, 64, v4
    v_xor_b32 v85, 96, v4
    v_xor_b32 v86, 128, v4
    v_xor_b32 v87, 160, v4
    v_xor_b32 v88, 192, v4
    v_xor_b32 v89, 224, v4
    v_add_u32 v80, s90, v80
    v_add_u32 v81, s90, v81
    s_lshr_b32 s36, s32, 3
    s_lshl_b32 s36, s36, 15
    s_lshl_b32 s38, s34, 8
    s_add_u32 s36, s36, s38
    s_add_u32 s36, s36, 2097152
    s_waitcnt vmcnt(5)
L_fcheck_23:
    v_cmp_ne_u32 vcc, s68, v7
    s_cbranch_vccz L_fok_24
    s_sleep 2
    s_mov_b32 s86, 131072
    buffer_load_dword v7, v101, s[48:51], s86 offen sc1
    s_waitcnt vmcnt(0)
    s_sub_u32 s84, s84, 1
    s_cmp_lg_u32 s84, 0
    s_cbranch_scc1 L_fcheck_23
    s_branch L_end
L_fok_24:
    buffer_load_dwordx4 v[20:23], v9, s[48:51], s36 offen sc1
    s_add_u32 s36, s36, 4096
    buffer_load_dwordx4 v[24:27], v9, s[48:51], s36 offen sc1
    s_add_u32 s36, s36, 4096
    buffer_load_dwordx4 v[28:31], v9, s[48:51], s36 offen sc1
    s_add_u32 s36, s36, 4096
    buffer_load_dwordx4 v[32:35], v9, s[48:51], s36 offen sc1
    s_add_u32 s36, s36, 4096
    buffer_load_dwordx4 v[36:39], v9, s[48:51], s36 offen sc1
    s_add_u32 s36, s36, 4096
    buffer_load_dwordx4 v[40:43], v9, s[48:51], s36 offen sc1
    s_add_u32 s36, s36, 4096
    buffer_load_dwordx4 v[44:47], v9, s[48:51], s36 offen sc1
    s_add_u32 s36, s36, 4096
    buffer_load_dwordx4 v[48:51], v9, s[48:51], s36 offen sc1
    s_waitcnt vmcnt(7)
    ds_write_b128 v96, v[20:23] offset:0
    s_waitcnt vmcnt(6)
    ds_write_b128 v97, v[24:27] offset:1024
    s_waitcnt vmcnt(5)
    ds_write_b128 v98, v[28:31] offset:2048
    s_waitcnt vmcnt(4)
    ds_write_b128 v99, v[32:35] offset:3072
    s_waitcnt vmcnt(3)
    ds_write_b128 v96, v[36:39] offset:4096
    s_waitcnt vmcnt(2)
    ds_write_b128 v97, v[40:43] offset:5120
    s_waitcnt vmcnt(1)
    ds_write_b128 v98, v[44:47] offset:6144
    s_waitcnt vmcnt(0)
    ds_write_b128 v99, v[48:51] offset:7168
    s_waitcnt lgkmcnt(0)
    ds_read_b128 v[104:107], v82
    ds_read_b128 v[108:111], v83
    ds_read_b128 v[112:115], v84
    ds_read_b128 v[116:119], v85
    ds_read_b128 v[120:123], v86
    ds_read_b128 v[124:127], v87
    ds_read_b128 v[128:131], v88
    ds_read_b128 v[132:135], v89
    v_xor_b32 v82, 0, v80
    ds_read_b128 v[216:219], v82
    v_xor_b32 v83, 32, v80
    ds_read_b128 v[220:223], v83
    v_xor_b32 v84, 64, v80
    ds_read_b128 v[224:227], v84
    v_xor_b32 v85, 96, v80
    ds_read_b128 v[228:231], v85
    v_xor_b32 v86, 128, v80
    ds_read_b128 v[232:235], v86
    v_xor_b32 v87, 160, v80
    ds_read_b128 v[236:239], v87
    v_xor_b32 v88, 192, v80
    ds_read_b128 v[240:243], v88
    v_xor_b32 v89, 224, v80
    ds_read_b128 v[244:247], v89
L_att:
    v_add_u32 v4, s94, v81
    s_waitcnt lgkmcnt(0)
    v_mfma_f32_32x32x16_bf16 v[200:215], v[216:219], v[104:107], 0
    v_xor_b32 v82, 0, v4
    ds_read_b64_tr_b16 v[20:21], v82 offset:0
    ds_read_b64_tr_b16 v[24:25], v82 offset:4096
    buffer_load_dwordx4 v77, s[52:55], s95 offen offset:1024 nt lds
    v_mfma_f32_32x32x16_bf16 v[200:215], v[220:223], v[108:111], v[200:215]
    v_xor_b32 v83, 32, v4
    ds_read_b64_tr_b16 v[22:23], v83 offset:2048
    ds_read_b64_tr_b16 v[26:27], v83 offset:6144
    v_mfma_f32_32x32x16_bf16 v[200:215], v[224:227], v[112:115], v[200:215]
    v_xor_b32 v84, 64, v4
    ds_read_b64_tr_b16 v[28:29], v84 offset:0
    ds_read_b64_tr_b16 v[32:33], v84 offset:4096
    v_mfma_f32_32x32x16_bf16 v[200:215], v[228:231], v[116:119], v[200:215]
    v_xor_b32 v85, 96, v4
    ds_read_b64_tr_b16 v[30:31], v85 offset:2048
    ds_read_b64_tr_b16 v[34:35], v85 offset:6144
    v_mfma_f32_32x32x16_bf16 v[200:215], v[232:235], v[120:123], v[200:215]
    v_xor_b32 v86, 128, v4
    ds_read_b64_tr_b16 v[36:37], v86 offset:0
    ds_read_b64_tr_b16 v[40:41], v86 offset:4096
    buffer_load_dwordx4 v78, s[52:55], s95 offen offset:2048 nt lds
    v_mfma_f32_32x32x16_bf16 v[200:215], v[236:239], v[124:127], v[200:215]
    v_xor_b32 v87, 160, v4
    ds_read_b64_tr_b16 v[38:39], v87 offset:2048
    ds_read_b64_tr_b16 v[42:43], v87 offset:6144
    v_mfma_f32_32x32x16_bf16 v[200:215], v[240:243], v[128:131], v[200:215]
    v_xor_b32 v88, 192, v4
    ds_read_b64_tr_b16 v[44:45], v88 offset:0
    ds_read_b64_tr_b16 v[48:49], v88 offset:4096
    v_mfma_f32_32x32x16_bf16 v[200:215], v[244:247], v[132:135], v[200:215]
    v_xor_b32 v89, 224, v4
    ds_read_b64_tr_b16 v[46:47], v89 offset:2048
    ds_read_b64_tr_b16 v[50:51], v89 offset:6144
    buffer_load_dwordx4 v79, s[52:55], s95 offen offset:3072 nt lds
    s_add_u32 s95, s95, 16384
    v_xor_b32 v5, 0x2000, v94
    v_xor_b32 v6, 0x4000, v94
    v_xor_b32 v7, 0x6000, v94
    s_cmp_lg_u32 s93, 12
    s_cbranch_scc1 L_noswitch_25
    s_mov_b32 s52, s24
    s_and_b32 s53, s25, 0xffff
    s_mov_b32 s54, 4194304
    s_mov_b32 s55, 0x20000
    s_mov_b32 s95, s63
L_noswitch_25:
    s_nop 1
    ds_write_b128 v94, v[200:203] offset:0
    ds_write_b128 v94, v[204:207] offset:1024
    ds_write_b128 v94, v[208:211] offset:2048
    ds_write_b128 v94, v[212:215] offset:3072
    s_waitcnt lgkmcnt(0)
    s_barrier
    ds_read_b128 v[60:63], v5 offset:0
    ds_read_b128 v[216:219], v6 offset:0
    ds_read_b128 v[232:235], v7 offset:0
    ds_read_b128 v[64:67], v5 offset:1024
    ds_read_b128 v[220:223], v6 offset:1024
    ds_read_b128 v[236:239], v7 offset:1024
    ds_read_b128 v[68:71], v5 offset:2048
    ds_read_b128 v[224:227], v6 offset:2048
    ds_read_b128 v[240:243], v7 offset:2048
    ds_read_b128 v[72:75], v5 offset:3072
    ds_read_b128 v[228:231], v6 offset:3072
    ds_read_b128 v[244:247], v7 offset:3072
    v_xor_b32 v94, 0x1000, v94
    s_add_u32 s39, s90, s62
    s_mov_b32 m0, s39
    s_add_u32 s62, s62, 4096
    s_and_b32 s62, s62, 0x7fff
    buffer_load_dwordx4 v76, s[52:55], s95 offen offset:0 nt lds
    s_add_u32 s94, s94, 8192
    s_and_b32 s94, s94, 0x7fff
    s_waitcnt lgkmcnt(9)
    v_pk_add_f32 v[200:201], v[200:201], v[60:61]
    v_pk_add_f32 v[216:217], v[216:217], v[232:233]
    v_pk_add_f32 v[202:203], v[202:203], v[62:63]
    v_pk_add_f32 v[218:219], v[218:219], v[234:235]
    v_pk_add_f32 v[200:201], v[200:201], v[216:217]
    v_pk_add_f32 v[202:203], v[202:203], v[218:219]
    s_waitcnt lgkmcnt(6)
    v_pk_add_f32 v[204:205], v[204:205], v[64:65]
    v_pk_add_f32 v[220:221], v[220:221], v[236:237]
    v_pk_add_f32 v[206:207], v[206:207], v[66:67]
    v_pk_add_f32 v[222:223], v[222:223], v[238:239]
    v_pk_add_f32 v[204:205], v[204:205], v[220:221]
    v_pk_add_f32 v[206:207], v[206:207], v[222:223]
    s_waitcnt lgkmcnt(3)
    v_pk_add_f32 v[208:209], v[208:209], v[68:69]
    v_pk_add_f32 v[224:225], v[224:225], v[240:241]
    v_pk_add_f32 v[210:211], v[210:211], v[70:71]
    v_pk_add_f32 v[226:227], v[226:227], v[242:243]
    v_pk_add_f32 v[208:209], v[208:209], v[224:225]
    v_pk_add_f32 v[210:211], v[210:211], v[226:227]
    s_waitcnt lgkmcnt(0)
    v_pk_add_f32 v[212:213], v[212:213], v[72:73]
    v_pk_add_f32 v[228:229], v[228:229], v[244:245]
    v_pk_add_f32 v[214:215], v[214:215], v[74:75]
    v_pk_add_f32 v[230:231], v[230:231], v[246:247]
    v_pk_add_f32 v[212:213], v[212:213], v[228:229]
    v_pk_add_f32 v[214:215], v[214:215], v[230:231]
    buffer_load_dwordx4 v77, s[52:55], s95 offen offset:1024 nt lds
    v_max_f32 v4, v200, v201
    v_max3_f32 v4, v4, v202, v203
    v_max3_f32 v4, v4, v204, v205
    v_max3_f32 v4, v4, v206, v207
    v_max3_f32 v4, v4, v208, v209
    v_max3_f32 v4, v4, v210, v211
    v_max3_f32 v4, v4, v212, v213
    v_max3_f32 v4, v4, v214, v215
    v_mov_b32 v5, v4
    s_nop 1
    v_permlane32_swap_b32 v4, v5
    v_max_f32 v4, v4, v5
    v_mul_f32 v4, s83, v4
    v_max_f32 v4, v4, v90
    v_sub_f32 v92, v90, v4
    v_exp_f32 v92, v92
    v_mov_b32 v90, v4
    v_pk_fma_f32 v[200:201], v[200:201], s[60:61], v[90:91] op_sel_hi:[1,1,0] neg_lo:[0,0,1] neg_hi:[0,0,1]
    v_pk_fma_f32 v[202:203], v[202:203], s[60:61], v[90:91] op_sel_hi:[1,1,0] neg_lo:[0,0,1] neg_hi:[0,0,1]
    v_pk_fma_f32 v[204:205], v[204:205], s[60:61], v[90:91] op_sel_hi:[1,1,0] neg_lo:[0,0,1] neg_hi:[0,0,1]
    v_pk_fma_f32 v[206:207], v[206:207], s[60:61], v[90:91] op_sel_hi:[1,1,0] neg_lo:[0,0,1] neg_hi:[0,0,1]
    v_pk_fma_f32 v[208:209], v[208:209], s[60:61], v[90:91] op_sel_hi:[1,1,0] neg_lo:[0,0,1] neg_hi:[0,0,1]
    v_pk_fma_f32 v[210:211], v[210:211], s[60:61], v[90:91] op_sel_hi:[1,1,0] neg_lo:[0,0,1] neg_hi:[0,0,1]
    v_pk_fma_f32 v[212:213], v[212:213], s[60:61], v[90:91] op_sel_hi:[1,1,0] neg_lo:[0,0,1] neg_hi:[0,0,1]
    v_pk_fma_f32 v[214:215], v[214:215], s[60:61], v[90:91] op_sel_hi:[1,1,0] neg_lo:[0,0,1] neg_hi:[0,0,1]
    v_exp_f32 v200, v200
    v_exp_f32 v201, v201
    v_exp_f32 v202, v202
    v_exp_f32 v203, v203
    v_exp_f32 v204, v204
    buffer_load_dwordx4 v78, s[52:55], s95 offen offset:2048 nt lds
    v_exp_f32 v205, v205
    v_exp_f32 v206, v206
    v_exp_f32 v207, v207
    v_exp_f32 v208, v208
    v_exp_f32 v209, v209
    v_exp_f32 v210, v210
    v_exp_f32 v211, v211
    v_exp_f32 v212, v212
    v_exp_f32 v213, v213
    v_exp_f32 v214, v214
    v_exp_f32 v215, v215
    v_add_u32 v4, s94, v80
    v_pk_mul_f32 v[102:103], v[102:103], v[92:93] op_sel_hi:[1,0]
    v_pk_mul_f32 v[136:137], v[136:137], v[92:93] op_sel_hi:[1,0]
    v_pk_mul_f32 v[138:139], v[138:139], v[92:93] op_sel_hi:[1,0]
    v_pk_mul_f32 v[140:141], v[140:141], v[92:93] op_sel_hi:[1,0]
    v_pk_mul_f32 v[142:143], v[142:143], v[92:93] op_sel_hi:[1,0]
    v_pk_mul_f32 v[144:145], v[144:145], v[92:93] op_sel_hi:[1,0]
    v_pk_mul_f32 v[146:147], v[146:147], v[92:93] op_sel_hi:[1,0]
    v_pk_mul_f32 v[148:149], v[148:149], v[92:93] op_sel_hi:[1,0]
    v_pk_mul_f32 v[150:151], v[150:151], v[92:93] op_sel_hi:[1,0]
    v_pk_mul_f32 v[152:153], v[152:153], v[92:93] op_sel_hi:[1,0]
    v_pk_mul_f32 v[154:155], v[154:155], v[92:93] op_sel_hi:[1,0]
    v_pk_mul_f32 v[156:157], v[156:157], v[92:93] op_sel_hi:[1,0]
    v_pk_mul_f32 v[158:159], v[158:159], v[92:93] op_sel_hi:[1,0]
    v_pk_mul_f32 v[160:161], v[160:161], v[92:93] op_sel_hi:[1,0]
    v_pk_mul_f32 v[162:163], v[162:163], v[92:93] op_sel_hi:[1,0]
    v_pk_mul_f32 v[164:165], v[164:165], v[92:93] op_sel_hi:[1,0]
    v_pk_mul_f32 v[166:167], v[166:167], v[92:93] op_sel_hi:[1,0]
    v_pk_mul_f32 v[168:169], v[168:169], v[92:93] op_sel_hi:[1,0]
    v_pk_mul_f32 v[170:171], v[170:171], v[92:93] op_sel_hi:[1,0]
    v_pk_mul_f32 v[172:173], v[172:173], v[92:93] op_sel_hi:[1,0]
    v_pk_mul_f32 v[174:175], v[174:175], v[92:93] op_sel_hi:[1,0]
    v_pk_mul_f32 v[176:177], v[176:177], v[92:93] op_sel_hi:[1,0]
    buffer_load_dwordx4 v79, s[52:55], s95 offen offset:3072 nt lds
    s_add_u32 s95, s95, 16384
    v_pk_mul_f32 v[178:179], v[178:179], v[92:93] op_sel_hi:[1,0]
    v_pk_mul_f32 v[180:181], v[180:181], v[92:93] op_sel_hi:[1,0]
    v_pk_mul_f32 v[182:183], v[182:183], v[92:93] op_sel_hi:[1,0]
    v_pk_mul_f32 v[184:185], v[184:185], v[92:93] op_sel_hi:[1,0]
    v_pk_mul_f32 v[186:187], v[186:187], v[92:93] op_sel_hi:[1,0]
    v_pk_mul_f32 v[188:189], v[188:189], v[92:93] op_sel_hi:[1,0]
    v_pk_mul_f32 v[190:191], v[190:191], v[92:93] op_sel_hi:[1,0]
    v_pk_mul_f32 v[192:193], v[192:193], v[92:93] op_sel_hi:[1,0]
    v_pk_mul_f32 v[194:195], v[194:195], v[92:93] op_sel_hi:[1,0]
    v_pk_mul_f32 v[196:197], v[196:197], v[92:93] op_sel_hi:[1,0]
    v_pk_mul_f32 v[198:199], v[198:199], v[92:93] op_sel_hi:[1,0]
    v_cvt_pk_bf16_f32 v52, v200, v201
    v_pk_add_f32 v[102:103], v[102:103], v[200:201]
    v_cvt_pk_bf16_f32 v53, v202, v203
    v_pk_add_f32 v[102:103], v[102:103], v[202:203]
    v_cvt_pk_bf16_f32 v54, v204, v205
    v_pk_add_f32 v[102:103], v[102:103], v[204:205]
    v_cvt_pk_bf16_f32 v55, v206, v207
    v_pk_add_f32 v[102:103], v[102:103], v[206:207]
    v_cvt_pk_bf16_f32 v56, v208, v209
    v_pk_add_f32 v[102:103], v[102:103], v[208:209]
    v_cvt_pk_bf16_f32 v57, v210, v211
    v_pk_add_f32 v[102:103], v[102:103], v[210:211]
    v_cvt_pk_bf16_f32 v58, v212, v213
    v_pk_add_f32 v[102:103], v[102:103], v[212:213]
    v_cvt_pk_bf16_f32 v59, v214, v215
    v_pk_add_f32 v[102:103], v[102:103], v[214:215]
    s_waitcnt vmcnt(20)
    v_mfma_f32_32x32x16_bf16 v[136:151], v[20:23], v[52:55], v[136:151]
    v_xor_b32 v82, 0, v4
    ds_read_b128 v[216:219], v82
    v_xor_b32 v83, 32, v4
    ds_read_b128 v[220:223], v83
    v_mfma_f32_32x32x16_bf16 v[152:167], v[28:31], v[52:55], v[152:167]
    v_xor_b32 v84, 64, v4
    ds_read_b128 v[224:227], v84
    v_xor_b32 v85, 96, v4
    ds_read_b128 v[228:231], v85
    v_mfma_f32_32x32x16_bf16 v[168:183], v[36:39], v[52:55], v[168:183]
    v_xor_b32 v86, 128, v4
    ds_read_b128 v[232:235], v86
    v_xor_b32 v87, 160, v4
    ds_read_b128 v[236:239], v87
    v_mfma_f32_32x32x16_bf16 v[184:199], v[44:47], v[52:55], v[184:199]
    v_xor_b32 v88, 192, v4
    ds_read_b128 v[240:243], v88
    v_xor_b32 v89, 224, v4
    ds_read_b128 v[244:247], v89
    v_mfma_f32_32x32x16_bf16 v[136:151], v[24:27], v[56:59], v[136:151]
    s_add_u32 s39, s90, s62
    s_mov_b32 m0, s39
    s_add_u32 s62, s62, 4096
    s_and_b32 s62, s62, 0x7fff
    buffer_load_dwordx4 v76, s[52:55], s95 offen offset:0 nt lds
    v_mfma_f32_32x32x16_bf16 v[152:167], v[32:35], v[56:59], v[152:167]
    v_mfma_f32_32x32x16_bf16 v[168:183], v[40:43], v[56:59], v[168:183]
    v_mfma_f32_32x32x16_bf16 v[184:199], v[48:51], v[56:59], v[184:199]
    s_add_u32 s93, s93, 1
    s_cmp_lt_u32 s93, 16
    s_cbranch_scc1 L_att
    v_add_f32 v91, v102, v103
    v_mov_b32 v5, v91
    s_nop 1
    v_permlane32_swap_b32 v91, v5
    v_add_f32 v91, v91, v5
    v_and_b32 v4, 31, v1
    v_lshlrev_b32 v5, 8, v4
    v_lshl_add_u32 v5, v3, 4, v5
    v_lshrrev_b32 v6, 5, v1
    v_lshl_add_u32 v5, v6, 3, v5
    v_add_u32 v5, s85, v5
    s_waitcnt lgkmcnt(0)
    s_barrier
    v_cvt_pk_bf16_f32 v20, v136, v137
    v_cvt_pk_bf16_f32 v21, v138, v139
    v_xor_b32 v82, 0, v5
    ds_write_b64 v82, v[20:21]
    v_cvt_pk_bf16_f32 v22, v140, v141
    v_cvt_pk_bf16_f32 v23, v142, v143
    v_xor_b32 v83, 16, v5
    ds_write_b64 v83, v[22:23]
    v_cvt_pk_bf16_f32 v24, v144, v145
    v_cvt_pk_bf16_f32 v25, v146, v147
    v_xor_b32 v84, 32, v5
    ds_write_b64 v84, v[24:25]
    v_cvt_pk_bf16_f32 v26, v148, v149
    v_cvt_pk_bf16_f32 v27, v150, v151
    v_xor_b32 v85, 48, v5
    ds_write_b64 v85, v[26:27]
    v_cvt_pk_bf16_f32 v28, v152, v153
    v_cvt_pk_bf16_f32 v29, v154, v155
    v_xor_b32 v86, 64, v5
    ds_write_b64 v86, v[28:29]
    v_cvt_pk_bf16_f32 v30, v156, v157
    v_cvt_pk_bf16_f32 v31, v158, v159
    v_xor_b32 v87, 80, v5
    ds_write_b64 v87, v[30:31]
    v_cvt_pk_bf16_f32 v32, v160, v161
    v_cvt_pk_bf16_f32 v33, v162, v163
    v_xor_b32 v88, 96, v5
    ds_write_b64 v88, v[32:33]
    v_cvt_pk_bf16_f32 v34, v164, v165
    v_cvt_pk_bf16_f32 v35, v166, v167
    v_xor_b32 v89, 112, v5
    ds_write_b64 v89, v[34:35]
    v_cvt_pk_bf16_f32 v36, v168, v169
    v_cvt_pk_bf16_f32 v37, v170, v171
    v_xor_b32 v82, 128, v5
    ds_write_b64 v82, v[36:37]
    v_cvt_pk_bf16_f32 v38, v172, v173
    v_cvt_pk_bf16_f32 v39, v174, v175
    v_xor_b32 v83, 144, v5
    ds_write_b64 v83, v[38:39]
    v_cvt_pk_bf16_f32 v40, v176, v177
    v_cvt_pk_bf16_f32 v41, v178, v179
    v_xor_b32 v84, 160, v5
    ds_write_b64 v84, v[40:41]
    v_cvt_pk_bf16_f32 v42, v180, v181
    v_cvt_pk_bf16_f32 v43, v182, v183
    v_xor_b32 v85, 176, v5
    ds_write_b64 v85, v[42:43]
    v_cvt_pk_bf16_f32 v44, v184, v185
    v_cvt_pk_bf16_f32 v45, v186, v187
    v_xor_b32 v86, 192, v5
    ds_write_b64 v86, v[44:45]
    v_cvt_pk_bf16_f32 v46, v188, v189
    v_cvt_pk_bf16_f32 v47, v190, v191
    v_xor_b32 v87, 208, v5
    ds_write_b64 v87, v[46:47]
    v_cvt_pk_bf16_f32 v48, v192, v193
    v_cvt_pk_bf16_f32 v49, v194, v195
    v_xor_b32 v88, 224, v5
    ds_write_b64 v88, v[48:49]
    v_cvt_pk_bf16_f32 v50, v196, v197
    v_cvt_pk_bf16_f32 v51, v198, v199
    v_xor_b32 v89, 240, v5
    ds_write_b64 v89, v[50:51]
    v_xor_b32 v6, v3, v2
    v_lshlrev_b32 v6, 4, v6
    v_lshl_add_u32 v6, v2, 8, v6
    v_add_u32 v6, s85, v6
    v_xor_b32 v82, 0, v6
    v_xor_b32 v83, 64, v6
    v_xor_b32 v84, 128, v6
    v_xor_b32 v85, 192, v6
    v_lshlrev_b32 v7, 4, v3
    v_lshl_add_u32 v7, v2, 15, v7
    s_lshl_b32 s36, s32, 10
    s_lshl_b32 s38, s34, 8
    s_add_u32 s36, s36, s38
    s_add_u32 s36, s36, 4194304
    s_waitcnt lgkmcnt(0)
    ds_read_b128 v[200:203], v82 offset:0
    ds_read_b128 v[204:207], v83 offset:1024
    ds_read_b128 v[208:211], v84 offset:2048
    ds_read_b128 v[212:215], v85 offset:3072
    ds_read_b128 v[216:219], v82 offset:4096
    ds_read_b128 v[220:223], v83 offset:5120
    ds_read_b128 v[224:227], v84 offset:6144
    ds_read_b128 v[228:231], v85 offset:7168
    v_lshlrev_b32 v4, 3, v4
    s_lshl_b32 s37, s32, 8
    s_lshl_b32 s38, s34, 13
    s_add_u32 s37, s37, s38
    s_add_u32 s37, s37, 2621440
    s_mov_b32 exec_lo, 0xffffffff
    s_mov_b32 exec_hi, 0x0
    buffer_store_dwordx2 v[90:91], v4, s[48:51], s37 offen sc1
    s_mov_b64 exec, -1
    s_waitcnt lgkmcnt(7)
    buffer_store_dwordx4 v[200:203], v7, s[48:51], s36 offen sc1
    s_add_u32 s36, s36, 131072
    s_waitcnt lgkmcnt(6)
    buffer_store_dwordx4 v[204:207], v7, s[48:51], s36 offen sc1
    s_add_u32 s36, s36, 131072
    s_waitcnt lgkmcnt(5)
    buffer_store_dwordx4 v[208:211], v7, s[48:51], s36 offen sc1
    s_add_u32 s36, s36, 131072
    s_waitcnt lgkmcnt(4)
    buffer_store_dwordx4 v[212:215], v7, s[48:51], s36 offen sc1
    s_add_u32 s36, s36, 131072
    s_waitcnt lgkmcnt(3)
    buffer_store_dwordx4 v[216:219], v7, s[48:51], s36 offen sc1
    s_add_u32 s36, s36, 131072
    s_waitcnt lgkmcnt(2)
    buffer_store_dwordx4 v[220:223], v7, s[48:51], s36 offen sc1
    s_add_u32 s36, s36, 131072
    s_waitcnt lgkmcnt(1)
    buffer_store_dwordx4 v[224:227], v7, s[48:51], s36 offen sc1
    s_add_u32 s36, s36, 131072
    s_waitcnt lgkmcnt(0)
    buffer_store_dwordx4 v[228:231], v7, s[48:51], s36 offen sc1
    buffer_load_dwordx4 v77, s[52:55], s95 offen offset:1024 nt lds
    buffer_load_dwordx4 v78, s[52:55], s95 offen offset:2048 nt lds
    buffer_load_dwordx4 v79, s[52:55], s95 offen offset:3072 nt lds
    s_add_u32 s95, s95, 16384
    v_and_b32 v4, 3, v3
    v_lshrrev_b32 v5, 2, v3
    v_lshlrev_b32 v6, 4, v2
    v_add_u32 v6, 147456, v6
    s_movk_i32 s36, 320
    v_cmp_eq_u32 vcc, 0, v5
    s_nop 1
    v_cndmask_b32 v112, 4, v4, vcc
    v_mad_u32_u24 v112, v112, s36, v6
    v_cmp_eq_u32 vcc, 1, v5
    s_nop 1
    v_cndmask_b32 v113, 4, v4, vcc
    v_mad_u32_u24 v113, v113, s36, v6
    v_cmp_eq_u32 vcc, 2, v5
    s_nop 1
    v_cndmask_b32 v114, 4, v4, vcc
    v_mad_u32_u24 v114, v114, s36, v6
    v_cmp_eq_u32 vcc, 3, v5
    s_nop 1
    v_cndmask_b32 v115, 4, v4, vcc
    v_mad_u32_u24 v115, v115, s36, v6
    s_lshl_b32 s36, s34, 16
    s_lshl_b32 s38, s32, 8
    s_add_u32 s36, s36, s38
    v_add_u32 v77, s36, v19
    s_lshl_b32 s36, s32, 13
    s_lshl_b32 s38, s34, 6
    s_add_u32 s36, s36, s38
    v_lshrrev_b32 v5, 2, v1
    v_lshlrev_b32 v5, 8, v5
    v_lshl_add_u32 v5, v4, 4, v5
    v_add_u32 v78, s36, v5
    s_lshr_b32 s36, s32, 2
    s_lshl_b32 s36, s36, 7
    s_lshl_b32 s38, s34, 5
    s_add_u32 s36, s36, s38
    s_and_b32 s38, s32, 3
    s_lshl_b32 s38, s38, 3
    s_add_u32 s36, s36, s38
    v_lshlrev_b32 v5, 11, v4
    v_lshl_add_u32 v5, v2, 1, v5
    v_add_u32 v79, s36, v5
    v_lshrrev_b32 v5, 2, v3
    v_lshl_add_u32 v6, v4, 3, v5
    v_lshlrev_b32 v81, 8, v6
    v_lshlrev_b32 v6, 10, v6
    v_lshl_add_u32 v80, v2, 4, v6
    s_lshl_b32 s38, s34, 11
    s_add_u32 s38, s38, 131072
    v_lshlrev_b32 v4, 9, v4
    v_lshl_add_u32 v4, v2, 4, v4
    v_add_u32 v94, s38, v4
    s_lshl_b32 s38, s34, 9
    s_add_u32 s38, s38, 131072
    v_and_b32 v5, 31, v1
    v_lshl_add_u32 v96, v5, 4, s38
    s_mul_i32 s38, s34, 320
    s_add_u32 s38, s38, 147456
    v_lshl_add_u32 v97, v5, 3, s38
    v_lshlrev_b32 v4, 6, v2
    v_lshl_add_u32 v4, v3, 1, v4
    v_add_u32 v93, s38, v4
    v_lshlrev_b32 v4, 7, v2
    v_lshl_add_u32 v4, v3, 4, v4
    v_mov_b32 v5, 512
    v_cmp_gt_u32 vcc, 8, v3
    s_nop 1
    v_cndmask_b32 v92, v5, v4, vcc
    s_mov_b32 s92, 0
    s_mov_b32 s96, 3145728
    s_mov_b32 s97, 0
    s_lshl_b32 s36, s32, 15
    s_lshl_b32 s38, s34, 8
    s_add_u32 s36, s36, s38
    s_add_u32 s36, s36, 4194304
    s_lshl_b32 s37, s32, 3
    s_lshl_b32 s38, s34, 13
    s_add_u32 s37, s37, s38
    s_add_u32 s37, s37, 2621440
    s_barrier
    s_lshl_b32 s38, s34, 5
    s_add_u32 s38, s38, s32
    s_lshl_b32 s38, s38, 8
    s_add_u32 s38, s38, 196608
    v_mov_b32 v4, s38
    v_mov_b32 v5, s68
    s_waitcnt vmcnt(3)
    s_mov_b64 exec, 1
    buffer_store_dword v5, v4, s[48:51], 0 offen sc1
    s_mov_b64 exec, -1
    s_mov_b32 s86, 196608
    buffer_load_dword v7, v101, s[48:51], s86 offen sc1
    s_waitcnt vmcnt(0)
L_fcheck_26:
    v_cmp_ne_u32 vcc, s68, v7
    s_cbranch_vccz L_fok_27
    s_sleep 2
    s_mov_b32 s86, 196608
    buffer_load_dword v7, v101, s[48:51], s86 offen sc1
    s_waitcnt vmcnt(0)
    s_sub_u32 s84, s84, 1
    s_cmp_lg_u32 s84, 0
    s_cbranch_scc1 L_fcheck_26
    s_branch L_end
L_fok_27:
    buffer_load_dwordx2 v[52:53], v81, s[48:51], s37 offen offset:0 sc1
    buffer_load_dwordx2 v[54:55], v81, s[48:51], s37 offen offset:1024 sc1
    buffer_load_dwordx4 v[20:23], v80, s[48:51], s36 offen offset:0 sc1
    buffer_load_dwordx4 v[24:27], v80, s[48:51], s36 offen offset:64 sc1
    buffer_load_dwordx4 v[28:31], v80, s[48:51], s36 offen offset:128 sc1
    buffer_load_dwordx4 v[32:35], v80, s[48:51], s36 offen offset:192 sc1
    s_add_u32 s36, s36, 4096
    buffer_load_dwordx4 v[36:39], v80, s[48:51], s36 offen offset:0 sc1
    buffer_load_dwordx4 v[40:43], v80, s[48:51], s36 offen offset:64 sc1
    buffer_load_dwordx4 v[44:47], v80, s[48:51], s36 offen offset:128 sc1
    buffer_load_dwordx4 v[48:51], v80, s[48:51], s36 offen offset:192 sc1
    s_add_u32 s36, s36, 4096
    s_waitcnt vmcnt(8)
    v_max_f32 v4, v52, v54
    s_nop 1
    v_max_f32_dpp v4, v4, v4 row_ror:8 row_mask:0xf bank_mask:0xf
    s_nop 1
    v_max_f32_dpp v4, v4, v4 row_ror:4 row_mask:0xf bank_mask:0xf
    v_sub_f32 v52, v52, v4
    v_sub_f32 v54, v54, v4
    v_exp_f32 v52, v52
    v_exp_f32 v54, v54
    v_mul_f32 v5, v52, v53
    v_fmac_f32 v5, v54, v55
    s_nop 1
    v_add_f32_dpp v5, v5, v5 row_ror:8 row_mask:0xf bank_mask:0xf
    s_nop 1
    v_add_f32_dpp v5, v5, v5 row_ror:4 row_mask:0xf bank_mask:0xf
    v_rcp_f32 v5, v5
    s_nop 0
    v_mul_f32 v52, v52, v5
    v_mul_f32 v54, v54, v5
    s_waitcnt vmcnt(0)
    v_mfma_f32_16x16x32_bf16 v[60:63], a[128:131], v[20:23], 0
    v_mfma_f32_16x16x32_bf16 v[64:67], a[128:131], v[36:39], 0
    v_mfma_f32_16x16x32_bf16 v[60:63], a[132:135], v[24:27], v[60:63]
    v_mfma_f32_16x16x32_bf16 v[64:67], a[132:135], v[40:43], v[64:67]
    v_mfma_f32_16x16x32_bf16 v[60:63], a[136:139], v[28:31], v[60:63]
    v_mfma_f32_16x16x32_bf16 v[64:67], a[136:139], v[44:47], v[64:67]
    v_mfma_f32_16x16x32_bf16 v[60:63], a[140:143], v[32:35], v[60:63]
    v_mfma_f32_16x16x32_bf16 v[64:67], a[140:143], v[48:51], v[64:67]
    v_mfma_f32_16x16x32_bf16 v[68:71], a[144:147], v[20:23], 0
    v_mfma_f32_16x16x32_bf16 v[72:75], a[144:147], v[36:39], 0
    v_mfma_f32_16x16x32_bf16 v[68:71], a[148:151], v[24:27], v[68:71]
    v_mfma_f32_16x16x32_bf16 v[72:75], a[148:151], v[40:43], v[72:75]
    v_mfma_f32_16x16x32_bf16 v[68:71], a[152:155], v[28:31], v[68:71]
    v_mfma_f32_16x16x32_bf16 v[72:75], a[152:155], v[44:47], v[72:75]
    v_mfma_f32_16x16x32_bf16 v[68:71], a[156:159], v[32:35], v[68:71]
    v_mfma_f32_16x16x32_bf16 v[72:75], a[156:159], v[48:51], v[72:75]
    v_mul_f32 v104, v60, v52
    v_mul_f32 v105, v61, v52
    v_mul_f32 v106, v62, v52
    v_mul_f32 v107, v63, v52
    v_fmac_f32 v104, v64, v54
    v_fmac_f32 v105, v65, v54
    v_fmac_f32 v106, v66, v54
    v_fmac_f32 v107, v67, v54
    v_add_f32_dpp v104, v104, v104 row_ror:8 row_mask:0xf bank_mask:0xf
    v_add_f32_dpp v105, v105, v105 row_ror:8 row_mask:0xf bank_mask:0xf
    v_add_f32_dpp v106, v106, v106 row_ror:8 row_mask:0xf bank_mask:0xf
    v_add_f32_dpp v107, v107, v107 row_ror:8 row_mask:0xf bank_mask:0xf
    v_add_f32_dpp v104, v104, v104 row_ror:4 row_mask:0xf bank_mask:0xf
    v_add_f32_dpp v105, v105, v105 row_ror:4 row_mask:0xf bank_mask:0xf
    v_add_f32_dpp v106, v106, v106 row_ror:4 row_mask:0xf bank_mask:0xf
    v_add_f32_dpp v107, v107, v107 row_ror:4 row_mask:0xf bank_mask:0xf
    ds_write_b128 v94, v[104:107] offset:0
    v_mfma_f32_16x16x32_bf16 v[60:63], a[160:163], v[20:23], 0
    v_mfma_f32_16x16x32_bf16 v[64:67], a[160:163], v[36:39], 0
    v_mfma_f32_16x16x32_bf16 v[60:63], a[164:167], v[24:27], v[60:63]
    v_mfma_f32_16x16x32_bf16 v[64:67], a[164:167], v[40:43], v[64:67]
    v_mfma_f32_16x16x32_bf16 v[60:63], a[168:171], v[28:31], v[60:63]
    v_mfma_f32_16x16x32_bf16 v[64:67], a[168:171], v[44:47], v[64:67]
    v_mfma_f32_16x16x32_bf16 v[60:63], a[172:175], v[32:35], v[60:63]
    v_mfma_f32_16x16x32_bf16 v[64:67], a[172:175], v[48:51], v[64:67]
    v_mul_f32 v108, v68, v52
    v_mul_f32 v109, v69, v52
    v_mul_f32 v110, v70, v52
    v_mul_f32 v111, v71, v52
    v_fmac_f32 v108, v72, v54
    v_fmac_f32 v109, v73, v54
    v_fmac_f32 v110, v74, v54
    v_fmac_f32 v111, v75, v54
    v_add_f32_dpp v108, v108, v108 row_ror:8 row_mask:0xf bank_mask:0xf
    v_add_f32_dpp v109, v109, v109 row_ror:8 row_mask:0xf bank_mask:0xf
    v_add_f32_dpp v110, v110, v110 row_ror:8 row_mask:0xf bank_mask:0xf
    v_add_f32_dpp v111, v111, v111 row_ror:8 row_mask:0xf bank_mask:0xf
    v_add_f32_dpp v108, v108, v108 row_ror:4 row_mask:0xf bank_mask:0xf
    v_add_f32_dpp v109, v109, v109 row_ror:4 row_mask:0xf bank_mask:0xf
    v_add_f32_dpp v110, v110, v110 row_ror:4 row_mask:0xf bank_mask:0xf
    v_add_f32_dpp v111, v111, v111 row_ror:4 row_mask:0xf bank_mask:0xf
    ds_write_b128 v94, v[108:111] offset:64
    v_mfma_f32_16x16x32_bf16 v[68:71], a[176:179], v[20:23], 0
    v_mfma_f32_16x16x32_bf16 v[72:75], a[176:179], v[36:39], 0
    v_mfma_f32_16x16x32_bf16 v[68:71], a[180:183], v[24:27], v[68:71]
    v_mfma_f32_16x16x32_bf16 v[72:75], a[180:183], v[40:43], v[72:75]
    v_mfma_f32_16x16x32_bf16 v[68:71], a[184:187], v[28:31], v[68:71]
    v_mfma_f32_16x16x32_bf16 v[72:75], a[184:187], v[44:47], v[72:75]
    v_mfma_f32_16x16x32_bf16 v[68:71], a[188:191], v[32:35], v[68:71]
    v_mfma_f32_16x16x32_bf16 v[72:75], a[188:191], v[48:51], v[72:75]
    v_mul_f32 v104, v60, v52
    v_mul_f32 v105, v61, v52
    v_mul_f32 v106, v62, v52
    v_mul_f32 v107, v63, v52
    v_fmac_f32 v104, v64, v54
    v_fmac_f32 v105, v65, v54
    v_fmac_f32 v106, v66, v54
    v_fmac_f32 v107, v67, v54
    v_add_f32_dpp v104, v104, v104 row_ror:8 row_mask:0xf bank_mask:0xf
    v_add_f32_dpp v105, v105, v105 row_ror:8 row_mask:0xf bank_mask:0xf
    v_add_f32_dpp v106, v106, v106 row_ror:8 row_mask:0xf bank_mask:0xf
    v_add_f32_dpp v107, v107, v107 row_ror:8 row_mask:0xf bank_mask:0xf
    v_add_f32_dpp v104, v104, v104 row_ror:4 row_mask:0xf bank_mask:0xf
    v_add_f32_dpp v105, v105, v105 row_ror:4 row_mask:0xf bank_mask:0xf
    v_add_f32_dpp v106, v106, v106 row_ror:4 row_mask:0xf bank_mask:0xf
    v_add_f32_dpp v107, v107, v107 row_ror:4 row_mask:0xf bank_mask:0xf
    ds_write_b128 v94, v[104:107] offset:128
    v_mfma_f32_16x16x32_bf16 v[60:63], a[192:195], v[20:23], 0
    v_mfma_f32_16x16x32_bf16 v[64:67], a[192:195], v[36:39], 0
    v_mfma_f32_16x16x32_bf16 v[60:63], a[196:199], v[24:27], v[60:63]
    v_mfma_f32_16x16x32_bf16 v[64:67], a[196:199], v[40:43], v[64:67]
    v_mfma_f32_16x16x32_bf16 v[60:63], a[200:203], v[28:31], v[60:63]
    v_mfma_f32_16x16x32_bf16 v[64:67], a[200:203], v[44:47], v[64:67]
    v_mfma_f32_16x16x32_bf16 v[60:63], a[204:207], v[32:35], v[60:63]
    v_mfma_f32_16x16x32_bf16 v[64:67], a[204:207], v[48:51], v[64:67]
    v_mul_f32 v108, v68, v52
    v_mul_f32 v109, v69, v52
    v_mul_f32 v110, v70, v52
    v_mul_f32 v111, v71, v52
    v_fmac_f32 v108, v72, v54
    v_fmac_f32 v109, v73, v54
    v_fmac_f32 v110, v74, v54
    v_fmac_f32 v111, v75, v54
    v_add_f32_dpp v108, v108, v108 row_ror:8 row_mask:0xf bank_mask:0xf
    v_add_f32_dpp v109, v109, v109 row_ror:8 row_mask:0xf bank_mask:0xf
    v_add_f32_dpp v110, v110, v110 row_ror:8 row_mask:0xf bank_mask:0xf
    v_add_f32_dpp v111, v111, v111 row_ror:8 row_mask:0xf bank_mask:0xf
    v_add_f32_dpp v108, v108, v108 row_ror:4 row_mask:0xf bank_mask:0xf
    v_add_f32_dpp v109, v109, v109 row_ror:4 row_mask:0xf bank_mask:0xf
    v_add_f32_dpp v110, v110, v110 row_ror:4 row_mask:0xf bank_mask:0xf
    v_add_f32_dpp v111, v111, v111 row_ror:4 row_mask:0xf bank_mask:0xf
    ds_write_b128 v94, v[108:111] offset:192
    v_mfma_f32_16x16x32_bf16 v[68:71], a[208:211], v[20:23], 0
    v_mfma_f32_16x16x32_bf16 v[72:75], a[208:211], v[36:39], 0
    v_mfma_f32_16x16x32_bf16 v[68:71], a[212:215], v[24:27], v[68:71]
    v_mfma_f32_16x16x32_bf16 v[72:75], a[212:215], v[40:43], v[72:75]
    v_mfma_f32_16x16x32_bf16 v[68:71], a[216:219], v[28:31], v[68:71]
    v_mfma_f32_16x16x32_bf16 v[72:75], a[216:219], v[44:47], v[72:75]
    v_mfma_f32_16x16x32_bf16 v[68:71], a[220:223], v[32:35], v[68:71]
    v_mfma_f32_16x16x32_bf16 v[72:75], a[220:223], v[48:51], v[72:75]
    v_mul_f32 v104, v60, v52
    v_mul_f32 v105, v61, v52
    v_mul_f32 v106, v62, v52
    v_mul_f32 v107, v63, v52
    v_fmac_f32 v104, v64, v54
    v_fmac_f32 v105, v65, v54
    v_fmac_f32 v106, v66, v54
    v_fmac_f32 v107, v67, v54
    v_add_f32_dpp v104, v104, v104 row_ror:8 row_mask:0xf bank_mask:0xf
    v_add_f32_dpp v105, v105, v105 row_ror:8 row_mask:0xf bank_mask:0xf
    v_add_f32_dpp v106, v106, v106 row_ror:8 row_mask:0xf bank_mask:0xf
    v_add_f32_dpp v107, v107, v107 row_ror:8 row_mask:0xf bank_mask:0xf
    v_add_f32_dpp v104, v104, v104 row_ror:4 row_mask:0xf bank_mask:0xf
    v_add_f32_dpp v105, v105, v105 row_ror:4 row_mask:0xf bank_mask:0xf
    v_add_f32_dpp v106, v106, v106 row_ror:4 row_mask:0xf bank_mask:0xf
    v_add_f32_dpp v107, v107, v107 row_ror:4 row_mask:0xf bank_mask:0xf
    ds_write_b128 v94, v[104:107] offset:256
    v_mfma_f32_16x16x32_bf16 v[60:63], a[224:227], v[20:23], 0
    v_mfma_f32_16x16x32_bf16 v[64:67], a[224:227], v[36:39], 0
    v_mfma_f32_16x16x32_bf16 v[60:63], a[228:231], v[24:27], v[60:63]
    v_mfma_f32_16x16x32_bf16 v[64:67], a[228:231], v[40:43], v[64:67]
    v_mfma_f32_16x16x32_bf16 v[60:63], a[232:235], v[28:31], v[60:63]
    v_mfma_f32_16x16x32_bf16 v[64:67], a[232:235], v[44:47], v[64:67]
    v_mfma_f32_16x16x32_bf16 v[60:63], a[236:239], v[32:35], v[60:63]
    v_mfma_f32_16x16x32_bf16 v[64:67], a[236:239], v[48:51], v[64:67]
    v_mul_f32 v108, v68, v52
    v_mul_f32 v109, v69, v52
    v_mul_f32 v110, v70, v52
    v_mul_f32 v111, v71, v52
    v_fmac_f32 v108, v72, v54
    v_fmac_f32 v109, v73, v54
    v_fmac_f32 v110, v74, v54
    v_fmac_f32 v111, v75, v54
    v_add_f32_dpp v108, v108, v108 row_ror:8 row_mask:0xf bank_mask:0xf
    v_add_f32_dpp v109, v109, v109 row_ror:8 row_mask:0xf bank_mask:0xf
    v_add_f32_dpp v110, v110, v110 row_ror:8 row_mask:0xf bank_mask:0xf
    v_add_f32_dpp v111, v111, v111 row_ror:8 row_mask:0xf bank_mask:0xf
    v_add_f32_dpp v108, v108, v108 row_ror:4 row_mask:0xf bank_mask:0xf
    v_add_f32_dpp v109, v109, v109 row_ror:4 row_mask:0xf bank_mask:0xf
    v_add_f32_dpp v110, v110, v110 row_ror:4 row_mask:0xf bank_mask:0xf
    v_add_f32_dpp v111, v111, v111 row_ror:4 row_mask:0xf bank_mask:0xf
    ds_write_b128 v94, v[108:111] offset:320
    v_mfma_f32_16x16x32_bf16 v[68:71], a[240:243], v[20:23], 0
    v_mfma_f32_16x16x32_bf16 v[72:75], a[240:243], v[36:39], 0
    v_mfma_f32_16x16x32_bf16 v[68:71], a[244:247], v[24:27], v[68:71]
    v_mfma_f32_16x16x32_bf16 v[72:75], a[244:247], v[40:43], v[72:75]
    v_mfma_f32_16x16x32_bf16 v[68:71], a[248:251], v[28:31], v[68:71]
    v_mfma_f32_16x16x32_bf16 v[72:75], a[248:251], v[44:47], v[72:75]
    v_mfma_f32_16x16x32_bf16 v[68:71], a[252:255], v[32:35], v[68:71]
    v_mfma_f32_16x16x32_bf16 v[72:75], a[252:255], v[48:51], v[72:75]
    v_mul_f32 v104, v60, v52
    v_mul_f32 v105, v61, v52
    v_mul_f32 v106, v62, v52
    v_mul_f32 v107, v63, v52
    v_fmac_f32 v104, v64, v54
    v_fmac_f32 v105, v65, v54
    v_fmac_f32 v106, v66, v54
    v_fmac_f32 v107, v67, v54
    v_add_f32_dpp v104, v104, v104 row_ror:8 row_mask:0xf bank_mask:0xf
    v_add_f32_dpp v105, v105, v105 row_ror:8 row_mask:0xf bank_mask:0xf
    v_add_f32_dpp v106, v106, v106 row_ror:8 row_mask:0xf bank_mask:0xf
    v_add_f32_dpp v107, v107, v107 row_ror:8 row_mask:0xf bank_mask:0xf
    v_add_f32_dpp v104, v104, v104 row_ror:4 row_mask:0xf bank_mask:0xf
    v_add_f32_dpp v105, v105, v105 row_ror:4 row_mask:0xf bank_mask:0xf
    v_add_f32_dpp v106, v106, v106 row_ror:4 row_mask:0xf bank_mask:0xf
    v_add_f32_dpp v107, v107, v107 row_ror:4 row_mask:0xf bank_mask:0xf
    ds_write_b128 v94, v[104:107] offset:384
    v_mul_f32 v108, v68, v52
    v_mul_f32 v109, v69, v52
    v_mul_f32 v110, v70, v52
    v_mul_f32 v111, v71, v52
    v_fmac_f32 v108, v72, v54
    v_fmac_f32 v109, v73, v54
    v_fmac_f32 v110, v74, v54
    v_fmac_f32 v111, v75, v54
    v_add_f32_dpp v108, v108, v108 row_ror:8 row_mask:0xf bank_mask:0xf
    v_add_f32_dpp v109, v109, v109 row_ror:8 row_mask:0xf bank_mask:0xf
    v_add_f32_dpp v110, v110, v110 row_ror:8 row_mask:0xf bank_mask:0xf
    v_add_f32_dpp v111, v111, v111 row_ror:8 row_mask:0xf bank_mask:0xf
    v_add_f32_dpp v108, v108, v108 row_ror:4 row_mask:0xf bank_mask:0xf
    v_add_f32_dpp v109, v109, v109 row_ror:4 row_mask:0xf bank_mask:0xf
    v_add_f32_dpp v110, v110, v110 row_ror:4 row_mask:0xf bank_mask:0xf
    v_add_f32_dpp v111, v111, v111 row_ror:4 row_mask:0xf bank_mask:0xf
    ds_write_b128 v94, v[108:111] offset:448
    s_waitcnt lgkmcnt(0)
    s_barrier
    ds_read_b128 v[20:23], v96 offset:0
    ds_read_b128 v[24:27], v96 offset:2048
    ds_read_b128 v[28:31], v96 offset:4096
    ds_read_b128 v[32:35], v96 offset:6144
    s_waitcnt lgkmcnt(0)
    v_add_f32 v20, v20, v24
    v_add_f32 v28, v28, v32
    v_add_f32 v21, v21, v25
    v_add_f32 v29, v29, v33
    v_add_f32 v22, v22, v26
    v_add_f32 v30, v30, v34
    v_add_f32 v23, v23, v27
    v_add_f32 v31, v31, v35
    v_add_f32 v20, v20, v28
    v_add_f32 v21, v21, v29
    v_add_f32 v22, v22, v30
    v_add_f32 v23, v23, v31
    v_cvt_pk_bf16_f32 v20, v20, v21
    v_cvt_pk_bf16_f32 v21, v22, v23
    ds_write_b64 v97, v[20:21]
    v_lshlrev_b32 v4, 2, v1
    v_add_u32 v4, 148736, v4
    ds_write_b32 v4, v100
L_final:
    s_waitcnt lgkmcnt(0)
    s_barrier
    ds_read_b128 v[136:139], v112 offset:0
    ds_read_b128 v[140:143], v112 offset:64
    ds_read_b128 v[144:147], v112 offset:128
    ds_read_b128 v[148:151], v112 offset:192
    ds_read_b128 v[152:155], v113 offset:0
    ds_read_b128 v[156:159], v113 offset:64
    s_add_u32 s36, s96, 32768
    s_add_u32 s37, s96, 4096
    s_waitcnt lgkmcnt(5)
    v_mfma_f32_16x16x32_bf16 v[84:87], a[0:3], v[136:139], 0
    ds_read_b128 v[160:163], v113 offset:128
    v_mfma_f32_16x16x32_bf16 v[88:91], a[64:67], v[136:139], 0
    s_waitcnt lgkmcnt(5)
    v_mfma_f32_16x16x32_bf16 v[84:87], a[4:7], v[140:143], v[84:87]
    ds_read_b128 v[164:167], v113 offset:192
    v_mfma_f32_16x16x32_bf16 v[88:91], a[68:71], v[140:143], v[88:91]
    s_waitcnt lgkmcnt(5)
    v_mfma_f32_16x16x32_bf16 v[84:87], a[8:11], v[144:147], v[84:87]
    ds_read_b128 v[168:171], v114 offset:0
    v_mfma_f32_16x16x32_bf16 v[88:91], a[72:75], v[144:147], v[88:91]
    s_waitcnt lgkmcnt(5)
    v_mfma_f32_16x16x32_bf16 v[84:87], a[12:15], v[148:151], v[84:87]
    ds_read_b128 v[172:175], v114 offset:64
    v_mfma_f32_16x16x32_bf16 v[88:91], a[76:79], v[148:151], v[88:91]
    s_waitcnt lgkmcnt(5)
    v_mfma_f32_16x16x32_bf16 v[84:87], a[16:19], v[152:155], v[84:87]
    ds_read_b128 v[176:179], v114 offset:128
    v_mfma_f32_16x16x32_bf16 v[88:91], a[80:83], v[152:155], v[88:91]
    s_waitcnt lgkmcnt(5)
    v_mfma_f32_16x16x32_bf16 v[84:87], a[20:23], v[156:159], v[84:87]
    ds_read_b128 v[180:183], v114 offset:192
    v_mfma_f32_16x16x32_bf16 v[88:91], a[84:87], v[156:159], v[88:91]
    s_waitcnt lgkmcnt(5)
    v_mfma_f32_16x16x32_bf16 v[84:87], a[24:27], v[160:163], v[84:87]
    ds_read_b128 v[184:187], v115 offset:0
    v_mfma_f32_16x16x32_bf16 v[88:91], a[88:91], v[160:163], v[88:91]
    s_waitcnt lgkmcnt(5)
    v_mfma_f32_16x16x32_bf16 v[84:87], a[28:31], v[164:167], v[84:87]
    ds_read_b128 v[188:191], v115 offset:64
    v_mfma_f32_16x16x32_bf16 v[88:91], a[92:95], v[164:167], v[88:91]
    s_waitcnt lgkmcnt(5)
    v_mfma_f32_16x16x32_bf16 v[84:87], a[32:35], v[168:171], v[84:87]
    ds_read_b128 v[192:195], v115 offset:128
    v_mfma_f32_16x16x32_bf16 v[88:91], a[96:99], v[168:171], v[88:91]
    s_waitcnt lgkmcnt(5)
    v_mfma_f32_16x16x32_bf16 v[84:87], a[36:39], v[172:175], v[84:87]
    ds_read_b128 v[196:199], v115 offset:192
    v_mfma_f32_16x16x32_bf16 v[88:91], a[100:103], v[172:175], v[88:91]
    s_waitcnt lgkmcnt(5)
    v_mfma_f32_16x16x32_bf16 v[84:87], a[40:43], v[176:179], v[84:87]
    v_mfma_f32_16x16x32_bf16 v[88:91], a[104:107], v[176:179], v[88:91]
    s_waitcnt lgkmcnt(4)
    v_mfma_f32_16x16x32_bf16 v[84:87], a[44:47], v[180:183], v[84:87]
    v_mfma_f32_16x16x32_bf16 v[88:91], a[108:111], v[180:183], v[88:91]
    s_waitcnt lgkmcnt(3)
    v_mfma_f32_16x16x32_bf16 v[84:87], a[48:51], v[184:187], v[84:87]
    v_mfma_f32_16x16x32_bf16 v[88:91], a[112:115], v[184:187], v[88:91]
    s_waitcnt lgkmcnt(2)
    v_mfma_f32_16x16x32_bf16 v[84:87], a[52:55], v[188:191], v[84:87]
    v_mfma_f32_16x16x32_bf16 v[88:91], a[116:119], v[188:191], v[88:91]
    s_waitcnt lgkmcnt(1)
    v_mfma_f32_16x16x32_bf16 v[84:87], a[56:59], v[192:195], v[84:87]
    v_mfma_f32_16x16x32_bf16 v[88:91], a[120:123], v[192:195], v[88:91]
    s_waitcnt lgkmcnt(0)
    v_mfma_f32_16x16x32_bf16 v[84:87], a[60:63], v[196:199], v[84:87]
    v_mfma_f32_16x16x32_bf16 v[88:91], a[124:127], v[196:199], v[88:91]
    s_nop 6
    v_and_or_b32 v84, v84, s82, v8
    v_and_or_b32 v85, v85, s82, v8
    v_and_or_b32 v86, v86, s82, v8
    v_and_or_b32 v87, v87, s82, v8
    buffer_store_dwordx4 v[84:87], v77, s[48:51], s96 offen sc1
    v_and_or_b32 v88, v88, s82, v8
    v_and_or_b32 v89, v89, s82, v8
    v_and_or_b32 v90, v90, s82, v8
    v_and_or_b32 v91, v91, s82, v8
    buffer_store_dwordx4 v[88:91], v77, s[48:51], s36 offen sc1
    s_cmp_eq_u32 s92, 0
    s_cbranch_scc1 L_prepb
L_hop2:
L_hop2poll:
    buffer_load_dwordx4 v[200:203], v78, s[48:51], s96 offen sc1
    buffer_load_dwordx4 v[204:207], v78, s[48:51], s37 offen sc1
    s_waitcnt vmcnt(0)
    v_xor_b32 v200, s35, v200
    v_xor_b32 v201, s35, v201
    v_xor_b32 v202, s35, v202
    v_xor_b32 v203, s35, v203
    v_xor_b32 v204, s35, v204
    v_xor_b32 v205, s35, v205
    v_xor_b32 v206, s35, v206
    v_xor_b32 v207, s35, v207
    v_or_b32 v4, v200, v201
    v_or3_b32 v4, v4, v202, v203
    v_or3_b32 v4, v4, v204, v205
    v_or3_b32 v4, v4, v206, v207
    v_and_b32 v4, 0xff, v4
    v_cmp_ne_u32 vcc, 0, v4
    v_add_f32 v104, v200, v204
    v_add_f32 v105, v201, v205
    v_add_f32 v106, v202, v206
    v_add_f32 v107, v203, v207
    s_cbranch_vccz L_hop2ok
    s_sub_u32 s84, s84, 1
    s_cmp_lg_u32 s84, 0
    s_cbranch_scc1 L_hop2poll
    s_branch L_end
L_hop2ok:
    v_permlane16_swap_b32 v104, v105
    v_permlane16_swap_b32 v106, v107
    v_add_f32 v104, v104, v105
    v_add_f32 v106, v106, v107
    s_nop 1
    v_permlane32_swap_b32 v104, v106
    v_add_f32 v104, v104, v106
    s_nop 1
    v_add_f32_dpp v104, v104, v104 row_ror:8 row_mask:0xf bank_mask:0xf
    s_nop 1
    v_add_f32_dpp v104, v104, v104 row_ror:4 row_mask:0xf bank_mask:0xf
    v_cvt_pk_bf16_f32 v104, v104, v104
    s_mov_b32 exec_lo, 0xf000f
    s_mov_b32 exec_hi, 0xf000f
    buffer_store_short v104, v79, s[72:75], s97 offen
    s_mov_b64 exec, -1
    s_cmp_lg_u32 s92, 0
    s_cbranch_scc1 L_fin
    s_mov_b32 s92, 1
    s_mov_b32 s96, 3670016
    s_mov_b32 s97, 1024
    s_lshl_b32 s85, s32, 2
    s_add_u32 s85, s85, s34
    s_lshl_b32 s85, s85, 13
    s_add_u32 s85, s85, 5242880
    s_branch L_hop1
    v_min_u32 v5, 6, v1
    v_lshlrev_b32 v5, 10, v5
L_light:
    buffer_load_dword v6, v5, s[48:51], s85 offen offset:512 sc1
    s_waitcnt vmcnt(0)
    v_xor_b32 v6, s35, v6
    v_and_b32 v6, 0xff, v6
    v_cmp_ne_u32 vcc, 0, v6
    s_nop 0
    s_and_b32 s36, vcc_lo, 0x7f
    s_bcnt1_i32_b32 s36, s36
    s_cmp_le_u32 s36, 7
    s_cbranch_scc1 L_hop1
    s_sleep 2
    s_sub_u32 s84, s84, 1
    s_cmp_lg_u32 s84, 0
    s_cbranch_scc1 L_light
    s_branch L_end
L_hop1:
    s_mov_b32 s93, 0x7f
    s_mov_b32 s94, 0
    v_mov_b32 v55, 0xff7f0000
    v_mov_b32 v56, 0
    v_mov_b32 v57, 0
    v_mov_b32 v58, 0
    v_mov_b32 v59, 0
    s_and_b32 s94, s94, s93
    s_cselect_b32 s94, s94, s93
    s_ff1_i32_b32 s4, s94
    s_bitset0_b32 s94, s4
    s_lshl_b32 s36, s4, 10
    s_add_u32 s36, s36, s85
    buffer_load_dwordx4 v[20:23], v92, s[48:51], s36 offen sc1
    s_and_b32 s94, s94, s93
    s_cselect_b32 s94, s94, s93
    s_ff1_i32_b32 s5, s94
    s_bitset0_b32 s94, s5
    s_lshl_b32 s36, s5, 10
    s_add_u32 s36, s36, s85
    buffer_load_dwordx4 v[24:27], v92, s[48:51], s36 offen sc1
    s_and_b32 s94, s94, s93
    s_cselect_b32 s94, s94, s93
    s_ff1_i32_b32 s6, s94
    s_bitset0_b32 s94, s6
    s_lshl_b32 s36, s6, 10
    s_add_u32 s36, s36, s85
    buffer_load_dwordx4 v[28:31], v92, s[48:51], s36 offen sc1
L_hop1poll:
    s_and_b32 s94, s94, s93
    s_cselect_b32 s94, s94, s93
    s_ff1_i32_b32 s7, s94
    s_bitset0_b32 s94, s7
    s_lshl_b32 s36, s7, 10
    s_add_u32 s36, s36, s85
    buffer_load_dwordx4 v[32:35], v92, s[48:51], s36 offen sc1
    s_waitcnt vmcnt(3)
    v_xor_b32 v20, s35, v20
    v_xor_b32 v21, s35, v21
    v_xor_b32 v22, s35, v22
    v_xor_b32 v23, s35, v23
    v_or_b32 v4, v20, v21
    v_or3_b32 v4, v4, v22, v23
    v_and_b32 v4, 0xff, v4
    v_cmp_ne_u32 vcc, 0, v4
    v_max_f32 v5, v55, v20
    s_cbranch_vccnz L_mnext_28
    s_bitcmp1_b32 s93, s4
    s_cbranch_scc0 L_mnext_28
    v_sub_f32 v52, v55, v5
    v_sub_f32 v53, v20, v5
    v_exp_f32 v52, v52
    v_exp_f32 v53, v53
    v_mov_b32 v55, v5
    s_bitset0_b32 s93, s4
    v_mul_f32_dpp v57, v52, v57 row_newbcast:8 row_mask:0xf bank_mask:0xf
    v_mul_f32_dpp v56, v52, v56 row_newbcast:8 row_mask:0xf bank_mask:0xf
    v_mul_f32_dpp v58, v52, v58 row_newbcast:8 row_mask:0xf bank_mask:0xf
    v_mul_f32_dpp v59, v52, v59 row_newbcast:8 row_mask:0xf bank_mask:0xf
    v_fmac_f32_dpp v57, v53, v21 row_newbcast:8 row_mask:0xf bank_mask:0xf
    v_fmac_f32_dpp v56, v53, v20 row_newbcast:8 row_mask:0xf bank_mask:0xf
    v_fmac_f32_dpp v58, v53, v22 row_newbcast:8 row_mask:0xf bank_mask:0xf
    v_fmac_f32_dpp v59, v53, v23 row_newbcast:8 row_mask:0xf bank_mask:0xf
    s_cmp_eq_u32 s93, 0
    s_cbranch_scc1 L_hop1ok
L_mnext_28:
    s_and_b32 s94, s94, s93
    s_cselect_b32 s94, s94, s93
    s_ff1_i32_b32 s4, s94
    s_bitset0_b32 s94, s4
    s_lshl_b32 s36, s4, 10
    s_add_u32 s36, s36, s85
    buffer_load_dwordx4 v[20:23], v92, s[48:51], s36 offen sc1
    s_waitcnt vmcnt(3)
    v_xor_b32 v24, s35, v24
    v_xor_b32 v25, s35, v25
    v_xor_b32 v26, s35, v26
    v_xor_b32 v27, s35, v27
    v_or_b32 v4, v24, v25
    v_or3_b32 v4, v4, v26, v27
    v_and_b32 v4, 0xff, v4
    v_cmp_ne_u32 vcc, 0, v4
    v_max_f32 v5, v55, v24
    s_cbranch_vccnz L_mnext_29
    s_bitcmp1_b32 s93, s5
    s_cbranch_scc0 L_mnext_29
    v_sub_f32 v52, v55, v5
    v_sub_f32 v53, v24, v5
    v_exp_f32 v52, v52
    v_exp_f32 v53, v53
    v_mov_b32 v55, v5
    s_bitset0_b32 s93, s5
    v_mul_f32_dpp v57, v52, v57 row_newbcast:8 row_mask:0xf bank_mask:0xf
    v_mul_f32_dpp v56, v52, v56 row_newbcast:8 row_mask:0xf bank_mask:0xf
    v_mul_f32_dpp v58, v52, v58 row_newbcast:8 row_mask:0xf bank_mask:0xf
    v_mul_f32_dpp v59, v52, v59 row_newbcast:8 row_mask:0xf bank_mask:0xf
    v_fmac_f32_dpp v57, v53, v25 row_newbcast:8 row_mask:0xf bank_mask:0xf
    v_fmac_f32_dpp v56, v53, v24 row_newbcast:8 row_mask:0xf bank_mask:0xf
    v_fmac_f32_dpp v58, v53, v26 row_newbcast:8 row_mask:0xf bank_mask:0xf
    v_fmac_f32_dpp v59, v53, v27 row_newbcast:8 row_mask:0xf bank_mask:0xf
    s_cmp_eq_u32 s93, 0
    s_cbranch_scc1 L_hop1ok
L_mnext_29:
    s_and_b32 s94, s94, s93
    s_cselect_b32 s94, s94, s93
    s_ff1_i32_b32 s5, s94
    s_bitset0_b32 s94, s5
    s_lshl_b32 s36, s5, 10
    s_add_u32 s36, s36, s85
    buffer_load_dwordx4 v[24:27], v92, s[48:51], s36 offen sc1
    s_waitcnt vmcnt(3)
    v_xor_b32 v28, s35, v28
    v_xor_b32 v29, s35, v29
    v_xor_b32 v30, s35, v30
    v_xor_b32 v31, s35, v31
    v_or_b32 v4, v28, v29
    v_or3_b32 v4, v4, v30, v31
    v_and_b32 v4, 0xff, v4
    v_cmp_ne_u32 vcc, 0, v4
    v_max_f32 v5, v55, v28
    s_cbranch_vccnz L_mnext_30
    s_bitcmp1_b32 s93, s6
    s_cbranch_scc0 L_mnext_30
    v_sub_f32 v52, v55, v5
    v_sub_f32 v53, v28, v5
    v_exp_f32 v52, v52
    v_exp_f32 v53, v53
    v_mov_b32 v55, v5
    s_bitset0_b32 s93, s6
    v_mul_f32_dpp v57, v52, v57 row_newbcast:8 row_mask:0xf bank_mask:0xf
    v_mul_f32_dpp v56, v52, v56 row_newbcast:8 row_mask:0xf bank_mask:0xf
    v_mul_f32_dpp v58, v52, v58 row_newbcast:8 row_mask:0xf bank_mask:0xf
    v_mul_f32_dpp v59, v52, v59 row_newbcast:8 row_mask:0xf bank_mask:0xf
    v_fmac_f32_dpp v57, v53, v29 row_newbcast:8 row_mask:0xf bank_mask:0xf
    v_fmac_f32_dpp v56, v53, v28 row_newbcast:8 row_mask:0xf bank_mask:0xf
    v_fmac_f32_dpp v58, v53, v30 row_newbcast:8 row_mask:0xf bank_mask:0xf
    v_fmac_f32_dpp v59, v53, v31 row_newbcast:8 row_mask:0xf bank_mask:0xf
    s_cmp_eq_u32 s93, 0
    s_cbranch_scc1 L_hop1ok
L_mnext_30:
    s_and_b32 s94, s94, s93
    s_cselect_b32 s94, s94, s93
    s_ff1_i32_b32 s6, s94
    s_bitset0_b32 s94, s6
    s_lshl_b32 s36, s6, 10
    s_add_u32 s36, s36, s85
    buffer_load_dwordx4 v[28:31], v92, s[48:51], s36 offen sc1
    s_waitcnt vmcnt(3)
    v_xor_b32 v32, s35, v32
    v_xor_b32 v33, s35, v33
    v_xor_b32 v34, s35, v34
    v_xor_b32 v35, s35, v35
    v_or_b32 v4, v32, v33
    v_or3_b32 v4, v4, v34, v35
    v_and_b32 v4, 0xff, v4
    v_cmp_ne_u32 vcc, 0, v4
    v_max_f32 v5, v55, v32
    s_cbranch_vccnz L_mnext_31
    s_bitcmp1_b32 s93, s7
    s_cbranch_scc0 L_mnext_31
    v_sub_f32 v52, v55, v5
    v_sub_f32 v53, v32, v5
    v_exp_f32 v52, v52
    v_exp_f32 v53, v53
    v_mov_b32 v55, v5
    s_bitset0_b32 s93, s7
    v_mul_f32_dpp v57, v52, v57 row_newbcast:8 row_mask:0xf bank_mask:0xf
    v_mul_f32_dpp v56, v52, v56 row_newbcast:8 row_mask:0xf bank_mask:0xf
    v_mul_f32_dpp v58, v52, v58 row_newbcast:8 row_mask:0xf bank_mask:0xf
    v_mul_f32_dpp v59, v52, v59 row_newbcast:8 row_mask:0xf bank_mask:0xf
    v_fmac_f32_dpp v57, v53, v33 row_newbcast:8 row_mask:0xf bank_mask:0xf
    v_fmac_f32_dpp v56, v53, v32 row_newbcast:8 row_mask:0xf bank_mask:0xf
    v_fmac_f32_dpp v58, v53, v34 row_newbcast:8 row_mask:0xf bank_mask:0xf
    v_fmac_f32_dpp v59, v53, v35 row_newbcast:8 row_mask:0xf bank_mask:0xf
    s_cmp_eq_u32 s93, 0
    s_cbranch_scc1 L_hop1ok
L_mnext_31:
    s_sub_u32 s84, s84, 1
    s_cmp_lg_u32 s84, 0
    s_cbranch_scc1 L_hop1poll
    s_branch L_end
L_hop1ok:
    v_rcp_f32 v55, v57
    s_nop 1
    v_mul_f32_dpp v56, v55, v56 row_newbcast:8 row_mask:0xf bank_mask:0xf
    v_mul_f32_dpp v57, v55, v57 row_newbcast:8 row_mask:0xf bank_mask:0xf
    v_mul_f32_dpp v58, v55, v58 row_newbcast:8 row_mask:0xf bank_mask:0xf
    v_mul_f32_dpp v59, v55, v59 row_newbcast:8 row_mask:0xf bank_mask:0xf
    v_cvt_pk_bf16_f32 v56, v56, v57
    v_cvt_pk_bf16_f32 v58, v58, v59
    s_mov_b32 exec_lo, 0xff00ff
    s_mov_b32 exec_hi, 0xff00ff
    ds_write_b16 v93, v56
    ds_write_b16_d16_hi v93, v56 offset:16
    ds_write_b16 v93, v58 offset:32
    ds_write_b16_d16_hi v93, v58 offset:48
    s_mov_b64 exec, -1
    s_branch L_final
L_prepb:
    v_xor_b32 v4, 0, v95
    ds_read_b64_tr_b16 a[0:1], v4 offset:0
    ds_read_b64_tr_b16 a[4:5], v4 offset:8192
    ds_read_b64_tr_b16 a[8:9], v4 offset:16384
    ds_read_b64_tr_b16 a[12:13], v4 offset:24576
    v_xor_b32 v5, 16, v95
    ds_read_b64_tr_b16 a[2:3], v5 offset:1024
    ds_read_b64_tr_b16 a[6:7], v5 offset:9216
    ds_read_b64_tr_b16 a[10:11], v5 offset:17408
    ds_read_b64_tr_b16 a[14:15], v5 offset:25600
    v_xor_b32 v4, 32, v95
    ds_read_b64_tr_b16 a[16:17], v4 offset:0
    ds_read_b64_tr_b16 a[20:21], v4 offset:8192
    ds_read_b64_tr_b16 a[24:25], v4 offset:16384
    ds_read_b64_tr_b16 a[28:29], v4 offset:24576
    v_xor_b32 v5, 48, v95
    ds_read_b64_tr_b16 a[18:19], v5 offset:1024
    ds_read_b64_tr_b16 a[22:23], v5 offset:9216
    ds_read_b64_tr_b16 a[26:27], v5 offset:17408
    ds_read_b64_tr_b16 a[30:31], v5 offset:25600
    v_xor_b32 v4, 64, v95
    ds_read_b64_tr_b16 a[32:33], v4 offset:0
    ds_read_b64_tr_b16 a[36:37], v4 offset:8192
    ds_read_b64_tr_b16 a[40:41], v4 offset:16384
    ds_read_b64_tr_b16 a[44:45], v4 offset:24576
    v_xor_b32 v5, 80, v95
    ds_read_b64_tr_b16 a[34:35], v5 offset:1024
    ds_read_b64_tr_b16 a[38:39], v5 offset:9216
    ds_read_b64_tr_b16 a[42:43], v5 offset:17408
    ds_read_b64_tr_b16 a[46:47], v5 offset:25600
    v_xor_b32 v4, 96, v95
    ds_read_b64_tr_b16 a[48:49], v4 offset:0
    ds_read_b64_tr_b16 a[52:53], v4 offset:8192
    ds_read_b64_tr_b16 a[56:57], v4 offset:16384
    ds_read_b64_tr_b16 a[60:61], v4 offset:24576
    v_xor_b32 v5, 112, v95
    ds_read_b64_tr_b16 a[50:51], v5 offset:1024
    ds_read_b64_tr_b16 a[54:55], v5 offset:9216
    ds_read_b64_tr_b16 a[58:59], v5 offset:17408
    ds_read_b64_tr_b16 a[62:63], v5 offset:25600
    v_xor_b32 v4, 128, v95
    ds_read_b64_tr_b16 a[64:65], v4 offset:0
    ds_read_b64_tr_b16 a[68:69], v4 offset:8192
    ds_read_b64_tr_b16 a[72:73], v4 offset:16384
    ds_read_b64_tr_b16 a[76:77], v4 offset:24576
    v_xor_b32 v5, 144, v95
    ds_read_b64_tr_b16 a[66:67], v5 offset:1024
    ds_read_b64_tr_b16 a[70:71], v5 offset:9216
    ds_read_b64_tr_b16 a[74:75], v5 offset:17408
    ds_read_b64_tr_b16 a[78:79], v5 offset:25600
    v_xor_b32 v4, 160, v95
    ds_read_b64_tr_b16 a[80:81], v4 offset:0
    ds_read_b64_tr_b16 a[84:85], v4 offset:8192
    ds_read_b64_tr_b16 a[88:89], v4 offset:16384
    ds_read_b64_tr_b16 a[92:93], v4 offset:24576
    v_xor_b32 v5, 176, v95
    ds_read_b64_tr_b16 a[82:83], v5 offset:1024
    ds_read_b64_tr_b16 a[86:87], v5 offset:9216
    ds_read_b64_tr_b16 a[90:91], v5 offset:17408
    ds_read_b64_tr_b16 a[94:95], v5 offset:25600
    v_xor_b32 v4, 192, v95
    ds_read_b64_tr_b16 a[96:97], v4 offset:0
    ds_read_b64_tr_b16 a[100:101], v4 offset:8192
    ds_read_b64_tr_b16 a[104:105], v4 offset:16384
    ds_read_b64_tr_b16 a[108:109], v4 offset:24576
    v_xor_b32 v5, 208, v95
    ds_read_b64_tr_b16 a[98:99], v5 offset:1024
    ds_read_b64_tr_b16 a[102:103], v5 offset:9216
    ds_read_b64_tr_b16 a[106:107], v5 offset:17408
    ds_read_b64_tr_b16 a[110:111], v5 offset:25600
    v_xor_b32 v4, 224, v95
    ds_read_b64_tr_b16 a[112:113], v4 offset:0
    ds_read_b64_tr_b16 a[116:117], v4 offset:8192
    ds_read_b64_tr_b16 a[120:121], v4 offset:16384
    ds_read_b64_tr_b16 a[124:125], v4 offset:24576
    v_xor_b32 v5, 240, v95
    ds_read_b64_tr_b16 a[114:115], v5 offset:1024
    ds_read_b64_tr_b16 a[118:119], v5 offset:9216
    ds_read_b64_tr_b16 a[122:123], v5 offset:17408
    ds_read_b64_tr_b16 a[126:127], v5 offset:25600
    s_waitcnt lgkmcnt(0)
    s_barrier
    s_branch L_hop2
L_fin:
    s_or_b32 s36, s32, s34
    s_cmp_lg_u32 s36, 0
    s_cbranch_scc1 L_end
    s_mov_b64 exec, 1
    buffer_store_dword v8, v100, s[48:51], 0 offen
L_end:
    s_endpgm
    .fill (32768 - (. - concat_heads__compressed_kv_cla__mha_block_cached__decode_kernel)) / 4 + 1, 4, 0xbf810000
.section .rodata,"a"
.p2align 6
.amdhsa_kernel concat_heads__compressed_kv_cla__mha_block_cached__decode_kernel
  .amdhsa_next_free_vgpr 512
  .amdhsa_next_free_sgpr 102
  .amdhsa_accum_offset 256
  .amdhsa_group_segment_fixed_size 0
  .amdhsa_kernarg_size 112
  .amdhsa_user_sgpr_count 2
  .amdhsa_user_sgpr_kernarg_segment_ptr 1
  .amdhsa_system_sgpr_workgroup_id_x 1
.end_amdhsa_kernel
```

```asm
; @launch grid=(256,1,1) block=(256,1,1) lds=163840
    .amdgcn_target "amdgcn-amd-amdhsa--gfx950"
    .text
    .globl concat_heads__compressed_kv_cla__mha_block_cached__decode_kernel
    .p2align 8
    .type concat_heads__compressed_kv_cla__mha_block_cached__decode_kernel,@function
concat_heads__compressed_kv_cla__mha_block_cached__decode_kernel:
    s_cmp_ge_u32 s2, 256
    s_cbranch_scc1 L_end
    s_load_dwordx16 s[4:19], s[0:1], 0
    s_load_dwordx8 s[20:27], s[0:1], 64
    s_load_dwordx4 s[28:31], s[0:1], 96
    v_lshrrev_b32 v4, 6, v0
    v_and_b32 v1, 63, v0
    v_readfirstlane_b32 s34, v4
    s_lshr_b32 s32, s2, 3
    s_sub_u32 s33, s2, s32
    s_sub_u32 s33, s33, 1
    s_and_b32 s33, s33, 7
    v_lshrrev_b32 v2, 4, v1
    v_and_b32 v3, 15, v1
    s_cmp_lt_u32 s33, 2
    s_cbranch_scc1 L_qp
    s_cmp_eq_u32 s33, 2
    s_cbranch_scc1 L_ql
    s_cmp_eq_u32 s33, 7
    s_cbranch_scc1 L_aux
    v_lshrrev_b32 v4, 2, v3
    v_and_b32 v5, 3, v3
    v_lshlrev_b32 v76, 8, v4
    v_lshlrev_b32 v126, 8, v2
    v_lshl_add_u32 v76, v2, 6, v76
    v_lshl_add_u32 v76, v5, 4, v76
    v_lshl_add_u32 v126, v3, 4, v126
    v_xor_b32 v77, 32768, v76
    v_xor_b32 v127, 32768, v126
    s_add_u32 s3, s34, s33
    s_and_b32 s3, s3, 3
    s_lshl_b32 s89, s3, 5
    s_add_u32 s89, s89, s32
    s_lshl_b32 s89, s89, 20
    s_mul_i32 s88, s32, 8
    s_add_u32 s88, s88, s3
    s_add_u32 s87, s33, 0
    s_mov_b32 s54, 134217728
    s_mov_b32 s55, 0x20000
    s_mov_b32 s58, 134217728
    s_mov_b32 s59, 0x20000
    s_add_u32 s39, s87, s88
    s_bfe_u32 s37, s39, 0x30000
    s_lshl_b32 s37, s37, 12
    s_add_u32 s85, s37, s89
    s_bfe_u32 s37, s39, 0x10003
    s_lshl_b32 s37, s37, 11
    s_add_u32 s85, s37, s85
    s_bfe_u32 s37, s39, 0x40004
    s_lshl_b32 s37, s37, 16
    s_add_u32 s85, s37, s85
    s_waitcnt lgkmcnt(0)
    s_mov_b64 s[52:53], s[18:19]
    s_mov_b64 s[56:57], s[20:21]
    s_and_b32 s36, s32, 24
    s_and_b32 s38, s2, 7
    s_add_u32 s36, s36, s38
    s_lshl_b32 s36, s36, 2
    s_add_u32 s36, s36, s33
    s_sub_u32 s36, s36, 3
    v_and_b32 v4, 31, v1
    v_lshlrev_b32 v4, 7, v4
    v_lshrrev_b32 v5, 5, v1
    v_lshl_add_u32 v4, v5, 15, v4
    v_lshlrev_b32 v5, 7, v1
    s_mov_b32 s40, s6
    s_and_b32 s41, s7, 0xffff
    s_mov_b32 s42, 16777216
    s_mov_b32 s43, 0x20000
    s_lshl_b32 s38, s36, 17
    s_lshl_b32 s39, s34, 12
    s_add_u32 s38, s38, s39
    buffer_load_dword v20, v4, s[40:43], s38 offen
    s_add_u32 s38, s38, 16384
    buffer_load_dword v21, v4, s[40:43], s38 offen
    s_add_u32 s38, s38, 49152
    buffer_load_dword v22, v4, s[40:43], s38 offen
    s_add_u32 s38, s38, 16384
    buffer_load_dword v23, v4, s[40:43], s38 offen
    buffer_load_dwordx4 v[128:131], v76, s[52:55], s85 offen offset:0 nt
    buffer_load_dwordx4 v[132:135], v77, s[52:55], s85 offen offset:0 nt
    buffer_load_dwordx4 v[136:139], v76, s[52:55], s85 offen offset:1024 nt
    buffer_load_dwordx4 v[140:143], v77, s[52:55], s85 offen offset:1024 nt
    s_add_u32 s87, s87, 7
    s_add_u32 s39, s87, s88
    s_bfe_u32 s37, s39, 0x30000
    s_lshl_b32 s37, s37, 12
    s_add_u32 s85, s37, s89
    s_bfe_u32 s37, s39, 0x10003
    s_lshl_b32 s37, s37, 11
    s_add_u32 s85, s37, s85
    s_bfe_u32 s37, s39, 0x40004
    s_lshl_b32 s37, s37, 16
    s_add_u32 s85, s37, s85
    buffer_load_dwordx4 v[144:147], v76, s[52:55], s85 offen offset:0 nt
    buffer_load_dwordx4 v[148:151], v77, s[52:55], s85 offen offset:0 nt
    buffer_load_dwordx4 v[152:155], v76, s[52:55], s85 offen offset:1024 nt
    s_getpc_b64 s[36:37]
L_pc_1:
    s_sub_u32 s36, s36, L_pc_1 - concat_heads__compressed_kv_cla__mha_block_cached__decode_kernel
    s_subb_u32 s37, s37, 0
    s_lshl_b32 s38, s32, 10
    v_lshl_add_u32 v6, v0, 2, s38
    v_mov_b32 v7, s37
    v_add_co_u32 v6, vcc, s36, v6
    s_nop 1
    v_addc_co_u32 v7, vcc, 0, v7, vcc
    global_load_dword v0, v[6:7], off
    s_load_dword s35, s[30:31], 0
    s_mov_b32 s48, s30
    s_and_b32 s49, s31, 0xffff
    s_mov_b32 s50, 8388608
    s_mov_b32 s51, 0x20000
    s_mov_b32 s82, 0xffffff00
    s_mov_b32 s83, 0x3e0293ee
    s_mov_b32 s84, 2097152
    s_waitcnt vmcnt(7)
    buffer_load_dwordx4 v[156:159], v77, s[52:55], s85 offen offset:1024 nt
    s_add_u32 s87, s87, 7
    s_add_u32 s39, s87, s88
    s_bfe_u32 s37, s39, 0x30000
    s_lshl_b32 s37, s37, 12
    s_add_u32 s85, s37, s89
    s_bfe_u32 s37, s39, 0x10003
    s_lshl_b32 s37, s37, 11
    s_add_u32 s85, s37, s85
    s_bfe_u32 s37, s39, 0x40004
    s_lshl_b32 s37, s37, 16
    s_add_u32 s85, s37, s85
    s_waitcnt vmcnt(7)
    buffer_load_dwordx4 v[160:163], v76, s[52:55], s85 offen offset:0 nt
    s_waitcnt vmcnt(7)
    buffer_load_dwordx4 v[164:167], v77, s[52:55], s85 offen offset:0 nt
    s_waitcnt vmcnt(7)
    buffer_load_dwordx4 v[168:171], v76, s[52:55], s85 offen offset:1024 nt
    v_and_b32 v4, 1, v1
    v_lshlrev_b32 v4, 4, v4
    v_mov_b32 v5, 0xffff
    v_lshlrev_b32 v4, v4, v5
    v_bfe_u32 v5, v1, 1, 2
    v_cmp_eq_u32 vcc, 0, v5
    s_nop 1
    v_cndmask_b32 v10, 0, v4, vcc
    v_cmp_eq_u32 vcc, 1, v5
    s_nop 1
    v_cndmask_b32 v11, 0, v4, vcc
    v_cmp_eq_u32 vcc, 2, v5
    s_nop 1
    v_cndmask_b32 v12, 0, v4, vcc
    v_cmp_eq_u32 vcc, 3, v5
    s_nop 1
    v_cndmask_b32 v13, 0, v4, vcc
    s_waitcnt vmcnt(7)
    buffer_load_dwordx4 v[172:175], v77, s[52:55], s85 offen offset:1024 nt
    s_add_u32 s87, s87, 7
    s_add_u32 s39, s87, s88
    s_bfe_u32 s37, s39, 0x30000
    s_lshl_b32 s37, s37, 12
    s_add_u32 s85, s37, s89
    s_bfe_u32 s37, s39, 0x10003
    s_lshl_b32 s37, s37, 11
    s_add_u32 s85, s37, s85
    s_bfe_u32 s37, s39, 0x40004
    s_lshl_b32 s37, s37, 16
    s_add_u32 s85, s37, s85
    s_waitcnt vmcnt(7)
    buffer_load_dwordx4 v[176:179], v76, s[52:55], s85 offen offset:0 nt
    s_waitcnt vmcnt(7)
    buffer_load_dwordx4 v[180:183], v77, s[52:55], s85 offen offset:0 nt
    s_waitcnt vmcnt(6)
    buffer_load_dwordx4 v[184:187], v76, s[52:55], s85 offen offset:1024 nt
    v_mov_b32 v120, 0xff7f0000
    v_mov_b32 v121, 0
    v_mov_b32 v18, 1
    v_mov_b32 v116, 0
    v_mov_b32 v117, 0
    v_mov_b32 v118, 0
    v_mov_b32 v119, 0
    s_lshl_b32 s38, s32, 2
    s_add_u32 s38, s38, s3
    s_lshl_b32 s96, s38, 3
    s_lshl_b32 s38, s38, 8
    s_add_u32 s38, s38, 65536
    v_mov_b32 v9, s38
    s_add_u32 s96, s96, s33
    s_lshl_b32 s96, s96, 10
    s_add_u32 s96, s96, 5242880
    v_and_b32 v5, 3, v3
    v_lshlrev_b32 v78, 7, v2
    v_lshl_add_u32 v78, v5, 5, v78
    s_lshl_b32 s91, s32, 12
    s_lshl_b32 s38, s3, 9
    s_add_u32 s91, s91, s38
    s_add_u32 s91, s91, 1048576
    v_lshlrev_b32 v4, 7, v2
    v_lshl_add_u32 v4, v3, 4, v4
    v_mov_b32 v5, 512
    v_cmp_gt_u32 vcc, 8, v3
    s_nop 1
    v_cndmask_b32 v79, v5, v4, vcc
    s_waitcnt vmcnt(6)
    buffer_load_dwordx4 v[188:191], v77, s[52:55], s85 offen offset:1024 nt
    s_add_u32 s87, s87, 7
    s_add_u32 s39, s87, s88
    s_bfe_u32 s37, s39, 0x30000
    s_lshl_b32 s37, s37, 12
    s_add_u32 s85, s37, s89
    s_bfe_u32 s37, s39, 0x10003
    s_lshl_b32 s37, s37, 11
    s_add_u32 s85, s37, s85
    s_bfe_u32 s37, s39, 0x40004
    s_lshl_b32 s37, s37, 16
    s_add_u32 s85, s37, s85
    s_waitcnt vmcnt(6)
    buffer_load_dwordx4 v[192:195], v76, s[52:55], s85 offen offset:0 nt
    s_waitcnt vmcnt(6)
    buffer_load_dwordx4 v[196:199], v77, s[52:55], s85 offen offset:0 nt
    s_waitcnt vmcnt(6)
    buffer_load_dwordx4 v[200:203], v76, s[52:55], s85 offen offset:1024 nt
    s_waitcnt vmcnt(6)
    buffer_load_dwordx4 v[204:207], v77, s[52:55], s85 offen offset:1024 nt
    s_add_u32 s87, s87, 7
    s_add_u32 s39, s87, s88
    s_bfe_u32 s37, s39, 0x30000
    s_lshl_b32 s37, s37, 12
    s_add_u32 s85, s37, s89
    s_bfe_u32 s37, s39, 0x10003
    s_lshl_b32 s37, s37, 11
    s_add_u32 s85, s37, s85
    s_bfe_u32 s37, s39, 0x40004
    s_lshl_b32 s37, s37, 16
    s_add_u32 s85, s37, s85
    s_waitcnt vmcnt(6)
    buffer_load_dwordx4 v[208:211], v76, s[52:55], s85 offen offset:0 nt
    s_waitcnt vmcnt(6)
    buffer_load_dwordx4 v[212:215], v77, s[52:55], s85 offen offset:0 nt
    s_waitcnt vmcnt(6)
    buffer_load_dwordx4 v[216:219], v76, s[52:55], s85 offen offset:1024 nt
    s_waitcnt vmcnt(6)
    buffer_load_dwordx4 v[220:223], v77, s[52:55], s85 offen offset:1024 nt
    s_add_u32 s87, s87, 7
    s_add_u32 s39, s87, s88
    s_bfe_u32 s37, s39, 0x30000
    s_lshl_b32 s37, s37, 12
    s_add_u32 s85, s37, s89
    s_bfe_u32 s37, s39, 0x10003
    s_lshl_b32 s37, s37, 11
    s_add_u32 s85, s37, s85
    s_bfe_u32 s37, s39, 0x40004
    s_lshl_b32 s37, s37, 16
    s_add_u32 s85, s37, s85
    s_waitcnt vmcnt(6)
    buffer_load_dwordx4 v[224:227], v76, s[52:55], s85 offen offset:0 nt
    s_waitcnt vmcnt(6)
    buffer_load_dwordx4 v[228:231], v77, s[52:55], s85 offen offset:0 nt
    s_waitcnt vmcnt(6)
    buffer_load_dwordx4 v[232:235], v76, s[52:55], s85 offen offset:1024 nt
    s_waitcnt vmcnt(6)
    buffer_load_dwordx4 v[236:239], v77, s[52:55], s85 offen offset:1024 nt
    s_add_u32 s87, s87, 7
    s_add_u32 s39, s87, s88
    s_bfe_u32 s37, s39, 0x30000
    s_lshl_b32 s37, s37, 12
    s_add_u32 s85, s37, s89
    s_bfe_u32 s37, s39, 0x10003
    s_lshl_b32 s37, s37, 11
    s_add_u32 s85, s37, s85
    s_bfe_u32 s37, s39, 0x40004
    s_lshl_b32 s37, s37, 16
    s_add_u32 s85, s37, s85
    s_waitcnt vmcnt(6)
    buffer_load_dwordx4 v[240:243], v76, s[52:55], s85 offen offset:0 nt
    s_waitcnt vmcnt(6)
    buffer_load_dwordx4 v[244:247], v77, s[52:55], s85 offen offset:0 nt
    s_waitcnt vmcnt(6)
    buffer_load_dwordx4 v[248:251], v76, s[52:55], s85 offen offset:1024 nt
    s_waitcnt vmcnt(6)
    buffer_load_dwordx4 v[252:255], v77, s[52:55], s85 offen offset:1024 nt
    s_add_u32 s87, s87, 7
    s_add_u32 s39, s87, s88
    s_bfe_u32 s37, s39, 0x30000
    s_lshl_b32 s37, s37, 12
    s_add_u32 s85, s37, s89
    s_bfe_u32 s37, s39, 0x10003
    s_lshl_b32 s37, s37, 11
    s_add_u32 s85, s37, s85
    s_bfe_u32 s37, s39, 0x40004
    s_lshl_b32 s37, s37, 16
    s_add_u32 s85, s37, s85
    s_waitcnt vmcnt(6)
    buffer_load_dwordx4 a[0:3], v76, s[52:55], s85 offen offset:0 nt
    s_waitcnt vmcnt(6)
    buffer_load_dwordx4 a[4:7], v77, s[52:55], s85 offen offset:0 nt
    buffer_load_dwordx4 v[68:71], v78, s[48:51], s91 offen offset:0 sc1
    buffer_load_dwordx4 v[72:75], v78, s[48:51], s91 offen offset:16 sc1
    s_waitcnt vmcnt(8)
    buffer_load_dwordx4 a[8:11], v76, s[52:55], s85 offen offset:1024 nt
    s_waitcnt vmcnt(8)
    buffer_load_dwordx4 a[12:15], v77, s[52:55], s85 offen offset:1024 nt
    s_add_u32 s87, s87, 7
    s_add_u32 s39, s87, s88
    s_bfe_u32 s37, s39, 0x30000
    s_lshl_b32 s37, s37, 12
    s_add_u32 s85, s37, s89
    s_bfe_u32 s37, s39, 0x10003
    s_lshl_b32 s37, s37, 11
    s_add_u32 s85, s37, s85
    s_bfe_u32 s37, s39, 0x40004
    s_lshl_b32 s37, s37, 16
    s_add_u32 s85, s37, s85
    s_waitcnt vmcnt(8)
    buffer_load_dwordx4 a[16:19], v76, s[52:55], s85 offen offset:0 nt
    s_waitcnt vmcnt(8)
    buffer_load_dwordx4 a[20:23], v77, s[52:55], s85 offen offset:0 nt
    s_waitcnt vmcnt(8)
    buffer_load_dwordx4 a[24:27], v76, s[52:55], s85 offen offset:1024 nt
    s_waitcnt vmcnt(8)
    buffer_load_dwordx4 a[28:31], v77, s[52:55], s85 offen offset:1024 nt
    s_add_u32 s87, s87, 7
    s_add_u32 s39, s87, s88
    s_bfe_u32 s37, s39, 0x30000
    s_lshl_b32 s37, s37, 12
    s_add_u32 s85, s37, s89
    s_bfe_u32 s37, s39, 0x10003
    s_lshl_b32 s37, s37, 11
    s_add_u32 s85, s37, s85
    s_bfe_u32 s37, s39, 0x40004
    s_lshl_b32 s37, s37, 16
    s_add_u32 s85, s37, s85
    s_waitcnt lgkmcnt(0)
    s_add_u32 s35, s35, 0x5b
    s_and_b32 s35, s35, 0xff
    v_mov_b32 v8, s35
    s_waitcnt vmcnt(6)
L_qcheck_2:
    v_xor_b32 v68, s35, v68
    v_xor_b32 v69, s35, v69
    v_xor_b32 v70, s35, v70
    v_xor_b32 v71, s35, v71
    v_xor_b32 v72, s35, v72
    v_xor_b32 v73, s35, v73
    v_xor_b32 v74, s35, v74
    v_xor_b32 v75, s35, v75
    v_or_b32 v4, v68, v69
    v_or3_b32 v4, v4, v70, v71
    v_or3_b32 v4, v4, v72, v73
    v_or3_b32 v4, v4, v74, v75
    v_and_b32 v4, 0xff, v4
    v_cmp_ne_u32 vcc, 0, v4
    s_cbranch_vccz L_qok_3
    buffer_load_dwordx4 v[68:71], v78, s[48:51], s91 offen offset:0 sc1
    buffer_load_dwordx4 v[72:75], v78, s[48:51], s91 offen offset:16 sc1
    s_waitcnt vmcnt(0)
    s_sub_u32 s84, s84, 1
    s_cmp_lg_u32 s84, 0
    s_cbranch_scc1 L_qcheck_2
    s_branch L_end
L_qok_3:
    v_cvt_pk_bf16_f32 v68, v68, v69
    v_cvt_pk_bf16_f32 v69, v70, v71
    v_cvt_pk_bf16_f32 v70, v72, v73
    v_cvt_pk_bf16_f32 v71, v74, v75
    s_mov_b32 vcc_lo, 0xf000f
    s_mov_b32 vcc_hi, 0xf000f
    v_cndmask_b32 v80, 0, v68, vcc
    v_cndmask_b32 v81, 0, v69, vcc
    v_cndmask_b32 v82, 0, v70, vcc
    v_cndmask_b32 v83, 0, v71, vcc
    s_mov_b32 vcc_lo, 0xf000f0
    s_mov_b32 vcc_hi, 0xf000f0
    v_cndmask_b32 v84, 0, v68, vcc
    v_cndmask_b32 v85, 0, v69, vcc
    v_cndmask_b32 v86, 0, v70, vcc
    v_cndmask_b32 v87, 0, v71, vcc
    s_mov_b32 vcc_lo, 0xf000f00
    s_mov_b32 vcc_hi, 0xf000f00
    v_cndmask_b32 v88, 0, v68, vcc
    v_cndmask_b32 v89, 0, v69, vcc
    v_cndmask_b32 v90, 0, v70, vcc
    v_cndmask_b32 v91, 0, v71, vcc
    s_mov_b32 vcc_lo, 0xf000f000
    s_mov_b32 vcc_hi, 0xf000f000
    v_cndmask_b32 v92, 0, v68, vcc
    v_cndmask_b32 v93, 0, v69, vcc
    v_cndmask_b32 v94, 0, v70, vcc
    v_cndmask_b32 v95, 0, v71, vcc
    v_mov_b32 v65, 0xff7f0000
    s_lshl_b32 s38, s34, 14
    s_add_u32 s38, s38, 16384
    v_lshl_add_u32 v64, v1, 2, s38
    buffer_load_dwordx4 a[32:35], v76, s[52:55], s85 offen offset:0 nt
    v_mfma_f32_16x16x32_bf16 v[112:115], v[128:131], v[80:83], 0
    v_mfma_f32_16x16x32_bf16 v[112:115], v[132:135], v[84:87], v[112:115]
    v_mfma_f32_16x16x32_bf16 v[112:115], v[136:139], v[88:91], v[112:115]
    s_waitcnt vmcnt(6)
    buffer_load_dwordx4 a[36:39], v77, s[52:55], s85 offen offset:0 nt
    v_mfma_f32_16x16x32_bf16 v[112:115], v[140:143], v[92:95], v[112:115]
    v_mfma_f32_16x16x32_bf16 v[96:99], v[144:147], v[80:83], 0
    v_mfma_f32_16x16x32_bf16 v[96:99], v[148:151], v[84:87], v[96:99]
    s_waitcnt vmcnt(6)
    buffer_load_dwordx4 a[40:43], v76, s[52:55], s85 offen offset:1024 nt
    v_mfma_f32_16x16x32_bf16 v[96:99], v[152:155], v[88:91], v[96:99]
    s_nop 2
    v_mov_b32_dpp v122, v112 quad_perm:[0,0,0,0] row_mask:0xf bank_mask:0xf
    v_mov_b32_dpp v124, v114 quad_perm:[2,2,2,2] row_mask:0xf bank_mask:0xf
    s_nop 0
    v_add_f32_dpp v122, v113, v122 quad_perm:[1,1,1,1] row_mask:0xf bank_mask:0xf
    v_add_f32_dpp v124, v115, v124 quad_perm:[3,3,3,3] row_mask:0xf bank_mask:0xf
    v_add_f32 v122, v122, v124
    v_max_f32 v65, v65, v122
    ds_write_b32 v64, v122 offset:0
    v_mfma_f32_16x16x32_bf16 v[96:99], v[156:159], v[92:95], v[96:99]
    v_mfma_f32_16x16x32_bf16 v[112:115], v[160:163], v[80:83], 0
    v_mfma_f32_16x16x32_bf16 v[112:115], v[164:167], v[84:87], v[112:115]
    s_waitcnt vmcnt(6)
    buffer_load_dwordx4 a[44:47], v77, s[52:55], s85 offen offset:1024 nt
    s_add_u32 s87, s87, 7
    s_add_u32 s39, s87, s88
    s_bfe_u32 s37, s39, 0x30000
    s_lshl_b32 s37, s37, 12
    s_add_u32 s85, s37, s89
    s_bfe_u32 s37, s39, 0x10003
    s_lshl_b32 s37, s37, 11
    s_add_u32 s85, s37, s85
    s_bfe_u32 s37, s39, 0x40004
    s_lshl_b32 s37, s37, 16
    s_add_u32 s85, s37, s85
    v_mfma_f32_16x16x32_bf16 v[112:115], v[168:171], v[88:91], v[112:115]
    v_mov_b32_dpp v122, v96 quad_perm:[0,0,0,0] row_mask:0xf bank_mask:0xf
    v_mov_b32_dpp v124, v98 quad_perm:[2,2,2,2] row_mask:0xf bank_mask:0xf
    s_nop 0
    v_add_f32_dpp v122, v97, v122 quad_perm:[1,1,1,1] row_mask:0xf bank_mask:0xf
    v_add_f32_dpp v124, v99, v124 quad_perm:[3,3,3,3] row_mask:0xf bank_mask:0xf
    v_add_f32 v122, v122, v124
    v_max_f32 v65, v65, v122
    ds_write_b32 v64, v122 offset:256
    v_mfma_f32_16x16x32_bf16 v[112:115], v[172:175], v[92:95], v[112:115]
    v_mfma_f32_16x16x32_bf16 v[96:99], v[176:179], v[80:83], 0
    s_waitcnt vmcnt(6)
    buffer_load_dwordx4 a[48:51], v76, s[52:55], s85 offen offset:0 nt
    v_mfma_f32_16x16x32_bf16 v[96:99], v[180:183], v[84:87], v[96:99]
    v_mfma_f32_16x16x32_bf16 v[96:99], v[184:187], v[88:91], v[96:99]
    s_nop 2
    v_mov_b32_dpp v122, v112 quad_perm:[0,0,0,0] row_mask:0xf bank_mask:0xf
    v_mov_b32_dpp v124, v114 quad_perm:[2,2,2,2] row_mask:0xf bank_mask:0xf
    s_nop 0
    v_add_f32_dpp v122, v113, v122 quad_perm:[1,1,1,1] row_mask:0xf bank_mask:0xf
    v_add_f32_dpp v124, v115, v124 quad_perm:[3,3,3,3] row_mask:0xf bank_mask:0xf
    v_add_f32 v122, v122, v124
    v_max_f32 v65, v65, v122
    ds_write_b32 v64, v122 offset:512
    v_mfma_f32_16x16x32_bf16 v[96:99], v[188:191], v[92:95], v[96:99]
    v_mfma_f32_16x16x32_bf16 v[112:115], v[192:195], v[80:83], 0
    s_waitcnt vmcnt(6)
    buffer_load_dwordx4 a[52:55], v77, s[52:55], s85 offen offset:0 nt
    v_mfma_f32_16x16x32_bf16 v[112:115], v[196:199], v[84:87], v[112:115]
    v_mfma_f32_16x16x32_bf16 v[112:115], v[200:203], v[88:91], v[112:115]
    s_nop 2
    v_mov_b32_dpp v122, v96 quad_perm:[0,0,0,0] row_mask:0xf bank_mask:0xf
    v_mov_b32_dpp v124, v98 quad_perm:[2,2,2,2] row_mask:0xf bank_mask:0xf
    s_nop 0
    v_add_f32_dpp v122, v97, v122 quad_perm:[1,1,1,1] row_mask:0xf bank_mask:0xf
    v_add_f32_dpp v124, v99, v124 quad_perm:[3,3,3,3] row_mask:0xf bank_mask:0xf
    v_add_f32 v122, v122, v124
    v_max_f32 v65, v65, v122
    ds_write_b32 v64, v122 offset:768
    v_mfma_f32_16x16x32_bf16 v[112:115], v[204:207], v[92:95], v[112:115]
    s_waitcnt vmcnt(6)
    buffer_load_dwordx4 a[56:59], v76, s[52:55], s85 offen offset:1024 nt
    v_mfma_f32_16x16x32_bf16 v[96:99], v[208:211], v[80:83], 0
    v_mfma_f32_16x16x32_bf16 v[96:99], v[212:215], v[84:87], v[96:99]
    v_mfma_f32_16x16x32_bf16 v[96:99], v[216:219], v[88:91], v[96:99]
    s_nop 2
    v_mov_b32_dpp v122, v112 quad_perm:[0,0,0,0] row_mask:0xf bank_mask:0xf
    v_mov_b32_dpp v124, v114 quad_perm:[2,2,2,2] row_mask:0xf bank_mask:0xf
    s_nop 0
    v_add_f32_dpp v122, v113, v122 quad_perm:[1,1,1,1] row_mask:0xf bank_mask:0xf
    v_add_f32_dpp v124, v115, v124 quad_perm:[3,3,3,3] row_mask:0xf bank_mask:0xf
    v_add_f32 v122, v122, v124
    v_max_f32 v65, v65, v122
    ds_write_b32 v64, v122 offset:1024
    v_mfma_f32_16x16x32_bf16 v[96:99], v[220:223], v[92:95], v[96:99]
    s_waitcnt vmcnt(6)
    buffer_load_dwordx4 a[60:63], v77, s[52:55], s85 offen offset:1024 nt
    s_add_u32 s87, s87, 7
    s_add_u32 s39, s87, s88
    s_bfe_u32 s37, s39, 0x30000
    s_lshl_b32 s37, s37, 12
    s_add_u32 s85, s37, s89
    s_bfe_u32 s37, s39, 0x10003
    s_lshl_b32 s37, s37, 11
    s_add_u32 s85, s37, s85
    s_bfe_u32 s37, s39, 0x40004
    s_lshl_b32 s37, s37, 16
    s_add_u32 s85, s37, s85
    v_mfma_f32_16x16x32_bf16 v[112:115], v[224:227], v[80:83], 0
    v_mfma_f32_16x16x32_bf16 v[112:115], v[228:231], v[84:87], v[112:115]
    v_mfma_f32_16x16x32_bf16 v[112:115], v[232:235], v[88:91], v[112:115]
    v_mov_b32_dpp v122, v96 quad_perm:[0,0,0,0] row_mask:0xf bank_mask:0xf
    v_mov_b32_dpp v124, v98 quad_perm:[2,2,2,2] row_mask:0xf bank_mask:0xf
    s_nop 0
    v_add_f32_dpp v122, v97, v122 quad_perm:[1,1,1,1] row_mask:0xf bank_mask:0xf
    v_add_f32_dpp v124, v99, v124 quad_perm:[3,3,3,3] row_mask:0xf bank_mask:0xf
    v_add_f32 v122, v122, v124
    v_max_f32 v65, v65, v122
    ds_write_b32 v64, v122 offset:1280
    s_waitcnt vmcnt(5)
    buffer_load_dwordx4 v[128:131], v76, s[52:55], s85 offen offset:0 nt
    v_mfma_f32_16x16x32_bf16 v[112:115], v[236:239], v[92:95], v[112:115]
    v_mfma_f32_16x16x32_bf16 v[96:99], v[240:243], v[80:83], 0
    v_mfma_f32_16x16x32_bf16 v[96:99], v[244:247], v[84:87], v[96:99]
    s_waitcnt vmcnt(5)
    buffer_load_dwordx4 v[132:135], v77, s[52:55], s85 offen offset:0 nt
    v_mfma_f32_16x16x32_bf16 v[96:99], v[248:251], v[88:91], v[96:99]
    s_nop 2
    v_mov_b32_dpp v122, v112 quad_perm:[0,0,0,0] row_mask:0xf bank_mask:0xf
    v_mov_b32_dpp v124, v114 quad_perm:[2,2,2,2] row_mask:0xf bank_mask:0xf
    s_nop 0
    v_add_f32_dpp v122, v113, v122 quad_perm:[1,1,1,1] row_mask:0xf bank_mask:0xf
    v_add_f32_dpp v124, v115, v124 quad_perm:[3,3,3,3] row_mask:0xf bank_mask:0xf
    v_add_f32 v122, v122, v124
    v_max_f32 v65, v65, v122
    ds_write_b32 v64, v122 offset:1536
    v_mfma_f32_16x16x32_bf16 v[96:99], v[252:255], v[92:95], v[96:99]
    v_mfma_f32_16x16x32_bf16 v[112:115], a[0:3], v[80:83], 0
    v_mfma_f32_16x16x32_bf16 v[112:115], a[4:7], v[84:87], v[112:115]
    s_waitcnt vmcnt(5)
    buffer_load_dwordx4 v[136:139], v76, s[52:55], s85 offen offset:1024 nt
    v_mfma_f32_16x16x32_bf16 v[112:115], a[8:11], v[88:91], v[112:115]
    s_nop 2
    v_mov_b32_dpp v122, v96 quad_perm:[0,0,0,0] row_mask:0xf bank_mask:0xf
    v_mov_b32_dpp v124, v98 quad_perm:[2,2,2,2] row_mask:0xf bank_mask:0xf
    s_nop 0
    v_add_f32_dpp v122, v97, v122 quad_perm:[1,1,1,1] row_mask:0xf bank_mask:0xf
    v_add_f32_dpp v124, v99, v124 quad_perm:[3,3,3,3] row_mask:0xf bank_mask:0xf
    v_add_f32 v122, v122, v124
    v_max_f32 v65, v65, v122
    ds_write_b32 v64, v122 offset:1792
    v_mfma_f32_16x16x32_bf16 v[112:115], a[12:15], v[92:95], v[112:115]
    v_mfma_f32_16x16x32_bf16 v[96:99], a[16:19], v[80:83], 0
    s_waitcnt vmcnt(5)
    buffer_load_dwordx4 v[140:143], v77, s[52:55], s85 offen offset:1024 nt
    s_add_u32 s87, s87, 7
    s_add_u32 s39, s87, s88
    s_bfe_u32 s37, s39, 0x30000
    s_lshl_b32 s37, s37, 12
    s_add_u32 s85, s37, s89
    s_bfe_u32 s37, s39, 0x10003
    s_lshl_b32 s37, s37, 11
    s_add_u32 s85, s37, s85
    s_bfe_u32 s37, s39, 0x40004
    s_lshl_b32 s37, s37, 16
    s_add_u32 s85, s37, s85
    v_mfma_f32_16x16x32_bf16 v[96:99], a[20:23], v[84:87], v[96:99]
    v_mfma_f32_16x16x32_bf16 v[96:99], a[24:27], v[88:91], v[96:99]
    v_mov_b32_dpp v122, v112 quad_perm:[0,0,0,0] row_mask:0xf bank_mask:0xf
    v_mov_b32_dpp v124, v114 quad_perm:[2,2,2,2] row_mask:0xf bank_mask:0xf
    s_nop 0
    v_add_f32_dpp v122, v113, v122 quad_perm:[1,1,1,1] row_mask:0xf bank_mask:0xf
    v_add_f32_dpp v124, v115, v124 quad_perm:[3,3,3,3] row_mask:0xf bank_mask:0xf
    v_add_f32 v122, v122, v124
    v_max_f32 v65, v65, v122
    ds_write_b32 v64, v122 offset:2048
    v_mfma_f32_16x16x32_bf16 v[96:99], a[28:31], v[92:95], v[96:99]
    v_mfma_f32_16x16x32_bf16 v[112:115], a[32:35], v[80:83], 0
    s_waitcnt vmcnt(5)
    buffer_load_dwordx4 v[144:147], v76, s[52:55], s85 offen offset:0 nt
    v_mfma_f32_16x16x32_bf16 v[112:115], a[36:39], v[84:87], v[112:115]
    v_mfma_f32_16x16x32_bf16 v[112:115], a[40:43], v[88:91], v[112:115]
    s_nop 2
    v_mov_b32_dpp v122, v96 quad_perm:[0,0,0,0] row_mask:0xf bank_mask:0xf
    v_mov_b32_dpp v124, v98 quad_perm:[2,2,2,2] row_mask:0xf bank_mask:0xf
    s_nop 0
    v_add_f32_dpp v122, v97, v122 quad_perm:[1,1,1,1] row_mask:0xf bank_mask:0xf
    v_add_f32_dpp v124, v99, v124 quad_perm:[3,3,3,3] row_mask:0xf bank_mask:0xf
    v_add_f32 v122, v122, v124
    v_max_f32 v65, v65, v122
    ds_write_b32 v64, v122 offset:2304
    v_mfma_f32_16x16x32_bf16 v[112:115], a[44:47], v[92:95], v[112:115]
    s_waitcnt vmcnt(5)
    buffer_load_dwordx4 v[148:151], v77, s[52:55], s85 offen offset:0 nt
    v_mfma_f32_16x16x32_bf16 v[96:99], a[48:51], v[80:83], 0
    v_mfma_f32_16x16x32_bf16 v[96:99], a[52:55], v[84:87], v[96:99]
    v_mfma_f32_16x16x32_bf16 v[96:99], a[56:59], v[88:91], v[96:99]
    s_nop 2
    v_mov_b32_dpp v122, v112 quad_perm:[0,0,0,0] row_mask:0xf bank_mask:0xf
    v_mov_b32_dpp v124, v114 quad_perm:[2,2,2,2] row_mask:0xf bank_mask:0xf
    s_nop 0
    v_add_f32_dpp v122, v113, v122 quad_perm:[1,1,1,1] row_mask:0xf bank_mask:0xf
    v_add_f32_dpp v124, v115, v124 quad_perm:[3,3,3,3] row_mask:0xf bank_mask:0xf
    v_add_f32 v122, v122, v124
    v_max_f32 v65, v65, v122
    ds_write_b32 v64, v122 offset:2560
    v_mfma_f32_16x16x32_bf16 v[96:99], a[60:63], v[92:95], v[96:99]
    v_add_u32 v64, 2816, v64
    s_mov_b32 s97, 10
    s_mov_b32 s86, 32
    s_add_u32 s92, s33, 224
    s_mov_b32 s66, 134217728
    s_mov_b32 s67, 0x20000
    s_mov_b64 s[64:65], s[52:53]
    v_mov_b32 v62, v76
    v_mov_b32 v63, v77
L_bloop:
    s_waitcnt vmcnt(5)
    buffer_load_dwordx4 v[152:155], v62, s[64:67], s85 offen offset:1024 nt
    v_mfma_f32_16x16x32_bf16 v[112:115], v[128:131], v[80:83], 0
    s_waitcnt vmcnt(5)
    buffer_load_dwordx4 v[156:159], v63, s[64:67], s85 offen offset:1024 nt
    v_mfma_f32_16x16x32_bf16 v[112:115], v[132:135], v[84:87], v[112:115]
    s_add_u32 s87, s87, 7
    s_cmp_lg_u32 s87, s92
    s_cbranch_scc1 L_stayk_4
    s_mov_b64 s[64:65], s[56:57]
    v_mov_b32 v62, v126
    v_mov_b32 v63, v127
    s_mul_i32 s37, s86, 7
    s_sub_u32 s87, s87, s37
L_stayk_4:
    s_add_u32 s39, s87, s88
    s_bfe_u32 s37, s39, 0x30000
    s_lshl_b32 s37, s37, 12
    s_add_u32 s85, s37, s89
    s_bfe_u32 s37, s39, 0x10003
    s_lshl_b32 s37, s37, 11
    s_add_u32 s85, s37, s85
    s_bfe_u32 s37, s39, 0x40004
    s_lshl_b32 s37, s37, 16
    s_add_u32 s85, s37, s85
    v_mov_b32_dpp v122, v96 quad_perm:[0,0,0,0] row_mask:0xf bank_mask:0xf
    v_mov_b32_dpp v124, v98 quad_perm:[2,2,2,2] row_mask:0xf bank_mask:0xf
    s_nop 0
    v_add_f32_dpp v122, v97, v122 quad_perm:[1,1,1,1] row_mask:0xf bank_mask:0xf
    v_add_f32_dpp v124, v99, v124 quad_perm:[3,3,3,3] row_mask:0xf bank_mask:0xf
    v_add_f32 v122, v122, v124
    v_max_f32 v65, v65, v122
    ds_write_b32 v64, v122 offset:0
    s_waitcnt vmcnt(5)
    buffer_load_dwordx4 v[128:131], v62, s[64:67], s85 offen offset:0 nt
    v_mfma_f32_16x16x32_bf16 v[112:115], v[136:139], v[88:91], v[112:115]
    s_waitcnt vmcnt(5)
    buffer_load_dwordx4 v[132:135], v63, s[64:67], s85 offen offset:0 nt
    v_mfma_f32_16x16x32_bf16 v[112:115], v[140:143], v[92:95], v[112:115]
    s_waitcnt vmcnt(5)
    buffer_load_dwordx4 v[136:139], v62, s[64:67], s85 offen offset:1024 nt
    v_mfma_f32_16x16x32_bf16 v[96:99], v[144:147], v[80:83], 0
    s_waitcnt vmcnt(5)
    buffer_load_dwordx4 v[140:143], v63, s[64:67], s85 offen offset:1024 nt
    v_mfma_f32_16x16x32_bf16 v[96:99], v[148:151], v[84:87], v[96:99]
    s_add_u32 s87, s87, 7
    s_add_u32 s39, s87, s88
    s_bfe_u32 s37, s39, 0x30000
    s_lshl_b32 s37, s37, 12
    s_add_u32 s85, s37, s89
    s_bfe_u32 s37, s39, 0x10003
    s_lshl_b32 s37, s37, 11
    s_add_u32 s85, s37, s85
    s_bfe_u32 s37, s39, 0x40004
    s_lshl_b32 s37, s37, 16
    s_add_u32 s85, s37, s85
    v_mov_b32_dpp v122, v112 quad_perm:[0,0,0,0] row_mask:0xf bank_mask:0xf
    v_mov_b32_dpp v124, v114 quad_perm:[2,2,2,2] row_mask:0xf bank_mask:0xf
    s_nop 0
    v_add_f32_dpp v122, v113, v122 quad_perm:[1,1,1,1] row_mask:0xf bank_mask:0xf
    v_add_f32_dpp v124, v115, v124 quad_perm:[3,3,3,3] row_mask:0xf bank_mask:0xf
    v_add_f32 v122, v122, v124
    v_max_f32 v65, v65, v122
    ds_write_b32 v64, v122 offset:256
    s_waitcnt vmcnt(5)
    buffer_load_dwordx4 v[144:147], v62, s[64:67], s85 offen offset:0 nt
    v_mfma_f32_16x16x32_bf16 v[96:99], v[152:155], v[88:91], v[96:99]
    s_waitcnt vmcnt(5)
    buffer_load_dwordx4 v[148:151], v63, s[64:67], s85 offen offset:0 nt
    v_mfma_f32_16x16x32_bf16 v[96:99], v[156:159], v[92:95], v[96:99]
    v_add_u32 v64, 512, v64
    s_sub_u32 s97, s97, 1
    s_cmp_lg_u32 s97, 0
    s_cbranch_scc1 L_bloop
    s_nop 3
    v_mov_b32_dpp v122, v96 quad_perm:[0,0,0,0] row_mask:0xf bank_mask:0xf
    v_mov_b32_dpp v124, v98 quad_perm:[2,2,2,2] row_mask:0xf bank_mask:0xf
    s_nop 0
    v_add_f32_dpp v122, v97, v122 quad_perm:[1,1,1,1] row_mask:0xf bank_mask:0xf
    v_add_f32_dpp v124, v99, v124 quad_perm:[3,3,3,3] row_mask:0xf bank_mask:0xf
    v_add_f32 v122, v122, v124
    v_max_f32 v65, v65, v122
    ds_write_b32 v64, v122 offset:0
    v_mov_b32 v123, 0xff7f0000
    ds_write_b32 v64, v123 offset:256
    s_lshl_b32 s38, s34, 14
    s_add_u32 s38, s38, 16384
    v_lshl_add_u32 v64, v1, 2, s38
    ds_read_b32 v66, v64
    ds_read_b32 v67, v64 offset:256
    v_mul_f32 v65, s83, v65
    s_nop 1
    v_max_f32_dpp v124, v65, v65 row_ror:4 row_mask:0xf bank_mask:0xf
    s_nop 1
    v_max_f32_dpp v124, v124, v124 row_ror:8 row_mask:0xf bank_mask:0xf
    v_mov_b32 v125, v124
    s_nop 1
    v_permlane16_swap_b32 v124, v125
    v_max_f32 v124, v124, v125
    v_mov_b32 v125, v124
    s_nop 1
    v_permlane32_swap_b32 v124, v125
    v_max_f32 v124, v124, v125
    v_and_b32 v120, s82, v124
    s_lshr_b32 s97, s86, 1
    s_waitcnt lgkmcnt(1)
    v_fma_f32 v123, v66, s83, -v120
    v_exp_f32 v123, v123
    ds_read_b32 v66, v64 offset:512
    v_cvt_pk_bf16_f32 v100, v123, v123
    v_add_f32 v121, v121, v123
L_vloop:
    s_nop 0
    v_and_b32_dpp v104, v100, v10 row_newbcast:0 row_mask:0xf bank_mask:0xf
    v_and_b32_dpp v105, v100, v11 row_newbcast:0 row_mask:0xf bank_mask:0xf
    v_and_b32_dpp v106, v100, v12 row_newbcast:0 row_mask:0xf bank_mask:0xf
    v_and_b32_dpp v107, v100, v13 row_newbcast:0 row_mask:0xf bank_mask:0xf
    s_waitcnt vmcnt(5)
    buffer_load_dwordx4 v[152:155], v62, s[64:67], s85 offen offset:1024 nt
    v_mfma_f32_16x16x32_bf16 v[116:119], v[128:131], v[104:107], v[116:119]
    v_and_b32_dpp v108, v100, v10 row_newbcast:4 row_mask:0xf bank_mask:0xf
    v_and_b32_dpp v109, v100, v11 row_newbcast:4 row_mask:0xf bank_mask:0xf
    v_and_b32_dpp v110, v100, v12 row_newbcast:4 row_mask:0xf bank_mask:0xf
    v_and_b32_dpp v111, v100, v13 row_newbcast:4 row_mask:0xf bank_mask:0xf
    s_waitcnt vmcnt(5)
    buffer_load_dwordx4 v[156:159], v63, s[64:67], s85 offen offset:1024 nt
    v_mfma_f32_16x16x32_bf16 v[116:119], v[132:135], v[108:111], v[116:119]
    s_add_u32 s87, s87, 7
    s_cmp_lg_u32 s97, 1
    s_cbranch_scc1 L_stayv_5
    s_mov_b64 s[64:65], s[52:53]
    v_mov_b32 v62, v76
    v_mov_b32 v63, v77
    s_mov_b64 exec, 1
    global_atomic_add v19, v9, v18, s[30:31] sc0 sc1
    s_mov_b64 exec, -1
    s_add_u32 s87, s33, 224
L_stayv_5:
    s_add_u32 s39, s87, s88
    s_bfe_u32 s37, s39, 0x30000
    s_lshl_b32 s37, s37, 12
    s_add_u32 s85, s37, s89
    s_bfe_u32 s37, s39, 0x10003
    s_lshl_b32 s37, s37, 11
    s_add_u32 s85, s37, s85
    s_bfe_u32 s37, s39, 0x40004
    s_lshl_b32 s37, s37, 16
    s_add_u32 s85, s37, s85
    s_waitcnt lgkmcnt(1)
    v_fma_f32 v123, v67, s83, -v120
    v_exp_f32 v123, v123
    ds_read_b32 v67, v64 offset:768
    v_cvt_pk_bf16_f32 v101, v123, v123
    v_add_f32 v121, v121, v123
    v_and_b32_dpp v104, v100, v10 row_newbcast:8 row_mask:0xf bank_mask:0xf
    v_and_b32_dpp v105, v100, v11 row_newbcast:8 row_mask:0xf bank_mask:0xf
    v_and_b32_dpp v106, v100, v12 row_newbcast:8 row_mask:0xf bank_mask:0xf
    v_and_b32_dpp v107, v100, v13 row_newbcast:8 row_mask:0xf bank_mask:0xf
    s_waitcnt vmcnt(5)
    buffer_load_dwordx4 v[128:131], v62, s[64:67], s85 offen offset:0 nt
    v_mfma_f32_16x16x32_bf16 v[116:119], v[136:139], v[104:107], v[116:119]
    v_and_b32_dpp v108, v100, v10 row_newbcast:12 row_mask:0xf bank_mask:0xf
    v_and_b32_dpp v109, v100, v11 row_newbcast:12 row_mask:0xf bank_mask:0xf
    v_and_b32_dpp v110, v100, v12 row_newbcast:12 row_mask:0xf bank_mask:0xf
    v_and_b32_dpp v111, v100, v13 row_newbcast:12 row_mask:0xf bank_mask:0xf
    s_waitcnt vmcnt(5)
    buffer_load_dwordx4 v[132:135], v63, s[64:67], s85 offen offset:0 nt
    v_mfma_f32_16x16x32_bf16 v[116:119], v[140:143], v[108:111], v[116:119]
    v_and_b32_dpp v104, v101, v10 row_newbcast:0 row_mask:0xf bank_mask:0xf
    v_and_b32_dpp v105, v101, v11 row_newbcast:0 row_mask:0xf bank_mask:0xf
    v_and_b32_dpp v106, v101, v12 row_newbcast:0 row_mask:0xf bank_mask:0xf
    v_and_b32_dpp v107, v101, v13 row_newbcast:0 row_mask:0xf bank_mask:0xf
    s_waitcnt vmcnt(5)
    buffer_load_dwordx4 v[136:139], v62, s[64:67], s85 offen offset:1024 nt
    v_mfma_f32_16x16x32_bf16 v[116:119], v[144:147], v[104:107], v[116:119]
    v_and_b32_dpp v108, v101, v10 row_newbcast:4 row_mask:0xf bank_mask:0xf
    v_and_b32_dpp v109, v101, v11 row_newbcast:4 row_mask:0xf bank_mask:0xf
    v_and_b32_dpp v110, v101, v12 row_newbcast:4 row_mask:0xf bank_mask:0xf
    v_and_b32_dpp v111, v101, v13 row_newbcast:4 row_mask:0xf bank_mask:0xf
    s_waitcnt vmcnt(5)
    buffer_load_dwordx4 v[140:143], v63, s[64:67], s85 offen offset:1024 nt
    v_mfma_f32_16x16x32_bf16 v[116:119], v[148:151], v[108:111], v[116:119]
    s_add_u32 s87, s87, 7
    s_cmp_lg_u32 s97, 1
    s_cbranch_scc1 L_stayv_6
    s_mov_b64 s[64:65], s[56:57]
    v_mov_b32 v62, v126
    v_mov_b32 v63, v127
    s_add_u32 s87, s33, 224
L_stayv_6:
    s_add_u32 s39, s87, s88
    s_bfe_u32 s37, s39, 0x30000
    s_lshl_b32 s37, s37, 12
    s_add_u32 s85, s37, s89
    s_bfe_u32 s37, s39, 0x10003
    s_lshl_b32 s37, s37, 11
    s_add_u32 s85, s37, s85
    s_bfe_u32 s37, s39, 0x40004
    s_lshl_b32 s37, s37, 16
    s_add_u32 s85, s37, s85
    v_add_u32 v64, 512, v64
    s_waitcnt lgkmcnt(1)
    v_fma_f32 v123, v66, s83, -v120
    v_exp_f32 v123, v123
    ds_read_b32 v66, v64 offset:512
    v_cvt_pk_bf16_f32 v100, v123, v123
    v_add_f32 v121, v121, v123
    v_and_b32_dpp v104, v101, v10 row_newbcast:8 row_mask:0xf bank_mask:0xf
    v_and_b32_dpp v105, v101, v11 row_newbcast:8 row_mask:0xf bank_mask:0xf
    v_and_b32_dpp v106, v101, v12 row_newbcast:8 row_mask:0xf bank_mask:0xf
    v_and_b32_dpp v107, v101, v13 row_newbcast:8 row_mask:0xf bank_mask:0xf
    s_waitcnt vmcnt(5)
    buffer_load_dwordx4 v[144:147], v62, s[64:67], s85 offen offset:0 nt
    v_mfma_f32_16x16x32_bf16 v[116:119], v[152:155], v[104:107], v[116:119]
    v_and_b32_dpp v108, v101, v10 row_newbcast:12 row_mask:0xf bank_mask:0xf
    v_and_b32_dpp v109, v101, v11 row_newbcast:12 row_mask:0xf bank_mask:0xf
    v_and_b32_dpp v110, v101, v12 row_newbcast:12 row_mask:0xf bank_mask:0xf
    v_and_b32_dpp v111, v101, v13 row_newbcast:12 row_mask:0xf bank_mask:0xf
    s_waitcnt vmcnt(5)
    buffer_load_dwordx4 v[148:151], v63, s[64:67], s85 offen offset:0 nt
    v_mfma_f32_16x16x32_bf16 v[116:119], v[156:159], v[108:111], v[116:119]
    s_sub_u32 s97, s97, 1
    s_cmp_lg_u32 s97, 0
    s_cbranch_scc1 L_vloop
    buffer_load_dwordx4 v[152:155], v126, s[56:59], s85 offen offset:1024 nt
    buffer_load_dwordx4 v[156:159], v127, s[56:59], s85 offen offset:1024 nt
L_dloop:
    s_waitcnt vmcnt(7)
    v_readfirstlane_b32 s93, v19
    s_nop 0
    s_sub_u32 s36, s93, 25
    s_and_b32 s38, s36, 3
    s_mul_i32 s38, s38, 7
    s_lshr_b32 s36, s36, 2
    s_add_u32 s87, s38, s36
    s_add_u32 s38, s93, 231
    s_cmp_lt_i32 s93, 25
    s_cselect_b32 s87, s38, s87
    s_add_u32 s93, s93, 8
    s_add_u32 s39, s87, s88
    s_bfe_u32 s37, s39, 0x30000
    s_lshl_b32 s37, s37, 12
    s_add_u32 s86, s37, s89
    s_bfe_u32 s37, s39, 0x10003
    s_lshl_b32 s37, s37, 11
    s_add_u32 s86, s37, s86
    s_bfe_u32 s37, s39, 0x40004
    s_lshl_b32 s37, s37, 16
    s_add_u32 s86, s37, s86
    s_cmp_ge_u32 s93, 33
    s_cselect_b32 s86, 134217728, s86
    v_mov_b32 v19, 25
    s_cmp_ge_u32 s93, 32
    s_cbranch_scc1 L_noclaim_7
    s_mov_b64 exec, 1
    global_atomic_add v19, v9, v18, s[30:31] sc0 sc1
    s_mov_b64 exec, -1
L_noclaim_7:
    buffer_load_dwordx4 v[160:163], v76, s[52:55], s86 offen offset:0 nt
    v_mfma_f32_16x16x32_bf16 v[112:115], v[128:131], v[80:83], 0
    s_waitcnt vmcnt(7)
    buffer_load_dwordx4 v[164:167], v77, s[52:55], s86 offen offset:0 nt
    v_mfma_f32_16x16x32_bf16 v[112:115], v[132:135], v[84:87], v[112:115]
    s_waitcnt vmcnt(7)
    buffer_load_dwordx4 v[168:171], v76, s[52:55], s86 offen offset:1024 nt
    v_mfma_f32_16x16x32_bf16 v[112:115], v[136:139], v[88:91], v[112:115]
    s_waitcnt vmcnt(7)
    buffer_load_dwordx4 v[172:175], v77, s[52:55], s86 offen offset:1024 nt
    v_mfma_f32_16x16x32_bf16 v[112:115], v[140:143], v[92:95], v[112:115]
    s_nop 7
    v_mov_b32_dpp v122, v112 quad_perm:[0,0,0,0] row_mask:0xf bank_mask:0xf
    v_mov_b32_dpp v124, v114 quad_perm:[2,2,2,2] row_mask:0xf bank_mask:0xf
    s_nop 0
    v_add_f32_dpp v122, v113, v122 quad_perm:[1,1,1,1] row_mask:0xf bank_mask:0xf
    v_add_f32_dpp v124, v115, v124 quad_perm:[3,3,3,3] row_mask:0xf bank_mask:0xf
    v_add_f32 v122, v122, v124
    v_fma_f32 v123, v122, s83, -v120
    v_cmp_lt_f32 vcc, 0, v123
    s_cbranch_vccz L_nomax_8
    v_mul_f32 v122, s83, v122
    s_nop 1
    v_max_f32_dpp v124, v122, v122 row_ror:4 row_mask:0xf bank_mask:0xf
    s_nop 1
    v_max_f32_dpp v124, v124, v124 row_ror:8 row_mask:0xf bank_mask:0xf
    v_mov_b32 v125, v124
    s_nop 1
    v_permlane16_swap_b32 v124, v125
    v_max_f32 v124, v124, v125
    v_mov_b32 v125, v124
    s_nop 1
    v_permlane32_swap_b32 v124, v125
    v_max_f32 v124, v124, v125
    v_and_b32 v124, s82, v124
    v_max_f32 v124, v124, v120
    v_sub_f32 v125, v120, v124
    v_exp_f32 v125, v125
    v_mov_b32 v120, v124
    v_sub_f32 v123, v122, v124
    v_mul_f32 v121, v121, v125
    v_mul_f32 v116, v116, v125
    v_mul_f32 v117, v117, v125
    v_mul_f32 v118, v118, v125
    v_mul_f32 v119, v119, v125
L_nomax_8:
    v_exp_f32 v123, v123
    s_nop 0
    v_cvt_pk_bf16_f32 v124, v123, v123
    v_add_f32 v121, v121, v123
    s_nop 0
    v_and_b32_dpp v96, v124, v10 row_newbcast:0 row_mask:0xf bank_mask:0xf
    v_and_b32_dpp v97, v124, v11 row_newbcast:0 row_mask:0xf bank_mask:0xf
    v_and_b32_dpp v98, v124, v12 row_newbcast:0 row_mask:0xf bank_mask:0xf
    v_and_b32_dpp v99, v124, v13 row_newbcast:0 row_mask:0xf bank_mask:0xf
    v_and_b32_dpp v100, v124, v10 row_newbcast:4 row_mask:0xf bank_mask:0xf
    v_and_b32_dpp v101, v124, v11 row_newbcast:4 row_mask:0xf bank_mask:0xf
    v_and_b32_dpp v102, v124, v12 row_newbcast:4 row_mask:0xf bank_mask:0xf
    v_and_b32_dpp v103, v124, v13 row_newbcast:4 row_mask:0xf bank_mask:0xf
    v_and_b32_dpp v104, v124, v10 row_newbcast:8 row_mask:0xf bank_mask:0xf
    v_and_b32_dpp v105, v124, v11 row_newbcast:8 row_mask:0xf bank_mask:0xf
    v_and_b32_dpp v106, v124, v12 row_newbcast:8 row_mask:0xf bank_mask:0xf
    v_and_b32_dpp v107, v124, v13 row_newbcast:8 row_mask:0xf bank_mask:0xf
    v_and_b32_dpp v108, v124, v10 row_newbcast:12 row_mask:0xf bank_mask:0xf
    v_and_b32_dpp v109, v124, v11 row_newbcast:12 row_mask:0xf bank_mask:0xf
    v_and_b32_dpp v110, v124, v12 row_newbcast:12 row_mask:0xf bank_mask:0xf
    v_and_b32_dpp v111, v124, v13 row_newbcast:12 row_mask:0xf bank_mask:0xf
    s_waitcnt vmcnt(7)
    buffer_load_dwordx4 v[176:179], v126, s[56:59], s86 offen offset:0 nt
    v_mfma_f32_16x16x32_bf16 v[116:119], v[144:147], v[96:99], v[116:119]
    s_waitcnt vmcnt(7)
    buffer_load_dwordx4 v[180:183], v127, s[56:59], s86 offen offset:0 nt
    v_mfma_f32_16x16x32_bf16 v[116:119], v[148:151], v[100:103], v[116:119]
    s_waitcnt vmcnt(7)
    buffer_load_dwordx4 v[184:187], v126, s[56:59], s86 offen offset:1024 nt
    v_mfma_f32_16x16x32_bf16 v[116:119], v[152:155], v[104:107], v[116:119]
    s_waitcnt vmcnt(7)
    buffer_load_dwordx4 v[188:191], v127, s[56:59], s86 offen offset:1024 nt
    v_mfma_f32_16x16x32_bf16 v[116:119], v[156:159], v[108:111], v[116:119]
    s_cmp_ge_u32 s93, 33
    s_cbranch_scc1 L_bdone
    s_waitcnt vmcnt(7)
    v_readfirstlane_b32 s93, v19
    s_nop 0
    s_sub_u32 s36, s93, 25
    s_and_b32 s38, s36, 3
    s_mul_i32 s38, s38, 7
    s_lshr_b32 s36, s36, 2
    s_add_u32 s87, s38, s36
    s_add_u32 s38, s93, 231
    s_cmp_lt_i32 s93, 25
    s_cselect_b32 s87, s38, s87
    s_add_u32 s93, s93, 8
    s_add_u32 s39, s87, s88
    s_bfe_u32 s37, s39, 0x30000
    s_lshl_b32 s37, s37, 12
    s_add_u32 s85, s37, s89
    s_bfe_u32 s37, s39, 0x10003
    s_lshl_b32 s37, s37, 11
    s_add_u32 s85, s37, s85
    s_bfe_u32 s37, s39, 0x40004
    s_lshl_b32 s37, s37, 16
    s_add_u32 s85, s37, s85
    s_cmp_ge_u32 s93, 33
    s_cselect_b32 s85, 134217728, s85
    v_mov_b32 v19, 25
    s_cmp_ge_u32 s93, 32
    s_cbranch_scc1 L_noclaim_9
    s_mov_b64 exec, 1
    global_atomic_add v19, v9, v18, s[30:31] sc0 sc1
    s_mov_b64 exec, -1
L_noclaim_9:
    buffer_load_dwordx4 v[128:131], v76, s[52:55], s85 offen offset:0 nt
    v_mfma_f32_16x16x32_bf16 v[112:115], v[160:163], v[80:83], 0
    s_waitcnt vmcnt(7)
    buffer_load_dwordx4 v[132:135], v77, s[52:55], s85 offen offset:0 nt
    v_mfma_f32_16x16x32_bf16 v[112:115], v[164:167], v[84:87], v[112:115]
    s_waitcnt vmcnt(7)
    buffer_load_dwordx4 v[136:139], v76, s[52:55], s85 offen offset:1024 nt
    v_mfma_f32_16x16x32_bf16 v[112:115], v[168:171], v[88:91], v[112:115]
    s_waitcnt vmcnt(7)
    buffer_load_dwordx4 v[140:143], v77, s[52:55], s85 offen offset:1024 nt
    v_mfma_f32_16x16x32_bf16 v[112:115], v[172:175], v[92:95], v[112:115]
    s_nop 7
    v_mov_b32_dpp v122, v112 quad_perm:[0,0,0,0] row_mask:0xf bank_mask:0xf
    v_mov_b32_dpp v124, v114 quad_perm:[2,2,2,2] row_mask:0xf bank_mask:0xf
    s_nop 0
    v_add_f32_dpp v122, v113, v122 quad_perm:[1,1,1,1] row_mask:0xf bank_mask:0xf
    v_add_f32_dpp v124, v115, v124 quad_perm:[3,3,3,3] row_mask:0xf bank_mask:0xf
    v_add_f32 v122, v122, v124
    v_fma_f32 v123, v122, s83, -v120
    v_cmp_lt_f32 vcc, 0, v123
    s_cbranch_vccz L_nomax_10
    v_mul_f32 v122, s83, v122
    s_nop 1
    v_max_f32_dpp v124, v122, v122 row_ror:4 row_mask:0xf bank_mask:0xf
    s_nop 1
    v_max_f32_dpp v124, v124, v124 row_ror:8 row_mask:0xf bank_mask:0xf
    v_mov_b32 v125, v124
    s_nop 1
    v_permlane16_swap_b32 v124, v125
    v_max_f32 v124, v124, v125
    v_mov_b32 v125, v124
    s_nop 1
    v_permlane32_swap_b32 v124, v125
    v_max_f32 v124, v124, v125
    v_and_b32 v124, s82, v124
    v_max_f32 v124, v124, v120
    v_sub_f32 v125, v120, v124
    v_exp_f32 v125, v125
    v_mov_b32 v120, v124
    v_sub_f32 v123, v122, v124
    v_mul_f32 v121, v121, v125
    v_mul_f32 v116, v116, v125
    v_mul_f32 v117, v117, v125
    v_mul_f32 v118, v118, v125
    v_mul_f32 v119, v119, v125
L_nomax_10:
    v_exp_f32 v123, v123
    s_nop 0
    v_cvt_pk_bf16_f32 v124, v123, v123
    v_add_f32 v121, v121, v123
    s_nop 0
    v_and_b32_dpp v96, v124, v10 row_newbcast:0 row_mask:0xf bank_mask:0xf
    v_and_b32_dpp v97, v124, v11 row_newbcast:0 row_mask:0xf bank_mask:0xf
    v_and_b32_dpp v98, v124, v12 row_newbcast:0 row_mask:0xf bank_mask:0xf
    v_and_b32_dpp v99, v124, v13 row_newbcast:0 row_mask:0xf bank_mask:0xf
    v_and_b32_dpp v100, v124, v10 row_newbcast:4 row_mask:0xf bank_mask:0xf
    v_and_b32_dpp v101, v124, v11 row_newbcast:4 row_mask:0xf bank_mask:0xf
    v_and_b32_dpp v102, v124, v12 row_newbcast:4 row_mask:0xf bank_mask:0xf
    v_and_b32_dpp v103, v124, v13 row_newbcast:4 row_mask:0xf bank_mask:0xf
    v_and_b32_dpp v104, v124, v10 row_newbcast:8 row_mask:0xf bank_mask:0xf
    v_and_b32_dpp v105, v124, v11 row_newbcast:8 row_mask:0xf bank_mask:0xf
    v_and_b32_dpp v106, v124, v12 row_newbcast:8 row_mask:0xf bank_mask:0xf
    v_and_b32_dpp v107, v124, v13 row_newbcast:8 row_mask:0xf bank_mask:0xf
    v_and_b32_dpp v108, v124, v10 row_newbcast:12 row_mask:0xf bank_mask:0xf
    v_and_b32_dpp v109, v124, v11 row_newbcast:12 row_mask:0xf bank_mask:0xf
    v_and_b32_dpp v110, v124, v12 row_newbcast:12 row_mask:0xf bank_mask:0xf
    v_and_b32_dpp v111, v124, v13 row_newbcast:12 row_mask:0xf bank_mask:0xf
    s_waitcnt vmcnt(7)
    buffer_load_dwordx4 v[144:147], v126, s[56:59], s85 offen offset:0 nt
    v_mfma_f32_16x16x32_bf16 v[116:119], v[176:179], v[96:99], v[116:119]
    s_waitcnt vmcnt(7)
    buffer_load_dwordx4 v[148:151], v127, s[56:59], s85 offen offset:0 nt
    v_mfma_f32_16x16x32_bf16 v[116:119], v[180:183], v[100:103], v[116:119]
    s_waitcnt vmcnt(7)
    buffer_load_dwordx4 v[152:155], v126, s[56:59], s85 offen offset:1024 nt
    v_mfma_f32_16x16x32_bf16 v[116:119], v[184:187], v[104:107], v[116:119]
    s_waitcnt vmcnt(7)
    buffer_load_dwordx4 v[156:159], v127, s[56:59], s85 offen offset:1024 nt
    v_mfma_f32_16x16x32_bf16 v[116:119], v[188:191], v[108:111], v[116:119]
    s_cmp_ge_u32 s93, 33
    s_cbranch_scc0 L_dloop
L_bdone:
    v_add_f32_dpp v121, v121, v121 row_ror:8 row_mask:0xf bank_mask:0xf
    s_nop 1
    v_add_f32_dpp v121, v121, v121 row_ror:4 row_mask:0xf bank_mask:0xf
    v_mov_b32 v125, v121
    s_nop 1
    v_permlane16_swap_b32 v121, v125
    v_add_f32 v121, v121, v125
    v_mov_b32 v125, v121
    v_and_or_b32 v118, v118, s82, v8
    v_and_or_b32 v119, v119, s82, v8
    v_permlane32_swap_b32 v121, v125
    s_mov_b32 exec_lo, 0x100
    s_mov_b32 exec_hi, 0x0
    v_add_f32 v117, v121, v125
    v_mov_b32 v116, v120
    s_mov_b32 exec_lo, 0xff01ff
    s_mov_b32 exec_hi, 0xff00ff
    v_and_or_b32 v116, v116, s82, v8
    v_and_or_b32 v117, v117, s82, v8
    buffer_store_dwordx4 v[116:119], v79, s[48:51], s96 offen sc1
    s_endpgm
L_qp:
    v_lshlrev_b32 v4, 18, v2
    v_lshl_add_u32 v14, v3, 4, v4
    v_lshrrev_b32 v5, 3, v3
    v_lshlrev_b32 v5, 10, v5
    v_lshl_add_u32 v15, v2, 6, v5
    s_cmp_eq_u32 s33, 0
    s_cselect_b32 s61, 3, 2
    s_xor_b32 s61, s61, s32
    s_lshl_b32 s86, s34, 8
    s_lshl_b32 s63, s34, 20
    s_lshl_b32 s38, s61, 8
    s_add_u32 s63, s63, s38
    s_mov_b32 s42, 4194304
    s_mov_b32 s43, 0x20000
    s_mov_b32 s46, 4096
    s_mov_b32 s47, 0x20000
    s_cmp_eq_u32 s33, 0
    s_waitcnt lgkmcnt(0)
    s_cselect_b64 s[40:41], s[22:23], s[8:9]
    s_cselect_b64 s[44:45], s[16:17], s[4:5]
    buffer_load_dwordx4 a[128:131], v14, s[40:43], s63 offen nt
    s_add_u32 s63, s63, 8192
    buffer_load_dwordx4 a[132:135], v14, s[40:43], s63 offen nt
    s_add_u32 s63, s63, 8192
    buffer_load_dwordx4 v[20:23], v15, s[44:47], s86 offen offset:0
    buffer_load_dwordx4 v[36:39], v15, s[44:47], s86 offen offset:2048
    buffer_load_dwordx4 a[136:139], v14, s[40:43], s63 offen nt
    s_add_u32 s63, s63, 8192
    buffer_load_dwordx4 a[140:143], v14, s[40:43], s63 offen nt
    s_add_u32 s63, s63, 8192
    buffer_load_dwordx4 a[144:147], v14, s[40:43], s63 offen nt
    s_add_u32 s63, s63, 8192
    buffer_load_dwordx4 a[148:151], v14, s[40:43], s63 offen nt
    s_add_u32 s63, s63, 8192
    buffer_load_dwordx4 a[152:155], v14, s[40:43], s63 offen nt
    s_add_u32 s63, s63, 8192
    buffer_load_dwordx4 a[156:159], v14, s[40:43], s63 offen nt
    s_add_u32 s63, s63, 8192
    s_getpc_b64 s[36:37]
L_pc_11:
    s_sub_u32 s36, s36, L_pc_11 - concat_heads__compressed_kv_cla__mha_block_cached__decode_kernel
    s_subb_u32 s37, s37, 0
    s_lshl_b32 s38, s32, 10
    v_lshl_add_u32 v6, v0, 2, s38
    v_mov_b32 v7, s37
    v_add_co_u32 v6, vcc, s36, v6
    s_nop 1
    v_addc_co_u32 v7, vcc, 0, v7, vcc
    global_load_dword v0, v[6:7], off
    s_load_dword s35, s[30:31], 0
    s_mov_b32 s48, s30
    s_and_b32 s49, s31, 0xffff
    s_mov_b32 s50, 8388608
    s_mov_b32 s51, 0x20000
    s_mov_b32 s82, 0xffffff00
    s_mov_b32 s83, 0x3e0293ee
    s_mov_b32 s84, 2097152
    v_and_b32 v4, 1, v1
    v_lshlrev_b32 v4, 4, v4
    v_mov_b32 v5, 0xffff
    v_lshlrev_b32 v4, v4, v5
    v_bfe_u32 v5, v1, 1, 2
    v_cmp_eq_u32 vcc, 0, v5
    s_nop 1
    v_cndmask_b32 v10, 0, v4, vcc
    v_cmp_eq_u32 vcc, 1, v5
    s_nop 1
    v_cndmask_b32 v11, 0, v4, vcc
    v_cmp_eq_u32 vcc, 2, v5
    s_nop 1
    v_cndmask_b32 v12, 0, v4, vcc
    v_cmp_eq_u32 vcc, 3, v5
    s_nop 1
    v_cndmask_b32 v13, 0, v4, vcc
    buffer_load_dwordx4 v[24:27], v15, s[44:47], s86 offen offset:16
    buffer_load_dwordx4 v[40:43], v15, s[44:47], s86 offen offset:2064
    buffer_load_dwordx4 v[28:31], v15, s[44:47], s86 offen offset:32
    buffer_load_dwordx4 v[44:47], v15, s[44:47], s86 offen offset:2080
    buffer_load_dwordx4 v[32:35], v15, s[44:47], s86 offen offset:48
    buffer_load_dwordx4 v[48:51], v15, s[44:47], s86 offen offset:2096
    s_lshl_b32 s38, s61, 2
    s_add_u32 s38, s38, s34
    s_lshl_b32 s38, s38, 8
    s_add_u32 s38, s38, 65536
    v_mov_b32 v19, 0
    s_cmp_eq_u32 s33, 0
    s_cselect_b32 s38, s38, 8388608
    s_mov_b64 exec, 1
    buffer_store_dword v19, v19, s[48:51], s38 offen sc1
    s_mov_b64 exec, -1
    s_mov_b32 s80, 0x01000100
    s_mov_b32 s81, 0x03020302
    s_waitcnt vmcnt(14)
    buffer_load_dwordx4 a[160:163], v14, s[40:43], s63 offen nt
    s_add_u32 s63, s63, 8192
    v_perm_b32 v4, v20, v20, s80
    v_perm_b32 v5, v36, v36, s80
    v_and_b32 v52, v4, v10
    v_and_b32 v53, v4, v11
    v_and_b32 v54, v4, v12
    v_and_b32 v55, v4, v13
    v_and_b32 v56, v5, v10
    v_and_b32 v57, v5, v11
    v_and_b32 v58, v5, v12
    v_and_b32 v59, v5, v13
    v_mfma_f32_16x16x32_bf16 v[60:63], a[128:131], v[52:55], 0
    s_nop 0
    v_mfma_f32_16x16x32_bf16 v[64:67], a[128:131], v[56:59], 0
    buffer_load_dwordx4 a[164:167], v14, s[40:43], s63 offen nt
    s_add_u32 s63, s63, 8192
    v_perm_b32 v4, v20, v20, s81
    v_perm_b32 v5, v36, v36, s81
    v_and_b32 v52, v4, v10
    v_and_b32 v53, v4, v11
    v_and_b32 v54, v4, v12
    v_and_b32 v55, v4, v13
    v_and_b32 v56, v5, v10
    v_and_b32 v57, v5, v11
    v_and_b32 v58, v5, v12
    v_and_b32 v59, v5, v13
    v_mfma_f32_16x16x32_bf16 v[60:63], a[132:135], v[52:55], v[60:63]
    s_nop 0
    v_mfma_f32_16x16x32_bf16 v[64:67], a[132:135], v[56:59], v[64:67]
    s_waitcnt vmcnt(15)
    buffer_load_dwordx4 a[168:171], v14, s[40:43], s63 offen nt
    s_add_u32 s63, s63, 8192
    v_perm_b32 v4, v21, v21, s80
    v_perm_b32 v5, v37, v37, s80
    v_and_b32 v52, v4, v10
    v_and_b32 v53, v4, v11
    v_and_b32 v54, v4, v12
    v_and_b32 v55, v4, v13
    v_and_b32 v56, v5, v10
    v_and_b32 v57, v5, v11
    v_and_b32 v58, v5, v12
    v_and_b32 v59, v5, v13
    v_mfma_f32_16x16x32_bf16 v[60:63], a[136:139], v[52:55], v[60:63]
    s_nop 0
    v_mfma_f32_16x16x32_bf16 v[64:67], a[136:139], v[56:59], v[64:67]
    s_waitcnt vmcnt(15)
    buffer_load_dwordx4 a[172:175], v14, s[40:43], s63 offen nt
    s_add_u32 s63, s63, 8192
    v_perm_b32 v4, v21, v21, s81
    v_perm_b32 v5, v37, v37, s81
    v_and_b32 v52, v4, v10
    v_and_b32 v53, v4, v11
    v_and_b32 v54, v4, v12
    v_and_b32 v55, v4, v13
    v_and_b32 v56, v5, v10
    v_and_b32 v57, v5, v11
    v_and_b32 v58, v5, v12
    v_and_b32 v59, v5, v13
    v_mfma_f32_16x16x32_bf16 v[60:63], a[140:143], v[52:55], v[60:63]
    s_nop 0
    v_mfma_f32_16x16x32_bf16 v[64:67], a[140:143], v[56:59], v[64:67]
    s_waitcnt vmcnt(15)
    buffer_load_dwordx4 a[176:179], v14, s[40:43], s63 offen nt
    s_add_u32 s63, s63, 8192
    v_lshrrev_b32 v4, 2, v3
    v_and_b32 v5, 3, v3
    v_lshlrev_b32 v76, 8, v4
    v_lshlrev_b32 v126, 8, v2
    v_lshl_add_u32 v76, v2, 6, v76
    v_lshl_add_u32 v76, v5, 4, v76
    v_lshl_add_u32 v126, v3, 4, v126
    v_xor_b32 v77, 32768, v76
    v_xor_b32 v127, 32768, v126
    s_add_u32 s3, s34, s33
    s_and_b32 s3, s3, 3
    s_lshl_b32 s89, s3, 5
    s_add_u32 s89, s89, s32
    s_lshl_b32 s89, s89, 20
    s_mul_i32 s88, s32, 8
    s_add_u32 s88, s88, s3
    s_add_u32 s87, s33, 0
    v_perm_b32 v4, v22, v22, s80
    v_perm_b32 v5, v38, v38, s80
    v_and_b32 v52, v4, v10
    v_and_b32 v53, v4, v11
    v_and_b32 v54, v4, v12
    v_and_b32 v55, v4, v13
    v_and_b32 v56, v5, v10
    v_and_b32 v57, v5, v11
    v_and_b32 v58, v5, v12
    v_and_b32 v59, v5, v13
    v_mfma_f32_16x16x32_bf16 v[60:63], a[144:147], v[52:55], v[60:63]
    s_nop 0
    v_mfma_f32_16x16x32_bf16 v[64:67], a[144:147], v[56:59], v[64:67]
    s_waitcnt vmcnt(15)
    buffer_load_dwordx4 a[180:183], v14, s[40:43], s63 offen nt
    s_add_u32 s63, s63, 8192
    v_perm_b32 v4, v22, v22, s81
    v_perm_b32 v5, v38, v38, s81
    v_and_b32 v52, v4, v10
    v_and_b32 v53, v4, v11
    v_and_b32 v54, v4, v12
    v_and_b32 v55, v4, v13
    v_and_b32 v56, v5, v10
    v_and_b32 v57, v5, v11
    v_and_b32 v58, v5, v12
    v_and_b32 v59, v5, v13
    v_mfma_f32_16x16x32_bf16 v[60:63], a[148:151], v[52:55], v[60:63]
    s_nop 0
    v_mfma_f32_16x16x32_bf16 v[64:67], a[148:151], v[56:59], v[64:67]
    s_waitcnt vmcnt(15)
    buffer_load_dwordx4 a[184:187], v14, s[40:43], s63 offen nt
    s_add_u32 s63, s63, 8192
    v_perm_b32 v4, v23, v23, s80
    v_perm_b32 v5, v39, v39, s80
    v_and_b32 v52, v4, v10
    v_and_b32 v53, v4, v11
    v_and_b32 v54, v4, v12
    v_and_b32 v55, v4, v13
    v_and_b32 v56, v5, v10
    v_and_b32 v57, v5, v11
    v_and_b32 v58, v5, v12
    v_and_b32 v59, v5, v13
    v_mfma_f32_16x16x32_bf16 v[60:63], a[152:155], v[52:55], v[60:63]
    s_nop 0
    v_mfma_f32_16x16x32_bf16 v[64:67], a[152:155], v[56:59], v[64:67]
    s_waitcnt vmcnt(15)
    buffer_load_dwordx4 a[188:191], v14, s[40:43], s63 offen nt
    s_add_u32 s63, s63, 8192
    v_perm_b32 v4, v23, v23, s81
    v_perm_b32 v5, v39, v39, s81
    v_and_b32 v52, v4, v10
    v_and_b32 v53, v4, v11
    v_and_b32 v54, v4, v12
    v_and_b32 v55, v4, v13
    v_and_b32 v56, v5, v10
    v_and_b32 v57, v5, v11
    v_and_b32 v58, v5, v12
    v_and_b32 v59, v5, v13
    v_mfma_f32_16x16x32_bf16 v[60:63], a[156:159], v[52:55], v[60:63]
    s_nop 0
    v_mfma_f32_16x16x32_bf16 v[64:67], a[156:159], v[56:59], v[64:67]
    s_waitcnt vmcnt(13)
    s_waitcnt vmcnt(7)
    buffer_load_dwordx4 a[192:195], v14, s[40:43], s63 offen nt
    s_add_u32 s63, s63, 8192
    s_mov_b32 s52, s18
    s_and_b32 s53, s19, 0xffff
    s_mov_b32 s54, 134217728
    s_mov_b32 s55, 0x20000
    s_mov_b32 s56, s20
    s_and_b32 s57, s21, 0xffff
    s_mov_b32 s58, 134217728
    s_mov_b32 s59, 0x20000
    v_perm_b32 v4, v24, v24, s80
    v_perm_b32 v5, v40, v40, s80
    v_and_b32 v52, v4, v10
    v_and_b32 v53, v4, v11
    v_and_b32 v54, v4, v12
    v_and_b32 v55, v4, v13
    v_and_b32 v56, v5, v10
    v_and_b32 v57, v5, v11
    v_and_b32 v58, v5, v12
    v_and_b32 v59, v5, v13
    v_mfma_f32_16x16x32_bf16 v[60:63], a[160:163], v[52:55], v[60:63]
    s_nop 0
    v_mfma_f32_16x16x32_bf16 v[64:67], a[160:163], v[56:59], v[64:67]
    s_waitcnt vmcnt(7)
    buffer_load_dwordx4 a[196:199], v14, s[40:43], s63 offen nt
    s_add_u32 s63, s63, 8192
    v_perm_b32 v4, v24, v24, s81
    v_perm_b32 v5, v40, v40, s81
    v_and_b32 v52, v4, v10
    v_and_b32 v53, v4, v11
    v_and_b32 v54, v4, v12
    v_and_b32 v55, v4, v13
    v_and_b32 v56, v5, v10
    v_and_b32 v57, v5, v11
    v_and_b32 v58, v5, v12
    v_and_b32 v59, v5, v13
    v_mfma_f32_16x16x32_bf16 v[60:63], a[164:167], v[52:55], v[60:63]
    s_nop 0
    v_mfma_f32_16x16x32_bf16 v[64:67], a[164:167], v[56:59], v[64:67]
    s_waitcnt vmcnt(7)
    buffer_load_dwordx4 a[200:203], v14, s[40:43], s63 offen nt
    s_add_u32 s63, s63, 8192
    v_perm_b32 v4, v25, v25, s80
    v_perm_b32 v5, v41, v41, s80
    v_and_b32 v52, v4, v10
    v_and_b32 v53, v4, v11
    v_and_b32 v54, v4, v12
    v_and_b32 v55, v4, v13
    v_and_b32 v56, v5, v10
    v_and_b32 v57, v5, v11
    v_and_b32 v58, v5, v12
    v_and_b32 v59, v5, v13
    v_mfma_f32_16x16x32_bf16 v[60:63], a[168:171], v[52:55], v[60:63]
    s_nop 0
    v_mfma_f32_16x16x32_bf16 v[64:67], a[168:171], v[56:59], v[64:67]
    s_waitcnt vmcnt(7)
    buffer_load_dwordx4 a[204:207], v14, s[40:43], s63 offen nt
    s_add_u32 s63, s63, 8192
    v_perm_b32 v4, v25, v25, s81
    v_perm_b32 v5, v41, v41, s81
    v_and_b32 v52, v4, v10
    v_and_b32 v53, v4, v11
    v_and_b32 v54, v4, v12
    v_and_b32 v55, v4, v13
    v_and_b32 v56, v5, v10
    v_and_b32 v57, v5, v11
    v_and_b32 v58, v5, v12
    v_and_b32 v59, v5, v13
    v_mfma_f32_16x16x32_bf16 v[60:63], a[172:175], v[52:55], v[60:63]
    s_nop 0
    v_mfma_f32_16x16x32_bf16 v[64:67], a[172:175], v[56:59], v[64:67]
    s_waitcnt vmcnt(7)
    buffer_load_dwordx4 a[208:211], v14, s[40:43], s63 offen nt
    s_add_u32 s63, s63, 8192
    v_mov_b32 v120, 0xff7f0000
    v_mov_b32 v121, 0
    v_mov_b32 v18, 1
    v_mov_b32 v116, 0
    v_mov_b32 v117, 0
    v_mov_b32 v118, 0
    v_mov_b32 v119, 0
    s_lshl_b32 s38, s32, 2
    s_add_u32 s38, s38, s3
    s_lshl_b32 s96, s38, 3
    s_lshl_b32 s38, s38, 8
    s_add_u32 s38, s38, 65536
    v_mov_b32 v9, s38
    s_add_u32 s96, s96, s33
    s_lshl_b32 s96, s96, 10
    s_add_u32 s96, s96, 5242880
    v_and_b32 v5, 3, v3
    v_lshlrev_b32 v78, 7, v2
    v_lshl_add_u32 v78, v5, 5, v78
    s_lshl_b32 s91, s32, 12
    s_lshl_b32 s38, s3, 9
    s_add_u32 s91, s91, s38
    s_add_u32 s91, s91, 1048576
    v_lshlrev_b32 v4, 7, v2
    v_lshl_add_u32 v4, v3, 4, v4
    v_mov_b32 v5, 512
    v_cmp_gt_u32 vcc, 8, v3
    s_nop 1
    v_cndmask_b32 v79, v5, v4, vcc
    v_perm_b32 v4, v26, v26, s80
    v_perm_b32 v5, v42, v42, s80
    v_and_b32 v52, v4, v10
    v_and_b32 v53, v4, v11
    v_and_b32 v54, v4, v12
    v_and_b32 v55, v4, v13
    v_and_b32 v56, v5, v10
    v_and_b32 v57, v5, v11
    v_and_b32 v58, v5, v12
    v_and_b32 v59, v5, v13
    v_mfma_f32_16x16x32_bf16 v[60:63], a[176:179], v[52:55], v[60:63]
    s_nop 0
    v_mfma_f32_16x16x32_bf16 v[64:67], a[176:179], v[56:59], v[64:67]
    s_waitcnt vmcnt(7)
    buffer_load_dwordx4 a[212:215], v14, s[40:43], s63 offen nt
    s_add_u32 s63, s63, 8192
    v_perm_b32 v4, v26, v26, s81
    v_perm_b32 v5, v42, v42, s81
    v_and_b32 v52, v4, v10
    v_and_b32 v53, v4, v11
    v_and_b32 v54, v4, v12
    v_and_b32 v55, v4, v13
    v_and_b32 v56, v5, v10
    v_and_b32 v57, v5, v11
    v_and_b32 v58, v5, v12
    v_and_b32 v59, v5, v13
    v_mfma_f32_16x16x32_bf16 v[60:63], a[180:183], v[52:55], v[60:63]
    s_nop 0
    v_mfma_f32_16x16x32_bf16 v[64:67], a[180:183], v[56:59], v[64:67]
    s_waitcnt vmcnt(7)
    buffer_load_dwordx4 a[216:219], v14, s[40:43], s63 offen nt
    s_add_u32 s63, s63, 8192
    v_perm_b32 v4, v27, v27, s80
    v_perm_b32 v5, v43, v43, s80
    v_and_b32 v52, v4, v10
    v_and_b32 v53, v4, v11
    v_and_b32 v54, v4, v12
    v_and_b32 v55, v4, v13
    v_and_b32 v56, v5, v10
    v_and_b32 v57, v5, v11
    v_and_b32 v58, v5, v12
    v_and_b32 v59, v5, v13
    v_mfma_f32_16x16x32_bf16 v[60:63], a[184:187], v[52:55], v[60:63]
    s_nop 0
    v_mfma_f32_16x16x32_bf16 v[64:67], a[184:187], v[56:59], v[64:67]
    s_waitcnt vmcnt(7)
    buffer_load_dwordx4 a[220:223], v14, s[40:43], s63 offen nt
    s_add_u32 s63, s63, 8192
    v_perm_b32 v4, v27, v27, s81
    v_perm_b32 v5, v43, v43, s81
    v_and_b32 v52, v4, v10
    v_and_b32 v53, v4, v11
    v_and_b32 v54, v4, v12
    v_and_b32 v55, v4, v13
    v_and_b32 v56, v5, v10
    v_and_b32 v57, v5, v11
    v_and_b32 v58, v5, v12
    v_and_b32 v59, v5, v13
    v_mfma_f32_16x16x32_bf16 v[60:63], a[188:191], v[52:55], v[60:63]
    s_nop 0
    v_mfma_f32_16x16x32_bf16 v[64:67], a[188:191], v[56:59], v[64:67]
    s_waitcnt vmcnt(7)
    buffer_load_dwordx4 a[224:227], v14, s[40:43], s63 offen nt
    s_add_u32 s63, s63, 8192
    v_perm_b32 v4, v28, v28, s80
    v_perm_b32 v5, v44, v44, s80
    v_and_b32 v52, v4, v10
    v_and_b32 v53, v4, v11
    v_and_b32 v54, v4, v12
    v_and_b32 v55, v4, v13
    v_and_b32 v56, v5, v10
    v_and_b32 v57, v5, v11
    v_and_b32 v58, v5, v12
    v_and_b32 v59, v5, v13
    v_mfma_f32_16x16x32_bf16 v[60:63], a[192:195], v[52:55], v[60:63]
    s_nop 0
    v_mfma_f32_16x16x32_bf16 v[64:67], a[192:195], v[56:59], v[64:67]
    s_waitcnt vmcnt(7)
    buffer_load_dwordx4 a[228:231], v14, s[40:43], s63 offen nt
    s_add_u32 s63, s63, 8192
    v_perm_b32 v4, v28, v28, s81
    v_perm_b32 v5, v44, v44, s81
    v_and_b32 v52, v4, v10
    v_and_b32 v53, v4, v11
    v_and_b32 v54, v4, v12
    v_and_b32 v55, v4, v13
    v_and_b32 v56, v5, v10
    v_and_b32 v57, v5, v11
    v_and_b32 v58, v5, v12
    v_and_b32 v59, v5, v13
    v_mfma_f32_16x16x32_bf16 v[60:63], a[196:199], v[52:55], v[60:63]
    s_nop 0
    v_mfma_f32_16x16x32_bf16 v[64:67], a[196:199], v[56:59], v[64:67]
    s_waitcnt vmcnt(7)
    buffer_load_dwordx4 a[232:235], v14, s[40:43], s63 offen nt
    s_add_u32 s63, s63, 8192
    v_perm_b32 v4, v29, v29, s80
    v_perm_b32 v5, v45, v45, s80
    v_and_b32 v52, v4, v10
    v_and_b32 v53, v4, v11
    v_and_b32 v54, v4, v12
    v_and_b32 v55, v4, v13
    v_and_b32 v56, v5, v10
    v_and_b32 v57, v5, v11
    v_and_b32 v58, v5, v12
    v_and_b32 v59, v5, v13
    v_mfma_f32_16x16x32_bf16 v[60:63], a[200:203], v[52:55], v[60:63]
    s_nop 0
    v_mfma_f32_16x16x32_bf16 v[64:67], a[200:203], v[56:59], v[64:67]
    s_waitcnt vmcnt(7)
    buffer_load_dwordx4 a[236:239], v14, s[40:43], s63 offen nt
    s_add_u32 s63, s63, 8192
    v_perm_b32 v4, v29, v29, s81
    v_perm_b32 v5, v45, v45, s81
    v_and_b32 v52, v4, v10
    v_and_b32 v53, v4, v11
    v_and_b32 v54, v4, v12
    v_and_b32 v55, v4, v13
    v_and_b32 v56, v5, v10
    v_and_b32 v57, v5, v11
    v_and_b32 v58, v5, v12
    v_and_b32 v59, v5, v13
    v_mfma_f32_16x16x32_bf16 v[60:63], a[204:207], v[52:55], v[60:63]
    s_nop 0
    v_mfma_f32_16x16x32_bf16 v[64:67], a[204:207], v[56:59], v[64:67]
    s_waitcnt vmcnt(7)
    buffer_load_dwordx4 a[240:243], v14, s[40:43], s63 offen nt
    s_add_u32 s63, s63, 8192
    v_perm_b32 v4, v30, v30, s80
    v_perm_b32 v5, v46, v46, s80
    v_and_b32 v52, v4, v10
    v_and_b32 v53, v4, v11
    v_and_b32 v54, v4, v12
    v_and_b32 v55, v4, v13
    v_and_b32 v56, v5, v10
    v_and_b32 v57, v5, v11
    v_and_b32 v58, v5, v12
    v_and_b32 v59, v5, v13
    v_mfma_f32_16x16x32_bf16 v[60:63], a[208:211], v[52:55], v[60:63]
    s_nop 0
    v_mfma_f32_16x16x32_bf16 v[64:67], a[208:211], v[56:59], v[64:67]
    s_waitcnt vmcnt(7)
    buffer_load_dwordx4 a[244:247], v14, s[40:43], s63 offen nt
    s_add_u32 s63, s63, 8192
    v_perm_b32 v4, v30, v30, s81
    v_perm_b32 v5, v46, v46, s81
    v_and_b32 v52, v4, v10
    v_and_b32 v53, v4, v11
    v_and_b32 v54, v4, v12
    v_and_b32 v55, v4, v13
    v_and_b32 v56, v5, v10
    v_and_b32 v57, v5, v11
    v_and_b32 v58, v5, v12
    v_and_b32 v59, v5, v13
    v_mfma_f32_16x16x32_bf16 v[60:63], a[212:215], v[52:55], v[60:63]
    s_nop 0
    v_mfma_f32_16x16x32_bf16 v[64:67], a[212:215], v[56:59], v[64:67]
    s_waitcnt vmcnt(7)
    buffer_load_dwordx4 a[248:251], v14, s[40:43], s63 offen nt
    s_add_u32 s63, s63, 8192
    v_perm_b32 v4, v31, v31, s80
    v_perm_b32 v5, v47, v47, s80
    v_and_b32 v52, v4, v10
    v_and_b32 v53, v4, v11
    v_and_b32 v54, v4, v12
    v_and_b32 v55, v4, v13
    v_and_b32 v56, v5, v10
    v_and_b32 v57, v5, v11
    v_and_b32 v58, v5, v12
    v_and_b32 v59, v5, v13
    v_mfma_f32_16x16x32_bf16 v[60:63], a[216:219], v[52:55], v[60:63]
    s_nop 0
    v_mfma_f32_16x16x32_bf16 v[64:67], a[216:219], v[56:59], v[64:67]
    s_waitcnt vmcnt(7)
    buffer_load_dwordx4 a[252:255], v14, s[40:43], s63 offen nt
    s_add_u32 s63, s63, 8192
    v_perm_b32 v4, v31, v31, s81
    v_perm_b32 v5, v47, v47, s81
    v_and_b32 v52, v4, v10
    v_and_b32 v53, v4, v11
    v_and_b32 v54, v4, v12
    v_and_b32 v55, v4, v13
    v_and_b32 v56, v5, v10
    v_and_b32 v57, v5, v11
    v_and_b32 v58, v5, v12
    v_and_b32 v59, v5, v13
    v_mfma_f32_16x16x32_bf16 v[60:63], a[220:223], v[52:55], v[60:63]
    s_nop 0
    v_mfma_f32_16x16x32_bf16 v[64:67], a[220:223], v[56:59], v[64:67]
    s_waitcnt vmcnt(7)
    v_perm_b32 v4, v32, v32, s80
    v_perm_b32 v5, v48, v48, s80
    v_and_b32 v52, v4, v10
    v_and_b32 v53, v4, v11
    v_and_b32 v54, v4, v12
    v_and_b32 v55, v4, v13
    v_and_b32 v56, v5, v10
    v_and_b32 v57, v5, v11
    v_and_b32 v58, v5, v12
    v_and_b32 v59, v5, v13
    v_mfma_f32_16x16x32_bf16 v[60:63], a[224:227], v[52:55], v[60:63]
    s_nop 0
    v_mfma_f32_16x16x32_bf16 v[64:67], a[224:227], v[56:59], v[64:67]
    s_waitcnt vmcnt(6)
    s_add_u32 s39, s87, s88
    s_bfe_u32 s37, s39, 0x30000
    s_lshl_b32 s37, s37, 12
    s_add_u32 s85, s37, s89
    s_bfe_u32 s37, s39, 0x10003
    s_lshl_b32 s37, s37, 11
    s_add_u32 s85, s37, s85
    s_bfe_u32 s37, s39, 0x40004
    s_lshl_b32 s37, s37, 16
    s_add_u32 s85, s37, s85
    buffer_load_dwordx4 v[128:131], v76, s[52:55], s85 offen offset:0 nt
    v_perm_b32 v4, v32, v32, s81
    v_perm_b32 v5, v48, v48, s81
    v_and_b32 v52, v4, v10
    v_and_b32 v53, v4, v11
    v_and_b32 v54, v4, v12
    v_and_b32 v55, v4, v13
    v_and_b32 v56, v5, v10
    v_and_b32 v57, v5, v11
    v_and_b32 v58, v5, v12
    v_and_b32 v59, v5, v13
    v_mfma_f32_16x16x32_bf16 v[60:63], a[228:231], v[52:55], v[60:63]
    s_nop 0
    v_mfma_f32_16x16x32_bf16 v[64:67], a[228:231], v[56:59], v[64:67]
    s_waitcnt vmcnt(6)
    buffer_load_dwordx4 v[132:135], v77, s[52:55], s85 offen offset:0 nt
    v_perm_b32 v4, v33, v33, s80
    v_perm_b32 v5, v49, v49, s80
    v_and_b32 v52, v4, v10
    v_and_b32 v53, v4, v11
    v_and_b32 v54, v4, v12
    v_and_b32 v55, v4, v13
    v_and_b32 v56, v5, v10
    v_and_b32 v57, v5, v11
    v_and_b32 v58, v5, v12
    v_and_b32 v59, v5, v13
    v_mfma_f32_16x16x32_bf16 v[60:63], a[232:235], v[52:55], v[60:63]
    s_nop 0
    v_mfma_f32_16x16x32_bf16 v[64:67], a[232:235], v[56:59], v[64:67]
    s_waitcnt vmcnt(6)
    buffer_load_dwordx4 v[136:139], v76, s[52:55], s85 offen offset:1024 nt
    v_perm_b32 v4, v33, v33, s81
    v_perm_b32 v5, v49, v49, s81
    v_and_b32 v52, v4, v10
    v_and_b32 v53, v4, v11
    v_and_b32 v54, v4, v12
    v_and_b32 v55, v4, v13
    v_and_b32 v56, v5, v10
    v_and_b32 v57, v5, v11
    v_and_b32 v58, v5, v12
    v_and_b32 v59, v5, v13
    v_mfma_f32_16x16x32_bf16 v[60:63], a[236:239], v[52:55], v[60:63]
    s_nop 0
    v_mfma_f32_16x16x32_bf16 v[64:67], a[236:239], v[56:59], v[64:67]
    s_waitcnt vmcnt(6)
    buffer_load_dwordx4 v[140:143], v77, s[52:55], s85 offen offset:1024 nt
    s_add_u32 s87, s87, 7
    s_add_u32 s39, s87, s88
    s_bfe_u32 s37, s39, 0x30000
    s_lshl_b32 s37, s37, 12
    s_add_u32 s85, s37, s89
    s_bfe_u32 s37, s39, 0x10003
    s_lshl_b32 s37, s37, 11
    s_add_u32 s85, s37, s85
    s_bfe_u32 s37, s39, 0x40004
    s_lshl_b32 s37, s37, 16
    s_add_u32 s85, s37, s85
    v_perm_b32 v4, v34, v34, s80
    v_perm_b32 v5, v50, v50, s80
    v_and_b32 v52, v4, v10
    v_and_b32 v53, v4, v11
    v_and_b32 v54, v4, v12
    v_and_b32 v55, v4, v13
    v_and_b32 v56, v5, v10
    v_and_b32 v57, v5, v11
    v_and_b32 v58, v5, v12
    v_and_b32 v59, v5, v13
    v_mfma_f32_16x16x32_bf16 v[60:63], a[240:243], v[52:55], v[60:63]
    s_nop 0
    v_mfma_f32_16x16x32_bf16 v[64:67], a[240:243], v[56:59], v[64:67]
    s_waitcnt vmcnt(6)
    buffer_load_dwordx4 v[144:147], v76, s[52:55], s85 offen offset:0 nt
    v_perm_b32 v4, v34, v34, s81
    v_perm_b32 v5, v50, v50, s81
    v_and_b32 v52, v4, v10
    v_and_b32 v53, v4, v11
    v_and_b32 v54, v4, v12
    v_and_b32 v55, v4, v13
    v_and_b32 v56, v5, v10
    v_and_b32 v57, v5, v11
    v_and_b32 v58, v5, v12
    v_and_b32 v59, v5, v13
    v_mfma_f32_16x16x32_bf16 v[60:63], a[244:247], v[52:55], v[60:63]
    s_nop 0
    v_mfma_f32_16x16x32_bf16 v[64:67], a[244:247], v[56:59], v[64:67]
    s_waitcnt vmcnt(6)
    buffer_load_dwordx4 v[148:151], v77, s[52:55], s85 offen offset:0 nt
    v_perm_b32 v4, v35, v35, s80
    v_perm_b32 v5, v51, v51, s80
    v_and_b32 v52, v4, v10
    v_and_b32 v53, v4, v11
    v_and_b32 v54, v4, v12
    v_and_b32 v55, v4, v13
    v_and_b32 v56, v5, v10
    v_and_b32 v57, v5, v11
    v_and_b32 v58, v5, v12
    v_and_b32 v59, v5, v13
    v_mfma_f32_16x16x32_bf16 v[60:63], a[248:251], v[52:55], v[60:63]
    s_nop 0
    v_mfma_f32_16x16x32_bf16 v[64:67], a[248:251], v[56:59], v[64:67]
    s_waitcnt vmcnt(6)
    buffer_load_dwordx4 v[152:155], v76, s[52:55], s85 offen offset:1024 nt
    v_perm_b32 v4, v35, v35, s81
    v_perm_b32 v5, v51, v51, s81
    v_and_b32 v52, v4, v10
    v_and_b32 v53, v4, v11
    v_and_b32 v54, v4, v12
    v_and_b32 v55, v4, v13
    v_and_b32 v56, v5, v10
    v_and_b32 v57, v5, v11
    v_and_b32 v58, v5, v12
    v_and_b32 v59, v5, v13
    v_mfma_f32_16x16x32_bf16 v[60:63], a[252:255], v[52:55], v[60:63]
    s_nop 0
    v_mfma_f32_16x16x32_bf16 v[64:67], a[252:255], v[56:59], v[64:67]
    s_lshl_b32 s38, s34, 11
    v_lshrrev_b32 v4, 3, v3
    v_lshlrev_b32 v4, 9, v4
    v_lshl_add_u32 v4, v2, 7, v4
    v_and_b32 v5, 7, v3
    v_lshl_add_u32 v4, v5, 2, v4
    v_add_u32 v4, s38, v4
    ds_write_b32 v4, v60 offset:0
    ds_write_b32 v4, v61 offset:32
    ds_write_b32 v4, v62 offset:64
    ds_write_b32 v4, v63 offset:96
    ds_write_b32 v4, v64 offset:1024
    ds_write_b32 v4, v65 offset:1056
    ds_write_b32 v4, v66 offset:1088
    ds_write_b32 v4, v67 offset:1120
    s_lshl_b32 s38, s34, 9
    v_and_b32 v5, 31, v1
    v_lshl_add_u32 v5, v5, 4, s38
    s_waitcnt lgkmcnt(0)
    s_add_u32 s35, s35, 0x5b
    s_and_b32 s35, s35, 0xff
    v_mov_b32 v8, s35
    s_barrier
    ds_read_b128 v[20:23], v5 offset:0
    ds_read_b128 v[24:27], v5 offset:2048
    ds_read_b128 v[28:31], v5 offset:4096
    ds_read_b128 v[32:35], v5 offset:6144
    s_lshl_b32 s38, s61, 1
    s_add_u32 s38, s38, s33
    s_lshl_b32 s38, s38, 11
    s_add_u32 s38, s38, 1048576
    s_waitcnt lgkmcnt(0)
    v_add_f32 v20, v20, v24
    v_add_f32 v28, v28, v32
    v_add_f32 v21, v21, v25
    v_add_f32 v29, v29, v33
    v_add_f32 v22, v22, v26
    v_add_f32 v30, v30, v34
    v_add_f32 v23, v23, v27
    v_add_f32 v31, v31, v35
    v_add_f32 v20, v20, v28
    v_add_f32 v21, v21, v29
    v_add_f32 v22, v22, v30
    v_add_f32 v23, v23, v31
    v_and_or_b32 v20, v20, s82, v8
    v_and_or_b32 v21, v21, s82, v8
    v_and_or_b32 v22, v22, s82, v8
    v_and_or_b32 v23, v23, s82, v8
    s_mov_b32 exec_lo, 0xffffffff
    s_mov_b32 exec_hi, 0x0
    buffer_store_dwordx4 v[20:23], v5, s[48:51], s38 offen sc1
    s_mov_b64 exec, -1
    s_waitcnt vmcnt(7)
    buffer_load_dwordx4 v[156:159], v77, s[52:55], s85 offen offset:1024 nt
    s_add_u32 s87, s87, 7
    s_add_u32 s39, s87, s88
    s_bfe_u32 s37, s39, 0x30000
    s_lshl_b32 s37, s37, 12
    s_add_u32 s85, s37, s89
    s_bfe_u32 s37, s39, 0x10003
    s_lshl_b32 s37, s37, 11
    s_add_u32 s85, s37, s85
    s_bfe_u32 s37, s39, 0x40004
    s_lshl_b32 s37, s37, 16
    s_add_u32 s85, s37, s85
    s_waitcnt vmcnt(7)
    buffer_load_dwordx4 v[160:163], v76, s[52:55], s85 offen offset:0 nt
    s_waitcnt vmcnt(7)
    buffer_load_dwordx4 v[164:167], v77, s[52:55], s85 offen offset:0 nt
    s_waitcnt vmcnt(7)
    buffer_load_dwordx4 v[168:171], v76, s[52:55], s85 offen offset:1024 nt
    s_waitcnt vmcnt(7)
    buffer_load_dwordx4 v[172:175], v77, s[52:55], s85 offen offset:1024 nt
    s_add_u32 s87, s87, 7
    s_add_u32 s39, s87, s88
    s_bfe_u32 s37, s39, 0x30000
    s_lshl_b32 s37, s37, 12
    s_add_u32 s85, s37, s89
    s_bfe_u32 s37, s39, 0x10003
    s_lshl_b32 s37, s37, 11
    s_add_u32 s85, s37, s85
    s_bfe_u32 s37, s39, 0x40004
    s_lshl_b32 s37, s37, 16
    s_add_u32 s85, s37, s85
    s_waitcnt vmcnt(7)
    buffer_load_dwordx4 v[176:179], v76, s[52:55], s85 offen offset:0 nt
    s_waitcnt vmcnt(7)
    buffer_load_dwordx4 v[180:183], v77, s[52:55], s85 offen offset:0 nt
    s_waitcnt vmcnt(6)
    buffer_load_dwordx4 v[184:187], v76, s[52:55], s85 offen offset:1024 nt
    s_waitcnt vmcnt(6)
    buffer_load_dwordx4 v[188:191], v77, s[52:55], s85 offen offset:1024 nt
    s_add_u32 s87, s87, 7
    s_add_u32 s39, s87, s88
    s_bfe_u32 s37, s39, 0x30000
    s_lshl_b32 s37, s37, 12
    s_add_u32 s85, s37, s89
    s_bfe_u32 s37, s39, 0x10003
    s_lshl_b32 s37, s37, 11
    s_add_u32 s85, s37, s85
    s_bfe_u32 s37, s39, 0x40004
    s_lshl_b32 s37, s37, 16
    s_add_u32 s85, s37, s85
    s_waitcnt vmcnt(6)
    buffer_load_dwordx4 v[192:195], v76, s[52:55], s85 offen offset:0 nt
    s_waitcnt vmcnt(6)
    buffer_load_dwordx4 v[196:199], v77, s[52:55], s85 offen offset:0 nt
    s_waitcnt vmcnt(6)
    buffer_load_dwordx4 v[200:203], v76, s[52:55], s85 offen offset:1024 nt
    s_waitcnt vmcnt(6)
    buffer_load_dwordx4 v[204:207], v77, s[52:55], s85 offen offset:1024 nt
    s_add_u32 s87, s87, 7
    s_add_u32 s39, s87, s88
    s_bfe_u32 s37, s39, 0x30000
    s_lshl_b32 s37, s37, 12
    s_add_u32 s85, s37, s89
    s_bfe_u32 s37, s39, 0x10003
    s_lshl_b32 s37, s37, 11
    s_add_u32 s85, s37, s85
    s_bfe_u32 s37, s39, 0x40004
    s_lshl_b32 s37, s37, 16
    s_add_u32 s85, s37, s85
    s_waitcnt vmcnt(6)
    buffer_load_dwordx4 v[208:211], v76, s[52:55], s85 offen offset:0 nt
    s_waitcnt vmcnt(6)
    buffer_load_dwordx4 v[212:215], v77, s[52:55], s85 offen offset:0 nt
    s_waitcnt vmcnt(6)
    buffer_load_dwordx4 v[216:219], v76, s[52:55], s85 offen offset:1024 nt
    s_waitcnt vmcnt(6)
    buffer_load_dwordx4 v[220:223], v77, s[52:55], s85 offen offset:1024 nt
    s_add_u32 s87, s87, 7
    s_add_u32 s39, s87, s88
    s_bfe_u32 s37, s39, 0x30000
    s_lshl_b32 s37, s37, 12
    s_add_u32 s85, s37, s89
    s_bfe_u32 s37, s39, 0x10003
    s_lshl_b32 s37, s37, 11
    s_add_u32 s85, s37, s85
    s_bfe_u32 s37, s39, 0x40004
    s_lshl_b32 s37, s37, 16
    s_add_u32 s85, s37, s85
    s_waitcnt vmcnt(6)
    buffer_load_dwordx4 v[224:227], v76, s[52:55], s85 offen offset:0 nt
    s_waitcnt vmcnt(6)
    buffer_load_dwordx4 v[228:231], v77, s[52:55], s85 offen offset:0 nt
    s_waitcnt vmcnt(6)
    buffer_load_dwordx4 v[232:235], v76, s[52:55], s85 offen offset:1024 nt
    s_waitcnt vmcnt(6)
    buffer_load_dwordx4 v[236:239], v77, s[52:55], s85 offen offset:1024 nt
    s_add_u32 s87, s87, 7
    s_add_u32 s39, s87, s88
    s_bfe_u32 s37, s39, 0x30000
    s_lshl_b32 s37, s37, 12
    s_add_u32 s85, s37, s89
    s_bfe_u32 s37, s39, 0x10003
    s_lshl_b32 s37, s37, 11
    s_add_u32 s85, s37, s85
    s_bfe_u32 s37, s39, 0x40004
    s_lshl_b32 s37, s37, 16
    s_add_u32 s85, s37, s85
    s_waitcnt vmcnt(6)
    buffer_load_dwordx4 v[240:243], v76, s[52:55], s85 offen offset:0 nt
    s_waitcnt vmcnt(6)
    buffer_load_dwordx4 v[244:247], v77, s[52:55], s85 offen offset:0 nt
    s_waitcnt vmcnt(6)
    buffer_load_dwordx4 v[248:251], v76, s[52:55], s85 offen offset:1024 nt
    s_waitcnt vmcnt(6)
    buffer_load_dwordx4 v[252:255], v77, s[52:55], s85 offen offset:1024 nt
    s_add_u32 s87, s87, 7
    s_add_u32 s39, s87, s88
    s_bfe_u32 s37, s39, 0x30000
    s_lshl_b32 s37, s37, 12
    s_add_u32 s85, s37, s89
    s_bfe_u32 s37, s39, 0x10003
    s_lshl_b32 s37, s37, 11
    s_add_u32 s85, s37, s85
    s_bfe_u32 s37, s39, 0x40004
    s_lshl_b32 s37, s37, 16
    s_add_u32 s85, s37, s85
    s_waitcnt vmcnt(6)
    buffer_load_dwordx4 a[0:3], v76, s[52:55], s85 offen offset:0 nt
    s_waitcnt vmcnt(6)
    buffer_load_dwordx4 a[4:7], v77, s[52:55], s85 offen offset:0 nt
    buffer_load_dwordx4 v[68:71], v78, s[48:51], s91 offen offset:0 sc1
    buffer_load_dwordx4 v[72:75], v78, s[48:51], s91 offen offset:16 sc1
    s_waitcnt vmcnt(8)
    buffer_load_dwordx4 a[8:11], v76, s[52:55], s85 offen offset:1024 nt
    s_waitcnt vmcnt(8)
    buffer_load_dwordx4 a[12:15], v77, s[52:55], s85 offen offset:1024 nt
    s_add_u32 s87, s87, 7
    s_add_u32 s39, s87, s88
    s_bfe_u32 s37, s39, 0x30000
    s_lshl_b32 s37, s37, 12
    s_add_u32 s85, s37, s89
    s_bfe_u32 s37, s39, 0x10003
    s_lshl_b32 s37, s37, 11
    s_add_u32 s85, s37, s85
    s_bfe_u32 s37, s39, 0x40004
    s_lshl_b32 s37, s37, 16
    s_add_u32 s85, s37, s85
    s_waitcnt vmcnt(8)
    buffer_load_dwordx4 a[16:19], v76, s[52:55], s85 offen offset:0 nt
    s_waitcnt vmcnt(8)
    buffer_load_dwordx4 a[20:23], v77, s[52:55], s85 offen offset:0 nt
    s_waitcnt vmcnt(8)
    buffer_load_dwordx4 a[24:27], v76, s[52:55], s85 offen offset:1024 nt
    s_waitcnt vmcnt(8)
    buffer_load_dwordx4 a[28:31], v77, s[52:55], s85 offen offset:1024 nt
    s_add_u32 s87, s87, 7
    s_add_u32 s39, s87, s88
    s_bfe_u32 s37, s39, 0x30000
    s_lshl_b32 s37, s37, 12
    s_add_u32 s85, s37, s89
    s_bfe_u32 s37, s39, 0x10003
    s_lshl_b32 s37, s37, 11
    s_add_u32 s85, s37, s85
    s_bfe_u32 s37, s39, 0x40004
    s_lshl_b32 s37, s37, 16
    s_add_u32 s85, s37, s85
    s_waitcnt vmcnt(6)
L_qcheck_12:
    v_xor_b32 v68, s35, v68
    v_xor_b32 v69, s35, v69
    v_xor_b32 v70, s35, v70
    v_xor_b32 v71, s35, v71
    v_xor_b32 v72, s35, v72
    v_xor_b32 v73, s35, v73
    v_xor_b32 v74, s35, v74
    v_xor_b32 v75, s35, v75
    v_or_b32 v4, v68, v69
    v_or3_b32 v4, v4, v70, v71
    v_or3_b32 v4, v4, v72, v73
    v_or3_b32 v4, v4, v74, v75
    v_and_b32 v4, 0xff, v4
    v_cmp_ne_u32 vcc, 0, v4
    s_cbranch_vccz L_qok_13
    buffer_load_dwordx4 v[68:71], v78, s[48:51], s91 offen offset:0 sc1
    buffer_load_dwordx4 v[72:75], v78, s[48:51], s91 offen offset:16 sc1
    s_waitcnt vmcnt(0)
    s_sub_u32 s84, s84, 1
    s_cmp_lg_u32 s84, 0
    s_cbranch_scc1 L_qcheck_12
    s_branch L_end
L_qok_13:
    v_cvt_pk_bf16_f32 v68, v68, v69
    v_cvt_pk_bf16_f32 v69, v70, v71
    v_cvt_pk_bf16_f32 v70, v72, v73
    v_cvt_pk_bf16_f32 v71, v74, v75
    s_mov_b32 vcc_lo, 0xf000f
    s_mov_b32 vcc_hi, 0xf000f
    v_cndmask_b32 v80, 0, v68, vcc
    v_cndmask_b32 v81, 0, v69, vcc
    v_cndmask_b32 v82, 0, v70, vcc
    v_cndmask_b32 v83, 0, v71, vcc
    s_mov_b32 vcc_lo, 0xf000f0
    s_mov_b32 vcc_hi, 0xf000f0
    v_cndmask_b32 v84, 0, v68, vcc
    v_cndmask_b32 v85, 0, v69, vcc
    v_cndmask_b32 v86, 0, v70, vcc
    v_cndmask_b32 v87, 0, v71, vcc
    s_mov_b32 vcc_lo, 0xf000f00
    s_mov_b32 vcc_hi, 0xf000f00
    v_cndmask_b32 v88, 0, v68, vcc
    v_cndmask_b32 v89, 0, v69, vcc
    v_cndmask_b32 v90, 0, v70, vcc
    v_cndmask_b32 v91, 0, v71, vcc
    s_mov_b32 vcc_lo, 0xf000f000
    s_mov_b32 vcc_hi, 0xf000f000
    v_cndmask_b32 v92, 0, v68, vcc
    v_cndmask_b32 v93, 0, v69, vcc
    v_cndmask_b32 v94, 0, v70, vcc
    v_cndmask_b32 v95, 0, v71, vcc
    v_mov_b32 v65, 0xff7f0000
    s_lshl_b32 s38, s34, 14
    s_add_u32 s38, s38, 16384
    v_lshl_add_u32 v64, v1, 2, s38
    buffer_load_dwordx4 a[32:35], v76, s[52:55], s85 offen offset:0 nt
    v_mfma_f32_16x16x32_bf16 v[112:115], v[128:131], v[80:83], 0
    v_mfma_f32_16x16x32_bf16 v[112:115], v[132:135], v[84:87], v[112:115]
    v_mfma_f32_16x16x32_bf16 v[112:115], v[136:139], v[88:91], v[112:115]
    s_waitcnt vmcnt(6)
    buffer_load_dwordx4 a[36:39], v77, s[52:55], s85 offen offset:0 nt
    v_mfma_f32_16x16x32_bf16 v[112:115], v[140:143], v[92:95], v[112:115]
    v_mfma_f32_16x16x32_bf16 v[96:99], v[144:147], v[80:83], 0
    v_mfma_f32_16x16x32_bf16 v[96:99], v[148:151], v[84:87], v[96:99]
    s_waitcnt vmcnt(6)
    buffer_load_dwordx4 a[40:43], v76, s[52:55], s85 offen offset:1024 nt
    v_mfma_f32_16x16x32_bf16 v[96:99], v[152:155], v[88:91], v[96:99]
    s_nop 2
    v_mov_b32_dpp v122, v112 quad_perm:[0,0,0,0] row_mask:0xf bank_mask:0xf
    v_mov_b32_dpp v124, v114 quad_perm:[2,2,2,2] row_mask:0xf bank_mask:0xf
    s_nop 0
    v_add_f32_dpp v122, v113, v122 quad_perm:[1,1,1,1] row_mask:0xf bank_mask:0xf
    v_add_f32_dpp v124, v115, v124 quad_perm:[3,3,3,3] row_mask:0xf bank_mask:0xf
    v_add_f32 v122, v122, v124
    v_max_f32 v65, v65, v122
    ds_write_b32 v64, v122 offset:0
    v_mfma_f32_16x16x32_bf16 v[96:99], v[156:159], v[92:95], v[96:99]
    v_mfma_f32_16x16x32_bf16 v[112:115], v[160:163], v[80:83], 0
    v_mfma_f32_16x16x32_bf16 v[112:115], v[164:167], v[84:87], v[112:115]
    s_waitcnt vmcnt(6)
    buffer_load_dwordx4 a[44:47], v77, s[52:55], s85 offen offset:1024 nt
    s_add_u32 s87, s87, 7
    s_add_u32 s39, s87, s88
    s_bfe_u32 s37, s39, 0x30000
    s_lshl_b32 s37, s37, 12
    s_add_u32 s85, s37, s89
    s_bfe_u32 s37, s39, 0x10003
    s_lshl_b32 s37, s37, 11
    s_add_u32 s85, s37, s85
    s_bfe_u32 s37, s39, 0x40004
    s_lshl_b32 s37, s37, 16
    s_add_u32 s85, s37, s85
    v_mfma_f32_16x16x32_bf16 v[112:115], v[168:171], v[88:91], v[112:115]
    v_mov_b32_dpp v122, v96 quad_perm:[0,0,0,0] row_mask:0xf bank_mask:0xf
    v_mov_b32_dpp v124, v98 quad_perm:[2,2,2,2] row_mask:0xf bank_mask:0xf
    s_nop 0
    v_add_f32_dpp v122, v97, v122 quad_perm:[1,1,1,1] row_mask:0xf bank_mask:0xf
    v_add_f32_dpp v124, v99, v124 quad_perm:[3,3,3,3] row_mask:0xf bank_mask:0xf
    v_add_f32 v122, v122, v124
    v_max_f32 v65, v65, v122
    ds_write_b32 v64, v122 offset:256
    v_mfma_f32_16x16x32_bf16 v[112:115], v[172:175], v[92:95], v[112:115]
    v_mfma_f32_16x16x32_bf16 v[96:99], v[176:179], v[80:83], 0
    s_waitcnt vmcnt(6)
    buffer_load_dwordx4 a[48:51], v76, s[52:55], s85 offen offset:0 nt
    v_mfma_f32_16x16x32_bf16 v[96:99], v[180:183], v[84:87], v[96:99]
    v_mfma_f32_16x16x32_bf16 v[96:99], v[184:187], v[88:91], v[96:99]
    s_nop 2
    v_mov_b32_dpp v122, v112 quad_perm:[0,0,0,0] row_mask:0xf bank_mask:0xf
    v_mov_b32_dpp v124, v114 quad_perm:[2,2,2,2] row_mask:0xf bank_mask:0xf
    s_nop 0
    v_add_f32_dpp v122, v113, v122 quad_perm:[1,1,1,1] row_mask:0xf bank_mask:0xf
    v_add_f32_dpp v124, v115, v124 quad_perm:[3,3,3,3] row_mask:0xf bank_mask:0xf
    v_add_f32 v122, v122, v124
    v_max_f32 v65, v65, v122
    ds_write_b32 v64, v122 offset:512
    v_mfma_f32_16x16x32_bf16 v[96:99], v[188:191], v[92:95], v[96:99]
    v_mfma_f32_16x16x32_bf16 v[112:115], v[192:195], v[80:83], 0
    s_waitcnt vmcnt(6)
    buffer_load_dwordx4 a[52:55], v77, s[52:55], s85 offen offset:0 nt
    v_mfma_f32_16x16x32_bf16 v[112:115], v[196:199], v[84:87], v[112:115]
    v_mfma_f32_16x16x32_bf16 v[112:115], v[200:203], v[88:91], v[112:115]
    s_nop 2
    v_mov_b32_dpp v122, v96 quad_perm:[0,0,0,0] row_mask:0xf bank_mask:0xf
    v_mov_b32_dpp v124, v98 quad_perm:[2,2,2,2] row_mask:0xf bank_mask:0xf
    s_nop 0
    v_add_f32_dpp v122, v97, v122 quad_perm:[1,1,1,1] row_mask:0xf bank_mask:0xf
    v_add_f32_dpp v124, v99, v124 quad_perm:[3,3,3,3] row_mask:0xf bank_mask:0xf
    v_add_f32 v122, v122, v124
    v_max_f32 v65, v65, v122
    ds_write_b32 v64, v122 offset:768
    v_mfma_f32_16x16x32_bf16 v[112:115], v[204:207], v[92:95], v[112:115]
    s_waitcnt vmcnt(6)
    buffer_load_dwordx4 a[56:59], v76, s[52:55], s85 offen offset:1024 nt
    v_mfma_f32_16x16x32_bf16 v[96:99], v[208:211], v[80:83], 0
    v_mfma_f32_16x16x32_bf16 v[96:99], v[212:215], v[84:87], v[96:99]
    v_mfma_f32_16x16x32_bf16 v[96:99], v[216:219], v[88:91], v[96:99]
    s_nop 2
    v_mov_b32_dpp v122, v112 quad_perm:[0,0,0,0] row_mask:0xf bank_mask:0xf
    v_mov_b32_dpp v124, v114 quad_perm:[2,2,2,2] row_mask:0xf bank_mask:0xf
    s_nop 0
    v_add_f32_dpp v122, v113, v122 quad_perm:[1,1,1,1] row_mask:0xf bank_mask:0xf
    v_add_f32_dpp v124, v115, v124 quad_perm:[3,3,3,3] row_mask:0xf bank_mask:0xf
    v_add_f32 v122, v122, v124
    v_max_f32 v65, v65, v122
    ds_write_b32 v64, v122 offset:1024
    v_mfma_f32_16x16x32_bf16 v[96:99], v[220:223], v[92:95], v[96:99]
    s_waitcnt vmcnt(6)
    buffer_load_dwordx4 a[60:63], v77, s[52:55], s85 offen offset:1024 nt
    s_add_u32 s87, s87, 7
    s_add_u32 s39, s87, s88
    s_bfe_u32 s37, s39, 0x30000
    s_lshl_b32 s37, s37, 12
    s_add_u32 s85, s37, s89
    s_bfe_u32 s37, s39, 0x10003
    s_lshl_b32 s37, s37, 11
    s_add_u32 s85, s37, s85
    s_bfe_u32 s37, s39, 0x40004
    s_lshl_b32 s37, s37, 16
    s_add_u32 s85, s37, s85
    v_mfma_f32_16x16x32_bf16 v[112:115], v[224:227], v[80:83], 0
    v_mfma_f32_16x16x32_bf16 v[112:115], v[228:231], v[84:87], v[112:115]
    v_mfma_f32_16x16x32_bf16 v[112:115], v[232:235], v[88:91], v[112:115]
    v_mov_b32_dpp v122, v96 quad_perm:[0,0,0,0] row_mask:0xf bank_mask:0xf
    v_mov_b32_dpp v124, v98 quad_perm:[2,2,2,2] row_mask:0xf bank_mask:0xf
    s_nop 0
    v_add_f32_dpp v122, v97, v122 quad_perm:[1,1,1,1] row_mask:0xf bank_mask:0xf
    v_add_f32_dpp v124, v99, v124 quad_perm:[3,3,3,3] row_mask:0xf bank_mask:0xf
    v_add_f32 v122, v122, v124
    v_max_f32 v65, v65, v122
    ds_write_b32 v64, v122 offset:1280
    s_waitcnt vmcnt(5)
    buffer_load_dwordx4 v[128:131], v76, s[52:55], s85 offen offset:0 nt
    v_mfma_f32_16x16x32_bf16 v[112:115], v[236:239], v[92:95], v[112:115]
    v_mfma_f32_16x16x32_bf16 v[96:99], v[240:243], v[80:83], 0
    v_mfma_f32_16x16x32_bf16 v[96:99], v[244:247], v[84:87], v[96:99]
    s_waitcnt vmcnt(5)
    buffer_load_dwordx4 v[132:135], v77, s[52:55], s85 offen offset:0 nt
    v_mfma_f32_16x16x32_bf16 v[96:99], v[248:251], v[88:91], v[96:99]
    s_nop 2
    v_mov_b32_dpp v122, v112 quad_perm:[0,0,0,0] row_mask:0xf bank_mask:0xf
    v_mov_b32_dpp v124, v114 quad_perm:[2,2,2,2] row_mask:0xf bank_mask:0xf
    s_nop 0
    v_add_f32_dpp v122, v113, v122 quad_perm:[1,1,1,1] row_mask:0xf bank_mask:0xf
    v_add_f32_dpp v124, v115, v124 quad_perm:[3,3,3,3] row_mask:0xf bank_mask:0xf
    v_add_f32 v122, v122, v124
    v_max_f32 v65, v65, v122
    ds_write_b32 v64, v122 offset:1536
    v_mfma_f32_16x16x32_bf16 v[96:99], v[252:255], v[92:95], v[96:99]
    v_mfma_f32_16x16x32_bf16 v[112:115], a[0:3], v[80:83], 0
    v_mfma_f32_16x16x32_bf16 v[112:115], a[4:7], v[84:87], v[112:115]
    s_waitcnt vmcnt(5)
    buffer_load_dwordx4 v[136:139], v76, s[52:55], s85 offen offset:1024 nt
    v_mfma_f32_16x16x32_bf16 v[112:115], a[8:11], v[88:91], v[112:115]
    s_nop 2
    v_mov_b32_dpp v122, v96 quad_perm:[0,0,0,0] row_mask:0xf bank_mask:0xf
    v_mov_b32_dpp v124, v98 quad_perm:[2,2,2,2] row_mask:0xf bank_mask:0xf
    s_nop 0
    v_add_f32_dpp v122, v97, v122 quad_perm:[1,1,1,1] row_mask:0xf bank_mask:0xf
    v_add_f32_dpp v124, v99, v124 quad_perm:[3,3,3,3] row_mask:0xf bank_mask:0xf
    v_add_f32 v122, v122, v124
    v_max_f32 v65, v65, v122
    ds_write_b32 v64, v122 offset:1792
    v_mfma_f32_16x16x32_bf16 v[112:115], a[12:15], v[92:95], v[112:115]
    v_mfma_f32_16x16x32_bf16 v[96:99], a[16:19], v[80:83], 0
    s_waitcnt vmcnt(5)
    buffer_load_dwordx4 v[140:143], v77, s[52:55], s85 offen offset:1024 nt
    s_add_u32 s87, s87, 7
    s_add_u32 s39, s87, s88
    s_bfe_u32 s37, s39, 0x30000
    s_lshl_b32 s37, s37, 12
    s_add_u32 s85, s37, s89
    s_bfe_u32 s37, s39, 0x10003
    s_lshl_b32 s37, s37, 11
    s_add_u32 s85, s37, s85
    s_bfe_u32 s37, s39, 0x40004
    s_lshl_b32 s37, s37, 16
    s_add_u32 s85, s37, s85
    v_mfma_f32_16x16x32_bf16 v[96:99], a[20:23], v[84:87], v[96:99]
    v_mfma_f32_16x16x32_bf16 v[96:99], a[24:27], v[88:91], v[96:99]
    v_mov_b32_dpp v122, v112 quad_perm:[0,0,0,0] row_mask:0xf bank_mask:0xf
    v_mov_b32_dpp v124, v114 quad_perm:[2,2,2,2] row_mask:0xf bank_mask:0xf
    s_nop 0
    v_add_f32_dpp v122, v113, v122 quad_perm:[1,1,1,1] row_mask:0xf bank_mask:0xf
    v_add_f32_dpp v124, v115, v124 quad_perm:[3,3,3,3] row_mask:0xf bank_mask:0xf
    v_add_f32 v122, v122, v124
    v_max_f32 v65, v65, v122
    ds_write_b32 v64, v122 offset:2048
    v_mfma_f32_16x16x32_bf16 v[96:99], a[28:31], v[92:95], v[96:99]
    v_mfma_f32_16x16x32_bf16 v[112:115], a[32:35], v[80:83], 0
    s_waitcnt vmcnt(5)
    buffer_load_dwordx4 v[144:147], v76, s[52:55], s85 offen offset:0 nt
    v_mfma_f32_16x16x32_bf16 v[112:115], a[36:39], v[84:87], v[112:115]
    v_mfma_f32_16x16x32_bf16 v[112:115], a[40:43], v[88:91], v[112:115]
    s_nop 2
    v_mov_b32_dpp v122, v96 quad_perm:[0,0,0,0] row_mask:0xf bank_mask:0xf
    v_mov_b32_dpp v124, v98 quad_perm:[2,2,2,2] row_mask:0xf bank_mask:0xf
    s_nop 0
    v_add_f32_dpp v122, v97, v122 quad_perm:[1,1,1,1] row_mask:0xf bank_mask:0xf
    v_add_f32_dpp v124, v99, v124 quad_perm:[3,3,3,3] row_mask:0xf bank_mask:0xf
    v_add_f32 v122, v122, v124
    v_max_f32 v65, v65, v122
    ds_write_b32 v64, v122 offset:2304
    v_mfma_f32_16x16x32_bf16 v[112:115], a[44:47], v[92:95], v[112:115]
    s_waitcnt vmcnt(5)
    buffer_load_dwordx4 v[148:151], v77, s[52:55], s85 offen offset:0 nt
    v_mfma_f32_16x16x32_bf16 v[96:99], a[48:51], v[80:83], 0
    v_mfma_f32_16x16x32_bf16 v[96:99], a[52:55], v[84:87], v[96:99]
    v_mfma_f32_16x16x32_bf16 v[96:99], a[56:59], v[88:91], v[96:99]
    s_nop 2
    v_mov_b32_dpp v122, v112 quad_perm:[0,0,0,0] row_mask:0xf bank_mask:0xf
    v_mov_b32_dpp v124, v114 quad_perm:[2,2,2,2] row_mask:0xf bank_mask:0xf
    s_nop 0
    v_add_f32_dpp v122, v113, v122 quad_perm:[1,1,1,1] row_mask:0xf bank_mask:0xf
    v_add_f32_dpp v124, v115, v124 quad_perm:[3,3,3,3] row_mask:0xf bank_mask:0xf
    v_add_f32 v122, v122, v124
    v_max_f32 v65, v65, v122
    ds_write_b32 v64, v122 offset:2560
    v_mfma_f32_16x16x32_bf16 v[96:99], a[60:63], v[92:95], v[96:99]
    v_add_u32 v64, 2816, v64
    s_mov_b32 s97, 10
    s_mov_b32 s86, 32
    s_add_u32 s92, s33, 224
    s_mov_b32 s66, 134217728
    s_mov_b32 s67, 0x20000
    s_mov_b64 s[64:65], s[52:53]
    v_mov_b32 v62, v76
    v_mov_b32 v63, v77
    s_branch L_bloop
L_ql:
    v_lshrrev_b32 v4, 2, v3
    v_and_b32 v5, 3, v3
    v_lshlrev_b32 v19, 6, v2
    v_lshl_add_u32 v19, v5, 4, v19
    v_lshl_add_u32 v14, v4, 18, v19
    s_lshl_b32 s63, s34, 20
    s_lshl_b32 s38, s32, 8
    s_add_u32 s63, s63, s38
    s_mov_b32 s74, 4194304
    s_mov_b32 s75, 0x20000
    s_waitcnt lgkmcnt(0)
    s_mov_b64 s[72:73], s[10:11]
    buffer_load_dwordx4 a[128:131], v14, s[72:75], s63 offen nt
    s_add_u32 s63, s63, 8192
    buffer_load_dwordx4 a[132:135], v14, s[72:75], s63 offen nt
    s_add_u32 s63, s63, 8192
    buffer_load_dwordx4 a[136:139], v14, s[72:75], s63 offen nt
    s_add_u32 s63, s63, 8192
    buffer_load_dwordx4 a[140:143], v14, s[72:75], s63 offen nt
    s_add_u32 s63, s63, 8192
    buffer_load_dwordx4 a[144:147], v14, s[72:75], s63 offen nt
    s_add_u32 s63, s63, 8192
    buffer_load_dwordx4 a[148:151], v14, s[72:75], s63 offen nt
    s_add_u32 s63, s63, 8192
    buffer_load_dwordx4 a[152:155], v14, s[72:75], s63 offen nt
    s_add_u32 s63, s63, 8192
    buffer_load_dwordx4 a[156:159], v14, s[72:75], s63 offen nt
    s_add_u32 s63, s63, 8192
    v_lshlrev_b32 v15, 1, v19
    v_lshl_add_u32 v15, v4, 9, v15
    v_lshl_add_u32 v19, v4, 15, v19
    s_getpc_b64 s[36:37]
L_pc_14:
    s_sub_u32 s36, s36, L_pc_14 - concat_heads__compressed_kv_cla__mha_block_cached__decode_kernel
    s_subb_u32 s37, s37, 0
    s_lshl_b32 s38, s32, 10
    v_lshl_add_u32 v6, v0, 2, s38
    v_mov_b32 v7, s37
    v_add_co_u32 v6, vcc, s36, v6
    s_nop 1
    v_addc_co_u32 v7, vcc, 0, v7, vcc
    global_load_dword v0, v[6:7], off
    s_load_dword s35, s[30:31], 0
    s_mov_b32 s48, s30
    s_and_b32 s49, s31, 0xffff
    s_mov_b32 s50, 8388608
    s_mov_b32 s51, 0x20000
    s_mov_b32 s82, 0xffffff00
    s_mov_b32 s83, 0x3e0293ee
    s_mov_b32 s84, 2097152
    s_lshl_b32 s95, s32, 12
    s_add_u32 s95, s95, 1050624
    s_lshl_b32 s94, s32, 10
    s_lshl_b32 s38, s34, 8
    s_add_u32 s94, s94, s38
    s_add_u32 s94, s94, 2097152
    s_waitcnt vmcnt(8)
    buffer_load_dwordx4 a[160:163], v14, s[72:75], s63 offen nt
    s_add_u32 s63, s63, 8192
    s_waitcnt vmcnt(8)
    buffer_load_dwordx4 a[164:167], v14, s[72:75], s63 offen nt
    s_add_u32 s63, s63, 8192
    s_waitcnt vmcnt(8)
    buffer_load_dwordx4 a[168:171], v14, s[72:75], s63 offen nt
    s_add_u32 s63, s63, 8192
    s_waitcnt vmcnt(8)
    buffer_load_dwordx4 a[172:175], v14, s[72:75], s63 offen nt
    s_add_u32 s63, s63, 8192
    s_waitcnt vmcnt(8)
    buffer_load_dwordx4 a[176:179], v14, s[72:75], s63 offen nt
    s_add_u32 s63, s63, 8192
    v_and_b32 v4, 1, v1
    v_lshlrev_b32 v4, 4, v4
    v_mov_b32 v5, 0xffff
    v_lshlrev_b32 v4, v4, v5
    v_bfe_u32 v5, v1, 1, 2
    v_cmp_eq_u32 vcc, 0, v5
    s_nop 1
    v_cndmask_b32 v10, 0, v4, vcc
    v_cmp_eq_u32 vcc, 1, v5
    s_nop 1
    v_cndmask_b32 v11, 0, v4, vcc
    v_cmp_eq_u32 vcc, 2, v5
    s_nop 1
    v_cndmask_b32 v12, 0, v4, vcc
    v_cmp_eq_u32 vcc, 3, v5
    s_nop 1
    v_cndmask_b32 v13, 0, v4, vcc
    s_waitcnt vmcnt(8)
    buffer_load_dwordx4 a[180:183], v14, s[72:75], s63 offen nt
    s_add_u32 s63, s63, 8192
    s_waitcnt vmcnt(8)
    buffer_load_dwordx4 a[184:187], v14, s[72:75], s63 offen nt
    s_add_u32 s63, s63, 8192
    s_waitcnt vmcnt(8)
    buffer_load_dwordx4 a[188:191], v14, s[72:75], s63 offen nt
    s_add_u32 s63, s63, 8192
    s_waitcnt vmcnt(7)
    buffer_load_dwordx4 a[192:195], v14, s[72:75], s63 offen nt
    s_add_u32 s63, s63, 8192
    v_lshrrev_b32 v4, 2, v3
    v_and_b32 v5, 3, v3
    v_lshlrev_b32 v76, 8, v4
    v_lshlrev_b32 v126, 8, v2
    v_lshl_add_u32 v76, v2, 6, v76
    v_lshl_add_u32 v76, v5, 4, v76
    v_lshl_add_u32 v126, v3, 4, v126
    v_xor_b32 v77, 32768, v76
    v_xor_b32 v127, 32768, v126
    s_add_u32 s3, s34, s33
    s_and_b32 s3, s3, 3
    s_lshl_b32 s89, s3, 5
    s_add_u32 s89, s89, s32
    s_lshl_b32 s89, s89, 20
    s_mul_i32 s88, s32, 8
    s_add_u32 s88, s88, s3
    s_add_u32 s87, s33, 0
    s_waitcnt vmcnt(7)
    buffer_load_dwordx4 a[196:199], v14, s[72:75], s63 offen nt
    s_add_u32 s63, s63, 8192
    s_waitcnt vmcnt(7)
    buffer_load_dwordx4 a[200:203], v14, s[72:75], s63 offen nt
    s_add_u32 s63, s63, 8192
    s_waitcnt vmcnt(7)
    buffer_load_dwordx4 a[204:207], v14, s[72:75], s63 offen nt
    s_add_u32 s63, s63, 8192
    s_waitcnt vmcnt(7)
    buffer_load_dwordx4 a[208:211], v14, s[72:75], s63 offen nt
    s_add_u32 s63, s63, 8192
    s_mov_b32 s52, s18
    s_and_b32 s53, s19, 0xffff
    s_mov_b32 s54, 134217728
    s_mov_b32 s55, 0x20000
    s_mov_b32 s56, s20
    s_and_b32 s57, s21, 0xffff
    s_mov_b32 s58, 134217728
    s_mov_b32 s59, 0x20000
    s_waitcnt vmcnt(7)
    buffer_load_dwordx4 a[212:215], v14, s[72:75], s63 offen nt
    s_add_u32 s63, s63, 8192
    s_waitcnt vmcnt(7)
    buffer_load_dwordx4 a[216:219], v14, s[72:75], s63 offen nt
    s_add_u32 s63, s63, 8192
    s_waitcnt vmcnt(7)
    buffer_load_dwordx4 a[220:223], v14, s[72:75], s63 offen nt
    s_add_u32 s63, s63, 8192
    s_waitcnt vmcnt(7)
    buffer_load_dwordx4 a[224:227], v14, s[72:75], s63 offen nt
    s_add_u32 s63, s63, 8192
    v_mov_b32 v120, 0xff7f0000
    v_mov_b32 v121, 0
    v_mov_b32 v18, 1
    v_mov_b32 v116, 0
    v_mov_b32 v117, 0
    v_mov_b32 v118, 0
    v_mov_b32 v119, 0
    s_lshl_b32 s38, s32, 2
    s_add_u32 s38, s38, s3
    s_lshl_b32 s96, s38, 3
    s_lshl_b32 s38, s38, 8
    s_add_u32 s38, s38, 65536
    v_mov_b32 v9, s38
    s_add_u32 s96, s96, s33
    s_lshl_b32 s96, s96, 10
    s_add_u32 s96, s96, 5242880
    v_and_b32 v5, 3, v3
    v_lshlrev_b32 v78, 7, v2
    v_lshl_add_u32 v78, v5, 5, v78
    s_lshl_b32 s91, s32, 12
    s_lshl_b32 s38, s3, 9
    s_add_u32 s91, s91, s38
    s_add_u32 s91, s91, 1048576
    v_lshlrev_b32 v4, 7, v2
    v_lshl_add_u32 v4, v3, 4, v4
    v_mov_b32 v5, 512
    v_cmp_gt_u32 vcc, 8, v3
    s_nop 1
    v_cndmask_b32 v79, v5, v4, vcc
    s_waitcnt vmcnt(7)
    buffer_load_dwordx4 a[228:231], v14, s[72:75], s63 offen nt
    s_add_u32 s63, s63, 8192
    s_waitcnt vmcnt(7)
    buffer_load_dwordx4 a[232:235], v14, s[72:75], s63 offen nt
    s_add_u32 s63, s63, 8192
    s_waitcnt vmcnt(7)
    buffer_load_dwordx4 a[236:239], v14, s[72:75], s63 offen nt
    s_add_u32 s63, s63, 8192
    s_waitcnt vmcnt(7)
    buffer_load_dwordx4 a[240:243], v14, s[72:75], s63 offen nt
    s_add_u32 s63, s63, 8192
    s_waitcnt vmcnt(7)
    buffer_load_dwordx4 a[244:247], v14, s[72:75], s63 offen nt
    s_add_u32 s63, s63, 8192
    s_waitcnt vmcnt(7)
    buffer_load_dwordx4 a[248:251], v14, s[72:75], s63 offen nt
    s_add_u32 s63, s63, 8192
    s_waitcnt vmcnt(7)
    buffer_load_dwordx4 a[252:255], v14, s[72:75], s63 offen nt
    s_add_u32 s63, s63, 8192
    s_waitcnt lgkmcnt(0)
    s_add_u32 s35, s35, 0x5b
    s_and_b32 s35, s35, 0xff
    v_mov_b32 v8, s35
    s_or_b32 s68, s35, 0x6b3ac500
    s_waitcnt vmcnt(6)
    s_add_u32 s39, s87, s88
    s_bfe_u32 s37, s39, 0x30000
    s_lshl_b32 s37, s37, 12
    s_add_u32 s85, s37, s89
    s_bfe_u32 s37, s39, 0x10003
    s_lshl_b32 s37, s37, 11
    s_add_u32 s85, s37, s85
    s_bfe_u32 s37, s39, 0x40004
    s_lshl_b32 s37, s37, 16
    s_add_u32 s85, s37, s85
    buffer_load_dwordx4 v[128:131], v76, s[52:55], s85 offen offset:0 nt
    s_waitcnt vmcnt(6)
    buffer_load_dwordx4 v[132:135], v77, s[52:55], s85 offen offset:0 nt
    s_waitcnt vmcnt(6)
    buffer_load_dwordx4 v[136:139], v76, s[52:55], s85 offen offset:1024 nt
    s_waitcnt vmcnt(6)
    buffer_load_dwordx4 v[140:143], v77, s[52:55], s85 offen offset:1024 nt
    s_add_u32 s87, s87, 7
    s_add_u32 s39, s87, s88
    s_bfe_u32 s37, s39, 0x30000
    s_lshl_b32 s37, s37, 12
    s_add_u32 s85, s37, s89
    s_bfe_u32 s37, s39, 0x10003
    s_lshl_b32 s37, s37, 11
    s_add_u32 s85, s37, s85
    s_bfe_u32 s37, s39, 0x40004
    s_lshl_b32 s37, s37, 16
    s_add_u32 s85, s37, s85
    s_waitcnt vmcnt(6)
    buffer_load_dwordx4 v[144:147], v76, s[52:55], s85 offen offset:0 nt
    s_waitcnt vmcnt(6)
    buffer_load_dwordx4 v[148:151], v77, s[52:55], s85 offen offset:0 nt
    s_waitcnt vmcnt(6)
    buffer_load_dwordx4 v[152:155], v76, s[52:55], s85 offen offset:1024 nt
    s_waitcnt vmcnt(6)
    buffer_load_dwordx4 v[156:159], v77, s[52:55], s85 offen offset:1024 nt
    s_add_u32 s87, s87, 7
    s_add_u32 s39, s87, s88
    s_bfe_u32 s37, s39, 0x30000
    s_lshl_b32 s37, s37, 12
    s_add_u32 s85, s37, s89
    s_bfe_u32 s37, s39, 0x10003
    s_lshl_b32 s37, s37, 11
    s_add_u32 s85, s37, s85
    s_bfe_u32 s37, s39, 0x40004
    s_lshl_b32 s37, s37, 16
    s_add_u32 s85, s37, s85
    s_waitcnt vmcnt(6)
    buffer_load_dwordx4 v[160:163], v76, s[52:55], s85 offen offset:0 nt
    s_waitcnt vmcnt(6)
    buffer_load_dwordx4 v[164:167], v77, s[52:55], s85 offen offset:0 nt
    s_waitcnt vmcnt(6)
    buffer_load_dwordx4 v[168:171], v76, s[52:55], s85 offen offset:1024 nt
    s_waitcnt vmcnt(6)
    buffer_load_dwordx4 v[172:175], v77, s[52:55], s85 offen offset:1024 nt
    s_add_u32 s87, s87, 7
    s_add_u32 s39, s87, s88
    s_bfe_u32 s37, s39, 0x30000
    s_lshl_b32 s37, s37, 12
    s_add_u32 s85, s37, s89
    s_bfe_u32 s37, s39, 0x10003
    s_lshl_b32 s37, s37, 11
    s_add_u32 s85, s37, s85
    s_bfe_u32 s37, s39, 0x40004
    s_lshl_b32 s37, s37, 16
    s_add_u32 s85, s37, s85
    s_waitcnt vmcnt(6)
    buffer_load_dwordx4 v[176:179], v76, s[52:55], s85 offen offset:0 nt
    s_waitcnt vmcnt(6)
    buffer_load_dwordx4 v[180:183], v77, s[52:55], s85 offen offset:0 nt
    s_waitcnt vmcnt(6)
    buffer_load_dwordx4 v[184:187], v76, s[52:55], s85 offen offset:1024 nt
    s_waitcnt vmcnt(6)
    buffer_load_dwordx4 v[188:191], v77, s[52:55], s85 offen offset:1024 nt
    s_add_u32 s87, s87, 7
    s_add_u32 s39, s87, s88
    s_bfe_u32 s37, s39, 0x30000
    s_lshl_b32 s37, s37, 12
    s_add_u32 s85, s37, s89
    s_bfe_u32 s37, s39, 0x10003
    s_lshl_b32 s37, s37, 11
    s_add_u32 s85, s37, s85
    s_bfe_u32 s37, s39, 0x40004
    s_lshl_b32 s37, s37, 16
    s_add_u32 s85, s37, s85
    s_waitcnt vmcnt(6)
    buffer_load_dwordx4 v[192:195], v76, s[52:55], s85 offen offset:0 nt
    s_waitcnt vmcnt(6)
    buffer_load_dwordx4 v[196:199], v77, s[52:55], s85 offen offset:0 nt
    s_waitcnt vmcnt(6)
    buffer_load_dwordx4 v[200:203], v76, s[52:55], s85 offen offset:1024 nt
    s_waitcnt vmcnt(6)
    buffer_load_dwordx4 v[204:207], v77, s[52:55], s85 offen offset:1024 nt
    s_add_u32 s87, s87, 7
    s_add_u32 s39, s87, s88
    s_bfe_u32 s37, s39, 0x30000
    s_lshl_b32 s37, s37, 12
    s_add_u32 s85, s37, s89
    s_bfe_u32 s37, s39, 0x10003
    s_lshl_b32 s37, s37, 11
    s_add_u32 s85, s37, s85
    s_bfe_u32 s37, s39, 0x40004
    s_lshl_b32 s37, s37, 16
    s_add_u32 s85, s37, s85
    s_waitcnt vmcnt(6)
    buffer_load_dwordx4 v[208:211], v76, s[52:55], s85 offen offset:0 nt
    s_waitcnt vmcnt(6)
    buffer_load_dwordx4 v[212:215], v77, s[52:55], s85 offen offset:0 nt
    s_waitcnt vmcnt(6)
    buffer_load_dwordx4 v[216:219], v76, s[52:55], s85 offen offset:1024 nt
    s_waitcnt vmcnt(6)
    buffer_load_dwordx4 v[220:223], v77, s[52:55], s85 offen offset:1024 nt
    s_add_u32 s87, s87, 7
    s_add_u32 s39, s87, s88
    s_bfe_u32 s37, s39, 0x30000
    s_lshl_b32 s37, s37, 12
    s_add_u32 s85, s37, s89
    s_bfe_u32 s37, s39, 0x10003
    s_lshl_b32 s37, s37, 11
    s_add_u32 s85, s37, s85
    s_bfe_u32 s37, s39, 0x40004
    s_lshl_b32 s37, s37, 16
    s_add_u32 s85, s37, s85
    buffer_load_dwordx4 v[20:23], v15, s[48:51], s95 offen offset:0 sc1
    buffer_load_dwordx4 v[24:27], v15, s[48:51], s95 offen offset:16 sc1
    s_waitcnt vmcnt(8)
    buffer_load_dwordx4 v[224:227], v76, s[52:55], s85 offen offset:0 nt
    s_waitcnt vmcnt(8)
    buffer_load_dwordx4 v[228:231], v77, s[52:55], s85 offen offset:0 nt
    s_waitcnt vmcnt(8)
    buffer_load_dwordx4 v[232:235], v76, s[52:55], s85 offen offset:1024 nt
    s_waitcnt vmcnt(8)
    buffer_load_dwordx4 v[236:239], v77, s[52:55], s85 offen offset:1024 nt
    s_add_u32 s87, s87, 7
    s_add_u32 s39, s87, s88
    s_bfe_u32 s37, s39, 0x30000
    s_lshl_b32 s37, s37, 12
    s_add_u32 s85, s37, s89
    s_bfe_u32 s37, s39, 0x10003
    s_lshl_b32 s37, s37, 11
    s_add_u32 s85, s37, s85
    s_bfe_u32 s37, s39, 0x40004
    s_lshl_b32 s37, s37, 16
    s_add_u32 s85, s37, s85
    s_waitcnt vmcnt(8)
    buffer_load_dwordx4 v[240:243], v76, s[52:55], s85 offen offset:0 nt
    s_waitcnt vmcnt(8)
    buffer_load_dwordx4 v[244:247], v77, s[52:55], s85 offen offset:0 nt
    s_waitcnt vmcnt(6)
L_qacheck_15:
    v_xor_b32 v20, s35, v20
    v_xor_b32 v21, s35, v21
    v_xor_b32 v22, s35, v22
    v_xor_b32 v23, s35, v23
    v_xor_b32 v24, s35, v24
    v_xor_b32 v25, s35, v25
    v_xor_b32 v26, s35, v26
    v_xor_b32 v27, s35, v27
    v_or_b32 v4, v20, v21
    v_or3_b32 v4, v4, v22, v23
    v_or3_b32 v4, v4, v24, v25
    v_or3_b32 v4, v4, v26, v27
    v_and_b32 v4, 0xff, v4
    v_cmp_ne_u32 vcc, 0, v4
    s_cbranch_vccz L_qaok_16
    buffer_load_dwordx4 v[20:23], v15, s[48:51], s95 offen offset:0 sc1
    buffer_load_dwordx4 v[24:27], v15, s[48:51], s95 offen offset:16 sc1
    s_waitcnt vmcnt(0)
    s_sub_u32 s84, s84, 1
    s_cmp_lg_u32 s84, 0
    s_cbranch_scc1 L_qacheck_15
    s_branch L_end
L_qaok_16:
    buffer_load_dwordx4 v[68:71], v78, s[48:51], s91 offen offset:0 sc1
    buffer_load_dwordx4 v[72:75], v78, s[48:51], s91 offen offset:16 sc1
    v_cvt_pk_bf16_f32 v20, v20, v21
    v_cvt_pk_bf16_f32 v21, v22, v23
    v_cvt_pk_bf16_f32 v22, v24, v25
    v_cvt_pk_bf16_f32 v23, v26, v27
    s_nop 1
    v_mfma_f32_16x16x32_bf16 v[28:31], a[128:131], v[20:23], 0
    v_mfma_f32_16x16x32_bf16 v[32:35], a[132:135], v[20:23], 0
    v_mfma_f32_16x16x32_bf16 v[36:39], a[136:139], v[20:23], 0
    s_nop 5
    v_mov_b32_dpp v60, v28 quad_perm:[0,0,0,0] row_mask:0xf bank_mask:0xf
    v_mov_b32_dpp v4, v30 quad_perm:[2,2,2,2] row_mask:0xf bank_mask:0xf
    s_nop 0
    v_add_f32_dpp v60, v29, v60 quad_perm:[1,1,1,1] row_mask:0xf bank_mask:0xf
    v_add_f32_dpp v4, v31, v4 quad_perm:[3,3,3,3] row_mask:0xf bank_mask:0xf
    v_add_f32 v60, v60, v4
    v_mfma_f32_16x16x32_bf16 v[40:43], a[140:143], v[20:23], 0
    v_mov_b32_dpp v61, v32 quad_perm:[0,0,0,0] row_mask:0xf bank_mask:0xf
    v_mov_b32_dpp v4, v34 quad_perm:[2,2,2,2] row_mask:0xf bank_mask:0xf
    s_nop 0
    v_add_f32_dpp v61, v33, v61 quad_perm:[1,1,1,1] row_mask:0xf bank_mask:0xf
    v_add_f32_dpp v4, v35, v4 quad_perm:[3,3,3,3] row_mask:0xf bank_mask:0xf
    v_add_f32 v61, v61, v4
    v_cvt_pk_bf16_f32 v44, v60, v61
    v_mfma_f32_16x16x32_bf16 v[28:31], a[144:147], v[20:23], 0
    v_mov_b32_dpp v60, v36 quad_perm:[0,0,0,0] row_mask:0xf bank_mask:0xf
    v_mov_b32_dpp v4, v38 quad_perm:[2,2,2,2] row_mask:0xf bank_mask:0xf
    s_nop 0
    v_add_f32_dpp v60, v37, v60 quad_perm:[1,1,1,1] row_mask:0xf bank_mask:0xf
    v_add_f32_dpp v4, v39, v4 quad_perm:[3,3,3,3] row_mask:0xf bank_mask:0xf
    v_add_f32 v60, v60, v4
    buffer_load_dwordx4 v[248:251], v76, s[52:55], s85 offen offset:1024 nt
    v_mfma_f32_16x16x32_bf16 v[32:35], a[148:151], v[20:23], 0
    v_mov_b32_dpp v61, v40 quad_perm:[0,0,0,0] row_mask:0xf bank_mask:0xf
    v_mov_b32_dpp v4, v42 quad_perm:[2,2,2,2] row_mask:0xf bank_mask:0xf
    s_nop 0
    v_add_f32_dpp v61, v41, v61 quad_perm:[1,1,1,1] row_mask:0xf bank_mask:0xf
    v_add_f32_dpp v4, v43, v4 quad_perm:[3,3,3,3] row_mask:0xf bank_mask:0xf
    v_add_f32 v61, v61, v4
    v_cvt_pk_bf16_f32 v45, v60, v61
    v_mfma_f32_16x16x32_bf16 v[36:39], a[152:155], v[20:23], 0
    v_mov_b32_dpp v60, v28 quad_perm:[0,0,0,0] row_mask:0xf bank_mask:0xf
    v_mov_b32_dpp v4, v30 quad_perm:[2,2,2,2] row_mask:0xf bank_mask:0xf
    s_nop 0
    v_add_f32_dpp v60, v29, v60 quad_perm:[1,1,1,1] row_mask:0xf bank_mask:0xf
    v_add_f32_dpp v4, v31, v4 quad_perm:[3,3,3,3] row_mask:0xf bank_mask:0xf
    v_add_f32 v60, v60, v4
    v_mfma_f32_16x16x32_bf16 v[40:43], a[156:159], v[20:23], 0
    v_mov_b32_dpp v61, v32 quad_perm:[0,0,0,0] row_mask:0xf bank_mask:0xf
    v_mov_b32_dpp v4, v34 quad_perm:[2,2,2,2] row_mask:0xf bank_mask:0xf
    s_nop 0
    v_add_f32_dpp v61, v33, v61 quad_perm:[1,1,1,1] row_mask:0xf bank_mask:0xf
    v_add_f32_dpp v4, v35, v4 quad_perm:[3,3,3,3] row_mask:0xf bank_mask:0xf
    v_add_f32 v61, v61, v4
    v_cvt_pk_bf16_f32 v46, v60, v61
    v_mfma_f32_16x16x32_bf16 v[28:31], a[160:163], v[20:23], 0
    v_mov_b32_dpp v60, v36 quad_perm:[0,0,0,0] row_mask:0xf bank_mask:0xf
    v_mov_b32_dpp v4, v38 quad_perm:[2,2,2,2] row_mask:0xf bank_mask:0xf
    s_nop 0
    v_add_f32_dpp v60, v37, v60 quad_perm:[1,1,1,1] row_mask:0xf bank_mask:0xf
    v_add_f32_dpp v4, v39, v4 quad_perm:[3,3,3,3] row_mask:0xf bank_mask:0xf
    v_add_f32 v60, v60, v4
    v_mfma_f32_16x16x32_bf16 v[32:35], a[164:167], v[20:23], 0
    v_mov_b32_dpp v61, v40 quad_perm:[0,0,0,0] row_mask:0xf bank_mask:0xf
    v_mov_b32_dpp v4, v42 quad_perm:[2,2,2,2] row_mask:0xf bank_mask:0xf
    s_nop 0
    v_add_f32_dpp v61, v41, v61 quad_perm:[1,1,1,1] row_mask:0xf bank_mask:0xf
    v_add_f32_dpp v4, v43, v4 quad_perm:[3,3,3,3] row_mask:0xf bank_mask:0xf
    v_add_f32 v61, v61, v4
    v_cvt_pk_bf16_f32 v47, v60, v61
    v_mfma_f32_16x16x32_bf16 v[36:39], a[168:171], v[20:23], 0
    v_mov_b32_dpp v60, v28 quad_perm:[0,0,0,0] row_mask:0xf bank_mask:0xf
    v_mov_b32_dpp v4, v30 quad_perm:[2,2,2,2] row_mask:0xf bank_mask:0xf
    s_nop 0
    v_add_f32_dpp v60, v29, v60 quad_perm:[1,1,1,1] row_mask:0xf bank_mask:0xf
    v_add_f32_dpp v4, v31, v4 quad_perm:[3,3,3,3] row_mask:0xf bank_mask:0xf
    v_add_f32 v60, v60, v4
    v_mfma_f32_16x16x32_bf16 v[40:43], a[172:175], v[20:23], 0
    v_mov_b32_dpp v61, v32 quad_perm:[0,0,0,0] row_mask:0xf bank_mask:0xf
    v_mov_b32_dpp v4, v34 quad_perm:[2,2,2,2] row_mask:0xf bank_mask:0xf
    s_nop 0
    v_add_f32_dpp v61, v33, v61 quad_perm:[1,1,1,1] row_mask:0xf bank_mask:0xf
    v_add_f32_dpp v4, v35, v4 quad_perm:[3,3,3,3] row_mask:0xf bank_mask:0xf
    v_add_f32 v61, v61, v4
    v_cvt_pk_bf16_f32 v48, v60, v61
    v_mfma_f32_16x16x32_bf16 v[28:31], a[176:179], v[20:23], 0
    v_mov_b32_dpp v60, v36 quad_perm:[0,0,0,0] row_mask:0xf bank_mask:0xf
    v_mov_b32_dpp v4, v38 quad_perm:[2,2,2,2] row_mask:0xf bank_mask:0xf
    s_nop 0
    v_add_f32_dpp v60, v37, v60 quad_perm:[1,1,1,1] row_mask:0xf bank_mask:0xf
    v_add_f32_dpp v4, v39, v4 quad_perm:[3,3,3,3] row_mask:0xf bank_mask:0xf
    v_add_f32 v60, v60, v4
    buffer_load_dwordx4 v[252:255], v77, s[52:55], s85 offen offset:1024 nt
    s_add_u32 s87, s87, 7
    s_add_u32 s39, s87, s88
    s_bfe_u32 s37, s39, 0x30000
    s_lshl_b32 s37, s37, 12
    s_add_u32 s85, s37, s89
    s_bfe_u32 s37, s39, 0x10003
    s_lshl_b32 s37, s37, 11
    s_add_u32 s85, s37, s85
    s_bfe_u32 s37, s39, 0x40004
    s_lshl_b32 s37, s37, 16
    s_add_u32 s85, s37, s85
    v_mfma_f32_16x16x32_bf16 v[32:35], a[180:183], v[20:23], 0
    v_mov_b32_dpp v61, v40 quad_perm:[0,0,0,0] row_mask:0xf bank_mask:0xf
    v_mov_b32_dpp v4, v42 quad_perm:[2,2,2,2] row_mask:0xf bank_mask:0xf
    s_nop 0
    v_add_f32_dpp v61, v41, v61 quad_perm:[1,1,1,1] row_mask:0xf bank_mask:0xf
    v_add_f32_dpp v4, v43, v4 quad_perm:[3,3,3,3] row_mask:0xf bank_mask:0xf
    v_add_f32 v61, v61, v4
    v_cvt_pk_bf16_f32 v49, v60, v61
    v_mfma_f32_16x16x32_bf16 v[36:39], a[184:187], v[20:23], 0
    v_mov_b32_dpp v60, v28 quad_perm:[0,0,0,0] row_mask:0xf bank_mask:0xf
    v_mov_b32_dpp v4, v30 quad_perm:[2,2,2,2] row_mask:0xf bank_mask:0xf
    s_nop 0
    v_add_f32_dpp v60, v29, v60 quad_perm:[1,1,1,1] row_mask:0xf bank_mask:0xf
    v_add_f32_dpp v4, v31, v4 quad_perm:[3,3,3,3] row_mask:0xf bank_mask:0xf
    v_add_f32 v60, v60, v4
    v_mfma_f32_16x16x32_bf16 v[40:43], a[188:191], v[20:23], 0
    v_mov_b32_dpp v61, v32 quad_perm:[0,0,0,0] row_mask:0xf bank_mask:0xf
    v_mov_b32_dpp v4, v34 quad_perm:[2,2,2,2] row_mask:0xf bank_mask:0xf
    s_nop 0
    v_add_f32_dpp v61, v33, v61 quad_perm:[1,1,1,1] row_mask:0xf bank_mask:0xf
    v_add_f32_dpp v4, v35, v4 quad_perm:[3,3,3,3] row_mask:0xf bank_mask:0xf
    v_add_f32 v61, v61, v4
    v_cvt_pk_bf16_f32 v50, v60, v61
    v_mfma_f32_16x16x32_bf16 v[28:31], a[192:195], v[20:23], 0
    v_mov_b32_dpp v60, v36 quad_perm:[0,0,0,0] row_mask:0xf bank_mask:0xf
    v_mov_b32_dpp v4, v38 quad_perm:[2,2,2,2] row_mask:0xf bank_mask:0xf
    s_nop 0
    v_add_f32_dpp v60, v37, v60 quad_perm:[1,1,1,1] row_mask:0xf bank_mask:0xf
    v_add_f32_dpp v4, v39, v4 quad_perm:[3,3,3,3] row_mask:0xf bank_mask:0xf
    v_add_f32 v60, v60, v4
    v_mfma_f32_16x16x32_bf16 v[32:35], a[196:199], v[20:23], 0
    v_mov_b32_dpp v61, v40 quad_perm:[0,0,0,0] row_mask:0xf bank_mask:0xf
    v_mov_b32_dpp v4, v42 quad_perm:[2,2,2,2] row_mask:0xf bank_mask:0xf
    s_nop 0
    v_add_f32_dpp v61, v41, v61 quad_perm:[1,1,1,1] row_mask:0xf bank_mask:0xf
    v_add_f32_dpp v4, v43, v4 quad_perm:[3,3,3,3] row_mask:0xf bank_mask:0xf
    v_add_f32 v61, v61, v4
    v_cvt_pk_bf16_f32 v51, v60, v61
    v_mfma_f32_16x16x32_bf16 v[36:39], a[200:203], v[20:23], 0
    v_mov_b32_dpp v60, v28 quad_perm:[0,0,0,0] row_mask:0xf bank_mask:0xf
    v_mov_b32_dpp v4, v30 quad_perm:[2,2,2,2] row_mask:0xf bank_mask:0xf
    s_nop 0
    v_add_f32_dpp v60, v29, v60 quad_perm:[1,1,1,1] row_mask:0xf bank_mask:0xf
    v_add_f32_dpp v4, v31, v4 quad_perm:[3,3,3,3] row_mask:0xf bank_mask:0xf
    v_add_f32 v60, v60, v4
    v_mfma_f32_16x16x32_bf16 v[40:43], a[204:207], v[20:23], 0
    v_mov_b32_dpp v61, v32 quad_perm:[0,0,0,0] row_mask:0xf bank_mask:0xf
    v_mov_b32_dpp v4, v34 quad_perm:[2,2,2,2] row_mask:0xf bank_mask:0xf
    s_nop 0
    v_add_f32_dpp v61, v33, v61 quad_perm:[1,1,1,1] row_mask:0xf bank_mask:0xf
    v_add_f32_dpp v4, v35, v4 quad_perm:[3,3,3,3] row_mask:0xf bank_mask:0xf
    v_add_f32 v61, v61, v4
    v_cvt_pk_bf16_f32 v52, v60, v61
    v_mfma_f32_16x16x32_bf16 v[28:31], a[208:211], v[20:23], 0
    v_mov_b32_dpp v60, v36 quad_perm:[0,0,0,0] row_mask:0xf bank_mask:0xf
    v_mov_b32_dpp v4, v38 quad_perm:[2,2,2,2] row_mask:0xf bank_mask:0xf
    s_nop 0
    v_add_f32_dpp v60, v37, v60 quad_perm:[1,1,1,1] row_mask:0xf bank_mask:0xf
    v_add_f32_dpp v4, v39, v4 quad_perm:[3,3,3,3] row_mask:0xf bank_mask:0xf
    v_add_f32 v60, v60, v4
    buffer_load_dwordx4 a[0:3], v76, s[52:55], s85 offen offset:0 nt
    v_mfma_f32_16x16x32_bf16 v[32:35], a[212:215], v[20:23], 0
    v_mov_b32_dpp v61, v40 quad_perm:[0,0,0,0] row_mask:0xf bank_mask:0xf
    v_mov_b32_dpp v4, v42 quad_perm:[2,2,2,2] row_mask:0xf bank_mask:0xf
    s_nop 0
    v_add_f32_dpp v61, v41, v61 quad_perm:[1,1,1,1] row_mask:0xf bank_mask:0xf
    v_add_f32_dpp v4, v43, v4 quad_perm:[3,3,3,3] row_mask:0xf bank_mask:0xf
    v_add_f32 v61, v61, v4
    v_cvt_pk_bf16_f32 v53, v60, v61
    v_mfma_f32_16x16x32_bf16 v[36:39], a[216:219], v[20:23], 0
    v_mov_b32_dpp v60, v28 quad_perm:[0,0,0,0] row_mask:0xf bank_mask:0xf
    v_mov_b32_dpp v4, v30 quad_perm:[2,2,2,2] row_mask:0xf bank_mask:0xf
    s_nop 0
    v_add_f32_dpp v60, v29, v60 quad_perm:[1,1,1,1] row_mask:0xf bank_mask:0xf
    v_add_f32_dpp v4, v31, v4 quad_perm:[3,3,3,3] row_mask:0xf bank_mask:0xf
    v_add_f32 v60, v60, v4
    v_mfma_f32_16x16x32_bf16 v[40:43], a[220:223], v[20:23], 0
    v_mov_b32_dpp v61, v32 quad_perm:[0,0,0,0] row_mask:0xf bank_mask:0xf
    v_mov_b32_dpp v4, v34 quad_perm:[2,2,2,2] row_mask:0xf bank_mask:0xf
    s_nop 0
    v_add_f32_dpp v61, v33, v61 quad_perm:[1,1,1,1] row_mask:0xf bank_mask:0xf
    v_add_f32_dpp v4, v35, v4 quad_perm:[3,3,3,3] row_mask:0xf bank_mask:0xf
    v_add_f32 v61, v61, v4
    v_cvt_pk_bf16_f32 v54, v60, v61
    v_mfma_f32_16x16x32_bf16 v[28:31], a[224:227], v[20:23], 0
    v_mov_b32_dpp v60, v36 quad_perm:[0,0,0,0] row_mask:0xf bank_mask:0xf
    v_mov_b32_dpp v4, v38 quad_perm:[2,2,2,2] row_mask:0xf bank_mask:0xf
    s_nop 0
    v_add_f32_dpp v60, v37, v60 quad_perm:[1,1,1,1] row_mask:0xf bank_mask:0xf
    v_add_f32_dpp v4, v39, v4 quad_perm:[3,3,3,3] row_mask:0xf bank_mask:0xf
    v_add_f32 v60, v60, v4
    v_mfma_f32_16x16x32_bf16 v[32:35], a[228:231], v[20:23], 0
    v_mov_b32_dpp v61, v40 quad_perm:[0,0,0,0] row_mask:0xf bank_mask:0xf
    v_mov_b32_dpp v4, v42 quad_perm:[2,2,2,2] row_mask:0xf bank_mask:0xf
    s_nop 0
    v_add_f32_dpp v61, v41, v61 quad_perm:[1,1,1,1] row_mask:0xf bank_mask:0xf
    v_add_f32_dpp v4, v43, v4 quad_perm:[3,3,3,3] row_mask:0xf bank_mask:0xf
    v_add_f32 v61, v61, v4
    v_cvt_pk_bf16_f32 v55, v60, v61
    v_mfma_f32_16x16x32_bf16 v[36:39], a[232:235], v[20:23], 0
    v_mov_b32_dpp v60, v28 quad_perm:[0,0,0,0] row_mask:0xf bank_mask:0xf
    v_mov_b32_dpp v4, v30 quad_perm:[2,2,2,2] row_mask:0xf bank_mask:0xf
    s_nop 0
    v_add_f32_dpp v60, v29, v60 quad_perm:[1,1,1,1] row_mask:0xf bank_mask:0xf
    v_add_f32_dpp v4, v31, v4 quad_perm:[3,3,3,3] row_mask:0xf bank_mask:0xf
    v_add_f32 v60, v60, v4
    v_mfma_f32_16x16x32_bf16 v[40:43], a[236:239], v[20:23], 0
    v_mov_b32_dpp v61, v32 quad_perm:[0,0,0,0] row_mask:0xf bank_mask:0xf
    v_mov_b32_dpp v4, v34 quad_perm:[2,2,2,2] row_mask:0xf bank_mask:0xf
    s_nop 0
    v_add_f32_dpp v61, v33, v61 quad_perm:[1,1,1,1] row_mask:0xf bank_mask:0xf
    v_add_f32_dpp v4, v35, v4 quad_perm:[3,3,3,3] row_mask:0xf bank_mask:0xf
    v_add_f32 v61, v61, v4
    v_cvt_pk_bf16_f32 v56, v60, v61
    v_mfma_f32_16x16x32_bf16 v[28:31], a[240:243], v[20:23], 0
    v_mov_b32_dpp v60, v36 quad_perm:[0,0,0,0] row_mask:0xf bank_mask:0xf
    v_mov_b32_dpp v4, v38 quad_perm:[2,2,2,2] row_mask:0xf bank_mask:0xf
    s_nop 0
    v_add_f32_dpp v60, v37, v60 quad_perm:[1,1,1,1] row_mask:0xf bank_mask:0xf
    v_add_f32_dpp v4, v39, v4 quad_perm:[3,3,3,3] row_mask:0xf bank_mask:0xf
    v_add_f32 v60, v60, v4
    buffer_load_dwordx4 a[4:7], v77, s[52:55], s85 offen offset:0 nt
    v_mfma_f32_16x16x32_bf16 v[32:35], a[244:247], v[20:23], 0
    v_mov_b32_dpp v61, v40 quad_perm:[0,0,0,0] row_mask:0xf bank_mask:0xf
    v_mov_b32_dpp v4, v42 quad_perm:[2,2,2,2] row_mask:0xf bank_mask:0xf
    s_nop 0
    v_add_f32_dpp v61, v41, v61 quad_perm:[1,1,1,1] row_mask:0xf bank_mask:0xf
    v_add_f32_dpp v4, v43, v4 quad_perm:[3,3,3,3] row_mask:0xf bank_mask:0xf
    v_add_f32 v61, v61, v4
    v_cvt_pk_bf16_f32 v57, v60, v61
    v_mfma_f32_16x16x32_bf16 v[36:39], a[248:251], v[20:23], 0
    v_mov_b32_dpp v60, v28 quad_perm:[0,0,0,0] row_mask:0xf bank_mask:0xf
    v_mov_b32_dpp v4, v30 quad_perm:[2,2,2,2] row_mask:0xf bank_mask:0xf
    s_nop 0
    v_add_f32_dpp v60, v29, v60 quad_perm:[1,1,1,1] row_mask:0xf bank_mask:0xf
    v_add_f32_dpp v4, v31, v4 quad_perm:[3,3,3,3] row_mask:0xf bank_mask:0xf
    v_add_f32 v60, v60, v4
    v_mfma_f32_16x16x32_bf16 v[40:43], a[252:255], v[20:23], 0
    v_mov_b32_dpp v61, v32 quad_perm:[0,0,0,0] row_mask:0xf bank_mask:0xf
    v_mov_b32_dpp v4, v34 quad_perm:[2,2,2,2] row_mask:0xf bank_mask:0xf
    s_nop 0
    v_add_f32_dpp v61, v33, v61 quad_perm:[1,1,1,1] row_mask:0xf bank_mask:0xf
    v_add_f32_dpp v4, v35, v4 quad_perm:[3,3,3,3] row_mask:0xf bank_mask:0xf
    v_add_f32 v61, v61, v4
    v_cvt_pk_bf16_f32 v58, v60, v61
    v_mov_b32_dpp v60, v36 quad_perm:[0,0,0,0] row_mask:0xf bank_mask:0xf
    v_mov_b32_dpp v4, v38 quad_perm:[2,2,2,2] row_mask:0xf bank_mask:0xf
    s_nop 0
    v_add_f32_dpp v60, v37, v60 quad_perm:[1,1,1,1] row_mask:0xf bank_mask:0xf
    v_add_f32_dpp v4, v39, v4 quad_perm:[3,3,3,3] row_mask:0xf bank_mask:0xf
    v_add_f32 v60, v60, v4
    v_mov_b32_dpp v61, v40 quad_perm:[0,0,0,0] row_mask:0xf bank_mask:0xf
    v_mov_b32_dpp v4, v42 quad_perm:[2,2,2,2] row_mask:0xf bank_mask:0xf
    s_nop 0
    v_add_f32_dpp v61, v41, v61 quad_perm:[1,1,1,1] row_mask:0xf bank_mask:0xf
    v_add_f32_dpp v4, v43, v4 quad_perm:[3,3,3,3] row_mask:0xf bank_mask:0xf
    v_add_f32 v61, v61, v4
    v_cvt_pk_bf16_f32 v59, v60, v61
    s_mov_b32 exec_lo, 0x22222222
    s_mov_b32 exec_hi, 0x22222222
    v_mov_b32 v44, v48
    v_mov_b32 v45, v49
    v_mov_b32 v46, v50
    v_mov_b32 v47, v51
    s_mov_b32 exec_lo, 0x44444444
    s_mov_b32 exec_hi, 0x44444444
    v_mov_b32 v44, v52
    v_mov_b32 v45, v53
    v_mov_b32 v46, v54
    v_mov_b32 v47, v55
    s_mov_b32 exec_lo, 0x88888888
    s_mov_b32 exec_hi, 0x88888888
    v_mov_b32 v44, v56
    v_mov_b32 v45, v57
    v_mov_b32 v46, v58
    v_mov_b32 v47, v59
    s_mov_b64 exec, -1
    buffer_store_dwordx4 v[44:47], v19, s[48:51], s94 offen sc1
    s_waitcnt vmcnt(5)
L_qcheck_17:
    v_xor_b32 v68, s35, v68
    v_xor_b32 v69, s35, v69
    v_xor_b32 v70, s35, v70
    v_xor_b32 v71, s35, v71
    v_xor_b32 v72, s35, v72
    v_xor_b32 v73, s35, v73
    v_xor_b32 v74, s35, v74
    v_xor_b32 v75, s35, v75
    v_or_b32 v4, v68, v69
    v_or3_b32 v4, v4, v70, v71
    v_or3_b32 v4, v4, v72, v73
    v_or3_b32 v4, v4, v74, v75
    v_and_b32 v4, 0xff, v4
    v_cmp_ne_u32 vcc, 0, v4
    s_cbranch_vccz L_qok_18
    buffer_load_dwordx4 v[68:71], v78, s[48:51], s91 offen offset:0 sc1
    buffer_load_dwordx4 v[72:75], v78, s[48:51], s91 offen offset:16 sc1
    s_waitcnt vmcnt(0)
    s_sub_u32 s84, s84, 1
    s_cmp_lg_u32 s84, 0
    s_cbranch_scc1 L_qcheck_17
    s_branch L_end
L_qok_18:
    v_cvt_pk_bf16_f32 v68, v68, v69
    v_cvt_pk_bf16_f32 v69, v70, v71
    v_cvt_pk_bf16_f32 v70, v72, v73
    v_cvt_pk_bf16_f32 v71, v74, v75
    s_mov_b32 vcc_lo, 0xf000f
    s_mov_b32 vcc_hi, 0xf000f
    v_cndmask_b32 v80, 0, v68, vcc
    v_cndmask_b32 v81, 0, v69, vcc
    v_cndmask_b32 v82, 0, v70, vcc
    v_cndmask_b32 v83, 0, v71, vcc
    s_mov_b32 vcc_lo, 0xf000f0
    s_mov_b32 vcc_hi, 0xf000f0
    v_cndmask_b32 v84, 0, v68, vcc
    v_cndmask_b32 v85, 0, v69, vcc
    v_cndmask_b32 v86, 0, v70, vcc
    v_cndmask_b32 v87, 0, v71, vcc
    s_mov_b32 vcc_lo, 0xf000f00
    s_mov_b32 vcc_hi, 0xf000f00
    v_cndmask_b32 v88, 0, v68, vcc
    v_cndmask_b32 v89, 0, v69, vcc
    v_cndmask_b32 v90, 0, v70, vcc
    v_cndmask_b32 v91, 0, v71, vcc
    s_mov_b32 vcc_lo, 0xf000f000
    s_mov_b32 vcc_hi, 0xf000f000
    v_cndmask_b32 v92, 0, v68, vcc
    v_cndmask_b32 v93, 0, v69, vcc
    v_cndmask_b32 v94, 0, v70, vcc
    v_cndmask_b32 v95, 0, v71, vcc
    v_mov_b32 v65, 0xff7f0000
    s_lshl_b32 s38, s34, 14
    s_add_u32 s38, s38, 16384
    v_lshl_add_u32 v64, v1, 2, s38
    buffer_load_dwordx4 a[8:11], v76, s[52:55], s85 offen offset:1024 nt
    v_mfma_f32_16x16x32_bf16 v[112:115], v[128:131], v[80:83], 0
    v_mfma_f32_16x16x32_bf16 v[112:115], v[132:135], v[84:87], v[112:115]
    buffer_load_dwordx4 a[12:15], v77, s[52:55], s85 offen offset:1024 nt
    s_add_u32 s87, s87, 7
    s_add_u32 s39, s87, s88
    s_bfe_u32 s37, s39, 0x30000
    s_lshl_b32 s37, s37, 12
    s_add_u32 s85, s37, s89
    s_bfe_u32 s37, s39, 0x10003
    s_lshl_b32 s37, s37, 11
    s_add_u32 s85, s37, s85
    s_bfe_u32 s37, s39, 0x40004
    s_lshl_b32 s37, s37, 16
    s_add_u32 s85, s37, s85
    v_mfma_f32_16x16x32_bf16 v[112:115], v[136:139], v[88:91], v[112:115]
    v_mfma_f32_16x16x32_bf16 v[112:115], v[140:143], v[92:95], v[112:115]
    buffer_load_dwordx4 a[16:19], v76, s[52:55], s85 offen offset:0 nt
    v_mfma_f32_16x16x32_bf16 v[96:99], v[144:147], v[80:83], 0
    v_mfma_f32_16x16x32_bf16 v[96:99], v[148:151], v[84:87], v[96:99]
    v_mfma_f32_16x16x32_bf16 v[96:99], v[152:155], v[88:91], v[96:99]
    s_nop 3
    v_mov_b32_dpp v122, v112 quad_perm:[0,0,0,0] row_mask:0xf bank_mask:0xf
    v_mov_b32_dpp v124, v114 quad_perm:[2,2,2,2] row_mask:0xf bank_mask:0xf
    s_nop 0
    v_add_f32_dpp v122, v113, v122 quad_perm:[1,1,1,1] row_mask:0xf bank_mask:0xf
    v_add_f32_dpp v124, v115, v124 quad_perm:[3,3,3,3] row_mask:0xf bank_mask:0xf
    v_add_f32 v122, v122, v124
    v_max_f32 v65, v65, v122
    ds_write_b32 v64, v122 offset:0
    s_waitcnt vmcnt(7)
    buffer_load_dwordx4 a[20:23], v77, s[52:55], s85 offen offset:0 nt
    v_mfma_f32_16x16x32_bf16 v[96:99], v[156:159], v[92:95], v[96:99]
    v_mfma_f32_16x16x32_bf16 v[112:115], v[160:163], v[80:83], 0
    s_waitcnt vmcnt(7)
    buffer_load_dwordx4 a[24:27], v76, s[52:55], s85 offen offset:1024 nt
    v_mfma_f32_16x16x32_bf16 v[112:115], v[164:167], v[84:87], v[112:115]
    v_mfma_f32_16x16x32_bf16 v[112:115], v[168:171], v[88:91], v[112:115]
    s_nop 2
    v_mov_b32_dpp v122, v96 quad_perm:[0,0,0,0] row_mask:0xf bank_mask:0xf
    v_mov_b32_dpp v124, v98 quad_perm:[2,2,2,2] row_mask:0xf bank_mask:0xf
    s_nop 0
    v_add_f32_dpp v122, v97, v122 quad_perm:[1,1,1,1] row_mask:0xf bank_mask:0xf
    v_add_f32_dpp v124, v99, v124 quad_perm:[3,3,3,3] row_mask:0xf bank_mask:0xf
    v_add_f32 v122, v122, v124
    v_max_f32 v65, v65, v122
    ds_write_b32 v64, v122 offset:256
    v_mfma_f32_16x16x32_bf16 v[112:115], v[172:175], v[92:95], v[112:115]
    s_waitcnt vmcnt(7)
    buffer_load_dwordx4 a[28:31], v77, s[52:55], s85 offen offset:1024 nt
    s_add_u32 s87, s87, 7
    s_add_u32 s39, s87, s88
    s_bfe_u32 s37, s39, 0x30000
    s_lshl_b32 s37, s37, 12
    s_add_u32 s85, s37, s89
    s_bfe_u32 s37, s39, 0x10003
    s_lshl_b32 s37, s37, 11
    s_add_u32 s85, s37, s85
    s_bfe_u32 s37, s39, 0x40004
    s_lshl_b32 s37, s37, 16
    s_add_u32 s85, s37, s85
    v_mfma_f32_16x16x32_bf16 v[96:99], v[176:179], v[80:83], 0
    v_mfma_f32_16x16x32_bf16 v[96:99], v[180:183], v[84:87], v[96:99]
    s_waitcnt vmcnt(7)
    buffer_load_dwordx4 a[32:35], v76, s[52:55], s85 offen offset:0 nt
    v_mfma_f32_16x16x32_bf16 v[96:99], v[184:187], v[88:91], v[96:99]
    v_mov_b32_dpp v122, v112 quad_perm:[0,0,0,0] row_mask:0xf bank_mask:0xf
    v_mov_b32_dpp v124, v114 quad_perm:[2,2,2,2] row_mask:0xf bank_mask:0xf
    s_nop 0
    v_add_f32_dpp v122, v113, v122 quad_perm:[1,1,1,1] row_mask:0xf bank_mask:0xf
    v_add_f32_dpp v124, v115, v124 quad_perm:[3,3,3,3] row_mask:0xf bank_mask:0xf
    v_add_f32 v122, v122, v124
    v_max_f32 v65, v65, v122
    ds_write_b32 v64, v122 offset:512
    v_mfma_f32_16x16x32_bf16 v[96:99], v[188:191], v[92:95], v[96:99]
    s_lshl_b32 s38, s34, 5
    s_add_u32 s38, s38, s32
    s_lshl_b32 s38, s38, 8
    s_add_u32 s38, s38, 131072
    v_mov_b32 v28, s38
    v_mov_b32 v29, s68
    s_waitcnt vmcnt(7)
    s_mov_b64 exec, 1
    buffer_store_dword v29, v28, s[48:51], 0 offen sc1
    s_mov_b64 exec, -1
    s_waitcnt vmcnt(7)
    buffer_load_dwordx4 a[36:39], v77, s[52:55], s85 offen offset:0 nt
    v_mfma_f32_16x16x32_bf16 v[112:115], v[192:195], v[80:83], 0
    v_mfma_f32_16x16x32_bf16 v[112:115], v[196:199], v[84:87], v[112:115]
    v_mfma_f32_16x16x32_bf16 v[112:115], v[200:203], v[88:91], v[112:115]
    v_mov_b32_dpp v122, v96 quad_perm:[0,0,0,0] row_mask:0xf bank_mask:0xf
    v_mov_b32_dpp v124, v98 quad_perm:[2,2,2,2] row_mask:0xf bank_mask:0xf
    s_nop 0
    v_add_f32_dpp v122, v97, v122 quad_perm:[1,1,1,1] row_mask:0xf bank_mask:0xf
    v_add_f32_dpp v124, v99, v124 quad_perm:[3,3,3,3] row_mask:0xf bank_mask:0xf
    v_add_f32 v122, v122, v124
    v_max_f32 v65, v65, v122
    ds_write_b32 v64, v122 offset:768
    s_waitcnt vmcnt(7)
    buffer_load_dwordx4 a[40:43], v76, s[52:55], s85 offen offset:1024 nt
    v_mfma_f32_16x16x32_bf16 v[112:115], v[204:207], v[92:95], v[112:115]
    v_mfma_f32_16x16x32_bf16 v[96:99], v[208:211], v[80:83], 0
    s_waitcnt vmcnt(7)
    buffer_load_dwordx4 a[44:47], v77, s[52:55], s85 offen offset:1024 nt
    s_add_u32 s87, s87, 7
    s_add_u32 s39, s87, s88
    s_bfe_u32 s37, s39, 0x30000
    s_lshl_b32 s37, s37, 12
    s_add_u32 s85, s37, s89
    s_bfe_u32 s37, s39, 0x10003
    s_lshl_b32 s37, s37, 11
    s_add_u32 s85, s37, s85
    s_bfe_u32 s37, s39, 0x40004
    s_lshl_b32 s37, s37, 16
    s_add_u32 s85, s37, s85
    v_mfma_f32_16x16x32_bf16 v[96:99], v[212:215], v[84:87], v[96:99]
    v_mfma_f32_16x16x32_bf16 v[96:99], v[216:219], v[88:91], v[96:99]
    v_mov_b32_dpp v122, v112 quad_perm:[0,0,0,0] row_mask:0xf bank_mask:0xf
    v_mov_b32_dpp v124, v114 quad_perm:[2,2,2,2] row_mask:0xf bank_mask:0xf
    s_nop 0
    v_add_f32_dpp v122, v113, v122 quad_perm:[1,1,1,1] row_mask:0xf bank_mask:0xf
    v_add_f32_dpp v124, v115, v124 quad_perm:[3,3,3,3] row_mask:0xf bank_mask:0xf
    v_add_f32 v122, v122, v124
    v_max_f32 v65, v65, v122
    ds_write_b32 v64, v122 offset:1024
    v_mfma_f32_16x16x32_bf16 v[96:99], v[220:223], v[92:95], v[96:99]
    s_waitcnt vmcnt(7)
    buffer_load_dwordx4 a[48:51], v76, s[52:55], s85 offen offset:0 nt
    v_mfma_f32_16x16x32_bf16 v[112:115], v[224:227], v[80:83], 0
    v_mfma_f32_16x16x32_bf16 v[112:115], v[228:231], v[84:87], v[112:115]
    s_waitcnt vmcnt(7)
    buffer_load_dwordx4 a[52:55], v77, s[52:55], s85 offen offset:0 nt
    v_mfma_f32_16x16x32_bf16 v[112:115], v[232:235], v[88:91], v[112:115]
    s_nop 0
    v_mov_b32_dpp v122, v96 quad_perm:[0,0,0,0] row_mask:0xf bank_mask:0xf
    v_mov_b32_dpp v124, v98 quad_perm:[2,2,2,2] row_mask:0xf bank_mask:0xf
    s_nop 0
    v_add_f32_dpp v122, v97, v122 quad_perm:[1,1,1,1] row_mask:0xf bank_mask:0xf
    v_add_f32_dpp v124, v99, v124 quad_perm:[3,3,3,3] row_mask:0xf bank_mask:0xf
    v_add_f32 v122, v122, v124
    v_max_f32 v65, v65, v122
    ds_write_b32 v64, v122 offset:1280
    v_mfma_f32_16x16x32_bf16 v[112:115], v[236:239], v[92:95], v[112:115]
    s_waitcnt vmcnt(7)
    buffer_load_dwordx4 a[56:59], v76, s[52:55], s85 offen offset:1024 nt
    v_mfma_f32_16x16x32_bf16 v[96:99], v[240:243], v[80:83], 0
    v_mfma_f32_16x16x32_bf16 v[96:99], v[244:247], v[84:87], v[96:99]
    v_mfma_f32_16x16x32_bf16 v[96:99], v[248:251], v[88:91], v[96:99]
    s_nop 2
    v_mov_b32_dpp v122, v112 quad_perm:[0,0,0,0] row_mask:0xf bank_mask:0xf
    v_mov_b32_dpp v124, v114 quad_perm:[2,2,2,2] row_mask:0xf bank_mask:0xf
    s_nop 0
    v_add_f32_dpp v122, v113, v122 quad_perm:[1,1,1,1] row_mask:0xf bank_mask:0xf
    v_add_f32_dpp v124, v115, v124 quad_perm:[3,3,3,3] row_mask:0xf bank_mask:0xf
    v_add_f32 v122, v122, v124
    v_max_f32 v65, v65, v122
    ds_write_b32 v64, v122 offset:1536
    s_waitcnt vmcnt(7)
    buffer_load_dwordx4 a[60:63], v77, s[52:55], s85 offen offset:1024 nt
    s_add_u32 s87, s87, 7
    s_add_u32 s39, s87, s88
    s_bfe_u32 s37, s39, 0x30000
    s_lshl_b32 s37, s37, 12
    s_add_u32 s85, s37, s89
    s_bfe_u32 s37, s39, 0x10003
    s_lshl_b32 s37, s37, 11
    s_add_u32 s85, s37, s85
    s_bfe_u32 s37, s39, 0x40004
    s_lshl_b32 s37, s37, 16
    s_add_u32 s85, s37, s85
    v_mfma_f32_16x16x32_bf16 v[96:99], v[252:255], v[92:95], v[96:99]
    v_mfma_f32_16x16x32_bf16 v[112:115], a[0:3], v[80:83], 0
    s_waitcnt vmcnt(5)
    buffer_load_dwordx4 v[128:131], v76, s[52:55], s85 offen offset:0 nt
    v_mfma_f32_16x16x32_bf16 v[112:115], a[4:7], v[84:87], v[112:115]
    v_mfma_f32_16x16x32_bf16 v[112:115], a[8:11], v[88:91], v[112:115]
    s_nop 2
    v_mov_b32_dpp v122, v96 quad_perm:[0,0,0,0] row_mask:0xf bank_mask:0xf
    v_mov_b32_dpp v124, v98 quad_perm:[2,2,2,2] row_mask:0xf bank_mask:0xf
    s_nop 0
    v_add_f32_dpp v122, v97, v122 quad_perm:[1,1,1,1] row_mask:0xf bank_mask:0xf
    v_add_f32_dpp v124, v99, v124 quad_perm:[3,3,3,3] row_mask:0xf bank_mask:0xf
    v_add_f32 v122, v122, v124
    v_max_f32 v65, v65, v122
    ds_write_b32 v64, v122 offset:1792
    v_mfma_f32_16x16x32_bf16 v[112:115], a[12:15], v[92:95], v[112:115]
    s_waitcnt vmcnt(5)
    buffer_load_dwordx4 v[132:135], v77, s[52:55], s85 offen offset:0 nt
    v_mfma_f32_16x16x32_bf16 v[96:99], a[16:19], v[80:83], 0
    v_mfma_f32_16x16x32_bf16 v[96:99], a[20:23], v[84:87], v[96:99]
    s_waitcnt vmcnt(5)
    buffer_load_dwordx4 v[136:139], v76, s[52:55], s85 offen offset:1024 nt
    v_mfma_f32_16x16x32_bf16 v[96:99], a[24:27], v[88:91], v[96:99]
    s_nop 0
    v_mov_b32_dpp v122, v112 quad_perm:[0,0,0,0] row_mask:0xf bank_mask:0xf
    v_mov_b32_dpp v124, v114 quad_perm:[2,2,2,2] row_mask:0xf bank_mask:0xf
    s_nop 0
    v_add_f32_dpp v122, v113, v122 quad_perm:[1,1,1,1] row_mask:0xf bank_mask:0xf
    v_add_f32_dpp v124, v115, v124 quad_perm:[3,3,3,3] row_mask:0xf bank_mask:0xf
    v_add_f32 v122, v122, v124
    v_max_f32 v65, v65, v122
    ds_write_b32 v64, v122 offset:2048
    v_mfma_f32_16x16x32_bf16 v[96:99], a[28:31], v[92:95], v[96:99]
    s_waitcnt vmcnt(5)
    buffer_load_dwordx4 v[140:143], v77, s[52:55], s85 offen offset:1024 nt
    s_add_u32 s87, s87, 7
    s_add_u32 s39, s87, s88
    s_bfe_u32 s37, s39, 0x30000
    s_lshl_b32 s37, s37, 12
    s_add_u32 s85, s37, s89
    s_bfe_u32 s37, s39, 0x10003
    s_lshl_b32 s37, s37, 11
    s_add_u32 s85, s37, s85
    s_bfe_u32 s37, s39, 0x40004
    s_lshl_b32 s37, s37, 16
    s_add_u32 s85, s37, s85
    v_mfma_f32_16x16x32_bf16 v[112:115], a[32:35], v[80:83], 0
    v_mfma_f32_16x16x32_bf16 v[112:115], a[36:39], v[84:87], v[112:115]
    v_mfma_f32_16x16x32_bf16 v[112:115], a[40:43], v[88:91], v[112:115]
    v_mov_b32_dpp v122, v96 quad_perm:[0,0,0,0] row_mask:0xf bank_mask:0xf
    v_mov_b32_dpp v124, v98 quad_perm:[2,2,2,2] row_mask:0xf bank_mask:0xf
    s_nop 0
    v_add_f32_dpp v122, v97, v122 quad_perm:[1,1,1,1] row_mask:0xf bank_mask:0xf
    v_add_f32_dpp v124, v99, v124 quad_perm:[3,3,3,3] row_mask:0xf bank_mask:0xf
    v_add_f32 v122, v122, v124
    v_max_f32 v65, v65, v122
    ds_write_b32 v64, v122 offset:2304
    s_waitcnt vmcnt(5)
    buffer_load_dwordx4 v[144:147], v76, s[52:55], s85 offen offset:0 nt
    v_mfma_f32_16x16x32_bf16 v[112:115], a[44:47], v[92:95], v[112:115]
    v_mfma_f32_16x16x32_bf16 v[96:99], a[48:51], v[80:83], 0
    s_waitcnt vmcnt(5)
    buffer_load_dwordx4 v[148:151], v77, s[52:55], s85 offen offset:0 nt
    v_mfma_f32_16x16x32_bf16 v[96:99], a[52:55], v[84:87], v[96:99]
    v_mfma_f32_16x16x32_bf16 v[96:99], a[56:59], v[88:91], v[96:99]
    s_nop 2
    v_mov_b32_dpp v122, v112 quad_perm:[0,0,0,0] row_mask:0xf bank_mask:0xf
    v_mov_b32_dpp v124, v114 quad_perm:[2,2,2,2] row_mask:0xf bank_mask:0xf
    s_nop 0
    v_add_f32_dpp v122, v113, v122 quad_perm:[1,1,1,1] row_mask:0xf bank_mask:0xf
    v_add_f32_dpp v124, v115, v124 quad_perm:[3,3,3,3] row_mask:0xf bank_mask:0xf
    v_add_f32 v122, v122, v124
    v_max_f32 v65, v65, v122
    ds_write_b32 v64, v122 offset:2560
    v_mfma_f32_16x16x32_bf16 v[96:99], a[60:63], v[92:95], v[96:99]
    v_add_u32 v64, 2816, v64
    s_mov_b32 s97, 10
    s_mov_b32 s86, 32
    s_add_u32 s92, s33, 224
    s_mov_b32 s66, 134217728
    s_mov_b32 s67, 0x20000
    s_mov_b64 s[64:65], s[52:53]
    v_mov_b32 v62, v76
    v_mov_b32 v63, v77
    s_branch L_bloop
L_aux:
    v_lshlrev_b32 v4, 2, v2
    v_xor_b32 v4, v4, v3
    v_xor_b32 v96, 0, v4
    v_lshlrev_b32 v96, 4, v96
    v_lshl_add_u32 v10, v2, 13, v96
    v_xor_b32 v97, 1, v4
    v_lshlrev_b32 v97, 4, v97
    v_lshl_add_u32 v11, v2, 13, v97
    v_add_u32 v11, 31744, v11
    v_xor_b32 v98, 2, v4
    v_lshlrev_b32 v98, 4, v98
    v_lshl_add_u32 v12, v2, 13, v98
    v_add_u32 v12, 63488, v12
    v_xor_b32 v99, 3, v4
    v_lshlrev_b32 v99, 4, v99
    v_lshl_add_u32 v13, v2, 13, v99
    v_add_u32 v13, 95232, v13
    s_lshl_b32 s90, s34, 15
    s_mov_b32 s62, 0
    s_mov_b32 s94, 0
    s_lshl_b32 s95, s34, 20
    s_lshl_b32 s38, s32, 8
    s_add_u32 s95, s95, s38
    s_waitcnt lgkmcnt(0)
    s_mov_b32 s52, s12
    s_and_b32 s53, s13, 0xffff
    s_mov_b32 s54, 4194304
    s_mov_b32 s55, 0x20000
    s_add_u32 s39, s90, s62
    s_mov_b32 m0, s39
    s_add_u32 s62, s62, 4096
    s_and_b32 s62, s62, 0x7fff
    buffer_load_dwordx4 v10, s[52:55], s95 offen offset:0 nt lds
    buffer_load_dwordx4 v11, s[52:55], s95 offen offset:1024 nt lds
    buffer_load_dwordx4 v12, s[52:55], s95 offen offset:2048 nt lds
    buffer_load_dwordx4 v13, s[52:55], s95 offen offset:3072 nt lds
    s_add_u32 s95, s95, 131072
    s_add_u32 s39, s90, s62
    s_mov_b32 m0, s39
    s_add_u32 s62, s62, 4096
    s_and_b32 s62, s62, 0x7fff
    buffer_load_dwordx4 v10, s[52:55], s95 offen offset:0 nt lds
    buffer_load_dwordx4 v11, s[52:55], s95 offen offset:1024 nt lds
    buffer_load_dwordx4 v12, s[52:55], s95 offen offset:2048 nt lds
    buffer_load_dwordx4 v13, s[52:55], s95 offen offset:3072 nt lds
    s_add_u32 s95, s95, 131072
    s_getpc_b64 s[36:37]
L_pc_19:
    s_sub_u32 s36, s36, L_pc_19 - concat_heads__compressed_kv_cla__mha_block_cached__decode_kernel
    s_subb_u32 s37, s37, 0
    s_lshl_b32 s38, s32, 10
    v_lshl_add_u32 v6, v0, 2, s38
    v_mov_b32 v7, s37
    v_add_co_u32 v6, vcc, s36, v6
    s_nop 1
    v_addc_co_u32 v7, vcc, 0, v7, vcc
    global_load_dword v0, v[6:7], off
    s_load_dword s35, s[30:31], 0
    s_mov_b32 s48, s30
    s_and_b32 s49, s31, 0xffff
    s_mov_b32 s50, 8388608
    s_mov_b32 s51, 0x20000
    s_mov_b32 s82, 0xffffff00
    s_mov_b32 s83, 0x3e0293ee
    s_mov_b32 s84, 2097152
    s_mov_b32 s72, s26
    s_and_b32 s73, s27, 0xffff
    s_mov_b32 s74, 8192
    s_mov_b32 s75, 0x20000
    v_lshl_add_u32 v76, v2, 10, v96
    v_lshl_add_u32 v96, v2, 8, v96
    v_lshl_add_u32 v77, v2, 10, v97
    v_lshl_add_u32 v97, v2, 8, v97
    v_add_u32 v77, 3072, v77
    v_lshl_add_u32 v78, v2, 10, v98
    v_lshl_add_u32 v98, v2, 8, v98
    v_add_u32 v78, 6144, v78
    v_lshl_add_u32 v79, v2, 10, v99
    v_lshl_add_u32 v99, v2, 8, v99
    v_add_u32 v79, 9216, v79
    v_mov_b32 v100, 0
    v_and_b32 v101, 31, v1
    s_lshl_b32 s38, s34, 13
    v_lshl_add_u32 v101, v101, 8, s38
    v_lshlrev_b32 v4, 4, v3
    v_lshl_add_u32 v19, v2, 13, v4
    v_lshl_add_u32 v9, v2, 10, v4
    s_lshl_b32 s63, s32, 17
    s_lshl_b32 s38, s34, 8
    s_add_u32 s63, s63, s38
    v_and_b32 v4, 3, v1
    v_bfe_u32 v5, v1, 2, 2
    v_lshrrev_b32 v6, 5, v1
    v_lshl_add_u32 v7, v4, 2, v5
    v_xor_b32 v7, v7, v6
    v_lshlrev_b32 v7, 4, v7
    v_and_b32 v80, 31, v1
    v_lshl_add_u32 v80, v80, 8, v7
    v_lshl_add_u32 v81, v6, 2, v5
    v_lshlrev_b32 v81, 8, v81
    v_lshl_add_u32 v81, v5, 6, v81
    v_bfe_u32 v7, v1, 4, 1
    v_lshlrev_b32 v7, 1, v7
    v_bfe_u32 v82, v1, 1, 1
    v_add_u32 v7, v7, v82
    v_xor_b32 v7, v7, v6
    v_lshl_add_u32 v81, v7, 4, v81
    v_and_b32 v7, 1, v1
    v_lshl_add_u32 v81, v7, 3, v81
    v_lshl_add_u32 v95, v2, 3, v5
    v_lshlrev_b32 v95, 8, v95
    v_lshl_add_u32 v95, v5, 6, v95
    v_bfe_u32 v4, v1, 4, 1
    v_lshl_add_u32 v4, v4, 1, v82
    v_lshl_add_u32 v95, v4, 4, v95
    v_lshl_add_u32 v95, v7, 3, v95
    v_add_u32 v95, s90, v95
    v_xor_b32 v136, 0, v95
    v_xor_b32 v137, 16, v95
    v_xor_b32 v138, 32, v95
    v_xor_b32 v139, 48, v95
    v_xor_b32 v140, 64, v95
    v_xor_b32 v141, 80, v95
    v_xor_b32 v142, 96, v95
    v_xor_b32 v143, 112, v95
    v_xor_b32 v144, 128, v95
    v_xor_b32 v145, 144, v95
    v_xor_b32 v146, 160, v95
    v_xor_b32 v147, 176, v95
    v_xor_b32 v148, 192, v95
    v_xor_b32 v149, 208, v95
    v_xor_b32 v150, 224, v95
    v_xor_b32 v151, 240, v95
    s_lshl_b32 s85, s34, 13
    s_add_u32 s85, s85, 131072
    v_lshl_add_u32 v94, v1, 4, s85
    v_add_u32 v96, s85, v96
    v_add_u32 v97, s85, v97
    v_add_u32 v98, s85, v98
    v_add_u32 v99, s85, v99
    s_add_u32 s39, s90, s62
    s_mov_b32 m0, s39
    s_add_u32 s62, s62, 4096
    s_and_b32 s62, s62, 0x7fff
    buffer_load_dwordx4 v10, s[52:55], s95 offen offset:0 nt lds
    buffer_load_dwordx4 v11, s[52:55], s95 offen offset:1024 nt lds
    buffer_load_dwordx4 v12, s[52:55], s95 offen offset:2048 nt lds
    buffer_load_dwordx4 v13, s[52:55], s95 offen offset:3072 nt lds
    s_add_u32 s95, s95, 131072
    s_add_u32 s39, s90, s62
    s_mov_b32 m0, s39
    s_add_u32 s62, s62, 4096
    s_and_b32 s62, s62, 0x7fff
    buffer_load_dwordx4 v10, s[52:55], s95 offen offset:0 nt lds
    buffer_load_dwordx4 v11, s[52:55], s95 offen offset:1024 nt lds
    buffer_load_dwordx4 v12, s[52:55], s95 offen offset:2048 nt lds
    buffer_load_dwordx4 v13, s[52:55], s95 offen offset:3072 nt lds
    s_add_u32 s95, s95, 131072
    s_add_u32 s39, s90, s62
    s_mov_b32 m0, s39
    s_add_u32 s62, s62, 4096
    s_and_b32 s62, s62, 0x7fff
    buffer_load_dwordx4 v10, s[52:55], s95 offen offset:0 nt lds
    buffer_load_dwordx4 v11, s[52:55], s95 offen offset:1024 nt lds
    buffer_load_dwordx4 v12, s[52:55], s95 offen offset:2048 nt lds
    buffer_load_dwordx4 v13, s[52:55], s95 offen offset:3072 nt lds
    s_add_u32 s95, s95, 131072
    s_add_u32 s39, s90, s62
    s_mov_b32 m0, s39
    s_add_u32 s62, s62, 4096
    s_and_b32 s62, s62, 0x7fff
    buffer_load_dwordx4 v10, s[52:55], s95 offen offset:0 nt lds
    buffer_load_dwordx4 v11, s[52:55], s95 offen offset:1024 nt lds
    buffer_load_dwordx4 v12, s[52:55], s95 offen offset:2048 nt lds
    buffer_load_dwordx4 v13, s[52:55], s95 offen offset:3072 nt lds
    s_add_u32 s95, s95, 131072
    s_add_u32 s39, s90, s62
    s_mov_b32 m0, s39
    s_add_u32 s62, s62, 4096
    s_and_b32 s62, s62, 0x7fff
    buffer_load_dwordx4 v10, s[52:55], s95 offen offset:0 nt lds
    buffer_load_dwordx4 v11, s[52:55], s95 offen offset:1024 nt lds
    buffer_load_dwordx4 v12, s[52:55], s95 offen offset:2048 nt lds
    buffer_load_dwordx4 v13, s[52:55], s95 offen offset:3072 nt lds
    s_add_u32 s95, s95, 131072
    s_add_u32 s39, s90, s62
    s_mov_b32 m0, s39
    s_add_u32 s62, s62, 4096
    s_and_b32 s62, s62, 0x7fff
    buffer_load_dwordx4 v10, s[52:55], s95 offen offset:0 nt lds
    buffer_load_dwordx4 v11, s[52:55], s95 offen offset:1024 nt lds
    buffer_load_dwordx4 v12, s[52:55], s95 offen offset:2048 nt lds
    buffer_load_dwordx4 v13, s[52:55], s95 offen offset:3072 nt lds
    s_add_u32 s95, s95, 131072
    s_waitcnt lgkmcnt(0)
    s_add_u32 s35, s35, 0x5b
    s_and_b32 s35, s35, 0xff
    v_mov_b32 v8, s35
    s_or_b32 s68, s35, 0x6b3ac500
    s_mov_b32 s52, s14
    s_and_b32 s53, s15, 0xffff
    s_mov_b32 s54, 4194304
    s_mov_b32 s55, 0x20000
    s_mov_b32 s95, s63
    s_waitcnt vmcnt(25)
    ds_read_b64_tr_b16 a[128:129], v136 offset:0
    ds_read_b64_tr_b16 a[130:131], v137 offset:1024
    ds_read_b64_tr_b16 a[144:145], v138 offset:0
    ds_read_b64_tr_b16 a[146:147], v139 offset:1024
    ds_read_b64_tr_b16 a[160:161], v140 offset:0
    ds_read_b64_tr_b16 a[162:163], v141 offset:1024
    ds_read_b64_tr_b16 a[176:177], v142 offset:0
    ds_read_b64_tr_b16 a[178:179], v143 offset:1024
    ds_read_b64_tr_b16 a[192:193], v144 offset:0
    ds_read_b64_tr_b16 a[194:195], v145 offset:1024
    ds_read_b64_tr_b16 a[208:209], v146 offset:0
    ds_read_b64_tr_b16 a[210:211], v147 offset:1024
    ds_read_b64_tr_b16 a[224:225], v148 offset:0
    ds_read_b64_tr_b16 a[226:227], v149 offset:1024
    ds_read_b64_tr_b16 a[240:241], v150 offset:0
    ds_read_b64_tr_b16 a[242:243], v151 offset:1024
    s_waitcnt lgkmcnt(0)
    s_add_u32 s39, s90, s62
    s_mov_b32 m0, s39
    s_add_u32 s62, s62, 4096
    s_and_b32 s62, s62, 0x7fff
    buffer_load_dwordx4 v76, s[52:55], s95 offen offset:0 nt lds
    buffer_load_dwordx4 v77, s[52:55], s95 offen offset:1024 nt lds
    buffer_load_dwordx4 v78, s[52:55], s95 offen offset:2048 nt lds
    buffer_load_dwordx4 v79, s[52:55], s95 offen offset:3072 nt lds
    s_add_u32 s95, s95, 16384
    s_add_u32 s39, s90, s62
    s_mov_b32 m0, s39
    s_add_u32 s62, s62, 4096
    s_and_b32 s62, s62, 0x7fff
    buffer_load_dwordx4 v76, s[52:55], s95 offen offset:0 nt lds
    buffer_load_dwordx4 v77, s[52:55], s95 offen offset:1024 nt lds
    buffer_load_dwordx4 v78, s[52:55], s95 offen offset:2048 nt lds
    buffer_load_dwordx4 v79, s[52:55], s95 offen offset:3072 nt lds
    s_add_u32 s95, s95, 16384
    s_waitcnt vmcnt(24)
    ds_read_b64_tr_b16 a[132:133], v136 offset:8192
    ds_read_b64_tr_b16 a[134:135], v137 offset:9216
    ds_read_b64_tr_b16 a[148:149], v138 offset:8192
    ds_read_b64_tr_b16 a[150:151], v139 offset:9216
    ds_read_b64_tr_b16 a[164:165], v140 offset:8192
    ds_read_b64_tr_b16 a[166:167], v141 offset:9216
    ds_read_b64_tr_b16 a[180:181], v142 offset:8192
    ds_read_b64_tr_b16 a[182:183], v143 offset:9216
    ds_read_b64_tr_b16 a[196:197], v144 offset:8192
    ds_read_b64_tr_b16 a[198:199], v145 offset:9216
    ds_read_b64_tr_b16 a[212:213], v146 offset:8192
    ds_read_b64_tr_b16 a[214:215], v147 offset:9216
    ds_read_b64_tr_b16 a[228:229], v148 offset:8192
    ds_read_b64_tr_b16 a[230:231], v149 offset:9216
    ds_read_b64_tr_b16 a[244:245], v150 offset:8192
    ds_read_b64_tr_b16 a[246:247], v151 offset:9216
    s_waitcnt lgkmcnt(0)
    s_add_u32 s39, s90, s62
    s_mov_b32 m0, s39
    s_add_u32 s62, s62, 4096
    s_and_b32 s62, s62, 0x7fff
    buffer_load_dwordx4 v76, s[52:55], s95 offen offset:0 nt lds
    buffer_load_dwordx4 v77, s[52:55], s95 offen offset:1024 nt lds
    buffer_load_dwordx4 v78, s[52:55], s95 offen offset:2048 nt lds
    buffer_load_dwordx4 v79, s[52:55], s95 offen offset:3072 nt lds
    s_add_u32 s95, s95, 16384
    s_add_u32 s39, s90, s62
    s_mov_b32 m0, s39
    s_add_u32 s62, s62, 4096
    s_and_b32 s62, s62, 0x7fff
    buffer_load_dwordx4 v76, s[52:55], s95 offen offset:0 nt lds
    buffer_load_dwordx4 v77, s[52:55], s95 offen offset:1024 nt lds
    buffer_load_dwordx4 v78, s[52:55], s95 offen offset:2048 nt lds
    buffer_load_dwordx4 v79, s[52:55], s95 offen offset:3072 nt lds
    s_add_u32 s95, s95, 16384
    s_waitcnt vmcnt(24)
    ds_read_b64_tr_b16 a[136:137], v136 offset:16384
    ds_read_b64_tr_b16 a[138:139], v137 offset:17408
    ds_read_b64_tr_b16 a[152:153], v138 offset:16384
    ds_read_b64_tr_b16 a[154:155], v139 offset:17408
    ds_read_b64_tr_b16 a[168:169], v140 offset:16384
    ds_read_b64_tr_b16 a[170:171], v141 offset:17408
    ds_read_b64_tr_b16 a[184:185], v142 offset:16384
    ds_read_b64_tr_b16 a[186:187], v143 offset:17408
    ds_read_b64_tr_b16 a[200:201], v144 offset:16384
    ds_read_b64_tr_b16 a[202:203], v145 offset:17408
    ds_read_b64_tr_b16 a[216:217], v146 offset:16384
    ds_read_b64_tr_b16 a[218:219], v147 offset:17408
    ds_read_b64_tr_b16 a[232:233], v148 offset:16384
    ds_read_b64_tr_b16 a[234:235], v149 offset:17408
    ds_read_b64_tr_b16 a[248:249], v150 offset:16384
    ds_read_b64_tr_b16 a[250:251], v151 offset:17408
    s_waitcnt lgkmcnt(0)
    s_add_u32 s39, s90, s62
    s_mov_b32 m0, s39
    s_add_u32 s62, s62, 4096
    s_and_b32 s62, s62, 0x7fff
    buffer_load_dwordx4 v76, s[52:55], s95 offen offset:0 nt lds
    buffer_load_dwordx4 v77, s[52:55], s95 offen offset:1024 nt lds
    buffer_load_dwordx4 v78, s[52:55], s95 offen offset:2048 nt lds
    buffer_load_dwordx4 v79, s[52:55], s95 offen offset:3072 nt lds
    s_add_u32 s95, s95, 16384
    s_add_u32 s39, s90, s62
    s_mov_b32 m0, s39
    s_add_u32 s62, s62, 4096
    s_and_b32 s62, s62, 0x7fff
    buffer_load_dwordx4 v76, s[52:55], s95 offen offset:0 nt lds
    buffer_load_dwordx4 v77, s[52:55], s95 offen offset:1024 nt lds
    buffer_load_dwordx4 v78, s[52:55], s95 offen offset:2048 nt lds
    buffer_load_dwordx4 v79, s[52:55], s95 offen offset:3072 nt lds
    s_add_u32 s95, s95, 16384
    s_waitcnt vmcnt(24)
    ds_read_b64_tr_b16 a[140:141], v136 offset:24576
    ds_read_b64_tr_b16 a[142:143], v137 offset:25600
    ds_read_b64_tr_b16 a[156:157], v138 offset:24576
    ds_read_b64_tr_b16 a[158:159], v139 offset:25600
    ds_read_b64_tr_b16 a[172:173], v140 offset:24576
    ds_read_b64_tr_b16 a[174:175], v141 offset:25600
    ds_read_b64_tr_b16 a[188:189], v142 offset:24576
    ds_read_b64_tr_b16 a[190:191], v143 offset:25600
    ds_read_b64_tr_b16 a[204:205], v144 offset:24576
    ds_read_b64_tr_b16 a[206:207], v145 offset:25600
    ds_read_b64_tr_b16 a[220:221], v146 offset:24576
    ds_read_b64_tr_b16 a[222:223], v147 offset:25600
    ds_read_b64_tr_b16 a[236:237], v148 offset:24576
    ds_read_b64_tr_b16 a[238:239], v149 offset:25600
    ds_read_b64_tr_b16 a[252:253], v150 offset:24576
    ds_read_b64_tr_b16 a[254:255], v151 offset:25600
    s_waitcnt lgkmcnt(0)
    s_add_u32 s39, s90, s62
    s_mov_b32 m0, s39
    s_add_u32 s62, s62, 4096
    s_and_b32 s62, s62, 0x7fff
    buffer_load_dwordx4 v76, s[52:55], s95 offen offset:0 nt lds
    buffer_load_dwordx4 v77, s[52:55], s95 offen offset:1024 nt lds
    buffer_load_dwordx4 v78, s[52:55], s95 offen offset:2048 nt lds
    buffer_load_dwordx4 v79, s[52:55], s95 offen offset:3072 nt lds
    s_add_u32 s95, s95, 16384
    s_add_u32 s39, s90, s62
    s_mov_b32 m0, s39
    s_add_u32 s62, s62, 4096
    s_and_b32 s62, s62, 0x7fff
    buffer_load_dwordx4 v76, s[52:55], s95 offen offset:0 nt lds
    buffer_load_dwordx4 v77, s[52:55], s95 offen offset:1024 nt lds
    buffer_load_dwordx4 v78, s[52:55], s95 offen offset:2048 nt lds
    buffer_load_dwordx4 v79, s[52:55], s95 offen offset:3072 nt lds
    s_add_u32 s95, s95, 16384
    s_mov_b32 s52, s6
    s_and_b32 s53, s7, 0xffff
    s_mov_b32 s54, 16777216
    s_mov_b32 s55, 0x20000
    s_lshl_b32 s95, s32, 19
    s_lshl_b32 s38, s34, 8
    s_add_u32 s95, s95, s38
    s_waitcnt vmcnt(24)
    ds_read_b64_tr_b16 a[0:1], v136 offset:0
    ds_read_b64_tr_b16 a[2:3], v137 offset:1024
    ds_read_b64_tr_b16 a[16:17], v138 offset:0
    ds_read_b64_tr_b16 a[18:19], v139 offset:1024
    ds_read_b64_tr_b16 a[32:33], v140 offset:0
    ds_read_b64_tr_b16 a[34:35], v141 offset:1024
    ds_read_b64_tr_b16 a[48:49], v142 offset:0
    ds_read_b64_tr_b16 a[50:51], v143 offset:1024
    ds_read_b64_tr_b16 a[64:65], v144 offset:0
    ds_read_b64_tr_b16 a[66:67], v145 offset:1024
    ds_read_b64_tr_b16 a[80:81], v146 offset:0
    ds_read_b64_tr_b16 a[82:83], v147 offset:1024
    ds_read_b64_tr_b16 a[96:97], v148 offset:0
    ds_read_b64_tr_b16 a[98:99], v149 offset:1024
    ds_read_b64_tr_b16 a[112:113], v150 offset:0
    ds_read_b64_tr_b16 a[114:115], v151 offset:1024
    s_waitcnt lgkmcnt(0)
    s_add_u32 s39, s90, s62
    s_mov_b32 m0, s39
    s_add_u32 s62, s62, 4096
    s_and_b32 s62, s62, 0x7fff
    buffer_load_dwordx4 v76, s[52:55], s95 offen offset:0 nt lds
    buffer_load_dwordx4 v77, s[52:55], s95 offen offset:1024 nt lds
    buffer_load_dwordx4 v78, s[52:55], s95 offen offset:2048 nt lds
    buffer_load_dwordx4 v79, s[52:55], s95 offen offset:3072 nt lds
    s_add_u32 s95, s95, 16384
    s_add_u32 s39, s90, s62
    s_mov_b32 m0, s39
    s_add_u32 s62, s62, 4096
    s_and_b32 s62, s62, 0x7fff
    buffer_load_dwordx4 v76, s[52:55], s95 offen offset:0 nt lds
    buffer_load_dwordx4 v77, s[52:55], s95 offen offset:1024 nt lds
    buffer_load_dwordx4 v78, s[52:55], s95 offen offset:2048 nt lds
    buffer_load_dwordx4 v79, s[52:55], s95 offen offset:3072 nt lds
    s_add_u32 s95, s95, 16384
    s_waitcnt vmcnt(24)
    ds_read_b64_tr_b16 a[4:5], v136 offset:8192
    ds_read_b64_tr_b16 a[6:7], v137 offset:9216
    ds_read_b64_tr_b16 a[20:21], v138 offset:8192
    ds_read_b64_tr_b16 a[22:23], v139 offset:9216
    ds_read_b64_tr_b16 a[36:37], v140 offset:8192
    ds_read_b64_tr_b16 a[38:39], v141 offset:9216
    ds_read_b64_tr_b16 a[52:53], v142 offset:8192
    ds_read_b64_tr_b16 a[54:55], v143 offset:9216
    ds_read_b64_tr_b16 a[68:69], v144 offset:8192
    ds_read_b64_tr_b16 a[70:71], v145 offset:9216
    ds_read_b64_tr_b16 a[84:85], v146 offset:8192
    ds_read_b64_tr_b16 a[86:87], v147 offset:9216
    ds_read_b64_tr_b16 a[100:101], v148 offset:8192
    ds_read_b64_tr_b16 a[102:103], v149 offset:9216
    ds_read_b64_tr_b16 a[116:117], v150 offset:8192
    ds_read_b64_tr_b16 a[118:119], v151 offset:9216
    s_waitcnt lgkmcnt(0)
    s_add_u32 s39, s90, s62
    s_mov_b32 m0, s39
    s_add_u32 s62, s62, 4096
    s_and_b32 s62, s62, 0x7fff
    buffer_load_dwordx4 v76, s[52:55], s95 offen offset:0 nt lds
    buffer_load_dwordx4 v77, s[52:55], s95 offen offset:1024 nt lds
    buffer_load_dwordx4 v78, s[52:55], s95 offen offset:2048 nt lds
    buffer_load_dwordx4 v79, s[52:55], s95 offen offset:3072 nt lds
    s_add_u32 s95, s95, 16384
    s_add_u32 s39, s90, s62
    s_mov_b32 m0, s39
    s_add_u32 s62, s62, 4096
    s_and_b32 s62, s62, 0x7fff
    buffer_load_dwordx4 v76, s[52:55], s95 offen offset:0 nt lds
    buffer_load_dwordx4 v77, s[52:55], s95 offen offset:1024 nt lds
    buffer_load_dwordx4 v78, s[52:55], s95 offen offset:2048 nt lds
    buffer_load_dwordx4 v79, s[52:55], s95 offen offset:3072 nt lds
    s_add_u32 s95, s95, 16384
    s_waitcnt vmcnt(24)
    ds_read_b64_tr_b16 a[8:9], v136 offset:16384
    ds_read_b64_tr_b16 a[10:11], v137 offset:17408
    ds_read_b64_tr_b16 a[24:25], v138 offset:16384
    ds_read_b64_tr_b16 a[26:27], v139 offset:17408
    ds_read_b64_tr_b16 a[40:41], v140 offset:16384
    ds_read_b64_tr_b16 a[42:43], v141 offset:17408
    ds_read_b64_tr_b16 a[56:57], v142 offset:16384
    ds_read_b64_tr_b16 a[58:59], v143 offset:17408
    ds_read_b64_tr_b16 a[72:73], v144 offset:16384
    ds_read_b64_tr_b16 a[74:75], v145 offset:17408
    ds_read_b64_tr_b16 a[88:89], v146 offset:16384
    ds_read_b64_tr_b16 a[90:91], v147 offset:17408
    ds_read_b64_tr_b16 a[104:105], v148 offset:16384
    ds_read_b64_tr_b16 a[106:107], v149 offset:17408
    ds_read_b64_tr_b16 a[120:121], v150 offset:16384
    ds_read_b64_tr_b16 a[122:123], v151 offset:17408
    s_waitcnt lgkmcnt(0)
    s_add_u32 s39, s90, s62
    s_mov_b32 m0, s39
    s_add_u32 s62, s62, 4096
    s_and_b32 s62, s62, 0x7fff
    buffer_load_dwordx4 v76, s[52:55], s95 offen offset:0 nt lds
    buffer_load_dwordx4 v77, s[52:55], s95 offen offset:1024 nt lds
    buffer_load_dwordx4 v78, s[52:55], s95 offen offset:2048 nt lds
    buffer_load_dwordx4 v79, s[52:55], s95 offen offset:3072 nt lds
    s_add_u32 s95, s95, 16384
    s_add_u32 s39, s90, s62
    s_mov_b32 m0, s39
    s_add_u32 s62, s62, 4096
    s_and_b32 s62, s62, 0x7fff
    buffer_load_dwordx4 v76, s[52:55], s95 offen offset:0 nt lds
    buffer_load_dwordx4 v77, s[52:55], s95 offen offset:1024 nt lds
    buffer_load_dwordx4 v78, s[52:55], s95 offen offset:2048 nt lds
    buffer_load_dwordx4 v79, s[52:55], s95 offen offset:3072 nt lds
    s_add_u32 s95, s95, 16384
    s_waitcnt vmcnt(24)
    ds_read_b64_tr_b16 a[12:13], v136 offset:24576
    ds_read_b64_tr_b16 a[14:15], v137 offset:25600
    ds_read_b64_tr_b16 a[28:29], v138 offset:24576
    ds_read_b64_tr_b16 a[30:31], v139 offset:25600
    ds_read_b64_tr_b16 a[44:45], v140 offset:24576
    ds_read_b64_tr_b16 a[46:47], v141 offset:25600
    ds_read_b64_tr_b16 a[60:61], v142 offset:24576
    ds_read_b64_tr_b16 a[62:63], v143 offset:25600
    ds_read_b64_tr_b16 a[76:77], v144 offset:24576
    ds_read_b64_tr_b16 a[78:79], v145 offset:25600
    ds_read_b64_tr_b16 a[92:93], v146 offset:24576
    ds_read_b64_tr_b16 a[94:95], v147 offset:25600
    ds_read_b64_tr_b16 a[108:109], v148 offset:24576
    ds_read_b64_tr_b16 a[110:111], v149 offset:25600
    ds_read_b64_tr_b16 a[124:125], v150 offset:24576
    ds_read_b64_tr_b16 a[126:127], v151 offset:25600
    s_waitcnt lgkmcnt(0)
    s_mov_b32 s86, 131072
    buffer_load_dword v7, v101, s[48:51], s86 offen sc1
    s_add_u32 s39, s90, s62
    s_mov_b32 m0, s39
    s_add_u32 s62, s62, 4096
    s_and_b32 s62, s62, 0x7fff
    buffer_load_dwordx4 v76, s[52:55], s95 offen offset:0 nt lds
    buffer_load_dwordx4 v77, s[52:55], s95 offen offset:1024 nt lds
    buffer_load_dwordx4 v78, s[52:55], s95 offen offset:2048 nt lds
    buffer_load_dwordx4 v79, s[52:55], s95 offen offset:3072 nt lds
    s_add_u32 s95, s95, 16384
    s_add_u32 s39, s90, s62
    s_mov_b32 m0, s39
    s_add_u32 s62, s62, 4096
    s_and_b32 s62, s62, 0x7fff
    buffer_load_dwordx4 v76, s[52:55], s95 offen offset:0 nt lds
    v_mov_b32 v136, 0
    v_mov_b32 v137, 0
    v_mov_b32 v138, 0
    v_mov_b32 v139, 0
    v_mov_b32 v140, 0
    v_mov_b32 v141, 0
    v_mov_b32 v142, 0
    v_mov_b32 v143, 0
    v_mov_b32 v144, 0
    v_mov_b32 v145, 0
    v_mov_b32 v146, 0
    v_mov_b32 v147, 0
    v_mov_b32 v148, 0
    v_mov_b32 v149, 0
    v_mov_b32 v150, 0
    v_mov_b32 v151, 0
    v_mov_b32 v152, 0
    v_mov_b32 v153, 0
    v_mov_b32 v154, 0
    v_mov_b32 v155, 0
    v_mov_b32 v156, 0
    v_mov_b32 v157, 0
    v_mov_b32 v158, 0
    v_mov_b32 v159, 0
    v_mov_b32 v160, 0
    v_mov_b32 v161, 0
    v_mov_b32 v162, 0
    v_mov_b32 v163, 0
    v_mov_b32 v164, 0
    v_mov_b32 v165, 0
    v_mov_b32 v166, 0
    v_mov_b32 v167, 0
    v_mov_b32 v168, 0
    v_mov_b32 v169, 0
    v_mov_b32 v170, 0
    v_mov_b32 v171, 0
    v_mov_b32 v172, 0
    v_mov_b32 v173, 0
    v_mov_b32 v174, 0
    v_mov_b32 v175, 0
    v_mov_b32 v176, 0
    v_mov_b32 v177, 0
    v_mov_b32 v178, 0
    v_mov_b32 v179, 0
    v_mov_b32 v180, 0
    v_mov_b32 v181, 0
    v_mov_b32 v182, 0
    v_mov_b32 v183, 0
    v_mov_b32 v184, 0
    v_mov_b32 v185, 0
    v_mov_b32 v186, 0
    v_mov_b32 v187, 0
    v_mov_b32 v188, 0
    v_mov_b32 v189, 0
    v_mov_b32 v190, 0
    v_mov_b32 v191, 0
    v_mov_b32 v192, 0
    v_mov_b32 v193, 0
    v_mov_b32 v194, 0
    v_mov_b32 v195, 0
    v_mov_b32 v196, 0
    v_mov_b32 v197, 0
    v_mov_b32 v198, 0
    v_mov_b32 v199, 0
    v_mov_b32 v90, 0xff7f0000
    s_mov_b32 s93, 0
    v_mov_b32 v102, 0
    v_mov_b32 v103, 0
    s_mov_b32 s60, s83
    s_mov_b32 s61, s83
    v_add_u32 v4, s85, v80
    v_xor_b32 v82, 0, v4
    v_xor_b32 v83, 32, v4
    v_xor_b32 v84, 64, v4
    v_xor_b32 v85, 96, v4
    v_xor_b32 v86, 128, v4
    v_xor_b32 v87, 160, v4
    v_xor_b32 v88, 192, v4
    v_xor_b32 v89, 224, v4
    v_add_u32 v80, s90, v80
    v_add_u32 v81, s90, v81
    s_lshr_b32 s36, s32, 3
    s_lshl_b32 s36, s36, 15
    s_lshl_b32 s38, s34, 8
    s_add_u32 s36, s36, s38
    s_add_u32 s36, s36, 2097152
    s_waitcnt vmcnt(5)
L_fcheck_20:
    v_cmp_ne_u32 vcc, s68, v7
    s_cbranch_vccz L_fok_21
    s_sleep 2
    s_mov_b32 s86, 131072
    buffer_load_dword v7, v101, s[48:51], s86 offen sc1
    s_waitcnt vmcnt(0)
    s_sub_u32 s84, s84, 1
    s_cmp_lg_u32 s84, 0
    s_cbranch_scc1 L_fcheck_20
    s_branch L_end
L_fok_21:
    buffer_load_dwordx4 v[20:23], v9, s[48:51], s36 offen sc1
    s_add_u32 s36, s36, 4096
    buffer_load_dwordx4 v[24:27], v9, s[48:51], s36 offen sc1
    s_add_u32 s36, s36, 4096
    buffer_load_dwordx4 v[28:31], v9, s[48:51], s36 offen sc1
    s_add_u32 s36, s36, 4096
    buffer_load_dwordx4 v[32:35], v9, s[48:51], s36 offen sc1
    s_add_u32 s36, s36, 4096
    buffer_load_dwordx4 v[36:39], v9, s[48:51], s36 offen sc1
    s_add_u32 s36, s36, 4096
    buffer_load_dwordx4 v[40:43], v9, s[48:51], s36 offen sc1
    s_add_u32 s36, s36, 4096
    buffer_load_dwordx4 v[44:47], v9, s[48:51], s36 offen sc1
    s_add_u32 s36, s36, 4096
    buffer_load_dwordx4 v[48:51], v9, s[48:51], s36 offen sc1
    s_waitcnt vmcnt(7)
    ds_write_b128 v96, v[20:23] offset:0
    s_waitcnt vmcnt(6)
    ds_write_b128 v97, v[24:27] offset:1024
    s_waitcnt vmcnt(5)
    ds_write_b128 v98, v[28:31] offset:2048
    s_waitcnt vmcnt(4)
    ds_write_b128 v99, v[32:35] offset:3072
    s_waitcnt vmcnt(3)
    ds_write_b128 v96, v[36:39] offset:4096
    s_waitcnt vmcnt(2)
    ds_write_b128 v97, v[40:43] offset:5120
    s_waitcnt vmcnt(1)
    ds_write_b128 v98, v[44:47] offset:6144
    s_waitcnt vmcnt(0)
    ds_write_b128 v99, v[48:51] offset:7168
    s_waitcnt lgkmcnt(0)
    ds_read_b128 v[104:107], v82
    ds_read_b128 v[108:111], v83
    ds_read_b128 v[112:115], v84
    ds_read_b128 v[116:119], v85
    ds_read_b128 v[120:123], v86
    ds_read_b128 v[124:127], v87
    ds_read_b128 v[128:131], v88
    ds_read_b128 v[132:135], v89
    v_xor_b32 v82, 0, v80
    ds_read_b128 v[216:219], v82
    v_xor_b32 v83, 32, v80
    ds_read_b128 v[220:223], v83
    v_xor_b32 v84, 64, v80
    ds_read_b128 v[224:227], v84
    v_xor_b32 v85, 96, v80
    ds_read_b128 v[228:231], v85
    v_xor_b32 v86, 128, v80
    ds_read_b128 v[232:235], v86
    v_xor_b32 v87, 160, v80
    ds_read_b128 v[236:239], v87
    v_xor_b32 v88, 192, v80
    ds_read_b128 v[240:243], v88
    v_xor_b32 v89, 224, v80
    ds_read_b128 v[244:247], v89
L_att:
    v_add_u32 v4, s94, v81
    s_waitcnt lgkmcnt(0)
    v_mfma_f32_32x32x16_bf16 v[200:215], v[216:219], v[104:107], 0
    v_xor_b32 v82, 0, v4
    ds_read_b64_tr_b16 v[20:21], v82 offset:0
    ds_read_b64_tr_b16 v[24:25], v82 offset:4096
    buffer_load_dwordx4 v77, s[52:55], s95 offen offset:1024 nt lds
    v_mfma_f32_32x32x16_bf16 v[200:215], v[220:223], v[108:111], v[200:215]
    v_xor_b32 v83, 32, v4
    ds_read_b64_tr_b16 v[22:23], v83 offset:2048
    ds_read_b64_tr_b16 v[26:27], v83 offset:6144
    v_mfma_f32_32x32x16_bf16 v[200:215], v[224:227], v[112:115], v[200:215]
    v_xor_b32 v84, 64, v4
    ds_read_b64_tr_b16 v[28:29], v84 offset:0
    ds_read_b64_tr_b16 v[32:33], v84 offset:4096
    v_mfma_f32_32x32x16_bf16 v[200:215], v[228:231], v[116:119], v[200:215]
    v_xor_b32 v85, 96, v4
    ds_read_b64_tr_b16 v[30:31], v85 offset:2048
    ds_read_b64_tr_b16 v[34:35], v85 offset:6144
    v_mfma_f32_32x32x16_bf16 v[200:215], v[232:235], v[120:123], v[200:215]
    v_xor_b32 v86, 128, v4
    ds_read_b64_tr_b16 v[36:37], v86 offset:0
    ds_read_b64_tr_b16 v[40:41], v86 offset:4096
    buffer_load_dwordx4 v78, s[52:55], s95 offen offset:2048 nt lds
    v_mfma_f32_32x32x16_bf16 v[200:215], v[236:239], v[124:127], v[200:215]
    v_xor_b32 v87, 160, v4
    ds_read_b64_tr_b16 v[38:39], v87 offset:2048
    ds_read_b64_tr_b16 v[42:43], v87 offset:6144
    v_mfma_f32_32x32x16_bf16 v[200:215], v[240:243], v[128:131], v[200:215]
    v_xor_b32 v88, 192, v4
    ds_read_b64_tr_b16 v[44:45], v88 offset:0
    ds_read_b64_tr_b16 v[48:49], v88 offset:4096
    v_mfma_f32_32x32x16_bf16 v[200:215], v[244:247], v[132:135], v[200:215]
    v_xor_b32 v89, 224, v4
    ds_read_b64_tr_b16 v[46:47], v89 offset:2048
    ds_read_b64_tr_b16 v[50:51], v89 offset:6144
    buffer_load_dwordx4 v79, s[52:55], s95 offen offset:3072 nt lds
    s_add_u32 s95, s95, 16384
    v_xor_b32 v5, 0x2000, v94
    v_xor_b32 v6, 0x4000, v94
    v_xor_b32 v7, 0x6000, v94
    s_cmp_lg_u32 s93, 12
    s_cbranch_scc1 L_noswitch_22
    s_mov_b32 s52, s24
    s_and_b32 s53, s25, 0xffff
    s_mov_b32 s54, 4194304
    s_mov_b32 s55, 0x20000
    s_mov_b32 s95, s63
L_noswitch_22:
    s_nop 1
    ds_write_b128 v94, v[200:203] offset:0
    ds_write_b128 v94, v[204:207] offset:1024
    ds_write_b128 v94, v[208:211] offset:2048
    ds_write_b128 v94, v[212:215] offset:3072
    s_waitcnt lgkmcnt(0)
    s_barrier
    ds_read_b128 v[60:63], v5 offset:0
    ds_read_b128 v[216:219], v6 offset:0
    ds_read_b128 v[232:235], v7 offset:0
    ds_read_b128 v[64:67], v5 offset:1024
    ds_read_b128 v[220:223], v6 offset:1024
    ds_read_b128 v[236:239], v7 offset:1024
    ds_read_b128 v[68:71], v5 offset:2048
    ds_read_b128 v[224:227], v6 offset:2048
    ds_read_b128 v[240:243], v7 offset:2048
    ds_read_b128 v[72:75], v5 offset:3072
    ds_read_b128 v[228:231], v6 offset:3072
    ds_read_b128 v[244:247], v7 offset:3072
    v_xor_b32 v94, 0x1000, v94
    s_add_u32 s39, s90, s62
    s_mov_b32 m0, s39
    s_add_u32 s62, s62, 4096
    s_and_b32 s62, s62, 0x7fff
    buffer_load_dwordx4 v76, s[52:55], s95 offen offset:0 nt lds
    s_add_u32 s94, s94, 8192
    s_and_b32 s94, s94, 0x7fff
    s_waitcnt lgkmcnt(9)
    v_pk_add_f32 v[200:201], v[200:201], v[60:61]
    v_pk_add_f32 v[216:217], v[216:217], v[232:233]
    v_pk_add_f32 v[202:203], v[202:203], v[62:63]
    v_pk_add_f32 v[218:219], v[218:219], v[234:235]
    v_pk_add_f32 v[200:201], v[200:201], v[216:217]
    v_pk_add_f32 v[202:203], v[202:203], v[218:219]
    s_waitcnt lgkmcnt(6)
    v_pk_add_f32 v[204:205], v[204:205], v[64:65]
    v_pk_add_f32 v[220:221], v[220:221], v[236:237]
    v_pk_add_f32 v[206:207], v[206:207], v[66:67]
    v_pk_add_f32 v[222:223], v[222:223], v[238:239]
    v_pk_add_f32 v[204:205], v[204:205], v[220:221]
    v_pk_add_f32 v[206:207], v[206:207], v[222:223]
    s_waitcnt lgkmcnt(3)
    v_pk_add_f32 v[208:209], v[208:209], v[68:69]
    v_pk_add_f32 v[224:225], v[224:225], v[240:241]
    v_pk_add_f32 v[210:211], v[210:211], v[70:71]
    v_pk_add_f32 v[226:227], v[226:227], v[242:243]
    v_pk_add_f32 v[208:209], v[208:209], v[224:225]
    v_pk_add_f32 v[210:211], v[210:211], v[226:227]
    s_waitcnt lgkmcnt(0)
    v_pk_add_f32 v[212:213], v[212:213], v[72:73]
    v_pk_add_f32 v[228:229], v[228:229], v[244:245]
    v_pk_add_f32 v[214:215], v[214:215], v[74:75]
    v_pk_add_f32 v[230:231], v[230:231], v[246:247]
    v_pk_add_f32 v[212:213], v[212:213], v[228:229]
    v_pk_add_f32 v[214:215], v[214:215], v[230:231]
    buffer_load_dwordx4 v77, s[52:55], s95 offen offset:1024 nt lds
    v_max_f32 v4, v200, v201
    v_max3_f32 v4, v4, v202, v203
    v_max3_f32 v4, v4, v204, v205
    v_max3_f32 v4, v4, v206, v207
    v_max3_f32 v4, v4, v208, v209
    v_max3_f32 v4, v4, v210, v211
    v_max3_f32 v4, v4, v212, v213
    v_max3_f32 v4, v4, v214, v215
    v_mov_b32 v5, v4
    s_nop 1
    v_permlane32_swap_b32 v4, v5
    v_max_f32 v4, v4, v5
    v_mul_f32 v4, s83, v4
    v_max_f32 v4, v4, v90
    v_sub_f32 v92, v90, v4
    v_exp_f32 v92, v92
    v_mov_b32 v90, v4
    v_pk_fma_f32 v[200:201], v[200:201], s[60:61], v[90:91] op_sel_hi:[1,1,0] neg_lo:[0,0,1] neg_hi:[0,0,1]
    v_pk_fma_f32 v[202:203], v[202:203], s[60:61], v[90:91] op_sel_hi:[1,1,0] neg_lo:[0,0,1] neg_hi:[0,0,1]
    v_pk_fma_f32 v[204:205], v[204:205], s[60:61], v[90:91] op_sel_hi:[1,1,0] neg_lo:[0,0,1] neg_hi:[0,0,1]
    v_pk_fma_f32 v[206:207], v[206:207], s[60:61], v[90:91] op_sel_hi:[1,1,0] neg_lo:[0,0,1] neg_hi:[0,0,1]
    v_pk_fma_f32 v[208:209], v[208:209], s[60:61], v[90:91] op_sel_hi:[1,1,0] neg_lo:[0,0,1] neg_hi:[0,0,1]
    v_pk_fma_f32 v[210:211], v[210:211], s[60:61], v[90:91] op_sel_hi:[1,1,0] neg_lo:[0,0,1] neg_hi:[0,0,1]
    v_pk_fma_f32 v[212:213], v[212:213], s[60:61], v[90:91] op_sel_hi:[1,1,0] neg_lo:[0,0,1] neg_hi:[0,0,1]
    v_pk_fma_f32 v[214:215], v[214:215], s[60:61], v[90:91] op_sel_hi:[1,1,0] neg_lo:[0,0,1] neg_hi:[0,0,1]
    v_exp_f32 v200, v200
    v_exp_f32 v201, v201
    v_exp_f32 v202, v202
    v_exp_f32 v203, v203
    v_exp_f32 v204, v204
    buffer_load_dwordx4 v78, s[52:55], s95 offen offset:2048 nt lds
    v_exp_f32 v205, v205
    v_exp_f32 v206, v206
    v_exp_f32 v207, v207
    v_exp_f32 v208, v208
    v_exp_f32 v209, v209
    v_exp_f32 v210, v210
    v_exp_f32 v211, v211
    v_exp_f32 v212, v212
    v_exp_f32 v213, v213
    v_exp_f32 v214, v214
    v_exp_f32 v215, v215
    v_add_u32 v4, s94, v80
    v_pk_mul_f32 v[102:103], v[102:103], v[92:93] op_sel_hi:[1,0]
    v_pk_mul_f32 v[136:137], v[136:137], v[92:93] op_sel_hi:[1,0]
    v_pk_mul_f32 v[138:139], v[138:139], v[92:93] op_sel_hi:[1,0]
    v_pk_mul_f32 v[140:141], v[140:141], v[92:93] op_sel_hi:[1,0]
    v_pk_mul_f32 v[142:143], v[142:143], v[92:93] op_sel_hi:[1,0]
    v_pk_mul_f32 v[144:145], v[144:145], v[92:93] op_sel_hi:[1,0]
    v_pk_mul_f32 v[146:147], v[146:147], v[92:93] op_sel_hi:[1,0]
    v_pk_mul_f32 v[148:149], v[148:149], v[92:93] op_sel_hi:[1,0]
    v_pk_mul_f32 v[150:151], v[150:151], v[92:93] op_sel_hi:[1,0]
    v_pk_mul_f32 v[152:153], v[152:153], v[92:93] op_sel_hi:[1,0]
    v_pk_mul_f32 v[154:155], v[154:155], v[92:93] op_sel_hi:[1,0]
    v_pk_mul_f32 v[156:157], v[156:157], v[92:93] op_sel_hi:[1,0]
    v_pk_mul_f32 v[158:159], v[158:159], v[92:93] op_sel_hi:[1,0]
    v_pk_mul_f32 v[160:161], v[160:161], v[92:93] op_sel_hi:[1,0]
    v_pk_mul_f32 v[162:163], v[162:163], v[92:93] op_sel_hi:[1,0]
    v_pk_mul_f32 v[164:165], v[164:165], v[92:93] op_sel_hi:[1,0]
    v_pk_mul_f32 v[166:167], v[166:167], v[92:93] op_sel_hi:[1,0]
    v_pk_mul_f32 v[168:169], v[168:169], v[92:93] op_sel_hi:[1,0]
    v_pk_mul_f32 v[170:171], v[170:171], v[92:93] op_sel_hi:[1,0]
    v_pk_mul_f32 v[172:173], v[172:173], v[92:93] op_sel_hi:[1,0]
    v_pk_mul_f32 v[174:175], v[174:175], v[92:93] op_sel_hi:[1,0]
    v_pk_mul_f32 v[176:177], v[176:177], v[92:93] op_sel_hi:[1,0]
    buffer_load_dwordx4 v79, s[52:55], s95 offen offset:3072 nt lds
    s_add_u32 s95, s95, 16384
    v_pk_mul_f32 v[178:179], v[178:179], v[92:93] op_sel_hi:[1,0]
    v_pk_mul_f32 v[180:181], v[180:181], v[92:93] op_sel_hi:[1,0]
    v_pk_mul_f32 v[182:183], v[182:183], v[92:93] op_sel_hi:[1,0]
    v_pk_mul_f32 v[184:185], v[184:185], v[92:93] op_sel_hi:[1,0]
    v_pk_mul_f32 v[186:187], v[186:187], v[92:93] op_sel_hi:[1,0]
    v_pk_mul_f32 v[188:189], v[188:189], v[92:93] op_sel_hi:[1,0]
    v_pk_mul_f32 v[190:191], v[190:191], v[92:93] op_sel_hi:[1,0]
    v_pk_mul_f32 v[192:193], v[192:193], v[92:93] op_sel_hi:[1,0]
    v_pk_mul_f32 v[194:195], v[194:195], v[92:93] op_sel_hi:[1,0]
    v_pk_mul_f32 v[196:197], v[196:197], v[92:93] op_sel_hi:[1,0]
    v_pk_mul_f32 v[198:199], v[198:199], v[92:93] op_sel_hi:[1,0]
    v_cvt_pk_bf16_f32 v52, v200, v201
    v_pk_add_f32 v[102:103], v[102:103], v[200:201]
    v_cvt_pk_bf16_f32 v53, v202, v203
    v_pk_add_f32 v[102:103], v[102:103], v[202:203]
    v_cvt_pk_bf16_f32 v54, v204, v205
    v_pk_add_f32 v[102:103], v[102:103], v[204:205]
    v_cvt_pk_bf16_f32 v55, v206, v207
    v_pk_add_f32 v[102:103], v[102:103], v[206:207]
    v_cvt_pk_bf16_f32 v56, v208, v209
    v_pk_add_f32 v[102:103], v[102:103], v[208:209]
    v_cvt_pk_bf16_f32 v57, v210, v211
    v_pk_add_f32 v[102:103], v[102:103], v[210:211]
    v_cvt_pk_bf16_f32 v58, v212, v213
    v_pk_add_f32 v[102:103], v[102:103], v[212:213]
    v_cvt_pk_bf16_f32 v59, v214, v215
    v_pk_add_f32 v[102:103], v[102:103], v[214:215]
    s_waitcnt vmcnt(20)
    v_mfma_f32_32x32x16_bf16 v[136:151], v[20:23], v[52:55], v[136:151]
    v_xor_b32 v82, 0, v4
    ds_read_b128 v[216:219], v82
    v_xor_b32 v83, 32, v4
    ds_read_b128 v[220:223], v83
    v_mfma_f32_32x32x16_bf16 v[152:167], v[28:31], v[52:55], v[152:167]
    v_xor_b32 v84, 64, v4
    ds_read_b128 v[224:227], v84
    v_xor_b32 v85, 96, v4
    ds_read_b128 v[228:231], v85
    v_mfma_f32_32x32x16_bf16 v[168:183], v[36:39], v[52:55], v[168:183]
    v_xor_b32 v86, 128, v4
    ds_read_b128 v[232:235], v86
    v_xor_b32 v87, 160, v4
    ds_read_b128 v[236:239], v87
    v_mfma_f32_32x32x16_bf16 v[184:199], v[44:47], v[52:55], v[184:199]
    v_xor_b32 v88, 192, v4
    ds_read_b128 v[240:243], v88
    v_xor_b32 v89, 224, v4
    ds_read_b128 v[244:247], v89
    v_mfma_f32_32x32x16_bf16 v[136:151], v[24:27], v[56:59], v[136:151]
    s_add_u32 s39, s90, s62
    s_mov_b32 m0, s39
    s_add_u32 s62, s62, 4096
    s_and_b32 s62, s62, 0x7fff
    buffer_load_dwordx4 v76, s[52:55], s95 offen offset:0 nt lds
    v_mfma_f32_32x32x16_bf16 v[152:167], v[32:35], v[56:59], v[152:167]
    v_mfma_f32_32x32x16_bf16 v[168:183], v[40:43], v[56:59], v[168:183]
    v_mfma_f32_32x32x16_bf16 v[184:199], v[48:51], v[56:59], v[184:199]
    s_add_u32 s93, s93, 1
    s_cmp_lt_u32 s93, 16
    s_cbranch_scc1 L_att
    v_add_f32 v91, v102, v103
    v_mov_b32 v5, v91
    s_nop 1
    v_permlane32_swap_b32 v91, v5
    v_add_f32 v91, v91, v5
    v_and_b32 v4, 31, v1
    v_lshlrev_b32 v5, 8, v4
    v_lshl_add_u32 v5, v3, 4, v5
    v_lshrrev_b32 v6, 5, v1
    v_lshl_add_u32 v5, v6, 3, v5
    v_add_u32 v5, s85, v5
    s_waitcnt lgkmcnt(0)
    s_barrier
    v_cvt_pk_bf16_f32 v20, v136, v137
    v_cvt_pk_bf16_f32 v21, v138, v139
    v_xor_b32 v82, 0, v5
    ds_write_b64 v82, v[20:21]
    v_cvt_pk_bf16_f32 v22, v140, v141
    v_cvt_pk_bf16_f32 v23, v142, v143
    v_xor_b32 v83, 16, v5
    ds_write_b64 v83, v[22:23]
    v_cvt_pk_bf16_f32 v24, v144, v145
    v_cvt_pk_bf16_f32 v25, v146, v147
    v_xor_b32 v84, 32, v5
    ds_write_b64 v84, v[24:25]
    v_cvt_pk_bf16_f32 v26, v148, v149
    v_cvt_pk_bf16_f32 v27, v150, v151
    v_xor_b32 v85, 48, v5
    ds_write_b64 v85, v[26:27]
    v_cvt_pk_bf16_f32 v28, v152, v153
    v_cvt_pk_bf16_f32 v29, v154, v155
    v_xor_b32 v86, 64, v5
    ds_write_b64 v86, v[28:29]
    v_cvt_pk_bf16_f32 v30, v156, v157
    v_cvt_pk_bf16_f32 v31, v158, v159
    v_xor_b32 v87, 80, v5
    ds_write_b64 v87, v[30:31]
    v_cvt_pk_bf16_f32 v32, v160, v161
    v_cvt_pk_bf16_f32 v33, v162, v163
    v_xor_b32 v88, 96, v5
    ds_write_b64 v88, v[32:33]
    v_cvt_pk_bf16_f32 v34, v164, v165
    v_cvt_pk_bf16_f32 v35, v166, v167
    v_xor_b32 v89, 112, v5
    ds_write_b64 v89, v[34:35]
    v_cvt_pk_bf16_f32 v36, v168, v169
    v_cvt_pk_bf16_f32 v37, v170, v171
    v_xor_b32 v82, 128, v5
    ds_write_b64 v82, v[36:37]
    v_cvt_pk_bf16_f32 v38, v172, v173
    v_cvt_pk_bf16_f32 v39, v174, v175
    v_xor_b32 v83, 144, v5
    ds_write_b64 v83, v[38:39]
    v_cvt_pk_bf16_f32 v40, v176, v177
    v_cvt_pk_bf16_f32 v41, v178, v179
    v_xor_b32 v84, 160, v5
    ds_write_b64 v84, v[40:41]
    v_cvt_pk_bf16_f32 v42, v180, v181
    v_cvt_pk_bf16_f32 v43, v182, v183
    v_xor_b32 v85, 176, v5
    ds_write_b64 v85, v[42:43]
    v_cvt_pk_bf16_f32 v44, v184, v185
    v_cvt_pk_bf16_f32 v45, v186, v187
    v_xor_b32 v86, 192, v5
    ds_write_b64 v86, v[44:45]
    v_cvt_pk_bf16_f32 v46, v188, v189
    v_cvt_pk_bf16_f32 v47, v190, v191
    v_xor_b32 v87, 208, v5
    ds_write_b64 v87, v[46:47]
    v_cvt_pk_bf16_f32 v48, v192, v193
    v_cvt_pk_bf16_f32 v49, v194, v195
    v_xor_b32 v88, 224, v5
    ds_write_b64 v88, v[48:49]
    v_cvt_pk_bf16_f32 v50, v196, v197
    v_cvt_pk_bf16_f32 v51, v198, v199
    v_xor_b32 v89, 240, v5
    ds_write_b64 v89, v[50:51]
    v_xor_b32 v6, v3, v2
    v_lshlrev_b32 v6, 4, v6
    v_lshl_add_u32 v6, v2, 8, v6
    v_add_u32 v6, s85, v6
    v_xor_b32 v82, 0, v6
    v_xor_b32 v83, 64, v6
    v_xor_b32 v84, 128, v6
    v_xor_b32 v85, 192, v6
    v_lshlrev_b32 v7, 4, v3
    v_lshl_add_u32 v7, v2, 15, v7
    s_lshl_b32 s36, s32, 10
    s_lshl_b32 s38, s34, 8
    s_add_u32 s36, s36, s38
    s_add_u32 s36, s36, 4194304
    s_waitcnt lgkmcnt(0)
    ds_read_b128 v[200:203], v82 offset:0
    ds_read_b128 v[204:207], v83 offset:1024
    ds_read_b128 v[208:211], v84 offset:2048
    ds_read_b128 v[212:215], v85 offset:3072
    ds_read_b128 v[216:219], v82 offset:4096
    ds_read_b128 v[220:223], v83 offset:5120
    ds_read_b128 v[224:227], v84 offset:6144
    ds_read_b128 v[228:231], v85 offset:7168
    v_lshlrev_b32 v4, 3, v4
    s_lshl_b32 s37, s32, 8
    s_lshl_b32 s38, s34, 13
    s_add_u32 s37, s37, s38
    s_add_u32 s37, s37, 2621440
    s_mov_b32 exec_lo, 0xffffffff
    s_mov_b32 exec_hi, 0x0
    buffer_store_dwordx2 v[90:91], v4, s[48:51], s37 offen sc1
    s_mov_b64 exec, -1
    s_waitcnt lgkmcnt(7)
    buffer_store_dwordx4 v[200:203], v7, s[48:51], s36 offen sc1
    s_add_u32 s36, s36, 131072
    s_waitcnt lgkmcnt(6)
    buffer_store_dwordx4 v[204:207], v7, s[48:51], s36 offen sc1
    s_add_u32 s36, s36, 131072
    s_waitcnt lgkmcnt(5)
    buffer_store_dwordx4 v[208:211], v7, s[48:51], s36 offen sc1
    s_add_u32 s36, s36, 131072
    s_waitcnt lgkmcnt(4)
    buffer_store_dwordx4 v[212:215], v7, s[48:51], s36 offen sc1
    s_add_u32 s36, s36, 131072
    s_waitcnt lgkmcnt(3)
    buffer_store_dwordx4 v[216:219], v7, s[48:51], s36 offen sc1
    s_add_u32 s36, s36, 131072
    s_waitcnt lgkmcnt(2)
    buffer_store_dwordx4 v[220:223], v7, s[48:51], s36 offen sc1
    s_add_u32 s36, s36, 131072
    s_waitcnt lgkmcnt(1)
    buffer_store_dwordx4 v[224:227], v7, s[48:51], s36 offen sc1
    s_add_u32 s36, s36, 131072
    s_waitcnt lgkmcnt(0)
    buffer_store_dwordx4 v[228:231], v7, s[48:51], s36 offen sc1
    buffer_load_dwordx4 v77, s[52:55], s95 offen offset:1024 nt lds
    buffer_load_dwordx4 v78, s[52:55], s95 offen offset:2048 nt lds
    buffer_load_dwordx4 v79, s[52:55], s95 offen offset:3072 nt lds
    s_add_u32 s95, s95, 16384
    v_and_b32 v4, 3, v3
    v_lshrrev_b32 v5, 2, v3
    v_lshlrev_b32 v6, 4, v2
    v_add_u32 v6, 147456, v6
    s_movk_i32 s36, 320
    v_cmp_eq_u32 vcc, 0, v5
    s_nop 1
    v_cndmask_b32 v112, 4, v4, vcc
    v_mad_u32_u24 v112, v112, s36, v6
    v_cmp_eq_u32 vcc, 1, v5
    s_nop 1
    v_cndmask_b32 v113, 4, v4, vcc
    v_mad_u32_u24 v113, v113, s36, v6
    v_cmp_eq_u32 vcc, 2, v5
    s_nop 1
    v_cndmask_b32 v114, 4, v4, vcc
    v_mad_u32_u24 v114, v114, s36, v6
    v_cmp_eq_u32 vcc, 3, v5
    s_nop 1
    v_cndmask_b32 v115, 4, v4, vcc
    v_mad_u32_u24 v115, v115, s36, v6
    s_lshl_b32 s36, s34, 16
    s_lshl_b32 s38, s32, 8
    s_add_u32 s36, s36, s38
    v_add_u32 v77, s36, v19
    s_lshl_b32 s36, s32, 13
    s_lshl_b32 s38, s34, 6
    s_add_u32 s36, s36, s38
    v_lshrrev_b32 v5, 2, v1
    v_lshlrev_b32 v5, 8, v5
    v_lshl_add_u32 v5, v4, 4, v5
    v_add_u32 v78, s36, v5
    s_lshr_b32 s36, s32, 2
    s_lshl_b32 s36, s36, 7
    s_lshl_b32 s38, s34, 5
    s_add_u32 s36, s36, s38
    s_and_b32 s38, s32, 3
    s_lshl_b32 s38, s38, 3
    s_add_u32 s36, s36, s38
    v_lshlrev_b32 v5, 11, v4
    v_lshl_add_u32 v5, v2, 1, v5
    v_add_u32 v79, s36, v5
    v_lshrrev_b32 v5, 2, v3
    v_lshl_add_u32 v6, v4, 3, v5
    v_lshlrev_b32 v81, 8, v6
    v_lshlrev_b32 v6, 10, v6
    v_lshl_add_u32 v80, v2, 4, v6
    s_lshl_b32 s38, s34, 11
    s_add_u32 s38, s38, 131072
    v_lshlrev_b32 v4, 9, v4
    v_lshl_add_u32 v4, v2, 4, v4
    v_add_u32 v94, s38, v4
    s_lshl_b32 s38, s34, 9
    s_add_u32 s38, s38, 131072
    v_and_b32 v5, 31, v1
    v_lshl_add_u32 v96, v5, 4, s38
    s_mul_i32 s38, s34, 320
    s_add_u32 s38, s38, 147456
    v_lshl_add_u32 v97, v5, 3, s38
    v_lshlrev_b32 v4, 6, v2
    v_lshl_add_u32 v4, v3, 1, v4
    v_add_u32 v93, s38, v4
    v_lshlrev_b32 v4, 7, v2
    v_lshl_add_u32 v4, v3, 4, v4
    v_mov_b32 v5, 512
    v_cmp_gt_u32 vcc, 8, v3
    s_nop 1
    v_cndmask_b32 v92, v5, v4, vcc
    s_mov_b32 s92, 0
    s_mov_b32 s96, 3145728
    s_mov_b32 s97, 0
    s_lshl_b32 s36, s32, 15
    s_lshl_b32 s38, s34, 8
    s_add_u32 s36, s36, s38
    s_add_u32 s36, s36, 4194304
    s_lshl_b32 s37, s32, 3
    s_lshl_b32 s38, s34, 13
    s_add_u32 s37, s37, s38
    s_add_u32 s37, s37, 2621440
    s_barrier
    s_lshl_b32 s38, s34, 5
    s_add_u32 s38, s38, s32
    s_lshl_b32 s38, s38, 8
    s_add_u32 s38, s38, 196608
    v_mov_b32 v4, s38
    v_mov_b32 v5, s68
    s_waitcnt vmcnt(3)
    s_mov_b64 exec, 1
    buffer_store_dword v5, v4, s[48:51], 0 offen sc1
    s_mov_b64 exec, -1
    s_mov_b32 s86, 196608
    buffer_load_dword v7, v101, s[48:51], s86 offen sc1
    s_waitcnt vmcnt(0)
L_fcheck_23:
    v_cmp_ne_u32 vcc, s68, v7
    s_cbranch_vccz L_fok_24
    s_sleep 2
    s_mov_b32 s86, 196608
    buffer_load_dword v7, v101, s[48:51], s86 offen sc1
    s_waitcnt vmcnt(0)
    s_sub_u32 s84, s84, 1
    s_cmp_lg_u32 s84, 0
    s_cbranch_scc1 L_fcheck_23
    s_branch L_end
L_fok_24:
    buffer_load_dwordx2 v[52:53], v81, s[48:51], s37 offen offset:0 sc1
    buffer_load_dwordx2 v[54:55], v81, s[48:51], s37 offen offset:1024 sc1
    buffer_load_dwordx4 v[20:23], v80, s[48:51], s36 offen offset:0 sc1
    buffer_load_dwordx4 v[24:27], v80, s[48:51], s36 offen offset:64 sc1
    buffer_load_dwordx4 v[28:31], v80, s[48:51], s36 offen offset:128 sc1
    buffer_load_dwordx4 v[32:35], v80, s[48:51], s36 offen offset:192 sc1
    s_add_u32 s36, s36, 4096
    buffer_load_dwordx4 v[36:39], v80, s[48:51], s36 offen offset:0 sc1
    buffer_load_dwordx4 v[40:43], v80, s[48:51], s36 offen offset:64 sc1
    buffer_load_dwordx4 v[44:47], v80, s[48:51], s36 offen offset:128 sc1
    buffer_load_dwordx4 v[48:51], v80, s[48:51], s36 offen offset:192 sc1
    s_add_u32 s36, s36, 4096
    s_waitcnt vmcnt(8)
    v_max_f32 v4, v52, v54
    s_nop 1
    v_max_f32_dpp v4, v4, v4 row_ror:8 row_mask:0xf bank_mask:0xf
    s_nop 1
    v_max_f32_dpp v4, v4, v4 row_ror:4 row_mask:0xf bank_mask:0xf
    v_sub_f32 v52, v52, v4
    v_sub_f32 v54, v54, v4
    v_exp_f32 v52, v52
    v_exp_f32 v54, v54
    v_mul_f32 v5, v52, v53
    v_fmac_f32 v5, v54, v55
    s_nop 1
    v_add_f32_dpp v5, v5, v5 row_ror:8 row_mask:0xf bank_mask:0xf
    s_nop 1
    v_add_f32_dpp v5, v5, v5 row_ror:4 row_mask:0xf bank_mask:0xf
    v_rcp_f32 v5, v5
    s_nop 0
    v_mul_f32 v52, v52, v5
    v_mul_f32 v54, v54, v5
    s_waitcnt vmcnt(0)
    v_mfma_f32_16x16x32_bf16 v[60:63], a[128:131], v[20:23], 0
    v_mfma_f32_16x16x32_bf16 v[64:67], a[128:131], v[36:39], 0
    v_mfma_f32_16x16x32_bf16 v[60:63], a[132:135], v[24:27], v[60:63]
    v_mfma_f32_16x16x32_bf16 v[64:67], a[132:135], v[40:43], v[64:67]
    v_mfma_f32_16x16x32_bf16 v[60:63], a[136:139], v[28:31], v[60:63]
    v_mfma_f32_16x16x32_bf16 v[64:67], a[136:139], v[44:47], v[64:67]
    v_mfma_f32_16x16x32_bf16 v[60:63], a[140:143], v[32:35], v[60:63]
    v_mfma_f32_16x16x32_bf16 v[64:67], a[140:143], v[48:51], v[64:67]
    v_mfma_f32_16x16x32_bf16 v[68:71], a[144:147], v[20:23], 0
    v_mfma_f32_16x16x32_bf16 v[72:75], a[144:147], v[36:39], 0
    v_mfma_f32_16x16x32_bf16 v[68:71], a[148:151], v[24:27], v[68:71]
    v_mfma_f32_16x16x32_bf16 v[72:75], a[148:151], v[40:43], v[72:75]
    v_mfma_f32_16x16x32_bf16 v[68:71], a[152:155], v[28:31], v[68:71]
    v_mfma_f32_16x16x32_bf16 v[72:75], a[152:155], v[44:47], v[72:75]
    v_mfma_f32_16x16x32_bf16 v[68:71], a[156:159], v[32:35], v[68:71]
    v_mfma_f32_16x16x32_bf16 v[72:75], a[156:159], v[48:51], v[72:75]
    v_mul_f32 v104, v60, v52
    v_mul_f32 v105, v61, v52
    v_mul_f32 v106, v62, v52
    v_mul_f32 v107, v63, v52
    v_fmac_f32 v104, v64, v54
    v_fmac_f32 v105, v65, v54
    v_fmac_f32 v106, v66, v54
    v_fmac_f32 v107, v67, v54
    v_add_f32_dpp v104, v104, v104 row_ror:8 row_mask:0xf bank_mask:0xf
    v_add_f32_dpp v105, v105, v105 row_ror:8 row_mask:0xf bank_mask:0xf
    v_add_f32_dpp v106, v106, v106 row_ror:8 row_mask:0xf bank_mask:0xf
    v_add_f32_dpp v107, v107, v107 row_ror:8 row_mask:0xf bank_mask:0xf
    v_add_f32_dpp v104, v104, v104 row_ror:4 row_mask:0xf bank_mask:0xf
    v_add_f32_dpp v105, v105, v105 row_ror:4 row_mask:0xf bank_mask:0xf
    v_add_f32_dpp v106, v106, v106 row_ror:4 row_mask:0xf bank_mask:0xf
    v_add_f32_dpp v107, v107, v107 row_ror:4 row_mask:0xf bank_mask:0xf
    ds_write_b128 v94, v[104:107] offset:0
    v_mfma_f32_16x16x32_bf16 v[60:63], a[160:163], v[20:23], 0
    v_mfma_f32_16x16x32_bf16 v[64:67], a[160:163], v[36:39], 0
    v_mfma_f32_16x16x32_bf16 v[60:63], a[164:167], v[24:27], v[60:63]
    v_mfma_f32_16x16x32_bf16 v[64:67], a[164:167], v[40:43], v[64:67]
    v_mfma_f32_16x16x32_bf16 v[60:63], a[168:171], v[28:31], v[60:63]
    v_mfma_f32_16x16x32_bf16 v[64:67], a[168:171], v[44:47], v[64:67]
    v_mfma_f32_16x16x32_bf16 v[60:63], a[172:175], v[32:35], v[60:63]
    v_mfma_f32_16x16x32_bf16 v[64:67], a[172:175], v[48:51], v[64:67]
    v_mul_f32 v108, v68, v52
    v_mul_f32 v109, v69, v52
    v_mul_f32 v110, v70, v52
    v_mul_f32 v111, v71, v52
    v_fmac_f32 v108, v72, v54
    v_fmac_f32 v109, v73, v54
    v_fmac_f32 v110, v74, v54
    v_fmac_f32 v111, v75, v54
    v_add_f32_dpp v108, v108, v108 row_ror:8 row_mask:0xf bank_mask:0xf
    v_add_f32_dpp v109, v109, v109 row_ror:8 row_mask:0xf bank_mask:0xf
    v_add_f32_dpp v110, v110, v110 row_ror:8 row_mask:0xf bank_mask:0xf
    v_add_f32_dpp v111, v111, v111 row_ror:8 row_mask:0xf bank_mask:0xf
    v_add_f32_dpp v108, v108, v108 row_ror:4 row_mask:0xf bank_mask:0xf
    v_add_f32_dpp v109, v109, v109 row_ror:4 row_mask:0xf bank_mask:0xf
    v_add_f32_dpp v110, v110, v110 row_ror:4 row_mask:0xf bank_mask:0xf
    v_add_f32_dpp v111, v111, v111 row_ror:4 row_mask:0xf bank_mask:0xf
    ds_write_b128 v94, v[108:111] offset:64
    v_mfma_f32_16x16x32_bf16 v[68:71], a[176:179], v[20:23], 0
    v_mfma_f32_16x16x32_bf16 v[72:75], a[176:179], v[36:39], 0
    v_mfma_f32_16x16x32_bf16 v[68:71], a[180:183], v[24:27], v[68:71]
    v_mfma_f32_16x16x32_bf16 v[72:75], a[180:183], v[40:43], v[72:75]
    v_mfma_f32_16x16x32_bf16 v[68:71], a[184:187], v[28:31], v[68:71]
    v_mfma_f32_16x16x32_bf16 v[72:75], a[184:187], v[44:47], v[72:75]
    v_mfma_f32_16x16x32_bf16 v[68:71], a[188:191], v[32:35], v[68:71]
    v_mfma_f32_16x16x32_bf16 v[72:75], a[188:191], v[48:51], v[72:75]
    v_mul_f32 v104, v60, v52
    v_mul_f32 v105, v61, v52
    v_mul_f32 v106, v62, v52
    v_mul_f32 v107, v63, v52
    v_fmac_f32 v104, v64, v54
    v_fmac_f32 v105, v65, v54
    v_fmac_f32 v106, v66, v54
    v_fmac_f32 v107, v67, v54
    v_add_f32_dpp v104, v104, v104 row_ror:8 row_mask:0xf bank_mask:0xf
    v_add_f32_dpp v105, v105, v105 row_ror:8 row_mask:0xf bank_mask:0xf
    v_add_f32_dpp v106, v106, v106 row_ror:8 row_mask:0xf bank_mask:0xf
    v_add_f32_dpp v107, v107, v107 row_ror:8 row_mask:0xf bank_mask:0xf
    v_add_f32_dpp v104, v104, v104 row_ror:4 row_mask:0xf bank_mask:0xf
    v_add_f32_dpp v105, v105, v105 row_ror:4 row_mask:0xf bank_mask:0xf
    v_add_f32_dpp v106, v106, v106 row_ror:4 row_mask:0xf bank_mask:0xf
    v_add_f32_dpp v107, v107, v107 row_ror:4 row_mask:0xf bank_mask:0xf
    ds_write_b128 v94, v[104:107] offset:128
    v_mfma_f32_16x16x32_bf16 v[60:63], a[192:195], v[20:23], 0
    v_mfma_f32_16x16x32_bf16 v[64:67], a[192:195], v[36:39], 0
    v_mfma_f32_16x16x32_bf16 v[60:63], a[196:199], v[24:27], v[60:63]
    v_mfma_f32_16x16x32_bf16 v[64:67], a[196:199], v[40:43], v[64:67]
    v_mfma_f32_16x16x32_bf16 v[60:63], a[200:203], v[28:31], v[60:63]
    v_mfma_f32_16x16x32_bf16 v[64:67], a[200:203], v[44:47], v[64:67]
    v_mfma_f32_16x16x32_bf16 v[60:63], a[204:207], v[32:35], v[60:63]
    v_mfma_f32_16x16x32_bf16 v[64:67], a[204:207], v[48:51], v[64:67]
    v_mul_f32 v108, v68, v52
    v_mul_f32 v109, v69, v52
    v_mul_f32 v110, v70, v52
    v_mul_f32 v111, v71, v52
    v_fmac_f32 v108, v72, v54
    v_fmac_f32 v109, v73, v54
    v_fmac_f32 v110, v74, v54
    v_fmac_f32 v111, v75, v54
    v_add_f32_dpp v108, v108, v108 row_ror:8 row_mask:0xf bank_mask:0xf
    v_add_f32_dpp v109, v109, v109 row_ror:8 row_mask:0xf bank_mask:0xf
    v_add_f32_dpp v110, v110, v110 row_ror:8 row_mask:0xf bank_mask:0xf
    v_add_f32_dpp v111, v111, v111 row_ror:8 row_mask:0xf bank_mask:0xf
    v_add_f32_dpp v108, v108, v108 row_ror:4 row_mask:0xf bank_mask:0xf
    v_add_f32_dpp v109, v109, v109 row_ror:4 row_mask:0xf bank_mask:0xf
    v_add_f32_dpp v110, v110, v110 row_ror:4 row_mask:0xf bank_mask:0xf
    v_add_f32_dpp v111, v111, v111 row_ror:4 row_mask:0xf bank_mask:0xf
    ds_write_b128 v94, v[108:111] offset:192
    v_mfma_f32_16x16x32_bf16 v[68:71], a[208:211], v[20:23], 0
    v_mfma_f32_16x16x32_bf16 v[72:75], a[208:211], v[36:39], 0
    v_mfma_f32_16x16x32_bf16 v[68:71], a[212:215], v[24:27], v[68:71]
    v_mfma_f32_16x16x32_bf16 v[72:75], a[212:215], v[40:43], v[72:75]
    v_mfma_f32_16x16x32_bf16 v[68:71], a[216:219], v[28:31], v[68:71]
    v_mfma_f32_16x16x32_bf16 v[72:75], a[216:219], v[44:47], v[72:75]
    v_mfma_f32_16x16x32_bf16 v[68:71], a[220:223], v[32:35], v[68:71]
    v_mfma_f32_16x16x32_bf16 v[72:75], a[220:223], v[48:51], v[72:75]
    v_mul_f32 v104, v60, v52
    v_mul_f32 v105, v61, v52
    v_mul_f32 v106, v62, v52
    v_mul_f32 v107, v63, v52
    v_fmac_f32 v104, v64, v54
    v_fmac_f32 v105, v65, v54
    v_fmac_f32 v106, v66, v54
    v_fmac_f32 v107, v67, v54
    v_add_f32_dpp v104, v104, v104 row_ror:8 row_mask:0xf bank_mask:0xf
    v_add_f32_dpp v105, v105, v105 row_ror:8 row_mask:0xf bank_mask:0xf
    v_add_f32_dpp v106, v106, v106 row_ror:8 row_mask:0xf bank_mask:0xf
    v_add_f32_dpp v107, v107, v107 row_ror:8 row_mask:0xf bank_mask:0xf
    v_add_f32_dpp v104, v104, v104 row_ror:4 row_mask:0xf bank_mask:0xf
    v_add_f32_dpp v105, v105, v105 row_ror:4 row_mask:0xf bank_mask:0xf
    v_add_f32_dpp v106, v106, v106 row_ror:4 row_mask:0xf bank_mask:0xf
    v_add_f32_dpp v107, v107, v107 row_ror:4 row_mask:0xf bank_mask:0xf
    ds_write_b128 v94, v[104:107] offset:256
    v_mfma_f32_16x16x32_bf16 v[60:63], a[224:227], v[20:23], 0
    v_mfma_f32_16x16x32_bf16 v[64:67], a[224:227], v[36:39], 0
    v_mfma_f32_16x16x32_bf16 v[60:63], a[228:231], v[24:27], v[60:63]
    v_mfma_f32_16x16x32_bf16 v[64:67], a[228:231], v[40:43], v[64:67]
    v_mfma_f32_16x16x32_bf16 v[60:63], a[232:235], v[28:31], v[60:63]
    v_mfma_f32_16x16x32_bf16 v[64:67], a[232:235], v[44:47], v[64:67]
    v_mfma_f32_16x16x32_bf16 v[60:63], a[236:239], v[32:35], v[60:63]
    v_mfma_f32_16x16x32_bf16 v[64:67], a[236:239], v[48:51], v[64:67]
    v_mul_f32 v108, v68, v52
    v_mul_f32 v109, v69, v52
    v_mul_f32 v110, v70, v52
    v_mul_f32 v111, v71, v52
    v_fmac_f32 v108, v72, v54
    v_fmac_f32 v109, v73, v54
    v_fmac_f32 v110, v74, v54
    v_fmac_f32 v111, v75, v54
    v_add_f32_dpp v108, v108, v108 row_ror:8 row_mask:0xf bank_mask:0xf
    v_add_f32_dpp v109, v109, v109 row_ror:8 row_mask:0xf bank_mask:0xf
    v_add_f32_dpp v110, v110, v110 row_ror:8 row_mask:0xf bank_mask:0xf
    v_add_f32_dpp v111, v111, v111 row_ror:8 row_mask:0xf bank_mask:0xf
    v_add_f32_dpp v108, v108, v108 row_ror:4 row_mask:0xf bank_mask:0xf
    v_add_f32_dpp v109, v109, v109 row_ror:4 row_mask:0xf bank_mask:0xf
    v_add_f32_dpp v110, v110, v110 row_ror:4 row_mask:0xf bank_mask:0xf
    v_add_f32_dpp v111, v111, v111 row_ror:4 row_mask:0xf bank_mask:0xf
    ds_write_b128 v94, v[108:111] offset:320
    v_mfma_f32_16x16x32_bf16 v[68:71], a[240:243], v[20:23], 0
    v_mfma_f32_16x16x32_bf16 v[72:75], a[240:243], v[36:39], 0
    v_mfma_f32_16x16x32_bf16 v[68:71], a[244:247], v[24:27], v[68:71]
    v_mfma_f32_16x16x32_bf16 v[72:75], a[244:247], v[40:43], v[72:75]
    v_mfma_f32_16x16x32_bf16 v[68:71], a[248:251], v[28:31], v[68:71]
    v_mfma_f32_16x16x32_bf16 v[72:75], a[248:251], v[44:47], v[72:75]
    v_mfma_f32_16x16x32_bf16 v[68:71], a[252:255], v[32:35], v[68:71]
    v_mfma_f32_16x16x32_bf16 v[72:75], a[252:255], v[48:51], v[72:75]
    v_mul_f32 v104, v60, v52
    v_mul_f32 v105, v61, v52
    v_mul_f32 v106, v62, v52
    v_mul_f32 v107, v63, v52
    v_fmac_f32 v104, v64, v54
    v_fmac_f32 v105, v65, v54
    v_fmac_f32 v106, v66, v54
    v_fmac_f32 v107, v67, v54
    v_add_f32_dpp v104, v104, v104 row_ror:8 row_mask:0xf bank_mask:0xf
    v_add_f32_dpp v105, v105, v105 row_ror:8 row_mask:0xf bank_mask:0xf
    v_add_f32_dpp v106, v106, v106 row_ror:8 row_mask:0xf bank_mask:0xf
    v_add_f32_dpp v107, v107, v107 row_ror:8 row_mask:0xf bank_mask:0xf
    v_add_f32_dpp v104, v104, v104 row_ror:4 row_mask:0xf bank_mask:0xf
    v_add_f32_dpp v105, v105, v105 row_ror:4 row_mask:0xf bank_mask:0xf
    v_add_f32_dpp v106, v106, v106 row_ror:4 row_mask:0xf bank_mask:0xf
    v_add_f32_dpp v107, v107, v107 row_ror:4 row_mask:0xf bank_mask:0xf
    ds_write_b128 v94, v[104:107] offset:384
    v_mul_f32 v108, v68, v52
    v_mul_f32 v109, v69, v52
    v_mul_f32 v110, v70, v52
    v_mul_f32 v111, v71, v52
    v_fmac_f32 v108, v72, v54
    v_fmac_f32 v109, v73, v54
    v_fmac_f32 v110, v74, v54
    v_fmac_f32 v111, v75, v54
    v_add_f32_dpp v108, v108, v108 row_ror:8 row_mask:0xf bank_mask:0xf
    v_add_f32_dpp v109, v109, v109 row_ror:8 row_mask:0xf bank_mask:0xf
    v_add_f32_dpp v110, v110, v110 row_ror:8 row_mask:0xf bank_mask:0xf
    v_add_f32_dpp v111, v111, v111 row_ror:8 row_mask:0xf bank_mask:0xf
    v_add_f32_dpp v108, v108, v108 row_ror:4 row_mask:0xf bank_mask:0xf
    v_add_f32_dpp v109, v109, v109 row_ror:4 row_mask:0xf bank_mask:0xf
    v_add_f32_dpp v110, v110, v110 row_ror:4 row_mask:0xf bank_mask:0xf
    v_add_f32_dpp v111, v111, v111 row_ror:4 row_mask:0xf bank_mask:0xf
    ds_write_b128 v94, v[108:111] offset:448
    s_waitcnt lgkmcnt(0)
    s_barrier
    ds_read_b128 v[20:23], v96 offset:0
    ds_read_b128 v[24:27], v96 offset:2048
    ds_read_b128 v[28:31], v96 offset:4096
    ds_read_b128 v[32:35], v96 offset:6144
    s_waitcnt lgkmcnt(0)
    v_add_f32 v20, v20, v24
    v_add_f32 v28, v28, v32
    v_add_f32 v21, v21, v25
    v_add_f32 v29, v29, v33
    v_add_f32 v22, v22, v26
    v_add_f32 v30, v30, v34
    v_add_f32 v23, v23, v27
    v_add_f32 v31, v31, v35
    v_add_f32 v20, v20, v28
    v_add_f32 v21, v21, v29
    v_add_f32 v22, v22, v30
    v_add_f32 v23, v23, v31
    v_cvt_pk_bf16_f32 v20, v20, v21
    v_cvt_pk_bf16_f32 v21, v22, v23
    ds_write_b64 v97, v[20:21]
    v_lshlrev_b32 v4, 2, v1
    v_add_u32 v4, 148736, v4
    ds_write_b32 v4, v100
L_final:
    s_waitcnt lgkmcnt(0)
    s_barrier
    ds_read_b128 v[136:139], v112 offset:0
    ds_read_b128 v[140:143], v112 offset:64
    ds_read_b128 v[144:147], v112 offset:128
    ds_read_b128 v[148:151], v112 offset:192
    ds_read_b128 v[152:155], v113 offset:0
    ds_read_b128 v[156:159], v113 offset:64
    s_add_u32 s36, s96, 32768
    s_add_u32 s37, s96, 4096
    s_waitcnt lgkmcnt(5)
    v_mfma_f32_16x16x32_bf16 v[84:87], a[0:3], v[136:139], 0
    ds_read_b128 v[160:163], v113 offset:128
    v_mfma_f32_16x16x32_bf16 v[88:91], a[64:67], v[136:139], 0
    s_waitcnt lgkmcnt(5)
    v_mfma_f32_16x16x32_bf16 v[84:87], a[4:7], v[140:143], v[84:87]
    ds_read_b128 v[164:167], v113 offset:192
    v_mfma_f32_16x16x32_bf16 v[88:91], a[68:71], v[140:143], v[88:91]
    s_waitcnt lgkmcnt(5)
    v_mfma_f32_16x16x32_bf16 v[84:87], a[8:11], v[144:147], v[84:87]
    ds_read_b128 v[168:171], v114 offset:0
    v_mfma_f32_16x16x32_bf16 v[88:91], a[72:75], v[144:147], v[88:91]
    s_waitcnt lgkmcnt(5)
    v_mfma_f32_16x16x32_bf16 v[84:87], a[12:15], v[148:151], v[84:87]
    ds_read_b128 v[172:175], v114 offset:64
    v_mfma_f32_16x16x32_bf16 v[88:91], a[76:79], v[148:151], v[88:91]
    s_waitcnt lgkmcnt(5)
    v_mfma_f32_16x16x32_bf16 v[84:87], a[16:19], v[152:155], v[84:87]
    ds_read_b128 v[176:179], v114 offset:128
    v_mfma_f32_16x16x32_bf16 v[88:91], a[80:83], v[152:155], v[88:91]
    s_waitcnt lgkmcnt(5)
    v_mfma_f32_16x16x32_bf16 v[84:87], a[20:23], v[156:159], v[84:87]
    ds_read_b128 v[180:183], v114 offset:192
    v_mfma_f32_16x16x32_bf16 v[88:91], a[84:87], v[156:159], v[88:91]
    s_waitcnt lgkmcnt(5)
    v_mfma_f32_16x16x32_bf16 v[84:87], a[24:27], v[160:163], v[84:87]
    ds_read_b128 v[184:187], v115 offset:0
    v_mfma_f32_16x16x32_bf16 v[88:91], a[88:91], v[160:163], v[88:91]
    s_waitcnt lgkmcnt(5)
    v_mfma_f32_16x16x32_bf16 v[84:87], a[28:31], v[164:167], v[84:87]
    ds_read_b128 v[188:191], v115 offset:64
    v_mfma_f32_16x16x32_bf16 v[88:91], a[92:95], v[164:167], v[88:91]
    s_waitcnt lgkmcnt(5)
    v_mfma_f32_16x16x32_bf16 v[84:87], a[32:35], v[168:171], v[84:87]
    ds_read_b128 v[192:195], v115 offset:128
    v_mfma_f32_16x16x32_bf16 v[88:91], a[96:99], v[168:171], v[88:91]
    s_waitcnt lgkmcnt(5)
    v_mfma_f32_16x16x32_bf16 v[84:87], a[36:39], v[172:175], v[84:87]
    ds_read_b128 v[196:199], v115 offset:192
    v_mfma_f32_16x16x32_bf16 v[88:91], a[100:103], v[172:175], v[88:91]
    s_waitcnt lgkmcnt(5)
    v_mfma_f32_16x16x32_bf16 v[84:87], a[40:43], v[176:179], v[84:87]
    v_mfma_f32_16x16x32_bf16 v[88:91], a[104:107], v[176:179], v[88:91]
    s_waitcnt lgkmcnt(4)
    v_mfma_f32_16x16x32_bf16 v[84:87], a[44:47], v[180:183], v[84:87]
    v_mfma_f32_16x16x32_bf16 v[88:91], a[108:111], v[180:183], v[88:91]
    s_waitcnt lgkmcnt(3)
    v_mfma_f32_16x16x32_bf16 v[84:87], a[48:51], v[184:187], v[84:87]
    v_mfma_f32_16x16x32_bf16 v[88:91], a[112:115], v[184:187], v[88:91]
    s_waitcnt lgkmcnt(2)
    v_mfma_f32_16x16x32_bf16 v[84:87], a[52:55], v[188:191], v[84:87]
    v_mfma_f32_16x16x32_bf16 v[88:91], a[116:119], v[188:191], v[88:91]
    s_waitcnt lgkmcnt(1)
    v_mfma_f32_16x16x32_bf16 v[84:87], a[56:59], v[192:195], v[84:87]
    v_mfma_f32_16x16x32_bf16 v[88:91], a[120:123], v[192:195], v[88:91]
    s_waitcnt lgkmcnt(0)
    v_mfma_f32_16x16x32_bf16 v[84:87], a[60:63], v[196:199], v[84:87]
    v_mfma_f32_16x16x32_bf16 v[88:91], a[124:127], v[196:199], v[88:91]
    s_nop 6
    v_and_or_b32 v84, v84, s82, v8
    v_and_or_b32 v85, v85, s82, v8
    v_and_or_b32 v86, v86, s82, v8
    v_and_or_b32 v87, v87, s82, v8
    buffer_store_dwordx4 v[84:87], v77, s[48:51], s96 offen sc1
    v_and_or_b32 v88, v88, s82, v8
    v_and_or_b32 v89, v89, s82, v8
    v_and_or_b32 v90, v90, s82, v8
    v_and_or_b32 v91, v91, s82, v8
    buffer_store_dwordx4 v[88:91], v77, s[48:51], s36 offen sc1
    s_cmp_eq_u32 s92, 0
    s_cbranch_scc1 L_prepb
L_hop2:
L_hop2poll:
    buffer_load_dwordx4 v[200:203], v78, s[48:51], s96 offen sc1
    buffer_load_dwordx4 v[204:207], v78, s[48:51], s37 offen sc1
    s_waitcnt vmcnt(0)
    v_xor_b32 v200, s35, v200
    v_xor_b32 v201, s35, v201
    v_xor_b32 v202, s35, v202
    v_xor_b32 v203, s35, v203
    v_xor_b32 v204, s35, v204
    v_xor_b32 v205, s35, v205
    v_xor_b32 v206, s35, v206
    v_xor_b32 v207, s35, v207
    v_or_b32 v4, v200, v201
    v_or3_b32 v4, v4, v202, v203
    v_or3_b32 v4, v4, v204, v205
    v_or3_b32 v4, v4, v206, v207
    v_and_b32 v4, 0xff, v4
    v_cmp_ne_u32 vcc, 0, v4
    v_add_f32 v104, v200, v204
    v_add_f32 v105, v201, v205
    v_add_f32 v106, v202, v206
    v_add_f32 v107, v203, v207
    s_cbranch_vccz L_hop2ok
    s_sub_u32 s84, s84, 1
    s_cmp_lg_u32 s84, 0
    s_cbranch_scc1 L_hop2poll
    s_branch L_end
L_hop2ok:
    v_permlane16_swap_b32 v104, v105
    v_permlane16_swap_b32 v106, v107
    v_add_f32 v104, v104, v105
    v_add_f32 v106, v106, v107
    s_nop 1
    v_permlane32_swap_b32 v104, v106
    v_add_f32 v104, v104, v106
    s_nop 1
    v_add_f32_dpp v104, v104, v104 row_ror:8 row_mask:0xf bank_mask:0xf
    s_nop 1
    v_add_f32_dpp v104, v104, v104 row_ror:4 row_mask:0xf bank_mask:0xf
    v_cvt_pk_bf16_f32 v104, v104, v104
    s_mov_b32 exec_lo, 0xf000f
    s_mov_b32 exec_hi, 0xf000f
    buffer_store_short v104, v79, s[72:75], s97 offen
    s_mov_b64 exec, -1
    s_cmp_lg_u32 s92, 0
    s_cbranch_scc1 L_fin
    s_mov_b32 s92, 1
    s_mov_b32 s96, 3670016
    s_mov_b32 s97, 1024
    s_lshl_b32 s85, s32, 2
    s_add_u32 s85, s85, s34
    s_lshl_b32 s85, s85, 13
    s_add_u32 s85, s85, 5242880
    s_branch L_hop1
    v_min_u32 v5, 6, v1
    v_lshlrev_b32 v5, 10, v5
L_light:
    buffer_load_dword v6, v5, s[48:51], s85 offen offset:512 sc1
    s_waitcnt vmcnt(0)
    v_xor_b32 v6, s35, v6
    v_and_b32 v6, 0xff, v6
    v_cmp_ne_u32 vcc, 0, v6
    s_nop 0
    s_and_b32 s36, vcc_lo, 0x7f
    s_bcnt1_i32_b32 s36, s36
    s_cmp_le_u32 s36, 7
    s_cbranch_scc1 L_hop1
    s_sleep 2
    s_sub_u32 s84, s84, 1
    s_cmp_lg_u32 s84, 0
    s_cbranch_scc1 L_light
    s_branch L_end
L_hop1:
    s_mov_b32 s93, 0x7f
    s_mov_b32 s94, 0
    v_mov_b32 v55, 0xff7f0000
    v_mov_b32 v56, 0
    v_mov_b32 v57, 0
    v_mov_b32 v58, 0
    v_mov_b32 v59, 0
    s_and_b32 s94, s94, s93
    s_cselect_b32 s94, s94, s93
    s_ff1_i32_b32 s4, s94
    s_bitset0_b32 s94, s4
    s_lshl_b32 s36, s4, 10
    s_add_u32 s36, s36, s85
    buffer_load_dwordx4 v[20:23], v92, s[48:51], s36 offen sc1
    s_and_b32 s94, s94, s93
    s_cselect_b32 s94, s94, s93
    s_ff1_i32_b32 s5, s94
    s_bitset0_b32 s94, s5
    s_lshl_b32 s36, s5, 10
    s_add_u32 s36, s36, s85
    buffer_load_dwordx4 v[24:27], v92, s[48:51], s36 offen sc1
    s_and_b32 s94, s94, s93
    s_cselect_b32 s94, s94, s93
    s_ff1_i32_b32 s6, s94
    s_bitset0_b32 s94, s6
    s_lshl_b32 s36, s6, 10
    s_add_u32 s36, s36, s85
    buffer_load_dwordx4 v[28:31], v92, s[48:51], s36 offen sc1
L_hop1poll:
    s_and_b32 s94, s94, s93
    s_cselect_b32 s94, s94, s93
    s_ff1_i32_b32 s7, s94
    s_bitset0_b32 s94, s7
    s_lshl_b32 s36, s7, 10
    s_add_u32 s36, s36, s85
    buffer_load_dwordx4 v[32:35], v92, s[48:51], s36 offen sc1
    s_waitcnt vmcnt(3)
    v_xor_b32 v20, s35, v20
    v_xor_b32 v21, s35, v21
    v_xor_b32 v22, s35, v22
    v_xor_b32 v23, s35, v23
    v_or_b32 v4, v20, v21
    v_or3_b32 v4, v4, v22, v23
    v_and_b32 v4, 0xff, v4
    v_cmp_ne_u32 vcc, 0, v4
    v_max_f32 v5, v55, v20
    s_cbranch_vccnz L_mnext_25
    s_bitcmp1_b32 s93, s4
    s_cbranch_scc0 L_mnext_25
    v_sub_f32 v52, v55, v5
    v_sub_f32 v53, v20, v5
    v_exp_f32 v52, v52
    v_exp_f32 v53, v53
    v_mov_b32 v55, v5
    s_bitset0_b32 s93, s4
    v_mul_f32_dpp v57, v52, v57 row_newbcast:8 row_mask:0xf bank_mask:0xf
    v_mul_f32_dpp v56, v52, v56 row_newbcast:8 row_mask:0xf bank_mask:0xf
    v_mul_f32_dpp v58, v52, v58 row_newbcast:8 row_mask:0xf bank_mask:0xf
    v_mul_f32_dpp v59, v52, v59 row_newbcast:8 row_mask:0xf bank_mask:0xf
    v_fmac_f32_dpp v57, v53, v21 row_newbcast:8 row_mask:0xf bank_mask:0xf
    v_fmac_f32_dpp v56, v53, v20 row_newbcast:8 row_mask:0xf bank_mask:0xf
    v_fmac_f32_dpp v58, v53, v22 row_newbcast:8 row_mask:0xf bank_mask:0xf
    v_fmac_f32_dpp v59, v53, v23 row_newbcast:8 row_mask:0xf bank_mask:0xf
    s_cmp_eq_u32 s93, 0
    s_cbranch_scc1 L_hop1ok
L_mnext_25:
    s_and_b32 s94, s94, s93
    s_cselect_b32 s94, s94, s93
    s_ff1_i32_b32 s4, s94
    s_bitset0_b32 s94, s4
    s_lshl_b32 s36, s4, 10
    s_add_u32 s36, s36, s85
    buffer_load_dwordx4 v[20:23], v92, s[48:51], s36 offen sc1
    s_waitcnt vmcnt(3)
    v_xor_b32 v24, s35, v24
    v_xor_b32 v25, s35, v25
    v_xor_b32 v26, s35, v26
    v_xor_b32 v27, s35, v27
    v_or_b32 v4, v24, v25
    v_or3_b32 v4, v4, v26, v27
    v_and_b32 v4, 0xff, v4
    v_cmp_ne_u32 vcc, 0, v4
    v_max_f32 v5, v55, v24
    s_cbranch_vccnz L_mnext_26
    s_bitcmp1_b32 s93, s5
    s_cbranch_scc0 L_mnext_26
    v_sub_f32 v52, v55, v5
    v_sub_f32 v53, v24, v5
    v_exp_f32 v52, v52
    v_exp_f32 v53, v53
    v_mov_b32 v55, v5
    s_bitset0_b32 s93, s5
    v_mul_f32_dpp v57, v52, v57 row_newbcast:8 row_mask:0xf bank_mask:0xf
    v_mul_f32_dpp v56, v52, v56 row_newbcast:8 row_mask:0xf bank_mask:0xf
    v_mul_f32_dpp v58, v52, v58 row_newbcast:8 row_mask:0xf bank_mask:0xf
    v_mul_f32_dpp v59, v52, v59 row_newbcast:8 row_mask:0xf bank_mask:0xf
    v_fmac_f32_dpp v57, v53, v25 row_newbcast:8 row_mask:0xf bank_mask:0xf
    v_fmac_f32_dpp v56, v53, v24 row_newbcast:8 row_mask:0xf bank_mask:0xf
    v_fmac_f32_dpp v58, v53, v26 row_newbcast:8 row_mask:0xf bank_mask:0xf
    v_fmac_f32_dpp v59, v53, v27 row_newbcast:8 row_mask:0xf bank_mask:0xf
    s_cmp_eq_u32 s93, 0
    s_cbranch_scc1 L_hop1ok
L_mnext_26:
    s_and_b32 s94, s94, s93
    s_cselect_b32 s94, s94, s93
    s_ff1_i32_b32 s5, s94
    s_bitset0_b32 s94, s5
    s_lshl_b32 s36, s5, 10
    s_add_u32 s36, s36, s85
    buffer_load_dwordx4 v[24:27], v92, s[48:51], s36 offen sc1
    s_waitcnt vmcnt(3)
    v_xor_b32 v28, s35, v28
    v_xor_b32 v29, s35, v29
    v_xor_b32 v30, s35, v30
    v_xor_b32 v31, s35, v31
    v_or_b32 v4, v28, v29
    v_or3_b32 v4, v4, v30, v31
    v_and_b32 v4, 0xff, v4
    v_cmp_ne_u32 vcc, 0, v4
    v_max_f32 v5, v55, v28
    s_cbranch_vccnz L_mnext_27
    s_bitcmp1_b32 s93, s6
    s_cbranch_scc0 L_mnext_27
    v_sub_f32 v52, v55, v5
    v_sub_f32 v53, v28, v5
    v_exp_f32 v52, v52
    v_exp_f32 v53, v53
    v_mov_b32 v55, v5
    s_bitset0_b32 s93, s6
    v_mul_f32_dpp v57, v52, v57 row_newbcast:8 row_mask:0xf bank_mask:0xf
    v_mul_f32_dpp v56, v52, v56 row_newbcast:8 row_mask:0xf bank_mask:0xf
    v_mul_f32_dpp v58, v52, v58 row_newbcast:8 row_mask:0xf bank_mask:0xf
    v_mul_f32_dpp v59, v52, v59 row_newbcast:8 row_mask:0xf bank_mask:0xf
    v_fmac_f32_dpp v57, v53, v29 row_newbcast:8 row_mask:0xf bank_mask:0xf
    v_fmac_f32_dpp v56, v53, v28 row_newbcast:8 row_mask:0xf bank_mask:0xf
    v_fmac_f32_dpp v58, v53, v30 row_newbcast:8 row_mask:0xf bank_mask:0xf
    v_fmac_f32_dpp v59, v53, v31 row_newbcast:8 row_mask:0xf bank_mask:0xf
    s_cmp_eq_u32 s93, 0
    s_cbranch_scc1 L_hop1ok
L_mnext_27:
    s_and_b32 s94, s94, s93
    s_cselect_b32 s94, s94, s93
    s_ff1_i32_b32 s6, s94
    s_bitset0_b32 s94, s6
    s_lshl_b32 s36, s6, 10
    s_add_u32 s36, s36, s85
    buffer_load_dwordx4 v[28:31], v92, s[48:51], s36 offen sc1
    s_waitcnt vmcnt(3)
    v_xor_b32 v32, s35, v32
    v_xor_b32 v33, s35, v33
    v_xor_b32 v34, s35, v34
    v_xor_b32 v35, s35, v35
    v_or_b32 v4, v32, v33
    v_or3_b32 v4, v4, v34, v35
    v_and_b32 v4, 0xff, v4
    v_cmp_ne_u32 vcc, 0, v4
    v_max_f32 v5, v55, v32
    s_cbranch_vccnz L_mnext_28
    s_bitcmp1_b32 s93, s7
    s_cbranch_scc0 L_mnext_28
    v_sub_f32 v52, v55, v5
    v_sub_f32 v53, v32, v5
    v_exp_f32 v52, v52
    v_exp_f32 v53, v53
    v_mov_b32 v55, v5
    s_bitset0_b32 s93, s7
    v_mul_f32_dpp v57, v52, v57 row_newbcast:8 row_mask:0xf bank_mask:0xf
    v_mul_f32_dpp v56, v52, v56 row_newbcast:8 row_mask:0xf bank_mask:0xf
    v_mul_f32_dpp v58, v52, v58 row_newbcast:8 row_mask:0xf bank_mask:0xf
    v_mul_f32_dpp v59, v52, v59 row_newbcast:8 row_mask:0xf bank_mask:0xf
    v_fmac_f32_dpp v57, v53, v33 row_newbcast:8 row_mask:0xf bank_mask:0xf
    v_fmac_f32_dpp v56, v53, v32 row_newbcast:8 row_mask:0xf bank_mask:0xf
    v_fmac_f32_dpp v58, v53, v34 row_newbcast:8 row_mask:0xf bank_mask:0xf
    v_fmac_f32_dpp v59, v53, v35 row_newbcast:8 row_mask:0xf bank_mask:0xf
    s_cmp_eq_u32 s93, 0
    s_cbranch_scc1 L_hop1ok
L_mnext_28:
    s_sub_u32 s84, s84, 1
    s_cmp_lg_u32 s84, 0
    s_cbranch_scc1 L_hop1poll
    s_branch L_end
L_hop1ok:
    v_rcp_f32 v55, v57
    s_nop 1
    v_mul_f32_dpp v56, v55, v56 row_newbcast:8 row_mask:0xf bank_mask:0xf
    v_mul_f32_dpp v57, v55, v57 row_newbcast:8 row_mask:0xf bank_mask:0xf
    v_mul_f32_dpp v58, v55, v58 row_newbcast:8 row_mask:0xf bank_mask:0xf
    v_mul_f32_dpp v59, v55, v59 row_newbcast:8 row_mask:0xf bank_mask:0xf
    v_cvt_pk_bf16_f32 v56, v56, v57
    v_cvt_pk_bf16_f32 v58, v58, v59
    s_mov_b32 exec_lo, 0xff00ff
    s_mov_b32 exec_hi, 0xff00ff
    ds_write_b16 v93, v56
    ds_write_b16_d16_hi v93, v56 offset:16
    ds_write_b16 v93, v58 offset:32
    ds_write_b16_d16_hi v93, v58 offset:48
    s_mov_b64 exec, -1
    s_branch L_final
L_prepb:
    v_xor_b32 v4, 0, v95
    ds_read_b64_tr_b16 a[0:1], v4 offset:0
    ds_read_b64_tr_b16 a[4:5], v4 offset:8192
    ds_read_b64_tr_b16 a[8:9], v4 offset:16384
    ds_read_b64_tr_b16 a[12:13], v4 offset:24576
    v_xor_b32 v5, 16, v95
    ds_read_b64_tr_b16 a[2:3], v5 offset:1024
    ds_read_b64_tr_b16 a[6:7], v5 offset:9216
    ds_read_b64_tr_b16 a[10:11], v5 offset:17408
    ds_read_b64_tr_b16 a[14:15], v5 offset:25600
    v_xor_b32 v4, 32, v95
    ds_read_b64_tr_b16 a[16:17], v4 offset:0
    ds_read_b64_tr_b16 a[20:21], v4 offset:8192
    ds_read_b64_tr_b16 a[24:25], v4 offset:16384
    ds_read_b64_tr_b16 a[28:29], v4 offset:24576
    v_xor_b32 v5, 48, v95
    ds_read_b64_tr_b16 a[18:19], v5 offset:1024
    ds_read_b64_tr_b16 a[22:23], v5 offset:9216
    ds_read_b64_tr_b16 a[26:27], v5 offset:17408
    ds_read_b64_tr_b16 a[30:31], v5 offset:25600
    v_xor_b32 v4, 64, v95
    ds_read_b64_tr_b16 a[32:33], v4 offset:0
    ds_read_b64_tr_b16 a[36:37], v4 offset:8192
    ds_read_b64_tr_b16 a[40:41], v4 offset:16384
    ds_read_b64_tr_b16 a[44:45], v4 offset:24576
    v_xor_b32 v5, 80, v95
    ds_read_b64_tr_b16 a[34:35], v5 offset:1024
    ds_read_b64_tr_b16 a[38:39], v5 offset:9216
    ds_read_b64_tr_b16 a[42:43], v5 offset:17408
    ds_read_b64_tr_b16 a[46:47], v5 offset:25600
    v_xor_b32 v4, 96, v95
    ds_read_b64_tr_b16 a[48:49], v4 offset:0
    ds_read_b64_tr_b16 a[52:53], v4 offset:8192
    ds_read_b64_tr_b16 a[56:57], v4 offset:16384
    ds_read_b64_tr_b16 a[60:61], v4 offset:24576
    v_xor_b32 v5, 112, v95
    ds_read_b64_tr_b16 a[50:51], v5 offset:1024
    ds_read_b64_tr_b16 a[54:55], v5 offset:9216
    ds_read_b64_tr_b16 a[58:59], v5 offset:17408
    ds_read_b64_tr_b16 a[62:63], v5 offset:25600
    v_xor_b32 v4, 128, v95
    ds_read_b64_tr_b16 a[64:65], v4 offset:0
    ds_read_b64_tr_b16 a[68:69], v4 offset:8192
    ds_read_b64_tr_b16 a[72:73], v4 offset:16384
    ds_read_b64_tr_b16 a[76:77], v4 offset:24576
    v_xor_b32 v5, 144, v95
    ds_read_b64_tr_b16 a[66:67], v5 offset:1024
    ds_read_b64_tr_b16 a[70:71], v5 offset:9216
    ds_read_b64_tr_b16 a[74:75], v5 offset:17408
    ds_read_b64_tr_b16 a[78:79], v5 offset:25600
    v_xor_b32 v4, 160, v95
    ds_read_b64_tr_b16 a[80:81], v4 offset:0
    ds_read_b64_tr_b16 a[84:85], v4 offset:8192
    ds_read_b64_tr_b16 a[88:89], v4 offset:16384
    ds_read_b64_tr_b16 a[92:93], v4 offset:24576
    v_xor_b32 v5, 176, v95
    ds_read_b64_tr_b16 a[82:83], v5 offset:1024
    ds_read_b64_tr_b16 a[86:87], v5 offset:9216
    ds_read_b64_tr_b16 a[90:91], v5 offset:17408
    ds_read_b64_tr_b16 a[94:95], v5 offset:25600
    v_xor_b32 v4, 192, v95
    ds_read_b64_tr_b16 a[96:97], v4 offset:0
    ds_read_b64_tr_b16 a[100:101], v4 offset:8192
    ds_read_b64_tr_b16 a[104:105], v4 offset:16384
    ds_read_b64_tr_b16 a[108:109], v4 offset:24576
    v_xor_b32 v5, 208, v95
    ds_read_b64_tr_b16 a[98:99], v5 offset:1024
    ds_read_b64_tr_b16 a[102:103], v5 offset:9216
    ds_read_b64_tr_b16 a[106:107], v5 offset:17408
    ds_read_b64_tr_b16 a[110:111], v5 offset:25600
    v_xor_b32 v4, 224, v95
    ds_read_b64_tr_b16 a[112:113], v4 offset:0
    ds_read_b64_tr_b16 a[116:117], v4 offset:8192
    ds_read_b64_tr_b16 a[120:121], v4 offset:16384
    ds_read_b64_tr_b16 a[124:125], v4 offset:24576
    v_xor_b32 v5, 240, v95
    ds_read_b64_tr_b16 a[114:115], v5 offset:1024
    ds_read_b64_tr_b16 a[118:119], v5 offset:9216
    ds_read_b64_tr_b16 a[122:123], v5 offset:17408
    ds_read_b64_tr_b16 a[126:127], v5 offset:25600
    s_waitcnt lgkmcnt(0)
    s_barrier
    s_branch L_hop2
L_fin:
    s_or_b32 s36, s32, s34
    s_cmp_lg_u32 s36, 0
    s_cbranch_scc1 L_end
    s_mov_b64 exec, 1
    buffer_store_dword v8, v100, s[48:51], 0 offen
L_end:
    s_endpgm
    .fill (32768 - (. - concat_heads__compressed_kv_cla__mha_block_cached__decode_kernel)) / 4 + 1, 4, 0xbf810000
.section .rodata,"a"
.p2align 6
.amdhsa_kernel concat_heads__compressed_kv_cla__mha_block_cached__decode_kernel
  .amdhsa_next_free_vgpr 512
  .amdhsa_next_free_sgpr 102
  .amdhsa_accum_offset 256
  .amdhsa_group_segment_fixed_size 0
  .amdhsa_kernarg_size 112
  .amdhsa_user_sgpr_count 2
  .amdhsa_user_sgpr_kernarg_segment_ptr 1
  .amdhsa_system_sgpr_workgroup_id_x 1
.end_amdhsa_kernel
```

```asm
; @launch grid=(256,1,1) block=(256,1,1) lds=163840
    .amdgcn_target "amdgcn-amd-amdhsa--gfx950"
    .text
    .globl concat_heads__compressed_kv_cla__mha_block_cached__decode_kernel
    .p2align 8
    .type concat_heads__compressed_kv_cla__mha_block_cached__decode_kernel,@function
concat_heads__compressed_kv_cla__mha_block_cached__decode_kernel:
    s_cmp_ge_u32 s2, 256
    s_cbranch_scc1 L_end
    s_load_dwordx16 s[4:19], s[0:1], 0
    s_load_dwordx8 s[20:27], s[0:1], 64
    s_load_dwordx4 s[28:31], s[0:1], 96
    v_lshrrev_b32 v4, 6, v0
    v_and_b32 v1, 63, v0
    v_readfirstlane_b32 s34, v4
    s_lshr_b32 s32, s2, 3
    s_sub_u32 s33, s2, s32
    s_sub_u32 s33, s33, 1
    s_and_b32 s33, s33, 7
    v_lshrrev_b32 v2, 4, v1
    v_and_b32 v3, 15, v1
    s_cmp_lt_u32 s33, 2
    s_cbranch_scc1 L_qp
    s_cmp_eq_u32 s33, 2
    s_cbranch_scc1 L_ql
    s_cmp_eq_u32 s33, 7
    s_cbranch_scc1 L_aux
    v_lshrrev_b32 v4, 2, v3
    v_and_b32 v5, 3, v3
    v_lshlrev_b32 v76, 8, v4
    v_lshlrev_b32 v126, 8, v2
    v_lshl_add_u32 v76, v2, 6, v76
    v_lshl_add_u32 v76, v5, 4, v76
    v_lshl_add_u32 v126, v3, 4, v126
    v_xor_b32 v77, 32768, v76
    v_xor_b32 v127, 32768, v126
    s_add_u32 s3, s34, s33
    s_and_b32 s3, s3, 3
    s_lshl_b32 s89, s3, 5
    s_add_u32 s89, s89, s32
    s_lshl_b32 s89, s89, 20
    s_mul_i32 s88, s32, 8
    s_add_u32 s88, s88, s3
    s_add_u32 s87, s33, 0
    s_mov_b32 s54, 134217728
    s_mov_b32 s55, 0x20000
    s_mov_b32 s58, 134217728
    s_mov_b32 s59, 0x20000
    s_add_u32 s39, s87, s88
    s_bfe_u32 s37, s39, 0x30000
    s_lshl_b32 s37, s37, 12
    s_add_u32 s85, s37, s89
    s_bfe_u32 s37, s39, 0x10003
    s_lshl_b32 s37, s37, 11
    s_add_u32 s85, s37, s85
    s_bfe_u32 s37, s39, 0x40004
    s_lshl_b32 s37, s37, 16
    s_add_u32 s85, s37, s85
    s_waitcnt lgkmcnt(0)
    s_mov_b64 s[52:53], s[18:19]
    s_mov_b64 s[56:57], s[20:21]
    s_and_b32 s36, s32, 24
    s_and_b32 s38, s2, 7
    s_add_u32 s36, s36, s38
    s_lshl_b32 s36, s36, 2
    s_add_u32 s36, s36, s33
    s_sub_u32 s36, s36, 3
    v_and_b32 v4, 31, v1
    v_lshlrev_b32 v4, 7, v4
    v_lshrrev_b32 v5, 5, v1
    v_lshl_add_u32 v4, v5, 15, v4
    v_lshlrev_b32 v5, 7, v1
    s_mov_b32 s40, s6
    s_and_b32 s41, s7, 0xffff
    s_mov_b32 s42, 16777216
    s_mov_b32 s43, 0x20000
    s_lshl_b32 s38, s36, 17
    s_lshl_b32 s39, s34, 12
    s_add_u32 s38, s38, s39
    buffer_load_dword v20, v4, s[40:43], s38 offen
    s_add_u32 s38, s38, 16384
    buffer_load_dword v21, v4, s[40:43], s38 offen
    s_add_u32 s38, s38, 49152
    buffer_load_dword v22, v4, s[40:43], s38 offen
    s_add_u32 s38, s38, 16384
    buffer_load_dword v23, v4, s[40:43], s38 offen
    buffer_load_dwordx4 v[128:131], v76, s[52:55], s85 offen offset:0 nt
    buffer_load_dwordx4 v[132:135], v77, s[52:55], s85 offen offset:0 nt
    buffer_load_dwordx4 v[136:139], v76, s[52:55], s85 offen offset:1024 nt
    buffer_load_dwordx4 v[140:143], v77, s[52:55], s85 offen offset:1024 nt
    s_add_u32 s87, s87, 7
    s_add_u32 s39, s87, s88
    s_bfe_u32 s37, s39, 0x30000
    s_lshl_b32 s37, s37, 12
    s_add_u32 s85, s37, s89
    s_bfe_u32 s37, s39, 0x10003
    s_lshl_b32 s37, s37, 11
    s_add_u32 s85, s37, s85
    s_bfe_u32 s37, s39, 0x40004
    s_lshl_b32 s37, s37, 16
    s_add_u32 s85, s37, s85
    buffer_load_dwordx4 v[144:147], v76, s[52:55], s85 offen offset:0 nt
    buffer_load_dwordx4 v[148:151], v77, s[52:55], s85 offen offset:0 nt
    buffer_load_dwordx4 v[152:155], v76, s[52:55], s85 offen offset:1024 nt
    s_load_dword s35, s[30:31], 0
    s_mov_b32 s48, s30
    s_and_b32 s49, s31, 0xffff
    s_mov_b32 s50, 16777216
    s_mov_b32 s51, 0x20000
    s_mov_b32 s82, 0xffffff00
    s_mov_b32 s83, 0x3e0293ee
    s_mov_b32 s84, 2097152
    s_waitcnt vmcnt(6)
    buffer_load_dwordx4 v[156:159], v77, s[52:55], s85 offen offset:1024 nt
    s_add_u32 s87, s87, 7
    s_add_u32 s39, s87, s88
    s_bfe_u32 s37, s39, 0x30000
    s_lshl_b32 s37, s37, 12
    s_add_u32 s85, s37, s89
    s_bfe_u32 s37, s39, 0x10003
    s_lshl_b32 s37, s37, 11
    s_add_u32 s85, s37, s85
    s_bfe_u32 s37, s39, 0x40004
    s_lshl_b32 s37, s37, 16
    s_add_u32 s85, s37, s85
    s_waitcnt vmcnt(6)
    buffer_load_dwordx4 v[160:163], v76, s[52:55], s85 offen offset:0 nt
    s_waitcnt vmcnt(6)
    buffer_load_dwordx4 v[164:167], v77, s[52:55], s85 offen offset:0 nt
    s_waitcnt vmcnt(6)
    buffer_load_dwordx4 v[168:171], v76, s[52:55], s85 offen offset:1024 nt
    v_and_b32 v4, 1, v1
    v_lshlrev_b32 v4, 4, v4
    v_mov_b32 v5, 0xffff
    v_lshlrev_b32 v4, v4, v5
    v_bfe_u32 v5, v1, 1, 2
    v_cmp_eq_u32 vcc, 0, v5
    s_nop 1
    v_cndmask_b32 v10, 0, v4, vcc
    v_cmp_eq_u32 vcc, 1, v5
    s_nop 1
    v_cndmask_b32 v11, 0, v4, vcc
    v_cmp_eq_u32 vcc, 2, v5
    s_nop 1
    v_cndmask_b32 v12, 0, v4, vcc
    v_cmp_eq_u32 vcc, 3, v5
    s_nop 1
    v_cndmask_b32 v13, 0, v4, vcc
    s_waitcnt vmcnt(6)
    buffer_load_dwordx4 v[172:175], v77, s[52:55], s85 offen offset:1024 nt
    s_add_u32 s87, s87, 7
    s_add_u32 s39, s87, s88
    s_bfe_u32 s37, s39, 0x30000
    s_lshl_b32 s37, s37, 12
    s_add_u32 s85, s37, s89
    s_bfe_u32 s37, s39, 0x10003
    s_lshl_b32 s37, s37, 11
    s_add_u32 s85, s37, s85
    s_bfe_u32 s37, s39, 0x40004
    s_lshl_b32 s37, s37, 16
    s_add_u32 s85, s37, s85
    s_waitcnt vmcnt(6)
    buffer_load_dwordx4 v[176:179], v76, s[52:55], s85 offen offset:0 nt
    s_waitcnt vmcnt(6)
    buffer_load_dwordx4 v[180:183], v77, s[52:55], s85 offen offset:0 nt
    s_waitcnt vmcnt(6)
    buffer_load_dwordx4 v[184:187], v76, s[52:55], s85 offen offset:1024 nt
    v_mov_b32 v120, 0xff7f0000
    v_mov_b32 v121, 0
    v_mov_b32 v18, 1
    v_mov_b32 v116, 0
    v_mov_b32 v117, 0
    v_mov_b32 v118, 0
    v_mov_b32 v119, 0
    s_lshr_b32 s38, s32, 1
    s_lshl_b32 s38, s38, 17
    s_add_u32 s96, s38, 2195456
    s_bfe_u32 s38, s32, 0x10000
    s_lshl_b32 s38, s38, 13
    s_add_u32 s96, s38, s96
    s_lshl_b32 s38, s3, 8
    s_add_u32 s96, s38, s96
    v_mov_b32 v9, s96
    s_lshr_b32 s38, s32, 1
    s_lshl_b32 s38, s38, 17
    s_add_u32 s96, s38, 2097152
    s_bfe_u32 s38, s32, 0x10000
    s_lshl_b32 s38, s38, 15
    s_add_u32 s96, s38, s96
    s_lshl_b32 s38, s3, 13
    s_add_u32 s96, s38, s96
    s_lshl_b32 s38, s33, 10
    s_add_u32 s96, s38, s96
    v_and_b32 v5, 3, v3
    v_lshlrev_b32 v78, 7, v2
    v_lshl_add_u32 v78, v5, 5, v78
    s_lshr_b32 s38, s32, 1
    s_lshl_b32 s38, s38, 17
    s_add_u32 s91, s38, 2162688
    s_bfe_u32 s38, s32, 0x10000
    s_lshl_b32 s38, s38, 13
    s_add_u32 s91, s38, s91
    s_lshl_b32 s38, s3, 9
    s_add_u32 s91, s38, s91
    v_lshlrev_b32 v4, 7, v2
    v_lshl_add_u32 v4, v3, 4, v4
    v_mov_b32 v5, 512
    v_cmp_gt_u32 vcc, 8, v3
    s_nop 1
    v_cndmask_b32 v79, v5, v4, vcc
    s_waitcnt vmcnt(6)
    buffer_load_dwordx4 v[188:191], v77, s[52:55], s85 offen offset:1024 nt
    s_add_u32 s87, s87, 7
    s_add_u32 s39, s87, s88
    s_bfe_u32 s37, s39, 0x30000
    s_lshl_b32 s37, s37, 12
    s_add_u32 s85, s37, s89
    s_bfe_u32 s37, s39, 0x10003
    s_lshl_b32 s37, s37, 11
    s_add_u32 s85, s37, s85
    s_bfe_u32 s37, s39, 0x40004
    s_lshl_b32 s37, s37, 16
    s_add_u32 s85, s37, s85
    s_waitcnt vmcnt(6)
    buffer_load_dwordx4 v[192:195], v76, s[52:55], s85 offen offset:0 nt
    s_waitcnt vmcnt(6)
    buffer_load_dwordx4 v[196:199], v77, s[52:55], s85 offen offset:0 nt
    s_waitcnt vmcnt(6)
    buffer_load_dwordx4 v[200:203], v76, s[52:55], s85 offen offset:1024 nt
    s_waitcnt vmcnt(6)
    buffer_load_dwordx4 v[204:207], v77, s[52:55], s85 offen offset:1024 nt
    s_add_u32 s87, s87, 7
    s_add_u32 s39, s87, s88
    s_bfe_u32 s37, s39, 0x30000
    s_lshl_b32 s37, s37, 12
    s_add_u32 s85, s37, s89
    s_bfe_u32 s37, s39, 0x10003
    s_lshl_b32 s37, s37, 11
    s_add_u32 s85, s37, s85
    s_bfe_u32 s37, s39, 0x40004
    s_lshl_b32 s37, s37, 16
    s_add_u32 s85, s37, s85
    s_waitcnt vmcnt(6)
    buffer_load_dwordx4 v[208:211], v76, s[52:55], s85 offen offset:0 nt
    s_waitcnt vmcnt(6)
    buffer_load_dwordx4 v[212:215], v77, s[52:55], s85 offen offset:0 nt
    s_waitcnt vmcnt(6)
    buffer_load_dwordx4 v[216:219], v76, s[52:55], s85 offen offset:1024 nt
    s_waitcnt vmcnt(6)
    buffer_load_dwordx4 v[220:223], v77, s[52:55], s85 offen offset:1024 nt
    s_add_u32 s87, s87, 7
    s_add_u32 s39, s87, s88
    s_bfe_u32 s37, s39, 0x30000
    s_lshl_b32 s37, s37, 12
    s_add_u32 s85, s37, s89
    s_bfe_u32 s37, s39, 0x10003
    s_lshl_b32 s37, s37, 11
    s_add_u32 s85, s37, s85
    s_bfe_u32 s37, s39, 0x40004
    s_lshl_b32 s37, s37, 16
    s_add_u32 s85, s37, s85
    s_waitcnt vmcnt(6)
    buffer_load_dwordx4 v[224:227], v76, s[52:55], s85 offen offset:0 nt
    s_waitcnt vmcnt(6)
    buffer_load_dwordx4 v[228:231], v77, s[52:55], s85 offen offset:0 nt
    s_waitcnt vmcnt(6)
    buffer_load_dwordx4 v[232:235], v76, s[52:55], s85 offen offset:1024 nt
    s_waitcnt vmcnt(6)
    buffer_load_dwordx4 v[236:239], v77, s[52:55], s85 offen offset:1024 nt
    s_add_u32 s87, s87, 7
    s_add_u32 s39, s87, s88
    s_bfe_u32 s37, s39, 0x30000
    s_lshl_b32 s37, s37, 12
    s_add_u32 s85, s37, s89
    s_bfe_u32 s37, s39, 0x10003
    s_lshl_b32 s37, s37, 11
    s_add_u32 s85, s37, s85
    s_bfe_u32 s37, s39, 0x40004
    s_lshl_b32 s37, s37, 16
    s_add_u32 s85, s37, s85
    s_waitcnt vmcnt(6)
    buffer_load_dwordx4 v[240:243], v76, s[52:55], s85 offen offset:0 nt
    s_waitcnt vmcnt(6)
    buffer_load_dwordx4 v[244:247], v77, s[52:55], s85 offen offset:0 nt
    s_waitcnt vmcnt(6)
    buffer_load_dwordx4 v[248:251], v76, s[52:55], s85 offen offset:1024 nt
    s_waitcnt vmcnt(6)
    buffer_load_dwordx4 v[252:255], v77, s[52:55], s85 offen offset:1024 nt
    s_add_u32 s87, s87, 7
    s_add_u32 s39, s87, s88
    s_bfe_u32 s37, s39, 0x30000
    s_lshl_b32 s37, s37, 12
    s_add_u32 s85, s37, s89
    s_bfe_u32 s37, s39, 0x10003
    s_lshl_b32 s37, s37, 11
    s_add_u32 s85, s37, s85
    s_bfe_u32 s37, s39, 0x40004
    s_lshl_b32 s37, s37, 16
    s_add_u32 s85, s37, s85
    s_waitcnt vmcnt(6)
    buffer_load_dwordx4 a[0:3], v76, s[52:55], s85 offen offset:0 nt
    s_waitcnt vmcnt(6)
    buffer_load_dwordx4 a[4:7], v77, s[52:55], s85 offen offset:0 nt
    buffer_load_dwordx4 v[68:71], v78, s[48:51], s91 offen offset:0 sc1
    buffer_load_dwordx4 v[72:75], v78, s[48:51], s91 offen offset:16 sc1
    s_waitcnt vmcnt(8)
    buffer_load_dwordx4 a[8:11], v76, s[52:55], s85 offen offset:1024 nt
    s_waitcnt vmcnt(8)
    buffer_load_dwordx4 a[12:15], v77, s[52:55], s85 offen offset:1024 nt
    s_add_u32 s87, s87, 7
    s_add_u32 s39, s87, s88
    s_bfe_u32 s37, s39, 0x30000
    s_lshl_b32 s37, s37, 12
    s_add_u32 s85, s37, s89
    s_bfe_u32 s37, s39, 0x10003
    s_lshl_b32 s37, s37, 11
    s_add_u32 s85, s37, s85
    s_bfe_u32 s37, s39, 0x40004
    s_lshl_b32 s37, s37, 16
    s_add_u32 s85, s37, s85
    s_waitcnt vmcnt(8)
    buffer_load_dwordx4 a[16:19], v76, s[52:55], s85 offen offset:0 nt
    s_waitcnt vmcnt(8)
    buffer_load_dwordx4 a[20:23], v77, s[52:55], s85 offen offset:0 nt
    s_waitcnt vmcnt(8)
    buffer_load_dwordx4 a[24:27], v76, s[52:55], s85 offen offset:1024 nt
    s_waitcnt vmcnt(8)
    buffer_load_dwordx4 a[28:31], v77, s[52:55], s85 offen offset:1024 nt
    s_add_u32 s87, s87, 7
    s_add_u32 s39, s87, s88
    s_bfe_u32 s37, s39, 0x30000
    s_lshl_b32 s37, s37, 12
    s_add_u32 s85, s37, s89
    s_bfe_u32 s37, s39, 0x10003
    s_lshl_b32 s37, s37, 11
    s_add_u32 s85, s37, s85
    s_bfe_u32 s37, s39, 0x40004
    s_lshl_b32 s37, s37, 16
    s_add_u32 s85, s37, s85
    s_waitcnt lgkmcnt(0)
    s_add_u32 s35, s35, 0x5b
    s_and_b32 s35, s35, 0xff
    v_mov_b32 v8, s35
    s_waitcnt vmcnt(6)
L_qcheck_1:
    v_xor_b32 v68, s35, v68
    v_xor_b32 v69, s35, v69
    v_xor_b32 v70, s35, v70
    v_xor_b32 v71, s35, v71
    v_xor_b32 v72, s35, v72
    v_xor_b32 v73, s35, v73
    v_xor_b32 v74, s35, v74
    v_xor_b32 v75, s35, v75
    v_or_b32 v4, v68, v69
    v_or3_b32 v4, v4, v70, v71
    v_or3_b32 v4, v4, v72, v73
    v_or3_b32 v4, v4, v74, v75
    v_and_b32 v4, 0xff, v4
    v_cmp_ne_u32 vcc, 0, v4
    s_cbranch_vccz L_qok_2
    buffer_load_dwordx4 v[68:71], v78, s[48:51], s91 offen offset:0 sc1
    buffer_load_dwordx4 v[72:75], v78, s[48:51], s91 offen offset:16 sc1
    s_waitcnt vmcnt(0)
    s_sub_u32 s84, s84, 1
    s_cmp_lg_u32 s84, 0
    s_cbranch_scc1 L_qcheck_1
    s_branch L_end
L_qok_2:
    v_cvt_pk_bf16_f32 v68, v68, v69
    v_cvt_pk_bf16_f32 v69, v70, v71
    v_cvt_pk_bf16_f32 v70, v72, v73
    v_cvt_pk_bf16_f32 v71, v74, v75
    s_mov_b32 vcc_lo, 0xf000f
    s_mov_b32 vcc_hi, 0xf000f
    v_cndmask_b32 v80, 0, v68, vcc
    v_cndmask_b32 v81, 0, v69, vcc
    v_cndmask_b32 v82, 0, v70, vcc
    v_cndmask_b32 v83, 0, v71, vcc
    s_mov_b32 vcc_lo, 0xf000f0
    s_mov_b32 vcc_hi, 0xf000f0
    v_cndmask_b32 v84, 0, v68, vcc
    v_cndmask_b32 v85, 0, v69, vcc
    v_cndmask_b32 v86, 0, v70, vcc
    v_cndmask_b32 v87, 0, v71, vcc
    s_mov_b32 vcc_lo, 0xf000f00
    s_mov_b32 vcc_hi, 0xf000f00
    v_cndmask_b32 v88, 0, v68, vcc
    v_cndmask_b32 v89, 0, v69, vcc
    v_cndmask_b32 v90, 0, v70, vcc
    v_cndmask_b32 v91, 0, v71, vcc
    s_mov_b32 vcc_lo, 0xf000f000
    s_mov_b32 vcc_hi, 0xf000f000
    v_cndmask_b32 v92, 0, v68, vcc
    v_cndmask_b32 v93, 0, v69, vcc
    v_cndmask_b32 v94, 0, v70, vcc
    v_cndmask_b32 v95, 0, v71, vcc
    v_mov_b32 v65, 0xff7f0000
    s_lshl_b32 s38, s34, 14
    s_add_u32 s38, s38, 16384
    v_lshl_add_u32 v64, v1, 2, s38
    buffer_load_dwordx4 a[32:35], v76, s[52:55], s85 offen offset:0 nt
    v_mfma_f32_16x16x32_bf16 v[112:115], v[128:131], v[80:83], 0
    v_mfma_f32_16x16x32_bf16 v[112:115], v[132:135], v[84:87], v[112:115]
    v_mfma_f32_16x16x32_bf16 v[112:115], v[136:139], v[88:91], v[112:115]
    s_waitcnt vmcnt(6)
    buffer_load_dwordx4 a[36:39], v77, s[52:55], s85 offen offset:0 nt
    v_mfma_f32_16x16x32_bf16 v[112:115], v[140:143], v[92:95], v[112:115]
    v_mfma_f32_16x16x32_bf16 v[96:99], v[144:147], v[80:83], 0
    v_mfma_f32_16x16x32_bf16 v[96:99], v[148:151], v[84:87], v[96:99]
    s_waitcnt vmcnt(6)
    buffer_load_dwordx4 a[40:43], v76, s[52:55], s85 offen offset:1024 nt
    v_mfma_f32_16x16x32_bf16 v[96:99], v[152:155], v[88:91], v[96:99]
    s_nop 2
    v_mov_b32_dpp v122, v112 quad_perm:[0,0,0,0] row_mask:0xf bank_mask:0xf
    v_mov_b32_dpp v124, v114 quad_perm:[2,2,2,2] row_mask:0xf bank_mask:0xf
    s_nop 0
    v_add_f32_dpp v122, v113, v122 quad_perm:[1,1,1,1] row_mask:0xf bank_mask:0xf
    v_add_f32_dpp v124, v115, v124 quad_perm:[3,3,3,3] row_mask:0xf bank_mask:0xf
    v_add_f32 v122, v122, v124
    v_max_f32 v65, v65, v122
    ds_write_b32 v64, v122 offset:0
    v_mfma_f32_16x16x32_bf16 v[96:99], v[156:159], v[92:95], v[96:99]
    v_mfma_f32_16x16x32_bf16 v[112:115], v[160:163], v[80:83], 0
    v_mfma_f32_16x16x32_bf16 v[112:115], v[164:167], v[84:87], v[112:115]
    s_waitcnt vmcnt(6)
    buffer_load_dwordx4 a[44:47], v77, s[52:55], s85 offen offset:1024 nt
    s_add_u32 s87, s87, 7
    s_add_u32 s39, s87, s88
    s_bfe_u32 s37, s39, 0x30000
    s_lshl_b32 s37, s37, 12
    s_add_u32 s85, s37, s89
    s_bfe_u32 s37, s39, 0x10003
    s_lshl_b32 s37, s37, 11
    s_add_u32 s85, s37, s85
    s_bfe_u32 s37, s39, 0x40004
    s_lshl_b32 s37, s37, 16
    s_add_u32 s85, s37, s85
    v_mfma_f32_16x16x32_bf16 v[112:115], v[168:171], v[88:91], v[112:115]
    v_mov_b32_dpp v122, v96 quad_perm:[0,0,0,0] row_mask:0xf bank_mask:0xf
    v_mov_b32_dpp v124, v98 quad_perm:[2,2,2,2] row_mask:0xf bank_mask:0xf
    s_nop 0
    v_add_f32_dpp v122, v97, v122 quad_perm:[1,1,1,1] row_mask:0xf bank_mask:0xf
    v_add_f32_dpp v124, v99, v124 quad_perm:[3,3,3,3] row_mask:0xf bank_mask:0xf
    v_add_f32 v122, v122, v124
    v_max_f32 v65, v65, v122
    ds_write_b32 v64, v122 offset:256
    v_mfma_f32_16x16x32_bf16 v[112:115], v[172:175], v[92:95], v[112:115]
    v_mfma_f32_16x16x32_bf16 v[96:99], v[176:179], v[80:83], 0
    s_waitcnt vmcnt(6)
    buffer_load_dwordx4 a[48:51], v76, s[52:55], s85 offen offset:0 nt
    v_mfma_f32_16x16x32_bf16 v[96:99], v[180:183], v[84:87], v[96:99]
    v_mfma_f32_16x16x32_bf16 v[96:99], v[184:187], v[88:91], v[96:99]
    s_nop 2
    v_mov_b32_dpp v122, v112 quad_perm:[0,0,0,0] row_mask:0xf bank_mask:0xf
    v_mov_b32_dpp v124, v114 quad_perm:[2,2,2,2] row_mask:0xf bank_mask:0xf
    s_nop 0
    v_add_f32_dpp v122, v113, v122 quad_perm:[1,1,1,1] row_mask:0xf bank_mask:0xf
    v_add_f32_dpp v124, v115, v124 quad_perm:[3,3,3,3] row_mask:0xf bank_mask:0xf
    v_add_f32 v122, v122, v124
    v_max_f32 v65, v65, v122
    ds_write_b32 v64, v122 offset:512
    v_mfma_f32_16x16x32_bf16 v[96:99], v[188:191], v[92:95], v[96:99]
    v_mfma_f32_16x16x32_bf16 v[112:115], v[192:195], v[80:83], 0
    s_waitcnt vmcnt(6)
    buffer_load_dwordx4 a[52:55], v77, s[52:55], s85 offen offset:0 nt
    v_mfma_f32_16x16x32_bf16 v[112:115], v[196:199], v[84:87], v[112:115]
    v_mfma_f32_16x16x32_bf16 v[112:115], v[200:203], v[88:91], v[112:115]
    s_nop 2
    v_mov_b32_dpp v122, v96 quad_perm:[0,0,0,0] row_mask:0xf bank_mask:0xf
    v_mov_b32_dpp v124, v98 quad_perm:[2,2,2,2] row_mask:0xf bank_mask:0xf
    s_nop 0
    v_add_f32_dpp v122, v97, v122 quad_perm:[1,1,1,1] row_mask:0xf bank_mask:0xf
    v_add_f32_dpp v124, v99, v124 quad_perm:[3,3,3,3] row_mask:0xf bank_mask:0xf
    v_add_f32 v122, v122, v124
    v_max_f32 v65, v65, v122
    ds_write_b32 v64, v122 offset:768
    v_mfma_f32_16x16x32_bf16 v[112:115], v[204:207], v[92:95], v[112:115]
    s_waitcnt vmcnt(6)
    buffer_load_dwordx4 a[56:59], v76, s[52:55], s85 offen offset:1024 nt
    v_mfma_f32_16x16x32_bf16 v[96:99], v[208:211], v[80:83], 0
    v_mfma_f32_16x16x32_bf16 v[96:99], v[212:215], v[84:87], v[96:99]
    v_mfma_f32_16x16x32_bf16 v[96:99], v[216:219], v[88:91], v[96:99]
    s_nop 2
    v_mov_b32_dpp v122, v112 quad_perm:[0,0,0,0] row_mask:0xf bank_mask:0xf
    v_mov_b32_dpp v124, v114 quad_perm:[2,2,2,2] row_mask:0xf bank_mask:0xf
    s_nop 0
    v_add_f32_dpp v122, v113, v122 quad_perm:[1,1,1,1] row_mask:0xf bank_mask:0xf
    v_add_f32_dpp v124, v115, v124 quad_perm:[3,3,3,3] row_mask:0xf bank_mask:0xf
    v_add_f32 v122, v122, v124
    v_max_f32 v65, v65, v122
    ds_write_b32 v64, v122 offset:1024
    v_mfma_f32_16x16x32_bf16 v[96:99], v[220:223], v[92:95], v[96:99]
    s_waitcnt vmcnt(6)
    buffer_load_dwordx4 a[60:63], v77, s[52:55], s85 offen offset:1024 nt
    s_add_u32 s87, s87, 7
    s_add_u32 s39, s87, s88
    s_bfe_u32 s37, s39, 0x30000
    s_lshl_b32 s37, s37, 12
    s_add_u32 s85, s37, s89
    s_bfe_u32 s37, s39, 0x10003
    s_lshl_b32 s37, s37, 11
    s_add_u32 s85, s37, s85
    s_bfe_u32 s37, s39, 0x40004
    s_lshl_b32 s37, s37, 16
    s_add_u32 s85, s37, s85
    v_mfma_f32_16x16x32_bf16 v[112:115], v[224:227], v[80:83], 0
    v_mfma_f32_16x16x32_bf16 v[112:115], v[228:231], v[84:87], v[112:115]
    v_mfma_f32_16x16x32_bf16 v[112:115], v[232:235], v[88:91], v[112:115]
    v_mov_b32_dpp v122, v96 quad_perm:[0,0,0,0] row_mask:0xf bank_mask:0xf
    v_mov_b32_dpp v124, v98 quad_perm:[2,2,2,2] row_mask:0xf bank_mask:0xf
    s_nop 0
    v_add_f32_dpp v122, v97, v122 quad_perm:[1,1,1,1] row_mask:0xf bank_mask:0xf
    v_add_f32_dpp v124, v99, v124 quad_perm:[3,3,3,3] row_mask:0xf bank_mask:0xf
    v_add_f32 v122, v122, v124
    v_max_f32 v65, v65, v122
    ds_write_b32 v64, v122 offset:1280
    s_waitcnt vmcnt(5)
    buffer_load_dwordx4 v[128:131], v76, s[52:55], s85 offen offset:0 nt
    v_mfma_f32_16x16x32_bf16 v[112:115], v[236:239], v[92:95], v[112:115]
    v_mfma_f32_16x16x32_bf16 v[96:99], v[240:243], v[80:83], 0
    v_mfma_f32_16x16x32_bf16 v[96:99], v[244:247], v[84:87], v[96:99]
    s_waitcnt vmcnt(5)
    buffer_load_dwordx4 v[132:135], v77, s[52:55], s85 offen offset:0 nt
    v_mfma_f32_16x16x32_bf16 v[96:99], v[248:251], v[88:91], v[96:99]
    s_nop 2
    v_mov_b32_dpp v122, v112 quad_perm:[0,0,0,0] row_mask:0xf bank_mask:0xf
    v_mov_b32_dpp v124, v114 quad_perm:[2,2,2,2] row_mask:0xf bank_mask:0xf
    s_nop 0
    v_add_f32_dpp v122, v113, v122 quad_perm:[1,1,1,1] row_mask:0xf bank_mask:0xf
    v_add_f32_dpp v124, v115, v124 quad_perm:[3,3,3,3] row_mask:0xf bank_mask:0xf
    v_add_f32 v122, v122, v124
    v_max_f32 v65, v65, v122
    ds_write_b32 v64, v122 offset:1536
    v_mfma_f32_16x16x32_bf16 v[96:99], v[252:255], v[92:95], v[96:99]
    v_mfma_f32_16x16x32_bf16 v[112:115], a[0:3], v[80:83], 0
    v_mfma_f32_16x16x32_bf16 v[112:115], a[4:7], v[84:87], v[112:115]
    s_waitcnt vmcnt(5)
    buffer_load_dwordx4 v[136:139], v76, s[52:55], s85 offen offset:1024 nt
    v_mfma_f32_16x16x32_bf16 v[112:115], a[8:11], v[88:91], v[112:115]
    s_nop 2
    v_mov_b32_dpp v122, v96 quad_perm:[0,0,0,0] row_mask:0xf bank_mask:0xf
    v_mov_b32_dpp v124, v98 quad_perm:[2,2,2,2] row_mask:0xf bank_mask:0xf
    s_nop 0
    v_add_f32_dpp v122, v97, v122 quad_perm:[1,1,1,1] row_mask:0xf bank_mask:0xf
    v_add_f32_dpp v124, v99, v124 quad_perm:[3,3,3,3] row_mask:0xf bank_mask:0xf
    v_add_f32 v122, v122, v124
    v_max_f32 v65, v65, v122
    ds_write_b32 v64, v122 offset:1792
    v_mfma_f32_16x16x32_bf16 v[112:115], a[12:15], v[92:95], v[112:115]
    v_mfma_f32_16x16x32_bf16 v[96:99], a[16:19], v[80:83], 0
    s_waitcnt vmcnt(5)
    buffer_load_dwordx4 v[140:143], v77, s[52:55], s85 offen offset:1024 nt
    s_add_u32 s87, s87, 7
    s_add_u32 s39, s87, s88
    s_bfe_u32 s37, s39, 0x30000
    s_lshl_b32 s37, s37, 12
    s_add_u32 s85, s37, s89
    s_bfe_u32 s37, s39, 0x10003
    s_lshl_b32 s37, s37, 11
    s_add_u32 s85, s37, s85
    s_bfe_u32 s37, s39, 0x40004
    s_lshl_b32 s37, s37, 16
    s_add_u32 s85, s37, s85
    v_mfma_f32_16x16x32_bf16 v[96:99], a[20:23], v[84:87], v[96:99]
    v_mfma_f32_16x16x32_bf16 v[96:99], a[24:27], v[88:91], v[96:99]
    v_mov_b32_dpp v122, v112 quad_perm:[0,0,0,0] row_mask:0xf bank_mask:0xf
    v_mov_b32_dpp v124, v114 quad_perm:[2,2,2,2] row_mask:0xf bank_mask:0xf
    s_nop 0
    v_add_f32_dpp v122, v113, v122 quad_perm:[1,1,1,1] row_mask:0xf bank_mask:0xf
    v_add_f32_dpp v124, v115, v124 quad_perm:[3,3,3,3] row_mask:0xf bank_mask:0xf
    v_add_f32 v122, v122, v124
    v_max_f32 v65, v65, v122
    ds_write_b32 v64, v122 offset:2048
    v_mfma_f32_16x16x32_bf16 v[96:99], a[28:31], v[92:95], v[96:99]
    v_mfma_f32_16x16x32_bf16 v[112:115], a[32:35], v[80:83], 0
    s_waitcnt vmcnt(5)
    buffer_load_dwordx4 v[144:147], v76, s[52:55], s85 offen offset:0 nt
    v_mfma_f32_16x16x32_bf16 v[112:115], a[36:39], v[84:87], v[112:115]
    v_mfma_f32_16x16x32_bf16 v[112:115], a[40:43], v[88:91], v[112:115]
    s_nop 2
    v_mov_b32_dpp v122, v96 quad_perm:[0,0,0,0] row_mask:0xf bank_mask:0xf
    v_mov_b32_dpp v124, v98 quad_perm:[2,2,2,2] row_mask:0xf bank_mask:0xf
    s_nop 0
    v_add_f32_dpp v122, v97, v122 quad_perm:[1,1,1,1] row_mask:0xf bank_mask:0xf
    v_add_f32_dpp v124, v99, v124 quad_perm:[3,3,3,3] row_mask:0xf bank_mask:0xf
    v_add_f32 v122, v122, v124
    v_max_f32 v65, v65, v122
    ds_write_b32 v64, v122 offset:2304
    v_mfma_f32_16x16x32_bf16 v[112:115], a[44:47], v[92:95], v[112:115]
    s_waitcnt vmcnt(5)
    buffer_load_dwordx4 v[148:151], v77, s[52:55], s85 offen offset:0 nt
    v_mfma_f32_16x16x32_bf16 v[96:99], a[48:51], v[80:83], 0
    v_mfma_f32_16x16x32_bf16 v[96:99], a[52:55], v[84:87], v[96:99]
    v_mfma_f32_16x16x32_bf16 v[96:99], a[56:59], v[88:91], v[96:99]
    s_nop 2
    v_mov_b32_dpp v122, v112 quad_perm:[0,0,0,0] row_mask:0xf bank_mask:0xf
    v_mov_b32_dpp v124, v114 quad_perm:[2,2,2,2] row_mask:0xf bank_mask:0xf
    s_nop 0
    v_add_f32_dpp v122, v113, v122 quad_perm:[1,1,1,1] row_mask:0xf bank_mask:0xf
    v_add_f32_dpp v124, v115, v124 quad_perm:[3,3,3,3] row_mask:0xf bank_mask:0xf
    v_add_f32 v122, v122, v124
    v_max_f32 v65, v65, v122
    ds_write_b32 v64, v122 offset:2560
    v_mfma_f32_16x16x32_bf16 v[96:99], a[60:63], v[92:95], v[96:99]
    v_add_u32 v64, 2816, v64
    s_mov_b32 s97, 10
    s_mov_b32 s86, 32
    s_add_u32 s92, s33, 224
    s_mov_b32 s66, 134217728
    s_mov_b32 s67, 0x20000
    s_mov_b64 s[64:65], s[52:53]
    v_mov_b32 v62, v76
    v_mov_b32 v63, v77
L_bloop:
    s_waitcnt vmcnt(5)
    buffer_load_dwordx4 v[152:155], v62, s[64:67], s85 offen offset:1024 nt
    v_mfma_f32_16x16x32_bf16 v[112:115], v[128:131], v[80:83], 0
    s_waitcnt vmcnt(5)
    buffer_load_dwordx4 v[156:159], v63, s[64:67], s85 offen offset:1024 nt
    v_mfma_f32_16x16x32_bf16 v[112:115], v[132:135], v[84:87], v[112:115]
    s_add_u32 s87, s87, 7
    s_cmp_lg_u32 s87, s92
    s_cbranch_scc1 L_stayk_3
    s_mov_b64 s[64:65], s[56:57]
    v_mov_b32 v62, v126
    v_mov_b32 v63, v127
    s_mul_i32 s37, s86, 7
    s_sub_u32 s87, s87, s37
L_stayk_3:
    s_add_u32 s39, s87, s88
    s_bfe_u32 s37, s39, 0x30000
    s_lshl_b32 s37, s37, 12
    s_add_u32 s85, s37, s89
    s_bfe_u32 s37, s39, 0x10003
    s_lshl_b32 s37, s37, 11
    s_add_u32 s85, s37, s85
    s_bfe_u32 s37, s39, 0x40004
    s_lshl_b32 s37, s37, 16
    s_add_u32 s85, s37, s85
    v_mov_b32_dpp v122, v96 quad_perm:[0,0,0,0] row_mask:0xf bank_mask:0xf
    v_mov_b32_dpp v124, v98 quad_perm:[2,2,2,2] row_mask:0xf bank_mask:0xf
    s_nop 0
    v_add_f32_dpp v122, v97, v122 quad_perm:[1,1,1,1] row_mask:0xf bank_mask:0xf
    v_add_f32_dpp v124, v99, v124 quad_perm:[3,3,3,3] row_mask:0xf bank_mask:0xf
    v_add_f32 v122, v122, v124
    v_max_f32 v65, v65, v122
    ds_write_b32 v64, v122 offset:0
    s_waitcnt vmcnt(5)
    buffer_load_dwordx4 v[128:131], v62, s[64:67], s85 offen offset:0 nt
    v_mfma_f32_16x16x32_bf16 v[112:115], v[136:139], v[88:91], v[112:115]
    s_waitcnt vmcnt(5)
    buffer_load_dwordx4 v[132:135], v63, s[64:67], s85 offen offset:0 nt
    v_mfma_f32_16x16x32_bf16 v[112:115], v[140:143], v[92:95], v[112:115]
    s_waitcnt vmcnt(5)
    buffer_load_dwordx4 v[136:139], v62, s[64:67], s85 offen offset:1024 nt
    v_mfma_f32_16x16x32_bf16 v[96:99], v[144:147], v[80:83], 0
    s_waitcnt vmcnt(5)
    buffer_load_dwordx4 v[140:143], v63, s[64:67], s85 offen offset:1024 nt
    v_mfma_f32_16x16x32_bf16 v[96:99], v[148:151], v[84:87], v[96:99]
    s_add_u32 s87, s87, 7
    s_add_u32 s39, s87, s88
    s_bfe_u32 s37, s39, 0x30000
    s_lshl_b32 s37, s37, 12
    s_add_u32 s85, s37, s89
    s_bfe_u32 s37, s39, 0x10003
    s_lshl_b32 s37, s37, 11
    s_add_u32 s85, s37, s85
    s_bfe_u32 s37, s39, 0x40004
    s_lshl_b32 s37, s37, 16
    s_add_u32 s85, s37, s85
    v_mov_b32_dpp v122, v112 quad_perm:[0,0,0,0] row_mask:0xf bank_mask:0xf
    v_mov_b32_dpp v124, v114 quad_perm:[2,2,2,2] row_mask:0xf bank_mask:0xf
    s_nop 0
    v_add_f32_dpp v122, v113, v122 quad_perm:[1,1,1,1] row_mask:0xf bank_mask:0xf
    v_add_f32_dpp v124, v115, v124 quad_perm:[3,3,3,3] row_mask:0xf bank_mask:0xf
    v_add_f32 v122, v122, v124
    v_max_f32 v65, v65, v122
    ds_write_b32 v64, v122 offset:256
    s_waitcnt vmcnt(5)
    buffer_load_dwordx4 v[144:147], v62, s[64:67], s85 offen offset:0 nt
    v_mfma_f32_16x16x32_bf16 v[96:99], v[152:155], v[88:91], v[96:99]
    s_waitcnt vmcnt(5)
    buffer_load_dwordx4 v[148:151], v63, s[64:67], s85 offen offset:0 nt
    v_mfma_f32_16x16x32_bf16 v[96:99], v[156:159], v[92:95], v[96:99]
    v_add_u32 v64, 512, v64
    s_sub_u32 s97, s97, 1
    s_cmp_lg_u32 s97, 0
    s_cbranch_scc1 L_bloop
    s_nop 3
    v_mov_b32_dpp v122, v96 quad_perm:[0,0,0,0] row_mask:0xf bank_mask:0xf
    v_mov_b32_dpp v124, v98 quad_perm:[2,2,2,2] row_mask:0xf bank_mask:0xf
    s_nop 0
    v_add_f32_dpp v122, v97, v122 quad_perm:[1,1,1,1] row_mask:0xf bank_mask:0xf
    v_add_f32_dpp v124, v99, v124 quad_perm:[3,3,3,3] row_mask:0xf bank_mask:0xf
    v_add_f32 v122, v122, v124
    v_max_f32 v65, v65, v122
    ds_write_b32 v64, v122 offset:0
    v_mov_b32 v123, 0xff7f0000
    ds_write_b32 v64, v123 offset:256
    s_lshl_b32 s38, s34, 14
    s_add_u32 s38, s38, 16384
    v_lshl_add_u32 v64, v1, 2, s38
    ds_read_b32 v66, v64
    ds_read_b32 v67, v64 offset:256
    v_mul_f32 v65, s83, v65
    s_nop 1
    v_max_f32_dpp v124, v65, v65 row_ror:4 row_mask:0xf bank_mask:0xf
    s_nop 1
    v_max_f32_dpp v124, v124, v124 row_ror:8 row_mask:0xf bank_mask:0xf
    v_mov_b32 v125, v124
    s_nop 1
    v_permlane16_swap_b32 v124, v125
    v_max_f32 v124, v124, v125
    v_mov_b32 v125, v124
    s_nop 1
    v_permlane32_swap_b32 v124, v125
    v_max_f32 v124, v124, v125
    v_and_b32 v120, s82, v124
    s_lshr_b32 s97, s86, 1
    s_waitcnt lgkmcnt(1)
    v_fma_f32 v123, v66, s83, -v120
    v_exp_f32 v123, v123
    ds_read_b32 v66, v64 offset:512
    v_cvt_pk_bf16_f32 v100, v123, v123
    v_add_f32 v121, v121, v123
L_vloop:
    s_nop 0
    v_and_b32_dpp v104, v100, v10 row_newbcast:0 row_mask:0xf bank_mask:0xf
    v_and_b32_dpp v105, v100, v11 row_newbcast:0 row_mask:0xf bank_mask:0xf
    v_and_b32_dpp v106, v100, v12 row_newbcast:0 row_mask:0xf bank_mask:0xf
    v_and_b32_dpp v107, v100, v13 row_newbcast:0 row_mask:0xf bank_mask:0xf
    s_waitcnt vmcnt(5)
    buffer_load_dwordx4 v[152:155], v62, s[64:67], s85 offen offset:1024 nt
    v_mfma_f32_16x16x32_bf16 v[116:119], v[128:131], v[104:107], v[116:119]
    v_and_b32_dpp v108, v100, v10 row_newbcast:4 row_mask:0xf bank_mask:0xf
    v_and_b32_dpp v109, v100, v11 row_newbcast:4 row_mask:0xf bank_mask:0xf
    v_and_b32_dpp v110, v100, v12 row_newbcast:4 row_mask:0xf bank_mask:0xf
    v_and_b32_dpp v111, v100, v13 row_newbcast:4 row_mask:0xf bank_mask:0xf
    s_waitcnt vmcnt(5)
    buffer_load_dwordx4 v[156:159], v63, s[64:67], s85 offen offset:1024 nt
    v_mfma_f32_16x16x32_bf16 v[116:119], v[132:135], v[108:111], v[116:119]
    s_add_u32 s87, s87, 7
    s_cmp_lg_u32 s97, 1
    s_cbranch_scc1 L_stayv_4
    s_mov_b64 s[64:65], s[52:53]
    v_mov_b32 v62, v76
    v_mov_b32 v63, v77
    s_mov_b64 exec, 1
    global_atomic_add v19, v9, v18, s[30:31] sc0 sc1
    s_mov_b64 exec, -1
    s_add_u32 s87, s33, 224
L_stayv_4:
    s_add_u32 s39, s87, s88
    s_bfe_u32 s37, s39, 0x30000
    s_lshl_b32 s37, s37, 12
    s_add_u32 s85, s37, s89
    s_bfe_u32 s37, s39, 0x10003
    s_lshl_b32 s37, s37, 11
    s_add_u32 s85, s37, s85
    s_bfe_u32 s37, s39, 0x40004
    s_lshl_b32 s37, s37, 16
    s_add_u32 s85, s37, s85
    s_waitcnt lgkmcnt(1)
    v_fma_f32 v123, v67, s83, -v120
    v_exp_f32 v123, v123
    ds_read_b32 v67, v64 offset:768
    v_cvt_pk_bf16_f32 v101, v123, v123
    v_add_f32 v121, v121, v123
    v_and_b32_dpp v104, v100, v10 row_newbcast:8 row_mask:0xf bank_mask:0xf
    v_and_b32_dpp v105, v100, v11 row_newbcast:8 row_mask:0xf bank_mask:0xf
    v_and_b32_dpp v106, v100, v12 row_newbcast:8 row_mask:0xf bank_mask:0xf
    v_and_b32_dpp v107, v100, v13 row_newbcast:8 row_mask:0xf bank_mask:0xf
    s_waitcnt vmcnt(5)
    buffer_load_dwordx4 v[128:131], v62, s[64:67], s85 offen offset:0 nt
    v_mfma_f32_16x16x32_bf16 v[116:119], v[136:139], v[104:107], v[116:119]
    v_and_b32_dpp v108, v100, v10 row_newbcast:12 row_mask:0xf bank_mask:0xf
    v_and_b32_dpp v109, v100, v11 row_newbcast:12 row_mask:0xf bank_mask:0xf
    v_and_b32_dpp v110, v100, v12 row_newbcast:12 row_mask:0xf bank_mask:0xf
    v_and_b32_dpp v111, v100, v13 row_newbcast:12 row_mask:0xf bank_mask:0xf
    s_waitcnt vmcnt(5)
    buffer_load_dwordx4 v[132:135], v63, s[64:67], s85 offen offset:0 nt
    v_mfma_f32_16x16x32_bf16 v[116:119], v[140:143], v[108:111], v[116:119]
    v_and_b32_dpp v104, v101, v10 row_newbcast:0 row_mask:0xf bank_mask:0xf
    v_and_b32_dpp v105, v101, v11 row_newbcast:0 row_mask:0xf bank_mask:0xf
    v_and_b32_dpp v106, v101, v12 row_newbcast:0 row_mask:0xf bank_mask:0xf
    v_and_b32_dpp v107, v101, v13 row_newbcast:0 row_mask:0xf bank_mask:0xf
    s_waitcnt vmcnt(5)
    buffer_load_dwordx4 v[136:139], v62, s[64:67], s85 offen offset:1024 nt
    v_mfma_f32_16x16x32_bf16 v[116:119], v[144:147], v[104:107], v[116:119]
    v_and_b32_dpp v108, v101, v10 row_newbcast:4 row_mask:0xf bank_mask:0xf
    v_and_b32_dpp v109, v101, v11 row_newbcast:4 row_mask:0xf bank_mask:0xf
    v_and_b32_dpp v110, v101, v12 row_newbcast:4 row_mask:0xf bank_mask:0xf
    v_and_b32_dpp v111, v101, v13 row_newbcast:4 row_mask:0xf bank_mask:0xf
    s_waitcnt vmcnt(5)
    buffer_load_dwordx4 v[140:143], v63, s[64:67], s85 offen offset:1024 nt
    v_mfma_f32_16x16x32_bf16 v[116:119], v[148:151], v[108:111], v[116:119]
    s_add_u32 s87, s87, 7
    s_cmp_lg_u32 s97, 1
    s_cbranch_scc1 L_stayv_5
    s_mov_b64 s[64:65], s[56:57]
    v_mov_b32 v62, v126
    v_mov_b32 v63, v127
    s_add_u32 s87, s33, 224
L_stayv_5:
    s_add_u32 s39, s87, s88
    s_bfe_u32 s37, s39, 0x30000
    s_lshl_b32 s37, s37, 12
    s_add_u32 s85, s37, s89
    s_bfe_u32 s37, s39, 0x10003
    s_lshl_b32 s37, s37, 11
    s_add_u32 s85, s37, s85
    s_bfe_u32 s37, s39, 0x40004
    s_lshl_b32 s37, s37, 16
    s_add_u32 s85, s37, s85
    v_add_u32 v64, 512, v64
    s_waitcnt lgkmcnt(1)
    v_fma_f32 v123, v66, s83, -v120
    v_exp_f32 v123, v123
    ds_read_b32 v66, v64 offset:512
    v_cvt_pk_bf16_f32 v100, v123, v123
    v_add_f32 v121, v121, v123
    v_and_b32_dpp v104, v101, v10 row_newbcast:8 row_mask:0xf bank_mask:0xf
    v_and_b32_dpp v105, v101, v11 row_newbcast:8 row_mask:0xf bank_mask:0xf
    v_and_b32_dpp v106, v101, v12 row_newbcast:8 row_mask:0xf bank_mask:0xf
    v_and_b32_dpp v107, v101, v13 row_newbcast:8 row_mask:0xf bank_mask:0xf
    s_waitcnt vmcnt(5)
    buffer_load_dwordx4 v[144:147], v62, s[64:67], s85 offen offset:0 nt
    v_mfma_f32_16x16x32_bf16 v[116:119], v[152:155], v[104:107], v[116:119]
    v_and_b32_dpp v108, v101, v10 row_newbcast:12 row_mask:0xf bank_mask:0xf
    v_and_b32_dpp v109, v101, v11 row_newbcast:12 row_mask:0xf bank_mask:0xf
    v_and_b32_dpp v110, v101, v12 row_newbcast:12 row_mask:0xf bank_mask:0xf
    v_and_b32_dpp v111, v101, v13 row_newbcast:12 row_mask:0xf bank_mask:0xf
    s_waitcnt vmcnt(5)
    buffer_load_dwordx4 v[148:151], v63, s[64:67], s85 offen offset:0 nt
    v_mfma_f32_16x16x32_bf16 v[116:119], v[156:159], v[108:111], v[116:119]
    s_sub_u32 s97, s97, 1
    s_cmp_lg_u32 s97, 0
    s_cbranch_scc1 L_vloop
    buffer_load_dwordx4 v[152:155], v126, s[56:59], s85 offen offset:1024 nt
    buffer_load_dwordx4 v[156:159], v127, s[56:59], s85 offen offset:1024 nt
L_dloop:
    s_waitcnt vmcnt(7)
    v_readfirstlane_b32 s93, v19
    s_nop 0
    s_sub_u32 s36, s93, 25
    s_and_b32 s38, s36, 3
    s_mul_i32 s38, s38, 7
    s_lshr_b32 s36, s36, 2
    s_add_u32 s87, s38, s36
    s_add_u32 s38, s93, 231
    s_cmp_lt_i32 s93, 25
    s_cselect_b32 s87, s38, s87
    s_add_u32 s93, s93, 8
    s_add_u32 s39, s87, s88
    s_bfe_u32 s37, s39, 0x30000
    s_lshl_b32 s37, s37, 12
    s_add_u32 s86, s37, s89
    s_bfe_u32 s37, s39, 0x10003
    s_lshl_b32 s37, s37, 11
    s_add_u32 s86, s37, s86
    s_bfe_u32 s37, s39, 0x40004
    s_lshl_b32 s37, s37, 16
    s_add_u32 s86, s37, s86
    s_cmp_ge_u32 s93, 33
    s_cselect_b32 s86, 134217728, s86
    v_mov_b32 v19, 25
    s_cmp_ge_u32 s93, 32
    s_cbranch_scc1 L_noclaim_6
    s_mov_b64 exec, 1
    global_atomic_add v19, v9, v18, s[30:31] sc0 sc1
    s_mov_b64 exec, -1
L_noclaim_6:
    buffer_load_dwordx4 v[160:163], v76, s[52:55], s86 offen offset:0 nt
    v_mfma_f32_16x16x32_bf16 v[112:115], v[128:131], v[80:83], 0
    s_waitcnt vmcnt(7)
    buffer_load_dwordx4 v[164:167], v77, s[52:55], s86 offen offset:0 nt
    v_mfma_f32_16x16x32_bf16 v[112:115], v[132:135], v[84:87], v[112:115]
    s_waitcnt vmcnt(7)
    buffer_load_dwordx4 v[168:171], v76, s[52:55], s86 offen offset:1024 nt
    v_mfma_f32_16x16x32_bf16 v[112:115], v[136:139], v[88:91], v[112:115]
    s_waitcnt vmcnt(7)
    buffer_load_dwordx4 v[172:175], v77, s[52:55], s86 offen offset:1024 nt
    v_mfma_f32_16x16x32_bf16 v[112:115], v[140:143], v[92:95], v[112:115]
    s_nop 7
    v_mov_b32_dpp v122, v112 quad_perm:[0,0,0,0] row_mask:0xf bank_mask:0xf
    v_mov_b32_dpp v124, v114 quad_perm:[2,2,2,2] row_mask:0xf bank_mask:0xf
    s_nop 0
    v_add_f32_dpp v122, v113, v122 quad_perm:[1,1,1,1] row_mask:0xf bank_mask:0xf
    v_add_f32_dpp v124, v115, v124 quad_perm:[3,3,3,3] row_mask:0xf bank_mask:0xf
    v_add_f32 v122, v122, v124
    v_fma_f32 v123, v122, s83, -v120
    v_cmp_lt_f32 vcc, 0, v123
    s_cbranch_vccz L_nomax_7
    v_mul_f32 v122, s83, v122
    s_nop 1
    v_max_f32_dpp v124, v122, v122 row_ror:4 row_mask:0xf bank_mask:0xf
    s_nop 1
    v_max_f32_dpp v124, v124, v124 row_ror:8 row_mask:0xf bank_mask:0xf
    v_mov_b32 v125, v124
    s_nop 1
    v_permlane16_swap_b32 v124, v125
    v_max_f32 v124, v124, v125
    v_mov_b32 v125, v124
    s_nop 1
    v_permlane32_swap_b32 v124, v125
    v_max_f32 v124, v124, v125
    v_and_b32 v124, s82, v124
    v_max_f32 v124, v124, v120
    v_sub_f32 v125, v120, v124
    v_exp_f32 v125, v125
    v_mov_b32 v120, v124
    v_sub_f32 v123, v122, v124
    v_mul_f32 v121, v121, v125
    v_mul_f32 v116, v116, v125
    v_mul_f32 v117, v117, v125
    v_mul_f32 v118, v118, v125
    v_mul_f32 v119, v119, v125
L_nomax_7:
    v_exp_f32 v123, v123
    s_nop 0
    v_cvt_pk_bf16_f32 v124, v123, v123
    v_add_f32 v121, v121, v123
    s_nop 0
    v_and_b32_dpp v96, v124, v10 row_newbcast:0 row_mask:0xf bank_mask:0xf
    v_and_b32_dpp v97, v124, v11 row_newbcast:0 row_mask:0xf bank_mask:0xf
    v_and_b32_dpp v98, v124, v12 row_newbcast:0 row_mask:0xf bank_mask:0xf
    v_and_b32_dpp v99, v124, v13 row_newbcast:0 row_mask:0xf bank_mask:0xf
    v_and_b32_dpp v100, v124, v10 row_newbcast:4 row_mask:0xf bank_mask:0xf
    v_and_b32_dpp v101, v124, v11 row_newbcast:4 row_mask:0xf bank_mask:0xf
    v_and_b32_dpp v102, v124, v12 row_newbcast:4 row_mask:0xf bank_mask:0xf
    v_and_b32_dpp v103, v124, v13 row_newbcast:4 row_mask:0xf bank_mask:0xf
    v_and_b32_dpp v104, v124, v10 row_newbcast:8 row_mask:0xf bank_mask:0xf
    v_and_b32_dpp v105, v124, v11 row_newbcast:8 row_mask:0xf bank_mask:0xf
    v_and_b32_dpp v106, v124, v12 row_newbcast:8 row_mask:0xf bank_mask:0xf
    v_and_b32_dpp v107, v124, v13 row_newbcast:8 row_mask:0xf bank_mask:0xf
    v_and_b32_dpp v108, v124, v10 row_newbcast:12 row_mask:0xf bank_mask:0xf
    v_and_b32_dpp v109, v124, v11 row_newbcast:12 row_mask:0xf bank_mask:0xf
    v_and_b32_dpp v110, v124, v12 row_newbcast:12 row_mask:0xf bank_mask:0xf
    v_and_b32_dpp v111, v124, v13 row_newbcast:12 row_mask:0xf bank_mask:0xf
    s_waitcnt vmcnt(7)
    buffer_load_dwordx4 v[176:179], v126, s[56:59], s86 offen offset:0 nt
    v_mfma_f32_16x16x32_bf16 v[116:119], v[144:147], v[96:99], v[116:119]
    s_waitcnt vmcnt(7)
    buffer_load_dwordx4 v[180:183], v127, s[56:59], s86 offen offset:0 nt
    v_mfma_f32_16x16x32_bf16 v[116:119], v[148:151], v[100:103], v[116:119]
    s_waitcnt vmcnt(7)
    buffer_load_dwordx4 v[184:187], v126, s[56:59], s86 offen offset:1024 nt
    v_mfma_f32_16x16x32_bf16 v[116:119], v[152:155], v[104:107], v[116:119]
    s_waitcnt vmcnt(7)
    buffer_load_dwordx4 v[188:191], v127, s[56:59], s86 offen offset:1024 nt
    v_mfma_f32_16x16x32_bf16 v[116:119], v[156:159], v[108:111], v[116:119]
    s_cmp_ge_u32 s93, 33
    s_cbranch_scc1 L_bdone
    s_waitcnt vmcnt(7)
    v_readfirstlane_b32 s93, v19
    s_nop 0
    s_sub_u32 s36, s93, 25
    s_and_b32 s38, s36, 3
    s_mul_i32 s38, s38, 7
    s_lshr_b32 s36, s36, 2
    s_add_u32 s87, s38, s36
    s_add_u32 s38, s93, 231
    s_cmp_lt_i32 s93, 25
    s_cselect_b32 s87, s38, s87
    s_add_u32 s93, s93, 8
    s_add_u32 s39, s87, s88
    s_bfe_u32 s37, s39, 0x30000
    s_lshl_b32 s37, s37, 12
    s_add_u32 s85, s37, s89
    s_bfe_u32 s37, s39, 0x10003
    s_lshl_b32 s37, s37, 11
    s_add_u32 s85, s37, s85
    s_bfe_u32 s37, s39, 0x40004
    s_lshl_b32 s37, s37, 16
    s_add_u32 s85, s37, s85
    s_cmp_ge_u32 s93, 33
    s_cselect_b32 s85, 134217728, s85
    v_mov_b32 v19, 25
    s_cmp_ge_u32 s93, 32
    s_cbranch_scc1 L_noclaim_8
    s_mov_b64 exec, 1
    global_atomic_add v19, v9, v18, s[30:31] sc0 sc1
    s_mov_b64 exec, -1
L_noclaim_8:
    buffer_load_dwordx4 v[128:131], v76, s[52:55], s85 offen offset:0 nt
    v_mfma_f32_16x16x32_bf16 v[112:115], v[160:163], v[80:83], 0
    s_waitcnt vmcnt(7)
    buffer_load_dwordx4 v[132:135], v77, s[52:55], s85 offen offset:0 nt
    v_mfma_f32_16x16x32_bf16 v[112:115], v[164:167], v[84:87], v[112:115]
    s_waitcnt vmcnt(7)
    buffer_load_dwordx4 v[136:139], v76, s[52:55], s85 offen offset:1024 nt
    v_mfma_f32_16x16x32_bf16 v[112:115], v[168:171], v[88:91], v[112:115]
    s_waitcnt vmcnt(7)
    buffer_load_dwordx4 v[140:143], v77, s[52:55], s85 offen offset:1024 nt
    v_mfma_f32_16x16x32_bf16 v[112:115], v[172:175], v[92:95], v[112:115]
    s_nop 7
    v_mov_b32_dpp v122, v112 quad_perm:[0,0,0,0] row_mask:0xf bank_mask:0xf
    v_mov_b32_dpp v124, v114 quad_perm:[2,2,2,2] row_mask:0xf bank_mask:0xf
    s_nop 0
    v_add_f32_dpp v122, v113, v122 quad_perm:[1,1,1,1] row_mask:0xf bank_mask:0xf
    v_add_f32_dpp v124, v115, v124 quad_perm:[3,3,3,3] row_mask:0xf bank_mask:0xf
    v_add_f32 v122, v122, v124
    v_fma_f32 v123, v122, s83, -v120
    v_cmp_lt_f32 vcc, 0, v123
    s_cbranch_vccz L_nomax_9
    v_mul_f32 v122, s83, v122
    s_nop 1
    v_max_f32_dpp v124, v122, v122 row_ror:4 row_mask:0xf bank_mask:0xf
    s_nop 1
    v_max_f32_dpp v124, v124, v124 row_ror:8 row_mask:0xf bank_mask:0xf
    v_mov_b32 v125, v124
    s_nop 1
    v_permlane16_swap_b32 v124, v125
    v_max_f32 v124, v124, v125
    v_mov_b32 v125, v124
    s_nop 1
    v_permlane32_swap_b32 v124, v125
    v_max_f32 v124, v124, v125
    v_and_b32 v124, s82, v124
    v_max_f32 v124, v124, v120
    v_sub_f32 v125, v120, v124
    v_exp_f32 v125, v125
    v_mov_b32 v120, v124
    v_sub_f32 v123, v122, v124
    v_mul_f32 v121, v121, v125
    v_mul_f32 v116, v116, v125
    v_mul_f32 v117, v117, v125
    v_mul_f32 v118, v118, v125
    v_mul_f32 v119, v119, v125
L_nomax_9:
    v_exp_f32 v123, v123
    s_nop 0
    v_cvt_pk_bf16_f32 v124, v123, v123
    v_add_f32 v121, v121, v123
    s_nop 0
    v_and_b32_dpp v96, v124, v10 row_newbcast:0 row_mask:0xf bank_mask:0xf
    v_and_b32_dpp v97, v124, v11 row_newbcast:0 row_mask:0xf bank_mask:0xf
    v_and_b32_dpp v98, v124, v12 row_newbcast:0 row_mask:0xf bank_mask:0xf
    v_and_b32_dpp v99, v124, v13 row_newbcast:0 row_mask:0xf bank_mask:0xf
    v_and_b32_dpp v100, v124, v10 row_newbcast:4 row_mask:0xf bank_mask:0xf
    v_and_b32_dpp v101, v124, v11 row_newbcast:4 row_mask:0xf bank_mask:0xf
    v_and_b32_dpp v102, v124, v12 row_newbcast:4 row_mask:0xf bank_mask:0xf
    v_and_b32_dpp v103, v124, v13 row_newbcast:4 row_mask:0xf bank_mask:0xf
    v_and_b32_dpp v104, v124, v10 row_newbcast:8 row_mask:0xf bank_mask:0xf
    v_and_b32_dpp v105, v124, v11 row_newbcast:8 row_mask:0xf bank_mask:0xf
    v_and_b32_dpp v106, v124, v12 row_newbcast:8 row_mask:0xf bank_mask:0xf
    v_and_b32_dpp v107, v124, v13 row_newbcast:8 row_mask:0xf bank_mask:0xf
    v_and_b32_dpp v108, v124, v10 row_newbcast:12 row_mask:0xf bank_mask:0xf
    v_and_b32_dpp v109, v124, v11 row_newbcast:12 row_mask:0xf bank_mask:0xf
    v_and_b32_dpp v110, v124, v12 row_newbcast:12 row_mask:0xf bank_mask:0xf
    v_and_b32_dpp v111, v124, v13 row_newbcast:12 row_mask:0xf bank_mask:0xf
    s_waitcnt vmcnt(7)
    buffer_load_dwordx4 v[144:147], v126, s[56:59], s85 offen offset:0 nt
    v_mfma_f32_16x16x32_bf16 v[116:119], v[176:179], v[96:99], v[116:119]
    s_waitcnt vmcnt(7)
    buffer_load_dwordx4 v[148:151], v127, s[56:59], s85 offen offset:0 nt
    v_mfma_f32_16x16x32_bf16 v[116:119], v[180:183], v[100:103], v[116:119]
    s_waitcnt vmcnt(7)
    buffer_load_dwordx4 v[152:155], v126, s[56:59], s85 offen offset:1024 nt
    v_mfma_f32_16x16x32_bf16 v[116:119], v[184:187], v[104:107], v[116:119]
    s_waitcnt vmcnt(7)
    buffer_load_dwordx4 v[156:159], v127, s[56:59], s85 offen offset:1024 nt
    v_mfma_f32_16x16x32_bf16 v[116:119], v[188:191], v[108:111], v[116:119]
    s_cmp_ge_u32 s93, 33
    s_cbranch_scc0 L_dloop
L_bdone:
    v_add_f32_dpp v121, v121, v121 row_ror:8 row_mask:0xf bank_mask:0xf
    s_nop 1
    v_add_f32_dpp v121, v121, v121 row_ror:4 row_mask:0xf bank_mask:0xf
    v_mov_b32 v125, v121
    s_nop 1
    v_permlane16_swap_b32 v121, v125
    v_add_f32 v121, v121, v125
    v_mov_b32 v125, v121
    v_and_or_b32 v118, v118, s82, v8
    v_and_or_b32 v119, v119, s82, v8
    v_permlane32_swap_b32 v121, v125
    s_mov_b32 exec_lo, 0x100
    s_mov_b32 exec_hi, 0x0
    v_add_f32 v117, v121, v125
    v_mov_b32 v116, v120
    s_mov_b32 exec_lo, 0xff01ff
    s_mov_b32 exec_hi, 0xff00ff
    v_and_or_b32 v116, v116, s82, v8
    v_and_or_b32 v117, v117, s82, v8
    buffer_store_dwordx4 v[116:119], v79, s[48:51], s96 offen sc1
    s_endpgm
L_qp:
    v_lshlrev_b32 v4, 18, v2
    v_lshl_add_u32 v14, v3, 4, v4
    v_lshrrev_b32 v5, 3, v3
    v_lshlrev_b32 v5, 10, v5
    v_lshl_add_u32 v15, v2, 6, v5
    s_cmp_eq_u32 s33, 0
    s_cselect_b32 s61, 3, 2
    s_xor_b32 s61, s61, s32
    s_lshl_b32 s86, s34, 8
    s_lshl_b32 s63, s34, 20
    s_lshl_b32 s38, s61, 8
    s_add_u32 s63, s63, s38
    s_mov_b32 s42, 4194304
    s_mov_b32 s43, 0x20000
    s_mov_b32 s46, 4096
    s_mov_b32 s47, 0x20000
    s_cmp_eq_u32 s33, 0
    s_waitcnt lgkmcnt(0)
    s_cselect_b64 s[40:41], s[22:23], s[8:9]
    s_cselect_b64 s[44:45], s[16:17], s[4:5]
    buffer_load_dwordx4 a[128:131], v14, s[40:43], s63 offen nt
    s_add_u32 s63, s63, 8192
    buffer_load_dwordx4 a[132:135], v14, s[40:43], s63 offen nt
    s_add_u32 s63, s63, 8192
    buffer_load_dwordx4 v[20:23], v15, s[44:47], s86 offen offset:0
    buffer_load_dwordx4 v[36:39], v15, s[44:47], s86 offen offset:2048
    buffer_load_dwordx4 a[136:139], v14, s[40:43], s63 offen nt
    s_add_u32 s63, s63, 8192
    buffer_load_dwordx4 a[140:143], v14, s[40:43], s63 offen nt
    s_add_u32 s63, s63, 8192
    buffer_load_dwordx4 a[144:147], v14, s[40:43], s63 offen nt
    s_add_u32 s63, s63, 8192
    buffer_load_dwordx4 a[148:151], v14, s[40:43], s63 offen nt
    s_add_u32 s63, s63, 8192
    buffer_load_dwordx4 a[152:155], v14, s[40:43], s63 offen nt
    s_add_u32 s63, s63, 8192
    buffer_load_dwordx4 a[156:159], v14, s[40:43], s63 offen nt
    s_add_u32 s63, s63, 8192
    s_load_dword s35, s[30:31], 0
    s_mov_b32 s48, s30
    s_and_b32 s49, s31, 0xffff
    s_mov_b32 s50, 16777216
    s_mov_b32 s51, 0x20000
    s_mov_b32 s82, 0xffffff00
    s_mov_b32 s83, 0x3e0293ee
    s_mov_b32 s84, 2097152
    v_and_b32 v4, 1, v1
    v_lshlrev_b32 v4, 4, v4
    v_mov_b32 v5, 0xffff
    v_lshlrev_b32 v4, v4, v5
    v_bfe_u32 v5, v1, 1, 2
    v_cmp_eq_u32 vcc, 0, v5
    s_nop 1
    v_cndmask_b32 v10, 0, v4, vcc
    v_cmp_eq_u32 vcc, 1, v5
    s_nop 1
    v_cndmask_b32 v11, 0, v4, vcc
    v_cmp_eq_u32 vcc, 2, v5
    s_nop 1
    v_cndmask_b32 v12, 0, v4, vcc
    v_cmp_eq_u32 vcc, 3, v5
    s_nop 1
    v_cndmask_b32 v13, 0, v4, vcc
    buffer_load_dwordx4 v[24:27], v15, s[44:47], s86 offen offset:16
    buffer_load_dwordx4 v[40:43], v15, s[44:47], s86 offen offset:2064
    buffer_load_dwordx4 v[28:31], v15, s[44:47], s86 offen offset:32
    buffer_load_dwordx4 v[44:47], v15, s[44:47], s86 offen offset:2080
    buffer_load_dwordx4 v[32:35], v15, s[44:47], s86 offen offset:48
    buffer_load_dwordx4 v[48:51], v15, s[44:47], s86 offen offset:2096
    s_lshr_b32 s38, s61, 1
    s_lshl_b32 s38, s38, 17
    s_add_u32 s36, s38, 2195456
    s_bfe_u32 s38, s61, 0x10000
    s_lshl_b32 s38, s38, 13
    s_add_u32 s36, s38, s36
    s_lshl_b32 s38, s34, 8
    s_add_u32 s36, s38, s36
    v_mov_b32 v19, 0
    s_cmp_eq_u32 s33, 0
    s_cselect_b32 s38, s36, 16777216
    s_mov_b64 exec, 1
    buffer_store_dword v19, v19, s[48:51], s38 offen sc1
    s_mov_b64 exec, -1
    s_mov_b32 s80, 0x01000100
    s_mov_b32 s81, 0x03020302
    s_waitcnt vmcnt(13)
    buffer_load_dwordx4 a[160:163], v14, s[40:43], s63 offen nt
    s_add_u32 s63, s63, 8192
    v_perm_b32 v4, v20, v20, s80
    v_perm_b32 v5, v36, v36, s80
    v_and_b32 v52, v4, v10
    v_and_b32 v53, v4, v11
    v_and_b32 v54, v4, v12
    v_and_b32 v55, v4, v13
    v_and_b32 v56, v5, v10
    v_and_b32 v57, v5, v11
    v_and_b32 v58, v5, v12
    v_and_b32 v59, v5, v13
    v_mfma_f32_16x16x32_bf16 v[60:63], a[128:131], v[52:55], 0
    s_nop 0
    v_mfma_f32_16x16x32_bf16 v[64:67], a[128:131], v[56:59], 0
    buffer_load_dwordx4 a[164:167], v14, s[40:43], s63 offen nt
    s_add_u32 s63, s63, 8192
    v_perm_b32 v4, v20, v20, s81
    v_perm_b32 v5, v36, v36, s81
    v_and_b32 v52, v4, v10
    v_and_b32 v53, v4, v11
    v_and_b32 v54, v4, v12
    v_and_b32 v55, v4, v13
    v_and_b32 v56, v5, v10
    v_and_b32 v57, v5, v11
    v_and_b32 v58, v5, v12
    v_and_b32 v59, v5, v13
    v_mfma_f32_16x16x32_bf16 v[60:63], a[132:135], v[52:55], v[60:63]
    s_nop 0
    v_mfma_f32_16x16x32_bf16 v[64:67], a[132:135], v[56:59], v[64:67]
    s_waitcnt vmcnt(14)
    buffer_load_dwordx4 a[168:171], v14, s[40:43], s63 offen nt
    s_add_u32 s63, s63, 8192
    v_perm_b32 v4, v21, v21, s80
    v_perm_b32 v5, v37, v37, s80
    v_and_b32 v52, v4, v10
    v_and_b32 v53, v4, v11
    v_and_b32 v54, v4, v12
    v_and_b32 v55, v4, v13
    v_and_b32 v56, v5, v10
    v_and_b32 v57, v5, v11
    v_and_b32 v58, v5, v12
    v_and_b32 v59, v5, v13
    v_mfma_f32_16x16x32_bf16 v[60:63], a[136:139], v[52:55], v[60:63]
    s_nop 0
    v_mfma_f32_16x16x32_bf16 v[64:67], a[136:139], v[56:59], v[64:67]
    s_waitcnt vmcnt(14)
    buffer_load_dwordx4 a[172:175], v14, s[40:43], s63 offen nt
    s_add_u32 s63, s63, 8192
    v_perm_b32 v4, v21, v21, s81
    v_perm_b32 v5, v37, v37, s81
    v_and_b32 v52, v4, v10
    v_and_b32 v53, v4, v11
    v_and_b32 v54, v4, v12
    v_and_b32 v55, v4, v13
    v_and_b32 v56, v5, v10
    v_and_b32 v57, v5, v11
    v_and_b32 v58, v5, v12
    v_and_b32 v59, v5, v13
    v_mfma_f32_16x16x32_bf16 v[60:63], a[140:143], v[52:55], v[60:63]
    s_nop 0
    v_mfma_f32_16x16x32_bf16 v[64:67], a[140:143], v[56:59], v[64:67]
    s_waitcnt vmcnt(14)
    buffer_load_dwordx4 a[176:179], v14, s[40:43], s63 offen nt
    s_add_u32 s63, s63, 8192
    v_lshrrev_b32 v4, 2, v3
    v_and_b32 v5, 3, v3
    v_lshlrev_b32 v76, 8, v4
    v_lshlrev_b32 v126, 8, v2
    v_lshl_add_u32 v76, v2, 6, v76
    v_lshl_add_u32 v76, v5, 4, v76
    v_lshl_add_u32 v126, v3, 4, v126
    v_xor_b32 v77, 32768, v76
    v_xor_b32 v127, 32768, v126
    s_add_u32 s3, s34, s33
    s_and_b32 s3, s3, 3
    s_lshl_b32 s89, s3, 5
    s_add_u32 s89, s89, s32
    s_lshl_b32 s89, s89, 20
    s_mul_i32 s88, s32, 8
    s_add_u32 s88, s88, s3
    s_add_u32 s87, s33, 0
    v_perm_b32 v4, v22, v22, s80
    v_perm_b32 v5, v38, v38, s80
    v_and_b32 v52, v4, v10
    v_and_b32 v53, v4, v11
    v_and_b32 v54, v4, v12
    v_and_b32 v55, v4, v13
    v_and_b32 v56, v5, v10
    v_and_b32 v57, v5, v11
    v_and_b32 v58, v5, v12
    v_and_b32 v59, v5, v13
    v_mfma_f32_16x16x32_bf16 v[60:63], a[144:147], v[52:55], v[60:63]
    s_nop 0
    v_mfma_f32_16x16x32_bf16 v[64:67], a[144:147], v[56:59], v[64:67]
    s_waitcnt vmcnt(14)
    buffer_load_dwordx4 a[180:183], v14, s[40:43], s63 offen nt
    s_add_u32 s63, s63, 8192
    v_perm_b32 v4, v22, v22, s81
    v_perm_b32 v5, v38, v38, s81
    v_and_b32 v52, v4, v10
    v_and_b32 v53, v4, v11
    v_and_b32 v54, v4, v12
    v_and_b32 v55, v4, v13
    v_and_b32 v56, v5, v10
    v_and_b32 v57, v5, v11
    v_and_b32 v58, v5, v12
    v_and_b32 v59, v5, v13
    v_mfma_f32_16x16x32_bf16 v[60:63], a[148:151], v[52:55], v[60:63]
    s_nop 0
    v_mfma_f32_16x16x32_bf16 v[64:67], a[148:151], v[56:59], v[64:67]
    s_waitcnt vmcnt(14)
    buffer_load_dwordx4 a[184:187], v14, s[40:43], s63 offen nt
    s_add_u32 s63, s63, 8192
    v_perm_b32 v4, v23, v23, s80
    v_perm_b32 v5, v39, v39, s80
    v_and_b32 v52, v4, v10
    v_and_b32 v53, v4, v11
    v_and_b32 v54, v4, v12
    v_and_b32 v55, v4, v13
    v_and_b32 v56, v5, v10
    v_and_b32 v57, v5, v11
    v_and_b32 v58, v5, v12
    v_and_b32 v59, v5, v13
    v_mfma_f32_16x16x32_bf16 v[60:63], a[152:155], v[52:55], v[60:63]
    s_nop 0
    v_mfma_f32_16x16x32_bf16 v[64:67], a[152:155], v[56:59], v[64:67]
    s_waitcnt vmcnt(14)
    buffer_load_dwordx4 a[188:191], v14, s[40:43], s63 offen nt
    s_add_u32 s63, s63, 8192
    v_perm_b32 v4, v23, v23, s81
    v_perm_b32 v5, v39, v39, s81
    v_and_b32 v52, v4, v10
    v_and_b32 v53, v4, v11
    v_and_b32 v54, v4, v12
    v_and_b32 v55, v4, v13
    v_and_b32 v56, v5, v10
    v_and_b32 v57, v5, v11
    v_and_b32 v58, v5, v12
    v_and_b32 v59, v5, v13
    v_mfma_f32_16x16x32_bf16 v[60:63], a[156:159], v[52:55], v[60:63]
    s_nop 0
    v_mfma_f32_16x16x32_bf16 v[64:67], a[156:159], v[56:59], v[64:67]
    s_waitcnt vmcnt(13)
    s_waitcnt vmcnt(7)
    buffer_load_dwordx4 a[192:195], v14, s[40:43], s63 offen nt
    s_add_u32 s63, s63, 8192
    s_mov_b32 s52, s18
    s_and_b32 s53, s19, 0xffff
    s_mov_b32 s54, 134217728
    s_mov_b32 s55, 0x20000
    s_mov_b32 s56, s20
    s_and_b32 s57, s21, 0xffff
    s_mov_b32 s58, 134217728
    s_mov_b32 s59, 0x20000
    v_perm_b32 v4, v24, v24, s80
    v_perm_b32 v5, v40, v40, s80
    v_and_b32 v52, v4, v10
    v_and_b32 v53, v4, v11
    v_and_b32 v54, v4, v12
    v_and_b32 v55, v4, v13
    v_and_b32 v56, v5, v10
    v_and_b32 v57, v5, v11
    v_and_b32 v58, v5, v12
    v_and_b32 v59, v5, v13
    v_mfma_f32_16x16x32_bf16 v[60:63], a[160:163], v[52:55], v[60:63]
    s_nop 0
    v_mfma_f32_16x16x32_bf16 v[64:67], a[160:163], v[56:59], v[64:67]
    s_waitcnt vmcnt(7)
    buffer_load_dwordx4 a[196:199], v14, s[40:43], s63 offen nt
    s_add_u32 s63, s63, 8192
    v_perm_b32 v4, v24, v24, s81
    v_perm_b32 v5, v40, v40, s81
    v_and_b32 v52, v4, v10
    v_and_b32 v53, v4, v11
    v_and_b32 v54, v4, v12
    v_and_b32 v55, v4, v13
    v_and_b32 v56, v5, v10
    v_and_b32 v57, v5, v11
    v_and_b32 v58, v5, v12
    v_and_b32 v59, v5, v13
    v_mfma_f32_16x16x32_bf16 v[60:63], a[164:167], v[52:55], v[60:63]
    s_nop 0
    v_mfma_f32_16x16x32_bf16 v[64:67], a[164:167], v[56:59], v[64:67]
    s_waitcnt vmcnt(7)
    buffer_load_dwordx4 a[200:203], v14, s[40:43], s63 offen nt
    s_add_u32 s63, s63, 8192
    v_perm_b32 v4, v25, v25, s80
    v_perm_b32 v5, v41, v41, s80
    v_and_b32 v52, v4, v10
    v_and_b32 v53, v4, v11
    v_and_b32 v54, v4, v12
    v_and_b32 v55, v4, v13
    v_and_b32 v56, v5, v10
    v_and_b32 v57, v5, v11
    v_and_b32 v58, v5, v12
    v_and_b32 v59, v5, v13
    v_mfma_f32_16x16x32_bf16 v[60:63], a[168:171], v[52:55], v[60:63]
    s_nop 0
    v_mfma_f32_16x16x32_bf16 v[64:67], a[168:171], v[56:59], v[64:67]
    s_waitcnt vmcnt(7)
    buffer_load_dwordx4 a[204:207], v14, s[40:43], s63 offen nt
    s_add_u32 s63, s63, 8192
    v_perm_b32 v4, v25, v25, s81
    v_perm_b32 v5, v41, v41, s81
    v_and_b32 v52, v4, v10
    v_and_b32 v53, v4, v11
    v_and_b32 v54, v4, v12
    v_and_b32 v55, v4, v13
    v_and_b32 v56, v5, v10
    v_and_b32 v57, v5, v11
    v_and_b32 v58, v5, v12
    v_and_b32 v59, v5, v13
    v_mfma_f32_16x16x32_bf16 v[60:63], a[172:175], v[52:55], v[60:63]
    s_nop 0
    v_mfma_f32_16x16x32_bf16 v[64:67], a[172:175], v[56:59], v[64:67]
    s_waitcnt vmcnt(7)
    buffer_load_dwordx4 a[208:211], v14, s[40:43], s63 offen nt
    s_add_u32 s63, s63, 8192
    v_mov_b32 v120, 0xff7f0000
    v_mov_b32 v121, 0
    v_mov_b32 v18, 1
    v_mov_b32 v116, 0
    v_mov_b32 v117, 0
    v_mov_b32 v118, 0
    v_mov_b32 v119, 0
    s_lshr_b32 s38, s32, 1
    s_lshl_b32 s38, s38, 17
    s_add_u32 s96, s38, 2195456
    s_bfe_u32 s38, s32, 0x10000
    s_lshl_b32 s38, s38, 13
    s_add_u32 s96, s38, s96
    s_lshl_b32 s38, s3, 8
    s_add_u32 s96, s38, s96
    v_mov_b32 v9, s96
    s_lshr_b32 s38, s32, 1
    s_lshl_b32 s38, s38, 17
    s_add_u32 s96, s38, 2097152
    s_bfe_u32 s38, s32, 0x10000
    s_lshl_b32 s38, s38, 15
    s_add_u32 s96, s38, s96
    s_lshl_b32 s38, s3, 13
    s_add_u32 s96, s38, s96
    s_lshl_b32 s38, s33, 10
    s_add_u32 s96, s38, s96
    v_and_b32 v5, 3, v3
    v_lshlrev_b32 v78, 7, v2
    v_lshl_add_u32 v78, v5, 5, v78
    s_lshr_b32 s38, s32, 1
    s_lshl_b32 s38, s38, 17
    s_add_u32 s91, s38, 2162688
    s_bfe_u32 s38, s32, 0x10000
    s_lshl_b32 s38, s38, 13
    s_add_u32 s91, s38, s91
    s_lshl_b32 s38, s3, 9
    s_add_u32 s91, s38, s91
    v_lshlrev_b32 v4, 7, v2
    v_lshl_add_u32 v4, v3, 4, v4
    v_mov_b32 v5, 512
    v_cmp_gt_u32 vcc, 8, v3
    s_nop 1
    v_cndmask_b32 v79, v5, v4, vcc
    v_perm_b32 v4, v26, v26, s80
    v_perm_b32 v5, v42, v42, s80
    v_and_b32 v52, v4, v10
    v_and_b32 v53, v4, v11
    v_and_b32 v54, v4, v12
    v_and_b32 v55, v4, v13
    v_and_b32 v56, v5, v10
    v_and_b32 v57, v5, v11
    v_and_b32 v58, v5, v12
    v_and_b32 v59, v5, v13
    v_mfma_f32_16x16x32_bf16 v[60:63], a[176:179], v[52:55], v[60:63]
    s_nop 0
    v_mfma_f32_16x16x32_bf16 v[64:67], a[176:179], v[56:59], v[64:67]
    s_waitcnt vmcnt(7)
    buffer_load_dwordx4 a[212:215], v14, s[40:43], s63 offen nt
    s_add_u32 s63, s63, 8192
    v_perm_b32 v4, v26, v26, s81
    v_perm_b32 v5, v42, v42, s81
    v_and_b32 v52, v4, v10
    v_and_b32 v53, v4, v11
    v_and_b32 v54, v4, v12
    v_and_b32 v55, v4, v13
    v_and_b32 v56, v5, v10
    v_and_b32 v57, v5, v11
    v_and_b32 v58, v5, v12
    v_and_b32 v59, v5, v13
    v_mfma_f32_16x16x32_bf16 v[60:63], a[180:183], v[52:55], v[60:63]
    s_nop 0
    v_mfma_f32_16x16x32_bf16 v[64:67], a[180:183], v[56:59], v[64:67]
    s_waitcnt vmcnt(7)
    buffer_load_dwordx4 a[216:219], v14, s[40:43], s63 offen nt
    s_add_u32 s63, s63, 8192
    v_perm_b32 v4, v27, v27, s80
    v_perm_b32 v5, v43, v43, s80
    v_and_b32 v52, v4, v10
    v_and_b32 v53, v4, v11
    v_and_b32 v54, v4, v12
    v_and_b32 v55, v4, v13
    v_and_b32 v56, v5, v10
    v_and_b32 v57, v5, v11
    v_and_b32 v58, v5, v12
    v_and_b32 v59, v5, v13
    v_mfma_f32_16x16x32_bf16 v[60:63], a[184:187], v[52:55], v[60:63]
    s_nop 0
    v_mfma_f32_16x16x32_bf16 v[64:67], a[184:187], v[56:59], v[64:67]
    s_waitcnt vmcnt(7)
    buffer_load_dwordx4 a[220:223], v14, s[40:43], s63 offen nt
    s_add_u32 s63, s63, 8192
    v_perm_b32 v4, v27, v27, s81
    v_perm_b32 v5, v43, v43, s81
    v_and_b32 v52, v4, v10
    v_and_b32 v53, v4, v11
    v_and_b32 v54, v4, v12
    v_and_b32 v55, v4, v13
    v_and_b32 v56, v5, v10
    v_and_b32 v57, v5, v11
    v_and_b32 v58, v5, v12
    v_and_b32 v59, v5, v13
    v_mfma_f32_16x16x32_bf16 v[60:63], a[188:191], v[52:55], v[60:63]
    s_nop 0
    v_mfma_f32_16x16x32_bf16 v[64:67], a[188:191], v[56:59], v[64:67]
    s_waitcnt vmcnt(7)
    buffer_load_dwordx4 a[224:227], v14, s[40:43], s63 offen nt
    s_add_u32 s63, s63, 8192
    v_perm_b32 v4, v28, v28, s80
    v_perm_b32 v5, v44, v44, s80
    v_and_b32 v52, v4, v10
    v_and_b32 v53, v4, v11
    v_and_b32 v54, v4, v12
    v_and_b32 v55, v4, v13
    v_and_b32 v56, v5, v10
    v_and_b32 v57, v5, v11
    v_and_b32 v58, v5, v12
    v_and_b32 v59, v5, v13
    v_mfma_f32_16x16x32_bf16 v[60:63], a[192:195], v[52:55], v[60:63]
    s_nop 0
    v_mfma_f32_16x16x32_bf16 v[64:67], a[192:195], v[56:59], v[64:67]
    s_waitcnt vmcnt(7)
    buffer_load_dwordx4 a[228:231], v14, s[40:43], s63 offen nt
    s_add_u32 s63, s63, 8192
    v_perm_b32 v4, v28, v28, s81
    v_perm_b32 v5, v44, v44, s81
    v_and_b32 v52, v4, v10
    v_and_b32 v53, v4, v11
    v_and_b32 v54, v4, v12
    v_and_b32 v55, v4, v13
    v_and_b32 v56, v5, v10
    v_and_b32 v57, v5, v11
    v_and_b32 v58, v5, v12
    v_and_b32 v59, v5, v13
    v_mfma_f32_16x16x32_bf16 v[60:63], a[196:199], v[52:55], v[60:63]
    s_nop 0
    v_mfma_f32_16x16x32_bf16 v[64:67], a[196:199], v[56:59], v[64:67]
    s_waitcnt vmcnt(7)
    buffer_load_dwordx4 a[232:235], v14, s[40:43], s63 offen nt
    s_add_u32 s63, s63, 8192
    v_perm_b32 v4, v29, v29, s80
    v_perm_b32 v5, v45, v45, s80
    v_and_b32 v52, v4, v10
    v_and_b32 v53, v4, v11
    v_and_b32 v54, v4, v12
    v_and_b32 v55, v4, v13
    v_and_b32 v56, v5, v10
    v_and_b32 v57, v5, v11
    v_and_b32 v58, v5, v12
    v_and_b32 v59, v5, v13
    v_mfma_f32_16x16x32_bf16 v[60:63], a[200:203], v[52:55], v[60:63]
    s_nop 0
    v_mfma_f32_16x16x32_bf16 v[64:67], a[200:203], v[56:59], v[64:67]
    s_waitcnt vmcnt(7)
    buffer_load_dwordx4 a[236:239], v14, s[40:43], s63 offen nt
    s_add_u32 s63, s63, 8192
    v_perm_b32 v4, v29, v29, s81
    v_perm_b32 v5, v45, v45, s81
    v_and_b32 v52, v4, v10
    v_and_b32 v53, v4, v11
    v_and_b32 v54, v4, v12
    v_and_b32 v55, v4, v13
    v_and_b32 v56, v5, v10
    v_and_b32 v57, v5, v11
    v_and_b32 v58, v5, v12
    v_and_b32 v59, v5, v13
    v_mfma_f32_16x16x32_bf16 v[60:63], a[204:207], v[52:55], v[60:63]
    s_nop 0
    v_mfma_f32_16x16x32_bf16 v[64:67], a[204:207], v[56:59], v[64:67]
    s_waitcnt vmcnt(7)
    buffer_load_dwordx4 a[240:243], v14, s[40:43], s63 offen nt
    s_add_u32 s63, s63, 8192
    v_perm_b32 v4, v30, v30, s80
    v_perm_b32 v5, v46, v46, s80
    v_and_b32 v52, v4, v10
    v_and_b32 v53, v4, v11
    v_and_b32 v54, v4, v12
    v_and_b32 v55, v4, v13
    v_and_b32 v56, v5, v10
    v_and_b32 v57, v5, v11
    v_and_b32 v58, v5, v12
    v_and_b32 v59, v5, v13
    v_mfma_f32_16x16x32_bf16 v[60:63], a[208:211], v[52:55], v[60:63]
    s_nop 0
    v_mfma_f32_16x16x32_bf16 v[64:67], a[208:211], v[56:59], v[64:67]
    s_waitcnt vmcnt(7)
    buffer_load_dwordx4 a[244:247], v14, s[40:43], s63 offen nt
    s_add_u32 s63, s63, 8192
    v_perm_b32 v4, v30, v30, s81
    v_perm_b32 v5, v46, v46, s81
    v_and_b32 v52, v4, v10
    v_and_b32 v53, v4, v11
    v_and_b32 v54, v4, v12
    v_and_b32 v55, v4, v13
    v_and_b32 v56, v5, v10
    v_and_b32 v57, v5, v11
    v_and_b32 v58, v5, v12
    v_and_b32 v59, v5, v13
    v_mfma_f32_16x16x32_bf16 v[60:63], a[212:215], v[52:55], v[60:63]
    s_nop 0
    v_mfma_f32_16x16x32_bf16 v[64:67], a[212:215], v[56:59], v[64:67]
    s_waitcnt vmcnt(7)
    buffer_load_dwordx4 a[248:251], v14, s[40:43], s63 offen nt
    s_add_u32 s63, s63, 8192
    v_perm_b32 v4, v31, v31, s80
    v_perm_b32 v5, v47, v47, s80
    v_and_b32 v52, v4, v10
    v_and_b32 v53, v4, v11
    v_and_b32 v54, v4, v12
    v_and_b32 v55, v4, v13
    v_and_b32 v56, v5, v10
    v_and_b32 v57, v5, v11
    v_and_b32 v58, v5, v12
    v_and_b32 v59, v5, v13
    v_mfma_f32_16x16x32_bf16 v[60:63], a[216:219], v[52:55], v[60:63]
    s_nop 0
    v_mfma_f32_16x16x32_bf16 v[64:67], a[216:219], v[56:59], v[64:67]
    s_waitcnt vmcnt(7)
    buffer_load_dwordx4 a[252:255], v14, s[40:43], s63 offen nt
    s_add_u32 s63, s63, 8192
    v_perm_b32 v4, v31, v31, s81
    v_perm_b32 v5, v47, v47, s81
    v_and_b32 v52, v4, v10
    v_and_b32 v53, v4, v11
    v_and_b32 v54, v4, v12
    v_and_b32 v55, v4, v13
    v_and_b32 v56, v5, v10
    v_and_b32 v57, v5, v11
    v_and_b32 v58, v5, v12
    v_and_b32 v59, v5, v13
    v_mfma_f32_16x16x32_bf16 v[60:63], a[220:223], v[52:55], v[60:63]
    s_nop 0
    v_mfma_f32_16x16x32_bf16 v[64:67], a[220:223], v[56:59], v[64:67]
    s_waitcnt vmcnt(7)
    v_perm_b32 v4, v32, v32, s80
    v_perm_b32 v5, v48, v48, s80
    v_and_b32 v52, v4, v10
    v_and_b32 v53, v4, v11
    v_and_b32 v54, v4, v12
    v_and_b32 v55, v4, v13
    v_and_b32 v56, v5, v10
    v_and_b32 v57, v5, v11
    v_and_b32 v58, v5, v12
    v_and_b32 v59, v5, v13
    v_mfma_f32_16x16x32_bf16 v[60:63], a[224:227], v[52:55], v[60:63]
    s_nop 0
    v_mfma_f32_16x16x32_bf16 v[64:67], a[224:227], v[56:59], v[64:67]
    s_waitcnt vmcnt(6)
    s_add_u32 s39, s87, s88
    s_bfe_u32 s37, s39, 0x30000
    s_lshl_b32 s37, s37, 12
    s_add_u32 s85, s37, s89
    s_bfe_u32 s37, s39, 0x10003
    s_lshl_b32 s37, s37, 11
    s_add_u32 s85, s37, s85
    s_bfe_u32 s37, s39, 0x40004
    s_lshl_b32 s37, s37, 16
    s_add_u32 s85, s37, s85
    buffer_load_dwordx4 v[128:131], v76, s[52:55], s85 offen offset:0 nt
    v_perm_b32 v4, v32, v32, s81
    v_perm_b32 v5, v48, v48, s81
    v_and_b32 v52, v4, v10
    v_and_b32 v53, v4, v11
    v_and_b32 v54, v4, v12
    v_and_b32 v55, v4, v13
    v_and_b32 v56, v5, v10
    v_and_b32 v57, v5, v11
    v_and_b32 v58, v5, v12
    v_and_b32 v59, v5, v13
    v_mfma_f32_16x16x32_bf16 v[60:63], a[228:231], v[52:55], v[60:63]
    s_nop 0
    v_mfma_f32_16x16x32_bf16 v[64:67], a[228:231], v[56:59], v[64:67]
    s_waitcnt vmcnt(6)
    buffer_load_dwordx4 v[132:135], v77, s[52:55], s85 offen offset:0 nt
    v_perm_b32 v4, v33, v33, s80
    v_perm_b32 v5, v49, v49, s80
    v_and_b32 v52, v4, v10
    v_and_b32 v53, v4, v11
    v_and_b32 v54, v4, v12
    v_and_b32 v55, v4, v13
    v_and_b32 v56, v5, v10
    v_and_b32 v57, v5, v11
    v_and_b32 v58, v5, v12
    v_and_b32 v59, v5, v13
    v_mfma_f32_16x16x32_bf16 v[60:63], a[232:235], v[52:55], v[60:63]
    s_nop 0
    v_mfma_f32_16x16x32_bf16 v[64:67], a[232:235], v[56:59], v[64:67]
    s_waitcnt vmcnt(6)
    buffer_load_dwordx4 v[136:139], v76, s[52:55], s85 offen offset:1024 nt
    v_perm_b32 v4, v33, v33, s81
    v_perm_b32 v5, v49, v49, s81
    v_and_b32 v52, v4, v10
    v_and_b32 v53, v4, v11
    v_and_b32 v54, v4, v12
    v_and_b32 v55, v4, v13
    v_and_b32 v56, v5, v10
    v_and_b32 v57, v5, v11
    v_and_b32 v58, v5, v12
    v_and_b32 v59, v5, v13
    v_mfma_f32_16x16x32_bf16 v[60:63], a[236:239], v[52:55], v[60:63]
    s_nop 0
    v_mfma_f32_16x16x32_bf16 v[64:67], a[236:239], v[56:59], v[64:67]
    s_waitcnt vmcnt(6)
    buffer_load_dwordx4 v[140:143], v77, s[52:55], s85 offen offset:1024 nt
    s_add_u32 s87, s87, 7
    s_add_u32 s39, s87, s88
    s_bfe_u32 s37, s39, 0x30000
    s_lshl_b32 s37, s37, 12
    s_add_u32 s85, s37, s89
    s_bfe_u32 s37, s39, 0x10003
    s_lshl_b32 s37, s37, 11
    s_add_u32 s85, s37, s85
    s_bfe_u32 s37, s39, 0x40004
    s_lshl_b32 s37, s37, 16
    s_add_u32 s85, s37, s85
    v_perm_b32 v4, v34, v34, s80
    v_perm_b32 v5, v50, v50, s80
    v_and_b32 v52, v4, v10
    v_and_b32 v53, v4, v11
    v_and_b32 v54, v4, v12
    v_and_b32 v55, v4, v13
    v_and_b32 v56, v5, v10
    v_and_b32 v57, v5, v11
    v_and_b32 v58, v5, v12
    v_and_b32 v59, v5, v13
    v_mfma_f32_16x16x32_bf16 v[60:63], a[240:243], v[52:55], v[60:63]
    s_nop 0
    v_mfma_f32_16x16x32_bf16 v[64:67], a[240:243], v[56:59], v[64:67]
    s_waitcnt vmcnt(6)
    buffer_load_dwordx4 v[144:147], v76, s[52:55], s85 offen offset:0 nt
    v_perm_b32 v4, v34, v34, s81
    v_perm_b32 v5, v50, v50, s81
    v_and_b32 v52, v4, v10
    v_and_b32 v53, v4, v11
    v_and_b32 v54, v4, v12
    v_and_b32 v55, v4, v13
    v_and_b32 v56, v5, v10
    v_and_b32 v57, v5, v11
    v_and_b32 v58, v5, v12
    v_and_b32 v59, v5, v13
    v_mfma_f32_16x16x32_bf16 v[60:63], a[244:247], v[52:55], v[60:63]
    s_nop 0
    v_mfma_f32_16x16x32_bf16 v[64:67], a[244:247], v[56:59], v[64:67]
    s_waitcnt vmcnt(6)
    buffer_load_dwordx4 v[148:151], v77, s[52:55], s85 offen offset:0 nt
    v_perm_b32 v4, v35, v35, s80
    v_perm_b32 v5, v51, v51, s80
    v_and_b32 v52, v4, v10
    v_and_b32 v53, v4, v11
    v_and_b32 v54, v4, v12
    v_and_b32 v55, v4, v13
    v_and_b32 v56, v5, v10
    v_and_b32 v57, v5, v11
    v_and_b32 v58, v5, v12
    v_and_b32 v59, v5, v13
    v_mfma_f32_16x16x32_bf16 v[60:63], a[248:251], v[52:55], v[60:63]
    s_nop 0
    v_mfma_f32_16x16x32_bf16 v[64:67], a[248:251], v[56:59], v[64:67]
    s_waitcnt vmcnt(6)
    buffer_load_dwordx4 v[152:155], v76, s[52:55], s85 offen offset:1024 nt
    v_perm_b32 v4, v35, v35, s81
    v_perm_b32 v5, v51, v51, s81
    v_and_b32 v52, v4, v10
    v_and_b32 v53, v4, v11
    v_and_b32 v54, v4, v12
    v_and_b32 v55, v4, v13
    v_and_b32 v56, v5, v10
    v_and_b32 v57, v5, v11
    v_and_b32 v58, v5, v12
    v_and_b32 v59, v5, v13
    v_mfma_f32_16x16x32_bf16 v[60:63], a[252:255], v[52:55], v[60:63]
    s_nop 0
    v_mfma_f32_16x16x32_bf16 v[64:67], a[252:255], v[56:59], v[64:67]
    s_lshl_b32 s38, s34, 11
    v_lshrrev_b32 v4, 3, v3
    v_lshlrev_b32 v4, 9, v4
    v_lshl_add_u32 v4, v2, 7, v4
    v_and_b32 v5, 7, v3
    v_lshl_add_u32 v4, v5, 2, v4
    v_add_u32 v4, s38, v4
    ds_write_b32 v4, v60 offset:0
    ds_write_b32 v4, v61 offset:32
    ds_write_b32 v4, v62 offset:64
    ds_write_b32 v4, v63 offset:96
    ds_write_b32 v4, v64 offset:1024
    ds_write_b32 v4, v65 offset:1056
    ds_write_b32 v4, v66 offset:1088
    ds_write_b32 v4, v67 offset:1120
    s_lshl_b32 s38, s34, 9
    v_and_b32 v5, 31, v1
    v_lshl_add_u32 v5, v5, 4, s38
    s_waitcnt lgkmcnt(0)
    s_add_u32 s35, s35, 0x5b
    s_and_b32 s35, s35, 0xff
    v_mov_b32 v8, s35
    s_barrier
    ds_read_b128 v[20:23], v5 offset:0
    ds_read_b128 v[24:27], v5 offset:2048
    ds_read_b128 v[28:31], v5 offset:4096
    ds_read_b128 v[32:35], v5 offset:6144
    s_lshr_b32 s38, s61, 1
    s_lshl_b32 s38, s38, 17
    s_add_u32 s36, s38, 2162688
    s_bfe_u32 s38, s61, 0x10000
    s_lshl_b32 s38, s38, 13
    s_add_u32 s36, s38, s36
    s_lshl_b32 s38, s33, 11
    s_add_u32 s36, s38, s36
    s_waitcnt lgkmcnt(0)
    v_add_f32 v20, v20, v24
    v_add_f32 v28, v28, v32
    v_add_f32 v21, v21, v25
    v_add_f32 v29, v29, v33
    v_add_f32 v22, v22, v26
    v_add_f32 v30, v30, v34
    v_add_f32 v23, v23, v27
    v_add_f32 v31, v31, v35
    v_add_f32 v20, v20, v28
    v_add_f32 v21, v21, v29
    v_add_f32 v22, v22, v30
    v_add_f32 v23, v23, v31
    v_and_or_b32 v20, v20, s82, v8
    v_and_or_b32 v21, v21, s82, v8
    v_and_or_b32 v22, v22, s82, v8
    v_and_or_b32 v23, v23, s82, v8
    s_mov_b32 exec_lo, 0xffffffff
    s_mov_b32 exec_hi, 0x0
    buffer_store_dwordx4 v[20:23], v5, s[48:51], s36 offen sc1
    s_mov_b64 exec, -1
    s_waitcnt vmcnt(7)
    buffer_load_dwordx4 v[156:159], v77, s[52:55], s85 offen offset:1024 nt
    s_add_u32 s87, s87, 7
    s_add_u32 s39, s87, s88
    s_bfe_u32 s37, s39, 0x30000
    s_lshl_b32 s37, s37, 12
    s_add_u32 s85, s37, s89
    s_bfe_u32 s37, s39, 0x10003
    s_lshl_b32 s37, s37, 11
    s_add_u32 s85, s37, s85
    s_bfe_u32 s37, s39, 0x40004
    s_lshl_b32 s37, s37, 16
    s_add_u32 s85, s37, s85
    s_waitcnt vmcnt(7)
    buffer_load_dwordx4 v[160:163], v76, s[52:55], s85 offen offset:0 nt
    s_waitcnt vmcnt(7)
    buffer_load_dwordx4 v[164:167], v77, s[52:55], s85 offen offset:0 nt
    s_waitcnt vmcnt(7)
    buffer_load_dwordx4 v[168:171], v76, s[52:55], s85 offen offset:1024 nt
    s_waitcnt vmcnt(7)
    buffer_load_dwordx4 v[172:175], v77, s[52:55], s85 offen offset:1024 nt
    s_add_u32 s87, s87, 7
    s_add_u32 s39, s87, s88
    s_bfe_u32 s37, s39, 0x30000
    s_lshl_b32 s37, s37, 12
    s_add_u32 s85, s37, s89
    s_bfe_u32 s37, s39, 0x10003
    s_lshl_b32 s37, s37, 11
    s_add_u32 s85, s37, s85
    s_bfe_u32 s37, s39, 0x40004
    s_lshl_b32 s37, s37, 16
    s_add_u32 s85, s37, s85
    s_waitcnt vmcnt(7)
    buffer_load_dwordx4 v[176:179], v76, s[52:55], s85 offen offset:0 nt
    s_waitcnt vmcnt(7)
    buffer_load_dwordx4 v[180:183], v77, s[52:55], s85 offen offset:0 nt
    s_waitcnt vmcnt(6)
    buffer_load_dwordx4 v[184:187], v76, s[52:55], s85 offen offset:1024 nt
    s_waitcnt vmcnt(6)
    buffer_load_dwordx4 v[188:191], v77, s[52:55], s85 offen offset:1024 nt
    s_add_u32 s87, s87, 7
    s_add_u32 s39, s87, s88
    s_bfe_u32 s37, s39, 0x30000
    s_lshl_b32 s37, s37, 12
    s_add_u32 s85, s37, s89
    s_bfe_u32 s37, s39, 0x10003
    s_lshl_b32 s37, s37, 11
    s_add_u32 s85, s37, s85
    s_bfe_u32 s37, s39, 0x40004
    s_lshl_b32 s37, s37, 16
    s_add_u32 s85, s37, s85
    s_waitcnt vmcnt(6)
    buffer_load_dwordx4 v[192:195], v76, s[52:55], s85 offen offset:0 nt
    s_waitcnt vmcnt(6)
    buffer_load_dwordx4 v[196:199], v77, s[52:55], s85 offen offset:0 nt
    s_waitcnt vmcnt(6)
    buffer_load_dwordx4 v[200:203], v76, s[52:55], s85 offen offset:1024 nt
    s_waitcnt vmcnt(6)
    buffer_load_dwordx4 v[204:207], v77, s[52:55], s85 offen offset:1024 nt
    s_add_u32 s87, s87, 7
    s_add_u32 s39, s87, s88
    s_bfe_u32 s37, s39, 0x30000
    s_lshl_b32 s37, s37, 12
    s_add_u32 s85, s37, s89
    s_bfe_u32 s37, s39, 0x10003
    s_lshl_b32 s37, s37, 11
    s_add_u32 s85, s37, s85
    s_bfe_u32 s37, s39, 0x40004
    s_lshl_b32 s37, s37, 16
    s_add_u32 s85, s37, s85
    s_waitcnt vmcnt(6)
    buffer_load_dwordx4 v[208:211], v76, s[52:55], s85 offen offset:0 nt
    s_waitcnt vmcnt(6)
    buffer_load_dwordx4 v[212:215], v77, s[52:55], s85 offen offset:0 nt
    s_waitcnt vmcnt(6)
    buffer_load_dwordx4 v[216:219], v76, s[52:55], s85 offen offset:1024 nt
    s_waitcnt vmcnt(6)
    buffer_load_dwordx4 v[220:223], v77, s[52:55], s85 offen offset:1024 nt
    s_add_u32 s87, s87, 7
    s_add_u32 s39, s87, s88
    s_bfe_u32 s37, s39, 0x30000
    s_lshl_b32 s37, s37, 12
    s_add_u32 s85, s37, s89
    s_bfe_u32 s37, s39, 0x10003
    s_lshl_b32 s37, s37, 11
    s_add_u32 s85, s37, s85
    s_bfe_u32 s37, s39, 0x40004
    s_lshl_b32 s37, s37, 16
    s_add_u32 s85, s37, s85
    s_waitcnt vmcnt(6)
    buffer_load_dwordx4 v[224:227], v76, s[52:55], s85 offen offset:0 nt
    s_waitcnt vmcnt(6)
    buffer_load_dwordx4 v[228:231], v77, s[52:55], s85 offen offset:0 nt
    s_waitcnt vmcnt(6)
    buffer_load_dwordx4 v[232:235], v76, s[52:55], s85 offen offset:1024 nt
    s_waitcnt vmcnt(6)
    buffer_load_dwordx4 v[236:239], v77, s[52:55], s85 offen offset:1024 nt
    s_add_u32 s87, s87, 7
    s_add_u32 s39, s87, s88
    s_bfe_u32 s37, s39, 0x30000
    s_lshl_b32 s37, s37, 12
    s_add_u32 s85, s37, s89
    s_bfe_u32 s37, s39, 0x10003
    s_lshl_b32 s37, s37, 11
    s_add_u32 s85, s37, s85
    s_bfe_u32 s37, s39, 0x40004
    s_lshl_b32 s37, s37, 16
    s_add_u32 s85, s37, s85
    s_waitcnt vmcnt(6)
    buffer_load_dwordx4 v[240:243], v76, s[52:55], s85 offen offset:0 nt
    s_waitcnt vmcnt(6)
    buffer_load_dwordx4 v[244:247], v77, s[52:55], s85 offen offset:0 nt
    s_waitcnt vmcnt(6)
    buffer_load_dwordx4 v[248:251], v76, s[52:55], s85 offen offset:1024 nt
    s_waitcnt vmcnt(6)
    buffer_load_dwordx4 v[252:255], v77, s[52:55], s85 offen offset:1024 nt
    s_add_u32 s87, s87, 7
    s_add_u32 s39, s87, s88
    s_bfe_u32 s37, s39, 0x30000
    s_lshl_b32 s37, s37, 12
    s_add_u32 s85, s37, s89
    s_bfe_u32 s37, s39, 0x10003
    s_lshl_b32 s37, s37, 11
    s_add_u32 s85, s37, s85
    s_bfe_u32 s37, s39, 0x40004
    s_lshl_b32 s37, s37, 16
    s_add_u32 s85, s37, s85
    s_waitcnt vmcnt(6)
    buffer_load_dwordx4 a[0:3], v76, s[52:55], s85 offen offset:0 nt
    s_waitcnt vmcnt(6)
    buffer_load_dwordx4 a[4:7], v77, s[52:55], s85 offen offset:0 nt
    buffer_load_dwordx4 v[68:71], v78, s[48:51], s91 offen offset:0 sc1
    buffer_load_dwordx4 v[72:75], v78, s[48:51], s91 offen offset:16 sc1
    s_waitcnt vmcnt(8)
    buffer_load_dwordx4 a[8:11], v76, s[52:55], s85 offen offset:1024 nt
    s_waitcnt vmcnt(8)
    buffer_load_dwordx4 a[12:15], v77, s[52:55], s85 offen offset:1024 nt
    s_add_u32 s87, s87, 7
    s_add_u32 s39, s87, s88
    s_bfe_u32 s37, s39, 0x30000
    s_lshl_b32 s37, s37, 12
    s_add_u32 s85, s37, s89
    s_bfe_u32 s37, s39, 0x10003
    s_lshl_b32 s37, s37, 11
    s_add_u32 s85, s37, s85
    s_bfe_u32 s37, s39, 0x40004
    s_lshl_b32 s37, s37, 16
    s_add_u32 s85, s37, s85
    s_waitcnt vmcnt(8)
    buffer_load_dwordx4 a[16:19], v76, s[52:55], s85 offen offset:0 nt
    s_waitcnt vmcnt(8)
    buffer_load_dwordx4 a[20:23], v77, s[52:55], s85 offen offset:0 nt
    s_waitcnt vmcnt(8)
    buffer_load_dwordx4 a[24:27], v76, s[52:55], s85 offen offset:1024 nt
    s_waitcnt vmcnt(8)
    buffer_load_dwordx4 a[28:31], v77, s[52:55], s85 offen offset:1024 nt
    s_add_u32 s87, s87, 7
    s_add_u32 s39, s87, s88
    s_bfe_u32 s37, s39, 0x30000
    s_lshl_b32 s37, s37, 12
    s_add_u32 s85, s37, s89
    s_bfe_u32 s37, s39, 0x10003
    s_lshl_b32 s37, s37, 11
    s_add_u32 s85, s37, s85
    s_bfe_u32 s37, s39, 0x40004
    s_lshl_b32 s37, s37, 16
    s_add_u32 s85, s37, s85
    s_waitcnt vmcnt(6)
L_qcheck_10:
    v_xor_b32 v68, s35, v68
    v_xor_b32 v69, s35, v69
    v_xor_b32 v70, s35, v70
    v_xor_b32 v71, s35, v71
    v_xor_b32 v72, s35, v72
    v_xor_b32 v73, s35, v73
    v_xor_b32 v74, s35, v74
    v_xor_b32 v75, s35, v75
    v_or_b32 v4, v68, v69
    v_or3_b32 v4, v4, v70, v71
    v_or3_b32 v4, v4, v72, v73
    v_or3_b32 v4, v4, v74, v75
    v_and_b32 v4, 0xff, v4
    v_cmp_ne_u32 vcc, 0, v4
    s_cbranch_vccz L_qok_11
    buffer_load_dwordx4 v[68:71], v78, s[48:51], s91 offen offset:0 sc1
    buffer_load_dwordx4 v[72:75], v78, s[48:51], s91 offen offset:16 sc1
    s_waitcnt vmcnt(0)
    s_sub_u32 s84, s84, 1
    s_cmp_lg_u32 s84, 0
    s_cbranch_scc1 L_qcheck_10
    s_branch L_end
L_qok_11:
    v_cvt_pk_bf16_f32 v68, v68, v69
    v_cvt_pk_bf16_f32 v69, v70, v71
    v_cvt_pk_bf16_f32 v70, v72, v73
    v_cvt_pk_bf16_f32 v71, v74, v75
    s_mov_b32 vcc_lo, 0xf000f
    s_mov_b32 vcc_hi, 0xf000f
    v_cndmask_b32 v80, 0, v68, vcc
    v_cndmask_b32 v81, 0, v69, vcc
    v_cndmask_b32 v82, 0, v70, vcc
    v_cndmask_b32 v83, 0, v71, vcc
    s_mov_b32 vcc_lo, 0xf000f0
    s_mov_b32 vcc_hi, 0xf000f0
    v_cndmask_b32 v84, 0, v68, vcc
    v_cndmask_b32 v85, 0, v69, vcc
    v_cndmask_b32 v86, 0, v70, vcc
    v_cndmask_b32 v87, 0, v71, vcc
    s_mov_b32 vcc_lo, 0xf000f00
    s_mov_b32 vcc_hi, 0xf000f00
    v_cndmask_b32 v88, 0, v68, vcc
    v_cndmask_b32 v89, 0, v69, vcc
    v_cndmask_b32 v90, 0, v70, vcc
    v_cndmask_b32 v91, 0, v71, vcc
    s_mov_b32 vcc_lo, 0xf000f000
    s_mov_b32 vcc_hi, 0xf000f000
    v_cndmask_b32 v92, 0, v68, vcc
    v_cndmask_b32 v93, 0, v69, vcc
    v_cndmask_b32 v94, 0, v70, vcc
    v_cndmask_b32 v95, 0, v71, vcc
    v_mov_b32 v65, 0xff7f0000
    s_lshl_b32 s38, s34, 14
    s_add_u32 s38, s38, 16384
    v_lshl_add_u32 v64, v1, 2, s38
    buffer_load_dwordx4 a[32:35], v76, s[52:55], s85 offen offset:0 nt
    v_mfma_f32_16x16x32_bf16 v[112:115], v[128:131], v[80:83], 0
    v_mfma_f32_16x16x32_bf16 v[112:115], v[132:135], v[84:87], v[112:115]
    v_mfma_f32_16x16x32_bf16 v[112:115], v[136:139], v[88:91], v[112:115]
    s_waitcnt vmcnt(6)
    buffer_load_dwordx4 a[36:39], v77, s[52:55], s85 offen offset:0 nt
    v_mfma_f32_16x16x32_bf16 v[112:115], v[140:143], v[92:95], v[112:115]
    v_mfma_f32_16x16x32_bf16 v[96:99], v[144:147], v[80:83], 0
    v_mfma_f32_16x16x32_bf16 v[96:99], v[148:151], v[84:87], v[96:99]
    s_waitcnt vmcnt(6)
    buffer_load_dwordx4 a[40:43], v76, s[52:55], s85 offen offset:1024 nt
    v_mfma_f32_16x16x32_bf16 v[96:99], v[152:155], v[88:91], v[96:99]
    s_nop 2
    v_mov_b32_dpp v122, v112 quad_perm:[0,0,0,0] row_mask:0xf bank_mask:0xf
    v_mov_b32_dpp v124, v114 quad_perm:[2,2,2,2] row_mask:0xf bank_mask:0xf
    s_nop 0
    v_add_f32_dpp v122, v113, v122 quad_perm:[1,1,1,1] row_mask:0xf bank_mask:0xf
    v_add_f32_dpp v124, v115, v124 quad_perm:[3,3,3,3] row_mask:0xf bank_mask:0xf
    v_add_f32 v122, v122, v124
    v_max_f32 v65, v65, v122
    ds_write_b32 v64, v122 offset:0
    v_mfma_f32_16x16x32_bf16 v[96:99], v[156:159], v[92:95], v[96:99]
    v_mfma_f32_16x16x32_bf16 v[112:115], v[160:163], v[80:83], 0
    v_mfma_f32_16x16x32_bf16 v[112:115], v[164:167], v[84:87], v[112:115]
    s_waitcnt vmcnt(6)
    buffer_load_dwordx4 a[44:47], v77, s[52:55], s85 offen offset:1024 nt
    s_add_u32 s87, s87, 7
    s_add_u32 s39, s87, s88
    s_bfe_u32 s37, s39, 0x30000
    s_lshl_b32 s37, s37, 12
    s_add_u32 s85, s37, s89
    s_bfe_u32 s37, s39, 0x10003
    s_lshl_b32 s37, s37, 11
    s_add_u32 s85, s37, s85
    s_bfe_u32 s37, s39, 0x40004
    s_lshl_b32 s37, s37, 16
    s_add_u32 s85, s37, s85
    v_mfma_f32_16x16x32_bf16 v[112:115], v[168:171], v[88:91], v[112:115]
    v_mov_b32_dpp v122, v96 quad_perm:[0,0,0,0] row_mask:0xf bank_mask:0xf
    v_mov_b32_dpp v124, v98 quad_perm:[2,2,2,2] row_mask:0xf bank_mask:0xf
    s_nop 0
    v_add_f32_dpp v122, v97, v122 quad_perm:[1,1,1,1] row_mask:0xf bank_mask:0xf
    v_add_f32_dpp v124, v99, v124 quad_perm:[3,3,3,3] row_mask:0xf bank_mask:0xf
    v_add_f32 v122, v122, v124
    v_max_f32 v65, v65, v122
    ds_write_b32 v64, v122 offset:256
    v_mfma_f32_16x16x32_bf16 v[112:115], v[172:175], v[92:95], v[112:115]
    v_mfma_f32_16x16x32_bf16 v[96:99], v[176:179], v[80:83], 0
    s_waitcnt vmcnt(6)
    buffer_load_dwordx4 a[48:51], v76, s[52:55], s85 offen offset:0 nt
    v_mfma_f32_16x16x32_bf16 v[96:99], v[180:183], v[84:87], v[96:99]
    v_mfma_f32_16x16x32_bf16 v[96:99], v[184:187], v[88:91], v[96:99]
    s_nop 2
    v_mov_b32_dpp v122, v112 quad_perm:[0,0,0,0] row_mask:0xf bank_mask:0xf
    v_mov_b32_dpp v124, v114 quad_perm:[2,2,2,2] row_mask:0xf bank_mask:0xf
    s_nop 0
    v_add_f32_dpp v122, v113, v122 quad_perm:[1,1,1,1] row_mask:0xf bank_mask:0xf
    v_add_f32_dpp v124, v115, v124 quad_perm:[3,3,3,3] row_mask:0xf bank_mask:0xf
    v_add_f32 v122, v122, v124
    v_max_f32 v65, v65, v122
    ds_write_b32 v64, v122 offset:512
    v_mfma_f32_16x16x32_bf16 v[96:99], v[188:191], v[92:95], v[96:99]
    v_mfma_f32_16x16x32_bf16 v[112:115], v[192:195], v[80:83], 0
    s_waitcnt vmcnt(6)
    buffer_load_dwordx4 a[52:55], v77, s[52:55], s85 offen offset:0 nt
    v_mfma_f32_16x16x32_bf16 v[112:115], v[196:199], v[84:87], v[112:115]
    v_mfma_f32_16x16x32_bf16 v[112:115], v[200:203], v[88:91], v[112:115]
    s_nop 2
    v_mov_b32_dpp v122, v96 quad_perm:[0,0,0,0] row_mask:0xf bank_mask:0xf
    v_mov_b32_dpp v124, v98 quad_perm:[2,2,2,2] row_mask:0xf bank_mask:0xf
    s_nop 0
    v_add_f32_dpp v122, v97, v122 quad_perm:[1,1,1,1] row_mask:0xf bank_mask:0xf
    v_add_f32_dpp v124, v99, v124 quad_perm:[3,3,3,3] row_mask:0xf bank_mask:0xf
    v_add_f32 v122, v122, v124
    v_max_f32 v65, v65, v122
    ds_write_b32 v64, v122 offset:768
    v_mfma_f32_16x16x32_bf16 v[112:115], v[204:207], v[92:95], v[112:115]
    s_waitcnt vmcnt(6)
    buffer_load_dwordx4 a[56:59], v76, s[52:55], s85 offen offset:1024 nt
    v_mfma_f32_16x16x32_bf16 v[96:99], v[208:211], v[80:83], 0
    v_mfma_f32_16x16x32_bf16 v[96:99], v[212:215], v[84:87], v[96:99]
    v_mfma_f32_16x16x32_bf16 v[96:99], v[216:219], v[88:91], v[96:99]
    s_nop 2
    v_mov_b32_dpp v122, v112 quad_perm:[0,0,0,0] row_mask:0xf bank_mask:0xf
    v_mov_b32_dpp v124, v114 quad_perm:[2,2,2,2] row_mask:0xf bank_mask:0xf
    s_nop 0
    v_add_f32_dpp v122, v113, v122 quad_perm:[1,1,1,1] row_mask:0xf bank_mask:0xf
    v_add_f32_dpp v124, v115, v124 quad_perm:[3,3,3,3] row_mask:0xf bank_mask:0xf
    v_add_f32 v122, v122, v124
    v_max_f32 v65, v65, v122
    ds_write_b32 v64, v122 offset:1024
    v_mfma_f32_16x16x32_bf16 v[96:99], v[220:223], v[92:95], v[96:99]
    s_waitcnt vmcnt(6)
    buffer_load_dwordx4 a[60:63], v77, s[52:55], s85 offen offset:1024 nt
    s_add_u32 s87, s87, 7
    s_add_u32 s39, s87, s88
    s_bfe_u32 s37, s39, 0x30000
    s_lshl_b32 s37, s37, 12
    s_add_u32 s85, s37, s89
    s_bfe_u32 s37, s39, 0x10003
    s_lshl_b32 s37, s37, 11
    s_add_u32 s85, s37, s85
    s_bfe_u32 s37, s39, 0x40004
    s_lshl_b32 s37, s37, 16
    s_add_u32 s85, s37, s85
    v_mfma_f32_16x16x32_bf16 v[112:115], v[224:227], v[80:83], 0
    v_mfma_f32_16x16x32_bf16 v[112:115], v[228:231], v[84:87], v[112:115]
    v_mfma_f32_16x16x32_bf16 v[112:115], v[232:235], v[88:91], v[112:115]
    v_mov_b32_dpp v122, v96 quad_perm:[0,0,0,0] row_mask:0xf bank_mask:0xf
    v_mov_b32_dpp v124, v98 quad_perm:[2,2,2,2] row_mask:0xf bank_mask:0xf
    s_nop 0
    v_add_f32_dpp v122, v97, v122 quad_perm:[1,1,1,1] row_mask:0xf bank_mask:0xf
    v_add_f32_dpp v124, v99, v124 quad_perm:[3,3,3,3] row_mask:0xf bank_mask:0xf
    v_add_f32 v122, v122, v124
    v_max_f32 v65, v65, v122
    ds_write_b32 v64, v122 offset:1280
    s_waitcnt vmcnt(5)
    buffer_load_dwordx4 v[128:131], v76, s[52:55], s85 offen offset:0 nt
    v_mfma_f32_16x16x32_bf16 v[112:115], v[236:239], v[92:95], v[112:115]
    v_mfma_f32_16x16x32_bf16 v[96:99], v[240:243], v[80:83], 0
    v_mfma_f32_16x16x32_bf16 v[96:99], v[244:247], v[84:87], v[96:99]
    s_waitcnt vmcnt(5)
    buffer_load_dwordx4 v[132:135], v77, s[52:55], s85 offen offset:0 nt
    v_mfma_f32_16x16x32_bf16 v[96:99], v[248:251], v[88:91], v[96:99]
    s_nop 2
    v_mov_b32_dpp v122, v112 quad_perm:[0,0,0,0] row_mask:0xf bank_mask:0xf
    v_mov_b32_dpp v124, v114 quad_perm:[2,2,2,2] row_mask:0xf bank_mask:0xf
    s_nop 0
    v_add_f32_dpp v122, v113, v122 quad_perm:[1,1,1,1] row_mask:0xf bank_mask:0xf
    v_add_f32_dpp v124, v115, v124 quad_perm:[3,3,3,3] row_mask:0xf bank_mask:0xf
    v_add_f32 v122, v122, v124
    v_max_f32 v65, v65, v122
    ds_write_b32 v64, v122 offset:1536
    v_mfma_f32_16x16x32_bf16 v[96:99], v[252:255], v[92:95], v[96:99]
    v_mfma_f32_16x16x32_bf16 v[112:115], a[0:3], v[80:83], 0
    v_mfma_f32_16x16x32_bf16 v[112:115], a[4:7], v[84:87], v[112:115]
    s_waitcnt vmcnt(5)
    buffer_load_dwordx4 v[136:139], v76, s[52:55], s85 offen offset:1024 nt
    v_mfma_f32_16x16x32_bf16 v[112:115], a[8:11], v[88:91], v[112:115]
    s_nop 2
    v_mov_b32_dpp v122, v96 quad_perm:[0,0,0,0] row_mask:0xf bank_mask:0xf
    v_mov_b32_dpp v124, v98 quad_perm:[2,2,2,2] row_mask:0xf bank_mask:0xf
    s_nop 0
    v_add_f32_dpp v122, v97, v122 quad_perm:[1,1,1,1] row_mask:0xf bank_mask:0xf
    v_add_f32_dpp v124, v99, v124 quad_perm:[3,3,3,3] row_mask:0xf bank_mask:0xf
    v_add_f32 v122, v122, v124
    v_max_f32 v65, v65, v122
    ds_write_b32 v64, v122 offset:1792
    v_mfma_f32_16x16x32_bf16 v[112:115], a[12:15], v[92:95], v[112:115]
    v_mfma_f32_16x16x32_bf16 v[96:99], a[16:19], v[80:83], 0
    s_waitcnt vmcnt(5)
    buffer_load_dwordx4 v[140:143], v77, s[52:55], s85 offen offset:1024 nt
    s_add_u32 s87, s87, 7
    s_add_u32 s39, s87, s88
    s_bfe_u32 s37, s39, 0x30000
    s_lshl_b32 s37, s37, 12
    s_add_u32 s85, s37, s89
    s_bfe_u32 s37, s39, 0x10003
    s_lshl_b32 s37, s37, 11
    s_add_u32 s85, s37, s85
    s_bfe_u32 s37, s39, 0x40004
    s_lshl_b32 s37, s37, 16
    s_add_u32 s85, s37, s85
    v_mfma_f32_16x16x32_bf16 v[96:99], a[20:23], v[84:87], v[96:99]
    v_mfma_f32_16x16x32_bf16 v[96:99], a[24:27], v[88:91], v[96:99]
    v_mov_b32_dpp v122, v112 quad_perm:[0,0,0,0] row_mask:0xf bank_mask:0xf
    v_mov_b32_dpp v124, v114 quad_perm:[2,2,2,2] row_mask:0xf bank_mask:0xf
    s_nop 0
    v_add_f32_dpp v122, v113, v122 quad_perm:[1,1,1,1] row_mask:0xf bank_mask:0xf
    v_add_f32_dpp v124, v115, v124 quad_perm:[3,3,3,3] row_mask:0xf bank_mask:0xf
    v_add_f32 v122, v122, v124
    v_max_f32 v65, v65, v122
    ds_write_b32 v64, v122 offset:2048
    v_mfma_f32_16x16x32_bf16 v[96:99], a[28:31], v[92:95], v[96:99]
    v_mfma_f32_16x16x32_bf16 v[112:115], a[32:35], v[80:83], 0
    s_waitcnt vmcnt(5)
    buffer_load_dwordx4 v[144:147], v76, s[52:55], s85 offen offset:0 nt
    v_mfma_f32_16x16x32_bf16 v[112:115], a[36:39], v[84:87], v[112:115]
    v_mfma_f32_16x16x32_bf16 v[112:115], a[40:43], v[88:91], v[112:115]
    s_nop 2
    v_mov_b32_dpp v122, v96 quad_perm:[0,0,0,0] row_mask:0xf bank_mask:0xf
    v_mov_b32_dpp v124, v98 quad_perm:[2,2,2,2] row_mask:0xf bank_mask:0xf
    s_nop 0
    v_add_f32_dpp v122, v97, v122 quad_perm:[1,1,1,1] row_mask:0xf bank_mask:0xf
    v_add_f32_dpp v124, v99, v124 quad_perm:[3,3,3,3] row_mask:0xf bank_mask:0xf
    v_add_f32 v122, v122, v124
    v_max_f32 v65, v65, v122
    ds_write_b32 v64, v122 offset:2304
    v_mfma_f32_16x16x32_bf16 v[112:115], a[44:47], v[92:95], v[112:115]
    s_waitcnt vmcnt(5)
    buffer_load_dwordx4 v[148:151], v77, s[52:55], s85 offen offset:0 nt
    v_mfma_f32_16x16x32_bf16 v[96:99], a[48:51], v[80:83], 0
    v_mfma_f32_16x16x32_bf16 v[96:99], a[52:55], v[84:87], v[96:99]
    v_mfma_f32_16x16x32_bf16 v[96:99], a[56:59], v[88:91], v[96:99]
    s_nop 2
    v_mov_b32_dpp v122, v112 quad_perm:[0,0,0,0] row_mask:0xf bank_mask:0xf
    v_mov_b32_dpp v124, v114 quad_perm:[2,2,2,2] row_mask:0xf bank_mask:0xf
    s_nop 0
    v_add_f32_dpp v122, v113, v122 quad_perm:[1,1,1,1] row_mask:0xf bank_mask:0xf
    v_add_f32_dpp v124, v115, v124 quad_perm:[3,3,3,3] row_mask:0xf bank_mask:0xf
    v_add_f32 v122, v122, v124
    v_max_f32 v65, v65, v122
    ds_write_b32 v64, v122 offset:2560
    v_mfma_f32_16x16x32_bf16 v[96:99], a[60:63], v[92:95], v[96:99]
    v_add_u32 v64, 2816, v64
    s_mov_b32 s97, 10
    s_mov_b32 s86, 32
    s_add_u32 s92, s33, 224
    s_mov_b32 s66, 134217728
    s_mov_b32 s67, 0x20000
    s_mov_b64 s[64:65], s[52:53]
    v_mov_b32 v62, v76
    v_mov_b32 v63, v77
    s_branch L_bloop
L_ql:
    v_lshrrev_b32 v4, 2, v3
    v_and_b32 v5, 3, v3
    v_lshlrev_b32 v19, 6, v2
    v_lshl_add_u32 v19, v5, 4, v19
    v_lshl_add_u32 v14, v4, 18, v19
    s_lshl_b32 s63, s34, 20
    s_lshl_b32 s38, s32, 8
    s_add_u32 s63, s63, s38
    s_mov_b32 s74, 4194304
    s_mov_b32 s75, 0x20000
    s_waitcnt lgkmcnt(0)
    s_mov_b64 s[72:73], s[10:11]
    buffer_load_dwordx4 a[128:131], v14, s[72:75], s63 offen nt
    s_add_u32 s63, s63, 8192
    buffer_load_dwordx4 a[132:135], v14, s[72:75], s63 offen nt
    s_add_u32 s63, s63, 8192
    buffer_load_dwordx4 a[136:139], v14, s[72:75], s63 offen nt
    s_add_u32 s63, s63, 8192
    buffer_load_dwordx4 a[140:143], v14, s[72:75], s63 offen nt
    s_add_u32 s63, s63, 8192
    buffer_load_dwordx4 a[144:147], v14, s[72:75], s63 offen nt
    s_add_u32 s63, s63, 8192
    buffer_load_dwordx4 a[148:151], v14, s[72:75], s63 offen nt
    s_add_u32 s63, s63, 8192
    buffer_load_dwordx4 a[152:155], v14, s[72:75], s63 offen nt
    s_add_u32 s63, s63, 8192
    buffer_load_dwordx4 a[156:159], v14, s[72:75], s63 offen nt
    s_add_u32 s63, s63, 8192
    v_lshlrev_b32 v15, 1, v19
    v_lshl_add_u32 v15, v4, 9, v15
    v_bfe_u32 v4, v3, 2, 1
    v_lshl_add_u32 v19, v4, 17, v19
    v_lshrrev_b32 v4, 3, v3
    v_lshl_add_u32 v19, v4, 13, v19
    s_load_dword s35, s[30:31], 0
    s_mov_b32 s48, s30
    s_and_b32 s49, s31, 0xffff
    s_mov_b32 s50, 16777216
    s_mov_b32 s51, 0x20000
    s_mov_b32 s82, 0xffffff00
    s_mov_b32 s83, 0x3e0293ee
    s_mov_b32 s84, 2097152
    s_lshr_b32 s38, s32, 1
    s_lshl_b32 s38, s38, 17
    s_add_u32 s95, s38, 2164736
    s_bfe_u32 s38, s32, 0x10000
    s_lshl_b32 s38, s38, 13
    s_add_u32 s95, s38, s95
    s_lshr_b32 s38, s32, 2
    s_lshl_b32 s38, s38, 18
    s_add_u32 s94, s38, 2179072
    s_bfe_u32 s38, s32, 0x20000
    s_lshl_b32 s38, s38, 10
    s_add_u32 s94, s38, s94
    s_lshl_b32 s38, s34, 8
    s_add_u32 s94, s38, s94
    s_waitcnt vmcnt(7)
    buffer_load_dwordx4 a[160:163], v14, s[72:75], s63 offen nt
    s_add_u32 s63, s63, 8192
    s_waitcnt vmcnt(7)
    buffer_load_dwordx4 a[164:167], v14, s[72:75], s63 offen nt
    s_add_u32 s63, s63, 8192
    s_waitcnt vmcnt(7)
    buffer_load_dwordx4 a[168:171], v14, s[72:75], s63 offen nt
    s_add_u32 s63, s63, 8192
    s_waitcnt vmcnt(7)
    buffer_load_dwordx4 a[172:175], v14, s[72:75], s63 offen nt
    s_add_u32 s63, s63, 8192
    s_waitcnt vmcnt(7)
    buffer_load_dwordx4 a[176:179], v14, s[72:75], s63 offen nt
    s_add_u32 s63, s63, 8192
    v_and_b32 v4, 1, v1
    v_lshlrev_b32 v4, 4, v4
    v_mov_b32 v5, 0xffff
    v_lshlrev_b32 v4, v4, v5
    v_bfe_u32 v5, v1, 1, 2
    v_cmp_eq_u32 vcc, 0, v5
    s_nop 1
    v_cndmask_b32 v10, 0, v4, vcc
    v_cmp_eq_u32 vcc, 1, v5
    s_nop 1
    v_cndmask_b32 v11, 0, v4, vcc
    v_cmp_eq_u32 vcc, 2, v5
    s_nop 1
    v_cndmask_b32 v12, 0, v4, vcc
    v_cmp_eq_u32 vcc, 3, v5
    s_nop 1
    v_cndmask_b32 v13, 0, v4, vcc
    s_waitcnt vmcnt(7)
    buffer_load_dwordx4 a[180:183], v14, s[72:75], s63 offen nt
    s_add_u32 s63, s63, 8192
    s_waitcnt vmcnt(7)
    buffer_load_dwordx4 a[184:187], v14, s[72:75], s63 offen nt
    s_add_u32 s63, s63, 8192
    s_waitcnt vmcnt(7)
    buffer_load_dwordx4 a[188:191], v14, s[72:75], s63 offen nt
    s_add_u32 s63, s63, 8192
    s_waitcnt vmcnt(7)
    buffer_load_dwordx4 a[192:195], v14, s[72:75], s63 offen nt
    s_add_u32 s63, s63, 8192
    v_lshrrev_b32 v4, 2, v3
    v_and_b32 v5, 3, v3
    v_lshlrev_b32 v76, 8, v4
    v_lshlrev_b32 v126, 8, v2
    v_lshl_add_u32 v76, v2, 6, v76
    v_lshl_add_u32 v76, v5, 4, v76
    v_lshl_add_u32 v126, v3, 4, v126
    v_xor_b32 v77, 32768, v76
    v_xor_b32 v127, 32768, v126
    s_add_u32 s3, s34, s33
    s_and_b32 s3, s3, 3
    s_lshl_b32 s89, s3, 5
    s_add_u32 s89, s89, s32
    s_lshl_b32 s89, s89, 20
    s_mul_i32 s88, s32, 8
    s_add_u32 s88, s88, s3
    s_add_u32 s87, s33, 0
    s_waitcnt vmcnt(7)
    buffer_load_dwordx4 a[196:199], v14, s[72:75], s63 offen nt
    s_add_u32 s63, s63, 8192
    s_waitcnt vmcnt(7)
    buffer_load_dwordx4 a[200:203], v14, s[72:75], s63 offen nt
    s_add_u32 s63, s63, 8192
    s_waitcnt vmcnt(7)
    buffer_load_dwordx4 a[204:207], v14, s[72:75], s63 offen nt
    s_add_u32 s63, s63, 8192
    s_waitcnt vmcnt(7)
    buffer_load_dwordx4 a[208:211], v14, s[72:75], s63 offen nt
    s_add_u32 s63, s63, 8192
    s_mov_b32 s52, s18
    s_and_b32 s53, s19, 0xffff
    s_mov_b32 s54, 134217728
    s_mov_b32 s55, 0x20000
    s_mov_b32 s56, s20
    s_and_b32 s57, s21, 0xffff
    s_mov_b32 s58, 134217728
    s_mov_b32 s59, 0x20000
    s_waitcnt vmcnt(7)
    buffer_load_dwordx4 a[212:215], v14, s[72:75], s63 offen nt
    s_add_u32 s63, s63, 8192
    s_waitcnt vmcnt(7)
    buffer_load_dwordx4 a[216:219], v14, s[72:75], s63 offen nt
    s_add_u32 s63, s63, 8192
    s_waitcnt vmcnt(7)
    buffer_load_dwordx4 a[220:223], v14, s[72:75], s63 offen nt
    s_add_u32 s63, s63, 8192
    s_waitcnt vmcnt(7)
    buffer_load_dwordx4 a[224:227], v14, s[72:75], s63 offen nt
    s_add_u32 s63, s63, 8192
    v_mov_b32 v120, 0xff7f0000
    v_mov_b32 v121, 0
    v_mov_b32 v18, 1
    v_mov_b32 v116, 0
    v_mov_b32 v117, 0
    v_mov_b32 v118, 0
    v_mov_b32 v119, 0
    s_lshr_b32 s38, s32, 1
    s_lshl_b32 s38, s38, 17
    s_add_u32 s96, s38, 2195456
    s_bfe_u32 s38, s32, 0x10000
    s_lshl_b32 s38, s38, 13
    s_add_u32 s96, s38, s96
    s_lshl_b32 s38, s3, 8
    s_add_u32 s96, s38, s96
    v_mov_b32 v9, s96
    s_lshr_b32 s38, s32, 1
    s_lshl_b32 s38, s38, 17
    s_add_u32 s96, s38, 2097152
    s_bfe_u32 s38, s32, 0x10000
    s_lshl_b32 s38, s38, 15
    s_add_u32 s96, s38, s96
    s_lshl_b32 s38, s3, 13
    s_add_u32 s96, s38, s96
    s_lshl_b32 s38, s33, 10
    s_add_u32 s96, s38, s96
    v_and_b32 v5, 3, v3
    v_lshlrev_b32 v78, 7, v2
    v_lshl_add_u32 v78, v5, 5, v78
    s_lshr_b32 s38, s32, 1
    s_lshl_b32 s38, s38, 17
    s_add_u32 s91, s38, 2162688
    s_bfe_u32 s38, s32, 0x10000
    s_lshl_b32 s38, s38, 13
    s_add_u32 s91, s38, s91
    s_lshl_b32 s38, s3, 9
    s_add_u32 s91, s38, s91
    v_lshlrev_b32 v4, 7, v2
    v_lshl_add_u32 v4, v3, 4, v4
    v_mov_b32 v5, 512
    v_cmp_gt_u32 vcc, 8, v3
    s_nop 1
    v_cndmask_b32 v79, v5, v4, vcc
    s_waitcnt vmcnt(7)
    buffer_load_dwordx4 a[228:231], v14, s[72:75], s63 offen nt
    s_add_u32 s63, s63, 8192
    s_waitcnt vmcnt(7)
    buffer_load_dwordx4 a[232:235], v14, s[72:75], s63 offen nt
    s_add_u32 s63, s63, 8192
    s_waitcnt vmcnt(7)
    buffer_load_dwordx4 a[236:239], v14, s[72:75], s63 offen nt
    s_add_u32 s63, s63, 8192
    s_waitcnt vmcnt(7)
    buffer_load_dwordx4 a[240:243], v14, s[72:75], s63 offen nt
    s_add_u32 s63, s63, 8192
    s_waitcnt vmcnt(7)
    buffer_load_dwordx4 a[244:247], v14, s[72:75], s63 offen nt
    s_add_u32 s63, s63, 8192
    s_waitcnt vmcnt(7)
    buffer_load_dwordx4 a[248:251], v14, s[72:75], s63 offen nt
    s_add_u32 s63, s63, 8192
    s_waitcnt vmcnt(7)
    buffer_load_dwordx4 a[252:255], v14, s[72:75], s63 offen nt
    s_add_u32 s63, s63, 8192
    s_waitcnt lgkmcnt(0)
    s_add_u32 s35, s35, 0x5b
    s_and_b32 s35, s35, 0xff
    v_mov_b32 v8, s35
    s_or_b32 s68, s35, 0x6b3ac500
    s_waitcnt vmcnt(6)
    s_add_u32 s39, s87, s88
    s_bfe_u32 s37, s39, 0x30000
    s_lshl_b32 s37, s37, 12
    s_add_u32 s85, s37, s89
    s_bfe_u32 s37, s39, 0x10003
    s_lshl_b32 s37, s37, 11
    s_add_u32 s85, s37, s85
    s_bfe_u32 s37, s39, 0x40004
    s_lshl_b32 s37, s37, 16
    s_add_u32 s85, s37, s85
    buffer_load_dwordx4 v[128:131], v76, s[52:55], s85 offen offset:0 nt
    s_waitcnt vmcnt(6)
    buffer_load_dwordx4 v[132:135], v77, s[52:55], s85 offen offset:0 nt
    s_waitcnt vmcnt(6)
    buffer_load_dwordx4 v[136:139], v76, s[52:55], s85 offen offset:1024 nt
    s_waitcnt vmcnt(6)
    buffer_load_dwordx4 v[140:143], v77, s[52:55], s85 offen offset:1024 nt
    s_add_u32 s87, s87, 7
    s_add_u32 s39, s87, s88
    s_bfe_u32 s37, s39, 0x30000
    s_lshl_b32 s37, s37, 12
    s_add_u32 s85, s37, s89
    s_bfe_u32 s37, s39, 0x10003
    s_lshl_b32 s37, s37, 11
    s_add_u32 s85, s37, s85
    s_bfe_u32 s37, s39, 0x40004
    s_lshl_b32 s37, s37, 16
    s_add_u32 s85, s37, s85
    s_waitcnt vmcnt(6)
    buffer_load_dwordx4 v[144:147], v76, s[52:55], s85 offen offset:0 nt
    s_waitcnt vmcnt(6)
    buffer_load_dwordx4 v[148:151], v77, s[52:55], s85 offen offset:0 nt
    s_waitcnt vmcnt(6)
    buffer_load_dwordx4 v[152:155], v76, s[52:55], s85 offen offset:1024 nt
    s_waitcnt vmcnt(6)
    buffer_load_dwordx4 v[156:159], v77, s[52:55], s85 offen offset:1024 nt
    s_add_u32 s87, s87, 7
    s_add_u32 s39, s87, s88
    s_bfe_u32 s37, s39, 0x30000
    s_lshl_b32 s37, s37, 12
    s_add_u32 s85, s37, s89
    s_bfe_u32 s37, s39, 0x10003
    s_lshl_b32 s37, s37, 11
    s_add_u32 s85, s37, s85
    s_bfe_u32 s37, s39, 0x40004
    s_lshl_b32 s37, s37, 16
    s_add_u32 s85, s37, s85
    s_waitcnt vmcnt(6)
    buffer_load_dwordx4 v[160:163], v76, s[52:55], s85 offen offset:0 nt
    s_waitcnt vmcnt(6)
    buffer_load_dwordx4 v[164:167], v77, s[52:55], s85 offen offset:0 nt
    s_waitcnt vmcnt(6)
    buffer_load_dwordx4 v[168:171], v76, s[52:55], s85 offen offset:1024 nt
    s_waitcnt vmcnt(6)
    buffer_load_dwordx4 v[172:175], v77, s[52:55], s85 offen offset:1024 nt
    s_add_u32 s87, s87, 7
    s_add_u32 s39, s87, s88
    s_bfe_u32 s37, s39, 0x30000
    s_lshl_b32 s37, s37, 12
    s_add_u32 s85, s37, s89
    s_bfe_u32 s37, s39, 0x10003
    s_lshl_b32 s37, s37, 11
    s_add_u32 s85, s37, s85
    s_bfe_u32 s37, s39, 0x40004
    s_lshl_b32 s37, s37, 16
    s_add_u32 s85, s37, s85
    s_waitcnt vmcnt(6)
    buffer_load_dwordx4 v[176:179], v76, s[52:55], s85 offen offset:0 nt
    s_waitcnt vmcnt(6)
    buffer_load_dwordx4 v[180:183], v77, s[52:55], s85 offen offset:0 nt
    s_waitcnt vmcnt(6)
    buffer_load_dwordx4 v[184:187], v76, s[52:55], s85 offen offset:1024 nt
    s_waitcnt vmcnt(6)
    buffer_load_dwordx4 v[188:191], v77, s[52:55], s85 offen offset:1024 nt
    s_add_u32 s87, s87, 7
    s_add_u32 s39, s87, s88
    s_bfe_u32 s37, s39, 0x30000
    s_lshl_b32 s37, s37, 12
    s_add_u32 s85, s37, s89
    s_bfe_u32 s37, s39, 0x10003
    s_lshl_b32 s37, s37, 11
    s_add_u32 s85, s37, s85
    s_bfe_u32 s37, s39, 0x40004
    s_lshl_b32 s37, s37, 16
    s_add_u32 s85, s37, s85
    s_waitcnt vmcnt(6)
    buffer_load_dwordx4 v[192:195], v76, s[52:55], s85 offen offset:0 nt
    s_waitcnt vmcnt(6)
    buffer_load_dwordx4 v[196:199], v77, s[52:55], s85 offen offset:0 nt
    s_waitcnt vmcnt(6)
    buffer_load_dwordx4 v[200:203], v76, s[52:55], s85 offen offset:1024 nt
    s_waitcnt vmcnt(6)
    buffer_load_dwordx4 v[204:207], v77, s[52:55], s85 offen offset:1024 nt
    s_add_u32 s87, s87, 7
    s_add_u32 s39, s87, s88
    s_bfe_u32 s37, s39, 0x30000
    s_lshl_b32 s37, s37, 12
    s_add_u32 s85, s37, s89
    s_bfe_u32 s37, s39, 0x10003
    s_lshl_b32 s37, s37, 11
    s_add_u32 s85, s37, s85
    s_bfe_u32 s37, s39, 0x40004
    s_lshl_b32 s37, s37, 16
    s_add_u32 s85, s37, s85
    s_waitcnt vmcnt(6)
    buffer_load_dwordx4 v[208:211], v76, s[52:55], s85 offen offset:0 nt
    s_waitcnt vmcnt(6)
    buffer_load_dwordx4 v[212:215], v77, s[52:55], s85 offen offset:0 nt
    s_waitcnt vmcnt(6)
    buffer_load_dwordx4 v[216:219], v76, s[52:55], s85 offen offset:1024 nt
    s_waitcnt vmcnt(6)
    buffer_load_dwordx4 v[220:223], v77, s[52:55], s85 offen offset:1024 nt
    s_add_u32 s87, s87, 7
    s_add_u32 s39, s87, s88
    s_bfe_u32 s37, s39, 0x30000
    s_lshl_b32 s37, s37, 12
    s_add_u32 s85, s37, s89
    s_bfe_u32 s37, s39, 0x10003
    s_lshl_b32 s37, s37, 11
    s_add_u32 s85, s37, s85
    s_bfe_u32 s37, s39, 0x40004
    s_lshl_b32 s37, s37, 16
    s_add_u32 s85, s37, s85
    buffer_load_dwordx4 v[20:23], v15, s[48:51], s95 offen offset:0 sc1
    buffer_load_dwordx4 v[24:27], v15, s[48:51], s95 offen offset:16 sc1
    s_waitcnt vmcnt(8)
    buffer_load_dwordx4 v[224:227], v76, s[52:55], s85 offen offset:0 nt
    s_waitcnt vmcnt(8)
    buffer_load_dwordx4 v[228:231], v77, s[52:55], s85 offen offset:0 nt
    s_waitcnt vmcnt(8)
    buffer_load_dwordx4 v[232:235], v76, s[52:55], s85 offen offset:1024 nt
    s_waitcnt vmcnt(8)
    buffer_load_dwordx4 v[236:239], v77, s[52:55], s85 offen offset:1024 nt
    s_add_u32 s87, s87, 7
    s_add_u32 s39, s87, s88
    s_bfe_u32 s37, s39, 0x30000
    s_lshl_b32 s37, s37, 12
    s_add_u32 s85, s37, s89
    s_bfe_u32 s37, s39, 0x10003
    s_lshl_b32 s37, s37, 11
    s_add_u32 s85, s37, s85
    s_bfe_u32 s37, s39, 0x40004
    s_lshl_b32 s37, s37, 16
    s_add_u32 s85, s37, s85
    s_waitcnt vmcnt(8)
    buffer_load_dwordx4 v[240:243], v76, s[52:55], s85 offen offset:0 nt
    s_waitcnt vmcnt(8)
    buffer_load_dwordx4 v[244:247], v77, s[52:55], s85 offen offset:0 nt
    s_waitcnt vmcnt(6)
L_qacheck_12:
    v_xor_b32 v20, s35, v20
    v_xor_b32 v21, s35, v21
    v_xor_b32 v22, s35, v22
    v_xor_b32 v23, s35, v23
    v_xor_b32 v24, s35, v24
    v_xor_b32 v25, s35, v25
    v_xor_b32 v26, s35, v26
    v_xor_b32 v27, s35, v27
    v_or_b32 v4, v20, v21
    v_or3_b32 v4, v4, v22, v23
    v_or3_b32 v4, v4, v24, v25
    v_or3_b32 v4, v4, v26, v27
    v_and_b32 v4, 0xff, v4
    v_cmp_ne_u32 vcc, 0, v4
    s_cbranch_vccz L_qaok_13
    buffer_load_dwordx4 v[20:23], v15, s[48:51], s95 offen offset:0 sc1
    buffer_load_dwordx4 v[24:27], v15, s[48:51], s95 offen offset:16 sc1
    s_waitcnt vmcnt(0)
    s_sub_u32 s84, s84, 1
    s_cmp_lg_u32 s84, 0
    s_cbranch_scc1 L_qacheck_12
    s_branch L_end
L_qaok_13:
    buffer_load_dwordx4 v[68:71], v78, s[48:51], s91 offen offset:0 sc1
    buffer_load_dwordx4 v[72:75], v78, s[48:51], s91 offen offset:16 sc1
    v_cvt_pk_bf16_f32 v20, v20, v21
    v_cvt_pk_bf16_f32 v21, v22, v23
    v_cvt_pk_bf16_f32 v22, v24, v25
    v_cvt_pk_bf16_f32 v23, v26, v27
    s_nop 1
    v_mfma_f32_16x16x32_bf16 v[28:31], a[128:131], v[20:23], 0
    v_mfma_f32_16x16x32_bf16 v[32:35], a[132:135], v[20:23], 0
    v_mfma_f32_16x16x32_bf16 v[36:39], a[136:139], v[20:23], 0
    s_nop 5
    v_mov_b32_dpp v60, v28 quad_perm:[0,0,0,0] row_mask:0xf bank_mask:0xf
    v_mov_b32_dpp v4, v30 quad_perm:[2,2,2,2] row_mask:0xf bank_mask:0xf
    s_nop 0
    v_add_f32_dpp v60, v29, v60 quad_perm:[1,1,1,1] row_mask:0xf bank_mask:0xf
    v_add_f32_dpp v4, v31, v4 quad_perm:[3,3,3,3] row_mask:0xf bank_mask:0xf
    v_add_f32 v60, v60, v4
    v_mfma_f32_16x16x32_bf16 v[40:43], a[140:143], v[20:23], 0
    v_mov_b32_dpp v61, v32 quad_perm:[0,0,0,0] row_mask:0xf bank_mask:0xf
    v_mov_b32_dpp v4, v34 quad_perm:[2,2,2,2] row_mask:0xf bank_mask:0xf
    s_nop 0
    v_add_f32_dpp v61, v33, v61 quad_perm:[1,1,1,1] row_mask:0xf bank_mask:0xf
    v_add_f32_dpp v4, v35, v4 quad_perm:[3,3,3,3] row_mask:0xf bank_mask:0xf
    v_add_f32 v61, v61, v4
    v_cvt_pk_bf16_f32 v44, v60, v61
    v_mfma_f32_16x16x32_bf16 v[28:31], a[144:147], v[20:23], 0
    v_mov_b32_dpp v60, v36 quad_perm:[0,0,0,0] row_mask:0xf bank_mask:0xf
    v_mov_b32_dpp v4, v38 quad_perm:[2,2,2,2] row_mask:0xf bank_mask:0xf
    s_nop 0
    v_add_f32_dpp v60, v37, v60 quad_perm:[1,1,1,1] row_mask:0xf bank_mask:0xf
    v_add_f32_dpp v4, v39, v4 quad_perm:[3,3,3,3] row_mask:0xf bank_mask:0xf
    v_add_f32 v60, v60, v4
    buffer_load_dwordx4 v[248:251], v76, s[52:55], s85 offen offset:1024 nt
    v_mfma_f32_16x16x32_bf16 v[32:35], a[148:151], v[20:23], 0
    v_mov_b32_dpp v61, v40 quad_perm:[0,0,0,0] row_mask:0xf bank_mask:0xf
    v_mov_b32_dpp v4, v42 quad_perm:[2,2,2,2] row_mask:0xf bank_mask:0xf
    s_nop 0
    v_add_f32_dpp v61, v41, v61 quad_perm:[1,1,1,1] row_mask:0xf bank_mask:0xf
    v_add_f32_dpp v4, v43, v4 quad_perm:[3,3,3,3] row_mask:0xf bank_mask:0xf
    v_add_f32 v61, v61, v4
    v_cvt_pk_bf16_f32 v45, v60, v61
    v_mfma_f32_16x16x32_bf16 v[36:39], a[152:155], v[20:23], 0
    v_mov_b32_dpp v60, v28 quad_perm:[0,0,0,0] row_mask:0xf bank_mask:0xf
    v_mov_b32_dpp v4, v30 quad_perm:[2,2,2,2] row_mask:0xf bank_mask:0xf
    s_nop 0
    v_add_f32_dpp v60, v29, v60 quad_perm:[1,1,1,1] row_mask:0xf bank_mask:0xf
    v_add_f32_dpp v4, v31, v4 quad_perm:[3,3,3,3] row_mask:0xf bank_mask:0xf
    v_add_f32 v60, v60, v4
    v_mfma_f32_16x16x32_bf16 v[40:43], a[156:159], v[20:23], 0
    v_mov_b32_dpp v61, v32 quad_perm:[0,0,0,0] row_mask:0xf bank_mask:0xf
    v_mov_b32_dpp v4, v34 quad_perm:[2,2,2,2] row_mask:0xf bank_mask:0xf
    s_nop 0
    v_add_f32_dpp v61, v33, v61 quad_perm:[1,1,1,1] row_mask:0xf bank_mask:0xf
    v_add_f32_dpp v4, v35, v4 quad_perm:[3,3,3,3] row_mask:0xf bank_mask:0xf
    v_add_f32 v61, v61, v4
    v_cvt_pk_bf16_f32 v46, v60, v61
    v_mfma_f32_16x16x32_bf16 v[28:31], a[160:163], v[20:23], 0
    v_mov_b32_dpp v60, v36 quad_perm:[0,0,0,0] row_mask:0xf bank_mask:0xf
    v_mov_b32_dpp v4, v38 quad_perm:[2,2,2,2] row_mask:0xf bank_mask:0xf
    s_nop 0
    v_add_f32_dpp v60, v37, v60 quad_perm:[1,1,1,1] row_mask:0xf bank_mask:0xf
    v_add_f32_dpp v4, v39, v4 quad_perm:[3,3,3,3] row_mask:0xf bank_mask:0xf
    v_add_f32 v60, v60, v4
    v_mfma_f32_16x16x32_bf16 v[32:35], a[164:167], v[20:23], 0
    v_mov_b32_dpp v61, v40 quad_perm:[0,0,0,0] row_mask:0xf bank_mask:0xf
    v_mov_b32_dpp v4, v42 quad_perm:[2,2,2,2] row_mask:0xf bank_mask:0xf
    s_nop 0
    v_add_f32_dpp v61, v41, v61 quad_perm:[1,1,1,1] row_mask:0xf bank_mask:0xf
    v_add_f32_dpp v4, v43, v4 quad_perm:[3,3,3,3] row_mask:0xf bank_mask:0xf
    v_add_f32 v61, v61, v4
    v_cvt_pk_bf16_f32 v47, v60, v61
    v_mfma_f32_16x16x32_bf16 v[36:39], a[168:171], v[20:23], 0
    v_mov_b32_dpp v60, v28 quad_perm:[0,0,0,0] row_mask:0xf bank_mask:0xf
    v_mov_b32_dpp v4, v30 quad_perm:[2,2,2,2] row_mask:0xf bank_mask:0xf
    s_nop 0
    v_add_f32_dpp v60, v29, v60 quad_perm:[1,1,1,1] row_mask:0xf bank_mask:0xf
    v_add_f32_dpp v4, v31, v4 quad_perm:[3,3,3,3] row_mask:0xf bank_mask:0xf
    v_add_f32 v60, v60, v4
    v_mfma_f32_16x16x32_bf16 v[40:43], a[172:175], v[20:23], 0
    v_mov_b32_dpp v61, v32 quad_perm:[0,0,0,0] row_mask:0xf bank_mask:0xf
    v_mov_b32_dpp v4, v34 quad_perm:[2,2,2,2] row_mask:0xf bank_mask:0xf
    s_nop 0
    v_add_f32_dpp v61, v33, v61 quad_perm:[1,1,1,1] row_mask:0xf bank_mask:0xf
    v_add_f32_dpp v4, v35, v4 quad_perm:[3,3,3,3] row_mask:0xf bank_mask:0xf
    v_add_f32 v61, v61, v4
    v_cvt_pk_bf16_f32 v48, v60, v61
    v_mfma_f32_16x16x32_bf16 v[28:31], a[176:179], v[20:23], 0
    v_mov_b32_dpp v60, v36 quad_perm:[0,0,0,0] row_mask:0xf bank_mask:0xf
    v_mov_b32_dpp v4, v38 quad_perm:[2,2,2,2] row_mask:0xf bank_mask:0xf
    s_nop 0
    v_add_f32_dpp v60, v37, v60 quad_perm:[1,1,1,1] row_mask:0xf bank_mask:0xf
    v_add_f32_dpp v4, v39, v4 quad_perm:[3,3,3,3] row_mask:0xf bank_mask:0xf
    v_add_f32 v60, v60, v4
    buffer_load_dwordx4 v[252:255], v77, s[52:55], s85 offen offset:1024 nt
    s_add_u32 s87, s87, 7
    s_add_u32 s39, s87, s88
    s_bfe_u32 s37, s39, 0x30000
    s_lshl_b32 s37, s37, 12
    s_add_u32 s85, s37, s89
    s_bfe_u32 s37, s39, 0x10003
    s_lshl_b32 s37, s37, 11
    s_add_u32 s85, s37, s85
    s_bfe_u32 s37, s39, 0x40004
    s_lshl_b32 s37, s37, 16
    s_add_u32 s85, s37, s85
    v_mfma_f32_16x16x32_bf16 v[32:35], a[180:183], v[20:23], 0
    v_mov_b32_dpp v61, v40 quad_perm:[0,0,0,0] row_mask:0xf bank_mask:0xf
    v_mov_b32_dpp v4, v42 quad_perm:[2,2,2,2] row_mask:0xf bank_mask:0xf
    s_nop 0
    v_add_f32_dpp v61, v41, v61 quad_perm:[1,1,1,1] row_mask:0xf bank_mask:0xf
    v_add_f32_dpp v4, v43, v4 quad_perm:[3,3,3,3] row_mask:0xf bank_mask:0xf
    v_add_f32 v61, v61, v4
    v_cvt_pk_bf16_f32 v49, v60, v61
    v_mfma_f32_16x16x32_bf16 v[36:39], a[184:187], v[20:23], 0
    v_mov_b32_dpp v60, v28 quad_perm:[0,0,0,0] row_mask:0xf bank_mask:0xf
    v_mov_b32_dpp v4, v30 quad_perm:[2,2,2,2] row_mask:0xf bank_mask:0xf
    s_nop 0
    v_add_f32_dpp v60, v29, v60 quad_perm:[1,1,1,1] row_mask:0xf bank_mask:0xf
    v_add_f32_dpp v4, v31, v4 quad_perm:[3,3,3,3] row_mask:0xf bank_mask:0xf
    v_add_f32 v60, v60, v4
    v_mfma_f32_16x16x32_bf16 v[40:43], a[188:191], v[20:23], 0
    v_mov_b32_dpp v61, v32 quad_perm:[0,0,0,0] row_mask:0xf bank_mask:0xf
    v_mov_b32_dpp v4, v34 quad_perm:[2,2,2,2] row_mask:0xf bank_mask:0xf
    s_nop 0
    v_add_f32_dpp v61, v33, v61 quad_perm:[1,1,1,1] row_mask:0xf bank_mask:0xf
    v_add_f32_dpp v4, v35, v4 quad_perm:[3,3,3,3] row_mask:0xf bank_mask:0xf
    v_add_f32 v61, v61, v4
    v_cvt_pk_bf16_f32 v50, v60, v61
    v_mfma_f32_16x16x32_bf16 v[28:31], a[192:195], v[20:23], 0
    v_mov_b32_dpp v60, v36 quad_perm:[0,0,0,0] row_mask:0xf bank_mask:0xf
    v_mov_b32_dpp v4, v38 quad_perm:[2,2,2,2] row_mask:0xf bank_mask:0xf
    s_nop 0
    v_add_f32_dpp v60, v37, v60 quad_perm:[1,1,1,1] row_mask:0xf bank_mask:0xf
    v_add_f32_dpp v4, v39, v4 quad_perm:[3,3,3,3] row_mask:0xf bank_mask:0xf
    v_add_f32 v60, v60, v4
    v_mfma_f32_16x16x32_bf16 v[32:35], a[196:199], v[20:23], 0
    v_mov_b32_dpp v61, v40 quad_perm:[0,0,0,0] row_mask:0xf bank_mask:0xf
    v_mov_b32_dpp v4, v42 quad_perm:[2,2,2,2] row_mask:0xf bank_mask:0xf
    s_nop 0
    v_add_f32_dpp v61, v41, v61 quad_perm:[1,1,1,1] row_mask:0xf bank_mask:0xf
    v_add_f32_dpp v4, v43, v4 quad_perm:[3,3,3,3] row_mask:0xf bank_mask:0xf
    v_add_f32 v61, v61, v4
    v_cvt_pk_bf16_f32 v51, v60, v61
    v_mfma_f32_16x16x32_bf16 v[36:39], a[200:203], v[20:23], 0
    v_mov_b32_dpp v60, v28 quad_perm:[0,0,0,0] row_mask:0xf bank_mask:0xf
    v_mov_b32_dpp v4, v30 quad_perm:[2,2,2,2] row_mask:0xf bank_mask:0xf
    s_nop 0
    v_add_f32_dpp v60, v29, v60 quad_perm:[1,1,1,1] row_mask:0xf bank_mask:0xf
    v_add_f32_dpp v4, v31, v4 quad_perm:[3,3,3,3] row_mask:0xf bank_mask:0xf
    v_add_f32 v60, v60, v4
    v_mfma_f32_16x16x32_bf16 v[40:43], a[204:207], v[20:23], 0
    v_mov_b32_dpp v61, v32 quad_perm:[0,0,0,0] row_mask:0xf bank_mask:0xf
    v_mov_b32_dpp v4, v34 quad_perm:[2,2,2,2] row_mask:0xf bank_mask:0xf
    s_nop 0
    v_add_f32_dpp v61, v33, v61 quad_perm:[1,1,1,1] row_mask:0xf bank_mask:0xf
    v_add_f32_dpp v4, v35, v4 quad_perm:[3,3,3,3] row_mask:0xf bank_mask:0xf
    v_add_f32 v61, v61, v4
    v_cvt_pk_bf16_f32 v52, v60, v61
    v_mfma_f32_16x16x32_bf16 v[28:31], a[208:211], v[20:23], 0
    v_mov_b32_dpp v60, v36 quad_perm:[0,0,0,0] row_mask:0xf bank_mask:0xf
    v_mov_b32_dpp v4, v38 quad_perm:[2,2,2,2] row_mask:0xf bank_mask:0xf
    s_nop 0
    v_add_f32_dpp v60, v37, v60 quad_perm:[1,1,1,1] row_mask:0xf bank_mask:0xf
    v_add_f32_dpp v4, v39, v4 quad_perm:[3,3,3,3] row_mask:0xf bank_mask:0xf
    v_add_f32 v60, v60, v4
    buffer_load_dwordx4 a[0:3], v76, s[52:55], s85 offen offset:0 nt
    v_mfma_f32_16x16x32_bf16 v[32:35], a[212:215], v[20:23], 0
    v_mov_b32_dpp v61, v40 quad_perm:[0,0,0,0] row_mask:0xf bank_mask:0xf
    v_mov_b32_dpp v4, v42 quad_perm:[2,2,2,2] row_mask:0xf bank_mask:0xf
    s_nop 0
    v_add_f32_dpp v61, v41, v61 quad_perm:[1,1,1,1] row_mask:0xf bank_mask:0xf
    v_add_f32_dpp v4, v43, v4 quad_perm:[3,3,3,3] row_mask:0xf bank_mask:0xf
    v_add_f32 v61, v61, v4
    v_cvt_pk_bf16_f32 v53, v60, v61
    v_mfma_f32_16x16x32_bf16 v[36:39], a[216:219], v[20:23], 0
    v_mov_b32_dpp v60, v28 quad_perm:[0,0,0,0] row_mask:0xf bank_mask:0xf
    v_mov_b32_dpp v4, v30 quad_perm:[2,2,2,2] row_mask:0xf bank_mask:0xf
    s_nop 0
    v_add_f32_dpp v60, v29, v60 quad_perm:[1,1,1,1] row_mask:0xf bank_mask:0xf
    v_add_f32_dpp v4, v31, v4 quad_perm:[3,3,3,3] row_mask:0xf bank_mask:0xf
    v_add_f32 v60, v60, v4
    v_mfma_f32_16x16x32_bf16 v[40:43], a[220:223], v[20:23], 0
    v_mov_b32_dpp v61, v32 quad_perm:[0,0,0,0] row_mask:0xf bank_mask:0xf
    v_mov_b32_dpp v4, v34 quad_perm:[2,2,2,2] row_mask:0xf bank_mask:0xf
    s_nop 0
    v_add_f32_dpp v61, v33, v61 quad_perm:[1,1,1,1] row_mask:0xf bank_mask:0xf
    v_add_f32_dpp v4, v35, v4 quad_perm:[3,3,3,3] row_mask:0xf bank_mask:0xf
    v_add_f32 v61, v61, v4
    v_cvt_pk_bf16_f32 v54, v60, v61
    v_mfma_f32_16x16x32_bf16 v[28:31], a[224:227], v[20:23], 0
    v_mov_b32_dpp v60, v36 quad_perm:[0,0,0,0] row_mask:0xf bank_mask:0xf
    v_mov_b32_dpp v4, v38 quad_perm:[2,2,2,2] row_mask:0xf bank_mask:0xf
    s_nop 0
    v_add_f32_dpp v60, v37, v60 quad_perm:[1,1,1,1] row_mask:0xf bank_mask:0xf
    v_add_f32_dpp v4, v39, v4 quad_perm:[3,3,3,3] row_mask:0xf bank_mask:0xf
    v_add_f32 v60, v60, v4
    v_mfma_f32_16x16x32_bf16 v[32:35], a[228:231], v[20:23], 0
    v_mov_b32_dpp v61, v40 quad_perm:[0,0,0,0] row_mask:0xf bank_mask:0xf
    v_mov_b32_dpp v4, v42 quad_perm:[2,2,2,2] row_mask:0xf bank_mask:0xf
    s_nop 0
    v_add_f32_dpp v61, v41, v61 quad_perm:[1,1,1,1] row_mask:0xf bank_mask:0xf
    v_add_f32_dpp v4, v43, v4 quad_perm:[3,3,3,3] row_mask:0xf bank_mask:0xf
    v_add_f32 v61, v61, v4
    v_cvt_pk_bf16_f32 v55, v60, v61
    v_mfma_f32_16x16x32_bf16 v[36:39], a[232:235], v[20:23], 0
    v_mov_b32_dpp v60, v28 quad_perm:[0,0,0,0] row_mask:0xf bank_mask:0xf
    v_mov_b32_dpp v4, v30 quad_perm:[2,2,2,2] row_mask:0xf bank_mask:0xf
    s_nop 0
    v_add_f32_dpp v60, v29, v60 quad_perm:[1,1,1,1] row_mask:0xf bank_mask:0xf
    v_add_f32_dpp v4, v31, v4 quad_perm:[3,3,3,3] row_mask:0xf bank_mask:0xf
    v_add_f32 v60, v60, v4
    v_mfma_f32_16x16x32_bf16 v[40:43], a[236:239], v[20:23], 0
    v_mov_b32_dpp v61, v32 quad_perm:[0,0,0,0] row_mask:0xf bank_mask:0xf
    v_mov_b32_dpp v4, v34 quad_perm:[2,2,2,2] row_mask:0xf bank_mask:0xf
    s_nop 0
    v_add_f32_dpp v61, v33, v61 quad_perm:[1,1,1,1] row_mask:0xf bank_mask:0xf
    v_add_f32_dpp v4, v35, v4 quad_perm:[3,3,3,3] row_mask:0xf bank_mask:0xf
    v_add_f32 v61, v61, v4
    v_cvt_pk_bf16_f32 v56, v60, v61
    v_mfma_f32_16x16x32_bf16 v[28:31], a[240:243], v[20:23], 0
    v_mov_b32_dpp v60, v36 quad_perm:[0,0,0,0] row_mask:0xf bank_mask:0xf
    v_mov_b32_dpp v4, v38 quad_perm:[2,2,2,2] row_mask:0xf bank_mask:0xf
    s_nop 0
    v_add_f32_dpp v60, v37, v60 quad_perm:[1,1,1,1] row_mask:0xf bank_mask:0xf
    v_add_f32_dpp v4, v39, v4 quad_perm:[3,3,3,3] row_mask:0xf bank_mask:0xf
    v_add_f32 v60, v60, v4
    buffer_load_dwordx4 a[4:7], v77, s[52:55], s85 offen offset:0 nt
    v_mfma_f32_16x16x32_bf16 v[32:35], a[244:247], v[20:23], 0
    v_mov_b32_dpp v61, v40 quad_perm:[0,0,0,0] row_mask:0xf bank_mask:0xf
    v_mov_b32_dpp v4, v42 quad_perm:[2,2,2,2] row_mask:0xf bank_mask:0xf
    s_nop 0
    v_add_f32_dpp v61, v41, v61 quad_perm:[1,1,1,1] row_mask:0xf bank_mask:0xf
    v_add_f32_dpp v4, v43, v4 quad_perm:[3,3,3,3] row_mask:0xf bank_mask:0xf
    v_add_f32 v61, v61, v4
    v_cvt_pk_bf16_f32 v57, v60, v61
    v_mfma_f32_16x16x32_bf16 v[36:39], a[248:251], v[20:23], 0
    v_mov_b32_dpp v60, v28 quad_perm:[0,0,0,0] row_mask:0xf bank_mask:0xf
    v_mov_b32_dpp v4, v30 quad_perm:[2,2,2,2] row_mask:0xf bank_mask:0xf
    s_nop 0
    v_add_f32_dpp v60, v29, v60 quad_perm:[1,1,1,1] row_mask:0xf bank_mask:0xf
    v_add_f32_dpp v4, v31, v4 quad_perm:[3,3,3,3] row_mask:0xf bank_mask:0xf
    v_add_f32 v60, v60, v4
    v_mfma_f32_16x16x32_bf16 v[40:43], a[252:255], v[20:23], 0
    v_mov_b32_dpp v61, v32 quad_perm:[0,0,0,0] row_mask:0xf bank_mask:0xf
    v_mov_b32_dpp v4, v34 quad_perm:[2,2,2,2] row_mask:0xf bank_mask:0xf
    s_nop 0
    v_add_f32_dpp v61, v33, v61 quad_perm:[1,1,1,1] row_mask:0xf bank_mask:0xf
    v_add_f32_dpp v4, v35, v4 quad_perm:[3,3,3,3] row_mask:0xf bank_mask:0xf
    v_add_f32 v61, v61, v4
    v_cvt_pk_bf16_f32 v58, v60, v61
    v_mov_b32_dpp v60, v36 quad_perm:[0,0,0,0] row_mask:0xf bank_mask:0xf
    v_mov_b32_dpp v4, v38 quad_perm:[2,2,2,2] row_mask:0xf bank_mask:0xf
    s_nop 0
    v_add_f32_dpp v60, v37, v60 quad_perm:[1,1,1,1] row_mask:0xf bank_mask:0xf
    v_add_f32_dpp v4, v39, v4 quad_perm:[3,3,3,3] row_mask:0xf bank_mask:0xf
    v_add_f32 v60, v60, v4
    v_mov_b32_dpp v61, v40 quad_perm:[0,0,0,0] row_mask:0xf bank_mask:0xf
    v_mov_b32_dpp v4, v42 quad_perm:[2,2,2,2] row_mask:0xf bank_mask:0xf
    s_nop 0
    v_add_f32_dpp v61, v41, v61 quad_perm:[1,1,1,1] row_mask:0xf bank_mask:0xf
    v_add_f32_dpp v4, v43, v4 quad_perm:[3,3,3,3] row_mask:0xf bank_mask:0xf
    v_add_f32 v61, v61, v4
    v_cvt_pk_bf16_f32 v59, v60, v61
    s_mov_b32 exec_lo, 0x22222222
    s_mov_b32 exec_hi, 0x22222222
    v_mov_b32 v44, v48
    v_mov_b32 v45, v49
    v_mov_b32 v46, v50
    v_mov_b32 v47, v51
    s_mov_b32 exec_lo, 0x44444444
    s_mov_b32 exec_hi, 0x44444444
    v_mov_b32 v44, v52
    v_mov_b32 v45, v53
    v_mov_b32 v46, v54
    v_mov_b32 v47, v55
    s_mov_b32 exec_lo, 0x88888888
    s_mov_b32 exec_hi, 0x88888888
    v_mov_b32 v44, v56
    v_mov_b32 v45, v57
    v_mov_b32 v46, v58
    v_mov_b32 v47, v59
    s_mov_b64 exec, -1
    buffer_store_dwordx4 v[44:47], v19, s[48:51], s94 offen sc1
    s_waitcnt vmcnt(5)
L_qcheck_14:
    v_xor_b32 v68, s35, v68
    v_xor_b32 v69, s35, v69
    v_xor_b32 v70, s35, v70
    v_xor_b32 v71, s35, v71
    v_xor_b32 v72, s35, v72
    v_xor_b32 v73, s35, v73
    v_xor_b32 v74, s35, v74
    v_xor_b32 v75, s35, v75
    v_or_b32 v4, v68, v69
    v_or3_b32 v4, v4, v70, v71
    v_or3_b32 v4, v4, v72, v73
    v_or3_b32 v4, v4, v74, v75
    v_and_b32 v4, 0xff, v4
    v_cmp_ne_u32 vcc, 0, v4
    s_cbranch_vccz L_qok_15
    buffer_load_dwordx4 v[68:71], v78, s[48:51], s91 offen offset:0 sc1
    buffer_load_dwordx4 v[72:75], v78, s[48:51], s91 offen offset:16 sc1
    s_waitcnt vmcnt(0)
    s_sub_u32 s84, s84, 1
    s_cmp_lg_u32 s84, 0
    s_cbranch_scc1 L_qcheck_14
    s_branch L_end
L_qok_15:
    v_cvt_pk_bf16_f32 v68, v68, v69
    v_cvt_pk_bf16_f32 v69, v70, v71
    v_cvt_pk_bf16_f32 v70, v72, v73
    v_cvt_pk_bf16_f32 v71, v74, v75
    s_mov_b32 vcc_lo, 0xf000f
    s_mov_b32 vcc_hi, 0xf000f
    v_cndmask_b32 v80, 0, v68, vcc
    v_cndmask_b32 v81, 0, v69, vcc
    v_cndmask_b32 v82, 0, v70, vcc
    v_cndmask_b32 v83, 0, v71, vcc
    s_mov_b32 vcc_lo, 0xf000f0
    s_mov_b32 vcc_hi, 0xf000f0
    v_cndmask_b32 v84, 0, v68, vcc
    v_cndmask_b32 v85, 0, v69, vcc
    v_cndmask_b32 v86, 0, v70, vcc
    v_cndmask_b32 v87, 0, v71, vcc
    s_mov_b32 vcc_lo, 0xf000f00
    s_mov_b32 vcc_hi, 0xf000f00
    v_cndmask_b32 v88, 0, v68, vcc
    v_cndmask_b32 v89, 0, v69, vcc
    v_cndmask_b32 v90, 0, v70, vcc
    v_cndmask_b32 v91, 0, v71, vcc
    s_mov_b32 vcc_lo, 0xf000f000
    s_mov_b32 vcc_hi, 0xf000f000
    v_cndmask_b32 v92, 0, v68, vcc
    v_cndmask_b32 v93, 0, v69, vcc
    v_cndmask_b32 v94, 0, v70, vcc
    v_cndmask_b32 v95, 0, v71, vcc
    v_mov_b32 v65, 0xff7f0000
    s_lshl_b32 s38, s34, 14
    s_add_u32 s38, s38, 16384
    v_lshl_add_u32 v64, v1, 2, s38
    buffer_load_dwordx4 a[8:11], v76, s[52:55], s85 offen offset:1024 nt
    v_mfma_f32_16x16x32_bf16 v[112:115], v[128:131], v[80:83], 0
    v_mfma_f32_16x16x32_bf16 v[112:115], v[132:135], v[84:87], v[112:115]
    buffer_load_dwordx4 a[12:15], v77, s[52:55], s85 offen offset:1024 nt
    s_add_u32 s87, s87, 7
    s_add_u32 s39, s87, s88
    s_bfe_u32 s37, s39, 0x30000
    s_lshl_b32 s37, s37, 12
    s_add_u32 s85, s37, s89
    s_bfe_u32 s37, s39, 0x10003
    s_lshl_b32 s37, s37, 11
    s_add_u32 s85, s37, s85
    s_bfe_u32 s37, s39, 0x40004
    s_lshl_b32 s37, s37, 16
    s_add_u32 s85, s37, s85
    v_mfma_f32_16x16x32_bf16 v[112:115], v[136:139], v[88:91], v[112:115]
    v_mfma_f32_16x16x32_bf16 v[112:115], v[140:143], v[92:95], v[112:115]
    buffer_load_dwordx4 a[16:19], v76, s[52:55], s85 offen offset:0 nt
    v_mfma_f32_16x16x32_bf16 v[96:99], v[144:147], v[80:83], 0
    v_mfma_f32_16x16x32_bf16 v[96:99], v[148:151], v[84:87], v[96:99]
    v_mfma_f32_16x16x32_bf16 v[96:99], v[152:155], v[88:91], v[96:99]
    s_nop 3
    v_mov_b32_dpp v122, v112 quad_perm:[0,0,0,0] row_mask:0xf bank_mask:0xf
    v_mov_b32_dpp v124, v114 quad_perm:[2,2,2,2] row_mask:0xf bank_mask:0xf
    s_nop 0
    v_add_f32_dpp v122, v113, v122 quad_perm:[1,1,1,1] row_mask:0xf bank_mask:0xf
    v_add_f32_dpp v124, v115, v124 quad_perm:[3,3,3,3] row_mask:0xf bank_mask:0xf
    v_add_f32 v122, v122, v124
    v_max_f32 v65, v65, v122
    ds_write_b32 v64, v122 offset:0
    s_waitcnt vmcnt(7)
    buffer_load_dwordx4 a[20:23], v77, s[52:55], s85 offen offset:0 nt
    v_mfma_f32_16x16x32_bf16 v[96:99], v[156:159], v[92:95], v[96:99]
    v_mfma_f32_16x16x32_bf16 v[112:115], v[160:163], v[80:83], 0
    s_waitcnt vmcnt(7)
    buffer_load_dwordx4 a[24:27], v76, s[52:55], s85 offen offset:1024 nt
    v_mfma_f32_16x16x32_bf16 v[112:115], v[164:167], v[84:87], v[112:115]
    v_mfma_f32_16x16x32_bf16 v[112:115], v[168:171], v[88:91], v[112:115]
    s_nop 2
    v_mov_b32_dpp v122, v96 quad_perm:[0,0,0,0] row_mask:0xf bank_mask:0xf
    v_mov_b32_dpp v124, v98 quad_perm:[2,2,2,2] row_mask:0xf bank_mask:0xf
    s_nop 0
    v_add_f32_dpp v122, v97, v122 quad_perm:[1,1,1,1] row_mask:0xf bank_mask:0xf
    v_add_f32_dpp v124, v99, v124 quad_perm:[3,3,3,3] row_mask:0xf bank_mask:0xf
    v_add_f32 v122, v122, v124
    v_max_f32 v65, v65, v122
    ds_write_b32 v64, v122 offset:256
    v_mfma_f32_16x16x32_bf16 v[112:115], v[172:175], v[92:95], v[112:115]
    s_waitcnt vmcnt(7)
    buffer_load_dwordx4 a[28:31], v77, s[52:55], s85 offen offset:1024 nt
    s_add_u32 s87, s87, 7
    s_add_u32 s39, s87, s88
    s_bfe_u32 s37, s39, 0x30000
    s_lshl_b32 s37, s37, 12
    s_add_u32 s85, s37, s89
    s_bfe_u32 s37, s39, 0x10003
    s_lshl_b32 s37, s37, 11
    s_add_u32 s85, s37, s85
    s_bfe_u32 s37, s39, 0x40004
    s_lshl_b32 s37, s37, 16
    s_add_u32 s85, s37, s85
    v_mfma_f32_16x16x32_bf16 v[96:99], v[176:179], v[80:83], 0
    v_mfma_f32_16x16x32_bf16 v[96:99], v[180:183], v[84:87], v[96:99]
    s_waitcnt vmcnt(7)
    buffer_load_dwordx4 a[32:35], v76, s[52:55], s85 offen offset:0 nt
    v_mfma_f32_16x16x32_bf16 v[96:99], v[184:187], v[88:91], v[96:99]
    v_mov_b32_dpp v122, v112 quad_perm:[0,0,0,0] row_mask:0xf bank_mask:0xf
    v_mov_b32_dpp v124, v114 quad_perm:[2,2,2,2] row_mask:0xf bank_mask:0xf
    s_nop 0
    v_add_f32_dpp v122, v113, v122 quad_perm:[1,1,1,1] row_mask:0xf bank_mask:0xf
    v_add_f32_dpp v124, v115, v124 quad_perm:[3,3,3,3] row_mask:0xf bank_mask:0xf
    v_add_f32 v122, v122, v124
    v_max_f32 v65, v65, v122
    ds_write_b32 v64, v122 offset:512
    v_mfma_f32_16x16x32_bf16 v[96:99], v[188:191], v[92:95], v[96:99]
    s_lshr_b32 s38, s32, 1
    s_lshl_b32 s38, s38, 17
    s_add_u32 s69, s38, 2211840
    s_bfe_u32 s38, s32, 0x10000
    s_lshl_b32 s38, s38, 13
    s_add_u32 s69, s38, s69
    s_lshl_b32 s38, s34, 8
    s_add_u32 s69, s38, s69
    v_mov_b32 v28, s69
    v_mov_b32 v29, s68
    s_waitcnt vmcnt(7)
    s_mov_b64 exec, 1
    buffer_store_dword v29, v28, s[48:51], 0 offen sc1
    s_mov_b64 exec, -1
    s_waitcnt vmcnt(7)
    buffer_load_dwordx4 a[36:39], v77, s[52:55], s85 offen offset:0 nt
    v_mfma_f32_16x16x32_bf16 v[112:115], v[192:195], v[80:83], 0
    v_mfma_f32_16x16x32_bf16 v[112:115], v[196:199], v[84:87], v[112:115]
    v_mfma_f32_16x16x32_bf16 v[112:115], v[200:203], v[88:91], v[112:115]
    v_mov_b32_dpp v122, v96 quad_perm:[0,0,0,0] row_mask:0xf bank_mask:0xf
    v_mov_b32_dpp v124, v98 quad_perm:[2,2,2,2] row_mask:0xf bank_mask:0xf
    s_nop 0
    v_add_f32_dpp v122, v97, v122 quad_perm:[1,1,1,1] row_mask:0xf bank_mask:0xf
    v_add_f32_dpp v124, v99, v124 quad_perm:[3,3,3,3] row_mask:0xf bank_mask:0xf
    v_add_f32 v122, v122, v124
    v_max_f32 v65, v65, v122
    ds_write_b32 v64, v122 offset:768
    s_waitcnt vmcnt(7)
    buffer_load_dwordx4 a[40:43], v76, s[52:55], s85 offen offset:1024 nt
    v_mfma_f32_16x16x32_bf16 v[112:115], v[204:207], v[92:95], v[112:115]
    v_mfma_f32_16x16x32_bf16 v[96:99], v[208:211], v[80:83], 0
    s_waitcnt vmcnt(7)
    buffer_load_dwordx4 a[44:47], v77, s[52:55], s85 offen offset:1024 nt
    s_add_u32 s87, s87, 7
    s_add_u32 s39, s87, s88
    s_bfe_u32 s37, s39, 0x30000
    s_lshl_b32 s37, s37, 12
    s_add_u32 s85, s37, s89
    s_bfe_u32 s37, s39, 0x10003
    s_lshl_b32 s37, s37, 11
    s_add_u32 s85, s37, s85
    s_bfe_u32 s37, s39, 0x40004
    s_lshl_b32 s37, s37, 16
    s_add_u32 s85, s37, s85
    v_mfma_f32_16x16x32_bf16 v[96:99], v[212:215], v[84:87], v[96:99]
    v_mfma_f32_16x16x32_bf16 v[96:99], v[216:219], v[88:91], v[96:99]
    v_mov_b32_dpp v122, v112 quad_perm:[0,0,0,0] row_mask:0xf bank_mask:0xf
    v_mov_b32_dpp v124, v114 quad_perm:[2,2,2,2] row_mask:0xf bank_mask:0xf
    s_nop 0
    v_add_f32_dpp v122, v113, v122 quad_perm:[1,1,1,1] row_mask:0xf bank_mask:0xf
    v_add_f32_dpp v124, v115, v124 quad_perm:[3,3,3,3] row_mask:0xf bank_mask:0xf
    v_add_f32 v122, v122, v124
    v_max_f32 v65, v65, v122
    ds_write_b32 v64, v122 offset:1024
    v_mfma_f32_16x16x32_bf16 v[96:99], v[220:223], v[92:95], v[96:99]
    s_waitcnt vmcnt(7)
    buffer_load_dwordx4 a[48:51], v76, s[52:55], s85 offen offset:0 nt
    v_mfma_f32_16x16x32_bf16 v[112:115], v[224:227], v[80:83], 0
    v_mfma_f32_16x16x32_bf16 v[112:115], v[228:231], v[84:87], v[112:115]
    s_waitcnt vmcnt(7)
    buffer_load_dwordx4 a[52:55], v77, s[52:55], s85 offen offset:0 nt
    v_mfma_f32_16x16x32_bf16 v[112:115], v[232:235], v[88:91], v[112:115]
    s_nop 0
    v_mov_b32_dpp v122, v96 quad_perm:[0,0,0,0] row_mask:0xf bank_mask:0xf
    v_mov_b32_dpp v124, v98 quad_perm:[2,2,2,2] row_mask:0xf bank_mask:0xf
    s_nop 0
    v_add_f32_dpp v122, v97, v122 quad_perm:[1,1,1,1] row_mask:0xf bank_mask:0xf
    v_add_f32_dpp v124, v99, v124 quad_perm:[3,3,3,3] row_mask:0xf bank_mask:0xf
    v_add_f32 v122, v122, v124
    v_max_f32 v65, v65, v122
    ds_write_b32 v64, v122 offset:1280
    v_mfma_f32_16x16x32_bf16 v[112:115], v[236:239], v[92:95], v[112:115]
    s_waitcnt vmcnt(7)
    buffer_load_dwordx4 a[56:59], v76, s[52:55], s85 offen offset:1024 nt
    v_mfma_f32_16x16x32_bf16 v[96:99], v[240:243], v[80:83], 0
    v_mfma_f32_16x16x32_bf16 v[96:99], v[244:247], v[84:87], v[96:99]
    v_mfma_f32_16x16x32_bf16 v[96:99], v[248:251], v[88:91], v[96:99]
    s_nop 2
    v_mov_b32_dpp v122, v112 quad_perm:[0,0,0,0] row_mask:0xf bank_mask:0xf
    v_mov_b32_dpp v124, v114 quad_perm:[2,2,2,2] row_mask:0xf bank_mask:0xf
    s_nop 0
    v_add_f32_dpp v122, v113, v122 quad_perm:[1,1,1,1] row_mask:0xf bank_mask:0xf
    v_add_f32_dpp v124, v115, v124 quad_perm:[3,3,3,3] row_mask:0xf bank_mask:0xf
    v_add_f32 v122, v122, v124
    v_max_f32 v65, v65, v122
    ds_write_b32 v64, v122 offset:1536
    s_waitcnt vmcnt(7)
    buffer_load_dwordx4 a[60:63], v77, s[52:55], s85 offen offset:1024 nt
    s_add_u32 s87, s87, 7
    s_add_u32 s39, s87, s88
    s_bfe_u32 s37, s39, 0x30000
    s_lshl_b32 s37, s37, 12
    s_add_u32 s85, s37, s89
    s_bfe_u32 s37, s39, 0x10003
    s_lshl_b32 s37, s37, 11
    s_add_u32 s85, s37, s85
    s_bfe_u32 s37, s39, 0x40004
    s_lshl_b32 s37, s37, 16
    s_add_u32 s85, s37, s85
    v_mfma_f32_16x16x32_bf16 v[96:99], v[252:255], v[92:95], v[96:99]
    v_mfma_f32_16x16x32_bf16 v[112:115], a[0:3], v[80:83], 0
    s_waitcnt vmcnt(5)
    buffer_load_dwordx4 v[128:131], v76, s[52:55], s85 offen offset:0 nt
    v_mfma_f32_16x16x32_bf16 v[112:115], a[4:7], v[84:87], v[112:115]
    v_mfma_f32_16x16x32_bf16 v[112:115], a[8:11], v[88:91], v[112:115]
    s_nop 2
    v_mov_b32_dpp v122, v96 quad_perm:[0,0,0,0] row_mask:0xf bank_mask:0xf
    v_mov_b32_dpp v124, v98 quad_perm:[2,2,2,2] row_mask:0xf bank_mask:0xf
    s_nop 0
    v_add_f32_dpp v122, v97, v122 quad_perm:[1,1,1,1] row_mask:0xf bank_mask:0xf
    v_add_f32_dpp v124, v99, v124 quad_perm:[3,3,3,3] row_mask:0xf bank_mask:0xf
    v_add_f32 v122, v122, v124
    v_max_f32 v65, v65, v122
    ds_write_b32 v64, v122 offset:1792
    v_mfma_f32_16x16x32_bf16 v[112:115], a[12:15], v[92:95], v[112:115]
    s_waitcnt vmcnt(5)
    buffer_load_dwordx4 v[132:135], v77, s[52:55], s85 offen offset:0 nt
    v_mfma_f32_16x16x32_bf16 v[96:99], a[16:19], v[80:83], 0
    v_mfma_f32_16x16x32_bf16 v[96:99], a[20:23], v[84:87], v[96:99]
    s_waitcnt vmcnt(5)
    buffer_load_dwordx4 v[136:139], v76, s[52:55], s85 offen offset:1024 nt
    v_mfma_f32_16x16x32_bf16 v[96:99], a[24:27], v[88:91], v[96:99]
    s_nop 0
    v_mov_b32_dpp v122, v112 quad_perm:[0,0,0,0] row_mask:0xf bank_mask:0xf
    v_mov_b32_dpp v124, v114 quad_perm:[2,2,2,2] row_mask:0xf bank_mask:0xf
    s_nop 0
    v_add_f32_dpp v122, v113, v122 quad_perm:[1,1,1,1] row_mask:0xf bank_mask:0xf
    v_add_f32_dpp v124, v115, v124 quad_perm:[3,3,3,3] row_mask:0xf bank_mask:0xf
    v_add_f32 v122, v122, v124
    v_max_f32 v65, v65, v122
    ds_write_b32 v64, v122 offset:2048
    v_mfma_f32_16x16x32_bf16 v[96:99], a[28:31], v[92:95], v[96:99]
    s_waitcnt vmcnt(5)
    buffer_load_dwordx4 v[140:143], v77, s[52:55], s85 offen offset:1024 nt
    s_add_u32 s87, s87, 7
    s_add_u32 s39, s87, s88
    s_bfe_u32 s37, s39, 0x30000
    s_lshl_b32 s37, s37, 12
    s_add_u32 s85, s37, s89
    s_bfe_u32 s37, s39, 0x10003
    s_lshl_b32 s37, s37, 11
    s_add_u32 s85, s37, s85
    s_bfe_u32 s37, s39, 0x40004
    s_lshl_b32 s37, s37, 16
    s_add_u32 s85, s37, s85
    v_mfma_f32_16x16x32_bf16 v[112:115], a[32:35], v[80:83], 0
    v_mfma_f32_16x16x32_bf16 v[112:115], a[36:39], v[84:87], v[112:115]
    v_mfma_f32_16x16x32_bf16 v[112:115], a[40:43], v[88:91], v[112:115]
    v_mov_b32_dpp v122, v96 quad_perm:[0,0,0,0] row_mask:0xf bank_mask:0xf
    v_mov_b32_dpp v124, v98 quad_perm:[2,2,2,2] row_mask:0xf bank_mask:0xf
    s_nop 0
    v_add_f32_dpp v122, v97, v122 quad_perm:[1,1,1,1] row_mask:0xf bank_mask:0xf
    v_add_f32_dpp v124, v99, v124 quad_perm:[3,3,3,3] row_mask:0xf bank_mask:0xf
    v_add_f32 v122, v122, v124
    v_max_f32 v65, v65, v122
    ds_write_b32 v64, v122 offset:2304
    s_waitcnt vmcnt(5)
    buffer_load_dwordx4 v[144:147], v76, s[52:55], s85 offen offset:0 nt
    v_mfma_f32_16x16x32_bf16 v[112:115], a[44:47], v[92:95], v[112:115]
    v_mfma_f32_16x16x32_bf16 v[96:99], a[48:51], v[80:83], 0
    s_waitcnt vmcnt(5)
    buffer_load_dwordx4 v[148:151], v77, s[52:55], s85 offen offset:0 nt
    v_mfma_f32_16x16x32_bf16 v[96:99], a[52:55], v[84:87], v[96:99]
    v_mfma_f32_16x16x32_bf16 v[96:99], a[56:59], v[88:91], v[96:99]
    s_nop 2
    v_mov_b32_dpp v122, v112 quad_perm:[0,0,0,0] row_mask:0xf bank_mask:0xf
    v_mov_b32_dpp v124, v114 quad_perm:[2,2,2,2] row_mask:0xf bank_mask:0xf
    s_nop 0
    v_add_f32_dpp v122, v113, v122 quad_perm:[1,1,1,1] row_mask:0xf bank_mask:0xf
    v_add_f32_dpp v124, v115, v124 quad_perm:[3,3,3,3] row_mask:0xf bank_mask:0xf
    v_add_f32 v122, v122, v124
    v_max_f32 v65, v65, v122
    ds_write_b32 v64, v122 offset:2560
    v_mfma_f32_16x16x32_bf16 v[96:99], a[60:63], v[92:95], v[96:99]
    v_add_u32 v64, 2816, v64
    s_mov_b32 s97, 10
    s_mov_b32 s86, 32
    s_add_u32 s92, s33, 224
    s_mov_b32 s66, 134217728
    s_mov_b32 s67, 0x20000
    s_mov_b64 s[64:65], s[52:53]
    v_mov_b32 v62, v76
    v_mov_b32 v63, v77
    s_branch L_bloop
L_aux:
    v_lshlrev_b32 v4, 2, v2
    v_xor_b32 v4, v4, v3
    v_xor_b32 v96, 0, v4
    v_lshlrev_b32 v96, 4, v96
    v_lshl_add_u32 v10, v2, 13, v96
    v_xor_b32 v97, 1, v4
    v_lshlrev_b32 v97, 4, v97
    v_lshl_add_u32 v11, v2, 13, v97
    v_add_u32 v11, 31744, v11
    v_xor_b32 v98, 2, v4
    v_lshlrev_b32 v98, 4, v98
    v_lshl_add_u32 v12, v2, 13, v98
    v_add_u32 v12, 63488, v12
    v_xor_b32 v99, 3, v4
    v_lshlrev_b32 v99, 4, v99
    v_lshl_add_u32 v13, v2, 13, v99
    v_add_u32 v13, 95232, v13
    s_lshl_b32 s90, s34, 15
    s_mov_b32 s62, 0
    s_mov_b32 s94, 0
    s_lshl_b32 s95, s34, 20
    s_lshl_b32 s38, s32, 8
    s_add_u32 s95, s95, s38
    s_waitcnt lgkmcnt(0)
    s_mov_b32 s52, s12
    s_and_b32 s53, s13, 0xffff
    s_mov_b32 s54, 4194304
    s_mov_b32 s55, 0x20000
    s_add_u32 s39, s90, s62
    s_mov_b32 m0, s39
    s_add_u32 s62, s62, 4096
    s_and_b32 s62, s62, 0x7fff
    buffer_load_dwordx4 v10, s[52:55], s95 offen offset:0 nt lds
    buffer_load_dwordx4 v11, s[52:55], s95 offen offset:1024 nt lds
    buffer_load_dwordx4 v12, s[52:55], s95 offen offset:2048 nt lds
    buffer_load_dwordx4 v13, s[52:55], s95 offen offset:3072 nt lds
    s_add_u32 s95, s95, 131072
    s_add_u32 s39, s90, s62
    s_mov_b32 m0, s39
    s_add_u32 s62, s62, 4096
    s_and_b32 s62, s62, 0x7fff
    buffer_load_dwordx4 v10, s[52:55], s95 offen offset:0 nt lds
    buffer_load_dwordx4 v11, s[52:55], s95 offen offset:1024 nt lds
    buffer_load_dwordx4 v12, s[52:55], s95 offen offset:2048 nt lds
    buffer_load_dwordx4 v13, s[52:55], s95 offen offset:3072 nt lds
    s_add_u32 s95, s95, 131072
    s_load_dword s35, s[30:31], 0
    s_mov_b32 s48, s30
    s_and_b32 s49, s31, 0xffff
    s_mov_b32 s50, 16777216
    s_mov_b32 s51, 0x20000
    s_mov_b32 s82, 0xffffff00
    s_mov_b32 s83, 0x3e0293ee
    s_mov_b32 s84, 2097152
    s_mov_b32 s72, s26
    s_and_b32 s73, s27, 0xffff
    s_mov_b32 s74, 8192
    s_mov_b32 s75, 0x20000
    v_lshl_add_u32 v76, v2, 10, v96
    v_lshl_add_u32 v96, v2, 8, v96
    v_lshl_add_u32 v77, v2, 10, v97
    v_lshl_add_u32 v97, v2, 8, v97
    v_add_u32 v77, 3072, v77
    v_lshl_add_u32 v78, v2, 10, v98
    v_lshl_add_u32 v98, v2, 8, v98
    v_add_u32 v78, 6144, v78
    v_lshl_add_u32 v79, v2, 10, v99
    v_lshl_add_u32 v99, v2, 8, v99
    v_add_u32 v79, 9216, v79
    v_bfe_u32 v100, v1, 1, 4
    v_lshlrev_b32 v101, 17, v100
    v_bfe_u32 v100, v1, 0, 1
    v_lshl_add_u32 v101, v100, 13, v101
    v_mov_b32 v100, 0
    s_lshl_b32 s38, s34, 8
    v_add_u32 v101, s38, v101
    v_lshlrev_b32 v4, 4, v3
    v_lshl_add_u32 v9, v2, 10, v4
    s_lshl_b32 s63, s32, 17
    s_lshl_b32 s38, s34, 8
    s_add_u32 s63, s63, s38
    v_and_b32 v4, 3, v1
    v_bfe_u32 v5, v1, 2, 2
    v_lshrrev_b32 v6, 5, v1
    v_lshl_add_u32 v7, v4, 2, v5
    v_xor_b32 v7, v7, v6
    v_lshlrev_b32 v7, 4, v7
    v_and_b32 v80, 31, v1
    v_lshl_add_u32 v80, v80, 8, v7
    v_lshl_add_u32 v81, v6, 2, v5
    v_lshlrev_b32 v81, 8, v81
    v_lshl_add_u32 v81, v5, 6, v81
    v_bfe_u32 v7, v1, 4, 1
    v_lshlrev_b32 v7, 1, v7
    v_bfe_u32 v82, v1, 1, 1
    v_add_u32 v7, v7, v82
    v_xor_b32 v7, v7, v6
    v_lshl_add_u32 v81, v7, 4, v81
    v_and_b32 v7, 1, v1
    v_lshl_add_u32 v81, v7, 3, v81
    v_lshl_add_u32 v95, v2, 3, v5
    v_lshlrev_b32 v95, 8, v95
    v_lshl_add_u32 v95, v5, 6, v95
    v_bfe_u32 v4, v1, 4, 1
    v_lshl_add_u32 v4, v4, 1, v82
    v_lshl_add_u32 v95, v4, 4, v95
    v_lshl_add_u32 v95, v7, 3, v95
    v_add_u32 v95, s90, v95
    v_xor_b32 v136, 0, v95
    v_xor_b32 v137, 16, v95
    v_xor_b32 v138, 32, v95
    v_xor_b32 v139, 48, v95
    v_xor_b32 v140, 64, v95
    v_xor_b32 v141, 80, v95
    v_xor_b32 v142, 96, v95
    v_xor_b32 v143, 112, v95
    v_xor_b32 v144, 128, v95
    v_xor_b32 v145, 144, v95
    v_xor_b32 v146, 160, v95
    v_xor_b32 v147, 176, v95
    v_xor_b32 v148, 192, v95
    v_xor_b32 v149, 208, v95
    v_xor_b32 v150, 224, v95
    v_xor_b32 v151, 240, v95
    s_lshl_b32 s85, s34, 13
    s_add_u32 s85, s85, 131072
    v_lshl_add_u32 v94, v1, 4, s85
    v_add_u32 v96, s85, v96
    v_add_u32 v97, s85, v97
    v_add_u32 v98, s85, v98
    v_add_u32 v99, s85, v99
    s_add_u32 s39, s90, s62
    s_mov_b32 m0, s39
    s_add_u32 s62, s62, 4096
    s_and_b32 s62, s62, 0x7fff
    buffer_load_dwordx4 v10, s[52:55], s95 offen offset:0 nt lds
    buffer_load_dwordx4 v11, s[52:55], s95 offen offset:1024 nt lds
    buffer_load_dwordx4 v12, s[52:55], s95 offen offset:2048 nt lds
    buffer_load_dwordx4 v13, s[52:55], s95 offen offset:3072 nt lds
    s_add_u32 s95, s95, 131072
    s_add_u32 s39, s90, s62
    s_mov_b32 m0, s39
    s_add_u32 s62, s62, 4096
    s_and_b32 s62, s62, 0x7fff
    buffer_load_dwordx4 v10, s[52:55], s95 offen offset:0 nt lds
    buffer_load_dwordx4 v11, s[52:55], s95 offen offset:1024 nt lds
    buffer_load_dwordx4 v12, s[52:55], s95 offen offset:2048 nt lds
    buffer_load_dwordx4 v13, s[52:55], s95 offen offset:3072 nt lds
    s_add_u32 s95, s95, 131072
    s_add_u32 s39, s90, s62
    s_mov_b32 m0, s39
    s_add_u32 s62, s62, 4096
    s_and_b32 s62, s62, 0x7fff
    buffer_load_dwordx4 v10, s[52:55], s95 offen offset:0 nt lds
    buffer_load_dwordx4 v11, s[52:55], s95 offen offset:1024 nt lds
    buffer_load_dwordx4 v12, s[52:55], s95 offen offset:2048 nt lds
    buffer_load_dwordx4 v13, s[52:55], s95 offen offset:3072 nt lds
    s_add_u32 s95, s95, 131072
    s_add_u32 s39, s90, s62
    s_mov_b32 m0, s39
    s_add_u32 s62, s62, 4096
    s_and_b32 s62, s62, 0x7fff
    buffer_load_dwordx4 v10, s[52:55], s95 offen offset:0 nt lds
    buffer_load_dwordx4 v11, s[52:55], s95 offen offset:1024 nt lds
    buffer_load_dwordx4 v12, s[52:55], s95 offen offset:2048 nt lds
    buffer_load_dwordx4 v13, s[52:55], s95 offen offset:3072 nt lds
    s_add_u32 s95, s95, 131072
    s_add_u32 s39, s90, s62
    s_mov_b32 m0, s39
    s_add_u32 s62, s62, 4096
    s_and_b32 s62, s62, 0x7fff
    buffer_load_dwordx4 v10, s[52:55], s95 offen offset:0 nt lds
    buffer_load_dwordx4 v11, s[52:55], s95 offen offset:1024 nt lds
    buffer_load_dwordx4 v12, s[52:55], s95 offen offset:2048 nt lds
    buffer_load_dwordx4 v13, s[52:55], s95 offen offset:3072 nt lds
    s_add_u32 s95, s95, 131072
    s_add_u32 s39, s90, s62
    s_mov_b32 m0, s39
    s_add_u32 s62, s62, 4096
    s_and_b32 s62, s62, 0x7fff
    buffer_load_dwordx4 v10, s[52:55], s95 offen offset:0 nt lds
    buffer_load_dwordx4 v11, s[52:55], s95 offen offset:1024 nt lds
    buffer_load_dwordx4 v12, s[52:55], s95 offen offset:2048 nt lds
    buffer_load_dwordx4 v13, s[52:55], s95 offen offset:3072 nt lds
    s_add_u32 s95, s95, 131072
    s_waitcnt lgkmcnt(0)
    s_add_u32 s35, s35, 0x5b
    s_and_b32 s35, s35, 0xff
    v_mov_b32 v8, s35
    s_or_b32 s68, s35, 0x6b3ac500
    s_mov_b32 s52, s14
    s_and_b32 s53, s15, 0xffff
    s_mov_b32 s54, 4194304
    s_mov_b32 s55, 0x20000
    s_mov_b32 s95, s63
    s_waitcnt vmcnt(24)
    ds_read_b64_tr_b16 a[128:129], v136 offset:0
    ds_read_b64_tr_b16 a[130:131], v137 offset:1024
    ds_read_b64_tr_b16 a[144:145], v138 offset:0
    ds_read_b64_tr_b16 a[146:147], v139 offset:1024
    ds_read_b64_tr_b16 a[160:161], v140 offset:0
    ds_read_b64_tr_b16 a[162:163], v141 offset:1024
    ds_read_b64_tr_b16 a[176:177], v142 offset:0
    ds_read_b64_tr_b16 a[178:179], v143 offset:1024
    ds_read_b64_tr_b16 a[192:193], v144 offset:0
    ds_read_b64_tr_b16 a[194:195], v145 offset:1024
    ds_read_b64_tr_b16 a[208:209], v146 offset:0
    ds_read_b64_tr_b16 a[210:211], v147 offset:1024
    ds_read_b64_tr_b16 a[224:225], v148 offset:0
    ds_read_b64_tr_b16 a[226:227], v149 offset:1024
    ds_read_b64_tr_b16 a[240:241], v150 offset:0
    ds_read_b64_tr_b16 a[242:243], v151 offset:1024
    s_waitcnt lgkmcnt(0)
    s_add_u32 s39, s90, s62
    s_mov_b32 m0, s39
    s_add_u32 s62, s62, 4096
    s_and_b32 s62, s62, 0x7fff
    buffer_load_dwordx4 v76, s[52:55], s95 offen offset:0 nt lds
    buffer_load_dwordx4 v77, s[52:55], s95 offen offset:1024 nt lds
    buffer_load_dwordx4 v78, s[52:55], s95 offen offset:2048 nt lds
    buffer_load_dwordx4 v79, s[52:55], s95 offen offset:3072 nt lds
    s_add_u32 s95, s95, 16384
    s_add_u32 s39, s90, s62
    s_mov_b32 m0, s39
    s_add_u32 s62, s62, 4096
    s_and_b32 s62, s62, 0x7fff
    buffer_load_dwordx4 v76, s[52:55], s95 offen offset:0 nt lds
    buffer_load_dwordx4 v77, s[52:55], s95 offen offset:1024 nt lds
    buffer_load_dwordx4 v78, s[52:55], s95 offen offset:2048 nt lds
    buffer_load_dwordx4 v79, s[52:55], s95 offen offset:3072 nt lds
    s_add_u32 s95, s95, 16384
    s_waitcnt vmcnt(24)
    ds_read_b64_tr_b16 a[132:133], v136 offset:8192
    ds_read_b64_tr_b16 a[134:135], v137 offset:9216
    ds_read_b64_tr_b16 a[148:149], v138 offset:8192
    ds_read_b64_tr_b16 a[150:151], v139 offset:9216
    ds_read_b64_tr_b16 a[164:165], v140 offset:8192
    ds_read_b64_tr_b16 a[166:167], v141 offset:9216
    ds_read_b64_tr_b16 a[180:181], v142 offset:8192
    ds_read_b64_tr_b16 a[182:183], v143 offset:9216
    ds_read_b64_tr_b16 a[196:197], v144 offset:8192
    ds_read_b64_tr_b16 a[198:199], v145 offset:9216
    ds_read_b64_tr_b16 a[212:213], v146 offset:8192
    ds_read_b64_tr_b16 a[214:215], v147 offset:9216
    ds_read_b64_tr_b16 a[228:229], v148 offset:8192
    ds_read_b64_tr_b16 a[230:231], v149 offset:9216
    ds_read_b64_tr_b16 a[244:245], v150 offset:8192
    ds_read_b64_tr_b16 a[246:247], v151 offset:9216
    s_waitcnt lgkmcnt(0)
    s_add_u32 s39, s90, s62
    s_mov_b32 m0, s39
    s_add_u32 s62, s62, 4096
    s_and_b32 s62, s62, 0x7fff
    buffer_load_dwordx4 v76, s[52:55], s95 offen offset:0 nt lds
    buffer_load_dwordx4 v77, s[52:55], s95 offen offset:1024 nt lds
    buffer_load_dwordx4 v78, s[52:55], s95 offen offset:2048 nt lds
    buffer_load_dwordx4 v79, s[52:55], s95 offen offset:3072 nt lds
    s_add_u32 s95, s95, 16384
    s_add_u32 s39, s90, s62
    s_mov_b32 m0, s39
    s_add_u32 s62, s62, 4096
    s_and_b32 s62, s62, 0x7fff
    buffer_load_dwordx4 v76, s[52:55], s95 offen offset:0 nt lds
    buffer_load_dwordx4 v77, s[52:55], s95 offen offset:1024 nt lds
    buffer_load_dwordx4 v78, s[52:55], s95 offen offset:2048 nt lds
    buffer_load_dwordx4 v79, s[52:55], s95 offen offset:3072 nt lds
    s_add_u32 s95, s95, 16384
    s_waitcnt vmcnt(24)
    ds_read_b64_tr_b16 a[136:137], v136 offset:16384
    ds_read_b64_tr_b16 a[138:139], v137 offset:17408
    ds_read_b64_tr_b16 a[152:153], v138 offset:16384
    ds_read_b64_tr_b16 a[154:155], v139 offset:17408
    ds_read_b64_tr_b16 a[168:169], v140 offset:16384
    ds_read_b64_tr_b16 a[170:171], v141 offset:17408
    ds_read_b64_tr_b16 a[184:185], v142 offset:16384
    ds_read_b64_tr_b16 a[186:187], v143 offset:17408
    ds_read_b64_tr_b16 a[200:201], v144 offset:16384
    ds_read_b64_tr_b16 a[202:203], v145 offset:17408
    ds_read_b64_tr_b16 a[216:217], v146 offset:16384
    ds_read_b64_tr_b16 a[218:219], v147 offset:17408
    ds_read_b64_tr_b16 a[232:233], v148 offset:16384
    ds_read_b64_tr_b16 a[234:235], v149 offset:17408
    ds_read_b64_tr_b16 a[248:249], v150 offset:16384
    ds_read_b64_tr_b16 a[250:251], v151 offset:17408
    s_waitcnt lgkmcnt(0)
    s_add_u32 s39, s90, s62
    s_mov_b32 m0, s39
    s_add_u32 s62, s62, 4096
    s_and_b32 s62, s62, 0x7fff
    buffer_load_dwordx4 v76, s[52:55], s95 offen offset:0 nt lds
    buffer_load_dwordx4 v77, s[52:55], s95 offen offset:1024 nt lds
    buffer_load_dwordx4 v78, s[52:55], s95 offen offset:2048 nt lds
    buffer_load_dwordx4 v79, s[52:55], s95 offen offset:3072 nt lds
    s_add_u32 s95, s95, 16384
    s_add_u32 s39, s90, s62
    s_mov_b32 m0, s39
    s_add_u32 s62, s62, 4096
    s_and_b32 s62, s62, 0x7fff
    buffer_load_dwordx4 v76, s[52:55], s95 offen offset:0 nt lds
    buffer_load_dwordx4 v77, s[52:55], s95 offen offset:1024 nt lds
    buffer_load_dwordx4 v78, s[52:55], s95 offen offset:2048 nt lds
    buffer_load_dwordx4 v79, s[52:55], s95 offen offset:3072 nt lds
    s_add_u32 s95, s95, 16384
    s_waitcnt vmcnt(24)
    ds_read_b64_tr_b16 a[140:141], v136 offset:24576
    ds_read_b64_tr_b16 a[142:143], v137 offset:25600
    ds_read_b64_tr_b16 a[156:157], v138 offset:24576
    ds_read_b64_tr_b16 a[158:159], v139 offset:25600
    ds_read_b64_tr_b16 a[172:173], v140 offset:24576
    ds_read_b64_tr_b16 a[174:175], v141 offset:25600
    ds_read_b64_tr_b16 a[188:189], v142 offset:24576
    ds_read_b64_tr_b16 a[190:191], v143 offset:25600
    ds_read_b64_tr_b16 a[204:205], v144 offset:24576
    ds_read_b64_tr_b16 a[206:207], v145 offset:25600
    ds_read_b64_tr_b16 a[220:221], v146 offset:24576
    ds_read_b64_tr_b16 a[222:223], v147 offset:25600
    ds_read_b64_tr_b16 a[236:237], v148 offset:24576
    ds_read_b64_tr_b16 a[238:239], v149 offset:25600
    ds_read_b64_tr_b16 a[252:253], v150 offset:24576
    ds_read_b64_tr_b16 a[254:255], v151 offset:25600
    s_waitcnt lgkmcnt(0)
    s_add_u32 s39, s90, s62
    s_mov_b32 m0, s39
    s_add_u32 s62, s62, 4096
    s_and_b32 s62, s62, 0x7fff
    buffer_load_dwordx4 v76, s[52:55], s95 offen offset:0 nt lds
    buffer_load_dwordx4 v77, s[52:55], s95 offen offset:1024 nt lds
    buffer_load_dwordx4 v78, s[52:55], s95 offen offset:2048 nt lds
    buffer_load_dwordx4 v79, s[52:55], s95 offen offset:3072 nt lds
    s_add_u32 s95, s95, 16384
    s_add_u32 s39, s90, s62
    s_mov_b32 m0, s39
    s_add_u32 s62, s62, 4096
    s_and_b32 s62, s62, 0x7fff
    buffer_load_dwordx4 v76, s[52:55], s95 offen offset:0 nt lds
    buffer_load_dwordx4 v77, s[52:55], s95 offen offset:1024 nt lds
    buffer_load_dwordx4 v78, s[52:55], s95 offen offset:2048 nt lds
    buffer_load_dwordx4 v79, s[52:55], s95 offen offset:3072 nt lds
    s_add_u32 s95, s95, 16384
    s_mov_b32 s52, s6
    s_and_b32 s53, s7, 0xffff
    s_mov_b32 s54, 16777216
    s_mov_b32 s55, 0x20000
    s_lshl_b32 s95, s32, 19
    s_lshl_b32 s38, s34, 8
    s_add_u32 s95, s95, s38
    s_waitcnt vmcnt(24)
    ds_read_b64_tr_b16 a[0:1], v136 offset:0
    ds_read_b64_tr_b16 a[2:3], v137 offset:1024
    ds_read_b64_tr_b16 a[16:17], v138 offset:0
    ds_read_b64_tr_b16 a[18:19], v139 offset:1024
    ds_read_b64_tr_b16 a[32:33], v140 offset:0
    ds_read_b64_tr_b16 a[34:35], v141 offset:1024
    ds_read_b64_tr_b16 a[48:49], v142 offset:0
    ds_read_b64_tr_b16 a[50:51], v143 offset:1024
    ds_read_b64_tr_b16 a[64:65], v144 offset:0
    ds_read_b64_tr_b16 a[66:67], v145 offset:1024
    ds_read_b64_tr_b16 a[80:81], v146 offset:0
    ds_read_b64_tr_b16 a[82:83], v147 offset:1024
    ds_read_b64_tr_b16 a[96:97], v148 offset:0
    ds_read_b64_tr_b16 a[98:99], v149 offset:1024
    ds_read_b64_tr_b16 a[112:113], v150 offset:0
    ds_read_b64_tr_b16 a[114:115], v151 offset:1024
    s_waitcnt lgkmcnt(0)
    s_add_u32 s39, s90, s62
    s_mov_b32 m0, s39
    s_add_u32 s62, s62, 4096
    s_and_b32 s62, s62, 0x7fff
    buffer_load_dwordx4 v76, s[52:55], s95 offen offset:0 nt lds
    buffer_load_dwordx4 v77, s[52:55], s95 offen offset:1024 nt lds
    buffer_load_dwordx4 v78, s[52:55], s95 offen offset:2048 nt lds
    buffer_load_dwordx4 v79, s[52:55], s95 offen offset:3072 nt lds
    s_add_u32 s95, s95, 16384
    s_add_u32 s39, s90, s62
    s_mov_b32 m0, s39
    s_add_u32 s62, s62, 4096
    s_and_b32 s62, s62, 0x7fff
    buffer_load_dwordx4 v76, s[52:55], s95 offen offset:0 nt lds
    buffer_load_dwordx4 v77, s[52:55], s95 offen offset:1024 nt lds
    buffer_load_dwordx4 v78, s[52:55], s95 offen offset:2048 nt lds
    buffer_load_dwordx4 v79, s[52:55], s95 offen offset:3072 nt lds
    s_add_u32 s95, s95, 16384
    s_waitcnt vmcnt(24)
    ds_read_b64_tr_b16 a[4:5], v136 offset:8192
    ds_read_b64_tr_b16 a[6:7], v137 offset:9216
    ds_read_b64_tr_b16 a[20:21], v138 offset:8192
    ds_read_b64_tr_b16 a[22:23], v139 offset:9216
    ds_read_b64_tr_b16 a[36:37], v140 offset:8192
    ds_read_b64_tr_b16 a[38:39], v141 offset:9216
    ds_read_b64_tr_b16 a[52:53], v142 offset:8192
    ds_read_b64_tr_b16 a[54:55], v143 offset:9216
    ds_read_b64_tr_b16 a[68:69], v144 offset:8192
    ds_read_b64_tr_b16 a[70:71], v145 offset:9216
    ds_read_b64_tr_b16 a[84:85], v146 offset:8192
    ds_read_b64_tr_b16 a[86:87], v147 offset:9216
    ds_read_b64_tr_b16 a[100:101], v148 offset:8192
    ds_read_b64_tr_b16 a[102:103], v149 offset:9216
    ds_read_b64_tr_b16 a[116:117], v150 offset:8192
    ds_read_b64_tr_b16 a[118:119], v151 offset:9216
    s_waitcnt lgkmcnt(0)
    s_add_u32 s39, s90, s62
    s_mov_b32 m0, s39
    s_add_u32 s62, s62, 4096
    s_and_b32 s62, s62, 0x7fff
    buffer_load_dwordx4 v76, s[52:55], s95 offen offset:0 nt lds
    buffer_load_dwordx4 v77, s[52:55], s95 offen offset:1024 nt lds
    buffer_load_dwordx4 v78, s[52:55], s95 offen offset:2048 nt lds
    buffer_load_dwordx4 v79, s[52:55], s95 offen offset:3072 nt lds
    s_add_u32 s95, s95, 16384
    s_add_u32 s39, s90, s62
    s_mov_b32 m0, s39
    s_add_u32 s62, s62, 4096
    s_and_b32 s62, s62, 0x7fff
    buffer_load_dwordx4 v76, s[52:55], s95 offen offset:0 nt lds
    buffer_load_dwordx4 v77, s[52:55], s95 offen offset:1024 nt lds
    buffer_load_dwordx4 v78, s[52:55], s95 offen offset:2048 nt lds
    buffer_load_dwordx4 v79, s[52:55], s95 offen offset:3072 nt lds
    s_add_u32 s95, s95, 16384
    s_waitcnt vmcnt(24)
    ds_read_b64_tr_b16 a[8:9], v136 offset:16384
    ds_read_b64_tr_b16 a[10:11], v137 offset:17408
    ds_read_b64_tr_b16 a[24:25], v138 offset:16384
    ds_read_b64_tr_b16 a[26:27], v139 offset:17408
    ds_read_b64_tr_b16 a[40:41], v140 offset:16384
    ds_read_b64_tr_b16 a[42:43], v141 offset:17408
    ds_read_b64_tr_b16 a[56:57], v142 offset:16384
    ds_read_b64_tr_b16 a[58:59], v143 offset:17408
    ds_read_b64_tr_b16 a[72:73], v144 offset:16384
    ds_read_b64_tr_b16 a[74:75], v145 offset:17408
    ds_read_b64_tr_b16 a[88:89], v146 offset:16384
    ds_read_b64_tr_b16 a[90:91], v147 offset:17408
    ds_read_b64_tr_b16 a[104:105], v148 offset:16384
    ds_read_b64_tr_b16 a[106:107], v149 offset:17408
    ds_read_b64_tr_b16 a[120:121], v150 offset:16384
    ds_read_b64_tr_b16 a[122:123], v151 offset:17408
    s_waitcnt lgkmcnt(0)
    s_add_u32 s39, s90, s62
    s_mov_b32 m0, s39
    s_add_u32 s62, s62, 4096
    s_and_b32 s62, s62, 0x7fff
    buffer_load_dwordx4 v76, s[52:55], s95 offen offset:0 nt lds
    buffer_load_dwordx4 v77, s[52:55], s95 offen offset:1024 nt lds
    buffer_load_dwordx4 v78, s[52:55], s95 offen offset:2048 nt lds
    buffer_load_dwordx4 v79, s[52:55], s95 offen offset:3072 nt lds
    s_add_u32 s95, s95, 16384
    s_add_u32 s39, s90, s62
    s_mov_b32 m0, s39
    s_add_u32 s62, s62, 4096
    s_and_b32 s62, s62, 0x7fff
    buffer_load_dwordx4 v76, s[52:55], s95 offen offset:0 nt lds
    buffer_load_dwordx4 v77, s[52:55], s95 offen offset:1024 nt lds
    buffer_load_dwordx4 v78, s[52:55], s95 offen offset:2048 nt lds
    buffer_load_dwordx4 v79, s[52:55], s95 offen offset:3072 nt lds
    s_add_u32 s95, s95, 16384
    s_waitcnt vmcnt(24)
    ds_read_b64_tr_b16 a[12:13], v136 offset:24576
    ds_read_b64_tr_b16 a[14:15], v137 offset:25600
    ds_read_b64_tr_b16 a[28:29], v138 offset:24576
    ds_read_b64_tr_b16 a[30:31], v139 offset:25600
    ds_read_b64_tr_b16 a[44:45], v140 offset:24576
    ds_read_b64_tr_b16 a[46:47], v141 offset:25600
    ds_read_b64_tr_b16 a[60:61], v142 offset:24576
    ds_read_b64_tr_b16 a[62:63], v143 offset:25600
    ds_read_b64_tr_b16 a[76:77], v144 offset:24576
    ds_read_b64_tr_b16 a[78:79], v145 offset:25600
    ds_read_b64_tr_b16 a[92:93], v146 offset:24576
    ds_read_b64_tr_b16 a[94:95], v147 offset:25600
    ds_read_b64_tr_b16 a[108:109], v148 offset:24576
    ds_read_b64_tr_b16 a[110:111], v149 offset:25600
    ds_read_b64_tr_b16 a[124:125], v150 offset:24576
    ds_read_b64_tr_b16 a[126:127], v151 offset:25600
    s_waitcnt lgkmcnt(0)
    s_mov_b32 s86, 2211840
    buffer_load_dword v7, v101, s[48:51], s86 offen sc1
    s_add_u32 s39, s90, s62
    s_mov_b32 m0, s39
    s_add_u32 s62, s62, 4096
    s_and_b32 s62, s62, 0x7fff
    buffer_load_dwordx4 v76, s[52:55], s95 offen offset:0 nt lds
    buffer_load_dwordx4 v77, s[52:55], s95 offen offset:1024 nt lds
    buffer_load_dwordx4 v78, s[52:55], s95 offen offset:2048 nt lds
    buffer_load_dwordx4 v79, s[52:55], s95 offen offset:3072 nt lds
    s_add_u32 s95, s95, 16384
    s_add_u32 s39, s90, s62
    s_mov_b32 m0, s39
    s_add_u32 s62, s62, 4096
    s_and_b32 s62, s62, 0x7fff
    buffer_load_dwordx4 v76, s[52:55], s95 offen offset:0 nt lds
    v_mov_b32 v136, 0
    v_mov_b32 v137, 0
    v_mov_b32 v138, 0
    v_mov_b32 v139, 0
    v_mov_b32 v140, 0
    v_mov_b32 v141, 0
    v_mov_b32 v142, 0
    v_mov_b32 v143, 0
    v_mov_b32 v144, 0
    v_mov_b32 v145, 0
    v_mov_b32 v146, 0
    v_mov_b32 v147, 0
    v_mov_b32 v148, 0
    v_mov_b32 v149, 0
    v_mov_b32 v150, 0
    v_mov_b32 v151, 0
    v_mov_b32 v152, 0
    v_mov_b32 v153, 0
    v_mov_b32 v154, 0
    v_mov_b32 v155, 0
    v_mov_b32 v156, 0
    v_mov_b32 v157, 0
    v_mov_b32 v158, 0
    v_mov_b32 v159, 0
    v_mov_b32 v160, 0
    v_mov_b32 v161, 0
    v_mov_b32 v162, 0
    v_mov_b32 v163, 0
    v_mov_b32 v164, 0
    v_mov_b32 v165, 0
    v_mov_b32 v166, 0
    v_mov_b32 v167, 0
    v_mov_b32 v168, 0
    v_mov_b32 v169, 0
    v_mov_b32 v170, 0
    v_mov_b32 v171, 0
    v_mov_b32 v172, 0
    v_mov_b32 v173, 0
    v_mov_b32 v174, 0
    v_mov_b32 v175, 0
    v_mov_b32 v176, 0
    v_mov_b32 v177, 0
    v_mov_b32 v178, 0
    v_mov_b32 v179, 0
    v_mov_b32 v180, 0
    v_mov_b32 v181, 0
    v_mov_b32 v182, 0
    v_mov_b32 v183, 0
    v_mov_b32 v184, 0
    v_mov_b32 v185, 0
    v_mov_b32 v186, 0
    v_mov_b32 v187, 0
    v_mov_b32 v188, 0
    v_mov_b32 v189, 0
    v_mov_b32 v190, 0
    v_mov_b32 v191, 0
    v_mov_b32 v192, 0
    v_mov_b32 v193, 0
    v_mov_b32 v194, 0
    v_mov_b32 v195, 0
    v_mov_b32 v196, 0
    v_mov_b32 v197, 0
    v_mov_b32 v198, 0
    v_mov_b32 v199, 0
    v_mov_b32 v90, 0xff7f0000
    s_mov_b32 s93, 0
    v_mov_b32 v102, 0
    v_mov_b32 v103, 0
    s_mov_b32 s60, s83
    s_mov_b32 s61, s83
    v_add_u32 v4, s85, v80
    v_xor_b32 v82, 0, v4
    v_xor_b32 v83, 32, v4
    v_xor_b32 v84, 64, v4
    v_xor_b32 v85, 96, v4
    v_xor_b32 v86, 128, v4
    v_xor_b32 v87, 160, v4
    v_xor_b32 v88, 192, v4
    v_xor_b32 v89, 224, v4
    v_add_u32 v80, s90, v80
    v_add_u32 v81, s90, v81
    s_bfe_u32 s38, s32, 0x10003
    s_lshl_b32 s38, s38, 17
    s_add_u32 s36, s38, 2179072
    s_lshr_b32 s38, s32, 4
    s_lshl_b32 s38, s38, 13
    s_add_u32 s36, s38, s36
    s_lshl_b32 s38, s34, 8
    s_add_u32 s36, s38, s36
    s_waitcnt vmcnt(5)
L_fcheck_16:
    v_cmp_ne_u32 vcc, s68, v7
    s_cbranch_vccz L_fok_17
    s_sleep 2
    s_mov_b32 s86, 2211840
    buffer_load_dword v7, v101, s[48:51], s86 offen sc1
    s_waitcnt vmcnt(0)
    s_sub_u32 s84, s84, 1
    s_cmp_lg_u32 s84, 0
    s_cbranch_scc1 L_fcheck_16
    s_branch L_end
L_fok_17:
    buffer_load_dwordx4 v[20:23], v9, s[48:51], s36 offen sc1
    s_add_u32 s36, s36, 262144
    buffer_load_dwordx4 v[24:27], v9, s[48:51], s36 offen sc1
    s_add_u32 s36, s36, 262144
    buffer_load_dwordx4 v[28:31], v9, s[48:51], s36 offen sc1
    s_add_u32 s36, s36, 262144
    buffer_load_dwordx4 v[32:35], v9, s[48:51], s36 offen sc1
    s_add_u32 s36, s36, 262144
    buffer_load_dwordx4 v[36:39], v9, s[48:51], s36 offen sc1
    s_add_u32 s36, s36, 262144
    buffer_load_dwordx4 v[40:43], v9, s[48:51], s36 offen sc1
    s_add_u32 s36, s36, 262144
    buffer_load_dwordx4 v[44:47], v9, s[48:51], s36 offen sc1
    s_add_u32 s36, s36, 262144
    buffer_load_dwordx4 v[48:51], v9, s[48:51], s36 offen sc1
    s_waitcnt vmcnt(7)
    ds_write_b128 v96, v[20:23] offset:0
    s_waitcnt vmcnt(6)
    ds_write_b128 v97, v[24:27] offset:1024
    s_waitcnt vmcnt(5)
    ds_write_b128 v98, v[28:31] offset:2048
    s_waitcnt vmcnt(4)
    ds_write_b128 v99, v[32:35] offset:3072
    s_waitcnt vmcnt(3)
    ds_write_b128 v96, v[36:39] offset:4096
    s_waitcnt vmcnt(2)
    ds_write_b128 v97, v[40:43] offset:5120
    s_waitcnt vmcnt(1)
    ds_write_b128 v98, v[44:47] offset:6144
    s_waitcnt vmcnt(0)
    ds_write_b128 v99, v[48:51] offset:7168
    s_waitcnt lgkmcnt(0)
    ds_read_b128 v[104:107], v82
    ds_read_b128 v[108:111], v83
    ds_read_b128 v[112:115], v84
    ds_read_b128 v[116:119], v85
    ds_read_b128 v[120:123], v86
    ds_read_b128 v[124:127], v87
    ds_read_b128 v[128:131], v88
    ds_read_b128 v[132:135], v89
    v_xor_b32 v82, 0, v80
    ds_read_b128 v[216:219], v82
    v_xor_b32 v83, 32, v80
    ds_read_b128 v[220:223], v83
    v_xor_b32 v84, 64, v80
    ds_read_b128 v[224:227], v84
    v_xor_b32 v85, 96, v80
    ds_read_b128 v[228:231], v85
    v_xor_b32 v86, 128, v80
    ds_read_b128 v[232:235], v86
    v_xor_b32 v87, 160, v80
    ds_read_b128 v[236:239], v87
    v_xor_b32 v88, 192, v80
    ds_read_b128 v[240:243], v88
    v_xor_b32 v89, 224, v80
    ds_read_b128 v[244:247], v89
L_att:
    v_add_u32 v4, s94, v81
    s_waitcnt lgkmcnt(0)
    v_mfma_f32_32x32x16_bf16 v[200:215], v[216:219], v[104:107], 0
    v_xor_b32 v82, 0, v4
    ds_read_b64_tr_b16 v[20:21], v82 offset:0
    ds_read_b64_tr_b16 v[24:25], v82 offset:4096
    buffer_load_dwordx4 v77, s[52:55], s95 offen offset:1024 nt lds
    v_mfma_f32_32x32x16_bf16 v[200:215], v[220:223], v[108:111], v[200:215]
    v_xor_b32 v83, 32, v4
    ds_read_b64_tr_b16 v[22:23], v83 offset:2048
    ds_read_b64_tr_b16 v[26:27], v83 offset:6144
    v_mfma_f32_32x32x16_bf16 v[200:215], v[224:227], v[112:115], v[200:215]
    v_xor_b32 v84, 64, v4
    ds_read_b64_tr_b16 v[28:29], v84 offset:0
    ds_read_b64_tr_b16 v[32:33], v84 offset:4096
    v_mfma_f32_32x32x16_bf16 v[200:215], v[228:231], v[116:119], v[200:215]
    v_xor_b32 v85, 96, v4
    ds_read_b64_tr_b16 v[30:31], v85 offset:2048
    ds_read_b64_tr_b16 v[34:35], v85 offset:6144
    v_mfma_f32_32x32x16_bf16 v[200:215], v[232:235], v[120:123], v[200:215]
    v_xor_b32 v86, 128, v4
    ds_read_b64_tr_b16 v[36:37], v86 offset:0
    ds_read_b64_tr_b16 v[40:41], v86 offset:4096
    buffer_load_dwordx4 v78, s[52:55], s95 offen offset:2048 nt lds
    v_mfma_f32_32x32x16_bf16 v[200:215], v[236:239], v[124:127], v[200:215]
    v_xor_b32 v87, 160, v4
    ds_read_b64_tr_b16 v[38:39], v87 offset:2048
    ds_read_b64_tr_b16 v[42:43], v87 offset:6144
    v_mfma_f32_32x32x16_bf16 v[200:215], v[240:243], v[128:131], v[200:215]
    v_xor_b32 v88, 192, v4
    ds_read_b64_tr_b16 v[44:45], v88 offset:0
    ds_read_b64_tr_b16 v[48:49], v88 offset:4096
    v_mfma_f32_32x32x16_bf16 v[200:215], v[244:247], v[132:135], v[200:215]
    v_xor_b32 v89, 224, v4
    ds_read_b64_tr_b16 v[46:47], v89 offset:2048
    ds_read_b64_tr_b16 v[50:51], v89 offset:6144
    buffer_load_dwordx4 v79, s[52:55], s95 offen offset:3072 nt lds
    s_add_u32 s95, s95, 16384
    v_xor_b32 v5, 0x2000, v94
    v_xor_b32 v6, 0x4000, v94
    v_xor_b32 v7, 0x6000, v94
    s_cmp_lg_u32 s93, 12
    s_cbranch_scc1 L_noswitch_18
    s_mov_b32 s52, s24
    s_and_b32 s53, s25, 0xffff
    s_mov_b32 s54, 4194304
    s_mov_b32 s55, 0x20000
    s_mov_b32 s95, s63
L_noswitch_18:
    s_nop 1
    ds_write_b128 v94, v[200:203] offset:0
    ds_write_b128 v94, v[204:207] offset:1024
    ds_write_b128 v94, v[208:211] offset:2048
    ds_write_b128 v94, v[212:215] offset:3072
    s_waitcnt lgkmcnt(0)
    s_barrier
    ds_read_b128 v[60:63], v5 offset:0
    ds_read_b128 v[216:219], v6 offset:0
    ds_read_b128 v[232:235], v7 offset:0
    ds_read_b128 v[64:67], v5 offset:1024
    ds_read_b128 v[220:223], v6 offset:1024
    ds_read_b128 v[236:239], v7 offset:1024
    ds_read_b128 v[68:71], v5 offset:2048
    ds_read_b128 v[224:227], v6 offset:2048
    ds_read_b128 v[240:243], v7 offset:2048
    ds_read_b128 v[72:75], v5 offset:3072
    ds_read_b128 v[228:231], v6 offset:3072
    ds_read_b128 v[244:247], v7 offset:3072
    v_xor_b32 v94, 0x1000, v94
    s_add_u32 s39, s90, s62
    s_mov_b32 m0, s39
    s_add_u32 s62, s62, 4096
    s_and_b32 s62, s62, 0x7fff
    buffer_load_dwordx4 v76, s[52:55], s95 offen offset:0 nt lds
    s_add_u32 s94, s94, 8192
    s_and_b32 s94, s94, 0x7fff
    s_waitcnt lgkmcnt(9)
    v_pk_add_f32 v[200:201], v[200:201], v[60:61]
    v_pk_add_f32 v[216:217], v[216:217], v[232:233]
    v_pk_add_f32 v[202:203], v[202:203], v[62:63]
    v_pk_add_f32 v[218:219], v[218:219], v[234:235]
    v_pk_add_f32 v[200:201], v[200:201], v[216:217]
    v_pk_add_f32 v[202:203], v[202:203], v[218:219]
    s_waitcnt lgkmcnt(6)
    v_pk_add_f32 v[204:205], v[204:205], v[64:65]
    v_pk_add_f32 v[220:221], v[220:221], v[236:237]
    v_pk_add_f32 v[206:207], v[206:207], v[66:67]
    v_pk_add_f32 v[222:223], v[222:223], v[238:239]
    v_pk_add_f32 v[204:205], v[204:205], v[220:221]
    v_pk_add_f32 v[206:207], v[206:207], v[222:223]
    s_waitcnt lgkmcnt(3)
    v_pk_add_f32 v[208:209], v[208:209], v[68:69]
    v_pk_add_f32 v[224:225], v[224:225], v[240:241]
    v_pk_add_f32 v[210:211], v[210:211], v[70:71]
    v_pk_add_f32 v[226:227], v[226:227], v[242:243]
    v_pk_add_f32 v[208:209], v[208:209], v[224:225]
    v_pk_add_f32 v[210:211], v[210:211], v[226:227]
    s_waitcnt lgkmcnt(0)
    v_pk_add_f32 v[212:213], v[212:213], v[72:73]
    v_pk_add_f32 v[228:229], v[228:229], v[244:245]
    v_pk_add_f32 v[214:215], v[214:215], v[74:75]
    v_pk_add_f32 v[230:231], v[230:231], v[246:247]
    v_pk_add_f32 v[212:213], v[212:213], v[228:229]
    v_pk_add_f32 v[214:215], v[214:215], v[230:231]
    buffer_load_dwordx4 v77, s[52:55], s95 offen offset:1024 nt lds
    v_max_f32 v4, v200, v201
    v_max3_f32 v4, v4, v202, v203
    v_max3_f32 v4, v4, v204, v205
    v_max3_f32 v4, v4, v206, v207
    v_max3_f32 v4, v4, v208, v209
    v_max3_f32 v4, v4, v210, v211
    v_max3_f32 v4, v4, v212, v213
    v_max3_f32 v4, v4, v214, v215
    v_mov_b32 v5, v4
    s_nop 1
    v_permlane32_swap_b32 v4, v5
    v_max_f32 v4, v4, v5
    v_mul_f32 v4, s83, v4
    v_max_f32 v4, v4, v90
    v_sub_f32 v92, v90, v4
    v_exp_f32 v92, v92
    v_mov_b32 v90, v4
    v_pk_fma_f32 v[200:201], v[200:201], s[60:61], v[90:91] op_sel_hi:[1,1,0] neg_lo:[0,0,1] neg_hi:[0,0,1]
    v_pk_fma_f32 v[202:203], v[202:203], s[60:61], v[90:91] op_sel_hi:[1,1,0] neg_lo:[0,0,1] neg_hi:[0,0,1]
    v_pk_fma_f32 v[204:205], v[204:205], s[60:61], v[90:91] op_sel_hi:[1,1,0] neg_lo:[0,0,1] neg_hi:[0,0,1]
    v_pk_fma_f32 v[206:207], v[206:207], s[60:61], v[90:91] op_sel_hi:[1,1,0] neg_lo:[0,0,1] neg_hi:[0,0,1]
    v_pk_fma_f32 v[208:209], v[208:209], s[60:61], v[90:91] op_sel_hi:[1,1,0] neg_lo:[0,0,1] neg_hi:[0,0,1]
    v_pk_fma_f32 v[210:211], v[210:211], s[60:61], v[90:91] op_sel_hi:[1,1,0] neg_lo:[0,0,1] neg_hi:[0,0,1]
    v_pk_fma_f32 v[212:213], v[212:213], s[60:61], v[90:91] op_sel_hi:[1,1,0] neg_lo:[0,0,1] neg_hi:[0,0,1]
    v_pk_fma_f32 v[214:215], v[214:215], s[60:61], v[90:91] op_sel_hi:[1,1,0] neg_lo:[0,0,1] neg_hi:[0,0,1]
    v_exp_f32 v200, v200
    v_exp_f32 v201, v201
    v_exp_f32 v202, v202
    v_exp_f32 v203, v203
    v_exp_f32 v204, v204
    buffer_load_dwordx4 v78, s[52:55], s95 offen offset:2048 nt lds
    v_exp_f32 v205, v205
    v_exp_f32 v206, v206
    v_exp_f32 v207, v207
    v_exp_f32 v208, v208
    v_exp_f32 v209, v209
    v_exp_f32 v210, v210
    v_exp_f32 v211, v211
    v_exp_f32 v212, v212
    v_exp_f32 v213, v213
    v_exp_f32 v214, v214
    v_exp_f32 v215, v215
    v_add_u32 v4, s94, v80
    v_pk_mul_f32 v[102:103], v[102:103], v[92:93] op_sel_hi:[1,0]
    v_pk_mul_f32 v[136:137], v[136:137], v[92:93] op_sel_hi:[1,0]
    v_pk_mul_f32 v[138:139], v[138:139], v[92:93] op_sel_hi:[1,0]
    v_pk_mul_f32 v[140:141], v[140:141], v[92:93] op_sel_hi:[1,0]
    v_pk_mul_f32 v[142:143], v[142:143], v[92:93] op_sel_hi:[1,0]
    v_pk_mul_f32 v[144:145], v[144:145], v[92:93] op_sel_hi:[1,0]
    v_pk_mul_f32 v[146:147], v[146:147], v[92:93] op_sel_hi:[1,0]
    v_pk_mul_f32 v[148:149], v[148:149], v[92:93] op_sel_hi:[1,0]
    v_pk_mul_f32 v[150:151], v[150:151], v[92:93] op_sel_hi:[1,0]
    v_pk_mul_f32 v[152:153], v[152:153], v[92:93] op_sel_hi:[1,0]
    v_pk_mul_f32 v[154:155], v[154:155], v[92:93] op_sel_hi:[1,0]
    v_pk_mul_f32 v[156:157], v[156:157], v[92:93] op_sel_hi:[1,0]
    v_pk_mul_f32 v[158:159], v[158:159], v[92:93] op_sel_hi:[1,0]
    v_pk_mul_f32 v[160:161], v[160:161], v[92:93] op_sel_hi:[1,0]
    v_pk_mul_f32 v[162:163], v[162:163], v[92:93] op_sel_hi:[1,0]
    v_pk_mul_f32 v[164:165], v[164:165], v[92:93] op_sel_hi:[1,0]
    v_pk_mul_f32 v[166:167], v[166:167], v[92:93] op_sel_hi:[1,0]
    v_pk_mul_f32 v[168:169], v[168:169], v[92:93] op_sel_hi:[1,0]
    v_pk_mul_f32 v[170:171], v[170:171], v[92:93] op_sel_hi:[1,0]
    v_pk_mul_f32 v[172:173], v[172:173], v[92:93] op_sel_hi:[1,0]
    v_pk_mul_f32 v[174:175], v[174:175], v[92:93] op_sel_hi:[1,0]
    v_pk_mul_f32 v[176:177], v[176:177], v[92:93] op_sel_hi:[1,0]
    buffer_load_dwordx4 v79, s[52:55], s95 offen offset:3072 nt lds
    s_add_u32 s95, s95, 16384
    v_pk_mul_f32 v[178:179], v[178:179], v[92:93] op_sel_hi:[1,0]
    v_pk_mul_f32 v[180:181], v[180:181], v[92:93] op_sel_hi:[1,0]
    v_pk_mul_f32 v[182:183], v[182:183], v[92:93] op_sel_hi:[1,0]
    v_pk_mul_f32 v[184:185], v[184:185], v[92:93] op_sel_hi:[1,0]
    v_pk_mul_f32 v[186:187], v[186:187], v[92:93] op_sel_hi:[1,0]
    v_pk_mul_f32 v[188:189], v[188:189], v[92:93] op_sel_hi:[1,0]
    v_pk_mul_f32 v[190:191], v[190:191], v[92:93] op_sel_hi:[1,0]
    v_pk_mul_f32 v[192:193], v[192:193], v[92:93] op_sel_hi:[1,0]
    v_pk_mul_f32 v[194:195], v[194:195], v[92:93] op_sel_hi:[1,0]
    v_pk_mul_f32 v[196:197], v[196:197], v[92:93] op_sel_hi:[1,0]
    v_pk_mul_f32 v[198:199], v[198:199], v[92:93] op_sel_hi:[1,0]
    v_cvt_pk_bf16_f32 v52, v200, v201
    v_pk_add_f32 v[102:103], v[102:103], v[200:201]
    v_cvt_pk_bf16_f32 v53, v202, v203
    v_pk_add_f32 v[102:103], v[102:103], v[202:203]
    v_cvt_pk_bf16_f32 v54, v204, v205
    v_pk_add_f32 v[102:103], v[102:103], v[204:205]
    v_cvt_pk_bf16_f32 v55, v206, v207
    v_pk_add_f32 v[102:103], v[102:103], v[206:207]
    v_cvt_pk_bf16_f32 v56, v208, v209
    v_pk_add_f32 v[102:103], v[102:103], v[208:209]
    v_cvt_pk_bf16_f32 v57, v210, v211
    v_pk_add_f32 v[102:103], v[102:103], v[210:211]
    v_cvt_pk_bf16_f32 v58, v212, v213
    v_pk_add_f32 v[102:103], v[102:103], v[212:213]
    v_cvt_pk_bf16_f32 v59, v214, v215
    v_pk_add_f32 v[102:103], v[102:103], v[214:215]
    s_waitcnt vmcnt(20)
    v_mfma_f32_32x32x16_bf16 v[136:151], v[20:23], v[52:55], v[136:151]
    v_xor_b32 v82, 0, v4
    ds_read_b128 v[216:219], v82
    v_xor_b32 v83, 32, v4
    ds_read_b128 v[220:223], v83
    v_mfma_f32_32x32x16_bf16 v[152:167], v[28:31], v[52:55], v[152:167]
    v_xor_b32 v84, 64, v4
    ds_read_b128 v[224:227], v84
    v_xor_b32 v85, 96, v4
    ds_read_b128 v[228:231], v85
    v_mfma_f32_32x32x16_bf16 v[168:183], v[36:39], v[52:55], v[168:183]
    v_xor_b32 v86, 128, v4
    ds_read_b128 v[232:235], v86
    v_xor_b32 v87, 160, v4
    ds_read_b128 v[236:239], v87
    v_mfma_f32_32x32x16_bf16 v[184:199], v[44:47], v[52:55], v[184:199]
    v_xor_b32 v88, 192, v4
    ds_read_b128 v[240:243], v88
    v_xor_b32 v89, 224, v4
    ds_read_b128 v[244:247], v89
    v_mfma_f32_32x32x16_bf16 v[136:151], v[24:27], v[56:59], v[136:151]
    s_add_u32 s39, s90, s62
    s_mov_b32 m0, s39
    s_add_u32 s62, s62, 4096
    s_and_b32 s62, s62, 0x7fff
    buffer_load_dwordx4 v76, s[52:55], s95 offen offset:0 nt lds
    v_mfma_f32_32x32x16_bf16 v[152:167], v[32:35], v[56:59], v[152:167]
    v_mfma_f32_32x32x16_bf16 v[168:183], v[40:43], v[56:59], v[168:183]
    v_mfma_f32_32x32x16_bf16 v[184:199], v[48:51], v[56:59], v[184:199]
    s_add_u32 s93, s93, 1
    s_cmp_lt_u32 s93, 16
    s_cbranch_scc1 L_att
    v_add_f32 v91, v102, v103
    v_mov_b32 v5, v91
    s_nop 1
    v_permlane32_swap_b32 v91, v5
    v_add_f32 v91, v91, v5
    v_and_b32 v4, 31, v1
    v_lshlrev_b32 v5, 8, v4
    v_lshl_add_u32 v5, v3, 4, v5
    v_lshrrev_b32 v6, 5, v1
    v_lshl_add_u32 v5, v6, 3, v5
    v_add_u32 v5, s85, v5
    s_waitcnt lgkmcnt(0)
    s_barrier
    v_cvt_pk_bf16_f32 v20, v136, v137
    v_cvt_pk_bf16_f32 v21, v138, v139
    v_xor_b32 v82, 0, v5
    ds_write_b64 v82, v[20:21]
    v_cvt_pk_bf16_f32 v22, v140, v141
    v_cvt_pk_bf16_f32 v23, v142, v143
    v_xor_b32 v83, 16, v5
    ds_write_b64 v83, v[22:23]
    v_cvt_pk_bf16_f32 v24, v144, v145
    v_cvt_pk_bf16_f32 v25, v146, v147
    v_xor_b32 v84, 32, v5
    ds_write_b64 v84, v[24:25]
    v_cvt_pk_bf16_f32 v26, v148, v149
    v_cvt_pk_bf16_f32 v27, v150, v151
    v_xor_b32 v85, 48, v5
    ds_write_b64 v85, v[26:27]
    v_cvt_pk_bf16_f32 v28, v152, v153
    v_cvt_pk_bf16_f32 v29, v154, v155
    v_xor_b32 v86, 64, v5
    ds_write_b64 v86, v[28:29]
    v_cvt_pk_bf16_f32 v30, v156, v157
    v_cvt_pk_bf16_f32 v31, v158, v159
    v_xor_b32 v87, 80, v5
    ds_write_b64 v87, v[30:31]
    v_cvt_pk_bf16_f32 v32, v160, v161
    v_cvt_pk_bf16_f32 v33, v162, v163
    v_xor_b32 v88, 96, v5
    ds_write_b64 v88, v[32:33]
    v_cvt_pk_bf16_f32 v34, v164, v165
    v_cvt_pk_bf16_f32 v35, v166, v167
    v_xor_b32 v89, 112, v5
    ds_write_b64 v89, v[34:35]
    v_cvt_pk_bf16_f32 v36, v168, v169
    v_cvt_pk_bf16_f32 v37, v170, v171
    v_xor_b32 v82, 128, v5
    ds_write_b64 v82, v[36:37]
    v_cvt_pk_bf16_f32 v38, v172, v173
    v_cvt_pk_bf16_f32 v39, v174, v175
    v_xor_b32 v83, 144, v5
    ds_write_b64 v83, v[38:39]
    v_cvt_pk_bf16_f32 v40, v176, v177
    v_cvt_pk_bf16_f32 v41, v178, v179
    v_xor_b32 v84, 160, v5
    ds_write_b64 v84, v[40:41]
    v_cvt_pk_bf16_f32 v42, v180, v181
    v_cvt_pk_bf16_f32 v43, v182, v183
    v_xor_b32 v85, 176, v5
    ds_write_b64 v85, v[42:43]
    v_cvt_pk_bf16_f32 v44, v184, v185
    v_cvt_pk_bf16_f32 v45, v186, v187
    v_xor_b32 v86, 192, v5
    ds_write_b64 v86, v[44:45]
    v_cvt_pk_bf16_f32 v46, v188, v189
    v_cvt_pk_bf16_f32 v47, v190, v191
    v_xor_b32 v87, 208, v5
    ds_write_b64 v87, v[46:47]
    v_cvt_pk_bf16_f32 v48, v192, v193
    v_cvt_pk_bf16_f32 v49, v194, v195
    v_xor_b32 v88, 224, v5
    ds_write_b64 v88, v[48:49]
    v_cvt_pk_bf16_f32 v50, v196, v197
    v_cvt_pk_bf16_f32 v51, v198, v199
    v_xor_b32 v89, 240, v5
    ds_write_b64 v89, v[50:51]
    v_xor_b32 v6, v3, v2
    v_lshlrev_b32 v6, 4, v6
    v_lshl_add_u32 v6, v2, 8, v6
    v_add_u32 v6, s85, v6
    v_xor_b32 v82, 0, v6
    v_xor_b32 v83, 64, v6
    v_xor_b32 v84, 128, v6
    v_xor_b32 v85, 192, v6
    v_lshlrev_b32 v7, 4, v3
    v_lshrrev_b32 v6, 1, v2
    v_lshl_add_u32 v7, v6, 17, v7
    v_bfe_u32 v6, v2, 0, 1
    v_lshl_add_u32 v7, v6, 15, v7
    s_lshl_b32 s38, s32, 10
    s_add_u32 s36, s38, 4194304
    s_lshl_b32 s38, s34, 8
    s_add_u32 s36, s38, s36
    s_waitcnt lgkmcnt(0)
    ds_read_b128 v[200:203], v82 offset:0
    ds_read_b128 v[204:207], v83 offset:1024
    ds_read_b128 v[208:211], v84 offset:2048
    ds_read_b128 v[212:215], v85 offset:3072
    ds_read_b128 v[216:219], v82 offset:4096
    ds_read_b128 v[220:223], v83 offset:5120
    ds_read_b128 v[224:227], v84 offset:6144
    ds_read_b128 v[228:231], v85 offset:7168
    v_lshlrev_b32 v4, 3, v4
    s_lshr_b32 s38, s32, 1
    s_lshl_b32 s38, s38, 17
    s_add_u32 s37, s38, 4292608
    s_bfe_u32 s38, s32, 0x10000
    s_lshl_b32 s38, s38, 13
    s_add_u32 s37, s38, s37
    s_lshl_b32 s38, s34, 8
    s_add_u32 s37, s38, s37
    s_mov_b32 exec_lo, 0xffffffff
    s_mov_b32 exec_hi, 0x0
    buffer_store_dwordx2 v[90:91], v4, s[48:51], s37 offen sc1
    s_mov_b64 exec, -1
    s_waitcnt lgkmcnt(7)
    buffer_store_dwordx4 v[200:203], v7, s[48:51], s36 offen sc1
    s_add_u32 s36, s36, 262144
    s_waitcnt lgkmcnt(6)
    buffer_store_dwordx4 v[204:207], v7, s[48:51], s36 offen sc1
    s_add_u32 s36, s36, 262144
    s_waitcnt lgkmcnt(5)
    buffer_store_dwordx4 v[208:211], v7, s[48:51], s36 offen sc1
    s_add_u32 s36, s36, 262144
    s_waitcnt lgkmcnt(4)
    buffer_store_dwordx4 v[212:215], v7, s[48:51], s36 offen sc1
    s_add_u32 s36, s36, 262144
    s_waitcnt lgkmcnt(3)
    buffer_store_dwordx4 v[216:219], v7, s[48:51], s36 offen sc1
    s_add_u32 s36, s36, 262144
    s_waitcnt lgkmcnt(2)
    buffer_store_dwordx4 v[220:223], v7, s[48:51], s36 offen sc1
    s_add_u32 s36, s36, 262144
    s_waitcnt lgkmcnt(1)
    buffer_store_dwordx4 v[224:227], v7, s[48:51], s36 offen sc1
    s_add_u32 s36, s36, 262144
    s_waitcnt lgkmcnt(0)
    buffer_store_dwordx4 v[228:231], v7, s[48:51], s36 offen sc1
    buffer_load_dwordx4 v77, s[52:55], s95 offen offset:1024 nt lds
    buffer_load_dwordx4 v78, s[52:55], s95 offen offset:2048 nt lds
    buffer_load_dwordx4 v79, s[52:55], s95 offen offset:3072 nt lds
    s_add_u32 s95, s95, 16384
    v_and_b32 v4, 3, v3
    v_lshrrev_b32 v5, 2, v3
    v_lshlrev_b32 v6, 4, v2
    v_add_u32 v6, 135168, v6
    s_movk_i32 s36, 320
    v_cmp_eq_u32 vcc, 0, v5
    s_nop 1
    v_cndmask_b32 v112, 4, v4, vcc
    v_mad_u32_u24 v112, v112, s36, v6
    v_cmp_eq_u32 vcc, 1, v5
    s_nop 1
    v_cndmask_b32 v113, 4, v4, vcc
    v_mad_u32_u24 v113, v113, s36, v6
    v_cmp_eq_u32 vcc, 2, v5
    s_nop 1
    v_cndmask_b32 v114, 4, v4, vcc
    v_mad_u32_u24 v114, v114, s36, v6
    v_cmp_eq_u32 vcc, 3, v5
    s_nop 1
    v_cndmask_b32 v115, 4, v4, vcc
    v_mad_u32_u24 v115, v115, s36, v6
    s_lshl_b32 s38, s34, 19
    s_add_u32 s36, s38, 0
    s_lshl_b32 s38, s32, 8
    s_add_u32 s36, s38, s36
    v_lshlrev_b32 v77, 4, v3
    v_lshrrev_b32 v5, 1, v2
    v_lshl_add_u32 v77, v5, 17, v77
    v_bfe_u32 v5, v2, 0, 1
    v_lshl_add_u32 v77, v5, 13, v77
    v_add_u32 v77, s36, v77
    s_lshr_b32 s38, s32, 1
    s_lshl_b32 s38, s38, 17
    s_add_u32 s36, s38, 0
    s_bfe_u32 s38, s32, 0x10000
    s_lshl_b32 s38, s38, 13
    s_add_u32 s36, s38, s36
    s_lshl_b32 s38, s34, 6
    s_add_u32 s36, s38, s36
    v_lshrrev_b32 v5, 2, v1
    v_lshlrev_b32 v5, 8, v5
    v_lshl_add_u32 v5, v4, 4, v5
    v_add_u32 v78, s36, v5
    s_lshr_b32 s36, s32, 2
    s_lshl_b32 s36, s36, 7
    s_lshl_b32 s38, s34, 5
    s_add_u32 s36, s36, s38
    s_and_b32 s38, s32, 3
    s_lshl_b32 s38, s38, 3
    s_add_u32 s36, s36, s38
    v_lshlrev_b32 v5, 11, v4
    v_lshl_add_u32 v5, v2, 1, v5
    v_add_u32 v79, s36, v5
    v_bfe_u32 v5, v3, 0, 2
    v_lshlrev_b32 v81, 19, v5
    v_bfe_u32 v5, v3, 3, 1
    v_lshl_add_u32 v81, v5, 17, v81
    v_bfe_u32 v5, v3, 2, 1
    v_lshl_add_u32 v81, v5, 13, v81
    v_and_b32 v5, 12, v3
    v_xor_b32 v5, v5, v2
    v_and_b32 v6, 1, v3
    v_lshlrev_b32 v6, 1, v6
    v_xor_b32 v5, v5, v6
    v_lshlrev_b32 v80, 4, v5
    v_bfe_u32 v6, v3, 0, 2
    v_lshl_add_u32 v80, v6, 11, v80
    v_lshrrev_b32 v6, 2, v3
    v_lshl_add_u32 v80, v6, 8, v80
    v_add_u32 v80, s85, v80
    v_lshlrev_b32 v4, 9, v4
    v_lshl_add_u32 v4, v2, 4, v4
    v_add_u32 v94, s85, v4
    s_lshl_b32 s38, s34, 9
    s_add_u32 s38, s38, 131072
    v_and_b32 v5, 31, v1
    v_lshl_add_u32 v102, v5, 4, s38
    s_mul_i32 s38, s34, 320
    s_add_u32 s38, s38, 135168
    v_lshl_add_u32 v103, v5, 3, s38
    v_lshlrev_b32 v4, 6, v2
    v_lshl_add_u32 v4, v3, 1, v4
    v_add_u32 v93, s38, v4
    v_lshlrev_b32 v4, 7, v2
    v_lshl_add_u32 v4, v3, 4, v4
    v_mov_b32 v5, 512
    v_cmp_gt_u32 vcc, 8, v3
    s_nop 1
    v_cndmask_b32 v92, v5, v4, vcc
    s_mov_b32 s92, 0
    s_mov_b32 s96, 4259840
    s_mov_b32 s97, 0
    s_lshr_b32 s38, s32, 1
    s_lshl_b32 s38, s38, 17
    s_add_u32 s36, s38, 4194304
    s_bfe_u32 s38, s32, 0x10000
    s_lshl_b32 s38, s38, 15
    s_add_u32 s36, s38, s36
    s_lshl_b32 s38, s34, 8
    s_add_u32 s36, s38, s36
    s_lshl_b32 s38, s32, 3
    s_add_u32 s37, s38, 4292608
    s_lshl_b32 s38, s34, 8
    s_add_u32 s37, s38, s37
    s_lshr_b32 s38, s32, 1
    s_lshl_b32 s38, s38, 17
    s_add_u32 s69, s38, 4308992
    s_bfe_u32 s38, s32, 0x10000
    s_lshl_b32 s38, s38, 13
    s_add_u32 s69, s38, s69
    s_lshl_b32 s38, s34, 8
    s_add_u32 s69, s38, s69
    v_mov_b32 v4, s69
    v_mov_b32 v5, s68
    s_waitcnt vmcnt(3)
    s_mov_b64 exec, 1
    buffer_store_dword v5, v4, s[48:51], 0 offen sc1
    s_mov_b64 exec, -1
    s_mov_b32 s86, 4308992
    buffer_load_dword v7, v101, s[48:51], s86 offen sc1
    s_waitcnt vmcnt(0)
L_fcheck_19:
    v_cmp_ne_u32 vcc, s68, v7
    s_cbranch_vccz L_fok_20
    s_sleep 2
    s_mov_b32 s86, 4308992
    buffer_load_dword v7, v101, s[48:51], s86 offen sc1
    s_waitcnt vmcnt(0)
    s_sub_u32 s84, s84, 1
    s_cmp_lg_u32 s84, 0
    s_cbranch_scc1 L_fcheck_19
    s_branch L_end
L_fok_20:
    buffer_load_dwordx2 v[52:53], v81, s[48:51], s37 offen sc1
    s_add_u32 s37, s37, 262144
    buffer_load_dwordx2 v[54:55], v81, s[48:51], s37 offen sc1
    buffer_load_dwordx4 v[200:203], v9, s[48:51], s36 offen sc1
    s_add_u32 s36, s36, 4096
    buffer_load_dwordx4 v[204:207], v9, s[48:51], s36 offen sc1
    s_add_u32 s36, s36, 4096
    buffer_load_dwordx4 v[208:211], v9, s[48:51], s36 offen sc1
    s_add_u32 s36, s36, 4096
    buffer_load_dwordx4 v[212:215], v9, s[48:51], s36 offen sc1
    s_add_u32 s36, s36, 4096
    buffer_load_dwordx4 v[216:219], v9, s[48:51], s36 offen sc1
    s_add_u32 s36, s36, 4096
    buffer_load_dwordx4 v[220:223], v9, s[48:51], s36 offen sc1
    s_add_u32 s36, s36, 4096
    buffer_load_dwordx4 v[224:227], v9, s[48:51], s36 offen sc1
    s_add_u32 s36, s36, 4096
    buffer_load_dwordx4 v[228:231], v9, s[48:51], s36 offen sc1
    v_xor_b32 v82, 0, v80
    v_xor_b32 v83, 64, v80
    v_xor_b32 v84, 128, v80
    v_xor_b32 v85, 192, v80
    v_xor_b32 v86, 16, v80
    v_xor_b32 v87, 80, v80
    v_xor_b32 v88, 144, v80
    v_xor_b32 v89, 208, v80
    s_waitcnt vmcnt(8)
    v_max_f32 v4, v52, v54
    s_nop 1
    v_max_f32_dpp v4, v4, v4 row_ror:8 row_mask:0xf bank_mask:0xf
    s_nop 1
    v_max_f32_dpp v4, v4, v4 row_ror:4 row_mask:0xf bank_mask:0xf
    v_sub_f32 v52, v52, v4
    v_sub_f32 v54, v54, v4
    v_exp_f32 v52, v52
    v_exp_f32 v54, v54
    v_mul_f32 v5, v52, v53
    v_fmac_f32 v5, v54, v55
    s_nop 1
    v_add_f32_dpp v5, v5, v5 row_ror:8 row_mask:0xf bank_mask:0xf
    s_nop 1
    v_add_f32_dpp v5, v5, v5 row_ror:4 row_mask:0xf bank_mask:0xf
    v_rcp_f32 v5, v5
    s_nop 0
    v_mul_f32 v52, v52, v5
    v_mul_f32 v54, v54, v5
    s_waitcnt vmcnt(7)
    ds_write_b128 v96, v[200:203] offset:0
    s_waitcnt vmcnt(6)
    ds_write_b128 v97, v[204:207] offset:1024
    s_waitcnt vmcnt(5)
    ds_write_b128 v98, v[208:211] offset:2048
    s_waitcnt vmcnt(4)
    ds_write_b128 v99, v[212:215] offset:3072
    s_waitcnt vmcnt(3)
    ds_write_b128 v96, v[216:219] offset:4096
    s_waitcnt vmcnt(2)
    ds_write_b128 v97, v[220:223] offset:5120
    s_waitcnt vmcnt(1)
    ds_write_b128 v98, v[224:227] offset:6144
    s_waitcnt vmcnt(0)
    ds_write_b128 v99, v[228:231] offset:7168
    s_waitcnt lgkmcnt(0)
    ds_read_b128 v[20:23], v82 offset:0
    ds_read_b128 v[24:27], v83 offset:0
    ds_read_b128 v[28:31], v84 offset:0
    ds_read_b128 v[32:35], v85 offset:0
    ds_read_b128 v[36:39], v86 offset:1024
    ds_read_b128 v[40:43], v87 offset:1024
    ds_read_b128 v[44:47], v88 offset:1024
    ds_read_b128 v[48:51], v89 offset:1024
    s_waitcnt lgkmcnt(0)
    v_mfma_f32_16x16x32_bf16 v[60:63], a[128:131], v[20:23], 0
    v_mfma_f32_16x16x32_bf16 v[64:67], a[128:131], v[36:39], 0
    v_mfma_f32_16x16x32_bf16 v[60:63], a[132:135], v[24:27], v[60:63]
    v_mfma_f32_16x16x32_bf16 v[64:67], a[132:135], v[40:43], v[64:67]
    v_mfma_f32_16x16x32_bf16 v[60:63], a[136:139], v[28:31], v[60:63]
    v_mfma_f32_16x16x32_bf16 v[64:67], a[136:139], v[44:47], v[64:67]
    v_mfma_f32_16x16x32_bf16 v[60:63], a[140:143], v[32:35], v[60:63]
    v_mfma_f32_16x16x32_bf16 v[64:67], a[140:143], v[48:51], v[64:67]
    v_mfma_f32_16x16x32_bf16 v[68:71], a[144:147], v[20:23], 0
    v_mfma_f32_16x16x32_bf16 v[72:75], a[144:147], v[36:39], 0
    v_mfma_f32_16x16x32_bf16 v[68:71], a[148:151], v[24:27], v[68:71]
    v_mfma_f32_16x16x32_bf16 v[72:75], a[148:151], v[40:43], v[72:75]
    v_mfma_f32_16x16x32_bf16 v[68:71], a[152:155], v[28:31], v[68:71]
    v_mfma_f32_16x16x32_bf16 v[72:75], a[152:155], v[44:47], v[72:75]
    v_mfma_f32_16x16x32_bf16 v[68:71], a[156:159], v[32:35], v[68:71]
    v_mfma_f32_16x16x32_bf16 v[72:75], a[156:159], v[48:51], v[72:75]
    v_mul_f32 v104, v60, v52
    v_mul_f32 v105, v61, v52
    v_mul_f32 v106, v62, v52
    v_mul_f32 v107, v63, v52
    v_fmac_f32 v104, v64, v54
    v_fmac_f32 v105, v65, v54
    v_fmac_f32 v106, v66, v54
    v_fmac_f32 v107, v67, v54
    v_add_f32_dpp v104, v104, v104 row_ror:8 row_mask:0xf bank_mask:0xf
    v_add_f32_dpp v105, v105, v105 row_ror:8 row_mask:0xf bank_mask:0xf
    v_add_f32_dpp v106, v106, v106 row_ror:8 row_mask:0xf bank_mask:0xf
    v_add_f32_dpp v107, v107, v107 row_ror:8 row_mask:0xf bank_mask:0xf
    v_add_f32_dpp v104, v104, v104 row_ror:4 row_mask:0xf bank_mask:0xf
    v_add_f32_dpp v105, v105, v105 row_ror:4 row_mask:0xf bank_mask:0xf
    v_add_f32_dpp v106, v106, v106 row_ror:4 row_mask:0xf bank_mask:0xf
    v_add_f32_dpp v107, v107, v107 row_ror:4 row_mask:0xf bank_mask:0xf
    ds_write_b128 v94, v[104:107] offset:0
    v_mfma_f32_16x16x32_bf16 v[60:63], a[160:163], v[20:23], 0
    v_mfma_f32_16x16x32_bf16 v[64:67], a[160:163], v[36:39], 0
    v_mfma_f32_16x16x32_bf16 v[60:63], a[164:167], v[24:27], v[60:63]
    v_mfma_f32_16x16x32_bf16 v[64:67], a[164:167], v[40:43], v[64:67]
    v_mfma_f32_16x16x32_bf16 v[60:63], a[168:171], v[28:31], v[60:63]
    v_mfma_f32_16x16x32_bf16 v[64:67], a[168:171], v[44:47], v[64:67]
    v_mfma_f32_16x16x32_bf16 v[60:63], a[172:175], v[32:35], v[60:63]
    v_mfma_f32_16x16x32_bf16 v[64:67], a[172:175], v[48:51], v[64:67]
    v_mul_f32 v108, v68, v52
    v_mul_f32 v109, v69, v52
    v_mul_f32 v110, v70, v52
    v_mul_f32 v111, v71, v52
    v_fmac_f32 v108, v72, v54
    v_fmac_f32 v109, v73, v54
    v_fmac_f32 v110, v74, v54
    v_fmac_f32 v111, v75, v54
    v_add_f32_dpp v108, v108, v108 row_ror:8 row_mask:0xf bank_mask:0xf
    v_add_f32_dpp v109, v109, v109 row_ror:8 row_mask:0xf bank_mask:0xf
    v_add_f32_dpp v110, v110, v110 row_ror:8 row_mask:0xf bank_mask:0xf
    v_add_f32_dpp v111, v111, v111 row_ror:8 row_mask:0xf bank_mask:0xf
    v_add_f32_dpp v108, v108, v108 row_ror:4 row_mask:0xf bank_mask:0xf
    v_add_f32_dpp v109, v109, v109 row_ror:4 row_mask:0xf bank_mask:0xf
    v_add_f32_dpp v110, v110, v110 row_ror:4 row_mask:0xf bank_mask:0xf
    v_add_f32_dpp v111, v111, v111 row_ror:4 row_mask:0xf bank_mask:0xf
    ds_write_b128 v94, v[108:111] offset:64
    v_mfma_f32_16x16x32_bf16 v[68:71], a[176:179], v[20:23], 0
    v_mfma_f32_16x16x32_bf16 v[72:75], a[176:179], v[36:39], 0
    v_mfma_f32_16x16x32_bf16 v[68:71], a[180:183], v[24:27], v[68:71]
    v_mfma_f32_16x16x32_bf16 v[72:75], a[180:183], v[40:43], v[72:75]
    v_mfma_f32_16x16x32_bf16 v[68:71], a[184:187], v[28:31], v[68:71]
    v_mfma_f32_16x16x32_bf16 v[72:75], a[184:187], v[44:47], v[72:75]
    v_mfma_f32_16x16x32_bf16 v[68:71], a[188:191], v[32:35], v[68:71]
    v_mfma_f32_16x16x32_bf16 v[72:75], a[188:191], v[48:51], v[72:75]
    v_mul_f32 v104, v60, v52
    v_mul_f32 v105, v61, v52
    v_mul_f32 v106, v62, v52
    v_mul_f32 v107, v63, v52
    v_fmac_f32 v104, v64, v54
    v_fmac_f32 v105, v65, v54
    v_fmac_f32 v106, v66, v54
    v_fmac_f32 v107, v67, v54
    v_add_f32_dpp v104, v104, v104 row_ror:8 row_mask:0xf bank_mask:0xf
    v_add_f32_dpp v105, v105, v105 row_ror:8 row_mask:0xf bank_mask:0xf
    v_add_f32_dpp v106, v106, v106 row_ror:8 row_mask:0xf bank_mask:0xf
    v_add_f32_dpp v107, v107, v107 row_ror:8 row_mask:0xf bank_mask:0xf
    v_add_f32_dpp v104, v104, v104 row_ror:4 row_mask:0xf bank_mask:0xf
    v_add_f32_dpp v105, v105, v105 row_ror:4 row_mask:0xf bank_mask:0xf
    v_add_f32_dpp v106, v106, v106 row_ror:4 row_mask:0xf bank_mask:0xf
    v_add_f32_dpp v107, v107, v107 row_ror:4 row_mask:0xf bank_mask:0xf
    ds_write_b128 v94, v[104:107] offset:128
    v_mfma_f32_16x16x32_bf16 v[60:63], a[192:195], v[20:23], 0
    v_mfma_f32_16x16x32_bf16 v[64:67], a[192:195], v[36:39], 0
    v_mfma_f32_16x16x32_bf16 v[60:63], a[196:199], v[24:27], v[60:63]
    v_mfma_f32_16x16x32_bf16 v[64:67], a[196:199], v[40:43], v[64:67]
    v_mfma_f32_16x16x32_bf16 v[60:63], a[200:203], v[28:31], v[60:63]
    v_mfma_f32_16x16x32_bf16 v[64:67], a[200:203], v[44:47], v[64:67]
    v_mfma_f32_16x16x32_bf16 v[60:63], a[204:207], v[32:35], v[60:63]
    v_mfma_f32_16x16x32_bf16 v[64:67], a[204:207], v[48:51], v[64:67]
    v_mul_f32 v108, v68, v52
    v_mul_f32 v109, v69, v52
    v_mul_f32 v110, v70, v52
    v_mul_f32 v111, v71, v52
    v_fmac_f32 v108, v72, v54
    v_fmac_f32 v109, v73, v54
    v_fmac_f32 v110, v74, v54
    v_fmac_f32 v111, v75, v54
    v_add_f32_dpp v108, v108, v108 row_ror:8 row_mask:0xf bank_mask:0xf
    v_add_f32_dpp v109, v109, v109 row_ror:8 row_mask:0xf bank_mask:0xf
    v_add_f32_dpp v110, v110, v110 row_ror:8 row_mask:0xf bank_mask:0xf
    v_add_f32_dpp v111, v111, v111 row_ror:8 row_mask:0xf bank_mask:0xf
    v_add_f32_dpp v108, v108, v108 row_ror:4 row_mask:0xf bank_mask:0xf
    v_add_f32_dpp v109, v109, v109 row_ror:4 row_mask:0xf bank_mask:0xf
    v_add_f32_dpp v110, v110, v110 row_ror:4 row_mask:0xf bank_mask:0xf
    v_add_f32_dpp v111, v111, v111 row_ror:4 row_mask:0xf bank_mask:0xf
    ds_write_b128 v94, v[108:111] offset:192
    v_mfma_f32_16x16x32_bf16 v[68:71], a[208:211], v[20:23], 0
    v_mfma_f32_16x16x32_bf16 v[72:75], a[208:211], v[36:39], 0
    v_mfma_f32_16x16x32_bf16 v[68:71], a[212:215], v[24:27], v[68:71]
    v_mfma_f32_16x16x32_bf16 v[72:75], a[212:215], v[40:43], v[72:75]
    v_mfma_f32_16x16x32_bf16 v[68:71], a[216:219], v[28:31], v[68:71]
    v_mfma_f32_16x16x32_bf16 v[72:75], a[216:219], v[44:47], v[72:75]
    v_mfma_f32_16x16x32_bf16 v[68:71], a[220:223], v[32:35], v[68:71]
    v_mfma_f32_16x16x32_bf16 v[72:75], a[220:223], v[48:51], v[72:75]
    v_mul_f32 v104, v60, v52
    v_mul_f32 v105, v61, v52
    v_mul_f32 v106, v62, v52
    v_mul_f32 v107, v63, v52
    v_fmac_f32 v104, v64, v54
    v_fmac_f32 v105, v65, v54
    v_fmac_f32 v106, v66, v54
    v_fmac_f32 v107, v67, v54
    v_add_f32_dpp v104, v104, v104 row_ror:8 row_mask:0xf bank_mask:0xf
    v_add_f32_dpp v105, v105, v105 row_ror:8 row_mask:0xf bank_mask:0xf
    v_add_f32_dpp v106, v106, v106 row_ror:8 row_mask:0xf bank_mask:0xf
    v_add_f32_dpp v107, v107, v107 row_ror:8 row_mask:0xf bank_mask:0xf
    v_add_f32_dpp v104, v104, v104 row_ror:4 row_mask:0xf bank_mask:0xf
    v_add_f32_dpp v105, v105, v105 row_ror:4 row_mask:0xf bank_mask:0xf
    v_add_f32_dpp v106, v106, v106 row_ror:4 row_mask:0xf bank_mask:0xf
    v_add_f32_dpp v107, v107, v107 row_ror:4 row_mask:0xf bank_mask:0xf
    ds_write_b128 v94, v[104:107] offset:256
    v_mfma_f32_16x16x32_bf16 v[60:63], a[224:227], v[20:23], 0
    v_mfma_f32_16x16x32_bf16 v[64:67], a[224:227], v[36:39], 0
    v_mfma_f32_16x16x32_bf16 v[60:63], a[228:231], v[24:27], v[60:63]
    v_mfma_f32_16x16x32_bf16 v[64:67], a[228:231], v[40:43], v[64:67]
    v_mfma_f32_16x16x32_bf16 v[60:63], a[232:235], v[28:31], v[60:63]
    v_mfma_f32_16x16x32_bf16 v[64:67], a[232:235], v[44:47], v[64:67]
    v_mfma_f32_16x16x32_bf16 v[60:63], a[236:239], v[32:35], v[60:63]
    v_mfma_f32_16x16x32_bf16 v[64:67], a[236:239], v[48:51], v[64:67]
    v_mul_f32 v108, v68, v52
    v_mul_f32 v109, v69, v52
    v_mul_f32 v110, v70, v52
    v_mul_f32 v111, v71, v52
    v_fmac_f32 v108, v72, v54
    v_fmac_f32 v109, v73, v54
    v_fmac_f32 v110, v74, v54
    v_fmac_f32 v111, v75, v54
    v_add_f32_dpp v108, v108, v108 row_ror:8 row_mask:0xf bank_mask:0xf
    v_add_f32_dpp v109, v109, v109 row_ror:8 row_mask:0xf bank_mask:0xf
    v_add_f32_dpp v110, v110, v110 row_ror:8 row_mask:0xf bank_mask:0xf
    v_add_f32_dpp v111, v111, v111 row_ror:8 row_mask:0xf bank_mask:0xf
    v_add_f32_dpp v108, v108, v108 row_ror:4 row_mask:0xf bank_mask:0xf
    v_add_f32_dpp v109, v109, v109 row_ror:4 row_mask:0xf bank_mask:0xf
    v_add_f32_dpp v110, v110, v110 row_ror:4 row_mask:0xf bank_mask:0xf
    v_add_f32_dpp v111, v111, v111 row_ror:4 row_mask:0xf bank_mask:0xf
    ds_write_b128 v94, v[108:111] offset:320
    v_mfma_f32_16x16x32_bf16 v[68:71], a[240:243], v[20:23], 0
    v_mfma_f32_16x16x32_bf16 v[72:75], a[240:243], v[36:39], 0
    v_mfma_f32_16x16x32_bf16 v[68:71], a[244:247], v[24:27], v[68:71]
    v_mfma_f32_16x16x32_bf16 v[72:75], a[244:247], v[40:43], v[72:75]
    v_mfma_f32_16x16x32_bf16 v[68:71], a[248:251], v[28:31], v[68:71]
    v_mfma_f32_16x16x32_bf16 v[72:75], a[248:251], v[44:47], v[72:75]
    v_mfma_f32_16x16x32_bf16 v[68:71], a[252:255], v[32:35], v[68:71]
    v_mfma_f32_16x16x32_bf16 v[72:75], a[252:255], v[48:51], v[72:75]
    v_mul_f32 v104, v60, v52
    v_mul_f32 v105, v61, v52
    v_mul_f32 v106, v62, v52
    v_mul_f32 v107, v63, v52
    v_fmac_f32 v104, v64, v54
    v_fmac_f32 v105, v65, v54
    v_fmac_f32 v106, v66, v54
    v_fmac_f32 v107, v67, v54
    v_add_f32_dpp v104, v104, v104 row_ror:8 row_mask:0xf bank_mask:0xf
    v_add_f32_dpp v105, v105, v105 row_ror:8 row_mask:0xf bank_mask:0xf
    v_add_f32_dpp v106, v106, v106 row_ror:8 row_mask:0xf bank_mask:0xf
    v_add_f32_dpp v107, v107, v107 row_ror:8 row_mask:0xf bank_mask:0xf
    v_add_f32_dpp v104, v104, v104 row_ror:4 row_mask:0xf bank_mask:0xf
    v_add_f32_dpp v105, v105, v105 row_ror:4 row_mask:0xf bank_mask:0xf
    v_add_f32_dpp v106, v106, v106 row_ror:4 row_mask:0xf bank_mask:0xf
    v_add_f32_dpp v107, v107, v107 row_ror:4 row_mask:0xf bank_mask:0xf
    ds_write_b128 v94, v[104:107] offset:384
    v_mul_f32 v108, v68, v52
    v_mul_f32 v109, v69, v52
    v_mul_f32 v110, v70, v52
    v_mul_f32 v111, v71, v52
    v_fmac_f32 v108, v72, v54
    v_fmac_f32 v109, v73, v54
    v_fmac_f32 v110, v74, v54
    v_fmac_f32 v111, v75, v54
    v_add_f32_dpp v108, v108, v108 row_ror:8 row_mask:0xf bank_mask:0xf
    v_add_f32_dpp v109, v109, v109 row_ror:8 row_mask:0xf bank_mask:0xf
    v_add_f32_dpp v110, v110, v110 row_ror:8 row_mask:0xf bank_mask:0xf
    v_add_f32_dpp v111, v111, v111 row_ror:8 row_mask:0xf bank_mask:0xf
    v_add_f32_dpp v108, v108, v108 row_ror:4 row_mask:0xf bank_mask:0xf
    v_add_f32_dpp v109, v109, v109 row_ror:4 row_mask:0xf bank_mask:0xf
    v_add_f32_dpp v110, v110, v110 row_ror:4 row_mask:0xf bank_mask:0xf
    v_add_f32_dpp v111, v111, v111 row_ror:4 row_mask:0xf bank_mask:0xf
    ds_write_b128 v94, v[108:111] offset:448
    s_waitcnt lgkmcnt(0)
    s_barrier
    ds_read_b128 v[20:23], v102 offset:0
    ds_read_b128 v[24:27], v102 offset:8192
    ds_read_b128 v[28:31], v102 offset:16384
    ds_read_b128 v[32:35], v102 offset:24576
    s_waitcnt lgkmcnt(0)
    v_add_f32 v20, v20, v24
    v_add_f32 v28, v28, v32
    v_add_f32 v21, v21, v25
    v_add_f32 v29, v29, v33
    v_add_f32 v22, v22, v26
    v_add_f32 v30, v30, v34
    v_add_f32 v23, v23, v27
    v_add_f32 v31, v31, v35
    v_add_f32 v20, v20, v28
    v_add_f32 v21, v21, v29
    v_add_f32 v22, v22, v30
    v_add_f32 v23, v23, v31
    v_cvt_pk_bf16_f32 v20, v20, v21
    v_cvt_pk_bf16_f32 v21, v22, v23
    ds_write_b64 v103, v[20:21]
    v_lshlrev_b32 v4, 2, v1
    v_add_u32 v4, 136448, v4
    ds_write_b32 v4, v100
L_final:
    s_waitcnt lgkmcnt(0)
    s_barrier
    ds_read_b128 v[136:139], v112 offset:0
    ds_read_b128 v[140:143], v112 offset:64
    ds_read_b128 v[144:147], v112 offset:128
    ds_read_b128 v[148:151], v112 offset:192
    ds_read_b128 v[152:155], v113 offset:0
    ds_read_b128 v[156:159], v113 offset:64
    s_add_u32 s36, s96, 262144
    s_add_u32 s37, s96, 4096
    s_waitcnt lgkmcnt(5)
    v_mfma_f32_16x16x32_bf16 v[84:87], a[0:3], v[136:139], 0
    ds_read_b128 v[160:163], v113 offset:128
    v_mfma_f32_16x16x32_bf16 v[88:91], a[64:67], v[136:139], 0
    s_waitcnt lgkmcnt(5)
    v_mfma_f32_16x16x32_bf16 v[84:87], a[4:7], v[140:143], v[84:87]
    ds_read_b128 v[164:167], v113 offset:192
    v_mfma_f32_16x16x32_bf16 v[88:91], a[68:71], v[140:143], v[88:91]
    s_waitcnt lgkmcnt(5)
    v_mfma_f32_16x16x32_bf16 v[84:87], a[8:11], v[144:147], v[84:87]
    ds_read_b128 v[168:171], v114 offset:0
    v_mfma_f32_16x16x32_bf16 v[88:91], a[72:75], v[144:147], v[88:91]
    s_waitcnt lgkmcnt(5)
    v_mfma_f32_16x16x32_bf16 v[84:87], a[12:15], v[148:151], v[84:87]
    ds_read_b128 v[172:175], v114 offset:64
    v_mfma_f32_16x16x32_bf16 v[88:91], a[76:79], v[148:151], v[88:91]
    s_waitcnt lgkmcnt(5)
    v_mfma_f32_16x16x32_bf16 v[84:87], a[16:19], v[152:155], v[84:87]
    ds_read_b128 v[176:179], v114 offset:128
    v_mfma_f32_16x16x32_bf16 v[88:91], a[80:83], v[152:155], v[88:91]
    s_waitcnt lgkmcnt(5)
    v_mfma_f32_16x16x32_bf16 v[84:87], a[20:23], v[156:159], v[84:87]
    ds_read_b128 v[180:183], v114 offset:192
    v_mfma_f32_16x16x32_bf16 v[88:91], a[84:87], v[156:159], v[88:91]
    s_waitcnt lgkmcnt(5)
    v_mfma_f32_16x16x32_bf16 v[84:87], a[24:27], v[160:163], v[84:87]
    ds_read_b128 v[184:187], v115 offset:0
    v_mfma_f32_16x16x32_bf16 v[88:91], a[88:91], v[160:163], v[88:91]
    s_waitcnt lgkmcnt(5)
    v_mfma_f32_16x16x32_bf16 v[84:87], a[28:31], v[164:167], v[84:87]
    ds_read_b128 v[188:191], v115 offset:64
    v_mfma_f32_16x16x32_bf16 v[88:91], a[92:95], v[164:167], v[88:91]
    s_waitcnt lgkmcnt(5)
    v_mfma_f32_16x16x32_bf16 v[84:87], a[32:35], v[168:171], v[84:87]
    ds_read_b128 v[192:195], v115 offset:128
    v_mfma_f32_16x16x32_bf16 v[88:91], a[96:99], v[168:171], v[88:91]
    s_waitcnt lgkmcnt(5)
    v_mfma_f32_16x16x32_bf16 v[84:87], a[36:39], v[172:175], v[84:87]
    ds_read_b128 v[196:199], v115 offset:192
    v_mfma_f32_16x16x32_bf16 v[88:91], a[100:103], v[172:175], v[88:91]
    s_waitcnt lgkmcnt(5)
    v_mfma_f32_16x16x32_bf16 v[84:87], a[40:43], v[176:179], v[84:87]
    v_mfma_f32_16x16x32_bf16 v[88:91], a[104:107], v[176:179], v[88:91]
    s_waitcnt lgkmcnt(4)
    v_mfma_f32_16x16x32_bf16 v[84:87], a[44:47], v[180:183], v[84:87]
    v_mfma_f32_16x16x32_bf16 v[88:91], a[108:111], v[180:183], v[88:91]
    s_waitcnt lgkmcnt(3)
    v_mfma_f32_16x16x32_bf16 v[84:87], a[48:51], v[184:187], v[84:87]
    v_mfma_f32_16x16x32_bf16 v[88:91], a[112:115], v[184:187], v[88:91]
    s_waitcnt lgkmcnt(2)
    v_mfma_f32_16x16x32_bf16 v[84:87], a[52:55], v[188:191], v[84:87]
    v_mfma_f32_16x16x32_bf16 v[88:91], a[116:119], v[188:191], v[88:91]
    s_waitcnt lgkmcnt(1)
    v_mfma_f32_16x16x32_bf16 v[84:87], a[56:59], v[192:195], v[84:87]
    v_mfma_f32_16x16x32_bf16 v[88:91], a[120:123], v[192:195], v[88:91]
    s_waitcnt lgkmcnt(0)
    v_mfma_f32_16x16x32_bf16 v[84:87], a[60:63], v[196:199], v[84:87]
    v_mfma_f32_16x16x32_bf16 v[88:91], a[124:127], v[196:199], v[88:91]
    s_nop 6
    v_and_or_b32 v84, v84, s82, v8
    v_and_or_b32 v85, v85, s82, v8
    v_and_or_b32 v86, v86, s82, v8
    v_and_or_b32 v87, v87, s82, v8
    buffer_store_dwordx4 v[84:87], v77, s[48:51], s96 offen sc1
    v_and_or_b32 v88, v88, s82, v8
    v_and_or_b32 v89, v89, s82, v8
    v_and_or_b32 v90, v90, s82, v8
    v_and_or_b32 v91, v91, s82, v8
    buffer_store_dwordx4 v[88:91], v77, s[48:51], s36 offen sc1
    s_cmp_eq_u32 s92, 0
    s_cbranch_scc1 L_prepb
L_hop2:
L_hop2poll:
    buffer_load_dwordx4 v[200:203], v78, s[48:51], s96 offen sc1
    buffer_load_dwordx4 v[204:207], v78, s[48:51], s37 offen sc1
    s_waitcnt vmcnt(0)
    v_xor_b32 v200, s35, v200
    v_xor_b32 v201, s35, v201
    v_xor_b32 v202, s35, v202
    v_xor_b32 v203, s35, v203
    v_xor_b32 v204, s35, v204
    v_xor_b32 v205, s35, v205
    v_xor_b32 v206, s35, v206
    v_xor_b32 v207, s35, v207
    v_or_b32 v4, v200, v201
    v_or3_b32 v4, v4, v202, v203
    v_or3_b32 v4, v4, v204, v205
    v_or3_b32 v4, v4, v206, v207
    v_and_b32 v4, 0xff, v4
    v_cmp_ne_u32 vcc, 0, v4
    v_add_f32 v104, v200, v204
    v_add_f32 v105, v201, v205
    v_add_f32 v106, v202, v206
    v_add_f32 v107, v203, v207
    s_cbranch_vccz L_hop2ok
    s_sub_u32 s84, s84, 1
    s_cmp_lg_u32 s84, 0
    s_cbranch_scc1 L_hop2poll
    s_branch L_end
L_hop2ok:
    v_permlane16_swap_b32 v104, v105
    v_permlane16_swap_b32 v106, v107
    v_add_f32 v104, v104, v105
    v_add_f32 v106, v106, v107
    s_nop 1
    v_permlane32_swap_b32 v104, v106
    v_add_f32 v104, v104, v106
    s_nop 1
    v_add_f32_dpp v104, v104, v104 row_ror:8 row_mask:0xf bank_mask:0xf
    s_nop 1
    v_add_f32_dpp v104, v104, v104 row_ror:4 row_mask:0xf bank_mask:0xf
    v_cvt_pk_bf16_f32 v104, v104, v104
    s_mov_b32 exec_lo, 0xf000f
    s_mov_b32 exec_hi, 0xf000f
    buffer_store_short v104, v79, s[72:75], s97 offen
    s_mov_b64 exec, -1
    s_cmp_lg_u32 s92, 0
    s_cbranch_scc1 L_fin
    s_mov_b32 s92, 1
    s_mov_b32 s96, 4276224
    s_mov_b32 s97, 1024
    s_lshr_b32 s38, s32, 1
    s_lshl_b32 s38, s38, 17
    s_add_u32 s85, s38, 2097152
    s_bfe_u32 s38, s32, 0x10000
    s_lshl_b32 s38, s38, 15
    s_add_u32 s85, s38, s85
    s_lshl_b32 s38, s34, 13
    s_add_u32 s85, s38, s85
    s_branch L_hop1
    v_min_u32 v5, 6, v1
    v_lshlrev_b32 v5, 10, v5
L_light:
    buffer_load_dword v6, v5, s[48:51], s85 offen offset:512 sc1
    s_waitcnt vmcnt(0)
    v_xor_b32 v6, s35, v6
    v_and_b32 v6, 0xff, v6
    v_cmp_ne_u32 vcc, 0, v6
    s_nop 0
    s_and_b32 s36, vcc_lo, 0x7f
    s_bcnt1_i32_b32 s36, s36
    s_cmp_le_u32 s36, 7
    s_cbranch_scc1 L_hop1
    s_sleep 2
    s_sub_u32 s84, s84, 1
    s_cmp_lg_u32 s84, 0
    s_cbranch_scc1 L_light
    s_branch L_end
L_hop1:
    s_mov_b32 s93, 0x7f
    s_mov_b32 s94, 0
    v_mov_b32 v55, 0xff7f0000
    v_mov_b32 v56, 0
    v_mov_b32 v57, 0
    v_mov_b32 v58, 0
    v_mov_b32 v59, 0
    s_and_b32 s94, s94, s93
    s_cselect_b32 s94, s94, s93
    s_ff1_i32_b32 s4, s94
    s_bitset0_b32 s94, s4
    s_lshl_b32 s36, s4, 10
    s_add_u32 s36, s36, s85
    buffer_load_dwordx4 v[20:23], v92, s[48:51], s36 offen sc1
    s_and_b32 s94, s94, s93
    s_cselect_b32 s94, s94, s93
    s_ff1_i32_b32 s5, s94
    s_bitset0_b32 s94, s5
    s_lshl_b32 s36, s5, 10
    s_add_u32 s36, s36, s85
    buffer_load_dwordx4 v[24:27], v92, s[48:51], s36 offen sc1
    s_and_b32 s94, s94, s93
    s_cselect_b32 s94, s94, s93
    s_ff1_i32_b32 s6, s94
    s_bitset0_b32 s94, s6
    s_lshl_b32 s36, s6, 10
    s_add_u32 s36, s36, s85
    buffer_load_dwordx4 v[28:31], v92, s[48:51], s36 offen sc1
    s_and_b32 s94, s94, s93
    s_cselect_b32 s94, s94, s93
    s_ff1_i32_b32 s7, s94
    s_bitset0_b32 s94, s7
    s_lshl_b32 s36, s7, 10
    s_add_u32 s36, s36, s85
    buffer_load_dwordx4 v[32:35], v92, s[48:51], s36 offen sc1
L_hop1poll:
    s_and_b32 s94, s94, s93
    s_cselect_b32 s94, s94, s93
    s_ff1_i32_b32 s8, s94
    s_bitset0_b32 s94, s8
    s_lshl_b32 s36, s8, 10
    s_add_u32 s36, s36, s85
    buffer_load_dwordx4 v[36:39], v92, s[48:51], s36 offen sc1
    s_waitcnt vmcnt(4)
    v_xor_b32 v20, s35, v20
    v_xor_b32 v21, s35, v21
    v_xor_b32 v22, s35, v22
    v_xor_b32 v23, s35, v23
    v_or_b32 v4, v20, v21
    v_or3_b32 v4, v4, v22, v23
    v_and_b32 v4, 0xff, v4
    v_cmp_ne_u32 vcc, 0, v4
    v_max_f32 v5, v55, v20
    s_cbranch_vccnz L_mnext_21
    s_bitcmp1_b32 s93, s4
    s_cbranch_scc0 L_mnext_21
    v_sub_f32 v52, v55, v5
    v_sub_f32 v53, v20, v5
    v_exp_f32 v52, v52
    v_exp_f32 v53, v53
    v_mov_b32 v55, v5
    s_bitset0_b32 s93, s4
    v_mul_f32_dpp v57, v52, v57 row_newbcast:8 row_mask:0xf bank_mask:0xf
    v_mul_f32_dpp v56, v52, v56 row_newbcast:8 row_mask:0xf bank_mask:0xf
    v_mul_f32_dpp v58, v52, v58 row_newbcast:8 row_mask:0xf bank_mask:0xf
    v_mul_f32_dpp v59, v52, v59 row_newbcast:8 row_mask:0xf bank_mask:0xf
    v_fmac_f32_dpp v57, v53, v21 row_newbcast:8 row_mask:0xf bank_mask:0xf
    v_fmac_f32_dpp v56, v53, v20 row_newbcast:8 row_mask:0xf bank_mask:0xf
    v_fmac_f32_dpp v58, v53, v22 row_newbcast:8 row_mask:0xf bank_mask:0xf
    v_fmac_f32_dpp v59, v53, v23 row_newbcast:8 row_mask:0xf bank_mask:0xf
    s_cmp_eq_u32 s93, 0
    s_cbranch_scc1 L_hop1ok
L_mnext_21:
    s_and_b32 s94, s94, s93
    s_cselect_b32 s94, s94, s93
    s_ff1_i32_b32 s4, s94
    s_bitset0_b32 s94, s4
    s_lshl_b32 s36, s4, 10
    s_add_u32 s36, s36, s85
    buffer_load_dwordx4 v[20:23], v92, s[48:51], s36 offen sc1
    s_waitcnt vmcnt(4)
    v_xor_b32 v24, s35, v24
    v_xor_b32 v25, s35, v25
    v_xor_b32 v26, s35, v26
    v_xor_b32 v27, s35, v27
    v_or_b32 v4, v24, v25
    v_or3_b32 v4, v4, v26, v27
    v_and_b32 v4, 0xff, v4
    v_cmp_ne_u32 vcc, 0, v4
    v_max_f32 v5, v55, v24
    s_cbranch_vccnz L_mnext_22
    s_bitcmp1_b32 s93, s5
    s_cbranch_scc0 L_mnext_22
    v_sub_f32 v52, v55, v5
    v_sub_f32 v53, v24, v5
    v_exp_f32 v52, v52
    v_exp_f32 v53, v53
    v_mov_b32 v55, v5
    s_bitset0_b32 s93, s5
    v_mul_f32_dpp v57, v52, v57 row_newbcast:8 row_mask:0xf bank_mask:0xf
    v_mul_f32_dpp v56, v52, v56 row_newbcast:8 row_mask:0xf bank_mask:0xf
    v_mul_f32_dpp v58, v52, v58 row_newbcast:8 row_mask:0xf bank_mask:0xf
    v_mul_f32_dpp v59, v52, v59 row_newbcast:8 row_mask:0xf bank_mask:0xf
    v_fmac_f32_dpp v57, v53, v25 row_newbcast:8 row_mask:0xf bank_mask:0xf
    v_fmac_f32_dpp v56, v53, v24 row_newbcast:8 row_mask:0xf bank_mask:0xf
    v_fmac_f32_dpp v58, v53, v26 row_newbcast:8 row_mask:0xf bank_mask:0xf
    v_fmac_f32_dpp v59, v53, v27 row_newbcast:8 row_mask:0xf bank_mask:0xf
    s_cmp_eq_u32 s93, 0
    s_cbranch_scc1 L_hop1ok
L_mnext_22:
    s_and_b32 s94, s94, s93
    s_cselect_b32 s94, s94, s93
    s_ff1_i32_b32 s5, s94
    s_bitset0_b32 s94, s5
    s_lshl_b32 s36, s5, 10
    s_add_u32 s36, s36, s85
    buffer_load_dwordx4 v[24:27], v92, s[48:51], s36 offen sc1
    s_waitcnt vmcnt(4)
    v_xor_b32 v28, s35, v28
    v_xor_b32 v29, s35, v29
    v_xor_b32 v30, s35, v30
    v_xor_b32 v31, s35, v31
    v_or_b32 v4, v28, v29
    v_or3_b32 v4, v4, v30, v31
    v_and_b32 v4, 0xff, v4
    v_cmp_ne_u32 vcc, 0, v4
    v_max_f32 v5, v55, v28
    s_cbranch_vccnz L_mnext_23
    s_bitcmp1_b32 s93, s6
    s_cbranch_scc0 L_mnext_23
    v_sub_f32 v52, v55, v5
    v_sub_f32 v53, v28, v5
    v_exp_f32 v52, v52
    v_exp_f32 v53, v53
    v_mov_b32 v55, v5
    s_bitset0_b32 s93, s6
    v_mul_f32_dpp v57, v52, v57 row_newbcast:8 row_mask:0xf bank_mask:0xf
    v_mul_f32_dpp v56, v52, v56 row_newbcast:8 row_mask:0xf bank_mask:0xf
    v_mul_f32_dpp v58, v52, v58 row_newbcast:8 row_mask:0xf bank_mask:0xf
    v_mul_f32_dpp v59, v52, v59 row_newbcast:8 row_mask:0xf bank_mask:0xf
    v_fmac_f32_dpp v57, v53, v29 row_newbcast:8 row_mask:0xf bank_mask:0xf
    v_fmac_f32_dpp v56, v53, v28 row_newbcast:8 row_mask:0xf bank_mask:0xf
    v_fmac_f32_dpp v58, v53, v30 row_newbcast:8 row_mask:0xf bank_mask:0xf
    v_fmac_f32_dpp v59, v53, v31 row_newbcast:8 row_mask:0xf bank_mask:0xf
    s_cmp_eq_u32 s93, 0
    s_cbranch_scc1 L_hop1ok
L_mnext_23:
    s_and_b32 s94, s94, s93
    s_cselect_b32 s94, s94, s93
    s_ff1_i32_b32 s6, s94
    s_bitset0_b32 s94, s6
    s_lshl_b32 s36, s6, 10
    s_add_u32 s36, s36, s85
    buffer_load_dwordx4 v[28:31], v92, s[48:51], s36 offen sc1
    s_waitcnt vmcnt(4)
    v_xor_b32 v32, s35, v32
    v_xor_b32 v33, s35, v33
    v_xor_b32 v34, s35, v34
    v_xor_b32 v35, s35, v35
    v_or_b32 v4, v32, v33
    v_or3_b32 v4, v4, v34, v35
    v_and_b32 v4, 0xff, v4
    v_cmp_ne_u32 vcc, 0, v4
    v_max_f32 v5, v55, v32
    s_cbranch_vccnz L_mnext_24
    s_bitcmp1_b32 s93, s7
    s_cbranch_scc0 L_mnext_24
    v_sub_f32 v52, v55, v5
    v_sub_f32 v53, v32, v5
    v_exp_f32 v52, v52
    v_exp_f32 v53, v53
    v_mov_b32 v55, v5
    s_bitset0_b32 s93, s7
    v_mul_f32_dpp v57, v52, v57 row_newbcast:8 row_mask:0xf bank_mask:0xf
    v_mul_f32_dpp v56, v52, v56 row_newbcast:8 row_mask:0xf bank_mask:0xf
    v_mul_f32_dpp v58, v52, v58 row_newbcast:8 row_mask:0xf bank_mask:0xf
    v_mul_f32_dpp v59, v52, v59 row_newbcast:8 row_mask:0xf bank_mask:0xf
    v_fmac_f32_dpp v57, v53, v33 row_newbcast:8 row_mask:0xf bank_mask:0xf
    v_fmac_f32_dpp v56, v53, v32 row_newbcast:8 row_mask:0xf bank_mask:0xf
    v_fmac_f32_dpp v58, v53, v34 row_newbcast:8 row_mask:0xf bank_mask:0xf
    v_fmac_f32_dpp v59, v53, v35 row_newbcast:8 row_mask:0xf bank_mask:0xf
    s_cmp_eq_u32 s93, 0
    s_cbranch_scc1 L_hop1ok
L_mnext_24:
    s_and_b32 s94, s94, s93
    s_cselect_b32 s94, s94, s93
    s_ff1_i32_b32 s7, s94
    s_bitset0_b32 s94, s7
    s_lshl_b32 s36, s7, 10
    s_add_u32 s36, s36, s85
    buffer_load_dwordx4 v[32:35], v92, s[48:51], s36 offen sc1
    s_waitcnt vmcnt(4)
    v_xor_b32 v36, s35, v36
    v_xor_b32 v37, s35, v37
    v_xor_b32 v38, s35, v38
    v_xor_b32 v39, s35, v39
    v_or_b32 v4, v36, v37
    v_or3_b32 v4, v4, v38, v39
    v_and_b32 v4, 0xff, v4
    v_cmp_ne_u32 vcc, 0, v4
    v_max_f32 v5, v55, v36
    s_cbranch_vccnz L_mnext_25
    s_bitcmp1_b32 s93, s8
    s_cbranch_scc0 L_mnext_25
    v_sub_f32 v52, v55, v5
    v_sub_f32 v53, v36, v5
    v_exp_f32 v52, v52
    v_exp_f32 v53, v53
    v_mov_b32 v55, v5
    s_bitset0_b32 s93, s8
    v_mul_f32_dpp v57, v52, v57 row_newbcast:8 row_mask:0xf bank_mask:0xf
    v_mul_f32_dpp v56, v52, v56 row_newbcast:8 row_mask:0xf bank_mask:0xf
    v_mul_f32_dpp v58, v52, v58 row_newbcast:8 row_mask:0xf bank_mask:0xf
    v_mul_f32_dpp v59, v52, v59 row_newbcast:8 row_mask:0xf bank_mask:0xf
    v_fmac_f32_dpp v57, v53, v37 row_newbcast:8 row_mask:0xf bank_mask:0xf
    v_fmac_f32_dpp v56, v53, v36 row_newbcast:8 row_mask:0xf bank_mask:0xf
    v_fmac_f32_dpp v58, v53, v38 row_newbcast:8 row_mask:0xf bank_mask:0xf
    v_fmac_f32_dpp v59, v53, v39 row_newbcast:8 row_mask:0xf bank_mask:0xf
    s_cmp_eq_u32 s93, 0
    s_cbranch_scc1 L_hop1ok
L_mnext_25:
    s_sub_u32 s84, s84, 1
    s_cmp_lg_u32 s84, 0
    s_cbranch_scc1 L_hop1poll
    s_branch L_end
L_hop1ok:
    v_rcp_f32 v55, v57
    s_nop 1
    v_mul_f32_dpp v56, v55, v56 row_newbcast:8 row_mask:0xf bank_mask:0xf
    v_mul_f32_dpp v57, v55, v57 row_newbcast:8 row_mask:0xf bank_mask:0xf
    v_mul_f32_dpp v58, v55, v58 row_newbcast:8 row_mask:0xf bank_mask:0xf
    v_mul_f32_dpp v59, v55, v59 row_newbcast:8 row_mask:0xf bank_mask:0xf
    v_cvt_pk_bf16_f32 v56, v56, v57
    v_cvt_pk_bf16_f32 v58, v58, v59
    s_mov_b32 exec_lo, 0xff00ff
    s_mov_b32 exec_hi, 0xff00ff
    ds_write_b16 v93, v56
    ds_write_b16_d16_hi v93, v56 offset:16
    ds_write_b16 v93, v58 offset:32
    ds_write_b16_d16_hi v93, v58 offset:48
    s_mov_b64 exec, -1
    s_branch L_final
L_prepb:
    v_xor_b32 v4, 0, v95
    ds_read_b64_tr_b16 a[0:1], v4 offset:0
    ds_read_b64_tr_b16 a[4:5], v4 offset:8192
    ds_read_b64_tr_b16 a[8:9], v4 offset:16384
    ds_read_b64_tr_b16 a[12:13], v4 offset:24576
    v_xor_b32 v5, 16, v95
    ds_read_b64_tr_b16 a[2:3], v5 offset:1024
    ds_read_b64_tr_b16 a[6:7], v5 offset:9216
    ds_read_b64_tr_b16 a[10:11], v5 offset:17408
    ds_read_b64_tr_b16 a[14:15], v5 offset:25600
    v_xor_b32 v4, 32, v95
    ds_read_b64_tr_b16 a[16:17], v4 offset:0
    ds_read_b64_tr_b16 a[20:21], v4 offset:8192
    ds_read_b64_tr_b16 a[24:25], v4 offset:16384
    ds_read_b64_tr_b16 a[28:29], v4 offset:24576
    v_xor_b32 v5, 48, v95
    ds_read_b64_tr_b16 a[18:19], v5 offset:1024
    ds_read_b64_tr_b16 a[22:23], v5 offset:9216
    ds_read_b64_tr_b16 a[26:27], v5 offset:17408
    ds_read_b64_tr_b16 a[30:31], v5 offset:25600
    v_xor_b32 v4, 64, v95
    ds_read_b64_tr_b16 a[32:33], v4 offset:0
    ds_read_b64_tr_b16 a[36:37], v4 offset:8192
    ds_read_b64_tr_b16 a[40:41], v4 offset:16384
    ds_read_b64_tr_b16 a[44:45], v4 offset:24576
    v_xor_b32 v5, 80, v95
    ds_read_b64_tr_b16 a[34:35], v5 offset:1024
    ds_read_b64_tr_b16 a[38:39], v5 offset:9216
    ds_read_b64_tr_b16 a[42:43], v5 offset:17408
    ds_read_b64_tr_b16 a[46:47], v5 offset:25600
    v_xor_b32 v4, 96, v95
    ds_read_b64_tr_b16 a[48:49], v4 offset:0
    ds_read_b64_tr_b16 a[52:53], v4 offset:8192
    ds_read_b64_tr_b16 a[56:57], v4 offset:16384
    ds_read_b64_tr_b16 a[60:61], v4 offset:24576
    v_xor_b32 v5, 112, v95
    ds_read_b64_tr_b16 a[50:51], v5 offset:1024
    ds_read_b64_tr_b16 a[54:55], v5 offset:9216
    ds_read_b64_tr_b16 a[58:59], v5 offset:17408
    ds_read_b64_tr_b16 a[62:63], v5 offset:25600
    v_xor_b32 v4, 128, v95
    ds_read_b64_tr_b16 a[64:65], v4 offset:0
    ds_read_b64_tr_b16 a[68:69], v4 offset:8192
    ds_read_b64_tr_b16 a[72:73], v4 offset:16384
    ds_read_b64_tr_b16 a[76:77], v4 offset:24576
    v_xor_b32 v5, 144, v95
    ds_read_b64_tr_b16 a[66:67], v5 offset:1024
    ds_read_b64_tr_b16 a[70:71], v5 offset:9216
    ds_read_b64_tr_b16 a[74:75], v5 offset:17408
    ds_read_b64_tr_b16 a[78:79], v5 offset:25600
    v_xor_b32 v4, 160, v95
    ds_read_b64_tr_b16 a[80:81], v4 offset:0
    ds_read_b64_tr_b16 a[84:85], v4 offset:8192
    ds_read_b64_tr_b16 a[88:89], v4 offset:16384
    ds_read_b64_tr_b16 a[92:93], v4 offset:24576
    v_xor_b32 v5, 176, v95
    ds_read_b64_tr_b16 a[82:83], v5 offset:1024
    ds_read_b64_tr_b16 a[86:87], v5 offset:9216
    ds_read_b64_tr_b16 a[90:91], v5 offset:17408
    ds_read_b64_tr_b16 a[94:95], v5 offset:25600
    v_xor_b32 v4, 192, v95
    ds_read_b64_tr_b16 a[96:97], v4 offset:0
    ds_read_b64_tr_b16 a[100:101], v4 offset:8192
    ds_read_b64_tr_b16 a[104:105], v4 offset:16384
    ds_read_b64_tr_b16 a[108:109], v4 offset:24576
    v_xor_b32 v5, 208, v95
    ds_read_b64_tr_b16 a[98:99], v5 offset:1024
    ds_read_b64_tr_b16 a[102:103], v5 offset:9216
    ds_read_b64_tr_b16 a[106:107], v5 offset:17408
    ds_read_b64_tr_b16 a[110:111], v5 offset:25600
    v_xor_b32 v4, 224, v95
    ds_read_b64_tr_b16 a[112:113], v4 offset:0
    ds_read_b64_tr_b16 a[116:117], v4 offset:8192
    ds_read_b64_tr_b16 a[120:121], v4 offset:16384
    ds_read_b64_tr_b16 a[124:125], v4 offset:24576
    v_xor_b32 v5, 240, v95
    ds_read_b64_tr_b16 a[114:115], v5 offset:1024
    ds_read_b64_tr_b16 a[118:119], v5 offset:9216
    ds_read_b64_tr_b16 a[122:123], v5 offset:17408
    ds_read_b64_tr_b16 a[126:127], v5 offset:25600
    s_waitcnt lgkmcnt(0)
    s_barrier
    s_branch L_hop2
L_fin:
    s_or_b32 s36, s32, s34
    s_cmp_lg_u32 s36, 0
    s_cbranch_scc1 L_end
    s_mov_b64 exec, 1
    buffer_store_dword v8, v100, s[48:51], 0 offen
L_end:
    s_endpgm
.section .rodata,"a"
.p2align 6
.amdhsa_kernel concat_heads__compressed_kv_cla__mha_block_cached__decode_kernel
  .amdhsa_next_free_vgpr 512
  .amdhsa_next_free_sgpr 102
  .amdhsa_accum_offset 256
  .amdhsa_group_segment_fixed_size 0
  .amdhsa_kernarg_size 112
  .amdhsa_user_sgpr_count 2
  .amdhsa_user_sgpr_kernarg_segment_ptr 1
  .amdhsa_system_sgpr_workgroup_id_x 1
.end_amdhsa_kernel
```

```asm
; @launch grid=(256,1,1) block=(256,1,1) lds=163840
    .amdgcn_target "amdgcn-amd-amdhsa--gfx950"
    .text
    .globl concat_heads__compressed_kv_cla__mha_block_cached__decode_kernel
    .p2align 8
    .type concat_heads__compressed_kv_cla__mha_block_cached__decode_kernel,@function
concat_heads__compressed_kv_cla__mha_block_cached__decode_kernel:
    s_cmp_ge_u32 s2, 256
    s_cbranch_scc1 L_end
    s_load_dwordx16 s[4:19], s[0:1], 0
    s_load_dwordx8 s[20:27], s[0:1], 64
    s_load_dwordx4 s[28:31], s[0:1], 96
    v_lshrrev_b32 v4, 6, v0
    v_and_b32 v1, 63, v0
    v_readfirstlane_b32 s34, v4
    s_lshr_b32 s32, s2, 3
    s_sub_u32 s33, s2, s32
    s_sub_u32 s33, s33, 1
    s_and_b32 s33, s33, 7
    v_lshrrev_b32 v2, 4, v1
    v_and_b32 v3, 15, v1
    s_cmp_lt_u32 s33, 2
    s_cbranch_scc1 L_qp
    s_cmp_eq_u32 s33, 2
    s_cbranch_scc1 L_ql
    s_cmp_eq_u32 s33, 7
    s_cbranch_scc1 L_aux
    v_lshrrev_b32 v4, 2, v3
    v_and_b32 v5, 3, v3
    v_lshlrev_b32 v76, 8, v4
    v_lshlrev_b32 v126, 8, v2
    v_lshl_add_u32 v76, v2, 6, v76
    v_lshl_add_u32 v76, v5, 4, v76
    v_lshl_add_u32 v126, v3, 4, v126
    v_xor_b32 v77, 32768, v76
    v_xor_b32 v127, 32768, v126
    s_add_u32 s3, s34, s33
    s_and_b32 s3, s3, 3
    s_lshl_b32 s89, s3, 5
    s_add_u32 s89, s89, s32
    s_lshl_b32 s89, s89, 20
    s_mul_i32 s88, s32, 8
    s_add_u32 s88, s88, s3
    s_add_u32 s87, s33, 0
    s_mov_b32 s54, 134217728
    s_mov_b32 s55, 0x20000
    s_mov_b32 s58, 134217728
    s_mov_b32 s59, 0x20000
    s_add_u32 s39, s87, s88
    s_bfe_u32 s37, s39, 0x30000
    s_lshl_b32 s37, s37, 12
    s_add_u32 s85, s37, s89
    s_bfe_u32 s37, s39, 0x10003
    s_lshl_b32 s37, s37, 11
    s_add_u32 s85, s37, s85
    s_bfe_u32 s37, s39, 0x40004
    s_lshl_b32 s37, s37, 16
    s_add_u32 s85, s37, s85
    s_waitcnt lgkmcnt(0)
    s_mov_b64 s[52:53], s[18:19]
    s_mov_b64 s[56:57], s[20:21]
    s_and_b32 s36, s32, 24
    s_and_b32 s38, s2, 7
    s_add_u32 s36, s36, s38
    s_lshl_b32 s36, s36, 2
    s_add_u32 s36, s36, s33
    s_sub_u32 s36, s36, 3
    v_and_b32 v4, 31, v1
    v_lshlrev_b32 v4, 7, v4
    v_lshrrev_b32 v5, 5, v1
    v_lshl_add_u32 v4, v5, 15, v4
    v_lshlrev_b32 v5, 7, v1
    s_mov_b32 s40, s6
    s_and_b32 s41, s7, 0xffff
    s_mov_b32 s42, 16777216
    s_mov_b32 s43, 0x20000
    s_lshl_b32 s38, s36, 17
    s_lshl_b32 s39, s34, 12
    s_add_u32 s38, s38, s39
    buffer_load_dword v20, v4, s[40:43], s38 offen
    s_add_u32 s38, s38, 16384
    buffer_load_dword v21, v4, s[40:43], s38 offen
    s_add_u32 s38, s38, 49152
    buffer_load_dword v22, v4, s[40:43], s38 offen
    s_add_u32 s38, s38, 16384
    buffer_load_dword v23, v4, s[40:43], s38 offen
    buffer_load_dwordx4 v[128:131], v76, s[52:55], s85 offen offset:0 nt
    buffer_load_dwordx4 v[132:135], v77, s[52:55], s85 offen offset:0 nt
    buffer_load_dwordx4 v[136:139], v76, s[52:55], s85 offen offset:1024 nt
    buffer_load_dwordx4 v[140:143], v77, s[52:55], s85 offen offset:1024 nt
    s_add_u32 s87, s87, 7
    s_add_u32 s39, s87, s88
    s_bfe_u32 s37, s39, 0x30000
    s_lshl_b32 s37, s37, 12
    s_add_u32 s85, s37, s89
    s_bfe_u32 s37, s39, 0x10003
    s_lshl_b32 s37, s37, 11
    s_add_u32 s85, s37, s85
    s_bfe_u32 s37, s39, 0x40004
    s_lshl_b32 s37, s37, 16
    s_add_u32 s85, s37, s85
    buffer_load_dwordx4 v[144:147], v76, s[52:55], s85 offen offset:0 nt
    buffer_load_dwordx4 v[148:151], v77, s[52:55], s85 offen offset:0 nt
    buffer_load_dwordx4 v[152:155], v76, s[52:55], s85 offen offset:1024 nt
    s_load_dword s35, s[30:31], 0
    s_mov_b32 s48, s30
    s_and_b32 s49, s31, 0xffff
    s_mov_b32 s50, 8388608
    s_mov_b32 s51, 0x20000
    s_mov_b32 s82, 0xffffff00
    s_mov_b32 s83, 0x3e0293ee
    s_mov_b32 s84, 2097152
    s_waitcnt vmcnt(6)
    buffer_load_dwordx4 v[156:159], v77, s[52:55], s85 offen offset:1024 nt
    s_add_u32 s87, s87, 7
    s_add_u32 s39, s87, s88
    s_bfe_u32 s37, s39, 0x30000
    s_lshl_b32 s37, s37, 12
    s_add_u32 s85, s37, s89
    s_bfe_u32 s37, s39, 0x10003
    s_lshl_b32 s37, s37, 11
    s_add_u32 s85, s37, s85
    s_bfe_u32 s37, s39, 0x40004
    s_lshl_b32 s37, s37, 16
    s_add_u32 s85, s37, s85
    s_waitcnt vmcnt(6)
    buffer_load_dwordx4 v[160:163], v76, s[52:55], s85 offen offset:0 nt
    s_waitcnt vmcnt(6)
    buffer_load_dwordx4 v[164:167], v77, s[52:55], s85 offen offset:0 nt
    s_waitcnt vmcnt(6)
    buffer_load_dwordx4 v[168:171], v76, s[52:55], s85 offen offset:1024 nt
    v_and_b32 v4, 1, v1
    v_lshlrev_b32 v4, 4, v4
    v_mov_b32 v5, 0xffff
    v_lshlrev_b32 v4, v4, v5
    v_bfe_u32 v5, v1, 1, 2
    v_cmp_eq_u32 vcc, 0, v5
    s_nop 1
    v_cndmask_b32 v10, 0, v4, vcc
    v_cmp_eq_u32 vcc, 1, v5
    s_nop 1
    v_cndmask_b32 v11, 0, v4, vcc
    v_cmp_eq_u32 vcc, 2, v5
    s_nop 1
    v_cndmask_b32 v12, 0, v4, vcc
    v_cmp_eq_u32 vcc, 3, v5
    s_nop 1
    v_cndmask_b32 v13, 0, v4, vcc
    s_waitcnt vmcnt(6)
    buffer_load_dwordx4 v[172:175], v77, s[52:55], s85 offen offset:1024 nt
    s_add_u32 s87, s87, 7
    s_add_u32 s39, s87, s88
    s_bfe_u32 s37, s39, 0x30000
    s_lshl_b32 s37, s37, 12
    s_add_u32 s85, s37, s89
    s_bfe_u32 s37, s39, 0x10003
    s_lshl_b32 s37, s37, 11
    s_add_u32 s85, s37, s85
    s_bfe_u32 s37, s39, 0x40004
    s_lshl_b32 s37, s37, 16
    s_add_u32 s85, s37, s85
    s_waitcnt vmcnt(6)
    buffer_load_dwordx4 v[176:179], v76, s[52:55], s85 offen offset:0 nt
    s_waitcnt vmcnt(6)
    buffer_load_dwordx4 v[180:183], v77, s[52:55], s85 offen offset:0 nt
    s_waitcnt vmcnt(6)
    buffer_load_dwordx4 v[184:187], v76, s[52:55], s85 offen offset:1024 nt
    v_mov_b32 v120, 0xff7f0000
    v_mov_b32 v121, 0
    v_mov_b32 v18, 1
    v_mov_b32 v116, 0
    v_mov_b32 v117, 0
    v_mov_b32 v118, 0
    v_mov_b32 v119, 0
    s_lshl_b32 s38, s32, 10
    s_add_u32 s96, s38, 65536
    s_lshl_b32 s38, s3, 8
    s_add_u32 s96, s38, s96
    v_mov_b32 v9, s96
    s_lshl_b32 s38, s32, 15
    s_add_u32 s96, s38, 1048576
    s_lshl_b32 s38, s3, 13
    s_add_u32 s96, s38, s96
    s_lshl_b32 s38, s33, 10
    s_add_u32 s96, s38, s96
    v_and_b32 v5, 3, v3
    v_lshlrev_b32 v78, 7, v2
    v_lshl_add_u32 v78, v5, 5, v78
    s_lshl_b32 s38, s32, 12
    s_add_u32 s91, s38, 262144
    s_lshl_b32 s38, s3, 9
    s_add_u32 s91, s38, s91
    v_lshlrev_b32 v4, 7, v2
    v_lshl_add_u32 v4, v3, 4, v4
    v_mov_b32 v5, 512
    v_cmp_gt_u32 vcc, 8, v3
    s_nop 1
    v_cndmask_b32 v79, v5, v4, vcc
    s_waitcnt vmcnt(6)
    buffer_load_dwordx4 v[188:191], v77, s[52:55], s85 offen offset:1024 nt
    s_add_u32 s87, s87, 7
    s_add_u32 s39, s87, s88
    s_bfe_u32 s37, s39, 0x30000
    s_lshl_b32 s37, s37, 12
    s_add_u32 s85, s37, s89
    s_bfe_u32 s37, s39, 0x10003
    s_lshl_b32 s37, s37, 11
    s_add_u32 s85, s37, s85
    s_bfe_u32 s37, s39, 0x40004
    s_lshl_b32 s37, s37, 16
    s_add_u32 s85, s37, s85
    s_waitcnt vmcnt(6)
    buffer_load_dwordx4 v[192:195], v76, s[52:55], s85 offen offset:0 nt
    s_waitcnt vmcnt(6)
    buffer_load_dwordx4 v[196:199], v77, s[52:55], s85 offen offset:0 nt
    s_waitcnt vmcnt(6)
    buffer_load_dwordx4 v[200:203], v76, s[52:55], s85 offen offset:1024 nt
    s_waitcnt vmcnt(6)
    buffer_load_dwordx4 v[204:207], v77, s[52:55], s85 offen offset:1024 nt
    s_add_u32 s87, s87, 7
    s_add_u32 s39, s87, s88
    s_bfe_u32 s37, s39, 0x30000
    s_lshl_b32 s37, s37, 12
    s_add_u32 s85, s37, s89
    s_bfe_u32 s37, s39, 0x10003
    s_lshl_b32 s37, s37, 11
    s_add_u32 s85, s37, s85
    s_bfe_u32 s37, s39, 0x40004
    s_lshl_b32 s37, s37, 16
    s_add_u32 s85, s37, s85
    s_waitcnt vmcnt(6)
    buffer_load_dwordx4 v[208:211], v76, s[52:55], s85 offen offset:0 nt
    s_waitcnt vmcnt(6)
    buffer_load_dwordx4 v[212:215], v77, s[52:55], s85 offen offset:0 nt
    s_waitcnt vmcnt(6)
    buffer_load_dwordx4 v[216:219], v76, s[52:55], s85 offen offset:1024 nt
    s_waitcnt vmcnt(6)
    buffer_load_dwordx4 v[220:223], v77, s[52:55], s85 offen offset:1024 nt
    s_add_u32 s87, s87, 7
    s_add_u32 s39, s87, s88
    s_bfe_u32 s37, s39, 0x30000
    s_lshl_b32 s37, s37, 12
    s_add_u32 s85, s37, s89
    s_bfe_u32 s37, s39, 0x10003
    s_lshl_b32 s37, s37, 11
    s_add_u32 s85, s37, s85
    s_bfe_u32 s37, s39, 0x40004
    s_lshl_b32 s37, s37, 16
    s_add_u32 s85, s37, s85
    s_waitcnt vmcnt(6)
    buffer_load_dwordx4 v[224:227], v76, s[52:55], s85 offen offset:0 nt
    s_waitcnt vmcnt(6)
    buffer_load_dwordx4 v[228:231], v77, s[52:55], s85 offen offset:0 nt
    s_waitcnt vmcnt(6)
    buffer_load_dwordx4 v[232:235], v76, s[52:55], s85 offen offset:1024 nt
    s_waitcnt vmcnt(6)
    buffer_load_dwordx4 v[236:239], v77, s[52:55], s85 offen offset:1024 nt
    s_add_u32 s87, s87, 7
    s_add_u32 s39, s87, s88
    s_bfe_u32 s37, s39, 0x30000
    s_lshl_b32 s37, s37, 12
    s_add_u32 s85, s37, s89
    s_bfe_u32 s37, s39, 0x10003
    s_lshl_b32 s37, s37, 11
    s_add_u32 s85, s37, s85
    s_bfe_u32 s37, s39, 0x40004
    s_lshl_b32 s37, s37, 16
    s_add_u32 s85, s37, s85
    s_waitcnt vmcnt(6)
    buffer_load_dwordx4 v[240:243], v76, s[52:55], s85 offen offset:0 nt
    s_waitcnt vmcnt(6)
    buffer_load_dwordx4 v[244:247], v77, s[52:55], s85 offen offset:0 nt
    s_waitcnt vmcnt(6)
    buffer_load_dwordx4 v[248:251], v76, s[52:55], s85 offen offset:1024 nt
    s_waitcnt vmcnt(6)
    buffer_load_dwordx4 v[252:255], v77, s[52:55], s85 offen offset:1024 nt
    s_add_u32 s87, s87, 7
    s_add_u32 s39, s87, s88
    s_bfe_u32 s37, s39, 0x30000
    s_lshl_b32 s37, s37, 12
    s_add_u32 s85, s37, s89
    s_bfe_u32 s37, s39, 0x10003
    s_lshl_b32 s37, s37, 11
    s_add_u32 s85, s37, s85
    s_bfe_u32 s37, s39, 0x40004
    s_lshl_b32 s37, s37, 16
    s_add_u32 s85, s37, s85
    s_waitcnt vmcnt(6)
    buffer_load_dwordx4 a[0:3], v76, s[52:55], s85 offen offset:0 nt
    s_waitcnt vmcnt(6)
    buffer_load_dwordx4 a[4:7], v77, s[52:55], s85 offen offset:0 nt
    buffer_load_dwordx4 v[68:71], v78, s[48:51], s91 offen offset:0 sc1
    buffer_load_dwordx4 v[72:75], v78, s[48:51], s91 offen offset:16 sc1
    s_waitcnt vmcnt(8)
    buffer_load_dwordx4 a[8:11], v76, s[52:55], s85 offen offset:1024 nt
    s_waitcnt vmcnt(8)
    buffer_load_dwordx4 a[12:15], v77, s[52:55], s85 offen offset:1024 nt
    s_add_u32 s87, s87, 7
    s_add_u32 s39, s87, s88
    s_bfe_u32 s37, s39, 0x30000
    s_lshl_b32 s37, s37, 12
    s_add_u32 s85, s37, s89
    s_bfe_u32 s37, s39, 0x10003
    s_lshl_b32 s37, s37, 11
    s_add_u32 s85, s37, s85
    s_bfe_u32 s37, s39, 0x40004
    s_lshl_b32 s37, s37, 16
    s_add_u32 s85, s37, s85
    s_waitcnt vmcnt(8)
    buffer_load_dwordx4 a[16:19], v76, s[52:55], s85 offen offset:0 nt
    s_waitcnt vmcnt(8)
    buffer_load_dwordx4 a[20:23], v77, s[52:55], s85 offen offset:0 nt
    s_waitcnt vmcnt(8)
    buffer_load_dwordx4 a[24:27], v76, s[52:55], s85 offen offset:1024 nt
    s_waitcnt vmcnt(8)
    buffer_load_dwordx4 a[28:31], v77, s[52:55], s85 offen offset:1024 nt
    s_add_u32 s87, s87, 7
    s_add_u32 s39, s87, s88
    s_bfe_u32 s37, s39, 0x30000
    s_lshl_b32 s37, s37, 12
    s_add_u32 s85, s37, s89
    s_bfe_u32 s37, s39, 0x10003
    s_lshl_b32 s37, s37, 11
    s_add_u32 s85, s37, s85
    s_bfe_u32 s37, s39, 0x40004
    s_lshl_b32 s37, s37, 16
    s_add_u32 s85, s37, s85
    s_waitcnt lgkmcnt(0)
    s_add_u32 s35, s35, 0x5b
    s_and_b32 s35, s35, 0xff
    v_mov_b32 v8, s35
    s_waitcnt vmcnt(6)
L_qcheck_1:
    v_xor_b32 v68, s35, v68
    v_xor_b32 v69, s35, v69
    v_xor_b32 v70, s35, v70
    v_xor_b32 v71, s35, v71
    v_xor_b32 v72, s35, v72
    v_xor_b32 v73, s35, v73
    v_xor_b32 v74, s35, v74
    v_xor_b32 v75, s35, v75
    v_or_b32 v4, v68, v69
    v_or3_b32 v4, v4, v70, v71
    v_or3_b32 v4, v4, v72, v73
    v_or3_b32 v4, v4, v74, v75
    v_and_b32 v4, 0xff, v4
    v_cmp_ne_u32 vcc, 0, v4
    s_cbranch_vccz L_qok_2
    buffer_load_dwordx4 v[68:71], v78, s[48:51], s91 offen offset:0 sc1
    buffer_load_dwordx4 v[72:75], v78, s[48:51], s91 offen offset:16 sc1
    s_waitcnt vmcnt(0)
    s_sub_u32 s84, s84, 1
    s_cmp_lg_u32 s84, 0
    s_cbranch_scc1 L_qcheck_1
    s_branch L_end
L_qok_2:
    v_cvt_pk_bf16_f32 v68, v68, v69
    v_cvt_pk_bf16_f32 v69, v70, v71
    v_cvt_pk_bf16_f32 v70, v72, v73
    v_cvt_pk_bf16_f32 v71, v74, v75
    s_mov_b32 vcc_lo, 0xf000f
    s_mov_b32 vcc_hi, 0xf000f
    v_cndmask_b32 v80, 0, v68, vcc
    v_cndmask_b32 v81, 0, v69, vcc
    v_cndmask_b32 v82, 0, v70, vcc
    v_cndmask_b32 v83, 0, v71, vcc
    s_mov_b32 vcc_lo, 0xf000f0
    s_mov_b32 vcc_hi, 0xf000f0
    v_cndmask_b32 v84, 0, v68, vcc
    v_cndmask_b32 v85, 0, v69, vcc
    v_cndmask_b32 v86, 0, v70, vcc
    v_cndmask_b32 v87, 0, v71, vcc
    s_mov_b32 vcc_lo, 0xf000f00
    s_mov_b32 vcc_hi, 0xf000f00
    v_cndmask_b32 v88, 0, v68, vcc
    v_cndmask_b32 v89, 0, v69, vcc
    v_cndmask_b32 v90, 0, v70, vcc
    v_cndmask_b32 v91, 0, v71, vcc
    s_mov_b32 vcc_lo, 0xf000f000
    s_mov_b32 vcc_hi, 0xf000f000
    v_cndmask_b32 v92, 0, v68, vcc
    v_cndmask_b32 v93, 0, v69, vcc
    v_cndmask_b32 v94, 0, v70, vcc
    v_cndmask_b32 v95, 0, v71, vcc
    v_mov_b32 v65, 0xff7f0000
    s_lshl_b32 s38, s34, 14
    s_add_u32 s38, s38, 16384
    v_lshl_add_u32 v64, v1, 2, s38
    buffer_load_dwordx4 a[32:35], v76, s[52:55], s85 offen offset:0 nt
    v_mfma_f32_16x16x32_bf16 v[112:115], v[128:131], v[80:83], 0
    v_mfma_f32_16x16x32_bf16 v[112:115], v[132:135], v[84:87], v[112:115]
    v_mfma_f32_16x16x32_bf16 v[112:115], v[136:139], v[88:91], v[112:115]
    s_waitcnt vmcnt(6)
    buffer_load_dwordx4 a[36:39], v77, s[52:55], s85 offen offset:0 nt
    v_mfma_f32_16x16x32_bf16 v[112:115], v[140:143], v[92:95], v[112:115]
    v_mfma_f32_16x16x32_bf16 v[96:99], v[144:147], v[80:83], 0
    v_mfma_f32_16x16x32_bf16 v[96:99], v[148:151], v[84:87], v[96:99]
    s_waitcnt vmcnt(6)
    buffer_load_dwordx4 a[40:43], v76, s[52:55], s85 offen offset:1024 nt
    v_mfma_f32_16x16x32_bf16 v[96:99], v[152:155], v[88:91], v[96:99]
    s_nop 2
    v_mov_b32_dpp v122, v112 quad_perm:[0,0,0,0] row_mask:0xf bank_mask:0xf
    v_mov_b32_dpp v124, v114 quad_perm:[2,2,2,2] row_mask:0xf bank_mask:0xf
    s_nop 0
    v_add_f32_dpp v122, v113, v122 quad_perm:[1,1,1,1] row_mask:0xf bank_mask:0xf
    v_add_f32_dpp v124, v115, v124 quad_perm:[3,3,3,3] row_mask:0xf bank_mask:0xf
    v_add_f32 v122, v122, v124
    v_max_f32 v65, v65, v122
    ds_write_b32 v64, v122 offset:0
    v_mfma_f32_16x16x32_bf16 v[96:99], v[156:159], v[92:95], v[96:99]
    v_mfma_f32_16x16x32_bf16 v[112:115], v[160:163], v[80:83], 0
    v_mfma_f32_16x16x32_bf16 v[112:115], v[164:167], v[84:87], v[112:115]
    s_waitcnt vmcnt(6)
    buffer_load_dwordx4 a[44:47], v77, s[52:55], s85 offen offset:1024 nt
    s_add_u32 s87, s87, 7
    s_add_u32 s39, s87, s88
    s_bfe_u32 s37, s39, 0x30000
    s_lshl_b32 s37, s37, 12
    s_add_u32 s85, s37, s89
    s_bfe_u32 s37, s39, 0x10003
    s_lshl_b32 s37, s37, 11
    s_add_u32 s85, s37, s85
    s_bfe_u32 s37, s39, 0x40004
    s_lshl_b32 s37, s37, 16
    s_add_u32 s85, s37, s85
    v_mfma_f32_16x16x32_bf16 v[112:115], v[168:171], v[88:91], v[112:115]
    v_mov_b32_dpp v122, v96 quad_perm:[0,0,0,0] row_mask:0xf bank_mask:0xf
    v_mov_b32_dpp v124, v98 quad_perm:[2,2,2,2] row_mask:0xf bank_mask:0xf
    s_nop 0
    v_add_f32_dpp v122, v97, v122 quad_perm:[1,1,1,1] row_mask:0xf bank_mask:0xf
    v_add_f32_dpp v124, v99, v124 quad_perm:[3,3,3,3] row_mask:0xf bank_mask:0xf
    v_add_f32 v122, v122, v124
    v_max_f32 v65, v65, v122
    ds_write_b32 v64, v122 offset:256
    v_mfma_f32_16x16x32_bf16 v[112:115], v[172:175], v[92:95], v[112:115]
    v_mfma_f32_16x16x32_bf16 v[96:99], v[176:179], v[80:83], 0
    s_waitcnt vmcnt(6)
    buffer_load_dwordx4 a[48:51], v76, s[52:55], s85 offen offset:0 nt
    v_mfma_f32_16x16x32_bf16 v[96:99], v[180:183], v[84:87], v[96:99]
    v_mfma_f32_16x16x32_bf16 v[96:99], v[184:187], v[88:91], v[96:99]
    s_nop 2
    v_mov_b32_dpp v122, v112 quad_perm:[0,0,0,0] row_mask:0xf bank_mask:0xf
    v_mov_b32_dpp v124, v114 quad_perm:[2,2,2,2] row_mask:0xf bank_mask:0xf
    s_nop 0
    v_add_f32_dpp v122, v113, v122 quad_perm:[1,1,1,1] row_mask:0xf bank_mask:0xf
    v_add_f32_dpp v124, v115, v124 quad_perm:[3,3,3,3] row_mask:0xf bank_mask:0xf
    v_add_f32 v122, v122, v124
    v_max_f32 v65, v65, v122
    ds_write_b32 v64, v122 offset:512
    v_mfma_f32_16x16x32_bf16 v[96:99], v[188:191], v[92:95], v[96:99]
    v_mfma_f32_16x16x32_bf16 v[112:115], v[192:195], v[80:83], 0
    s_waitcnt vmcnt(6)
    buffer_load_dwordx4 a[52:55], v77, s[52:55], s85 offen offset:0 nt
    v_mfma_f32_16x16x32_bf16 v[112:115], v[196:199], v[84:87], v[112:115]
    v_mfma_f32_16x16x32_bf16 v[112:115], v[200:203], v[88:91], v[112:115]
    s_nop 2
    v_mov_b32_dpp v122, v96 quad_perm:[0,0,0,0] row_mask:0xf bank_mask:0xf
    v_mov_b32_dpp v124, v98 quad_perm:[2,2,2,2] row_mask:0xf bank_mask:0xf
    s_nop 0
    v_add_f32_dpp v122, v97, v122 quad_perm:[1,1,1,1] row_mask:0xf bank_mask:0xf
    v_add_f32_dpp v124, v99, v124 quad_perm:[3,3,3,3] row_mask:0xf bank_mask:0xf
    v_add_f32 v122, v122, v124
    v_max_f32 v65, v65, v122
    ds_write_b32 v64, v122 offset:768
    v_mfma_f32_16x16x32_bf16 v[112:115], v[204:207], v[92:95], v[112:115]
    s_waitcnt vmcnt(6)
    buffer_load_dwordx4 a[56:59], v76, s[52:55], s85 offen offset:1024 nt
    v_mfma_f32_16x16x32_bf16 v[96:99], v[208:211], v[80:83], 0
    v_mfma_f32_16x16x32_bf16 v[96:99], v[212:215], v[84:87], v[96:99]
    v_mfma_f32_16x16x32_bf16 v[96:99], v[216:219], v[88:91], v[96:99]
    s_nop 2
    v_mov_b32_dpp v122, v112 quad_perm:[0,0,0,0] row_mask:0xf bank_mask:0xf
    v_mov_b32_dpp v124, v114 quad_perm:[2,2,2,2] row_mask:0xf bank_mask:0xf
    s_nop 0
    v_add_f32_dpp v122, v113, v122 quad_perm:[1,1,1,1] row_mask:0xf bank_mask:0xf
    v_add_f32_dpp v124, v115, v124 quad_perm:[3,3,3,3] row_mask:0xf bank_mask:0xf
    v_add_f32 v122, v122, v124
    v_max_f32 v65, v65, v122
    ds_write_b32 v64, v122 offset:1024
    v_mfma_f32_16x16x32_bf16 v[96:99], v[220:223], v[92:95], v[96:99]
    s_waitcnt vmcnt(6)
    buffer_load_dwordx4 a[60:63], v77, s[52:55], s85 offen offset:1024 nt
    s_add_u32 s87, s87, 7
    s_add_u32 s39, s87, s88
    s_bfe_u32 s37, s39, 0x30000
    s_lshl_b32 s37, s37, 12
    s_add_u32 s85, s37, s89
    s_bfe_u32 s37, s39, 0x10003
    s_lshl_b32 s37, s37, 11
    s_add_u32 s85, s37, s85
    s_bfe_u32 s37, s39, 0x40004
    s_lshl_b32 s37, s37, 16
    s_add_u32 s85, s37, s85
    v_mfma_f32_16x16x32_bf16 v[112:115], v[224:227], v[80:83], 0
    v_mfma_f32_16x16x32_bf16 v[112:115], v[228:231], v[84:87], v[112:115]
    v_mfma_f32_16x16x32_bf16 v[112:115], v[232:235], v[88:91], v[112:115]
    v_mov_b32_dpp v122, v96 quad_perm:[0,0,0,0] row_mask:0xf bank_mask:0xf
    v_mov_b32_dpp v124, v98 quad_perm:[2,2,2,2] row_mask:0xf bank_mask:0xf
    s_nop 0
    v_add_f32_dpp v122, v97, v122 quad_perm:[1,1,1,1] row_mask:0xf bank_mask:0xf
    v_add_f32_dpp v124, v99, v124 quad_perm:[3,3,3,3] row_mask:0xf bank_mask:0xf
    v_add_f32 v122, v122, v124
    v_max_f32 v65, v65, v122
    ds_write_b32 v64, v122 offset:1280
    s_waitcnt vmcnt(5)
    buffer_load_dwordx4 v[128:131], v76, s[52:55], s85 offen offset:0 nt
    v_mfma_f32_16x16x32_bf16 v[112:115], v[236:239], v[92:95], v[112:115]
    v_mfma_f32_16x16x32_bf16 v[96:99], v[240:243], v[80:83], 0
    v_mfma_f32_16x16x32_bf16 v[96:99], v[244:247], v[84:87], v[96:99]
    s_waitcnt vmcnt(5)
    buffer_load_dwordx4 v[132:135], v77, s[52:55], s85 offen offset:0 nt
    v_mfma_f32_16x16x32_bf16 v[96:99], v[248:251], v[88:91], v[96:99]
    s_nop 2
    v_mov_b32_dpp v122, v112 quad_perm:[0,0,0,0] row_mask:0xf bank_mask:0xf
    v_mov_b32_dpp v124, v114 quad_perm:[2,2,2,2] row_mask:0xf bank_mask:0xf
    s_nop 0
    v_add_f32_dpp v122, v113, v122 quad_perm:[1,1,1,1] row_mask:0xf bank_mask:0xf
    v_add_f32_dpp v124, v115, v124 quad_perm:[3,3,3,3] row_mask:0xf bank_mask:0xf
    v_add_f32 v122, v122, v124
    v_max_f32 v65, v65, v122
    ds_write_b32 v64, v122 offset:1536
    v_mfma_f32_16x16x32_bf16 v[96:99], v[252:255], v[92:95], v[96:99]
    v_mfma_f32_16x16x32_bf16 v[112:115], a[0:3], v[80:83], 0
    v_mfma_f32_16x16x32_bf16 v[112:115], a[4:7], v[84:87], v[112:115]
    s_waitcnt vmcnt(5)
    buffer_load_dwordx4 v[136:139], v76, s[52:55], s85 offen offset:1024 nt
    v_mfma_f32_16x16x32_bf16 v[112:115], a[8:11], v[88:91], v[112:115]
    s_nop 2
    v_mov_b32_dpp v122, v96 quad_perm:[0,0,0,0] row_mask:0xf bank_mask:0xf
    v_mov_b32_dpp v124, v98 quad_perm:[2,2,2,2] row_mask:0xf bank_mask:0xf
    s_nop 0
    v_add_f32_dpp v122, v97, v122 quad_perm:[1,1,1,1] row_mask:0xf bank_mask:0xf
    v_add_f32_dpp v124, v99, v124 quad_perm:[3,3,3,3] row_mask:0xf bank_mask:0xf
    v_add_f32 v122, v122, v124
    v_max_f32 v65, v65, v122
    ds_write_b32 v64, v122 offset:1792
    v_mfma_f32_16x16x32_bf16 v[112:115], a[12:15], v[92:95], v[112:115]
    v_mfma_f32_16x16x32_bf16 v[96:99], a[16:19], v[80:83], 0
    s_waitcnt vmcnt(5)
    buffer_load_dwordx4 v[140:143], v77, s[52:55], s85 offen offset:1024 nt
    s_add_u32 s87, s87, 7
    s_add_u32 s39, s87, s88
    s_bfe_u32 s37, s39, 0x30000
    s_lshl_b32 s37, s37, 12
    s_add_u32 s85, s37, s89
    s_bfe_u32 s37, s39, 0x10003
    s_lshl_b32 s37, s37, 11
    s_add_u32 s85, s37, s85
    s_bfe_u32 s37, s39, 0x40004
    s_lshl_b32 s37, s37, 16
    s_add_u32 s85, s37, s85
    v_mfma_f32_16x16x32_bf16 v[96:99], a[20:23], v[84:87], v[96:99]
    v_mfma_f32_16x16x32_bf16 v[96:99], a[24:27], v[88:91], v[96:99]
    v_mov_b32_dpp v122, v112 quad_perm:[0,0,0,0] row_mask:0xf bank_mask:0xf
    v_mov_b32_dpp v124, v114 quad_perm:[2,2,2,2] row_mask:0xf bank_mask:0xf
    s_nop 0
    v_add_f32_dpp v122, v113, v122 quad_perm:[1,1,1,1] row_mask:0xf bank_mask:0xf
    v_add_f32_dpp v124, v115, v124 quad_perm:[3,3,3,3] row_mask:0xf bank_mask:0xf
    v_add_f32 v122, v122, v124
    v_max_f32 v65, v65, v122
    ds_write_b32 v64, v122 offset:2048
    v_mfma_f32_16x16x32_bf16 v[96:99], a[28:31], v[92:95], v[96:99]
    v_mfma_f32_16x16x32_bf16 v[112:115], a[32:35], v[80:83], 0
    s_waitcnt vmcnt(5)
    buffer_load_dwordx4 v[144:147], v76, s[52:55], s85 offen offset:0 nt
    v_mfma_f32_16x16x32_bf16 v[112:115], a[36:39], v[84:87], v[112:115]
    v_mfma_f32_16x16x32_bf16 v[112:115], a[40:43], v[88:91], v[112:115]
    s_nop 2
    v_mov_b32_dpp v122, v96 quad_perm:[0,0,0,0] row_mask:0xf bank_mask:0xf
    v_mov_b32_dpp v124, v98 quad_perm:[2,2,2,2] row_mask:0xf bank_mask:0xf
    s_nop 0
    v_add_f32_dpp v122, v97, v122 quad_perm:[1,1,1,1] row_mask:0xf bank_mask:0xf
    v_add_f32_dpp v124, v99, v124 quad_perm:[3,3,3,3] row_mask:0xf bank_mask:0xf
    v_add_f32 v122, v122, v124
    v_max_f32 v65, v65, v122
    ds_write_b32 v64, v122 offset:2304
    v_mfma_f32_16x16x32_bf16 v[112:115], a[44:47], v[92:95], v[112:115]
    s_waitcnt vmcnt(5)
    buffer_load_dwordx4 v[148:151], v77, s[52:55], s85 offen offset:0 nt
    v_mfma_f32_16x16x32_bf16 v[96:99], a[48:51], v[80:83], 0
    v_mfma_f32_16x16x32_bf16 v[96:99], a[52:55], v[84:87], v[96:99]
    v_mfma_f32_16x16x32_bf16 v[96:99], a[56:59], v[88:91], v[96:99]
    s_nop 2
    v_mov_b32_dpp v122, v112 quad_perm:[0,0,0,0] row_mask:0xf bank_mask:0xf
    v_mov_b32_dpp v124, v114 quad_perm:[2,2,2,2] row_mask:0xf bank_mask:0xf
    s_nop 0
    v_add_f32_dpp v122, v113, v122 quad_perm:[1,1,1,1] row_mask:0xf bank_mask:0xf
    v_add_f32_dpp v124, v115, v124 quad_perm:[3,3,3,3] row_mask:0xf bank_mask:0xf
    v_add_f32 v122, v122, v124
    v_max_f32 v65, v65, v122
    ds_write_b32 v64, v122 offset:2560
    v_mfma_f32_16x16x32_bf16 v[96:99], a[60:63], v[92:95], v[96:99]
    v_add_u32 v64, 2816, v64
    s_mov_b32 s97, 10
    s_mov_b32 s86, 32
    s_add_u32 s92, s33, 224
    s_mov_b32 s66, 134217728
    s_mov_b32 s67, 0x20000
    s_mov_b64 s[64:65], s[52:53]
    v_mov_b32 v62, v76
    v_mov_b32 v63, v77
L_bloop:
    s_waitcnt vmcnt(5)
    buffer_load_dwordx4 v[152:155], v62, s[64:67], s85 offen offset:1024 nt
    v_mfma_f32_16x16x32_bf16 v[112:115], v[128:131], v[80:83], 0
    s_waitcnt vmcnt(5)
    buffer_load_dwordx4 v[156:159], v63, s[64:67], s85 offen offset:1024 nt
    v_mfma_f32_16x16x32_bf16 v[112:115], v[132:135], v[84:87], v[112:115]
    s_add_u32 s87, s87, 7
    s_cmp_lg_u32 s87, s92
    s_cbranch_scc1 L_stayk_3
    s_mov_b64 s[64:65], s[56:57]
    v_mov_b32 v62, v126
    v_mov_b32 v63, v127
    s_mul_i32 s37, s86, 7
    s_sub_u32 s87, s87, s37
L_stayk_3:
    s_add_u32 s39, s87, s88
    s_bfe_u32 s37, s39, 0x30000
    s_lshl_b32 s37, s37, 12
    s_add_u32 s85, s37, s89
    s_bfe_u32 s37, s39, 0x10003
    s_lshl_b32 s37, s37, 11
    s_add_u32 s85, s37, s85
    s_bfe_u32 s37, s39, 0x40004
    s_lshl_b32 s37, s37, 16
    s_add_u32 s85, s37, s85
    v_mov_b32_dpp v122, v96 quad_perm:[0,0,0,0] row_mask:0xf bank_mask:0xf
    v_mov_b32_dpp v124, v98 quad_perm:[2,2,2,2] row_mask:0xf bank_mask:0xf
    s_nop 0
    v_add_f32_dpp v122, v97, v122 quad_perm:[1,1,1,1] row_mask:0xf bank_mask:0xf
    v_add_f32_dpp v124, v99, v124 quad_perm:[3,3,3,3] row_mask:0xf bank_mask:0xf
    v_add_f32 v122, v122, v124
    v_max_f32 v65, v65, v122
    ds_write_b32 v64, v122 offset:0
    s_waitcnt vmcnt(5)
    buffer_load_dwordx4 v[128:131], v62, s[64:67], s85 offen offset:0 nt
    v_mfma_f32_16x16x32_bf16 v[112:115], v[136:139], v[88:91], v[112:115]
    s_waitcnt vmcnt(5)
    buffer_load_dwordx4 v[132:135], v63, s[64:67], s85 offen offset:0 nt
    v_mfma_f32_16x16x32_bf16 v[112:115], v[140:143], v[92:95], v[112:115]
    s_waitcnt vmcnt(5)
    buffer_load_dwordx4 v[136:139], v62, s[64:67], s85 offen offset:1024 nt
    v_mfma_f32_16x16x32_bf16 v[96:99], v[144:147], v[80:83], 0
    s_waitcnt vmcnt(5)
    buffer_load_dwordx4 v[140:143], v63, s[64:67], s85 offen offset:1024 nt
    v_mfma_f32_16x16x32_bf16 v[96:99], v[148:151], v[84:87], v[96:99]
    s_add_u32 s87, s87, 7
    s_add_u32 s39, s87, s88
    s_bfe_u32 s37, s39, 0x30000
    s_lshl_b32 s37, s37, 12
    s_add_u32 s85, s37, s89
    s_bfe_u32 s37, s39, 0x10003
    s_lshl_b32 s37, s37, 11
    s_add_u32 s85, s37, s85
    s_bfe_u32 s37, s39, 0x40004
    s_lshl_b32 s37, s37, 16
    s_add_u32 s85, s37, s85
    v_mov_b32_dpp v122, v112 quad_perm:[0,0,0,0] row_mask:0xf bank_mask:0xf
    v_mov_b32_dpp v124, v114 quad_perm:[2,2,2,2] row_mask:0xf bank_mask:0xf
    s_nop 0
    v_add_f32_dpp v122, v113, v122 quad_perm:[1,1,1,1] row_mask:0xf bank_mask:0xf
    v_add_f32_dpp v124, v115, v124 quad_perm:[3,3,3,3] row_mask:0xf bank_mask:0xf
    v_add_f32 v122, v122, v124
    v_max_f32 v65, v65, v122
    ds_write_b32 v64, v122 offset:256
    s_waitcnt vmcnt(5)
    buffer_load_dwordx4 v[144:147], v62, s[64:67], s85 offen offset:0 nt
    v_mfma_f32_16x16x32_bf16 v[96:99], v[152:155], v[88:91], v[96:99]
    s_waitcnt vmcnt(5)
    buffer_load_dwordx4 v[148:151], v63, s[64:67], s85 offen offset:0 nt
    v_mfma_f32_16x16x32_bf16 v[96:99], v[156:159], v[92:95], v[96:99]
    v_add_u32 v64, 512, v64
    s_sub_u32 s97, s97, 1
    s_cmp_lg_u32 s97, 0
    s_cbranch_scc1 L_bloop
    s_nop 3
    v_mov_b32_dpp v122, v96 quad_perm:[0,0,0,0] row_mask:0xf bank_mask:0xf
    v_mov_b32_dpp v124, v98 quad_perm:[2,2,2,2] row_mask:0xf bank_mask:0xf
    s_nop 0
    v_add_f32_dpp v122, v97, v122 quad_perm:[1,1,1,1] row_mask:0xf bank_mask:0xf
    v_add_f32_dpp v124, v99, v124 quad_perm:[3,3,3,3] row_mask:0xf bank_mask:0xf
    v_add_f32 v122, v122, v124
    v_max_f32 v65, v65, v122
    ds_write_b32 v64, v122 offset:0
    v_mov_b32 v123, 0xff7f0000
    ds_write_b32 v64, v123 offset:256
    s_lshl_b32 s38, s34, 14
    s_add_u32 s38, s38, 16384
    v_lshl_add_u32 v64, v1, 2, s38
    ds_read_b32 v66, v64
    ds_read_b32 v67, v64 offset:256
    v_mul_f32 v65, s83, v65
    s_nop 1
    v_max_f32_dpp v124, v65, v65 row_ror:4 row_mask:0xf bank_mask:0xf
    s_nop 1
    v_max_f32_dpp v124, v124, v124 row_ror:8 row_mask:0xf bank_mask:0xf
    v_mov_b32 v125, v124
    s_nop 1
    v_permlane16_swap_b32 v124, v125
    v_max_f32 v124, v124, v125
    v_mov_b32 v125, v124
    s_nop 1
    v_permlane32_swap_b32 v124, v125
    v_max_f32 v124, v124, v125
    v_and_b32 v120, s82, v124
    s_lshr_b32 s97, s86, 1
    s_waitcnt lgkmcnt(1)
    v_fma_f32 v123, v66, s83, -v120
    v_exp_f32 v123, v123
    ds_read_b32 v66, v64 offset:512
    v_cvt_pk_bf16_f32 v100, v123, v123
    v_add_f32 v121, v121, v123
L_vloop:
    s_nop 0
    v_and_b32_dpp v104, v100, v10 row_newbcast:0 row_mask:0xf bank_mask:0xf
    v_and_b32_dpp v105, v100, v11 row_newbcast:0 row_mask:0xf bank_mask:0xf
    v_and_b32_dpp v106, v100, v12 row_newbcast:0 row_mask:0xf bank_mask:0xf
    v_and_b32_dpp v107, v100, v13 row_newbcast:0 row_mask:0xf bank_mask:0xf
    s_waitcnt vmcnt(5)
    buffer_load_dwordx4 v[152:155], v62, s[64:67], s85 offen offset:1024 nt
    v_mfma_f32_16x16x32_bf16 v[116:119], v[128:131], v[104:107], v[116:119]
    v_and_b32_dpp v108, v100, v10 row_newbcast:4 row_mask:0xf bank_mask:0xf
    v_and_b32_dpp v109, v100, v11 row_newbcast:4 row_mask:0xf bank_mask:0xf
    v_and_b32_dpp v110, v100, v12 row_newbcast:4 row_mask:0xf bank_mask:0xf
    v_and_b32_dpp v111, v100, v13 row_newbcast:4 row_mask:0xf bank_mask:0xf
    s_waitcnt vmcnt(5)
    buffer_load_dwordx4 v[156:159], v63, s[64:67], s85 offen offset:1024 nt
    v_mfma_f32_16x16x32_bf16 v[116:119], v[132:135], v[108:111], v[116:119]
    s_add_u32 s87, s87, 7
    s_cmp_lg_u32 s97, 1
    s_cbranch_scc1 L_stayv_4
    s_mov_b64 s[64:65], s[52:53]
    v_mov_b32 v62, v76
    v_mov_b32 v63, v77
    s_mov_b64 exec, 1
    global_atomic_add v19, v9, v18, s[30:31] sc0 sc1
    s_mov_b64 exec, -1
    s_add_u32 s87, s33, 224
L_stayv_4:
    s_add_u32 s39, s87, s88
    s_bfe_u32 s37, s39, 0x30000
    s_lshl_b32 s37, s37, 12
    s_add_u32 s85, s37, s89
    s_bfe_u32 s37, s39, 0x10003
    s_lshl_b32 s37, s37, 11
    s_add_u32 s85, s37, s85
    s_bfe_u32 s37, s39, 0x40004
    s_lshl_b32 s37, s37, 16
    s_add_u32 s85, s37, s85
    s_waitcnt lgkmcnt(1)
    v_fma_f32 v123, v67, s83, -v120
    v_exp_f32 v123, v123
    ds_read_b32 v67, v64 offset:768
    v_cvt_pk_bf16_f32 v101, v123, v123
    v_add_f32 v121, v121, v123
    v_and_b32_dpp v104, v100, v10 row_newbcast:8 row_mask:0xf bank_mask:0xf
    v_and_b32_dpp v105, v100, v11 row_newbcast:8 row_mask:0xf bank_mask:0xf
    v_and_b32_dpp v106, v100, v12 row_newbcast:8 row_mask:0xf bank_mask:0xf
    v_and_b32_dpp v107, v100, v13 row_newbcast:8 row_mask:0xf bank_mask:0xf
    s_waitcnt vmcnt(5)
    buffer_load_dwordx4 v[128:131], v62, s[64:67], s85 offen offset:0 nt
    v_mfma_f32_16x16x32_bf16 v[116:119], v[136:139], v[104:107], v[116:119]
    v_and_b32_dpp v108, v100, v10 row_newbcast:12 row_mask:0xf bank_mask:0xf
    v_and_b32_dpp v109, v100, v11 row_newbcast:12 row_mask:0xf bank_mask:0xf
    v_and_b32_dpp v110, v100, v12 row_newbcast:12 row_mask:0xf bank_mask:0xf
    v_and_b32_dpp v111, v100, v13 row_newbcast:12 row_mask:0xf bank_mask:0xf
    s_waitcnt vmcnt(5)
    buffer_load_dwordx4 v[132:135], v63, s[64:67], s85 offen offset:0 nt
    v_mfma_f32_16x16x32_bf16 v[116:119], v[140:143], v[108:111], v[116:119]
    v_and_b32_dpp v104, v101, v10 row_newbcast:0 row_mask:0xf bank_mask:0xf
    v_and_b32_dpp v105, v101, v11 row_newbcast:0 row_mask:0xf bank_mask:0xf
    v_and_b32_dpp v106, v101, v12 row_newbcast:0 row_mask:0xf bank_mask:0xf
    v_and_b32_dpp v107, v101, v13 row_newbcast:0 row_mask:0xf bank_mask:0xf
    s_waitcnt vmcnt(5)
    buffer_load_dwordx4 v[136:139], v62, s[64:67], s85 offen offset:1024 nt
    v_mfma_f32_16x16x32_bf16 v[116:119], v[144:147], v[104:107], v[116:119]
    v_and_b32_dpp v108, v101, v10 row_newbcast:4 row_mask:0xf bank_mask:0xf
    v_and_b32_dpp v109, v101, v11 row_newbcast:4 row_mask:0xf bank_mask:0xf
    v_and_b32_dpp v110, v101, v12 row_newbcast:4 row_mask:0xf bank_mask:0xf
    v_and_b32_dpp v111, v101, v13 row_newbcast:4 row_mask:0xf bank_mask:0xf
    s_waitcnt vmcnt(5)
    buffer_load_dwordx4 v[140:143], v63, s[64:67], s85 offen offset:1024 nt
    v_mfma_f32_16x16x32_bf16 v[116:119], v[148:151], v[108:111], v[116:119]
    s_add_u32 s87, s87, 7
    s_cmp_lg_u32 s97, 1
    s_cbranch_scc1 L_stayv_5
    s_mov_b64 s[64:65], s[56:57]
    v_mov_b32 v62, v126
    v_mov_b32 v63, v127
    s_add_u32 s87, s33, 224
L_stayv_5:
    s_add_u32 s39, s87, s88
    s_bfe_u32 s37, s39, 0x30000
    s_lshl_b32 s37, s37, 12
    s_add_u32 s85, s37, s89
    s_bfe_u32 s37, s39, 0x10003
    s_lshl_b32 s37, s37, 11
    s_add_u32 s85, s37, s85
    s_bfe_u32 s37, s39, 0x40004
    s_lshl_b32 s37, s37, 16
    s_add_u32 s85, s37, s85
    v_add_u32 v64, 512, v64
    s_waitcnt lgkmcnt(1)
    v_fma_f32 v123, v66, s83, -v120
    v_exp_f32 v123, v123
    ds_read_b32 v66, v64 offset:512
    v_cvt_pk_bf16_f32 v100, v123, v123
    v_add_f32 v121, v121, v123
    v_and_b32_dpp v104, v101, v10 row_newbcast:8 row_mask:0xf bank_mask:0xf
    v_and_b32_dpp v105, v101, v11 row_newbcast:8 row_mask:0xf bank_mask:0xf
    v_and_b32_dpp v106, v101, v12 row_newbcast:8 row_mask:0xf bank_mask:0xf
    v_and_b32_dpp v107, v101, v13 row_newbcast:8 row_mask:0xf bank_mask:0xf
    s_waitcnt vmcnt(5)
    buffer_load_dwordx4 v[144:147], v62, s[64:67], s85 offen offset:0 nt
    v_mfma_f32_16x16x32_bf16 v[116:119], v[152:155], v[104:107], v[116:119]
    v_and_b32_dpp v108, v101, v10 row_newbcast:12 row_mask:0xf bank_mask:0xf
    v_and_b32_dpp v109, v101, v11 row_newbcast:12 row_mask:0xf bank_mask:0xf
    v_and_b32_dpp v110, v101, v12 row_newbcast:12 row_mask:0xf bank_mask:0xf
    v_and_b32_dpp v111, v101, v13 row_newbcast:12 row_mask:0xf bank_mask:0xf
    s_waitcnt vmcnt(5)
    buffer_load_dwordx4 v[148:151], v63, s[64:67], s85 offen offset:0 nt
    v_mfma_f32_16x16x32_bf16 v[116:119], v[156:159], v[108:111], v[116:119]
    s_sub_u32 s97, s97, 1
    s_cmp_lg_u32 s97, 0
    s_cbranch_scc1 L_vloop
    buffer_load_dwordx4 v[152:155], v126, s[56:59], s85 offen offset:1024 nt
    buffer_load_dwordx4 v[156:159], v127, s[56:59], s85 offen offset:1024 nt
L_dloop:
    s_waitcnt vmcnt(7)
    v_readfirstlane_b32 s93, v19
    s_nop 0
    s_sub_u32 s36, s93, 25
    s_and_b32 s38, s36, 3
    s_mul_i32 s38, s38, 7
    s_lshr_b32 s36, s36, 2
    s_add_u32 s87, s38, s36
    s_add_u32 s38, s93, 231
    s_cmp_lt_i32 s93, 25
    s_cselect_b32 s87, s38, s87
    s_add_u32 s93, s93, 8
    s_add_u32 s39, s87, s88
    s_bfe_u32 s37, s39, 0x30000
    s_lshl_b32 s37, s37, 12
    s_add_u32 s86, s37, s89
    s_bfe_u32 s37, s39, 0x10003
    s_lshl_b32 s37, s37, 11
    s_add_u32 s86, s37, s86
    s_bfe_u32 s37, s39, 0x40004
    s_lshl_b32 s37, s37, 16
    s_add_u32 s86, s37, s86
    s_cmp_ge_u32 s93, 33
    s_cselect_b32 s86, 134217728, s86
    v_mov_b32 v19, 25
    s_cmp_ge_u32 s93, 32
    s_cbranch_scc1 L_noclaim_6
    s_mov_b64 exec, 1
    global_atomic_add v19, v9, v18, s[30:31] sc0 sc1
    s_mov_b64 exec, -1
L_noclaim_6:
    buffer_load_dwordx4 v[160:163], v76, s[52:55], s86 offen offset:0 nt
    v_mfma_f32_16x16x32_bf16 v[112:115], v[128:131], v[80:83], 0
    s_waitcnt vmcnt(7)
    buffer_load_dwordx4 v[164:167], v77, s[52:55], s86 offen offset:0 nt
    v_mfma_f32_16x16x32_bf16 v[112:115], v[132:135], v[84:87], v[112:115]
    s_waitcnt vmcnt(7)
    buffer_load_dwordx4 v[168:171], v76, s[52:55], s86 offen offset:1024 nt
    v_mfma_f32_16x16x32_bf16 v[112:115], v[136:139], v[88:91], v[112:115]
    s_waitcnt vmcnt(7)
    buffer_load_dwordx4 v[172:175], v77, s[52:55], s86 offen offset:1024 nt
    v_mfma_f32_16x16x32_bf16 v[112:115], v[140:143], v[92:95], v[112:115]
    s_nop 7
    v_mov_b32_dpp v122, v112 quad_perm:[0,0,0,0] row_mask:0xf bank_mask:0xf
    v_mov_b32_dpp v124, v114 quad_perm:[2,2,2,2] row_mask:0xf bank_mask:0xf
    s_nop 0
    v_add_f32_dpp v122, v113, v122 quad_perm:[1,1,1,1] row_mask:0xf bank_mask:0xf
    v_add_f32_dpp v124, v115, v124 quad_perm:[3,3,3,3] row_mask:0xf bank_mask:0xf
    v_add_f32 v122, v122, v124
    v_fma_f32 v123, v122, s83, -v120
    v_cmp_lt_f32 vcc, 0, v123
    s_cbranch_vccz L_nomax_7
    v_mul_f32 v122, s83, v122
    s_nop 1
    v_max_f32_dpp v124, v122, v122 row_ror:4 row_mask:0xf bank_mask:0xf
    s_nop 1
    v_max_f32_dpp v124, v124, v124 row_ror:8 row_mask:0xf bank_mask:0xf
    v_mov_b32 v125, v124
    s_nop 1
    v_permlane16_swap_b32 v124, v125
    v_max_f32 v124, v124, v125
    v_mov_b32 v125, v124
    s_nop 1
    v_permlane32_swap_b32 v124, v125
    v_max_f32 v124, v124, v125
    v_and_b32 v124, s82, v124
    v_max_f32 v124, v124, v120
    v_sub_f32 v125, v120, v124
    v_exp_f32 v125, v125
    v_mov_b32 v120, v124
    v_sub_f32 v123, v122, v124
    v_mul_f32 v121, v121, v125
    v_mul_f32 v116, v116, v125
    v_mul_f32 v117, v117, v125
    v_mul_f32 v118, v118, v125
    v_mul_f32 v119, v119, v125
L_nomax_7:
    v_exp_f32 v123, v123
    s_nop 0
    v_cvt_pk_bf16_f32 v124, v123, v123
    v_add_f32 v121, v121, v123
    s_nop 0
    v_and_b32_dpp v96, v124, v10 row_newbcast:0 row_mask:0xf bank_mask:0xf
    v_and_b32_dpp v97, v124, v11 row_newbcast:0 row_mask:0xf bank_mask:0xf
    v_and_b32_dpp v98, v124, v12 row_newbcast:0 row_mask:0xf bank_mask:0xf
    v_and_b32_dpp v99, v124, v13 row_newbcast:0 row_mask:0xf bank_mask:0xf
    v_and_b32_dpp v100, v124, v10 row_newbcast:4 row_mask:0xf bank_mask:0xf
    v_and_b32_dpp v101, v124, v11 row_newbcast:4 row_mask:0xf bank_mask:0xf
    v_and_b32_dpp v102, v124, v12 row_newbcast:4 row_mask:0xf bank_mask:0xf
    v_and_b32_dpp v103, v124, v13 row_newbcast:4 row_mask:0xf bank_mask:0xf
    v_and_b32_dpp v104, v124, v10 row_newbcast:8 row_mask:0xf bank_mask:0xf
    v_and_b32_dpp v105, v124, v11 row_newbcast:8 row_mask:0xf bank_mask:0xf
    v_and_b32_dpp v106, v124, v12 row_newbcast:8 row_mask:0xf bank_mask:0xf
    v_and_b32_dpp v107, v124, v13 row_newbcast:8 row_mask:0xf bank_mask:0xf
    v_and_b32_dpp v108, v124, v10 row_newbcast:12 row_mask:0xf bank_mask:0xf
    v_and_b32_dpp v109, v124, v11 row_newbcast:12 row_mask:0xf bank_mask:0xf
    v_and_b32_dpp v110, v124, v12 row_newbcast:12 row_mask:0xf bank_mask:0xf
    v_and_b32_dpp v111, v124, v13 row_newbcast:12 row_mask:0xf bank_mask:0xf
    s_waitcnt vmcnt(7)
    buffer_load_dwordx4 v[176:179], v126, s[56:59], s86 offen offset:0 nt
    v_mfma_f32_16x16x32_bf16 v[116:119], v[144:147], v[96:99], v[116:119]
    s_waitcnt vmcnt(7)
    buffer_load_dwordx4 v[180:183], v127, s[56:59], s86 offen offset:0 nt
    v_mfma_f32_16x16x32_bf16 v[116:119], v[148:151], v[100:103], v[116:119]
    s_waitcnt vmcnt(7)
    buffer_load_dwordx4 v[184:187], v126, s[56:59], s86 offen offset:1024 nt
    v_mfma_f32_16x16x32_bf16 v[116:119], v[152:155], v[104:107], v[116:119]
    s_waitcnt vmcnt(7)
    buffer_load_dwordx4 v[188:191], v127, s[56:59], s86 offen offset:1024 nt
    v_mfma_f32_16x16x32_bf16 v[116:119], v[156:159], v[108:111], v[116:119]
    s_cmp_ge_u32 s93, 33
    s_cbranch_scc1 L_bdone
    s_waitcnt vmcnt(7)
    v_readfirstlane_b32 s93, v19
    s_nop 0
    s_sub_u32 s36, s93, 25
    s_and_b32 s38, s36, 3
    s_mul_i32 s38, s38, 7
    s_lshr_b32 s36, s36, 2
    s_add_u32 s87, s38, s36
    s_add_u32 s38, s93, 231
    s_cmp_lt_i32 s93, 25
    s_cselect_b32 s87, s38, s87
    s_add_u32 s93, s93, 8
    s_add_u32 s39, s87, s88
    s_bfe_u32 s37, s39, 0x30000
    s_lshl_b32 s37, s37, 12
    s_add_u32 s85, s37, s89
    s_bfe_u32 s37, s39, 0x10003
    s_lshl_b32 s37, s37, 11
    s_add_u32 s85, s37, s85
    s_bfe_u32 s37, s39, 0x40004
    s_lshl_b32 s37, s37, 16
    s_add_u32 s85, s37, s85
    s_cmp_ge_u32 s93, 33
    s_cselect_b32 s85, 134217728, s85
    v_mov_b32 v19, 25
    s_cmp_ge_u32 s93, 32
    s_cbranch_scc1 L_noclaim_8
    s_mov_b64 exec, 1
    global_atomic_add v19, v9, v18, s[30:31] sc0 sc1
    s_mov_b64 exec, -1
L_noclaim_8:
    buffer_load_dwordx4 v[128:131], v76, s[52:55], s85 offen offset:0 nt
    v_mfma_f32_16x16x32_bf16 v[112:115], v[160:163], v[80:83], 0
    s_waitcnt vmcnt(7)
    buffer_load_dwordx4 v[132:135], v77, s[52:55], s85 offen offset:0 nt
    v_mfma_f32_16x16x32_bf16 v[112:115], v[164:167], v[84:87], v[112:115]
    s_waitcnt vmcnt(7)
    buffer_load_dwordx4 v[136:139], v76, s[52:55], s85 offen offset:1024 nt
    v_mfma_f32_16x16x32_bf16 v[112:115], v[168:171], v[88:91], v[112:115]
    s_waitcnt vmcnt(7)
    buffer_load_dwordx4 v[140:143], v77, s[52:55], s85 offen offset:1024 nt
    v_mfma_f32_16x16x32_bf16 v[112:115], v[172:175], v[92:95], v[112:115]
    s_nop 7
    v_mov_b32_dpp v122, v112 quad_perm:[0,0,0,0] row_mask:0xf bank_mask:0xf
    v_mov_b32_dpp v124, v114 quad_perm:[2,2,2,2] row_mask:0xf bank_mask:0xf
    s_nop 0
    v_add_f32_dpp v122, v113, v122 quad_perm:[1,1,1,1] row_mask:0xf bank_mask:0xf
    v_add_f32_dpp v124, v115, v124 quad_perm:[3,3,3,3] row_mask:0xf bank_mask:0xf
    v_add_f32 v122, v122, v124
    v_fma_f32 v123, v122, s83, -v120
    v_cmp_lt_f32 vcc, 0, v123
    s_cbranch_vccz L_nomax_9
    v_mul_f32 v122, s83, v122
    s_nop 1
    v_max_f32_dpp v124, v122, v122 row_ror:4 row_mask:0xf bank_mask:0xf
    s_nop 1
    v_max_f32_dpp v124, v124, v124 row_ror:8 row_mask:0xf bank_mask:0xf
    v_mov_b32 v125, v124
    s_nop 1
    v_permlane16_swap_b32 v124, v125
    v_max_f32 v124, v124, v125
    v_mov_b32 v125, v124
    s_nop 1
    v_permlane32_swap_b32 v124, v125
    v_max_f32 v124, v124, v125
    v_and_b32 v124, s82, v124
    v_max_f32 v124, v124, v120
    v_sub_f32 v125, v120, v124
    v_exp_f32 v125, v125
    v_mov_b32 v120, v124
    v_sub_f32 v123, v122, v124
    v_mul_f32 v121, v121, v125
    v_mul_f32 v116, v116, v125
    v_mul_f32 v117, v117, v125
    v_mul_f32 v118, v118, v125
    v_mul_f32 v119, v119, v125
L_nomax_9:
    v_exp_f32 v123, v123
    s_nop 0
    v_cvt_pk_bf16_f32 v124, v123, v123
    v_add_f32 v121, v121, v123
    s_nop 0
    v_and_b32_dpp v96, v124, v10 row_newbcast:0 row_mask:0xf bank_mask:0xf
    v_and_b32_dpp v97, v124, v11 row_newbcast:0 row_mask:0xf bank_mask:0xf
    v_and_b32_dpp v98, v124, v12 row_newbcast:0 row_mask:0xf bank_mask:0xf
    v_and_b32_dpp v99, v124, v13 row_newbcast:0 row_mask:0xf bank_mask:0xf
    v_and_b32_dpp v100, v124, v10 row_newbcast:4 row_mask:0xf bank_mask:0xf
    v_and_b32_dpp v101, v124, v11 row_newbcast:4 row_mask:0xf bank_mask:0xf
    v_and_b32_dpp v102, v124, v12 row_newbcast:4 row_mask:0xf bank_mask:0xf
    v_and_b32_dpp v103, v124, v13 row_newbcast:4 row_mask:0xf bank_mask:0xf
    v_and_b32_dpp v104, v124, v10 row_newbcast:8 row_mask:0xf bank_mask:0xf
    v_and_b32_dpp v105, v124, v11 row_newbcast:8 row_mask:0xf bank_mask:0xf
    v_and_b32_dpp v106, v124, v12 row_newbcast:8 row_mask:0xf bank_mask:0xf
    v_and_b32_dpp v107, v124, v13 row_newbcast:8 row_mask:0xf bank_mask:0xf
    v_and_b32_dpp v108, v124, v10 row_newbcast:12 row_mask:0xf bank_mask:0xf
    v_and_b32_dpp v109, v124, v11 row_newbcast:12 row_mask:0xf bank_mask:0xf
    v_and_b32_dpp v110, v124, v12 row_newbcast:12 row_mask:0xf bank_mask:0xf
    v_and_b32_dpp v111, v124, v13 row_newbcast:12 row_mask:0xf bank_mask:0xf
    s_waitcnt vmcnt(7)
    buffer_load_dwordx4 v[144:147], v126, s[56:59], s85 offen offset:0 nt
    v_mfma_f32_16x16x32_bf16 v[116:119], v[176:179], v[96:99], v[116:119]
    s_waitcnt vmcnt(7)
    buffer_load_dwordx4 v[148:151], v127, s[56:59], s85 offen offset:0 nt
    v_mfma_f32_16x16x32_bf16 v[116:119], v[180:183], v[100:103], v[116:119]
    s_waitcnt vmcnt(7)
    buffer_load_dwordx4 v[152:155], v126, s[56:59], s85 offen offset:1024 nt
    v_mfma_f32_16x16x32_bf16 v[116:119], v[184:187], v[104:107], v[116:119]
    s_waitcnt vmcnt(7)
    buffer_load_dwordx4 v[156:159], v127, s[56:59], s85 offen offset:1024 nt
    v_mfma_f32_16x16x32_bf16 v[116:119], v[188:191], v[108:111], v[116:119]
    s_cmp_ge_u32 s93, 33
    s_cbranch_scc0 L_dloop
L_bdone:
    v_add_f32_dpp v121, v121, v121 row_ror:8 row_mask:0xf bank_mask:0xf
    s_nop 1
    v_add_f32_dpp v121, v121, v121 row_ror:4 row_mask:0xf bank_mask:0xf
    v_mov_b32 v125, v121
    s_nop 1
    v_permlane16_swap_b32 v121, v125
    v_add_f32 v121, v121, v125
    v_mov_b32 v125, v121
    v_and_or_b32 v118, v118, s82, v8
    v_and_or_b32 v119, v119, s82, v8
    v_permlane32_swap_b32 v121, v125
    s_mov_b32 exec_lo, 0x100
    s_mov_b32 exec_hi, 0x0
    v_add_f32 v117, v121, v125
    v_mov_b32 v116, v120
    s_mov_b32 exec_lo, 0xff01ff
    s_mov_b32 exec_hi, 0xff00ff
    v_and_or_b32 v116, v116, s82, v8
    v_and_or_b32 v117, v117, s82, v8
    buffer_store_dwordx4 v[116:119], v79, s[48:51], s96 offen sc1
    s_endpgm
L_qp:
    v_lshlrev_b32 v4, 18, v2
    v_lshl_add_u32 v14, v3, 4, v4
    v_lshrrev_b32 v5, 3, v3
    v_lshlrev_b32 v5, 10, v5
    v_lshl_add_u32 v15, v2, 6, v5
    s_cmp_eq_u32 s33, 0
    s_cselect_b32 s61, 3, 2
    s_xor_b32 s61, s61, s32
    s_lshl_b32 s86, s34, 8
    s_lshl_b32 s63, s34, 20
    s_lshl_b32 s38, s61, 8
    s_add_u32 s63, s63, s38
    s_mov_b32 s42, 4194304
    s_mov_b32 s43, 0x20000
    s_mov_b32 s46, 4096
    s_mov_b32 s47, 0x20000
    s_cmp_eq_u32 s33, 0
    s_waitcnt lgkmcnt(0)
    s_cselect_b64 s[40:41], s[22:23], s[8:9]
    s_cselect_b64 s[44:45], s[16:17], s[4:5]
    buffer_load_dwordx4 a[128:131], v14, s[40:43], s63 offen nt
    s_add_u32 s63, s63, 8192
    buffer_load_dwordx4 a[132:135], v14, s[40:43], s63 offen nt
    s_add_u32 s63, s63, 8192
    buffer_load_dwordx4 v[20:23], v15, s[44:47], s86 offen offset:0
    buffer_load_dwordx4 v[36:39], v15, s[44:47], s86 offen offset:2048
    buffer_load_dwordx4 a[136:139], v14, s[40:43], s63 offen nt
    s_add_u32 s63, s63, 8192
    buffer_load_dwordx4 a[140:143], v14, s[40:43], s63 offen nt
    s_add_u32 s63, s63, 8192
    buffer_load_dwordx4 a[144:147], v14, s[40:43], s63 offen nt
    s_add_u32 s63, s63, 8192
    buffer_load_dwordx4 a[148:151], v14, s[40:43], s63 offen nt
    s_add_u32 s63, s63, 8192
    buffer_load_dwordx4 a[152:155], v14, s[40:43], s63 offen nt
    s_add_u32 s63, s63, 8192
    buffer_load_dwordx4 a[156:159], v14, s[40:43], s63 offen nt
    s_add_u32 s63, s63, 8192
    s_load_dword s35, s[30:31], 0
    s_mov_b32 s48, s30
    s_and_b32 s49, s31, 0xffff
    s_mov_b32 s50, 8388608
    s_mov_b32 s51, 0x20000
    s_mov_b32 s82, 0xffffff00
    s_mov_b32 s83, 0x3e0293ee
    s_mov_b32 s84, 2097152
    v_and_b32 v4, 1, v1
    v_lshlrev_b32 v4, 4, v4
    v_mov_b32 v5, 0xffff
    v_lshlrev_b32 v4, v4, v5
    v_bfe_u32 v5, v1, 1, 2
    v_cmp_eq_u32 vcc, 0, v5
    s_nop 1
    v_cndmask_b32 v10, 0, v4, vcc
    v_cmp_eq_u32 vcc, 1, v5
    s_nop 1
    v_cndmask_b32 v11, 0, v4, vcc
    v_cmp_eq_u32 vcc, 2, v5
    s_nop 1
    v_cndmask_b32 v12, 0, v4, vcc
    v_cmp_eq_u32 vcc, 3, v5
    s_nop 1
    v_cndmask_b32 v13, 0, v4, vcc
    buffer_load_dwordx4 v[24:27], v15, s[44:47], s86 offen offset:16
    buffer_load_dwordx4 v[40:43], v15, s[44:47], s86 offen offset:2064
    buffer_load_dwordx4 v[28:31], v15, s[44:47], s86 offen offset:32
    buffer_load_dwordx4 v[44:47], v15, s[44:47], s86 offen offset:2080
    buffer_load_dwordx4 v[32:35], v15, s[44:47], s86 offen offset:48
    buffer_load_dwordx4 v[48:51], v15, s[44:47], s86 offen offset:2096
    s_lshl_b32 s38, s61, 10
    s_add_u32 s36, s38, 65536
    s_lshl_b32 s38, s34, 8
    s_add_u32 s36, s38, s36
    v_mov_b32 v19, 0
    s_cmp_eq_u32 s33, 0
    s_cselect_b32 s38, s36, 8388608
    s_mov_b64 exec, 1
    buffer_store_dword v19, v19, s[48:51], s38 offen sc1
    s_mov_b64 exec, -1
    s_mov_b32 s80, 0x01000100
    s_mov_b32 s81, 0x03020302
    s_waitcnt vmcnt(13)
    buffer_load_dwordx4 a[160:163], v14, s[40:43], s63 offen nt
    s_add_u32 s63, s63, 8192
    v_perm_b32 v4, v20, v20, s80
    v_perm_b32 v5, v36, v36, s80
    v_and_b32 v52, v4, v10
    v_and_b32 v53, v4, v11
    v_and_b32 v54, v4, v12
    v_and_b32 v55, v4, v13
    v_and_b32 v56, v5, v10
    v_and_b32 v57, v5, v11
    v_and_b32 v58, v5, v12
    v_and_b32 v59, v5, v13
    v_mfma_f32_16x16x32_bf16 v[60:63], a[128:131], v[52:55], 0
    s_nop 0
    v_mfma_f32_16x16x32_bf16 v[64:67], a[128:131], v[56:59], 0
    buffer_load_dwordx4 a[164:167], v14, s[40:43], s63 offen nt
    s_add_u32 s63, s63, 8192
    v_perm_b32 v4, v20, v20, s81
    v_perm_b32 v5, v36, v36, s81
    v_and_b32 v52, v4, v10
    v_and_b32 v53, v4, v11
    v_and_b32 v54, v4, v12
    v_and_b32 v55, v4, v13
    v_and_b32 v56, v5, v10
    v_and_b32 v57, v5, v11
    v_and_b32 v58, v5, v12
    v_and_b32 v59, v5, v13
    v_mfma_f32_16x16x32_bf16 v[60:63], a[132:135], v[52:55], v[60:63]
    s_nop 0
    v_mfma_f32_16x16x32_bf16 v[64:67], a[132:135], v[56:59], v[64:67]
    s_waitcnt vmcnt(14)
    buffer_load_dwordx4 a[168:171], v14, s[40:43], s63 offen nt
    s_add_u32 s63, s63, 8192
    v_perm_b32 v4, v21, v21, s80
    v_perm_b32 v5, v37, v37, s80
    v_and_b32 v52, v4, v10
    v_and_b32 v53, v4, v11
    v_and_b32 v54, v4, v12
    v_and_b32 v55, v4, v13
    v_and_b32 v56, v5, v10
    v_and_b32 v57, v5, v11
    v_and_b32 v58, v5, v12
    v_and_b32 v59, v5, v13
    v_mfma_f32_16x16x32_bf16 v[60:63], a[136:139], v[52:55], v[60:63]
    s_nop 0
    v_mfma_f32_16x16x32_bf16 v[64:67], a[136:139], v[56:59], v[64:67]
    s_waitcnt vmcnt(14)
    buffer_load_dwordx4 a[172:175], v14, s[40:43], s63 offen nt
    s_add_u32 s63, s63, 8192
    v_perm_b32 v4, v21, v21, s81
    v_perm_b32 v5, v37, v37, s81
    v_and_b32 v52, v4, v10
    v_and_b32 v53, v4, v11
    v_and_b32 v54, v4, v12
    v_and_b32 v55, v4, v13
    v_and_b32 v56, v5, v10
    v_and_b32 v57, v5, v11
    v_and_b32 v58, v5, v12
    v_and_b32 v59, v5, v13
    v_mfma_f32_16x16x32_bf16 v[60:63], a[140:143], v[52:55], v[60:63]
    s_nop 0
    v_mfma_f32_16x16x32_bf16 v[64:67], a[140:143], v[56:59], v[64:67]
    s_waitcnt vmcnt(14)
    buffer_load_dwordx4 a[176:179], v14, s[40:43], s63 offen nt
    s_add_u32 s63, s63, 8192
    v_lshrrev_b32 v4, 2, v3
    v_and_b32 v5, 3, v3
    v_lshlrev_b32 v76, 8, v4
    v_lshlrev_b32 v126, 8, v2
    v_lshl_add_u32 v76, v2, 6, v76
    v_lshl_add_u32 v76, v5, 4, v76
    v_lshl_add_u32 v126, v3, 4, v126
    v_xor_b32 v77, 32768, v76
    v_xor_b32 v127, 32768, v126
    s_add_u32 s3, s34, s33
    s_and_b32 s3, s3, 3
    s_lshl_b32 s89, s3, 5
    s_add_u32 s89, s89, s32
    s_lshl_b32 s89, s89, 20
    s_mul_i32 s88, s32, 8
    s_add_u32 s88, s88, s3
    s_add_u32 s87, s33, 0
    v_perm_b32 v4, v22, v22, s80
    v_perm_b32 v5, v38, v38, s80
    v_and_b32 v52, v4, v10
    v_and_b32 v53, v4, v11
    v_and_b32 v54, v4, v12
    v_and_b32 v55, v4, v13
    v_and_b32 v56, v5, v10
    v_and_b32 v57, v5, v11
    v_and_b32 v58, v5, v12
    v_and_b32 v59, v5, v13
    v_mfma_f32_16x16x32_bf16 v[60:63], a[144:147], v[52:55], v[60:63]
    s_nop 0
    v_mfma_f32_16x16x32_bf16 v[64:67], a[144:147], v[56:59], v[64:67]
    s_waitcnt vmcnt(14)
    buffer_load_dwordx4 a[180:183], v14, s[40:43], s63 offen nt
    s_add_u32 s63, s63, 8192
    v_perm_b32 v4, v22, v22, s81
    v_perm_b32 v5, v38, v38, s81
    v_and_b32 v52, v4, v10
    v_and_b32 v53, v4, v11
    v_and_b32 v54, v4, v12
    v_and_b32 v55, v4, v13
    v_and_b32 v56, v5, v10
    v_and_b32 v57, v5, v11
    v_and_b32 v58, v5, v12
    v_and_b32 v59, v5, v13
    v_mfma_f32_16x16x32_bf16 v[60:63], a[148:151], v[52:55], v[60:63]
    s_nop 0
    v_mfma_f32_16x16x32_bf16 v[64:67], a[148:151], v[56:59], v[64:67]
    s_waitcnt vmcnt(14)
    buffer_load_dwordx4 a[184:187], v14, s[40:43], s63 offen nt
    s_add_u32 s63, s63, 8192
    v_perm_b32 v4, v23, v23, s80
    v_perm_b32 v5, v39, v39, s80
    v_and_b32 v52, v4, v10
    v_and_b32 v53, v4, v11
    v_and_b32 v54, v4, v12
    v_and_b32 v55, v4, v13
    v_and_b32 v56, v5, v10
    v_and_b32 v57, v5, v11
    v_and_b32 v58, v5, v12
    v_and_b32 v59, v5, v13
    v_mfma_f32_16x16x32_bf16 v[60:63], a[152:155], v[52:55], v[60:63]
    s_nop 0
    v_mfma_f32_16x16x32_bf16 v[64:67], a[152:155], v[56:59], v[64:67]
    s_waitcnt vmcnt(14)
    buffer_load_dwordx4 a[188:191], v14, s[40:43], s63 offen nt
    s_add_u32 s63, s63, 8192
    v_perm_b32 v4, v23, v23, s81
    v_perm_b32 v5, v39, v39, s81
    v_and_b32 v52, v4, v10
    v_and_b32 v53, v4, v11
    v_and_b32 v54, v4, v12
    v_and_b32 v55, v4, v13
    v_and_b32 v56, v5, v10
    v_and_b32 v57, v5, v11
    v_and_b32 v58, v5, v12
    v_and_b32 v59, v5, v13
    v_mfma_f32_16x16x32_bf16 v[60:63], a[156:159], v[52:55], v[60:63]
    s_nop 0
    v_mfma_f32_16x16x32_bf16 v[64:67], a[156:159], v[56:59], v[64:67]
    s_waitcnt vmcnt(13)
    s_waitcnt vmcnt(7)
    buffer_load_dwordx4 a[192:195], v14, s[40:43], s63 offen nt
    s_add_u32 s63, s63, 8192
    s_mov_b32 s52, s18
    s_and_b32 s53, s19, 0xffff
    s_mov_b32 s54, 134217728
    s_mov_b32 s55, 0x20000
    s_mov_b32 s56, s20
    s_and_b32 s57, s21, 0xffff
    s_mov_b32 s58, 134217728
    s_mov_b32 s59, 0x20000
    v_perm_b32 v4, v24, v24, s80
    v_perm_b32 v5, v40, v40, s80
    v_and_b32 v52, v4, v10
    v_and_b32 v53, v4, v11
    v_and_b32 v54, v4, v12
    v_and_b32 v55, v4, v13
    v_and_b32 v56, v5, v10
    v_and_b32 v57, v5, v11
    v_and_b32 v58, v5, v12
    v_and_b32 v59, v5, v13
    v_mfma_f32_16x16x32_bf16 v[60:63], a[160:163], v[52:55], v[60:63]
    s_nop 0
    v_mfma_f32_16x16x32_bf16 v[64:67], a[160:163], v[56:59], v[64:67]
    s_waitcnt vmcnt(7)
    buffer_load_dwordx4 a[196:199], v14, s[40:43], s63 offen nt
    s_add_u32 s63, s63, 8192
    v_perm_b32 v4, v24, v24, s81
    v_perm_b32 v5, v40, v40, s81
    v_and_b32 v52, v4, v10
    v_and_b32 v53, v4, v11
    v_and_b32 v54, v4, v12
    v_and_b32 v55, v4, v13
    v_and_b32 v56, v5, v10
    v_and_b32 v57, v5, v11
    v_and_b32 v58, v5, v12
    v_and_b32 v59, v5, v13
    v_mfma_f32_16x16x32_bf16 v[60:63], a[164:167], v[52:55], v[60:63]
    s_nop 0
    v_mfma_f32_16x16x32_bf16 v[64:67], a[164:167], v[56:59], v[64:67]
    s_waitcnt vmcnt(7)
    buffer_load_dwordx4 a[200:203], v14, s[40:43], s63 offen nt
    s_add_u32 s63, s63, 8192
    v_perm_b32 v4, v25, v25, s80
    v_perm_b32 v5, v41, v41, s80
    v_and_b32 v52, v4, v10
    v_and_b32 v53, v4, v11
    v_and_b32 v54, v4, v12
    v_and_b32 v55, v4, v13
    v_and_b32 v56, v5, v10
    v_and_b32 v57, v5, v11
    v_and_b32 v58, v5, v12
    v_and_b32 v59, v5, v13
    v_mfma_f32_16x16x32_bf16 v[60:63], a[168:171], v[52:55], v[60:63]
    s_nop 0
    v_mfma_f32_16x16x32_bf16 v[64:67], a[168:171], v[56:59], v[64:67]
    s_waitcnt vmcnt(7)
    buffer_load_dwordx4 a[204:207], v14, s[40:43], s63 offen nt
    s_add_u32 s63, s63, 8192
    v_perm_b32 v4, v25, v25, s81
    v_perm_b32 v5, v41, v41, s81
    v_and_b32 v52, v4, v10
    v_and_b32 v53, v4, v11
    v_and_b32 v54, v4, v12
    v_and_b32 v55, v4, v13
    v_and_b32 v56, v5, v10
    v_and_b32 v57, v5, v11
    v_and_b32 v58, v5, v12
    v_and_b32 v59, v5, v13
    v_mfma_f32_16x16x32_bf16 v[60:63], a[172:175], v[52:55], v[60:63]
    s_nop 0
    v_mfma_f32_16x16x32_bf16 v[64:67], a[172:175], v[56:59], v[64:67]
    s_waitcnt vmcnt(7)
    buffer_load_dwordx4 a[208:211], v14, s[40:43], s63 offen nt
    s_add_u32 s63, s63, 8192
    v_mov_b32 v120, 0xff7f0000
    v_mov_b32 v121, 0
    v_mov_b32 v18, 1
    v_mov_b32 v116, 0
    v_mov_b32 v117, 0
    v_mov_b32 v118, 0
    v_mov_b32 v119, 0
    s_lshl_b32 s38, s32, 10
    s_add_u32 s96, s38, 65536
    s_lshl_b32 s38, s3, 8
    s_add_u32 s96, s38, s96
    v_mov_b32 v9, s96
    s_lshl_b32 s38, s32, 15
    s_add_u32 s96, s38, 1048576
    s_lshl_b32 s38, s3, 13
    s_add_u32 s96, s38, s96
    s_lshl_b32 s38, s33, 10
    s_add_u32 s96, s38, s96
    v_and_b32 v5, 3, v3
    v_lshlrev_b32 v78, 7, v2
    v_lshl_add_u32 v78, v5, 5, v78
    s_lshl_b32 s38, s32, 12
    s_add_u32 s91, s38, 262144
    s_lshl_b32 s38, s3, 9
    s_add_u32 s91, s38, s91
    v_lshlrev_b32 v4, 7, v2
    v_lshl_add_u32 v4, v3, 4, v4
    v_mov_b32 v5, 512
    v_cmp_gt_u32 vcc, 8, v3
    s_nop 1
    v_cndmask_b32 v79, v5, v4, vcc
    v_perm_b32 v4, v26, v26, s80
    v_perm_b32 v5, v42, v42, s80
    v_and_b32 v52, v4, v10
    v_and_b32 v53, v4, v11
    v_and_b32 v54, v4, v12
    v_and_b32 v55, v4, v13
    v_and_b32 v56, v5, v10
    v_and_b32 v57, v5, v11
    v_and_b32 v58, v5, v12
    v_and_b32 v59, v5, v13
    v_mfma_f32_16x16x32_bf16 v[60:63], a[176:179], v[52:55], v[60:63]
    s_nop 0
    v_mfma_f32_16x16x32_bf16 v[64:67], a[176:179], v[56:59], v[64:67]
    s_waitcnt vmcnt(7)
    buffer_load_dwordx4 a[212:215], v14, s[40:43], s63 offen nt
    s_add_u32 s63, s63, 8192
    v_perm_b32 v4, v26, v26, s81
    v_perm_b32 v5, v42, v42, s81
    v_and_b32 v52, v4, v10
    v_and_b32 v53, v4, v11
    v_and_b32 v54, v4, v12
    v_and_b32 v55, v4, v13
    v_and_b32 v56, v5, v10
    v_and_b32 v57, v5, v11
    v_and_b32 v58, v5, v12
    v_and_b32 v59, v5, v13
    v_mfma_f32_16x16x32_bf16 v[60:63], a[180:183], v[52:55], v[60:63]
    s_nop 0
    v_mfma_f32_16x16x32_bf16 v[64:67], a[180:183], v[56:59], v[64:67]
    s_waitcnt vmcnt(7)
    buffer_load_dwordx4 a[216:219], v14, s[40:43], s63 offen nt
    s_add_u32 s63, s63, 8192
    v_perm_b32 v4, v27, v27, s80
    v_perm_b32 v5, v43, v43, s80
    v_and_b32 v52, v4, v10
    v_and_b32 v53, v4, v11
    v_and_b32 v54, v4, v12
    v_and_b32 v55, v4, v13
    v_and_b32 v56, v5, v10
    v_and_b32 v57, v5, v11
    v_and_b32 v58, v5, v12
    v_and_b32 v59, v5, v13
    v_mfma_f32_16x16x32_bf16 v[60:63], a[184:187], v[52:55], v[60:63]
    s_nop 0
    v_mfma_f32_16x16x32_bf16 v[64:67], a[184:187], v[56:59], v[64:67]
    s_waitcnt vmcnt(7)
    buffer_load_dwordx4 a[220:223], v14, s[40:43], s63 offen nt
    s_add_u32 s63, s63, 8192
    v_perm_b32 v4, v27, v27, s81
    v_perm_b32 v5, v43, v43, s81
    v_and_b32 v52, v4, v10
    v_and_b32 v53, v4, v11
    v_and_b32 v54, v4, v12
    v_and_b32 v55, v4, v13
    v_and_b32 v56, v5, v10
    v_and_b32 v57, v5, v11
    v_and_b32 v58, v5, v12
    v_and_b32 v59, v5, v13
    v_mfma_f32_16x16x32_bf16 v[60:63], a[188:191], v[52:55], v[60:63]
    s_nop 0
    v_mfma_f32_16x16x32_bf16 v[64:67], a[188:191], v[56:59], v[64:67]
    s_waitcnt vmcnt(7)
    buffer_load_dwordx4 a[224:227], v14, s[40:43], s63 offen nt
    s_add_u32 s63, s63, 8192
    v_perm_b32 v4, v28, v28, s80
    v_perm_b32 v5, v44, v44, s80
    v_and_b32 v52, v4, v10
    v_and_b32 v53, v4, v11
    v_and_b32 v54, v4, v12
    v_and_b32 v55, v4, v13
    v_and_b32 v56, v5, v10
    v_and_b32 v57, v5, v11
    v_and_b32 v58, v5, v12
    v_and_b32 v59, v5, v13
    v_mfma_f32_16x16x32_bf16 v[60:63], a[192:195], v[52:55], v[60:63]
    s_nop 0
    v_mfma_f32_16x16x32_bf16 v[64:67], a[192:195], v[56:59], v[64:67]
    s_waitcnt vmcnt(7)
    buffer_load_dwordx4 a[228:231], v14, s[40:43], s63 offen nt
    s_add_u32 s63, s63, 8192
    v_perm_b32 v4, v28, v28, s81
    v_perm_b32 v5, v44, v44, s81
    v_and_b32 v52, v4, v10
    v_and_b32 v53, v4, v11
    v_and_b32 v54, v4, v12
    v_and_b32 v55, v4, v13
    v_and_b32 v56, v5, v10
    v_and_b32 v57, v5, v11
    v_and_b32 v58, v5, v12
    v_and_b32 v59, v5, v13
    v_mfma_f32_16x16x32_bf16 v[60:63], a[196:199], v[52:55], v[60:63]
    s_nop 0
    v_mfma_f32_16x16x32_bf16 v[64:67], a[196:199], v[56:59], v[64:67]
    s_waitcnt vmcnt(7)
    buffer_load_dwordx4 a[232:235], v14, s[40:43], s63 offen nt
    s_add_u32 s63, s63, 8192
    v_perm_b32 v4, v29, v29, s80
    v_perm_b32 v5, v45, v45, s80
    v_and_b32 v52, v4, v10
    v_and_b32 v53, v4, v11
    v_and_b32 v54, v4, v12
    v_and_b32 v55, v4, v13
    v_and_b32 v56, v5, v10
    v_and_b32 v57, v5, v11
    v_and_b32 v58, v5, v12
    v_and_b32 v59, v5, v13
    v_mfma_f32_16x16x32_bf16 v[60:63], a[200:203], v[52:55], v[60:63]
    s_nop 0
    v_mfma_f32_16x16x32_bf16 v[64:67], a[200:203], v[56:59], v[64:67]
    s_waitcnt vmcnt(7)
    buffer_load_dwordx4 a[236:239], v14, s[40:43], s63 offen nt
    s_add_u32 s63, s63, 8192
    v_perm_b32 v4, v29, v29, s81
    v_perm_b32 v5, v45, v45, s81
    v_and_b32 v52, v4, v10
    v_and_b32 v53, v4, v11
    v_and_b32 v54, v4, v12
    v_and_b32 v55, v4, v13
    v_and_b32 v56, v5, v10
    v_and_b32 v57, v5, v11
    v_and_b32 v58, v5, v12
    v_and_b32 v59, v5, v13
    v_mfma_f32_16x16x32_bf16 v[60:63], a[204:207], v[52:55], v[60:63]
    s_nop 0
    v_mfma_f32_16x16x32_bf16 v[64:67], a[204:207], v[56:59], v[64:67]
    s_waitcnt vmcnt(7)
    buffer_load_dwordx4 a[240:243], v14, s[40:43], s63 offen nt
    s_add_u32 s63, s63, 8192
    v_perm_b32 v4, v30, v30, s80
    v_perm_b32 v5, v46, v46, s80
    v_and_b32 v52, v4, v10
    v_and_b32 v53, v4, v11
    v_and_b32 v54, v4, v12
    v_and_b32 v55, v4, v13
    v_and_b32 v56, v5, v10
    v_and_b32 v57, v5, v11
    v_and_b32 v58, v5, v12
    v_and_b32 v59, v5, v13
    v_mfma_f32_16x16x32_bf16 v[60:63], a[208:211], v[52:55], v[60:63]
    s_nop 0
    v_mfma_f32_16x16x32_bf16 v[64:67], a[208:211], v[56:59], v[64:67]
    s_waitcnt vmcnt(7)
    buffer_load_dwordx4 a[244:247], v14, s[40:43], s63 offen nt
    s_add_u32 s63, s63, 8192
    v_perm_b32 v4, v30, v30, s81
    v_perm_b32 v5, v46, v46, s81
    v_and_b32 v52, v4, v10
    v_and_b32 v53, v4, v11
    v_and_b32 v54, v4, v12
    v_and_b32 v55, v4, v13
    v_and_b32 v56, v5, v10
    v_and_b32 v57, v5, v11
    v_and_b32 v58, v5, v12
    v_and_b32 v59, v5, v13
    v_mfma_f32_16x16x32_bf16 v[60:63], a[212:215], v[52:55], v[60:63]
    s_nop 0
    v_mfma_f32_16x16x32_bf16 v[64:67], a[212:215], v[56:59], v[64:67]
    s_waitcnt vmcnt(7)
    buffer_load_dwordx4 a[248:251], v14, s[40:43], s63 offen nt
    s_add_u32 s63, s63, 8192
    v_perm_b32 v4, v31, v31, s80
    v_perm_b32 v5, v47, v47, s80
    v_and_b32 v52, v4, v10
    v_and_b32 v53, v4, v11
    v_and_b32 v54, v4, v12
    v_and_b32 v55, v4, v13
    v_and_b32 v56, v5, v10
    v_and_b32 v57, v5, v11
    v_and_b32 v58, v5, v12
    v_and_b32 v59, v5, v13
    v_mfma_f32_16x16x32_bf16 v[60:63], a[216:219], v[52:55], v[60:63]
    s_nop 0
    v_mfma_f32_16x16x32_bf16 v[64:67], a[216:219], v[56:59], v[64:67]
    s_waitcnt vmcnt(7)
    buffer_load_dwordx4 a[252:255], v14, s[40:43], s63 offen nt
    s_add_u32 s63, s63, 8192
    v_perm_b32 v4, v31, v31, s81
    v_perm_b32 v5, v47, v47, s81
    v_and_b32 v52, v4, v10
    v_and_b32 v53, v4, v11
    v_and_b32 v54, v4, v12
    v_and_b32 v55, v4, v13
    v_and_b32 v56, v5, v10
    v_and_b32 v57, v5, v11
    v_and_b32 v58, v5, v12
    v_and_b32 v59, v5, v13
    v_mfma_f32_16x16x32_bf16 v[60:63], a[220:223], v[52:55], v[60:63]
    s_nop 0
    v_mfma_f32_16x16x32_bf16 v[64:67], a[220:223], v[56:59], v[64:67]
    s_waitcnt vmcnt(7)
    v_perm_b32 v4, v32, v32, s80
    v_perm_b32 v5, v48, v48, s80
    v_and_b32 v52, v4, v10
    v_and_b32 v53, v4, v11
    v_and_b32 v54, v4, v12
    v_and_b32 v55, v4, v13
    v_and_b32 v56, v5, v10
    v_and_b32 v57, v5, v11
    v_and_b32 v58, v5, v12
    v_and_b32 v59, v5, v13
    v_mfma_f32_16x16x32_bf16 v[60:63], a[224:227], v[52:55], v[60:63]
    s_nop 0
    v_mfma_f32_16x16x32_bf16 v[64:67], a[224:227], v[56:59], v[64:67]
    s_waitcnt vmcnt(6)
    s_add_u32 s39, s87, s88
    s_bfe_u32 s37, s39, 0x30000
    s_lshl_b32 s37, s37, 12
    s_add_u32 s85, s37, s89
    s_bfe_u32 s37, s39, 0x10003
    s_lshl_b32 s37, s37, 11
    s_add_u32 s85, s37, s85
    s_bfe_u32 s37, s39, 0x40004
    s_lshl_b32 s37, s37, 16
    s_add_u32 s85, s37, s85
    buffer_load_dwordx4 v[128:131], v76, s[52:55], s85 offen offset:0 nt
    v_perm_b32 v4, v32, v32, s81
    v_perm_b32 v5, v48, v48, s81
    v_and_b32 v52, v4, v10
    v_and_b32 v53, v4, v11
    v_and_b32 v54, v4, v12
    v_and_b32 v55, v4, v13
    v_and_b32 v56, v5, v10
    v_and_b32 v57, v5, v11
    v_and_b32 v58, v5, v12
    v_and_b32 v59, v5, v13
    v_mfma_f32_16x16x32_bf16 v[60:63], a[228:231], v[52:55], v[60:63]
    s_nop 0
    v_mfma_f32_16x16x32_bf16 v[64:67], a[228:231], v[56:59], v[64:67]
    s_waitcnt vmcnt(6)
    buffer_load_dwordx4 v[132:135], v77, s[52:55], s85 offen offset:0 nt
    v_perm_b32 v4, v33, v33, s80
    v_perm_b32 v5, v49, v49, s80
    v_and_b32 v52, v4, v10
    v_and_b32 v53, v4, v11
    v_and_b32 v54, v4, v12
    v_and_b32 v55, v4, v13
    v_and_b32 v56, v5, v10
    v_and_b32 v57, v5, v11
    v_and_b32 v58, v5, v12
    v_and_b32 v59, v5, v13
    v_mfma_f32_16x16x32_bf16 v[60:63], a[232:235], v[52:55], v[60:63]
    s_nop 0
    v_mfma_f32_16x16x32_bf16 v[64:67], a[232:235], v[56:59], v[64:67]
    s_waitcnt vmcnt(6)
    buffer_load_dwordx4 v[136:139], v76, s[52:55], s85 offen offset:1024 nt
    v_perm_b32 v4, v33, v33, s81
    v_perm_b32 v5, v49, v49, s81
    v_and_b32 v52, v4, v10
    v_and_b32 v53, v4, v11
    v_and_b32 v54, v4, v12
    v_and_b32 v55, v4, v13
    v_and_b32 v56, v5, v10
    v_and_b32 v57, v5, v11
    v_and_b32 v58, v5, v12
    v_and_b32 v59, v5, v13
    v_mfma_f32_16x16x32_bf16 v[60:63], a[236:239], v[52:55], v[60:63]
    s_nop 0
    v_mfma_f32_16x16x32_bf16 v[64:67], a[236:239], v[56:59], v[64:67]
    s_waitcnt vmcnt(6)
    buffer_load_dwordx4 v[140:143], v77, s[52:55], s85 offen offset:1024 nt
    s_add_u32 s87, s87, 7
    s_add_u32 s39, s87, s88
    s_bfe_u32 s37, s39, 0x30000
    s_lshl_b32 s37, s37, 12
    s_add_u32 s85, s37, s89
    s_bfe_u32 s37, s39, 0x10003
    s_lshl_b32 s37, s37, 11
    s_add_u32 s85, s37, s85
    s_bfe_u32 s37, s39, 0x40004
    s_lshl_b32 s37, s37, 16
    s_add_u32 s85, s37, s85
    v_perm_b32 v4, v34, v34, s80
    v_perm_b32 v5, v50, v50, s80
    v_and_b32 v52, v4, v10
    v_and_b32 v53, v4, v11
    v_and_b32 v54, v4, v12
    v_and_b32 v55, v4, v13
    v_and_b32 v56, v5, v10
    v_and_b32 v57, v5, v11
    v_and_b32 v58, v5, v12
    v_and_b32 v59, v5, v13
    v_mfma_f32_16x16x32_bf16 v[60:63], a[240:243], v[52:55], v[60:63]
    s_nop 0
    v_mfma_f32_16x16x32_bf16 v[64:67], a[240:243], v[56:59], v[64:67]
    s_waitcnt vmcnt(6)
    buffer_load_dwordx4 v[144:147], v76, s[52:55], s85 offen offset:0 nt
    v_perm_b32 v4, v34, v34, s81
    v_perm_b32 v5, v50, v50, s81
    v_and_b32 v52, v4, v10
    v_and_b32 v53, v4, v11
    v_and_b32 v54, v4, v12
    v_and_b32 v55, v4, v13
    v_and_b32 v56, v5, v10
    v_and_b32 v57, v5, v11
    v_and_b32 v58, v5, v12
    v_and_b32 v59, v5, v13
    v_mfma_f32_16x16x32_bf16 v[60:63], a[244:247], v[52:55], v[60:63]
    s_nop 0
    v_mfma_f32_16x16x32_bf16 v[64:67], a[244:247], v[56:59], v[64:67]
    s_waitcnt vmcnt(6)
    buffer_load_dwordx4 v[148:151], v77, s[52:55], s85 offen offset:0 nt
    v_perm_b32 v4, v35, v35, s80
    v_perm_b32 v5, v51, v51, s80
    v_and_b32 v52, v4, v10
    v_and_b32 v53, v4, v11
    v_and_b32 v54, v4, v12
    v_and_b32 v55, v4, v13
    v_and_b32 v56, v5, v10
    v_and_b32 v57, v5, v11
    v_and_b32 v58, v5, v12
    v_and_b32 v59, v5, v13
    v_mfma_f32_16x16x32_bf16 v[60:63], a[248:251], v[52:55], v[60:63]
    s_nop 0
    v_mfma_f32_16x16x32_bf16 v[64:67], a[248:251], v[56:59], v[64:67]
    s_waitcnt vmcnt(6)
    buffer_load_dwordx4 v[152:155], v76, s[52:55], s85 offen offset:1024 nt
    v_perm_b32 v4, v35, v35, s81
    v_perm_b32 v5, v51, v51, s81
    v_and_b32 v52, v4, v10
    v_and_b32 v53, v4, v11
    v_and_b32 v54, v4, v12
    v_and_b32 v55, v4, v13
    v_and_b32 v56, v5, v10
    v_and_b32 v57, v5, v11
    v_and_b32 v58, v5, v12
    v_and_b32 v59, v5, v13
    v_mfma_f32_16x16x32_bf16 v[60:63], a[252:255], v[52:55], v[60:63]
    s_nop 0
    v_mfma_f32_16x16x32_bf16 v[64:67], a[252:255], v[56:59], v[64:67]
    s_lshl_b32 s38, s34, 11
    v_lshrrev_b32 v4, 3, v3
    v_lshlrev_b32 v4, 9, v4
    v_lshl_add_u32 v4, v2, 7, v4
    v_and_b32 v5, 7, v3
    v_lshl_add_u32 v4, v5, 2, v4
    v_add_u32 v4, s38, v4
    ds_write_b32 v4, v60 offset:0
    ds_write_b32 v4, v61 offset:32
    ds_write_b32 v4, v62 offset:64
    ds_write_b32 v4, v63 offset:96
    ds_write_b32 v4, v64 offset:1024
    ds_write_b32 v4, v65 offset:1056
    ds_write_b32 v4, v66 offset:1088
    ds_write_b32 v4, v67 offset:1120
    s_lshl_b32 s38, s34, 9
    v_and_b32 v5, 31, v1
    v_lshl_add_u32 v5, v5, 4, s38
    s_waitcnt lgkmcnt(0)
    s_add_u32 s35, s35, 0x5b
    s_and_b32 s35, s35, 0xff
    v_mov_b32 v8, s35
    s_barrier
    ds_read_b128 v[20:23], v5 offset:0
    ds_read_b128 v[24:27], v5 offset:2048
    ds_read_b128 v[28:31], v5 offset:4096
    ds_read_b128 v[32:35], v5 offset:6144
    s_lshl_b32 s38, s61, 12
    s_add_u32 s36, s38, 262144
    s_lshl_b32 s38, s33, 11
    s_add_u32 s36, s38, s36
    s_waitcnt lgkmcnt(0)
    v_add_f32 v20, v20, v24
    v_add_f32 v28, v28, v32
    v_add_f32 v21, v21, v25
    v_add_f32 v29, v29, v33
    v_add_f32 v22, v22, v26
    v_add_f32 v30, v30, v34
    v_add_f32 v23, v23, v27
    v_add_f32 v31, v31, v35
    v_add_f32 v20, v20, v28
    v_add_f32 v21, v21, v29
    v_add_f32 v22, v22, v30
    v_add_f32 v23, v23, v31
    v_and_or_b32 v20, v20, s82, v8
    v_and_or_b32 v21, v21, s82, v8
    v_and_or_b32 v22, v22, s82, v8
    v_and_or_b32 v23, v23, s82, v8
    s_mov_b32 exec_lo, 0xffffffff
    s_mov_b32 exec_hi, 0x0
    buffer_store_dwordx4 v[20:23], v5, s[48:51], s36 offen sc1
    s_mov_b64 exec, -1
    s_waitcnt vmcnt(7)
    buffer_load_dwordx4 v[156:159], v77, s[52:55], s85 offen offset:1024 nt
    s_add_u32 s87, s87, 7
    s_add_u32 s39, s87, s88
    s_bfe_u32 s37, s39, 0x30000
    s_lshl_b32 s37, s37, 12
    s_add_u32 s85, s37, s89
    s_bfe_u32 s37, s39, 0x10003
    s_lshl_b32 s37, s37, 11
    s_add_u32 s85, s37, s85
    s_bfe_u32 s37, s39, 0x40004
    s_lshl_b32 s37, s37, 16
    s_add_u32 s85, s37, s85
    s_waitcnt vmcnt(7)
    buffer_load_dwordx4 v[160:163], v76, s[52:55], s85 offen offset:0 nt
    s_waitcnt vmcnt(7)
    buffer_load_dwordx4 v[164:167], v77, s[52:55], s85 offen offset:0 nt
    s_waitcnt vmcnt(7)
    buffer_load_dwordx4 v[168:171], v76, s[52:55], s85 offen offset:1024 nt
    s_waitcnt vmcnt(7)
    buffer_load_dwordx4 v[172:175], v77, s[52:55], s85 offen offset:1024 nt
    s_add_u32 s87, s87, 7
    s_add_u32 s39, s87, s88
    s_bfe_u32 s37, s39, 0x30000
    s_lshl_b32 s37, s37, 12
    s_add_u32 s85, s37, s89
    s_bfe_u32 s37, s39, 0x10003
    s_lshl_b32 s37, s37, 11
    s_add_u32 s85, s37, s85
    s_bfe_u32 s37, s39, 0x40004
    s_lshl_b32 s37, s37, 16
    s_add_u32 s85, s37, s85
    s_waitcnt vmcnt(7)
    buffer_load_dwordx4 v[176:179], v76, s[52:55], s85 offen offset:0 nt
    s_waitcnt vmcnt(7)
    buffer_load_dwordx4 v[180:183], v77, s[52:55], s85 offen offset:0 nt
    s_waitcnt vmcnt(6)
    buffer_load_dwordx4 v[184:187], v76, s[52:55], s85 offen offset:1024 nt
    s_waitcnt vmcnt(6)
    buffer_load_dwordx4 v[188:191], v77, s[52:55], s85 offen offset:1024 nt
    s_add_u32 s87, s87, 7
    s_add_u32 s39, s87, s88
    s_bfe_u32 s37, s39, 0x30000
    s_lshl_b32 s37, s37, 12
    s_add_u32 s85, s37, s89
    s_bfe_u32 s37, s39, 0x10003
    s_lshl_b32 s37, s37, 11
    s_add_u32 s85, s37, s85
    s_bfe_u32 s37, s39, 0x40004
    s_lshl_b32 s37, s37, 16
    s_add_u32 s85, s37, s85
    s_waitcnt vmcnt(6)
    buffer_load_dwordx4 v[192:195], v76, s[52:55], s85 offen offset:0 nt
    s_waitcnt vmcnt(6)
    buffer_load_dwordx4 v[196:199], v77, s[52:55], s85 offen offset:0 nt
    s_waitcnt vmcnt(6)
    buffer_load_dwordx4 v[200:203], v76, s[52:55], s85 offen offset:1024 nt
    s_waitcnt vmcnt(6)
    buffer_load_dwordx4 v[204:207], v77, s[52:55], s85 offen offset:1024 nt
    s_add_u32 s87, s87, 7
    s_add_u32 s39, s87, s88
    s_bfe_u32 s37, s39, 0x30000
    s_lshl_b32 s37, s37, 12
    s_add_u32 s85, s37, s89
    s_bfe_u32 s37, s39, 0x10003
    s_lshl_b32 s37, s37, 11
    s_add_u32 s85, s37, s85
    s_bfe_u32 s37, s39, 0x40004
    s_lshl_b32 s37, s37, 16
    s_add_u32 s85, s37, s85
    s_waitcnt vmcnt(6)
    buffer_load_dwordx4 v[208:211], v76, s[52:55], s85 offen offset:0 nt
    s_waitcnt vmcnt(6)
    buffer_load_dwordx4 v[212:215], v77, s[52:55], s85 offen offset:0 nt
    s_waitcnt vmcnt(6)
    buffer_load_dwordx4 v[216:219], v76, s[52:55], s85 offen offset:1024 nt
    s_waitcnt vmcnt(6)
    buffer_load_dwordx4 v[220:223], v77, s[52:55], s85 offen offset:1024 nt
    s_add_u32 s87, s87, 7
    s_add_u32 s39, s87, s88
    s_bfe_u32 s37, s39, 0x30000
    s_lshl_b32 s37, s37, 12
    s_add_u32 s85, s37, s89
    s_bfe_u32 s37, s39, 0x10003
    s_lshl_b32 s37, s37, 11
    s_add_u32 s85, s37, s85
    s_bfe_u32 s37, s39, 0x40004
    s_lshl_b32 s37, s37, 16
    s_add_u32 s85, s37, s85
    s_waitcnt vmcnt(6)
    buffer_load_dwordx4 v[224:227], v76, s[52:55], s85 offen offset:0 nt
    s_waitcnt vmcnt(6)
    buffer_load_dwordx4 v[228:231], v77, s[52:55], s85 offen offset:0 nt
    s_waitcnt vmcnt(6)
    buffer_load_dwordx4 v[232:235], v76, s[52:55], s85 offen offset:1024 nt
    s_waitcnt vmcnt(6)
    buffer_load_dwordx4 v[236:239], v77, s[52:55], s85 offen offset:1024 nt
    s_add_u32 s87, s87, 7
    s_add_u32 s39, s87, s88
    s_bfe_u32 s37, s39, 0x30000
    s_lshl_b32 s37, s37, 12
    s_add_u32 s85, s37, s89
    s_bfe_u32 s37, s39, 0x10003
    s_lshl_b32 s37, s37, 11
    s_add_u32 s85, s37, s85
    s_bfe_u32 s37, s39, 0x40004
    s_lshl_b32 s37, s37, 16
    s_add_u32 s85, s37, s85
    s_waitcnt vmcnt(6)
    buffer_load_dwordx4 v[240:243], v76, s[52:55], s85 offen offset:0 nt
    s_waitcnt vmcnt(6)
    buffer_load_dwordx4 v[244:247], v77, s[52:55], s85 offen offset:0 nt
    s_waitcnt vmcnt(6)
    buffer_load_dwordx4 v[248:251], v76, s[52:55], s85 offen offset:1024 nt
    s_waitcnt vmcnt(6)
    buffer_load_dwordx4 v[252:255], v77, s[52:55], s85 offen offset:1024 nt
    s_add_u32 s87, s87, 7
    s_add_u32 s39, s87, s88
    s_bfe_u32 s37, s39, 0x30000
    s_lshl_b32 s37, s37, 12
    s_add_u32 s85, s37, s89
    s_bfe_u32 s37, s39, 0x10003
    s_lshl_b32 s37, s37, 11
    s_add_u32 s85, s37, s85
    s_bfe_u32 s37, s39, 0x40004
    s_lshl_b32 s37, s37, 16
    s_add_u32 s85, s37, s85
    s_waitcnt vmcnt(6)
    buffer_load_dwordx4 a[0:3], v76, s[52:55], s85 offen offset:0 nt
    s_waitcnt vmcnt(6)
    buffer_load_dwordx4 a[4:7], v77, s[52:55], s85 offen offset:0 nt
    buffer_load_dwordx4 v[68:71], v78, s[48:51], s91 offen offset:0 sc1
    buffer_load_dwordx4 v[72:75], v78, s[48:51], s91 offen offset:16 sc1
    s_waitcnt vmcnt(8)
    buffer_load_dwordx4 a[8:11], v76, s[52:55], s85 offen offset:1024 nt
    s_waitcnt vmcnt(8)
    buffer_load_dwordx4 a[12:15], v77, s[52:55], s85 offen offset:1024 nt
    s_add_u32 s87, s87, 7
    s_add_u32 s39, s87, s88
    s_bfe_u32 s37, s39, 0x30000
    s_lshl_b32 s37, s37, 12
    s_add_u32 s85, s37, s89
    s_bfe_u32 s37, s39, 0x10003
    s_lshl_b32 s37, s37, 11
    s_add_u32 s85, s37, s85
    s_bfe_u32 s37, s39, 0x40004
    s_lshl_b32 s37, s37, 16
    s_add_u32 s85, s37, s85
    s_waitcnt vmcnt(8)
    buffer_load_dwordx4 a[16:19], v76, s[52:55], s85 offen offset:0 nt
    s_waitcnt vmcnt(8)
    buffer_load_dwordx4 a[20:23], v77, s[52:55], s85 offen offset:0 nt
    s_waitcnt vmcnt(8)
    buffer_load_dwordx4 a[24:27], v76, s[52:55], s85 offen offset:1024 nt
    s_waitcnt vmcnt(8)
    buffer_load_dwordx4 a[28:31], v77, s[52:55], s85 offen offset:1024 nt
    s_add_u32 s87, s87, 7
    s_add_u32 s39, s87, s88
    s_bfe_u32 s37, s39, 0x30000
    s_lshl_b32 s37, s37, 12
    s_add_u32 s85, s37, s89
    s_bfe_u32 s37, s39, 0x10003
    s_lshl_b32 s37, s37, 11
    s_add_u32 s85, s37, s85
    s_bfe_u32 s37, s39, 0x40004
    s_lshl_b32 s37, s37, 16
    s_add_u32 s85, s37, s85
    s_waitcnt vmcnt(6)
L_qcheck_10:
    v_xor_b32 v68, s35, v68
    v_xor_b32 v69, s35, v69
    v_xor_b32 v70, s35, v70
    v_xor_b32 v71, s35, v71
    v_xor_b32 v72, s35, v72
    v_xor_b32 v73, s35, v73
    v_xor_b32 v74, s35, v74
    v_xor_b32 v75, s35, v75
    v_or_b32 v4, v68, v69
    v_or3_b32 v4, v4, v70, v71
    v_or3_b32 v4, v4, v72, v73
    v_or3_b32 v4, v4, v74, v75
    v_and_b32 v4, 0xff, v4
    v_cmp_ne_u32 vcc, 0, v4
    s_cbranch_vccz L_qok_11
    buffer_load_dwordx4 v[68:71], v78, s[48:51], s91 offen offset:0 sc1
    buffer_load_dwordx4 v[72:75], v78, s[48:51], s91 offen offset:16 sc1
    s_waitcnt vmcnt(0)
    s_sub_u32 s84, s84, 1
    s_cmp_lg_u32 s84, 0
    s_cbranch_scc1 L_qcheck_10
    s_branch L_end
L_qok_11:
    v_cvt_pk_bf16_f32 v68, v68, v69
    v_cvt_pk_bf16_f32 v69, v70, v71
    v_cvt_pk_bf16_f32 v70, v72, v73
    v_cvt_pk_bf16_f32 v71, v74, v75
    s_mov_b32 vcc_lo, 0xf000f
    s_mov_b32 vcc_hi, 0xf000f
    v_cndmask_b32 v80, 0, v68, vcc
    v_cndmask_b32 v81, 0, v69, vcc
    v_cndmask_b32 v82, 0, v70, vcc
    v_cndmask_b32 v83, 0, v71, vcc
    s_mov_b32 vcc_lo, 0xf000f0
    s_mov_b32 vcc_hi, 0xf000f0
    v_cndmask_b32 v84, 0, v68, vcc
    v_cndmask_b32 v85, 0, v69, vcc
    v_cndmask_b32 v86, 0, v70, vcc
    v_cndmask_b32 v87, 0, v71, vcc
    s_mov_b32 vcc_lo, 0xf000f00
    s_mov_b32 vcc_hi, 0xf000f00
    v_cndmask_b32 v88, 0, v68, vcc
    v_cndmask_b32 v89, 0, v69, vcc
    v_cndmask_b32 v90, 0, v70, vcc
    v_cndmask_b32 v91, 0, v71, vcc
    s_mov_b32 vcc_lo, 0xf000f000
    s_mov_b32 vcc_hi, 0xf000f000
    v_cndmask_b32 v92, 0, v68, vcc
    v_cndmask_b32 v93, 0, v69, vcc
    v_cndmask_b32 v94, 0, v70, vcc
    v_cndmask_b32 v95, 0, v71, vcc
    v_mov_b32 v65, 0xff7f0000
    s_lshl_b32 s38, s34, 14
    s_add_u32 s38, s38, 16384
    v_lshl_add_u32 v64, v1, 2, s38
    buffer_load_dwordx4 a[32:35], v76, s[52:55], s85 offen offset:0 nt
    v_mfma_f32_16x16x32_bf16 v[112:115], v[128:131], v[80:83], 0
    v_mfma_f32_16x16x32_bf16 v[112:115], v[132:135], v[84:87], v[112:115]
    v_mfma_f32_16x16x32_bf16 v[112:115], v[136:139], v[88:91], v[112:115]
    s_waitcnt vmcnt(6)
    buffer_load_dwordx4 a[36:39], v77, s[52:55], s85 offen offset:0 nt
    v_mfma_f32_16x16x32_bf16 v[112:115], v[140:143], v[92:95], v[112:115]
    v_mfma_f32_16x16x32_bf16 v[96:99], v[144:147], v[80:83], 0
    v_mfma_f32_16x16x32_bf16 v[96:99], v[148:151], v[84:87], v[96:99]
    s_waitcnt vmcnt(6)
    buffer_load_dwordx4 a[40:43], v76, s[52:55], s85 offen offset:1024 nt
    v_mfma_f32_16x16x32_bf16 v[96:99], v[152:155], v[88:91], v[96:99]
    s_nop 2
    v_mov_b32_dpp v122, v112 quad_perm:[0,0,0,0] row_mask:0xf bank_mask:0xf
    v_mov_b32_dpp v124, v114 quad_perm:[2,2,2,2] row_mask:0xf bank_mask:0xf
    s_nop 0
    v_add_f32_dpp v122, v113, v122 quad_perm:[1,1,1,1] row_mask:0xf bank_mask:0xf
    v_add_f32_dpp v124, v115, v124 quad_perm:[3,3,3,3] row_mask:0xf bank_mask:0xf
    v_add_f32 v122, v122, v124
    v_max_f32 v65, v65, v122
    ds_write_b32 v64, v122 offset:0
    v_mfma_f32_16x16x32_bf16 v[96:99], v[156:159], v[92:95], v[96:99]
    v_mfma_f32_16x16x32_bf16 v[112:115], v[160:163], v[80:83], 0
    v_mfma_f32_16x16x32_bf16 v[112:115], v[164:167], v[84:87], v[112:115]
    s_waitcnt vmcnt(6)
    buffer_load_dwordx4 a[44:47], v77, s[52:55], s85 offen offset:1024 nt
    s_add_u32 s87, s87, 7
    s_add_u32 s39, s87, s88
    s_bfe_u32 s37, s39, 0x30000
    s_lshl_b32 s37, s37, 12
    s_add_u32 s85, s37, s89
    s_bfe_u32 s37, s39, 0x10003
    s_lshl_b32 s37, s37, 11
    s_add_u32 s85, s37, s85
    s_bfe_u32 s37, s39, 0x40004
    s_lshl_b32 s37, s37, 16
    s_add_u32 s85, s37, s85
    v_mfma_f32_16x16x32_bf16 v[112:115], v[168:171], v[88:91], v[112:115]
    v_mov_b32_dpp v122, v96 quad_perm:[0,0,0,0] row_mask:0xf bank_mask:0xf
    v_mov_b32_dpp v124, v98 quad_perm:[2,2,2,2] row_mask:0xf bank_mask:0xf
    s_nop 0
    v_add_f32_dpp v122, v97, v122 quad_perm:[1,1,1,1] row_mask:0xf bank_mask:0xf
    v_add_f32_dpp v124, v99, v124 quad_perm:[3,3,3,3] row_mask:0xf bank_mask:0xf
    v_add_f32 v122, v122, v124
    v_max_f32 v65, v65, v122
    ds_write_b32 v64, v122 offset:256
    v_mfma_f32_16x16x32_bf16 v[112:115], v[172:175], v[92:95], v[112:115]
    v_mfma_f32_16x16x32_bf16 v[96:99], v[176:179], v[80:83], 0
    s_waitcnt vmcnt(6)
    buffer_load_dwordx4 a[48:51], v76, s[52:55], s85 offen offset:0 nt
    v_mfma_f32_16x16x32_bf16 v[96:99], v[180:183], v[84:87], v[96:99]
    v_mfma_f32_16x16x32_bf16 v[96:99], v[184:187], v[88:91], v[96:99]
    s_nop 2
    v_mov_b32_dpp v122, v112 quad_perm:[0,0,0,0] row_mask:0xf bank_mask:0xf
    v_mov_b32_dpp v124, v114 quad_perm:[2,2,2,2] row_mask:0xf bank_mask:0xf
    s_nop 0
    v_add_f32_dpp v122, v113, v122 quad_perm:[1,1,1,1] row_mask:0xf bank_mask:0xf
    v_add_f32_dpp v124, v115, v124 quad_perm:[3,3,3,3] row_mask:0xf bank_mask:0xf
    v_add_f32 v122, v122, v124
    v_max_f32 v65, v65, v122
    ds_write_b32 v64, v122 offset:512
    v_mfma_f32_16x16x32_bf16 v[96:99], v[188:191], v[92:95], v[96:99]
    v_mfma_f32_16x16x32_bf16 v[112:115], v[192:195], v[80:83], 0
    s_waitcnt vmcnt(6)
    buffer_load_dwordx4 a[52:55], v77, s[52:55], s85 offen offset:0 nt
    v_mfma_f32_16x16x32_bf16 v[112:115], v[196:199], v[84:87], v[112:115]
    v_mfma_f32_16x16x32_bf16 v[112:115], v[200:203], v[88:91], v[112:115]
    s_nop 2
    v_mov_b32_dpp v122, v96 quad_perm:[0,0,0,0] row_mask:0xf bank_mask:0xf
    v_mov_b32_dpp v124, v98 quad_perm:[2,2,2,2] row_mask:0xf bank_mask:0xf
    s_nop 0
    v_add_f32_dpp v122, v97, v122 quad_perm:[1,1,1,1] row_mask:0xf bank_mask:0xf
    v_add_f32_dpp v124, v99, v124 quad_perm:[3,3,3,3] row_mask:0xf bank_mask:0xf
    v_add_f32 v122, v122, v124
    v_max_f32 v65, v65, v122
    ds_write_b32 v64, v122 offset:768
    v_mfma_f32_16x16x32_bf16 v[112:115], v[204:207], v[92:95], v[112:115]
    s_waitcnt vmcnt(6)
    buffer_load_dwordx4 a[56:59], v76, s[52:55], s85 offen offset:1024 nt
    v_mfma_f32_16x16x32_bf16 v[96:99], v[208:211], v[80:83], 0
    v_mfma_f32_16x16x32_bf16 v[96:99], v[212:215], v[84:87], v[96:99]
    v_mfma_f32_16x16x32_bf16 v[96:99], v[216:219], v[88:91], v[96:99]
    s_nop 2
    v_mov_b32_dpp v122, v112 quad_perm:[0,0,0,0] row_mask:0xf bank_mask:0xf
    v_mov_b32_dpp v124, v114 quad_perm:[2,2,2,2] row_mask:0xf bank_mask:0xf
    s_nop 0
    v_add_f32_dpp v122, v113, v122 quad_perm:[1,1,1,1] row_mask:0xf bank_mask:0xf
    v_add_f32_dpp v124, v115, v124 quad_perm:[3,3,3,3] row_mask:0xf bank_mask:0xf
    v_add_f32 v122, v122, v124
    v_max_f32 v65, v65, v122
    ds_write_b32 v64, v122 offset:1024
    v_mfma_f32_16x16x32_bf16 v[96:99], v[220:223], v[92:95], v[96:99]
    s_waitcnt vmcnt(6)
    buffer_load_dwordx4 a[60:63], v77, s[52:55], s85 offen offset:1024 nt
    s_add_u32 s87, s87, 7
    s_add_u32 s39, s87, s88
    s_bfe_u32 s37, s39, 0x30000
    s_lshl_b32 s37, s37, 12
    s_add_u32 s85, s37, s89
    s_bfe_u32 s37, s39, 0x10003
    s_lshl_b32 s37, s37, 11
    s_add_u32 s85, s37, s85
    s_bfe_u32 s37, s39, 0x40004
    s_lshl_b32 s37, s37, 16
    s_add_u32 s85, s37, s85
    v_mfma_f32_16x16x32_bf16 v[112:115], v[224:227], v[80:83], 0
    v_mfma_f32_16x16x32_bf16 v[112:115], v[228:231], v[84:87], v[112:115]
    v_mfma_f32_16x16x32_bf16 v[112:115], v[232:235], v[88:91], v[112:115]
    v_mov_b32_dpp v122, v96 quad_perm:[0,0,0,0] row_mask:0xf bank_mask:0xf
    v_mov_b32_dpp v124, v98 quad_perm:[2,2,2,2] row_mask:0xf bank_mask:0xf
    s_nop 0
    v_add_f32_dpp v122, v97, v122 quad_perm:[1,1,1,1] row_mask:0xf bank_mask:0xf
    v_add_f32_dpp v124, v99, v124 quad_perm:[3,3,3,3] row_mask:0xf bank_mask:0xf
    v_add_f32 v122, v122, v124
    v_max_f32 v65, v65, v122
    ds_write_b32 v64, v122 offset:1280
    s_waitcnt vmcnt(5)
    buffer_load_dwordx4 v[128:131], v76, s[52:55], s85 offen offset:0 nt
    v_mfma_f32_16x16x32_bf16 v[112:115], v[236:239], v[92:95], v[112:115]
    v_mfma_f32_16x16x32_bf16 v[96:99], v[240:243], v[80:83], 0
    v_mfma_f32_16x16x32_bf16 v[96:99], v[244:247], v[84:87], v[96:99]
    s_waitcnt vmcnt(5)
    buffer_load_dwordx4 v[132:135], v77, s[52:55], s85 offen offset:0 nt
    v_mfma_f32_16x16x32_bf16 v[96:99], v[248:251], v[88:91], v[96:99]
    s_nop 2
    v_mov_b32_dpp v122, v112 quad_perm:[0,0,0,0] row_mask:0xf bank_mask:0xf
    v_mov_b32_dpp v124, v114 quad_perm:[2,2,2,2] row_mask:0xf bank_mask:0xf
    s_nop 0
    v_add_f32_dpp v122, v113, v122 quad_perm:[1,1,1,1] row_mask:0xf bank_mask:0xf
    v_add_f32_dpp v124, v115, v124 quad_perm:[3,3,3,3] row_mask:0xf bank_mask:0xf
    v_add_f32 v122, v122, v124
    v_max_f32 v65, v65, v122
    ds_write_b32 v64, v122 offset:1536
    v_mfma_f32_16x16x32_bf16 v[96:99], v[252:255], v[92:95], v[96:99]
    v_mfma_f32_16x16x32_bf16 v[112:115], a[0:3], v[80:83], 0
    v_mfma_f32_16x16x32_bf16 v[112:115], a[4:7], v[84:87], v[112:115]
    s_waitcnt vmcnt(5)
    buffer_load_dwordx4 v[136:139], v76, s[52:55], s85 offen offset:1024 nt
    v_mfma_f32_16x16x32_bf16 v[112:115], a[8:11], v[88:91], v[112:115]
    s_nop 2
    v_mov_b32_dpp v122, v96 quad_perm:[0,0,0,0] row_mask:0xf bank_mask:0xf
    v_mov_b32_dpp v124, v98 quad_perm:[2,2,2,2] row_mask:0xf bank_mask:0xf
    s_nop 0
    v_add_f32_dpp v122, v97, v122 quad_perm:[1,1,1,1] row_mask:0xf bank_mask:0xf
    v_add_f32_dpp v124, v99, v124 quad_perm:[3,3,3,3] row_mask:0xf bank_mask:0xf
    v_add_f32 v122, v122, v124
    v_max_f32 v65, v65, v122
    ds_write_b32 v64, v122 offset:1792
    v_mfma_f32_16x16x32_bf16 v[112:115], a[12:15], v[92:95], v[112:115]
    v_mfma_f32_16x16x32_bf16 v[96:99], a[16:19], v[80:83], 0
    s_waitcnt vmcnt(5)
    buffer_load_dwordx4 v[140:143], v77, s[52:55], s85 offen offset:1024 nt
    s_add_u32 s87, s87, 7
    s_add_u32 s39, s87, s88
    s_bfe_u32 s37, s39, 0x30000
    s_lshl_b32 s37, s37, 12
    s_add_u32 s85, s37, s89
    s_bfe_u32 s37, s39, 0x10003
    s_lshl_b32 s37, s37, 11
    s_add_u32 s85, s37, s85
    s_bfe_u32 s37, s39, 0x40004
    s_lshl_b32 s37, s37, 16
    s_add_u32 s85, s37, s85
    v_mfma_f32_16x16x32_bf16 v[96:99], a[20:23], v[84:87], v[96:99]
    v_mfma_f32_16x16x32_bf16 v[96:99], a[24:27], v[88:91], v[96:99]
    v_mov_b32_dpp v122, v112 quad_perm:[0,0,0,0] row_mask:0xf bank_mask:0xf
    v_mov_b32_dpp v124, v114 quad_perm:[2,2,2,2] row_mask:0xf bank_mask:0xf
    s_nop 0
    v_add_f32_dpp v122, v113, v122 quad_perm:[1,1,1,1] row_mask:0xf bank_mask:0xf
    v_add_f32_dpp v124, v115, v124 quad_perm:[3,3,3,3] row_mask:0xf bank_mask:0xf
    v_add_f32 v122, v122, v124
    v_max_f32 v65, v65, v122
    ds_write_b32 v64, v122 offset:2048
    v_mfma_f32_16x16x32_bf16 v[96:99], a[28:31], v[92:95], v[96:99]
    v_mfma_f32_16x16x32_bf16 v[112:115], a[32:35], v[80:83], 0
    s_waitcnt vmcnt(5)
    buffer_load_dwordx4 v[144:147], v76, s[52:55], s85 offen offset:0 nt
    v_mfma_f32_16x16x32_bf16 v[112:115], a[36:39], v[84:87], v[112:115]
    v_mfma_f32_16x16x32_bf16 v[112:115], a[40:43], v[88:91], v[112:115]
    s_nop 2
    v_mov_b32_dpp v122, v96 quad_perm:[0,0,0,0] row_mask:0xf bank_mask:0xf
    v_mov_b32_dpp v124, v98 quad_perm:[2,2,2,2] row_mask:0xf bank_mask:0xf
    s_nop 0
    v_add_f32_dpp v122, v97, v122 quad_perm:[1,1,1,1] row_mask:0xf bank_mask:0xf
    v_add_f32_dpp v124, v99, v124 quad_perm:[3,3,3,3] row_mask:0xf bank_mask:0xf
    v_add_f32 v122, v122, v124
    v_max_f32 v65, v65, v122
    ds_write_b32 v64, v122 offset:2304
    v_mfma_f32_16x16x32_bf16 v[112:115], a[44:47], v[92:95], v[112:115]
    s_waitcnt vmcnt(5)
    buffer_load_dwordx4 v[148:151], v77, s[52:55], s85 offen offset:0 nt
    v_mfma_f32_16x16x32_bf16 v[96:99], a[48:51], v[80:83], 0
    v_mfma_f32_16x16x32_bf16 v[96:99], a[52:55], v[84:87], v[96:99]
    v_mfma_f32_16x16x32_bf16 v[96:99], a[56:59], v[88:91], v[96:99]
    s_nop 2
    v_mov_b32_dpp v122, v112 quad_perm:[0,0,0,0] row_mask:0xf bank_mask:0xf
    v_mov_b32_dpp v124, v114 quad_perm:[2,2,2,2] row_mask:0xf bank_mask:0xf
    s_nop 0
    v_add_f32_dpp v122, v113, v122 quad_perm:[1,1,1,1] row_mask:0xf bank_mask:0xf
    v_add_f32_dpp v124, v115, v124 quad_perm:[3,3,3,3] row_mask:0xf bank_mask:0xf
    v_add_f32 v122, v122, v124
    v_max_f32 v65, v65, v122
    ds_write_b32 v64, v122 offset:2560
    v_mfma_f32_16x16x32_bf16 v[96:99], a[60:63], v[92:95], v[96:99]
    v_add_u32 v64, 2816, v64
    s_mov_b32 s97, 10
    s_mov_b32 s86, 32
    s_add_u32 s92, s33, 224
    s_mov_b32 s66, 134217728
    s_mov_b32 s67, 0x20000
    s_mov_b64 s[64:65], s[52:53]
    v_mov_b32 v62, v76
    v_mov_b32 v63, v77
    s_branch L_bloop
L_ql:
    v_lshrrev_b32 v4, 2, v3
    v_and_b32 v5, 3, v3
    v_lshlrev_b32 v19, 6, v2
    v_lshl_add_u32 v19, v5, 4, v19
    v_lshl_add_u32 v14, v4, 18, v19
    s_lshl_b32 s63, s34, 20
    s_lshl_b32 s38, s32, 8
    s_add_u32 s63, s63, s38
    s_mov_b32 s74, 4194304
    s_mov_b32 s75, 0x20000
    s_waitcnt lgkmcnt(0)
    s_mov_b64 s[72:73], s[10:11]
    buffer_load_dwordx4 a[128:131], v14, s[72:75], s63 offen nt
    s_add_u32 s63, s63, 8192
    buffer_load_dwordx4 a[132:135], v14, s[72:75], s63 offen nt
    s_add_u32 s63, s63, 8192
    buffer_load_dwordx4 a[136:139], v14, s[72:75], s63 offen nt
    s_add_u32 s63, s63, 8192
    buffer_load_dwordx4 a[140:143], v14, s[72:75], s63 offen nt
    s_add_u32 s63, s63, 8192
    buffer_load_dwordx4 a[144:147], v14, s[72:75], s63 offen nt
    s_add_u32 s63, s63, 8192
    buffer_load_dwordx4 a[148:151], v14, s[72:75], s63 offen nt
    s_add_u32 s63, s63, 8192
    buffer_load_dwordx4 a[152:155], v14, s[72:75], s63 offen nt
    s_add_u32 s63, s63, 8192
    buffer_load_dwordx4 a[156:159], v14, s[72:75], s63 offen nt
    s_add_u32 s63, s63, 8192
    v_lshlrev_b32 v15, 1, v19
    v_lshl_add_u32 v15, v4, 9, v15
    v_lshl_add_u32 v19, v4, 15, v19
    s_load_dword s35, s[30:31], 0
    s_mov_b32 s48, s30
    s_and_b32 s49, s31, 0xffff
    s_mov_b32 s50, 8388608
    s_mov_b32 s51, 0x20000
    s_mov_b32 s82, 0xffffff00
    s_mov_b32 s83, 0x3e0293ee
    s_mov_b32 s84, 2097152
    s_lshl_b32 s38, s32, 12
    s_add_u32 s95, s38, 264192
    s_lshl_b32 s38, s32, 10
    s_add_u32 s94, s38, 393216
    s_lshl_b32 s38, s34, 8
    s_add_u32 s94, s38, s94
    s_waitcnt vmcnt(7)
    buffer_load_dwordx4 a[160:163], v14, s[72:75], s63 offen nt
    s_add_u32 s63, s63, 8192
    s_waitcnt vmcnt(7)
    buffer_load_dwordx4 a[164:167], v14, s[72:75], s63 offen nt
    s_add_u32 s63, s63, 8192
    s_waitcnt vmcnt(7)
    buffer_load_dwordx4 a[168:171], v14, s[72:75], s63 offen nt
    s_add_u32 s63, s63, 8192
    s_waitcnt vmcnt(7)
    buffer_load_dwordx4 a[172:175], v14, s[72:75], s63 offen nt
    s_add_u32 s63, s63, 8192
    s_waitcnt vmcnt(7)
    buffer_load_dwordx4 a[176:179], v14, s[72:75], s63 offen nt
    s_add_u32 s63, s63, 8192
    v_and_b32 v4, 1, v1
    v_lshlrev_b32 v4, 4, v4
    v_mov_b32 v5, 0xffff
    v_lshlrev_b32 v4, v4, v5
    v_bfe_u32 v5, v1, 1, 2
    v_cmp_eq_u32 vcc, 0, v5
    s_nop 1
    v_cndmask_b32 v10, 0, v4, vcc
    v_cmp_eq_u32 vcc, 1, v5
    s_nop 1
    v_cndmask_b32 v11, 0, v4, vcc
    v_cmp_eq_u32 vcc, 2, v5
    s_nop 1
    v_cndmask_b32 v12, 0, v4, vcc
    v_cmp_eq_u32 vcc, 3, v5
    s_nop 1
    v_cndmask_b32 v13, 0, v4, vcc
    s_waitcnt vmcnt(7)
    buffer_load_dwordx4 a[180:183], v14, s[72:75], s63 offen nt
    s_add_u32 s63, s63, 8192
    s_waitcnt vmcnt(7)
    buffer_load_dwordx4 a[184:187], v14, s[72:75], s63 offen nt
    s_add_u32 s63, s63, 8192
    s_waitcnt vmcnt(7)
    buffer_load_dwordx4 a[188:191], v14, s[72:75], s63 offen nt
    s_add_u32 s63, s63, 8192
    s_waitcnt vmcnt(7)
    buffer_load_dwordx4 a[192:195], v14, s[72:75], s63 offen nt
    s_add_u32 s63, s63, 8192
    v_lshrrev_b32 v4, 2, v3
    v_and_b32 v5, 3, v3
    v_lshlrev_b32 v76, 8, v4
    v_lshlrev_b32 v126, 8, v2
    v_lshl_add_u32 v76, v2, 6, v76
    v_lshl_add_u32 v76, v5, 4, v76
    v_lshl_add_u32 v126, v3, 4, v126
    v_xor_b32 v77, 32768, v76
    v_xor_b32 v127, 32768, v126
    s_add_u32 s3, s34, s33
    s_and_b32 s3, s3, 3
    s_lshl_b32 s89, s3, 5
    s_add_u32 s89, s89, s32
    s_lshl_b32 s89, s89, 20
    s_mul_i32 s88, s32, 8
    s_add_u32 s88, s88, s3
    s_add_u32 s87, s33, 0
    s_waitcnt vmcnt(7)
    buffer_load_dwordx4 a[196:199], v14, s[72:75], s63 offen nt
    s_add_u32 s63, s63, 8192
    s_waitcnt vmcnt(7)
    buffer_load_dwordx4 a[200:203], v14, s[72:75], s63 offen nt
    s_add_u32 s63, s63, 8192
    s_waitcnt vmcnt(7)
    buffer_load_dwordx4 a[204:207], v14, s[72:75], s63 offen nt
    s_add_u32 s63, s63, 8192
    s_waitcnt vmcnt(7)
    buffer_load_dwordx4 a[208:211], v14, s[72:75], s63 offen nt
    s_add_u32 s63, s63, 8192
    s_mov_b32 s52, s18
    s_and_b32 s53, s19, 0xffff
    s_mov_b32 s54, 134217728
    s_mov_b32 s55, 0x20000
    s_mov_b32 s56, s20
    s_and_b32 s57, s21, 0xffff
    s_mov_b32 s58, 134217728
    s_mov_b32 s59, 0x20000
    s_waitcnt vmcnt(7)
    buffer_load_dwordx4 a[212:215], v14, s[72:75], s63 offen nt
    s_add_u32 s63, s63, 8192
    s_waitcnt vmcnt(7)
    buffer_load_dwordx4 a[216:219], v14, s[72:75], s63 offen nt
    s_add_u32 s63, s63, 8192
    s_waitcnt vmcnt(7)
    buffer_load_dwordx4 a[220:223], v14, s[72:75], s63 offen nt
    s_add_u32 s63, s63, 8192
    s_waitcnt vmcnt(7)
    buffer_load_dwordx4 a[224:227], v14, s[72:75], s63 offen nt
    s_add_u32 s63, s63, 8192
    v_mov_b32 v120, 0xff7f0000
    v_mov_b32 v121, 0
    v_mov_b32 v18, 1
    v_mov_b32 v116, 0
    v_mov_b32 v117, 0
    v_mov_b32 v118, 0
    v_mov_b32 v119, 0
    s_lshl_b32 s38, s32, 10
    s_add_u32 s96, s38, 65536
    s_lshl_b32 s38, s3, 8
    s_add_u32 s96, s38, s96
    v_mov_b32 v9, s96
    s_lshl_b32 s38, s32, 15
    s_add_u32 s96, s38, 1048576
    s_lshl_b32 s38, s3, 13
    s_add_u32 s96, s38, s96
    s_lshl_b32 s38, s33, 10
    s_add_u32 s96, s38, s96
    v_and_b32 v5, 3, v3
    v_lshlrev_b32 v78, 7, v2
    v_lshl_add_u32 v78, v5, 5, v78
    s_lshl_b32 s38, s32, 12
    s_add_u32 s91, s38, 262144
    s_lshl_b32 s38, s3, 9
    s_add_u32 s91, s38, s91
    v_lshlrev_b32 v4, 7, v2
    v_lshl_add_u32 v4, v3, 4, v4
    v_mov_b32 v5, 512
    v_cmp_gt_u32 vcc, 8, v3
    s_nop 1
    v_cndmask_b32 v79, v5, v4, vcc
    s_waitcnt vmcnt(7)
    buffer_load_dwordx4 a[228:231], v14, s[72:75], s63 offen nt
    s_add_u32 s63, s63, 8192
    s_waitcnt vmcnt(7)
    buffer_load_dwordx4 a[232:235], v14, s[72:75], s63 offen nt
    s_add_u32 s63, s63, 8192
    s_waitcnt vmcnt(7)
    buffer_load_dwordx4 a[236:239], v14, s[72:75], s63 offen nt
    s_add_u32 s63, s63, 8192
    s_waitcnt vmcnt(7)
    buffer_load_dwordx4 a[240:243], v14, s[72:75], s63 offen nt
    s_add_u32 s63, s63, 8192
    s_waitcnt vmcnt(7)
    buffer_load_dwordx4 a[244:247], v14, s[72:75], s63 offen nt
    s_add_u32 s63, s63, 8192
    s_waitcnt vmcnt(7)
    buffer_load_dwordx4 a[248:251], v14, s[72:75], s63 offen nt
    s_add_u32 s63, s63, 8192
    s_waitcnt vmcnt(7)
    buffer_load_dwordx4 a[252:255], v14, s[72:75], s63 offen nt
    s_add_u32 s63, s63, 8192
    s_waitcnt lgkmcnt(0)
    s_add_u32 s35, s35, 0x5b
    s_and_b32 s35, s35, 0xff
    v_mov_b32 v8, s35
    s_or_b32 s68, s35, 0x6b3ac500
    s_waitcnt vmcnt(6)
    s_add_u32 s39, s87, s88
    s_bfe_u32 s37, s39, 0x30000
    s_lshl_b32 s37, s37, 12
    s_add_u32 s85, s37, s89
    s_bfe_u32 s37, s39, 0x10003
    s_lshl_b32 s37, s37, 11
    s_add_u32 s85, s37, s85
    s_bfe_u32 s37, s39, 0x40004
    s_lshl_b32 s37, s37, 16
    s_add_u32 s85, s37, s85
    buffer_load_dwordx4 v[128:131], v76, s[52:55], s85 offen offset:0 nt
    s_waitcnt vmcnt(6)
    buffer_load_dwordx4 v[132:135], v77, s[52:55], s85 offen offset:0 nt
    s_waitcnt vmcnt(6)
    buffer_load_dwordx4 v[136:139], v76, s[52:55], s85 offen offset:1024 nt
    s_waitcnt vmcnt(6)
    buffer_load_dwordx4 v[140:143], v77, s[52:55], s85 offen offset:1024 nt
    s_add_u32 s87, s87, 7
    s_add_u32 s39, s87, s88
    s_bfe_u32 s37, s39, 0x30000
    s_lshl_b32 s37, s37, 12
    s_add_u32 s85, s37, s89
    s_bfe_u32 s37, s39, 0x10003
    s_lshl_b32 s37, s37, 11
    s_add_u32 s85, s37, s85
    s_bfe_u32 s37, s39, 0x40004
    s_lshl_b32 s37, s37, 16
    s_add_u32 s85, s37, s85
    s_waitcnt vmcnt(6)
    buffer_load_dwordx4 v[144:147], v76, s[52:55], s85 offen offset:0 nt
    s_waitcnt vmcnt(6)
    buffer_load_dwordx4 v[148:151], v77, s[52:55], s85 offen offset:0 nt
    s_waitcnt vmcnt(6)
    buffer_load_dwordx4 v[152:155], v76, s[52:55], s85 offen offset:1024 nt
    s_waitcnt vmcnt(6)
    buffer_load_dwordx4 v[156:159], v77, s[52:55], s85 offen offset:1024 nt
    s_add_u32 s87, s87, 7
    s_add_u32 s39, s87, s88
    s_bfe_u32 s37, s39, 0x30000
    s_lshl_b32 s37, s37, 12
    s_add_u32 s85, s37, s89
    s_bfe_u32 s37, s39, 0x10003
    s_lshl_b32 s37, s37, 11
    s_add_u32 s85, s37, s85
    s_bfe_u32 s37, s39, 0x40004
    s_lshl_b32 s37, s37, 16
    s_add_u32 s85, s37, s85
    s_waitcnt vmcnt(6)
    buffer_load_dwordx4 v[160:163], v76, s[52:55], s85 offen offset:0 nt
    s_waitcnt vmcnt(6)
    buffer_load_dwordx4 v[164:167], v77, s[52:55], s85 offen offset:0 nt
    s_waitcnt vmcnt(6)
    buffer_load_dwordx4 v[168:171], v76, s[52:55], s85 offen offset:1024 nt
    s_waitcnt vmcnt(6)
    buffer_load_dwordx4 v[172:175], v77, s[52:55], s85 offen offset:1024 nt
    s_add_u32 s87, s87, 7
    s_add_u32 s39, s87, s88
    s_bfe_u32 s37, s39, 0x30000
    s_lshl_b32 s37, s37, 12
    s_add_u32 s85, s37, s89
    s_bfe_u32 s37, s39, 0x10003
    s_lshl_b32 s37, s37, 11
    s_add_u32 s85, s37, s85
    s_bfe_u32 s37, s39, 0x40004
    s_lshl_b32 s37, s37, 16
    s_add_u32 s85, s37, s85
    s_waitcnt vmcnt(6)
    buffer_load_dwordx4 v[176:179], v76, s[52:55], s85 offen offset:0 nt
    s_waitcnt vmcnt(6)
    buffer_load_dwordx4 v[180:183], v77, s[52:55], s85 offen offset:0 nt
    s_waitcnt vmcnt(6)
    buffer_load_dwordx4 v[184:187], v76, s[52:55], s85 offen offset:1024 nt
    s_waitcnt vmcnt(6)
    buffer_load_dwordx4 v[188:191], v77, s[52:55], s85 offen offset:1024 nt
    s_add_u32 s87, s87, 7
    s_add_u32 s39, s87, s88
    s_bfe_u32 s37, s39, 0x30000
    s_lshl_b32 s37, s37, 12
    s_add_u32 s85, s37, s89
    s_bfe_u32 s37, s39, 0x10003
    s_lshl_b32 s37, s37, 11
    s_add_u32 s85, s37, s85
    s_bfe_u32 s37, s39, 0x40004
    s_lshl_b32 s37, s37, 16
    s_add_u32 s85, s37, s85
    s_waitcnt vmcnt(6)
    buffer_load_dwordx4 v[192:195], v76, s[52:55], s85 offen offset:0 nt
    s_waitcnt vmcnt(6)
    buffer_load_dwordx4 v[196:199], v77, s[52:55], s85 offen offset:0 nt
    s_waitcnt vmcnt(6)
    buffer_load_dwordx4 v[200:203], v76, s[52:55], s85 offen offset:1024 nt
    s_waitcnt vmcnt(6)
    buffer_load_dwordx4 v[204:207], v77, s[52:55], s85 offen offset:1024 nt
    s_add_u32 s87, s87, 7
    s_add_u32 s39, s87, s88
    s_bfe_u32 s37, s39, 0x30000
    s_lshl_b32 s37, s37, 12
    s_add_u32 s85, s37, s89
    s_bfe_u32 s37, s39, 0x10003
    s_lshl_b32 s37, s37, 11
    s_add_u32 s85, s37, s85
    s_bfe_u32 s37, s39, 0x40004
    s_lshl_b32 s37, s37, 16
    s_add_u32 s85, s37, s85
    s_waitcnt vmcnt(6)
    buffer_load_dwordx4 v[208:211], v76, s[52:55], s85 offen offset:0 nt
    s_waitcnt vmcnt(6)
    buffer_load_dwordx4 v[212:215], v77, s[52:55], s85 offen offset:0 nt
    s_waitcnt vmcnt(6)
    buffer_load_dwordx4 v[216:219], v76, s[52:55], s85 offen offset:1024 nt
    s_waitcnt vmcnt(6)
    buffer_load_dwordx4 v[220:223], v77, s[52:55], s85 offen offset:1024 nt
    s_add_u32 s87, s87, 7
    s_add_u32 s39, s87, s88
    s_bfe_u32 s37, s39, 0x30000
    s_lshl_b32 s37, s37, 12
    s_add_u32 s85, s37, s89
    s_bfe_u32 s37, s39, 0x10003
    s_lshl_b32 s37, s37, 11
    s_add_u32 s85, s37, s85
    s_bfe_u32 s37, s39, 0x40004
    s_lshl_b32 s37, s37, 16
    s_add_u32 s85, s37, s85
    buffer_load_dwordx4 v[20:23], v15, s[48:51], s95 offen offset:0 sc1
    buffer_load_dwordx4 v[24:27], v15, s[48:51], s95 offen offset:16 sc1
    s_waitcnt vmcnt(8)
    buffer_load_dwordx4 v[224:227], v76, s[52:55], s85 offen offset:0 nt
    s_waitcnt vmcnt(8)
    buffer_load_dwordx4 v[228:231], v77, s[52:55], s85 offen offset:0 nt
    s_waitcnt vmcnt(8)
    buffer_load_dwordx4 v[232:235], v76, s[52:55], s85 offen offset:1024 nt
    s_waitcnt vmcnt(8)
    buffer_load_dwordx4 v[236:239], v77, s[52:55], s85 offen offset:1024 nt
    s_add_u32 s87, s87, 7
    s_add_u32 s39, s87, s88
    s_bfe_u32 s37, s39, 0x30000
    s_lshl_b32 s37, s37, 12
    s_add_u32 s85, s37, s89
    s_bfe_u32 s37, s39, 0x10003
    s_lshl_b32 s37, s37, 11
    s_add_u32 s85, s37, s85
    s_bfe_u32 s37, s39, 0x40004
    s_lshl_b32 s37, s37, 16
    s_add_u32 s85, s37, s85
    s_waitcnt vmcnt(8)
    buffer_load_dwordx4 v[240:243], v76, s[52:55], s85 offen offset:0 nt
    s_waitcnt vmcnt(8)
    buffer_load_dwordx4 v[244:247], v77, s[52:55], s85 offen offset:0 nt
    s_waitcnt vmcnt(6)
L_qacheck_12:
    v_xor_b32 v20, s35, v20
    v_xor_b32 v21, s35, v21
    v_xor_b32 v22, s35, v22
    v_xor_b32 v23, s35, v23
    v_xor_b32 v24, s35, v24
    v_xor_b32 v25, s35, v25
    v_xor_b32 v26, s35, v26
    v_xor_b32 v27, s35, v27
    v_or_b32 v4, v20, v21
    v_or3_b32 v4, v4, v22, v23
    v_or3_b32 v4, v4, v24, v25
    v_or3_b32 v4, v4, v26, v27
    v_and_b32 v4, 0xff, v4
    v_cmp_ne_u32 vcc, 0, v4
    s_cbranch_vccz L_qaok_13
    buffer_load_dwordx4 v[20:23], v15, s[48:51], s95 offen offset:0 sc1
    buffer_load_dwordx4 v[24:27], v15, s[48:51], s95 offen offset:16 sc1
    s_waitcnt vmcnt(0)
    s_sub_u32 s84, s84, 1
    s_cmp_lg_u32 s84, 0
    s_cbranch_scc1 L_qacheck_12
    s_branch L_end
L_qaok_13:
    buffer_load_dwordx4 v[68:71], v78, s[48:51], s91 offen offset:0 sc1
    buffer_load_dwordx4 v[72:75], v78, s[48:51], s91 offen offset:16 sc1
    v_cvt_pk_bf16_f32 v20, v20, v21
    v_cvt_pk_bf16_f32 v21, v22, v23
    v_cvt_pk_bf16_f32 v22, v24, v25
    v_cvt_pk_bf16_f32 v23, v26, v27
    s_nop 1
    v_mfma_f32_16x16x32_bf16 v[28:31], a[128:131], v[20:23], 0
    v_mfma_f32_16x16x32_bf16 v[32:35], a[132:135], v[20:23], 0
    v_mfma_f32_16x16x32_bf16 v[36:39], a[136:139], v[20:23], 0
    s_nop 5
    v_mov_b32_dpp v60, v28 quad_perm:[0,0,0,0] row_mask:0xf bank_mask:0xf
    v_mov_b32_dpp v4, v30 quad_perm:[2,2,2,2] row_mask:0xf bank_mask:0xf
    s_nop 0
    v_add_f32_dpp v60, v29, v60 quad_perm:[1,1,1,1] row_mask:0xf bank_mask:0xf
    v_add_f32_dpp v4, v31, v4 quad_perm:[3,3,3,3] row_mask:0xf bank_mask:0xf
    v_add_f32 v60, v60, v4
    v_mfma_f32_16x16x32_bf16 v[40:43], a[140:143], v[20:23], 0
    v_mov_b32_dpp v61, v32 quad_perm:[0,0,0,0] row_mask:0xf bank_mask:0xf
    v_mov_b32_dpp v4, v34 quad_perm:[2,2,2,2] row_mask:0xf bank_mask:0xf
    s_nop 0
    v_add_f32_dpp v61, v33, v61 quad_perm:[1,1,1,1] row_mask:0xf bank_mask:0xf
    v_add_f32_dpp v4, v35, v4 quad_perm:[3,3,3,3] row_mask:0xf bank_mask:0xf
    v_add_f32 v61, v61, v4
    v_cvt_pk_bf16_f32 v44, v60, v61
    v_mfma_f32_16x16x32_bf16 v[28:31], a[144:147], v[20:23], 0
    v_mov_b32_dpp v60, v36 quad_perm:[0,0,0,0] row_mask:0xf bank_mask:0xf
    v_mov_b32_dpp v4, v38 quad_perm:[2,2,2,2] row_mask:0xf bank_mask:0xf
    s_nop 0
    v_add_f32_dpp v60, v37, v60 quad_perm:[1,1,1,1] row_mask:0xf bank_mask:0xf
    v_add_f32_dpp v4, v39, v4 quad_perm:[3,3,3,3] row_mask:0xf bank_mask:0xf
    v_add_f32 v60, v60, v4
    buffer_load_dwordx4 v[248:251], v76, s[52:55], s85 offen offset:1024 nt
    v_mfma_f32_16x16x32_bf16 v[32:35], a[148:151], v[20:23], 0
    v_mov_b32_dpp v61, v40 quad_perm:[0,0,0,0] row_mask:0xf bank_mask:0xf
    v_mov_b32_dpp v4, v42 quad_perm:[2,2,2,2] row_mask:0xf bank_mask:0xf
    s_nop 0
    v_add_f32_dpp v61, v41, v61 quad_perm:[1,1,1,1] row_mask:0xf bank_mask:0xf
    v_add_f32_dpp v4, v43, v4 quad_perm:[3,3,3,3] row_mask:0xf bank_mask:0xf
    v_add_f32 v61, v61, v4
    v_cvt_pk_bf16_f32 v45, v60, v61
    v_mfma_f32_16x16x32_bf16 v[36:39], a[152:155], v[20:23], 0
    v_mov_b32_dpp v60, v28 quad_perm:[0,0,0,0] row_mask:0xf bank_mask:0xf
    v_mov_b32_dpp v4, v30 quad_perm:[2,2,2,2] row_mask:0xf bank_mask:0xf
    s_nop 0
    v_add_f32_dpp v60, v29, v60 quad_perm:[1,1,1,1] row_mask:0xf bank_mask:0xf
    v_add_f32_dpp v4, v31, v4 quad_perm:[3,3,3,3] row_mask:0xf bank_mask:0xf
    v_add_f32 v60, v60, v4
    v_mfma_f32_16x16x32_bf16 v[40:43], a[156:159], v[20:23], 0
    v_mov_b32_dpp v61, v32 quad_perm:[0,0,0,0] row_mask:0xf bank_mask:0xf
    v_mov_b32_dpp v4, v34 quad_perm:[2,2,2,2] row_mask:0xf bank_mask:0xf
    s_nop 0
    v_add_f32_dpp v61, v33, v61 quad_perm:[1,1,1,1] row_mask:0xf bank_mask:0xf
    v_add_f32_dpp v4, v35, v4 quad_perm:[3,3,3,3] row_mask:0xf bank_mask:0xf
    v_add_f32 v61, v61, v4
    v_cvt_pk_bf16_f32 v46, v60, v61
    v_mfma_f32_16x16x32_bf16 v[28:31], a[160:163], v[20:23], 0
    v_mov_b32_dpp v60, v36 quad_perm:[0,0,0,0] row_mask:0xf bank_mask:0xf
    v_mov_b32_dpp v4, v38 quad_perm:[2,2,2,2] row_mask:0xf bank_mask:0xf
    s_nop 0
    v_add_f32_dpp v60, v37, v60 quad_perm:[1,1,1,1] row_mask:0xf bank_mask:0xf
    v_add_f32_dpp v4, v39, v4 quad_perm:[3,3,3,3] row_mask:0xf bank_mask:0xf
    v_add_f32 v60, v60, v4
    v_mfma_f32_16x16x32_bf16 v[32:35], a[164:167], v[20:23], 0
    v_mov_b32_dpp v61, v40 quad_perm:[0,0,0,0] row_mask:0xf bank_mask:0xf
    v_mov_b32_dpp v4, v42 quad_perm:[2,2,2,2] row_mask:0xf bank_mask:0xf
    s_nop 0
    v_add_f32_dpp v61, v41, v61 quad_perm:[1,1,1,1] row_mask:0xf bank_mask:0xf
    v_add_f32_dpp v4, v43, v4 quad_perm:[3,3,3,3] row_mask:0xf bank_mask:0xf
    v_add_f32 v61, v61, v4
    v_cvt_pk_bf16_f32 v47, v60, v61
    v_mfma_f32_16x16x32_bf16 v[36:39], a[168:171], v[20:23], 0
    v_mov_b32_dpp v60, v28 quad_perm:[0,0,0,0] row_mask:0xf bank_mask:0xf
    v_mov_b32_dpp v4, v30 quad_perm:[2,2,2,2] row_mask:0xf bank_mask:0xf
    s_nop 0
    v_add_f32_dpp v60, v29, v60 quad_perm:[1,1,1,1] row_mask:0xf bank_mask:0xf
    v_add_f32_dpp v4, v31, v4 quad_perm:[3,3,3,3] row_mask:0xf bank_mask:0xf
    v_add_f32 v60, v60, v4
    v_mfma_f32_16x16x32_bf16 v[40:43], a[172:175], v[20:23], 0
    v_mov_b32_dpp v61, v32 quad_perm:[0,0,0,0] row_mask:0xf bank_mask:0xf
    v_mov_b32_dpp v4, v34 quad_perm:[2,2,2,2] row_mask:0xf bank_mask:0xf
    s_nop 0
    v_add_f32_dpp v61, v33, v61 quad_perm:[1,1,1,1] row_mask:0xf bank_mask:0xf
    v_add_f32_dpp v4, v35, v4 quad_perm:[3,3,3,3] row_mask:0xf bank_mask:0xf
    v_add_f32 v61, v61, v4
    v_cvt_pk_bf16_f32 v48, v60, v61
    v_mfma_f32_16x16x32_bf16 v[28:31], a[176:179], v[20:23], 0
    v_mov_b32_dpp v60, v36 quad_perm:[0,0,0,0] row_mask:0xf bank_mask:0xf
    v_mov_b32_dpp v4, v38 quad_perm:[2,2,2,2] row_mask:0xf bank_mask:0xf
    s_nop 0
    v_add_f32_dpp v60, v37, v60 quad_perm:[1,1,1,1] row_mask:0xf bank_mask:0xf
    v_add_f32_dpp v4, v39, v4 quad_perm:[3,3,3,3] row_mask:0xf bank_mask:0xf
    v_add_f32 v60, v60, v4
    buffer_load_dwordx4 v[252:255], v77, s[52:55], s85 offen offset:1024 nt
    s_add_u32 s87, s87, 7
    s_add_u32 s39, s87, s88
    s_bfe_u32 s37, s39, 0x30000
    s_lshl_b32 s37, s37, 12
    s_add_u32 s85, s37, s89
    s_bfe_u32 s37, s39, 0x10003
    s_lshl_b32 s37, s37, 11
    s_add_u32 s85, s37, s85
    s_bfe_u32 s37, s39, 0x40004
    s_lshl_b32 s37, s37, 16
    s_add_u32 s85, s37, s85
    v_mfma_f32_16x16x32_bf16 v[32:35], a[180:183], v[20:23], 0
    v_mov_b32_dpp v61, v40 quad_perm:[0,0,0,0] row_mask:0xf bank_mask:0xf
    v_mov_b32_dpp v4, v42 quad_perm:[2,2,2,2] row_mask:0xf bank_mask:0xf
    s_nop 0
    v_add_f32_dpp v61, v41, v61 quad_perm:[1,1,1,1] row_mask:0xf bank_mask:0xf
    v_add_f32_dpp v4, v43, v4 quad_perm:[3,3,3,3] row_mask:0xf bank_mask:0xf
    v_add_f32 v61, v61, v4
    v_cvt_pk_bf16_f32 v49, v60, v61
    v_mfma_f32_16x16x32_bf16 v[36:39], a[184:187], v[20:23], 0
    v_mov_b32_dpp v60, v28 quad_perm:[0,0,0,0] row_mask:0xf bank_mask:0xf
    v_mov_b32_dpp v4, v30 quad_perm:[2,2,2,2] row_mask:0xf bank_mask:0xf
    s_nop 0
    v_add_f32_dpp v60, v29, v60 quad_perm:[1,1,1,1] row_mask:0xf bank_mask:0xf
    v_add_f32_dpp v4, v31, v4 quad_perm:[3,3,3,3] row_mask:0xf bank_mask:0xf
    v_add_f32 v60, v60, v4
    v_mfma_f32_16x16x32_bf16 v[40:43], a[188:191], v[20:23], 0
    v_mov_b32_dpp v61, v32 quad_perm:[0,0,0,0] row_mask:0xf bank_mask:0xf
    v_mov_b32_dpp v4, v34 quad_perm:[2,2,2,2] row_mask:0xf bank_mask:0xf
    s_nop 0
    v_add_f32_dpp v61, v33, v61 quad_perm:[1,1,1,1] row_mask:0xf bank_mask:0xf
    v_add_f32_dpp v4, v35, v4 quad_perm:[3,3,3,3] row_mask:0xf bank_mask:0xf
    v_add_f32 v61, v61, v4
    v_cvt_pk_bf16_f32 v50, v60, v61
    v_mfma_f32_16x16x32_bf16 v[28:31], a[192:195], v[20:23], 0
    v_mov_b32_dpp v60, v36 quad_perm:[0,0,0,0] row_mask:0xf bank_mask:0xf
    v_mov_b32_dpp v4, v38 quad_perm:[2,2,2,2] row_mask:0xf bank_mask:0xf
    s_nop 0
    v_add_f32_dpp v60, v37, v60 quad_perm:[1,1,1,1] row_mask:0xf bank_mask:0xf
    v_add_f32_dpp v4, v39, v4 quad_perm:[3,3,3,3] row_mask:0xf bank_mask:0xf
    v_add_f32 v60, v60, v4
    v_mfma_f32_16x16x32_bf16 v[32:35], a[196:199], v[20:23], 0
    v_mov_b32_dpp v61, v40 quad_perm:[0,0,0,0] row_mask:0xf bank_mask:0xf
    v_mov_b32_dpp v4, v42 quad_perm:[2,2,2,2] row_mask:0xf bank_mask:0xf
    s_nop 0
    v_add_f32_dpp v61, v41, v61 quad_perm:[1,1,1,1] row_mask:0xf bank_mask:0xf
    v_add_f32_dpp v4, v43, v4 quad_perm:[3,3,3,3] row_mask:0xf bank_mask:0xf
    v_add_f32 v61, v61, v4
    v_cvt_pk_bf16_f32 v51, v60, v61
    v_mfma_f32_16x16x32_bf16 v[36:39], a[200:203], v[20:23], 0
    v_mov_b32_dpp v60, v28 quad_perm:[0,0,0,0] row_mask:0xf bank_mask:0xf
    v_mov_b32_dpp v4, v30 quad_perm:[2,2,2,2] row_mask:0xf bank_mask:0xf
    s_nop 0
    v_add_f32_dpp v60, v29, v60 quad_perm:[1,1,1,1] row_mask:0xf bank_mask:0xf
    v_add_f32_dpp v4, v31, v4 quad_perm:[3,3,3,3] row_mask:0xf bank_mask:0xf
    v_add_f32 v60, v60, v4
    v_mfma_f32_16x16x32_bf16 v[40:43], a[204:207], v[20:23], 0
    v_mov_b32_dpp v61, v32 quad_perm:[0,0,0,0] row_mask:0xf bank_mask:0xf
    v_mov_b32_dpp v4, v34 quad_perm:[2,2,2,2] row_mask:0xf bank_mask:0xf
    s_nop 0
    v_add_f32_dpp v61, v33, v61 quad_perm:[1,1,1,1] row_mask:0xf bank_mask:0xf
    v_add_f32_dpp v4, v35, v4 quad_perm:[3,3,3,3] row_mask:0xf bank_mask:0xf
    v_add_f32 v61, v61, v4
    v_cvt_pk_bf16_f32 v52, v60, v61
    v_mfma_f32_16x16x32_bf16 v[28:31], a[208:211], v[20:23], 0
    v_mov_b32_dpp v60, v36 quad_perm:[0,0,0,0] row_mask:0xf bank_mask:0xf
    v_mov_b32_dpp v4, v38 quad_perm:[2,2,2,2] row_mask:0xf bank_mask:0xf
    s_nop 0
    v_add_f32_dpp v60, v37, v60 quad_perm:[1,1,1,1] row_mask:0xf bank_mask:0xf
    v_add_f32_dpp v4, v39, v4 quad_perm:[3,3,3,3] row_mask:0xf bank_mask:0xf
    v_add_f32 v60, v60, v4
    buffer_load_dwordx4 a[0:3], v76, s[52:55], s85 offen offset:0 nt
    v_mfma_f32_16x16x32_bf16 v[32:35], a[212:215], v[20:23], 0
    v_mov_b32_dpp v61, v40 quad_perm:[0,0,0,0] row_mask:0xf bank_mask:0xf
    v_mov_b32_dpp v4, v42 quad_perm:[2,2,2,2] row_mask:0xf bank_mask:0xf
    s_nop 0
    v_add_f32_dpp v61, v41, v61 quad_perm:[1,1,1,1] row_mask:0xf bank_mask:0xf
    v_add_f32_dpp v4, v43, v4 quad_perm:[3,3,3,3] row_mask:0xf bank_mask:0xf
    v_add_f32 v61, v61, v4
    v_cvt_pk_bf16_f32 v53, v60, v61
    v_mfma_f32_16x16x32_bf16 v[36:39], a[216:219], v[20:23], 0
    v_mov_b32_dpp v60, v28 quad_perm:[0,0,0,0] row_mask:0xf bank_mask:0xf
    v_mov_b32_dpp v4, v30 quad_perm:[2,2,2,2] row_mask:0xf bank_mask:0xf
    s_nop 0
    v_add_f32_dpp v60, v29, v60 quad_perm:[1,1,1,1] row_mask:0xf bank_mask:0xf
    v_add_f32_dpp v4, v31, v4 quad_perm:[3,3,3,3] row_mask:0xf bank_mask:0xf
    v_add_f32 v60, v60, v4
    v_mfma_f32_16x16x32_bf16 v[40:43], a[220:223], v[20:23], 0
    v_mov_b32_dpp v61, v32 quad_perm:[0,0,0,0] row_mask:0xf bank_mask:0xf
    v_mov_b32_dpp v4, v34 quad_perm:[2,2,2,2] row_mask:0xf bank_mask:0xf
    s_nop 0
    v_add_f32_dpp v61, v33, v61 quad_perm:[1,1,1,1] row_mask:0xf bank_mask:0xf
    v_add_f32_dpp v4, v35, v4 quad_perm:[3,3,3,3] row_mask:0xf bank_mask:0xf
    v_add_f32 v61, v61, v4
    v_cvt_pk_bf16_f32 v54, v60, v61
    v_mfma_f32_16x16x32_bf16 v[28:31], a[224:227], v[20:23], 0
    v_mov_b32_dpp v60, v36 quad_perm:[0,0,0,0] row_mask:0xf bank_mask:0xf
    v_mov_b32_dpp v4, v38 quad_perm:[2,2,2,2] row_mask:0xf bank_mask:0xf
    s_nop 0
    v_add_f32_dpp v60, v37, v60 quad_perm:[1,1,1,1] row_mask:0xf bank_mask:0xf
    v_add_f32_dpp v4, v39, v4 quad_perm:[3,3,3,3] row_mask:0xf bank_mask:0xf
    v_add_f32 v60, v60, v4
    v_mfma_f32_16x16x32_bf16 v[32:35], a[228:231], v[20:23], 0
    v_mov_b32_dpp v61, v40 quad_perm:[0,0,0,0] row_mask:0xf bank_mask:0xf
    v_mov_b32_dpp v4, v42 quad_perm:[2,2,2,2] row_mask:0xf bank_mask:0xf
    s_nop 0
    v_add_f32_dpp v61, v41, v61 quad_perm:[1,1,1,1] row_mask:0xf bank_mask:0xf
    v_add_f32_dpp v4, v43, v4 quad_perm:[3,3,3,3] row_mask:0xf bank_mask:0xf
    v_add_f32 v61, v61, v4
    v_cvt_pk_bf16_f32 v55, v60, v61
    v_mfma_f32_16x16x32_bf16 v[36:39], a[232:235], v[20:23], 0
    v_mov_b32_dpp v60, v28 quad_perm:[0,0,0,0] row_mask:0xf bank_mask:0xf
    v_mov_b32_dpp v4, v30 quad_perm:[2,2,2,2] row_mask:0xf bank_mask:0xf
    s_nop 0
    v_add_f32_dpp v60, v29, v60 quad_perm:[1,1,1,1] row_mask:0xf bank_mask:0xf
    v_add_f32_dpp v4, v31, v4 quad_perm:[3,3,3,3] row_mask:0xf bank_mask:0xf
    v_add_f32 v60, v60, v4
    v_mfma_f32_16x16x32_bf16 v[40:43], a[236:239], v[20:23], 0
    v_mov_b32_dpp v61, v32 quad_perm:[0,0,0,0] row_mask:0xf bank_mask:0xf
    v_mov_b32_dpp v4, v34 quad_perm:[2,2,2,2] row_mask:0xf bank_mask:0xf
    s_nop 0
    v_add_f32_dpp v61, v33, v61 quad_perm:[1,1,1,1] row_mask:0xf bank_mask:0xf
    v_add_f32_dpp v4, v35, v4 quad_perm:[3,3,3,3] row_mask:0xf bank_mask:0xf
    v_add_f32 v61, v61, v4
    v_cvt_pk_bf16_f32 v56, v60, v61
    v_mfma_f32_16x16x32_bf16 v[28:31], a[240:243], v[20:23], 0
    v_mov_b32_dpp v60, v36 quad_perm:[0,0,0,0] row_mask:0xf bank_mask:0xf
    v_mov_b32_dpp v4, v38 quad_perm:[2,2,2,2] row_mask:0xf bank_mask:0xf
    s_nop 0
    v_add_f32_dpp v60, v37, v60 quad_perm:[1,1,1,1] row_mask:0xf bank_mask:0xf
    v_add_f32_dpp v4, v39, v4 quad_perm:[3,3,3,3] row_mask:0xf bank_mask:0xf
    v_add_f32 v60, v60, v4
    buffer_load_dwordx4 a[4:7], v77, s[52:55], s85 offen offset:0 nt
    v_mfma_f32_16x16x32_bf16 v[32:35], a[244:247], v[20:23], 0
    v_mov_b32_dpp v61, v40 quad_perm:[0,0,0,0] row_mask:0xf bank_mask:0xf
    v_mov_b32_dpp v4, v42 quad_perm:[2,2,2,2] row_mask:0xf bank_mask:0xf
    s_nop 0
    v_add_f32_dpp v61, v41, v61 quad_perm:[1,1,1,1] row_mask:0xf bank_mask:0xf
    v_add_f32_dpp v4, v43, v4 quad_perm:[3,3,3,3] row_mask:0xf bank_mask:0xf
    v_add_f32 v61, v61, v4
    v_cvt_pk_bf16_f32 v57, v60, v61
    v_mfma_f32_16x16x32_bf16 v[36:39], a[248:251], v[20:23], 0
    v_mov_b32_dpp v60, v28 quad_perm:[0,0,0,0] row_mask:0xf bank_mask:0xf
    v_mov_b32_dpp v4, v30 quad_perm:[2,2,2,2] row_mask:0xf bank_mask:0xf
    s_nop 0
    v_add_f32_dpp v60, v29, v60 quad_perm:[1,1,1,1] row_mask:0xf bank_mask:0xf
    v_add_f32_dpp v4, v31, v4 quad_perm:[3,3,3,3] row_mask:0xf bank_mask:0xf
    v_add_f32 v60, v60, v4
    v_mfma_f32_16x16x32_bf16 v[40:43], a[252:255], v[20:23], 0
    v_mov_b32_dpp v61, v32 quad_perm:[0,0,0,0] row_mask:0xf bank_mask:0xf
    v_mov_b32_dpp v4, v34 quad_perm:[2,2,2,2] row_mask:0xf bank_mask:0xf
    s_nop 0
    v_add_f32_dpp v61, v33, v61 quad_perm:[1,1,1,1] row_mask:0xf bank_mask:0xf
    v_add_f32_dpp v4, v35, v4 quad_perm:[3,3,3,3] row_mask:0xf bank_mask:0xf
    v_add_f32 v61, v61, v4
    v_cvt_pk_bf16_f32 v58, v60, v61
    v_mov_b32_dpp v60, v36 quad_perm:[0,0,0,0] row_mask:0xf bank_mask:0xf
    v_mov_b32_dpp v4, v38 quad_perm:[2,2,2,2] row_mask:0xf bank_mask:0xf
    s_nop 0
    v_add_f32_dpp v60, v37, v60 quad_perm:[1,1,1,1] row_mask:0xf bank_mask:0xf
    v_add_f32_dpp v4, v39, v4 quad_perm:[3,3,3,3] row_mask:0xf bank_mask:0xf
    v_add_f32 v60, v60, v4
    v_mov_b32_dpp v61, v40 quad_perm:[0,0,0,0] row_mask:0xf bank_mask:0xf
    v_mov_b32_dpp v4, v42 quad_perm:[2,2,2,2] row_mask:0xf bank_mask:0xf
    s_nop 0
    v_add_f32_dpp v61, v41, v61 quad_perm:[1,1,1,1] row_mask:0xf bank_mask:0xf
    v_add_f32_dpp v4, v43, v4 quad_perm:[3,3,3,3] row_mask:0xf bank_mask:0xf
    v_add_f32 v61, v61, v4
    v_cvt_pk_bf16_f32 v59, v60, v61
    s_mov_b32 exec_lo, 0x22222222
    s_mov_b32 exec_hi, 0x22222222
    v_mov_b32 v44, v48
    v_mov_b32 v45, v49
    v_mov_b32 v46, v50
    v_mov_b32 v47, v51
    s_mov_b32 exec_lo, 0x44444444
    s_mov_b32 exec_hi, 0x44444444
    v_mov_b32 v44, v52
    v_mov_b32 v45, v53
    v_mov_b32 v46, v54
    v_mov_b32 v47, v55
    s_mov_b32 exec_lo, 0x88888888
    s_mov_b32 exec_hi, 0x88888888
    v_mov_b32 v44, v56
    v_mov_b32 v45, v57
    v_mov_b32 v46, v58
    v_mov_b32 v47, v59
    s_mov_b64 exec, -1
    buffer_store_dwordx4 v[44:47], v19, s[48:51], s94 offen sc1
    s_waitcnt vmcnt(5)
L_qcheck_14:
    v_xor_b32 v68, s35, v68
    v_xor_b32 v69, s35, v69
    v_xor_b32 v70, s35, v70
    v_xor_b32 v71, s35, v71
    v_xor_b32 v72, s35, v72
    v_xor_b32 v73, s35, v73
    v_xor_b32 v74, s35, v74
    v_xor_b32 v75, s35, v75
    v_or_b32 v4, v68, v69
    v_or3_b32 v4, v4, v70, v71
    v_or3_b32 v4, v4, v72, v73
    v_or3_b32 v4, v4, v74, v75
    v_and_b32 v4, 0xff, v4
    v_cmp_ne_u32 vcc, 0, v4
    s_cbranch_vccz L_qok_15
    buffer_load_dwordx4 v[68:71], v78, s[48:51], s91 offen offset:0 sc1
    buffer_load_dwordx4 v[72:75], v78, s[48:51], s91 offen offset:16 sc1
    s_waitcnt vmcnt(0)
    s_sub_u32 s84, s84, 1
    s_cmp_lg_u32 s84, 0
    s_cbranch_scc1 L_qcheck_14
    s_branch L_end
L_qok_15:
    v_cvt_pk_bf16_f32 v68, v68, v69
    v_cvt_pk_bf16_f32 v69, v70, v71
    v_cvt_pk_bf16_f32 v70, v72, v73
    v_cvt_pk_bf16_f32 v71, v74, v75
    s_mov_b32 vcc_lo, 0xf000f
    s_mov_b32 vcc_hi, 0xf000f
    v_cndmask_b32 v80, 0, v68, vcc
    v_cndmask_b32 v81, 0, v69, vcc
    v_cndmask_b32 v82, 0, v70, vcc
    v_cndmask_b32 v83, 0, v71, vcc
    s_mov_b32 vcc_lo, 0xf000f0
    s_mov_b32 vcc_hi, 0xf000f0
    v_cndmask_b32 v84, 0, v68, vcc
    v_cndmask_b32 v85, 0, v69, vcc
    v_cndmask_b32 v86, 0, v70, vcc
    v_cndmask_b32 v87, 0, v71, vcc
    s_mov_b32 vcc_lo, 0xf000f00
    s_mov_b32 vcc_hi, 0xf000f00
    v_cndmask_b32 v88, 0, v68, vcc
    v_cndmask_b32 v89, 0, v69, vcc
    v_cndmask_b32 v90, 0, v70, vcc
    v_cndmask_b32 v91, 0, v71, vcc
    s_mov_b32 vcc_lo, 0xf000f000
    s_mov_b32 vcc_hi, 0xf000f000
    v_cndmask_b32 v92, 0, v68, vcc
    v_cndmask_b32 v93, 0, v69, vcc
    v_cndmask_b32 v94, 0, v70, vcc
    v_cndmask_b32 v95, 0, v71, vcc
    v_mov_b32 v65, 0xff7f0000
    s_lshl_b32 s38, s34, 14
    s_add_u32 s38, s38, 16384
    v_lshl_add_u32 v64, v1, 2, s38
    buffer_load_dwordx4 a[8:11], v76, s[52:55], s85 offen offset:1024 nt
    v_mfma_f32_16x16x32_bf16 v[112:115], v[128:131], v[80:83], 0
    v_mfma_f32_16x16x32_bf16 v[112:115], v[132:135], v[84:87], v[112:115]
    buffer_load_dwordx4 a[12:15], v77, s[52:55], s85 offen offset:1024 nt
    s_add_u32 s87, s87, 7
    s_add_u32 s39, s87, s88
    s_bfe_u32 s37, s39, 0x30000
    s_lshl_b32 s37, s37, 12
    s_add_u32 s85, s37, s89
    s_bfe_u32 s37, s39, 0x10003
    s_lshl_b32 s37, s37, 11
    s_add_u32 s85, s37, s85
    s_bfe_u32 s37, s39, 0x40004
    s_lshl_b32 s37, s37, 16
    s_add_u32 s85, s37, s85
    v_mfma_f32_16x16x32_bf16 v[112:115], v[136:139], v[88:91], v[112:115]
    v_mfma_f32_16x16x32_bf16 v[112:115], v[140:143], v[92:95], v[112:115]
    buffer_load_dwordx4 a[16:19], v76, s[52:55], s85 offen offset:0 nt
    v_mfma_f32_16x16x32_bf16 v[96:99], v[144:147], v[80:83], 0
    v_mfma_f32_16x16x32_bf16 v[96:99], v[148:151], v[84:87], v[96:99]
    v_mfma_f32_16x16x32_bf16 v[96:99], v[152:155], v[88:91], v[96:99]
    s_nop 3
    v_mov_b32_dpp v122, v112 quad_perm:[0,0,0,0] row_mask:0xf bank_mask:0xf
    v_mov_b32_dpp v124, v114 quad_perm:[2,2,2,2] row_mask:0xf bank_mask:0xf
    s_nop 0
    v_add_f32_dpp v122, v113, v122 quad_perm:[1,1,1,1] row_mask:0xf bank_mask:0xf
    v_add_f32_dpp v124, v115, v124 quad_perm:[3,3,3,3] row_mask:0xf bank_mask:0xf
    v_add_f32 v122, v122, v124
    v_max_f32 v65, v65, v122
    ds_write_b32 v64, v122 offset:0
    s_waitcnt vmcnt(7)
    buffer_load_dwordx4 a[20:23], v77, s[52:55], s85 offen offset:0 nt
    v_mfma_f32_16x16x32_bf16 v[96:99], v[156:159], v[92:95], v[96:99]
    v_mfma_f32_16x16x32_bf16 v[112:115], v[160:163], v[80:83], 0
    s_waitcnt vmcnt(7)
    buffer_load_dwordx4 a[24:27], v76, s[52:55], s85 offen offset:1024 nt
    v_mfma_f32_16x16x32_bf16 v[112:115], v[164:167], v[84:87], v[112:115]
    v_mfma_f32_16x16x32_bf16 v[112:115], v[168:171], v[88:91], v[112:115]
    s_nop 2
    v_mov_b32_dpp v122, v96 quad_perm:[0,0,0,0] row_mask:0xf bank_mask:0xf
    v_mov_b32_dpp v124, v98 quad_perm:[2,2,2,2] row_mask:0xf bank_mask:0xf
    s_nop 0
    v_add_f32_dpp v122, v97, v122 quad_perm:[1,1,1,1] row_mask:0xf bank_mask:0xf
    v_add_f32_dpp v124, v99, v124 quad_perm:[3,3,3,3] row_mask:0xf bank_mask:0xf
    v_add_f32 v122, v122, v124
    v_max_f32 v65, v65, v122
    ds_write_b32 v64, v122 offset:256
    v_mfma_f32_16x16x32_bf16 v[112:115], v[172:175], v[92:95], v[112:115]
    s_waitcnt vmcnt(7)
    buffer_load_dwordx4 a[28:31], v77, s[52:55], s85 offen offset:1024 nt
    s_add_u32 s87, s87, 7
    s_add_u32 s39, s87, s88
    s_bfe_u32 s37, s39, 0x30000
    s_lshl_b32 s37, s37, 12
    s_add_u32 s85, s37, s89
    s_bfe_u32 s37, s39, 0x10003
    s_lshl_b32 s37, s37, 11
    s_add_u32 s85, s37, s85
    s_bfe_u32 s37, s39, 0x40004
    s_lshl_b32 s37, s37, 16
    s_add_u32 s85, s37, s85
    v_mfma_f32_16x16x32_bf16 v[96:99], v[176:179], v[80:83], 0
    v_mfma_f32_16x16x32_bf16 v[96:99], v[180:183], v[84:87], v[96:99]
    s_waitcnt vmcnt(7)
    buffer_load_dwordx4 a[32:35], v76, s[52:55], s85 offen offset:0 nt
    v_mfma_f32_16x16x32_bf16 v[96:99], v[184:187], v[88:91], v[96:99]
    v_mov_b32_dpp v122, v112 quad_perm:[0,0,0,0] row_mask:0xf bank_mask:0xf
    v_mov_b32_dpp v124, v114 quad_perm:[2,2,2,2] row_mask:0xf bank_mask:0xf
    s_nop 0
    v_add_f32_dpp v122, v113, v122 quad_perm:[1,1,1,1] row_mask:0xf bank_mask:0xf
    v_add_f32_dpp v124, v115, v124 quad_perm:[3,3,3,3] row_mask:0xf bank_mask:0xf
    v_add_f32 v122, v122, v124
    v_max_f32 v65, v65, v122
    ds_write_b32 v64, v122 offset:512
    v_mfma_f32_16x16x32_bf16 v[96:99], v[188:191], v[92:95], v[96:99]
    s_lshl_b32 s38, s32, 8
    s_add_u32 s69, s38, 98304
    s_lshl_b32 s38, s34, 13
    s_add_u32 s69, s38, s69
    v_mov_b32 v28, s69
    v_mov_b32 v29, s68
    s_waitcnt vmcnt(7)
    s_mov_b64 exec, 1
    buffer_store_dword v29, v28, s[48:51], 0 offen sc1
    s_mov_b64 exec, -1
    s_waitcnt vmcnt(7)
    buffer_load_dwordx4 a[36:39], v77, s[52:55], s85 offen offset:0 nt
    v_mfma_f32_16x16x32_bf16 v[112:115], v[192:195], v[80:83], 0
    v_mfma_f32_16x16x32_bf16 v[112:115], v[196:199], v[84:87], v[112:115]
    v_mfma_f32_16x16x32_bf16 v[112:115], v[200:203], v[88:91], v[112:115]
    v_mov_b32_dpp v122, v96 quad_perm:[0,0,0,0] row_mask:0xf bank_mask:0xf
    v_mov_b32_dpp v124, v98 quad_perm:[2,2,2,2] row_mask:0xf bank_mask:0xf
    s_nop 0
    v_add_f32_dpp v122, v97, v122 quad_perm:[1,1,1,1] row_mask:0xf bank_mask:0xf
    v_add_f32_dpp v124, v99, v124 quad_perm:[3,3,3,3] row_mask:0xf bank_mask:0xf
    v_add_f32 v122, v122, v124
    v_max_f32 v65, v65, v122
    ds_write_b32 v64, v122 offset:768
    s_waitcnt vmcnt(7)
    buffer_load_dwordx4 a[40:43], v76, s[52:55], s85 offen offset:1024 nt
    v_mfma_f32_16x16x32_bf16 v[112:115], v[204:207], v[92:95], v[112:115]
    v_mfma_f32_16x16x32_bf16 v[96:99], v[208:211], v[80:83], 0
    s_waitcnt vmcnt(7)
    buffer_load_dwordx4 a[44:47], v77, s[52:55], s85 offen offset:1024 nt
    s_add_u32 s87, s87, 7
    s_add_u32 s39, s87, s88
    s_bfe_u32 s37, s39, 0x30000
    s_lshl_b32 s37, s37, 12
    s_add_u32 s85, s37, s89
    s_bfe_u32 s37, s39, 0x10003
    s_lshl_b32 s37, s37, 11
    s_add_u32 s85, s37, s85
    s_bfe_u32 s37, s39, 0x40004
    s_lshl_b32 s37, s37, 16
    s_add_u32 s85, s37, s85
    v_mfma_f32_16x16x32_bf16 v[96:99], v[212:215], v[84:87], v[96:99]
    v_mfma_f32_16x16x32_bf16 v[96:99], v[216:219], v[88:91], v[96:99]
    v_mov_b32_dpp v122, v112 quad_perm:[0,0,0,0] row_mask:0xf bank_mask:0xf
    v_mov_b32_dpp v124, v114 quad_perm:[2,2,2,2] row_mask:0xf bank_mask:0xf
    s_nop 0
    v_add_f32_dpp v122, v113, v122 quad_perm:[1,1,1,1] row_mask:0xf bank_mask:0xf
    v_add_f32_dpp v124, v115, v124 quad_perm:[3,3,3,3] row_mask:0xf bank_mask:0xf
    v_add_f32 v122, v122, v124
    v_max_f32 v65, v65, v122
    ds_write_b32 v64, v122 offset:1024
    v_mfma_f32_16x16x32_bf16 v[96:99], v[220:223], v[92:95], v[96:99]
    s_waitcnt vmcnt(7)
    buffer_load_dwordx4 a[48:51], v76, s[52:55], s85 offen offset:0 nt
    v_mfma_f32_16x16x32_bf16 v[112:115], v[224:227], v[80:83], 0
    v_mfma_f32_16x16x32_bf16 v[112:115], v[228:231], v[84:87], v[112:115]
    s_waitcnt vmcnt(7)
    buffer_load_dwordx4 a[52:55], v77, s[52:55], s85 offen offset:0 nt
    v_mfma_f32_16x16x32_bf16 v[112:115], v[232:235], v[88:91], v[112:115]
    s_nop 0
    v_mov_b32_dpp v122, v96 quad_perm:[0,0,0,0] row_mask:0xf bank_mask:0xf
    v_mov_b32_dpp v124, v98 quad_perm:[2,2,2,2] row_mask:0xf bank_mask:0xf
    s_nop 0
    v_add_f32_dpp v122, v97, v122 quad_perm:[1,1,1,1] row_mask:0xf bank_mask:0xf
    v_add_f32_dpp v124, v99, v124 quad_perm:[3,3,3,3] row_mask:0xf bank_mask:0xf
    v_add_f32 v122, v122, v124
    v_max_f32 v65, v65, v122
    ds_write_b32 v64, v122 offset:1280
    v_mfma_f32_16x16x32_bf16 v[112:115], v[236:239], v[92:95], v[112:115]
    s_waitcnt vmcnt(7)
    buffer_load_dwordx4 a[56:59], v76, s[52:55], s85 offen offset:1024 nt
    v_mfma_f32_16x16x32_bf16 v[96:99], v[240:243], v[80:83], 0
    v_mfma_f32_16x16x32_bf16 v[96:99], v[244:247], v[84:87], v[96:99]
    v_mfma_f32_16x16x32_bf16 v[96:99], v[248:251], v[88:91], v[96:99]
    s_nop 2
    v_mov_b32_dpp v122, v112 quad_perm:[0,0,0,0] row_mask:0xf bank_mask:0xf
    v_mov_b32_dpp v124, v114 quad_perm:[2,2,2,2] row_mask:0xf bank_mask:0xf
    s_nop 0
    v_add_f32_dpp v122, v113, v122 quad_perm:[1,1,1,1] row_mask:0xf bank_mask:0xf
    v_add_f32_dpp v124, v115, v124 quad_perm:[3,3,3,3] row_mask:0xf bank_mask:0xf
    v_add_f32 v122, v122, v124
    v_max_f32 v65, v65, v122
    ds_write_b32 v64, v122 offset:1536
    s_waitcnt vmcnt(7)
    buffer_load_dwordx4 a[60:63], v77, s[52:55], s85 offen offset:1024 nt
    s_add_u32 s87, s87, 7
    s_add_u32 s39, s87, s88
    s_bfe_u32 s37, s39, 0x30000
    s_lshl_b32 s37, s37, 12
    s_add_u32 s85, s37, s89
    s_bfe_u32 s37, s39, 0x10003
    s_lshl_b32 s37, s37, 11
    s_add_u32 s85, s37, s85
    s_bfe_u32 s37, s39, 0x40004
    s_lshl_b32 s37, s37, 16
    s_add_u32 s85, s37, s85
    v_mfma_f32_16x16x32_bf16 v[96:99], v[252:255], v[92:95], v[96:99]
    v_mfma_f32_16x16x32_bf16 v[112:115], a[0:3], v[80:83], 0
    s_waitcnt vmcnt(5)
    buffer_load_dwordx4 v[128:131], v76, s[52:55], s85 offen offset:0 nt
    v_mfma_f32_16x16x32_bf16 v[112:115], a[4:7], v[84:87], v[112:115]
    v_mfma_f32_16x16x32_bf16 v[112:115], a[8:11], v[88:91], v[112:115]
    s_nop 2
    v_mov_b32_dpp v122, v96 quad_perm:[0,0,0,0] row_mask:0xf bank_mask:0xf
    v_mov_b32_dpp v124, v98 quad_perm:[2,2,2,2] row_mask:0xf bank_mask:0xf
    s_nop 0
    v_add_f32_dpp v122, v97, v122 quad_perm:[1,1,1,1] row_mask:0xf bank_mask:0xf
    v_add_f32_dpp v124, v99, v124 quad_perm:[3,3,3,3] row_mask:0xf bank_mask:0xf
    v_add_f32 v122, v122, v124
    v_max_f32 v65, v65, v122
    ds_write_b32 v64, v122 offset:1792
    v_mfma_f32_16x16x32_bf16 v[112:115], a[12:15], v[92:95], v[112:115]
    s_waitcnt vmcnt(5)
    buffer_load_dwordx4 v[132:135], v77, s[52:55], s85 offen offset:0 nt
    v_mfma_f32_16x16x32_bf16 v[96:99], a[16:19], v[80:83], 0
    v_mfma_f32_16x16x32_bf16 v[96:99], a[20:23], v[84:87], v[96:99]
    s_waitcnt vmcnt(5)
    buffer_load_dwordx4 v[136:139], v76, s[52:55], s85 offen offset:1024 nt
    v_mfma_f32_16x16x32_bf16 v[96:99], a[24:27], v[88:91], v[96:99]
    s_nop 0
    v_mov_b32_dpp v122, v112 quad_perm:[0,0,0,0] row_mask:0xf bank_mask:0xf
    v_mov_b32_dpp v124, v114 quad_perm:[2,2,2,2] row_mask:0xf bank_mask:0xf
    s_nop 0
    v_add_f32_dpp v122, v113, v122 quad_perm:[1,1,1,1] row_mask:0xf bank_mask:0xf
    v_add_f32_dpp v124, v115, v124 quad_perm:[3,3,3,3] row_mask:0xf bank_mask:0xf
    v_add_f32 v122, v122, v124
    v_max_f32 v65, v65, v122
    ds_write_b32 v64, v122 offset:2048
    v_mfma_f32_16x16x32_bf16 v[96:99], a[28:31], v[92:95], v[96:99]
    s_waitcnt vmcnt(5)
    buffer_load_dwordx4 v[140:143], v77, s[52:55], s85 offen offset:1024 nt
    s_add_u32 s87, s87, 7
    s_add_u32 s39, s87, s88
    s_bfe_u32 s37, s39, 0x30000
    s_lshl_b32 s37, s37, 12
    s_add_u32 s85, s37, s89
    s_bfe_u32 s37, s39, 0x10003
    s_lshl_b32 s37, s37, 11
    s_add_u32 s85, s37, s85
    s_bfe_u32 s37, s39, 0x40004
    s_lshl_b32 s37, s37, 16
    s_add_u32 s85, s37, s85
    v_mfma_f32_16x16x32_bf16 v[112:115], a[32:35], v[80:83], 0
    v_mfma_f32_16x16x32_bf16 v[112:115], a[36:39], v[84:87], v[112:115]
    v_mfma_f32_16x16x32_bf16 v[112:115], a[40:43], v[88:91], v[112:115]
    v_mov_b32_dpp v122, v96 quad_perm:[0,0,0,0] row_mask:0xf bank_mask:0xf
    v_mov_b32_dpp v124, v98 quad_perm:[2,2,2,2] row_mask:0xf bank_mask:0xf
    s_nop 0
    v_add_f32_dpp v122, v97, v122 quad_perm:[1,1,1,1] row_mask:0xf bank_mask:0xf
    v_add_f32_dpp v124, v99, v124 quad_perm:[3,3,3,3] row_mask:0xf bank_mask:0xf
    v_add_f32 v122, v122, v124
    v_max_f32 v65, v65, v122
    ds_write_b32 v64, v122 offset:2304
    s_waitcnt vmcnt(5)
    buffer_load_dwordx4 v[144:147], v76, s[52:55], s85 offen offset:0 nt
    v_mfma_f32_16x16x32_bf16 v[112:115], a[44:47], v[92:95], v[112:115]
    v_mfma_f32_16x16x32_bf16 v[96:99], a[48:51], v[80:83], 0
    s_waitcnt vmcnt(5)
    buffer_load_dwordx4 v[148:151], v77, s[52:55], s85 offen offset:0 nt
    v_mfma_f32_16x16x32_bf16 v[96:99], a[52:55], v[84:87], v[96:99]
    v_mfma_f32_16x16x32_bf16 v[96:99], a[56:59], v[88:91], v[96:99]
    s_nop 2
    v_mov_b32_dpp v122, v112 quad_perm:[0,0,0,0] row_mask:0xf bank_mask:0xf
    v_mov_b32_dpp v124, v114 quad_perm:[2,2,2,2] row_mask:0xf bank_mask:0xf
    s_nop 0
    v_add_f32_dpp v122, v113, v122 quad_perm:[1,1,1,1] row_mask:0xf bank_mask:0xf
    v_add_f32_dpp v124, v115, v124 quad_perm:[3,3,3,3] row_mask:0xf bank_mask:0xf
    v_add_f32 v122, v122, v124
    v_max_f32 v65, v65, v122
    ds_write_b32 v64, v122 offset:2560
    v_mfma_f32_16x16x32_bf16 v[96:99], a[60:63], v[92:95], v[96:99]
    v_add_u32 v64, 2816, v64
    s_mov_b32 s97, 10
    s_mov_b32 s86, 32
    s_add_u32 s92, s33, 224
    s_mov_b32 s66, 134217728
    s_mov_b32 s67, 0x20000
    s_mov_b64 s[64:65], s[52:53]
    v_mov_b32 v62, v76
    v_mov_b32 v63, v77
    s_branch L_bloop
L_aux:
    v_lshlrev_b32 v4, 2, v2
    v_xor_b32 v4, v4, v3
    v_xor_b32 v96, 0, v4
    v_lshlrev_b32 v96, 4, v96
    v_lshl_add_u32 v10, v2, 13, v96
    v_xor_b32 v97, 1, v4
    v_lshlrev_b32 v97, 4, v97
    v_lshl_add_u32 v11, v2, 13, v97
    v_add_u32 v11, 31744, v11
    v_xor_b32 v98, 2, v4
    v_lshlrev_b32 v98, 4, v98
    v_lshl_add_u32 v12, v2, 13, v98
    v_add_u32 v12, 63488, v12
    v_xor_b32 v99, 3, v4
    v_lshlrev_b32 v99, 4, v99
    v_lshl_add_u32 v13, v2, 13, v99
    v_add_u32 v13, 95232, v13
    s_lshl_b32 s90, s34, 15
    s_mov_b32 s62, 0
    s_mov_b32 s94, 0
    s_lshl_b32 s95, s34, 20
    s_lshl_b32 s38, s32, 8
    s_add_u32 s95, s95, s38
    s_waitcnt lgkmcnt(0)
    s_mov_b32 s52, s12
    s_and_b32 s53, s13, 0xffff
    s_mov_b32 s54, 4194304
    s_mov_b32 s55, 0x20000
    s_add_u32 s39, s90, s62
    s_mov_b32 m0, s39
    s_add_u32 s62, s62, 4096
    s_and_b32 s62, s62, 0x7fff
    buffer_load_dwordx4 v10, s[52:55], s95 offen offset:0 nt lds
    buffer_load_dwordx4 v11, s[52:55], s95 offen offset:1024 nt lds
    buffer_load_dwordx4 v12, s[52:55], s95 offen offset:2048 nt lds
    buffer_load_dwordx4 v13, s[52:55], s95 offen offset:3072 nt lds
    s_add_u32 s95, s95, 131072
    s_add_u32 s39, s90, s62
    s_mov_b32 m0, s39
    s_add_u32 s62, s62, 4096
    s_and_b32 s62, s62, 0x7fff
    buffer_load_dwordx4 v10, s[52:55], s95 offen offset:0 nt lds
    buffer_load_dwordx4 v11, s[52:55], s95 offen offset:1024 nt lds
    buffer_load_dwordx4 v12, s[52:55], s95 offen offset:2048 nt lds
    buffer_load_dwordx4 v13, s[52:55], s95 offen offset:3072 nt lds
    s_add_u32 s95, s95, 131072
    s_load_dword s35, s[30:31], 0
    s_mov_b32 s48, s30
    s_and_b32 s49, s31, 0xffff
    s_mov_b32 s50, 8388608
    s_mov_b32 s51, 0x20000
    s_mov_b32 s82, 0xffffff00
    s_mov_b32 s83, 0x3e0293ee
    s_mov_b32 s84, 2097152
    s_mov_b32 s72, s26
    s_and_b32 s73, s27, 0xffff
    s_mov_b32 s74, 8192
    s_mov_b32 s75, 0x20000
    v_lshl_add_u32 v76, v2, 10, v96
    v_lshl_add_u32 v96, v2, 8, v96
    v_lshl_add_u32 v77, v2, 10, v97
    v_lshl_add_u32 v97, v2, 8, v97
    v_add_u32 v77, 3072, v77
    v_lshl_add_u32 v78, v2, 10, v98
    v_lshl_add_u32 v98, v2, 8, v98
    v_add_u32 v78, 6144, v78
    v_lshl_add_u32 v79, v2, 10, v99
    v_lshl_add_u32 v99, v2, 8, v99
    v_add_u32 v79, 9216, v79
    v_bfe_u32 v100, v1, 0, 5
    v_lshlrev_b32 v101, 8, v100
    v_mov_b32 v100, 0
    s_lshl_b32 s38, s34, 13
    v_add_u32 v101, s38, v101
    v_lshlrev_b32 v4, 4, v3
    v_lshl_add_u32 v9, v2, 10, v4
    s_lshl_b32 s63, s32, 17
    s_lshl_b32 s38, s34, 8
    s_add_u32 s63, s63, s38
    v_and_b32 v4, 3, v1
    v_bfe_u32 v5, v1, 2, 2
    v_lshrrev_b32 v6, 5, v1
    v_lshl_add_u32 v7, v4, 2, v5
    v_xor_b32 v7, v7, v6
    v_lshlrev_b32 v7, 4, v7
    v_and_b32 v80, 31, v1
    v_lshl_add_u32 v80, v80, 8, v7
    v_lshl_add_u32 v81, v6, 2, v5
    v_lshlrev_b32 v81, 8, v81
    v_lshl_add_u32 v81, v5, 6, v81
    v_bfe_u32 v7, v1, 4, 1
    v_lshlrev_b32 v7, 1, v7
    v_bfe_u32 v82, v1, 1, 1
    v_add_u32 v7, v7, v82
    v_xor_b32 v7, v7, v6
    v_lshl_add_u32 v81, v7, 4, v81
    v_and_b32 v7, 1, v1
    v_lshl_add_u32 v81, v7, 3, v81
    v_lshl_add_u32 v95, v2, 3, v5
    v_lshlrev_b32 v95, 8, v95
    v_lshl_add_u32 v95, v5, 6, v95
    v_bfe_u32 v4, v1, 4, 1
    v_lshl_add_u32 v4, v4, 1, v82
    v_lshl_add_u32 v95, v4, 4, v95
    v_lshl_add_u32 v95, v7, 3, v95
    v_add_u32 v95, s90, v95
    v_xor_b32 v136, 0, v95
    v_xor_b32 v137, 16, v95
    v_xor_b32 v138, 32, v95
    v_xor_b32 v139, 48, v95
    v_xor_b32 v140, 64, v95
    v_xor_b32 v141, 80, v95
    v_xor_b32 v142, 96, v95
    v_xor_b32 v143, 112, v95
    v_xor_b32 v144, 128, v95
    v_xor_b32 v145, 144, v95
    v_xor_b32 v146, 160, v95
    v_xor_b32 v147, 176, v95
    v_xor_b32 v148, 192, v95
    v_xor_b32 v149, 208, v95
    v_xor_b32 v150, 224, v95
    v_xor_b32 v151, 240, v95
    s_lshl_b32 s85, s34, 13
    s_add_u32 s85, s85, 131072
    v_lshl_add_u32 v94, v1, 4, s85
    v_add_u32 v96, s85, v96
    v_add_u32 v97, s85, v97
    v_add_u32 v98, s85, v98
    v_add_u32 v99, s85, v99
    s_add_u32 s39, s90, s62
    s_mov_b32 m0, s39
    s_add_u32 s62, s62, 4096
    s_and_b32 s62, s62, 0x7fff
    buffer_load_dwordx4 v10, s[52:55], s95 offen offset:0 nt lds
    buffer_load_dwordx4 v11, s[52:55], s95 offen offset:1024 nt lds
    buffer_load_dwordx4 v12, s[52:55], s95 offen offset:2048 nt lds
    buffer_load_dwordx4 v13, s[52:55], s95 offen offset:3072 nt lds
    s_add_u32 s95, s95, 131072
    s_add_u32 s39, s90, s62
    s_mov_b32 m0, s39
    s_add_u32 s62, s62, 4096
    s_and_b32 s62, s62, 0x7fff
    buffer_load_dwordx4 v10, s[52:55], s95 offen offset:0 nt lds
    buffer_load_dwordx4 v11, s[52:55], s95 offen offset:1024 nt lds
    buffer_load_dwordx4 v12, s[52:55], s95 offen offset:2048 nt lds
    buffer_load_dwordx4 v13, s[52:55], s95 offen offset:3072 nt lds
    s_add_u32 s95, s95, 131072
    s_add_u32 s39, s90, s62
    s_mov_b32 m0, s39
    s_add_u32 s62, s62, 4096
    s_and_b32 s62, s62, 0x7fff
    buffer_load_dwordx4 v10, s[52:55], s95 offen offset:0 nt lds
    buffer_load_dwordx4 v11, s[52:55], s95 offen offset:1024 nt lds
    buffer_load_dwordx4 v12, s[52:55], s95 offen offset:2048 nt lds
    buffer_load_dwordx4 v13, s[52:55], s95 offen offset:3072 nt lds
    s_add_u32 s95, s95, 131072
    s_add_u32 s39, s90, s62
    s_mov_b32 m0, s39
    s_add_u32 s62, s62, 4096
    s_and_b32 s62, s62, 0x7fff
    buffer_load_dwordx4 v10, s[52:55], s95 offen offset:0 nt lds
    buffer_load_dwordx4 v11, s[52:55], s95 offen offset:1024 nt lds
    buffer_load_dwordx4 v12, s[52:55], s95 offen offset:2048 nt lds
    buffer_load_dwordx4 v13, s[52:55], s95 offen offset:3072 nt lds
    s_add_u32 s95, s95, 131072
    s_add_u32 s39, s90, s62
    s_mov_b32 m0, s39
    s_add_u32 s62, s62, 4096
    s_and_b32 s62, s62, 0x7fff
    buffer_load_dwordx4 v10, s[52:55], s95 offen offset:0 nt lds
    buffer_load_dwordx4 v11, s[52:55], s95 offen offset:1024 nt lds
    buffer_load_dwordx4 v12, s[52:55], s95 offen offset:2048 nt lds
    buffer_load_dwordx4 v13, s[52:55], s95 offen offset:3072 nt lds
    s_add_u32 s95, s95, 131072
    s_add_u32 s39, s90, s62
    s_mov_b32 m0, s39
    s_add_u32 s62, s62, 4096
    s_and_b32 s62, s62, 0x7fff
    buffer_load_dwordx4 v10, s[52:55], s95 offen offset:0 nt lds
    buffer_load_dwordx4 v11, s[52:55], s95 offen offset:1024 nt lds
    buffer_load_dwordx4 v12, s[52:55], s95 offen offset:2048 nt lds
    buffer_load_dwordx4 v13, s[52:55], s95 offen offset:3072 nt lds
    s_add_u32 s95, s95, 131072
    s_waitcnt lgkmcnt(0)
    s_add_u32 s35, s35, 0x5b
    s_and_b32 s35, s35, 0xff
    v_mov_b32 v8, s35
    s_or_b32 s68, s35, 0x6b3ac500
    s_mov_b32 s52, s14
    s_and_b32 s53, s15, 0xffff
    s_mov_b32 s54, 4194304
    s_mov_b32 s55, 0x20000
    s_mov_b32 s95, s63
    s_waitcnt vmcnt(24)
    ds_read_b64_tr_b16 a[128:129], v136 offset:0
    ds_read_b64_tr_b16 a[130:131], v137 offset:1024
    ds_read_b64_tr_b16 a[144:145], v138 offset:0
    ds_read_b64_tr_b16 a[146:147], v139 offset:1024
    ds_read_b64_tr_b16 a[160:161], v140 offset:0
    ds_read_b64_tr_b16 a[162:163], v141 offset:1024
    ds_read_b64_tr_b16 a[176:177], v142 offset:0
    ds_read_b64_tr_b16 a[178:179], v143 offset:1024
    ds_read_b64_tr_b16 a[192:193], v144 offset:0
    ds_read_b64_tr_b16 a[194:195], v145 offset:1024
    ds_read_b64_tr_b16 a[208:209], v146 offset:0
    ds_read_b64_tr_b16 a[210:211], v147 offset:1024
    ds_read_b64_tr_b16 a[224:225], v148 offset:0
    ds_read_b64_tr_b16 a[226:227], v149 offset:1024
    ds_read_b64_tr_b16 a[240:241], v150 offset:0
    ds_read_b64_tr_b16 a[242:243], v151 offset:1024
    s_waitcnt lgkmcnt(0)
    s_add_u32 s39, s90, s62
    s_mov_b32 m0, s39
    s_add_u32 s62, s62, 4096
    s_and_b32 s62, s62, 0x7fff
    buffer_load_dwordx4 v76, s[52:55], s95 offen offset:0 nt lds
    buffer_load_dwordx4 v77, s[52:55], s95 offen offset:1024 nt lds
    buffer_load_dwordx4 v78, s[52:55], s95 offen offset:2048 nt lds
    buffer_load_dwordx4 v79, s[52:55], s95 offen offset:3072 nt lds
    s_add_u32 s95, s95, 16384
    s_add_u32 s39, s90, s62
    s_mov_b32 m0, s39
    s_add_u32 s62, s62, 4096
    s_and_b32 s62, s62, 0x7fff
    buffer_load_dwordx4 v76, s[52:55], s95 offen offset:0 nt lds
    buffer_load_dwordx4 v77, s[52:55], s95 offen offset:1024 nt lds
    buffer_load_dwordx4 v78, s[52:55], s95 offen offset:2048 nt lds
    buffer_load_dwordx4 v79, s[52:55], s95 offen offset:3072 nt lds
    s_add_u32 s95, s95, 16384
    s_waitcnt vmcnt(24)
    ds_read_b64_tr_b16 a[132:133], v136 offset:8192
    ds_read_b64_tr_b16 a[134:135], v137 offset:9216
    ds_read_b64_tr_b16 a[148:149], v138 offset:8192
    ds_read_b64_tr_b16 a[150:151], v139 offset:9216
    ds_read_b64_tr_b16 a[164:165], v140 offset:8192
    ds_read_b64_tr_b16 a[166:167], v141 offset:9216
    ds_read_b64_tr_b16 a[180:181], v142 offset:8192
    ds_read_b64_tr_b16 a[182:183], v143 offset:9216
    ds_read_b64_tr_b16 a[196:197], v144 offset:8192
    ds_read_b64_tr_b16 a[198:199], v145 offset:9216
    ds_read_b64_tr_b16 a[212:213], v146 offset:8192
    ds_read_b64_tr_b16 a[214:215], v147 offset:9216
    ds_read_b64_tr_b16 a[228:229], v148 offset:8192
    ds_read_b64_tr_b16 a[230:231], v149 offset:9216
    ds_read_b64_tr_b16 a[244:245], v150 offset:8192
    ds_read_b64_tr_b16 a[246:247], v151 offset:9216
    s_waitcnt lgkmcnt(0)
    s_add_u32 s39, s90, s62
    s_mov_b32 m0, s39
    s_add_u32 s62, s62, 4096
    s_and_b32 s62, s62, 0x7fff
    buffer_load_dwordx4 v76, s[52:55], s95 offen offset:0 nt lds
    buffer_load_dwordx4 v77, s[52:55], s95 offen offset:1024 nt lds
    buffer_load_dwordx4 v78, s[52:55], s95 offen offset:2048 nt lds
    buffer_load_dwordx4 v79, s[52:55], s95 offen offset:3072 nt lds
    s_add_u32 s95, s95, 16384
    s_add_u32 s39, s90, s62
    s_mov_b32 m0, s39
    s_add_u32 s62, s62, 4096
    s_and_b32 s62, s62, 0x7fff
    buffer_load_dwordx4 v76, s[52:55], s95 offen offset:0 nt lds
    buffer_load_dwordx4 v77, s[52:55], s95 offen offset:1024 nt lds
    buffer_load_dwordx4 v78, s[52:55], s95 offen offset:2048 nt lds
    buffer_load_dwordx4 v79, s[52:55], s95 offen offset:3072 nt lds
    s_add_u32 s95, s95, 16384
    s_waitcnt vmcnt(24)
    ds_read_b64_tr_b16 a[136:137], v136 offset:16384
    ds_read_b64_tr_b16 a[138:139], v137 offset:17408
    ds_read_b64_tr_b16 a[152:153], v138 offset:16384
    ds_read_b64_tr_b16 a[154:155], v139 offset:17408
    ds_read_b64_tr_b16 a[168:169], v140 offset:16384
    ds_read_b64_tr_b16 a[170:171], v141 offset:17408
    ds_read_b64_tr_b16 a[184:185], v142 offset:16384
    ds_read_b64_tr_b16 a[186:187], v143 offset:17408
    ds_read_b64_tr_b16 a[200:201], v144 offset:16384
    ds_read_b64_tr_b16 a[202:203], v145 offset:17408
    ds_read_b64_tr_b16 a[216:217], v146 offset:16384
    ds_read_b64_tr_b16 a[218:219], v147 offset:17408
    ds_read_b64_tr_b16 a[232:233], v148 offset:16384
    ds_read_b64_tr_b16 a[234:235], v149 offset:17408
    ds_read_b64_tr_b16 a[248:249], v150 offset:16384
    ds_read_b64_tr_b16 a[250:251], v151 offset:17408
    s_waitcnt lgkmcnt(0)
    s_add_u32 s39, s90, s62
    s_mov_b32 m0, s39
    s_add_u32 s62, s62, 4096
    s_and_b32 s62, s62, 0x7fff
    buffer_load_dwordx4 v76, s[52:55], s95 offen offset:0 nt lds
    buffer_load_dwordx4 v77, s[52:55], s95 offen offset:1024 nt lds
    buffer_load_dwordx4 v78, s[52:55], s95 offen offset:2048 nt lds
    buffer_load_dwordx4 v79, s[52:55], s95 offen offset:3072 nt lds
    s_add_u32 s95, s95, 16384
    s_add_u32 s39, s90, s62
    s_mov_b32 m0, s39
    s_add_u32 s62, s62, 4096
    s_and_b32 s62, s62, 0x7fff
    buffer_load_dwordx4 v76, s[52:55], s95 offen offset:0 nt lds
    buffer_load_dwordx4 v77, s[52:55], s95 offen offset:1024 nt lds
    buffer_load_dwordx4 v78, s[52:55], s95 offen offset:2048 nt lds
    buffer_load_dwordx4 v79, s[52:55], s95 offen offset:3072 nt lds
    s_add_u32 s95, s95, 16384
    s_waitcnt vmcnt(24)
    ds_read_b64_tr_b16 a[140:141], v136 offset:24576
    ds_read_b64_tr_b16 a[142:143], v137 offset:25600
    ds_read_b64_tr_b16 a[156:157], v138 offset:24576
    ds_read_b64_tr_b16 a[158:159], v139 offset:25600
    ds_read_b64_tr_b16 a[172:173], v140 offset:24576
    ds_read_b64_tr_b16 a[174:175], v141 offset:25600
    ds_read_b64_tr_b16 a[188:189], v142 offset:24576
    ds_read_b64_tr_b16 a[190:191], v143 offset:25600
    ds_read_b64_tr_b16 a[204:205], v144 offset:24576
    ds_read_b64_tr_b16 a[206:207], v145 offset:25600
    ds_read_b64_tr_b16 a[220:221], v146 offset:24576
    ds_read_b64_tr_b16 a[222:223], v147 offset:25600
    ds_read_b64_tr_b16 a[236:237], v148 offset:24576
    ds_read_b64_tr_b16 a[238:239], v149 offset:25600
    ds_read_b64_tr_b16 a[252:253], v150 offset:24576
    ds_read_b64_tr_b16 a[254:255], v151 offset:25600
    s_waitcnt lgkmcnt(0)
    s_add_u32 s39, s90, s62
    s_mov_b32 m0, s39
    s_add_u32 s62, s62, 4096
    s_and_b32 s62, s62, 0x7fff
    buffer_load_dwordx4 v76, s[52:55], s95 offen offset:0 nt lds
    buffer_load_dwordx4 v77, s[52:55], s95 offen offset:1024 nt lds
    buffer_load_dwordx4 v78, s[52:55], s95 offen offset:2048 nt lds
    buffer_load_dwordx4 v79, s[52:55], s95 offen offset:3072 nt lds
    s_add_u32 s95, s95, 16384
    s_add_u32 s39, s90, s62
    s_mov_b32 m0, s39
    s_add_u32 s62, s62, 4096
    s_and_b32 s62, s62, 0x7fff
    buffer_load_dwordx4 v76, s[52:55], s95 offen offset:0 nt lds
    buffer_load_dwordx4 v77, s[52:55], s95 offen offset:1024 nt lds
    buffer_load_dwordx4 v78, s[52:55], s95 offen offset:2048 nt lds
    buffer_load_dwordx4 v79, s[52:55], s95 offen offset:3072 nt lds
    s_add_u32 s95, s95, 16384
    s_mov_b32 s52, s6
    s_and_b32 s53, s7, 0xffff
    s_mov_b32 s54, 16777216
    s_mov_b32 s55, 0x20000
    s_lshl_b32 s95, s32, 19
    s_lshl_b32 s38, s34, 8
    s_add_u32 s95, s95, s38
    s_waitcnt vmcnt(24)
    ds_read_b64_tr_b16 a[0:1], v136 offset:0
    ds_read_b64_tr_b16 a[2:3], v137 offset:1024
    ds_read_b64_tr_b16 a[16:17], v138 offset:0
    ds_read_b64_tr_b16 a[18:19], v139 offset:1024
    ds_read_b64_tr_b16 a[32:33], v140 offset:0
    ds_read_b64_tr_b16 a[34:35], v141 offset:1024
    ds_read_b64_tr_b16 a[48:49], v142 offset:0
    ds_read_b64_tr_b16 a[50:51], v143 offset:1024
    ds_read_b64_tr_b16 a[64:65], v144 offset:0
    ds_read_b64_tr_b16 a[66:67], v145 offset:1024
    ds_read_b64_tr_b16 a[80:81], v146 offset:0
    ds_read_b64_tr_b16 a[82:83], v147 offset:1024
    ds_read_b64_tr_b16 a[96:97], v148 offset:0
    ds_read_b64_tr_b16 a[98:99], v149 offset:1024
    ds_read_b64_tr_b16 a[112:113], v150 offset:0
    ds_read_b64_tr_b16 a[114:115], v151 offset:1024
    s_waitcnt lgkmcnt(0)
    s_add_u32 s39, s90, s62
    s_mov_b32 m0, s39
    s_add_u32 s62, s62, 4096
    s_and_b32 s62, s62, 0x7fff
    buffer_load_dwordx4 v76, s[52:55], s95 offen offset:0 nt lds
    buffer_load_dwordx4 v77, s[52:55], s95 offen offset:1024 nt lds
    buffer_load_dwordx4 v78, s[52:55], s95 offen offset:2048 nt lds
    buffer_load_dwordx4 v79, s[52:55], s95 offen offset:3072 nt lds
    s_add_u32 s95, s95, 16384
    s_add_u32 s39, s90, s62
    s_mov_b32 m0, s39
    s_add_u32 s62, s62, 4096
    s_and_b32 s62, s62, 0x7fff
    buffer_load_dwordx4 v76, s[52:55], s95 offen offset:0 nt lds
    buffer_load_dwordx4 v77, s[52:55], s95 offen offset:1024 nt lds
    buffer_load_dwordx4 v78, s[52:55], s95 offen offset:2048 nt lds
    buffer_load_dwordx4 v79, s[52:55], s95 offen offset:3072 nt lds
    s_add_u32 s95, s95, 16384
    s_waitcnt vmcnt(24)
    ds_read_b64_tr_b16 a[4:5], v136 offset:8192
    ds_read_b64_tr_b16 a[6:7], v137 offset:9216
    ds_read_b64_tr_b16 a[20:21], v138 offset:8192
    ds_read_b64_tr_b16 a[22:23], v139 offset:9216
    ds_read_b64_tr_b16 a[36:37], v140 offset:8192
    ds_read_b64_tr_b16 a[38:39], v141 offset:9216
    ds_read_b64_tr_b16 a[52:53], v142 offset:8192
    ds_read_b64_tr_b16 a[54:55], v143 offset:9216
    ds_read_b64_tr_b16 a[68:69], v144 offset:8192
    ds_read_b64_tr_b16 a[70:71], v145 offset:9216
    ds_read_b64_tr_b16 a[84:85], v146 offset:8192
    ds_read_b64_tr_b16 a[86:87], v147 offset:9216
    ds_read_b64_tr_b16 a[100:101], v148 offset:8192
    ds_read_b64_tr_b16 a[102:103], v149 offset:9216
    ds_read_b64_tr_b16 a[116:117], v150 offset:8192
    ds_read_b64_tr_b16 a[118:119], v151 offset:9216
    s_waitcnt lgkmcnt(0)
    s_add_u32 s39, s90, s62
    s_mov_b32 m0, s39
    s_add_u32 s62, s62, 4096
    s_and_b32 s62, s62, 0x7fff
    buffer_load_dwordx4 v76, s[52:55], s95 offen offset:0 nt lds
    buffer_load_dwordx4 v77, s[52:55], s95 offen offset:1024 nt lds
    buffer_load_dwordx4 v78, s[52:55], s95 offen offset:2048 nt lds
    buffer_load_dwordx4 v79, s[52:55], s95 offen offset:3072 nt lds
    s_add_u32 s95, s95, 16384
    s_add_u32 s39, s90, s62
    s_mov_b32 m0, s39
    s_add_u32 s62, s62, 4096
    s_and_b32 s62, s62, 0x7fff
    buffer_load_dwordx4 v76, s[52:55], s95 offen offset:0 nt lds
    buffer_load_dwordx4 v77, s[52:55], s95 offen offset:1024 nt lds
    buffer_load_dwordx4 v78, s[52:55], s95 offen offset:2048 nt lds
    buffer_load_dwordx4 v79, s[52:55], s95 offen offset:3072 nt lds
    s_add_u32 s95, s95, 16384
    s_waitcnt vmcnt(24)
    ds_read_b64_tr_b16 a[8:9], v136 offset:16384
    ds_read_b64_tr_b16 a[10:11], v137 offset:17408
    ds_read_b64_tr_b16 a[24:25], v138 offset:16384
    ds_read_b64_tr_b16 a[26:27], v139 offset:17408
    ds_read_b64_tr_b16 a[40:41], v140 offset:16384
    ds_read_b64_tr_b16 a[42:43], v141 offset:17408
    ds_read_b64_tr_b16 a[56:57], v142 offset:16384
    ds_read_b64_tr_b16 a[58:59], v143 offset:17408
    ds_read_b64_tr_b16 a[72:73], v144 offset:16384
    ds_read_b64_tr_b16 a[74:75], v145 offset:17408
    ds_read_b64_tr_b16 a[88:89], v146 offset:16384
    ds_read_b64_tr_b16 a[90:91], v147 offset:17408
    ds_read_b64_tr_b16 a[104:105], v148 offset:16384
    ds_read_b64_tr_b16 a[106:107], v149 offset:17408
    ds_read_b64_tr_b16 a[120:121], v150 offset:16384
    ds_read_b64_tr_b16 a[122:123], v151 offset:17408
    s_waitcnt lgkmcnt(0)
    s_add_u32 s39, s90, s62
    s_mov_b32 m0, s39
    s_add_u32 s62, s62, 4096
    s_and_b32 s62, s62, 0x7fff
    buffer_load_dwordx4 v76, s[52:55], s95 offen offset:0 nt lds
    buffer_load_dwordx4 v77, s[52:55], s95 offen offset:1024 nt lds
    buffer_load_dwordx4 v78, s[52:55], s95 offen offset:2048 nt lds
    buffer_load_dwordx4 v79, s[52:55], s95 offen offset:3072 nt lds
    s_add_u32 s95, s95, 16384
    s_add_u32 s39, s90, s62
    s_mov_b32 m0, s39
    s_add_u32 s62, s62, 4096
    s_and_b32 s62, s62, 0x7fff
    buffer_load_dwordx4 v76, s[52:55], s95 offen offset:0 nt lds
    buffer_load_dwordx4 v77, s[52:55], s95 offen offset:1024 nt lds
    buffer_load_dwordx4 v78, s[52:55], s95 offen offset:2048 nt lds
    buffer_load_dwordx4 v79, s[52:55], s95 offen offset:3072 nt lds
    s_add_u32 s95, s95, 16384
    s_waitcnt vmcnt(24)
    ds_read_b64_tr_b16 a[12:13], v136 offset:24576
    ds_read_b64_tr_b16 a[14:15], v137 offset:25600
    ds_read_b64_tr_b16 a[28:29], v138 offset:24576
    ds_read_b64_tr_b16 a[30:31], v139 offset:25600
    ds_read_b64_tr_b16 a[44:45], v140 offset:24576
    ds_read_b64_tr_b16 a[46:47], v141 offset:25600
    ds_read_b64_tr_b16 a[60:61], v142 offset:24576
    ds_read_b64_tr_b16 a[62:63], v143 offset:25600
    ds_read_b64_tr_b16 a[76:77], v144 offset:24576
    ds_read_b64_tr_b16 a[78:79], v145 offset:25600
    ds_read_b64_tr_b16 a[92:93], v146 offset:24576
    ds_read_b64_tr_b16 a[94:95], v147 offset:25600
    ds_read_b64_tr_b16 a[108:109], v148 offset:24576
    ds_read_b64_tr_b16 a[110:111], v149 offset:25600
    ds_read_b64_tr_b16 a[124:125], v150 offset:24576
    ds_read_b64_tr_b16 a[126:127], v151 offset:25600
    s_waitcnt lgkmcnt(0)
    s_mov_b32 s86, 98304
    buffer_load_dword v7, v101, s[48:51], s86 offen sc1
    s_add_u32 s39, s90, s62
    s_mov_b32 m0, s39
    s_add_u32 s62, s62, 4096
    s_and_b32 s62, s62, 0x7fff
    buffer_load_dwordx4 v76, s[52:55], s95 offen offset:0 nt lds
    buffer_load_dwordx4 v77, s[52:55], s95 offen offset:1024 nt lds
    buffer_load_dwordx4 v78, s[52:55], s95 offen offset:2048 nt lds
    buffer_load_dwordx4 v79, s[52:55], s95 offen offset:3072 nt lds
    s_add_u32 s95, s95, 16384
    s_add_u32 s39, s90, s62
    s_mov_b32 m0, s39
    s_add_u32 s62, s62, 4096
    s_and_b32 s62, s62, 0x7fff
    buffer_load_dwordx4 v76, s[52:55], s95 offen offset:0 nt lds
    v_mov_b32 v136, 0
    v_mov_b32 v137, 0
    v_mov_b32 v138, 0
    v_mov_b32 v139, 0
    v_mov_b32 v140, 0
    v_mov_b32 v141, 0
    v_mov_b32 v142, 0
    v_mov_b32 v143, 0
    v_mov_b32 v144, 0
    v_mov_b32 v145, 0
    v_mov_b32 v146, 0
    v_mov_b32 v147, 0
    v_mov_b32 v148, 0
    v_mov_b32 v149, 0
    v_mov_b32 v150, 0
    v_mov_b32 v151, 0
    v_mov_b32 v152, 0
    v_mov_b32 v153, 0
    v_mov_b32 v154, 0
    v_mov_b32 v155, 0
    v_mov_b32 v156, 0
    v_mov_b32 v157, 0
    v_mov_b32 v158, 0
    v_mov_b32 v159, 0
    v_mov_b32 v160, 0
    v_mov_b32 v161, 0
    v_mov_b32 v162, 0
    v_mov_b32 v163, 0
    v_mov_b32 v164, 0
    v_mov_b32 v165, 0
    v_mov_b32 v166, 0
    v_mov_b32 v167, 0
    v_mov_b32 v168, 0
    v_mov_b32 v169, 0
    v_mov_b32 v170, 0
    v_mov_b32 v171, 0
    v_mov_b32 v172, 0
    v_mov_b32 v173, 0
    v_mov_b32 v174, 0
    v_mov_b32 v175, 0
    v_mov_b32 v176, 0
    v_mov_b32 v177, 0
    v_mov_b32 v178, 0
    v_mov_b32 v179, 0
    v_mov_b32 v180, 0
    v_mov_b32 v181, 0
    v_mov_b32 v182, 0
    v_mov_b32 v183, 0
    v_mov_b32 v184, 0
    v_mov_b32 v185, 0
    v_mov_b32 v186, 0
    v_mov_b32 v187, 0
    v_mov_b32 v188, 0
    v_mov_b32 v189, 0
    v_mov_b32 v190, 0
    v_mov_b32 v191, 0
    v_mov_b32 v192, 0
    v_mov_b32 v193, 0
    v_mov_b32 v194, 0
    v_mov_b32 v195, 0
    v_mov_b32 v196, 0
    v_mov_b32 v197, 0
    v_mov_b32 v198, 0
    v_mov_b32 v199, 0
    v_mov_b32 v90, 0xff7f0000
    s_mov_b32 s93, 0
    v_mov_b32 v102, 0
    v_mov_b32 v103, 0
    s_mov_b32 s60, s83
    s_mov_b32 s61, s83
    v_add_u32 v4, s85, v80
    v_xor_b32 v82, 0, v4
    v_xor_b32 v83, 32, v4
    v_xor_b32 v84, 64, v4
    v_xor_b32 v85, 96, v4
    v_xor_b32 v86, 128, v4
    v_xor_b32 v87, 160, v4
    v_xor_b32 v88, 192, v4
    v_xor_b32 v89, 224, v4
    v_add_u32 v80, s90, v80
    v_add_u32 v81, s90, v81
    s_lshr_b32 s38, s32, 3
    s_lshl_b32 s38, s38, 15
    s_add_u32 s36, s38, 393216
    s_lshl_b32 s38, s34, 8
    s_add_u32 s36, s38, s36
    s_waitcnt vmcnt(5)
L_fcheck_16:
    v_cmp_ne_u32 vcc, s68, v7
    s_cbranch_vccz L_fok_17
    s_sleep 2
    s_mov_b32 s86, 98304
    buffer_load_dword v7, v101, s[48:51], s86 offen sc1
    s_waitcnt vmcnt(0)
    s_sub_u32 s84, s84, 1
    s_cmp_lg_u32 s84, 0
    s_cbranch_scc1 L_fcheck_16
    s_branch L_end
L_fok_17:
    buffer_load_dwordx4 v[20:23], v9, s[48:51], s36 offen sc1
    s_add_u32 s36, s36, 4096
    buffer_load_dwordx4 v[24:27], v9, s[48:51], s36 offen sc1
    s_add_u32 s36, s36, 4096
    buffer_load_dwordx4 v[28:31], v9, s[48:51], s36 offen sc1
    s_add_u32 s36, s36, 4096
    buffer_load_dwordx4 v[32:35], v9, s[48:51], s36 offen sc1
    s_add_u32 s36, s36, 4096
    buffer_load_dwordx4 v[36:39], v9, s[48:51], s36 offen sc1
    s_add_u32 s36, s36, 4096
    buffer_load_dwordx4 v[40:43], v9, s[48:51], s36 offen sc1
    s_add_u32 s36, s36, 4096
    buffer_load_dwordx4 v[44:47], v9, s[48:51], s36 offen sc1
    s_add_u32 s36, s36, 4096
    buffer_load_dwordx4 v[48:51], v9, s[48:51], s36 offen sc1
    s_waitcnt vmcnt(7)
    ds_write_b128 v96, v[20:23] offset:0
    s_waitcnt vmcnt(6)
    ds_write_b128 v97, v[24:27] offset:1024
    s_waitcnt vmcnt(5)
    ds_write_b128 v98, v[28:31] offset:2048
    s_waitcnt vmcnt(4)
    ds_write_b128 v99, v[32:35] offset:3072
    s_waitcnt vmcnt(3)
    ds_write_b128 v96, v[36:39] offset:4096
    s_waitcnt vmcnt(2)
    ds_write_b128 v97, v[40:43] offset:5120
    s_waitcnt vmcnt(1)
    ds_write_b128 v98, v[44:47] offset:6144
    s_waitcnt vmcnt(0)
    ds_write_b128 v99, v[48:51] offset:7168
    s_waitcnt lgkmcnt(0)
    ds_read_b128 v[104:107], v82
    ds_read_b128 v[108:111], v83
    ds_read_b128 v[112:115], v84
    ds_read_b128 v[116:119], v85
    ds_read_b128 v[120:123], v86
    ds_read_b128 v[124:127], v87
    ds_read_b128 v[128:131], v88
    ds_read_b128 v[132:135], v89
    v_xor_b32 v82, 0, v80
    ds_read_b128 v[216:219], v82
    v_xor_b32 v83, 32, v80
    ds_read_b128 v[220:223], v83
    v_xor_b32 v84, 64, v80
    ds_read_b128 v[224:227], v84
    v_xor_b32 v85, 96, v80
    ds_read_b128 v[228:231], v85
    v_xor_b32 v86, 128, v80
    ds_read_b128 v[232:235], v86
    v_xor_b32 v87, 160, v80
    ds_read_b128 v[236:239], v87
    v_xor_b32 v88, 192, v80
    ds_read_b128 v[240:243], v88
    v_xor_b32 v89, 224, v80
    ds_read_b128 v[244:247], v89
L_att:
    v_add_u32 v4, s94, v81
    s_waitcnt lgkmcnt(0)
    v_mfma_f32_32x32x16_bf16 v[200:215], v[216:219], v[104:107], 0
    v_xor_b32 v82, 0, v4
    ds_read_b64_tr_b16 v[20:21], v82 offset:0
    ds_read_b64_tr_b16 v[24:25], v82 offset:4096
    buffer_load_dwordx4 v77, s[52:55], s95 offen offset:1024 nt lds
    v_mfma_f32_32x32x16_bf16 v[200:215], v[220:223], v[108:111], v[200:215]
    v_xor_b32 v83, 32, v4
    ds_read_b64_tr_b16 v[22:23], v83 offset:2048
    ds_read_b64_tr_b16 v[26:27], v83 offset:6144
    v_mfma_f32_32x32x16_bf16 v[200:215], v[224:227], v[112:115], v[200:215]
    v_xor_b32 v84, 64, v4
    ds_read_b64_tr_b16 v[28:29], v84 offset:0
    ds_read_b64_tr_b16 v[32:33], v84 offset:4096
    v_mfma_f32_32x32x16_bf16 v[200:215], v[228:231], v[116:119], v[200:215]
    v_xor_b32 v85, 96, v4
    ds_read_b64_tr_b16 v[30:31], v85 offset:2048
    ds_read_b64_tr_b16 v[34:35], v85 offset:6144
    v_mfma_f32_32x32x16_bf16 v[200:215], v[232:235], v[120:123], v[200:215]
    v_xor_b32 v86, 128, v4
    ds_read_b64_tr_b16 v[36:37], v86 offset:0
    ds_read_b64_tr_b16 v[40:41], v86 offset:4096
    buffer_load_dwordx4 v78, s[52:55], s95 offen offset:2048 nt lds
    v_mfma_f32_32x32x16_bf16 v[200:215], v[236:239], v[124:127], v[200:215]
    v_xor_b32 v87, 160, v4
    ds_read_b64_tr_b16 v[38:39], v87 offset:2048
    ds_read_b64_tr_b16 v[42:43], v87 offset:6144
    v_mfma_f32_32x32x16_bf16 v[200:215], v[240:243], v[128:131], v[200:215]
    v_xor_b32 v88, 192, v4
    ds_read_b64_tr_b16 v[44:45], v88 offset:0
    ds_read_b64_tr_b16 v[48:49], v88 offset:4096
    v_mfma_f32_32x32x16_bf16 v[200:215], v[244:247], v[132:135], v[200:215]
    v_xor_b32 v89, 224, v4
    ds_read_b64_tr_b16 v[46:47], v89 offset:2048
    ds_read_b64_tr_b16 v[50:51], v89 offset:6144
    buffer_load_dwordx4 v79, s[52:55], s95 offen offset:3072 nt lds
    s_add_u32 s95, s95, 16384
    v_xor_b32 v5, 0x2000, v94
    v_xor_b32 v6, 0x4000, v94
    v_xor_b32 v7, 0x6000, v94
    s_cmp_lg_u32 s93, 12
    s_cbranch_scc1 L_noswitch_18
    s_mov_b32 s52, s24
    s_and_b32 s53, s25, 0xffff
    s_mov_b32 s54, 4194304
    s_mov_b32 s55, 0x20000
    s_mov_b32 s95, s63
L_noswitch_18:
    s_nop 1
    ds_write_b128 v94, v[200:203] offset:0
    ds_write_b128 v94, v[204:207] offset:1024
    ds_write_b128 v94, v[208:211] offset:2048
    ds_write_b128 v94, v[212:215] offset:3072
    s_waitcnt lgkmcnt(0)
    s_barrier
    ds_read_b128 v[60:63], v5 offset:0
    ds_read_b128 v[216:219], v6 offset:0
    ds_read_b128 v[232:235], v7 offset:0
    ds_read_b128 v[64:67], v5 offset:1024
    ds_read_b128 v[220:223], v6 offset:1024
    ds_read_b128 v[236:239], v7 offset:1024
    ds_read_b128 v[68:71], v5 offset:2048
    ds_read_b128 v[224:227], v6 offset:2048
    ds_read_b128 v[240:243], v7 offset:2048
    ds_read_b128 v[72:75], v5 offset:3072
    ds_read_b128 v[228:231], v6 offset:3072
    ds_read_b128 v[244:247], v7 offset:3072
    v_xor_b32 v94, 0x1000, v94
    s_add_u32 s39, s90, s62
    s_mov_b32 m0, s39
    s_add_u32 s62, s62, 4096
    s_and_b32 s62, s62, 0x7fff
    buffer_load_dwordx4 v76, s[52:55], s95 offen offset:0 nt lds
    s_add_u32 s94, s94, 8192
    s_and_b32 s94, s94, 0x7fff
    s_waitcnt lgkmcnt(9)
    v_pk_add_f32 v[200:201], v[200:201], v[60:61]
    v_pk_add_f32 v[216:217], v[216:217], v[232:233]
    v_pk_add_f32 v[202:203], v[202:203], v[62:63]
    v_pk_add_f32 v[218:219], v[218:219], v[234:235]
    v_pk_add_f32 v[200:201], v[200:201], v[216:217]
    v_pk_add_f32 v[202:203], v[202:203], v[218:219]
    s_waitcnt lgkmcnt(6)
    v_pk_add_f32 v[204:205], v[204:205], v[64:65]
    v_pk_add_f32 v[220:221], v[220:221], v[236:237]
    v_pk_add_f32 v[206:207], v[206:207], v[66:67]
    v_pk_add_f32 v[222:223], v[222:223], v[238:239]
    v_pk_add_f32 v[204:205], v[204:205], v[220:221]
    v_pk_add_f32 v[206:207], v[206:207], v[222:223]
    s_waitcnt lgkmcnt(3)
    v_pk_add_f32 v[208:209], v[208:209], v[68:69]
    v_pk_add_f32 v[224:225], v[224:225], v[240:241]
    v_pk_add_f32 v[210:211], v[210:211], v[70:71]
    v_pk_add_f32 v[226:227], v[226:227], v[242:243]
    v_pk_add_f32 v[208:209], v[208:209], v[224:225]
    v_pk_add_f32 v[210:211], v[210:211], v[226:227]
    s_waitcnt lgkmcnt(0)
    v_pk_add_f32 v[212:213], v[212:213], v[72:73]
    v_pk_add_f32 v[228:229], v[228:229], v[244:245]
    v_pk_add_f32 v[214:215], v[214:215], v[74:75]
    v_pk_add_f32 v[230:231], v[230:231], v[246:247]
    v_pk_add_f32 v[212:213], v[212:213], v[228:229]
    v_pk_add_f32 v[214:215], v[214:215], v[230:231]
    buffer_load_dwordx4 v77, s[52:55], s95 offen offset:1024 nt lds
    v_max_f32 v4, v200, v201
    v_max3_f32 v4, v4, v202, v203
    v_max3_f32 v4, v4, v204, v205
    v_max3_f32 v4, v4, v206, v207
    v_max3_f32 v4, v4, v208, v209
    v_max3_f32 v4, v4, v210, v211
    v_max3_f32 v4, v4, v212, v213
    v_max3_f32 v4, v4, v214, v215
    v_mov_b32 v5, v4
    s_nop 1
    v_permlane32_swap_b32 v4, v5
    v_max_f32 v4, v4, v5
    v_mul_f32 v4, s83, v4
    v_max_f32 v4, v4, v90
    v_sub_f32 v92, v90, v4
    v_exp_f32 v92, v92
    v_mov_b32 v90, v4
    v_pk_fma_f32 v[200:201], v[200:201], s[60:61], v[90:91] op_sel_hi:[1,1,0] neg_lo:[0,0,1] neg_hi:[0,0,1]
    v_pk_fma_f32 v[202:203], v[202:203], s[60:61], v[90:91] op_sel_hi:[1,1,0] neg_lo:[0,0,1] neg_hi:[0,0,1]
    v_pk_fma_f32 v[204:205], v[204:205], s[60:61], v[90:91] op_sel_hi:[1,1,0] neg_lo:[0,0,1] neg_hi:[0,0,1]
    v_pk_fma_f32 v[206:207], v[206:207], s[60:61], v[90:91] op_sel_hi:[1,1,0] neg_lo:[0,0,1] neg_hi:[0,0,1]
    v_pk_fma_f32 v[208:209], v[208:209], s[60:61], v[90:91] op_sel_hi:[1,1,0] neg_lo:[0,0,1] neg_hi:[0,0,1]
    v_pk_fma_f32 v[210:211], v[210:211], s[60:61], v[90:91] op_sel_hi:[1,1,0] neg_lo:[0,0,1] neg_hi:[0,0,1]
    v_pk_fma_f32 v[212:213], v[212:213], s[60:61], v[90:91] op_sel_hi:[1,1,0] neg_lo:[0,0,1] neg_hi:[0,0,1]
    v_pk_fma_f32 v[214:215], v[214:215], s[60:61], v[90:91] op_sel_hi:[1,1,0] neg_lo:[0,0,1] neg_hi:[0,0,1]
    v_exp_f32 v200, v200
    v_exp_f32 v201, v201
    v_exp_f32 v202, v202
    v_exp_f32 v203, v203
    v_exp_f32 v204, v204
    buffer_load_dwordx4 v78, s[52:55], s95 offen offset:2048 nt lds
    v_exp_f32 v205, v205
    v_exp_f32 v206, v206
    v_exp_f32 v207, v207
    v_exp_f32 v208, v208
    v_exp_f32 v209, v209
    v_exp_f32 v210, v210
    v_exp_f32 v211, v211
    v_exp_f32 v212, v212
    v_exp_f32 v213, v213
    v_exp_f32 v214, v214
    v_exp_f32 v215, v215
    v_add_u32 v4, s94, v80
    v_pk_mul_f32 v[102:103], v[102:103], v[92:93] op_sel_hi:[1,0]
    v_pk_mul_f32 v[136:137], v[136:137], v[92:93] op_sel_hi:[1,0]
    v_pk_mul_f32 v[138:139], v[138:139], v[92:93] op_sel_hi:[1,0]
    v_pk_mul_f32 v[140:141], v[140:141], v[92:93] op_sel_hi:[1,0]
    v_pk_mul_f32 v[142:143], v[142:143], v[92:93] op_sel_hi:[1,0]
    v_pk_mul_f32 v[144:145], v[144:145], v[92:93] op_sel_hi:[1,0]
    v_pk_mul_f32 v[146:147], v[146:147], v[92:93] op_sel_hi:[1,0]
    v_pk_mul_f32 v[148:149], v[148:149], v[92:93] op_sel_hi:[1,0]
    v_pk_mul_f32 v[150:151], v[150:151], v[92:93] op_sel_hi:[1,0]
    v_pk_mul_f32 v[152:153], v[152:153], v[92:93] op_sel_hi:[1,0]
    v_pk_mul_f32 v[154:155], v[154:155], v[92:93] op_sel_hi:[1,0]
    v_pk_mul_f32 v[156:157], v[156:157], v[92:93] op_sel_hi:[1,0]
    v_pk_mul_f32 v[158:159], v[158:159], v[92:93] op_sel_hi:[1,0]
    v_pk_mul_f32 v[160:161], v[160:161], v[92:93] op_sel_hi:[1,0]
    v_pk_mul_f32 v[162:163], v[162:163], v[92:93] op_sel_hi:[1,0]
    v_pk_mul_f32 v[164:165], v[164:165], v[92:93] op_sel_hi:[1,0]
    v_pk_mul_f32 v[166:167], v[166:167], v[92:93] op_sel_hi:[1,0]
    v_pk_mul_f32 v[168:169], v[168:169], v[92:93] op_sel_hi:[1,0]
    v_pk_mul_f32 v[170:171], v[170:171], v[92:93] op_sel_hi:[1,0]
    v_pk_mul_f32 v[172:173], v[172:173], v[92:93] op_sel_hi:[1,0]
    v_pk_mul_f32 v[174:175], v[174:175], v[92:93] op_sel_hi:[1,0]
    v_pk_mul_f32 v[176:177], v[176:177], v[92:93] op_sel_hi:[1,0]
    buffer_load_dwordx4 v79, s[52:55], s95 offen offset:3072 nt lds
    s_add_u32 s95, s95, 16384
    v_pk_mul_f32 v[178:179], v[178:179], v[92:93] op_sel_hi:[1,0]
    v_pk_mul_f32 v[180:181], v[180:181], v[92:93] op_sel_hi:[1,0]
    v_pk_mul_f32 v[182:183], v[182:183], v[92:93] op_sel_hi:[1,0]
    v_pk_mul_f32 v[184:185], v[184:185], v[92:93] op_sel_hi:[1,0]
    v_pk_mul_f32 v[186:187], v[186:187], v[92:93] op_sel_hi:[1,0]
    v_pk_mul_f32 v[188:189], v[188:189], v[92:93] op_sel_hi:[1,0]
    v_pk_mul_f32 v[190:191], v[190:191], v[92:93] op_sel_hi:[1,0]
    v_pk_mul_f32 v[192:193], v[192:193], v[92:93] op_sel_hi:[1,0]
    v_pk_mul_f32 v[194:195], v[194:195], v[92:93] op_sel_hi:[1,0]
    v_pk_mul_f32 v[196:197], v[196:197], v[92:93] op_sel_hi:[1,0]
    v_pk_mul_f32 v[198:199], v[198:199], v[92:93] op_sel_hi:[1,0]
    v_cvt_pk_bf16_f32 v52, v200, v201
    v_pk_add_f32 v[102:103], v[102:103], v[200:201]
    v_cvt_pk_bf16_f32 v53, v202, v203
    v_pk_add_f32 v[102:103], v[102:103], v[202:203]
    v_cvt_pk_bf16_f32 v54, v204, v205
    v_pk_add_f32 v[102:103], v[102:103], v[204:205]
    v_cvt_pk_bf16_f32 v55, v206, v207
    v_pk_add_f32 v[102:103], v[102:103], v[206:207]
    v_cvt_pk_bf16_f32 v56, v208, v209
    v_pk_add_f32 v[102:103], v[102:103], v[208:209]
    v_cvt_pk_bf16_f32 v57, v210, v211
    v_pk_add_f32 v[102:103], v[102:103], v[210:211]
    v_cvt_pk_bf16_f32 v58, v212, v213
    v_pk_add_f32 v[102:103], v[102:103], v[212:213]
    v_cvt_pk_bf16_f32 v59, v214, v215
    v_pk_add_f32 v[102:103], v[102:103], v[214:215]
    s_waitcnt vmcnt(20)
    v_mfma_f32_32x32x16_bf16 v[136:151], v[20:23], v[52:55], v[136:151]
    v_xor_b32 v82, 0, v4
    ds_read_b128 v[216:219], v82
    v_xor_b32 v83, 32, v4
    ds_read_b128 v[220:223], v83
    v_mfma_f32_32x32x16_bf16 v[152:167], v[28:31], v[52:55], v[152:167]
    v_xor_b32 v84, 64, v4
    ds_read_b128 v[224:227], v84
    v_xor_b32 v85, 96, v4
    ds_read_b128 v[228:231], v85
    v_mfma_f32_32x32x16_bf16 v[168:183], v[36:39], v[52:55], v[168:183]
    v_xor_b32 v86, 128, v4
    ds_read_b128 v[232:235], v86
    v_xor_b32 v87, 160, v4
    ds_read_b128 v[236:239], v87
    v_mfma_f32_32x32x16_bf16 v[184:199], v[44:47], v[52:55], v[184:199]
    v_xor_b32 v88, 192, v4
    ds_read_b128 v[240:243], v88
    v_xor_b32 v89, 224, v4
    ds_read_b128 v[244:247], v89
    v_mfma_f32_32x32x16_bf16 v[136:151], v[24:27], v[56:59], v[136:151]
    s_add_u32 s39, s90, s62
    s_mov_b32 m0, s39
    s_add_u32 s62, s62, 4096
    s_and_b32 s62, s62, 0x7fff
    buffer_load_dwordx4 v76, s[52:55], s95 offen offset:0 nt lds
    v_mfma_f32_32x32x16_bf16 v[152:167], v[32:35], v[56:59], v[152:167]
    v_mfma_f32_32x32x16_bf16 v[168:183], v[40:43], v[56:59], v[168:183]
    v_mfma_f32_32x32x16_bf16 v[184:199], v[48:51], v[56:59], v[184:199]
    s_add_u32 s93, s93, 1
    s_cmp_lt_u32 s93, 16
    s_cbranch_scc1 L_att
    v_add_f32 v91, v102, v103
    v_mov_b32 v5, v91
    s_nop 1
    v_permlane32_swap_b32 v91, v5
    v_add_f32 v91, v91, v5
    v_and_b32 v4, 31, v1
    v_lshlrev_b32 v5, 8, v4
    v_lshl_add_u32 v5, v3, 4, v5
    v_lshrrev_b32 v6, 5, v1
    v_lshl_add_u32 v5, v6, 3, v5
    v_add_u32 v5, s85, v5
    s_waitcnt lgkmcnt(0)
    s_barrier
    v_cvt_pk_bf16_f32 v20, v136, v137
    v_cvt_pk_bf16_f32 v21, v138, v139
    v_xor_b32 v82, 0, v5
    ds_write_b64 v82, v[20:21]
    v_cvt_pk_bf16_f32 v22, v140, v141
    v_cvt_pk_bf16_f32 v23, v142, v143
    v_xor_b32 v83, 16, v5
    ds_write_b64 v83, v[22:23]
    v_cvt_pk_bf16_f32 v24, v144, v145
    v_cvt_pk_bf16_f32 v25, v146, v147
    v_xor_b32 v84, 32, v5
    ds_write_b64 v84, v[24:25]
    v_cvt_pk_bf16_f32 v26, v148, v149
    v_cvt_pk_bf16_f32 v27, v150, v151
    v_xor_b32 v85, 48, v5
    ds_write_b64 v85, v[26:27]
    v_cvt_pk_bf16_f32 v28, v152, v153
    v_cvt_pk_bf16_f32 v29, v154, v155
    v_xor_b32 v86, 64, v5
    ds_write_b64 v86, v[28:29]
    v_cvt_pk_bf16_f32 v30, v156, v157
    v_cvt_pk_bf16_f32 v31, v158, v159
    v_xor_b32 v87, 80, v5
    ds_write_b64 v87, v[30:31]
    v_cvt_pk_bf16_f32 v32, v160, v161
    v_cvt_pk_bf16_f32 v33, v162, v163
    v_xor_b32 v88, 96, v5
    ds_write_b64 v88, v[32:33]
    v_cvt_pk_bf16_f32 v34, v164, v165
    v_cvt_pk_bf16_f32 v35, v166, v167
    v_xor_b32 v89, 112, v5
    ds_write_b64 v89, v[34:35]
    v_cvt_pk_bf16_f32 v36, v168, v169
    v_cvt_pk_bf16_f32 v37, v170, v171
    v_xor_b32 v82, 128, v5
    ds_write_b64 v82, v[36:37]
    v_cvt_pk_bf16_f32 v38, v172, v173
    v_cvt_pk_bf16_f32 v39, v174, v175
    v_xor_b32 v83, 144, v5
    ds_write_b64 v83, v[38:39]
    v_cvt_pk_bf16_f32 v40, v176, v177
    v_cvt_pk_bf16_f32 v41, v178, v179
    v_xor_b32 v84, 160, v5
    ds_write_b64 v84, v[40:41]
    v_cvt_pk_bf16_f32 v42, v180, v181
    v_cvt_pk_bf16_f32 v43, v182, v183
    v_xor_b32 v85, 176, v5
    ds_write_b64 v85, v[42:43]
    v_cvt_pk_bf16_f32 v44, v184, v185
    v_cvt_pk_bf16_f32 v45, v186, v187
    v_xor_b32 v86, 192, v5
    ds_write_b64 v86, v[44:45]
    v_cvt_pk_bf16_f32 v46, v188, v189
    v_cvt_pk_bf16_f32 v47, v190, v191
    v_xor_b32 v87, 208, v5
    ds_write_b64 v87, v[46:47]
    v_cvt_pk_bf16_f32 v48, v192, v193
    v_cvt_pk_bf16_f32 v49, v194, v195
    v_xor_b32 v88, 224, v5
    ds_write_b64 v88, v[48:49]
    v_cvt_pk_bf16_f32 v50, v196, v197
    v_cvt_pk_bf16_f32 v51, v198, v199
    v_xor_b32 v89, 240, v5
    ds_write_b64 v89, v[50:51]
    v_xor_b32 v6, v3, v2
    v_lshlrev_b32 v6, 4, v6
    v_lshl_add_u32 v6, v2, 8, v6
    v_add_u32 v6, s85, v6
    v_xor_b32 v82, 0, v6
    v_xor_b32 v83, 64, v6
    v_xor_b32 v84, 128, v6
    v_xor_b32 v85, 192, v6
    v_lshlrev_b32 v7, 4, v3
    v_lshl_add_u32 v7, v2, 15, v7
    s_lshl_b32 s38, s32, 10
    s_add_u32 s36, s38, 2097152
    s_lshl_b32 s38, s34, 8
    s_add_u32 s36, s38, s36
    s_waitcnt lgkmcnt(0)
    ds_read_b128 v[200:203], v82 offset:0
    ds_read_b128 v[204:207], v83 offset:1024
    ds_read_b128 v[208:211], v84 offset:2048
    ds_read_b128 v[212:215], v85 offset:3072
    ds_read_b128 v[216:219], v82 offset:4096
    ds_read_b128 v[220:223], v83 offset:5120
    ds_read_b128 v[224:227], v84 offset:6144
    ds_read_b128 v[228:231], v85 offset:7168
    v_lshlrev_b32 v4, 3, v4
    s_lshl_b32 s38, s32, 8
    s_add_u32 s37, s38, 163840
    s_lshl_b32 s38, s34, 13
    s_add_u32 s37, s38, s37
    s_mov_b32 exec_lo, 0xffffffff
    s_mov_b32 exec_hi, 0x0
    buffer_store_dwordx2 v[90:91], v4, s[48:51], s37 offen sc1
    s_mov_b64 exec, -1
    s_waitcnt lgkmcnt(7)
    buffer_store_dwordx4 v[200:203], v7, s[48:51], s36 offen sc1
    s_add_u32 s36, s36, 131072
    s_waitcnt lgkmcnt(6)
    buffer_store_dwordx4 v[204:207], v7, s[48:51], s36 offen sc1
    s_add_u32 s36, s36, 131072
    s_waitcnt lgkmcnt(5)
    buffer_store_dwordx4 v[208:211], v7, s[48:51], s36 offen sc1
    s_add_u32 s36, s36, 131072
    s_waitcnt lgkmcnt(4)
    buffer_store_dwordx4 v[212:215], v7, s[48:51], s36 offen sc1
    s_add_u32 s36, s36, 131072
    s_waitcnt lgkmcnt(3)
    buffer_store_dwordx4 v[216:219], v7, s[48:51], s36 offen sc1
    s_add_u32 s36, s36, 131072
    s_waitcnt lgkmcnt(2)
    buffer_store_dwordx4 v[220:223], v7, s[48:51], s36 offen sc1
    s_add_u32 s36, s36, 131072
    s_waitcnt lgkmcnt(1)
    buffer_store_dwordx4 v[224:227], v7, s[48:51], s36 offen sc1
    s_add_u32 s36, s36, 131072
    s_waitcnt lgkmcnt(0)
    buffer_store_dwordx4 v[228:231], v7, s[48:51], s36 offen sc1
    buffer_load_dwordx4 v77, s[52:55], s95 offen offset:1024 nt lds
    buffer_load_dwordx4 v78, s[52:55], s95 offen offset:2048 nt lds
    buffer_load_dwordx4 v79, s[52:55], s95 offen offset:3072 nt lds
    s_add_u32 s95, s95, 16384
    v_and_b32 v4, 3, v3
    v_lshrrev_b32 v5, 2, v3
    v_lshlrev_b32 v6, 4, v2
    v_add_u32 v6, 135168, v6
    s_movk_i32 s36, 320
    v_cmp_eq_u32 vcc, 0, v5
    s_nop 1
    v_cndmask_b32 v112, 4, v4, vcc
    v_mad_u32_u24 v112, v112, s36, v6
    v_cmp_eq_u32 vcc, 1, v5
    s_nop 1
    v_cndmask_b32 v113, 4, v4, vcc
    v_mad_u32_u24 v113, v113, s36, v6
    v_cmp_eq_u32 vcc, 2, v5
    s_nop 1
    v_cndmask_b32 v114, 4, v4, vcc
    v_mad_u32_u24 v114, v114, s36, v6
    v_cmp_eq_u32 vcc, 3, v5
    s_nop 1
    v_cndmask_b32 v115, 4, v4, vcc
    v_mad_u32_u24 v115, v115, s36, v6
    s_lshl_b32 s38, s34, 16
    s_add_u32 s36, s38, 0
    s_lshl_b32 s38, s32, 8
    s_add_u32 s36, s38, s36
    v_lshlrev_b32 v77, 4, v3
    v_lshl_add_u32 v77, v2, 13, v77
    v_add_u32 v77, s36, v77
    s_lshl_b32 s38, s32, 13
    s_add_u32 s36, s38, 0
    s_lshl_b32 s38, s34, 6
    s_add_u32 s36, s38, s36
    v_lshrrev_b32 v5, 2, v1
    v_lshlrev_b32 v5, 8, v5
    v_lshl_add_u32 v5, v4, 4, v5
    v_add_u32 v78, s36, v5
    s_lshr_b32 s36, s32, 2
    s_lshl_b32 s36, s36, 7
    s_lshl_b32 s38, s34, 5
    s_add_u32 s36, s36, s38
    s_and_b32 s38, s32, 3
    s_lshl_b32 s38, s38, 3
    s_add_u32 s36, s36, s38
    v_lshlrev_b32 v5, 11, v4
    v_lshl_add_u32 v5, v2, 1, v5
    v_add_u32 v79, s36, v5
    v_bfe_u32 v5, v3, 0, 2
    v_lshlrev_b32 v81, 11, v5
    v_lshrrev_b32 v5, 2, v3
    v_lshl_add_u32 v81, v5, 8, v81
    v_and_b32 v5, 12, v3
    v_xor_b32 v5, v5, v2
    v_and_b32 v6, 1, v3
    v_lshlrev_b32 v6, 1, v6
    v_xor_b32 v5, v5, v6
    v_lshlrev_b32 v80, 4, v5
    v_bfe_u32 v6, v3, 0, 2
    v_lshl_add_u32 v80, v6, 11, v80
    v_lshrrev_b32 v6, 2, v3
    v_lshl_add_u32 v80, v6, 8, v80
    v_add_u32 v80, s85, v80
    v_lshlrev_b32 v4, 9, v4
    v_lshl_add_u32 v4, v2, 4, v4
    v_add_u32 v94, s85, v4
    s_lshl_b32 s38, s34, 9
    s_add_u32 s38, s38, 131072
    v_and_b32 v5, 31, v1
    v_lshl_add_u32 v102, v5, 4, s38
    s_mul_i32 s38, s34, 320
    s_add_u32 s38, s38, 135168
    v_lshl_add_u32 v103, v5, 3, s38
    v_lshlrev_b32 v4, 6, v2
    v_lshl_add_u32 v4, v3, 1, v4
    v_add_u32 v93, s38, v4
    v_lshlrev_b32 v4, 7, v2
    v_lshl_add_u32 v4, v3, 4, v4
    v_mov_b32 v5, 512
    v_cmp_gt_u32 vcc, 8, v3
    s_nop 1
    v_cndmask_b32 v92, v5, v4, vcc
    s_mov_b32 s92, 0
    s_mov_b32 s96, 524288
    s_mov_b32 s97, 0
    s_lshl_b32 s38, s32, 15
    s_add_u32 s36, s38, 2097152
    s_lshl_b32 s38, s34, 8
    s_add_u32 s36, s38, s36
    s_lshl_b32 s38, s32, 3
    s_add_u32 s37, s38, 163840
    s_lshl_b32 s38, s34, 13
    s_add_u32 s37, s38, s37
    s_lshl_b32 s38, s32, 8
    s_add_u32 s69, s38, 131072
    s_lshl_b32 s38, s34, 13
    s_add_u32 s69, s38, s69
    v_mov_b32 v4, s69
    v_mov_b32 v5, s68
    s_waitcnt vmcnt(3)
    s_mov_b64 exec, 1
    buffer_store_dword v5, v4, s[48:51], 0 offen sc1
    s_mov_b64 exec, -1
    s_mov_b32 s86, 131072
    buffer_load_dword v7, v101, s[48:51], s86 offen sc1
    s_waitcnt vmcnt(0)
L_fcheck_19:
    v_cmp_ne_u32 vcc, s68, v7
    s_cbranch_vccz L_fok_20
    s_sleep 2
    s_mov_b32 s86, 131072
    buffer_load_dword v7, v101, s[48:51], s86 offen sc1
    s_waitcnt vmcnt(0)
    s_sub_u32 s84, s84, 1
    s_cmp_lg_u32 s84, 0
    s_cbranch_scc1 L_fcheck_19
    s_branch L_end
L_fok_20:
    buffer_load_dwordx2 v[52:53], v81, s[48:51], s37 offen sc1
    s_add_u32 s37, s37, 1024
    buffer_load_dwordx2 v[54:55], v81, s[48:51], s37 offen sc1
    buffer_load_dwordx4 v[200:203], v9, s[48:51], s36 offen sc1
    s_add_u32 s36, s36, 4096
    buffer_load_dwordx4 v[204:207], v9, s[48:51], s36 offen sc1
    s_add_u32 s36, s36, 4096
    buffer_load_dwordx4 v[208:211], v9, s[48:51], s36 offen sc1
    s_add_u32 s36, s36, 4096
    buffer_load_dwordx4 v[212:215], v9, s[48:51], s36 offen sc1
    s_add_u32 s36, s36, 4096
    buffer_load_dwordx4 v[216:219], v9, s[48:51], s36 offen sc1
    s_add_u32 s36, s36, 4096
    buffer_load_dwordx4 v[220:223], v9, s[48:51], s36 offen sc1
    s_add_u32 s36, s36, 4096
    buffer_load_dwordx4 v[224:227], v9, s[48:51], s36 offen sc1
    s_add_u32 s36, s36, 4096
    buffer_load_dwordx4 v[228:231], v9, s[48:51], s36 offen sc1
    v_xor_b32 v82, 0, v80
    v_xor_b32 v83, 64, v80
    v_xor_b32 v84, 128, v80
    v_xor_b32 v85, 192, v80
    v_xor_b32 v86, 16, v80
    v_xor_b32 v87, 80, v80
    v_xor_b32 v88, 144, v80
    v_xor_b32 v89, 208, v80
    s_waitcnt vmcnt(8)
    v_max_f32 v4, v52, v54
    s_nop 1
    v_max_f32_dpp v4, v4, v4 row_ror:8 row_mask:0xf bank_mask:0xf
    s_nop 1
    v_max_f32_dpp v4, v4, v4 row_ror:4 row_mask:0xf bank_mask:0xf
    v_sub_f32 v52, v52, v4
    v_sub_f32 v54, v54, v4
    v_exp_f32 v52, v52
    v_exp_f32 v54, v54
    v_mul_f32 v5, v52, v53
    v_fmac_f32 v5, v54, v55
    s_nop 1
    v_add_f32_dpp v5, v5, v5 row_ror:8 row_mask:0xf bank_mask:0xf
    s_nop 1
    v_add_f32_dpp v5, v5, v5 row_ror:4 row_mask:0xf bank_mask:0xf
    v_rcp_f32 v5, v5
    s_nop 0
    v_mul_f32 v52, v52, v5
    v_mul_f32 v54, v54, v5
    s_waitcnt vmcnt(7)
    ds_write_b128 v96, v[200:203] offset:0
    s_waitcnt vmcnt(6)
    ds_write_b128 v97, v[204:207] offset:1024
    s_waitcnt vmcnt(5)
    ds_write_b128 v98, v[208:211] offset:2048
    s_waitcnt vmcnt(4)
    ds_write_b128 v99, v[212:215] offset:3072
    s_waitcnt vmcnt(3)
    ds_write_b128 v96, v[216:219] offset:4096
    s_waitcnt vmcnt(2)
    ds_write_b128 v97, v[220:223] offset:5120
    s_waitcnt vmcnt(1)
    ds_write_b128 v98, v[224:227] offset:6144
    s_waitcnt vmcnt(0)
    ds_write_b128 v99, v[228:231] offset:7168
    s_waitcnt lgkmcnt(0)
    ds_read_b128 v[20:23], v82 offset:0
    ds_read_b128 v[24:27], v83 offset:0
    ds_read_b128 v[28:31], v84 offset:0
    ds_read_b128 v[32:35], v85 offset:0
    ds_read_b128 v[36:39], v86 offset:1024
    ds_read_b128 v[40:43], v87 offset:1024
    ds_read_b128 v[44:47], v88 offset:1024
    ds_read_b128 v[48:51], v89 offset:1024
    s_waitcnt lgkmcnt(0)
    v_mfma_f32_16x16x32_bf16 v[60:63], a[128:131], v[20:23], 0
    v_mfma_f32_16x16x32_bf16 v[64:67], a[128:131], v[36:39], 0
    v_mfma_f32_16x16x32_bf16 v[60:63], a[132:135], v[24:27], v[60:63]
    v_mfma_f32_16x16x32_bf16 v[64:67], a[132:135], v[40:43], v[64:67]
    v_mfma_f32_16x16x32_bf16 v[60:63], a[136:139], v[28:31], v[60:63]
    v_mfma_f32_16x16x32_bf16 v[64:67], a[136:139], v[44:47], v[64:67]
    v_mfma_f32_16x16x32_bf16 v[60:63], a[140:143], v[32:35], v[60:63]
    v_mfma_f32_16x16x32_bf16 v[64:67], a[140:143], v[48:51], v[64:67]
    v_mfma_f32_16x16x32_bf16 v[68:71], a[144:147], v[20:23], 0
    v_mfma_f32_16x16x32_bf16 v[72:75], a[144:147], v[36:39], 0
    v_mfma_f32_16x16x32_bf16 v[68:71], a[148:151], v[24:27], v[68:71]
    v_mfma_f32_16x16x32_bf16 v[72:75], a[148:151], v[40:43], v[72:75]
    v_mfma_f32_16x16x32_bf16 v[68:71], a[152:155], v[28:31], v[68:71]
    v_mfma_f32_16x16x32_bf16 v[72:75], a[152:155], v[44:47], v[72:75]
    v_mfma_f32_16x16x32_bf16 v[68:71], a[156:159], v[32:35], v[68:71]
    v_mfma_f32_16x16x32_bf16 v[72:75], a[156:159], v[48:51], v[72:75]
    v_mul_f32 v104, v60, v52
    v_mul_f32 v105, v61, v52
    v_mul_f32 v106, v62, v52
    v_mul_f32 v107, v63, v52
    v_fmac_f32 v104, v64, v54
    v_fmac_f32 v105, v65, v54
    v_fmac_f32 v106, v66, v54
    v_fmac_f32 v107, v67, v54
    v_add_f32_dpp v104, v104, v104 row_ror:8 row_mask:0xf bank_mask:0xf
    v_add_f32_dpp v105, v105, v105 row_ror:8 row_mask:0xf bank_mask:0xf
    v_add_f32_dpp v106, v106, v106 row_ror:8 row_mask:0xf bank_mask:0xf
    v_add_f32_dpp v107, v107, v107 row_ror:8 row_mask:0xf bank_mask:0xf
    v_add_f32_dpp v104, v104, v104 row_ror:4 row_mask:0xf bank_mask:0xf
    v_add_f32_dpp v105, v105, v105 row_ror:4 row_mask:0xf bank_mask:0xf
    v_add_f32_dpp v106, v106, v106 row_ror:4 row_mask:0xf bank_mask:0xf
    v_add_f32_dpp v107, v107, v107 row_ror:4 row_mask:0xf bank_mask:0xf
    ds_write_b128 v94, v[104:107] offset:0
    v_mfma_f32_16x16x32_bf16 v[60:63], a[160:163], v[20:23], 0
    v_mfma_f32_16x16x32_bf16 v[64:67], a[160:163], v[36:39], 0
    v_mfma_f32_16x16x32_bf16 v[60:63], a[164:167], v[24:27], v[60:63]
    v_mfma_f32_16x16x32_bf16 v[64:67], a[164:167], v[40:43], v[64:67]
    v_mfma_f32_16x16x32_bf16 v[60:63], a[168:171], v[28:31], v[60:63]
    v_mfma_f32_16x16x32_bf16 v[64:67], a[168:171], v[44:47], v[64:67]
    v_mfma_f32_16x16x32_bf16 v[60:63], a[172:175], v[32:35], v[60:63]
    v_mfma_f32_16x16x32_bf16 v[64:67], a[172:175], v[48:51], v[64:67]
    v_mul_f32 v108, v68, v52
    v_mul_f32 v109, v69, v52
    v_mul_f32 v110, v70, v52
    v_mul_f32 v111, v71, v52
    v_fmac_f32 v108, v72, v54
    v_fmac_f32 v109, v73, v54
    v_fmac_f32 v110, v74, v54
    v_fmac_f32 v111, v75, v54
    v_add_f32_dpp v108, v108, v108 row_ror:8 row_mask:0xf bank_mask:0xf
    v_add_f32_dpp v109, v109, v109 row_ror:8 row_mask:0xf bank_mask:0xf
    v_add_f32_dpp v110, v110, v110 row_ror:8 row_mask:0xf bank_mask:0xf
    v_add_f32_dpp v111, v111, v111 row_ror:8 row_mask:0xf bank_mask:0xf
    v_add_f32_dpp v108, v108, v108 row_ror:4 row_mask:0xf bank_mask:0xf
    v_add_f32_dpp v109, v109, v109 row_ror:4 row_mask:0xf bank_mask:0xf
    v_add_f32_dpp v110, v110, v110 row_ror:4 row_mask:0xf bank_mask:0xf
    v_add_f32_dpp v111, v111, v111 row_ror:4 row_mask:0xf bank_mask:0xf
    ds_write_b128 v94, v[108:111] offset:64
    v_mfma_f32_16x16x32_bf16 v[68:71], a[176:179], v[20:23], 0
    v_mfma_f32_16x16x32_bf16 v[72:75], a[176:179], v[36:39], 0
    v_mfma_f32_16x16x32_bf16 v[68:71], a[180:183], v[24:27], v[68:71]
    v_mfma_f32_16x16x32_bf16 v[72:75], a[180:183], v[40:43], v[72:75]
    v_mfma_f32_16x16x32_bf16 v[68:71], a[184:187], v[28:31], v[68:71]
    v_mfma_f32_16x16x32_bf16 v[72:75], a[184:187], v[44:47], v[72:75]
    v_mfma_f32_16x16x32_bf16 v[68:71], a[188:191], v[32:35], v[68:71]
    v_mfma_f32_16x16x32_bf16 v[72:75], a[188:191], v[48:51], v[72:75]
    v_mul_f32 v104, v60, v52
    v_mul_f32 v105, v61, v52
    v_mul_f32 v106, v62, v52
    v_mul_f32 v107, v63, v52
    v_fmac_f32 v104, v64, v54
    v_fmac_f32 v105, v65, v54
    v_fmac_f32 v106, v66, v54
    v_fmac_f32 v107, v67, v54
    v_add_f32_dpp v104, v104, v104 row_ror:8 row_mask:0xf bank_mask:0xf
    v_add_f32_dpp v105, v105, v105 row_ror:8 row_mask:0xf bank_mask:0xf
    v_add_f32_dpp v106, v106, v106 row_ror:8 row_mask:0xf bank_mask:0xf
    v_add_f32_dpp v107, v107, v107 row_ror:8 row_mask:0xf bank_mask:0xf
    v_add_f32_dpp v104, v104, v104 row_ror:4 row_mask:0xf bank_mask:0xf
    v_add_f32_dpp v105, v105, v105 row_ror:4 row_mask:0xf bank_mask:0xf
    v_add_f32_dpp v106, v106, v106 row_ror:4 row_mask:0xf bank_mask:0xf
    v_add_f32_dpp v107, v107, v107 row_ror:4 row_mask:0xf bank_mask:0xf
    ds_write_b128 v94, v[104:107] offset:128
    v_mfma_f32_16x16x32_bf16 v[60:63], a[192:195], v[20:23], 0
    v_mfma_f32_16x16x32_bf16 v[64:67], a[192:195], v[36:39], 0
    v_mfma_f32_16x16x32_bf16 v[60:63], a[196:199], v[24:27], v[60:63]
    v_mfma_f32_16x16x32_bf16 v[64:67], a[196:199], v[40:43], v[64:67]
    v_mfma_f32_16x16x32_bf16 v[60:63], a[200:203], v[28:31], v[60:63]
    v_mfma_f32_16x16x32_bf16 v[64:67], a[200:203], v[44:47], v[64:67]
    v_mfma_f32_16x16x32_bf16 v[60:63], a[204:207], v[32:35], v[60:63]
    v_mfma_f32_16x16x32_bf16 v[64:67], a[204:207], v[48:51], v[64:67]
    v_mul_f32 v108, v68, v52
    v_mul_f32 v109, v69, v52
    v_mul_f32 v110, v70, v52
    v_mul_f32 v111, v71, v52
    v_fmac_f32 v108, v72, v54
    v_fmac_f32 v109, v73, v54
    v_fmac_f32 v110, v74, v54
    v_fmac_f32 v111, v75, v54
    v_add_f32_dpp v108, v108, v108 row_ror:8 row_mask:0xf bank_mask:0xf
    v_add_f32_dpp v109, v109, v109 row_ror:8 row_mask:0xf bank_mask:0xf
    v_add_f32_dpp v110, v110, v110 row_ror:8 row_mask:0xf bank_mask:0xf
    v_add_f32_dpp v111, v111, v111 row_ror:8 row_mask:0xf bank_mask:0xf
    v_add_f32_dpp v108, v108, v108 row_ror:4 row_mask:0xf bank_mask:0xf
    v_add_f32_dpp v109, v109, v109 row_ror:4 row_mask:0xf bank_mask:0xf
    v_add_f32_dpp v110, v110, v110 row_ror:4 row_mask:0xf bank_mask:0xf
    v_add_f32_dpp v111, v111, v111 row_ror:4 row_mask:0xf bank_mask:0xf
    ds_write_b128 v94, v[108:111] offset:192
    v_mfma_f32_16x16x32_bf16 v[68:71], a[208:211], v[20:23], 0
    v_mfma_f32_16x16x32_bf16 v[72:75], a[208:211], v[36:39], 0
    v_mfma_f32_16x16x32_bf16 v[68:71], a[212:215], v[24:27], v[68:71]
    v_mfma_f32_16x16x32_bf16 v[72:75], a[212:215], v[40:43], v[72:75]
    v_mfma_f32_16x16x32_bf16 v[68:71], a[216:219], v[28:31], v[68:71]
    v_mfma_f32_16x16x32_bf16 v[72:75], a[216:219], v[44:47], v[72:75]
    v_mfma_f32_16x16x32_bf16 v[68:71], a[220:223], v[32:35], v[68:71]
    v_mfma_f32_16x16x32_bf16 v[72:75], a[220:223], v[48:51], v[72:75]
    v_mul_f32 v104, v60, v52
    v_mul_f32 v105, v61, v52
    v_mul_f32 v106, v62, v52
    v_mul_f32 v107, v63, v52
    v_fmac_f32 v104, v64, v54
    v_fmac_f32 v105, v65, v54
    v_fmac_f32 v106, v66, v54
    v_fmac_f32 v107, v67, v54
    v_add_f32_dpp v104, v104, v104 row_ror:8 row_mask:0xf bank_mask:0xf
    v_add_f32_dpp v105, v105, v105 row_ror:8 row_mask:0xf bank_mask:0xf
    v_add_f32_dpp v106, v106, v106 row_ror:8 row_mask:0xf bank_mask:0xf
    v_add_f32_dpp v107, v107, v107 row_ror:8 row_mask:0xf bank_mask:0xf
    v_add_f32_dpp v104, v104, v104 row_ror:4 row_mask:0xf bank_mask:0xf
    v_add_f32_dpp v105, v105, v105 row_ror:4 row_mask:0xf bank_mask:0xf
    v_add_f32_dpp v106, v106, v106 row_ror:4 row_mask:0xf bank_mask:0xf
    v_add_f32_dpp v107, v107, v107 row_ror:4 row_mask:0xf bank_mask:0xf
    ds_write_b128 v94, v[104:107] offset:256
    v_mfma_f32_16x16x32_bf16 v[60:63], a[224:227], v[20:23], 0
    v_mfma_f32_16x16x32_bf16 v[64:67], a[224:227], v[36:39], 0
    v_mfma_f32_16x16x32_bf16 v[60:63], a[228:231], v[24:27], v[60:63]
    v_mfma_f32_16x16x32_bf16 v[64:67], a[228:231], v[40:43], v[64:67]
    v_mfma_f32_16x16x32_bf16 v[60:63], a[232:235], v[28:31], v[60:63]
    v_mfma_f32_16x16x32_bf16 v[64:67], a[232:235], v[44:47], v[64:67]
    v_mfma_f32_16x16x32_bf16 v[60:63], a[236:239], v[32:35], v[60:63]
    v_mfma_f32_16x16x32_bf16 v[64:67], a[236:239], v[48:51], v[64:67]
    v_mul_f32 v108, v68, v52
    v_mul_f32 v109, v69, v52
    v_mul_f32 v110, v70, v52
    v_mul_f32 v111, v71, v52
    v_fmac_f32 v108, v72, v54
    v_fmac_f32 v109, v73, v54
    v_fmac_f32 v110, v74, v54
    v_fmac_f32 v111, v75, v54
    v_add_f32_dpp v108, v108, v108 row_ror:8 row_mask:0xf bank_mask:0xf
    v_add_f32_dpp v109, v109, v109 row_ror:8 row_mask:0xf bank_mask:0xf
    v_add_f32_dpp v110, v110, v110 row_ror:8 row_mask:0xf bank_mask:0xf
    v_add_f32_dpp v111, v111, v111 row_ror:8 row_mask:0xf bank_mask:0xf
    v_add_f32_dpp v108, v108, v108 row_ror:4 row_mask:0xf bank_mask:0xf
    v_add_f32_dpp v109, v109, v109 row_ror:4 row_mask:0xf bank_mask:0xf
    v_add_f32_dpp v110, v110, v110 row_ror:4 row_mask:0xf bank_mask:0xf
    v_add_f32_dpp v111, v111, v111 row_ror:4 row_mask:0xf bank_mask:0xf
    ds_write_b128 v94, v[108:111] offset:320
    v_mfma_f32_16x16x32_bf16 v[68:71], a[240:243], v[20:23], 0
    v_mfma_f32_16x16x32_bf16 v[72:75], a[240:243], v[36:39], 0
    v_mfma_f32_16x16x32_bf16 v[68:71], a[244:247], v[24:27], v[68:71]
    v_mfma_f32_16x16x32_bf16 v[72:75], a[244:247], v[40:43], v[72:75]
    v_mfma_f32_16x16x32_bf16 v[68:71], a[248:251], v[28:31], v[68:71]
    v_mfma_f32_16x16x32_bf16 v[72:75], a[248:251], v[44:47], v[72:75]
    v_mfma_f32_16x16x32_bf16 v[68:71], a[252:255], v[32:35], v[68:71]
    v_mfma_f32_16x16x32_bf16 v[72:75], a[252:255], v[48:51], v[72:75]
    v_mul_f32 v104, v60, v52
    v_mul_f32 v105, v61, v52
    v_mul_f32 v106, v62, v52
    v_mul_f32 v107, v63, v52
    v_fmac_f32 v104, v64, v54
    v_fmac_f32 v105, v65, v54
    v_fmac_f32 v106, v66, v54
    v_fmac_f32 v107, v67, v54
    v_add_f32_dpp v104, v104, v104 row_ror:8 row_mask:0xf bank_mask:0xf
    v_add_f32_dpp v105, v105, v105 row_ror:8 row_mask:0xf bank_mask:0xf
    v_add_f32_dpp v106, v106, v106 row_ror:8 row_mask:0xf bank_mask:0xf
    v_add_f32_dpp v107, v107, v107 row_ror:8 row_mask:0xf bank_mask:0xf
    v_add_f32_dpp v104, v104, v104 row_ror:4 row_mask:0xf bank_mask:0xf
    v_add_f32_dpp v105, v105, v105 row_ror:4 row_mask:0xf bank_mask:0xf
    v_add_f32_dpp v106, v106, v106 row_ror:4 row_mask:0xf bank_mask:0xf
    v_add_f32_dpp v107, v107, v107 row_ror:4 row_mask:0xf bank_mask:0xf
    ds_write_b128 v94, v[104:107] offset:384
    v_mul_f32 v108, v68, v52
    v_mul_f32 v109, v69, v52
    v_mul_f32 v110, v70, v52
    v_mul_f32 v111, v71, v52
    v_fmac_f32 v108, v72, v54
    v_fmac_f32 v109, v73, v54
    v_fmac_f32 v110, v74, v54
    v_fmac_f32 v111, v75, v54
    v_add_f32_dpp v108, v108, v108 row_ror:8 row_mask:0xf bank_mask:0xf
    v_add_f32_dpp v109, v109, v109 row_ror:8 row_mask:0xf bank_mask:0xf
    v_add_f32_dpp v110, v110, v110 row_ror:8 row_mask:0xf bank_mask:0xf
    v_add_f32_dpp v111, v111, v111 row_ror:8 row_mask:0xf bank_mask:0xf
    v_add_f32_dpp v108, v108, v108 row_ror:4 row_mask:0xf bank_mask:0xf
    v_add_f32_dpp v109, v109, v109 row_ror:4 row_mask:0xf bank_mask:0xf
    v_add_f32_dpp v110, v110, v110 row_ror:4 row_mask:0xf bank_mask:0xf
    v_add_f32_dpp v111, v111, v111 row_ror:4 row_mask:0xf bank_mask:0xf
    ds_write_b128 v94, v[108:111] offset:448
    s_waitcnt lgkmcnt(0)
    s_barrier
    ds_read_b128 v[20:23], v102 offset:0
    ds_read_b128 v[24:27], v102 offset:8192
    ds_read_b128 v[28:31], v102 offset:16384
    ds_read_b128 v[32:35], v102 offset:24576
    s_waitcnt lgkmcnt(0)
    v_add_f32 v20, v20, v24
    v_add_f32 v28, v28, v32
    v_add_f32 v21, v21, v25
    v_add_f32 v29, v29, v33
    v_add_f32 v22, v22, v26
    v_add_f32 v30, v30, v34
    v_add_f32 v23, v23, v27
    v_add_f32 v31, v31, v35
    v_add_f32 v20, v20, v28
    v_add_f32 v21, v21, v29
    v_add_f32 v22, v22, v30
    v_add_f32 v23, v23, v31
    v_cvt_pk_bf16_f32 v20, v20, v21
    v_cvt_pk_bf16_f32 v21, v22, v23
    ds_write_b64 v103, v[20:21]
    v_lshlrev_b32 v4, 2, v1
    v_add_u32 v4, 136448, v4
    ds_write_b32 v4, v100
L_final:
    s_waitcnt lgkmcnt(0)
    s_barrier
    ds_read_b128 v[136:139], v112 offset:0
    ds_read_b128 v[140:143], v112 offset:64
    ds_read_b128 v[144:147], v112 offset:128
    ds_read_b128 v[148:151], v112 offset:192
    ds_read_b128 v[152:155], v113 offset:0
    ds_read_b128 v[156:159], v113 offset:64
    s_add_u32 s36, s96, 32768
    s_add_u32 s37, s96, 4096
    s_waitcnt lgkmcnt(5)
    v_mfma_f32_16x16x32_bf16 v[84:87], a[0:3], v[136:139], 0
    ds_read_b128 v[160:163], v113 offset:128
    v_mfma_f32_16x16x32_bf16 v[88:91], a[64:67], v[136:139], 0
    s_waitcnt lgkmcnt(5)
    v_mfma_f32_16x16x32_bf16 v[84:87], a[4:7], v[140:143], v[84:87]
    ds_read_b128 v[164:167], v113 offset:192
    v_mfma_f32_16x16x32_bf16 v[88:91], a[68:71], v[140:143], v[88:91]
    s_waitcnt lgkmcnt(5)
    v_mfma_f32_16x16x32_bf16 v[84:87], a[8:11], v[144:147], v[84:87]
    ds_read_b128 v[168:171], v114 offset:0
    v_mfma_f32_16x16x32_bf16 v[88:91], a[72:75], v[144:147], v[88:91]
    s_waitcnt lgkmcnt(5)
    v_mfma_f32_16x16x32_bf16 v[84:87], a[12:15], v[148:151], v[84:87]
    ds_read_b128 v[172:175], v114 offset:64
    v_mfma_f32_16x16x32_bf16 v[88:91], a[76:79], v[148:151], v[88:91]
    s_waitcnt lgkmcnt(5)
    v_mfma_f32_16x16x32_bf16 v[84:87], a[16:19], v[152:155], v[84:87]
    ds_read_b128 v[176:179], v114 offset:128
    v_mfma_f32_16x16x32_bf16 v[88:91], a[80:83], v[152:155], v[88:91]
    s_waitcnt lgkmcnt(5)
    v_mfma_f32_16x16x32_bf16 v[84:87], a[20:23], v[156:159], v[84:87]
    ds_read_b128 v[180:183], v114 offset:192
    v_mfma_f32_16x16x32_bf16 v[88:91], a[84:87], v[156:159], v[88:91]
    s_waitcnt lgkmcnt(5)
    v_mfma_f32_16x16x32_bf16 v[84:87], a[24:27], v[160:163], v[84:87]
    ds_read_b128 v[184:187], v115 offset:0
    v_mfma_f32_16x16x32_bf16 v[88:91], a[88:91], v[160:163], v[88:91]
    s_waitcnt lgkmcnt(5)
    v_mfma_f32_16x16x32_bf16 v[84:87], a[28:31], v[164:167], v[84:87]
    ds_read_b128 v[188:191], v115 offset:64
    v_mfma_f32_16x16x32_bf16 v[88:91], a[92:95], v[164:167], v[88:91]
    s_waitcnt lgkmcnt(5)
    v_mfma_f32_16x16x32_bf16 v[84:87], a[32:35], v[168:171], v[84:87]
    ds_read_b128 v[192:195], v115 offset:128
    v_mfma_f32_16x16x32_bf16 v[88:91], a[96:99], v[168:171], v[88:91]
    s_waitcnt lgkmcnt(5)
    v_mfma_f32_16x16x32_bf16 v[84:87], a[36:39], v[172:175], v[84:87]
    ds_read_b128 v[196:199], v115 offset:192
    v_mfma_f32_16x16x32_bf16 v[88:91], a[100:103], v[172:175], v[88:91]
    s_waitcnt lgkmcnt(5)
    v_mfma_f32_16x16x32_bf16 v[84:87], a[40:43], v[176:179], v[84:87]
    v_mfma_f32_16x16x32_bf16 v[88:91], a[104:107], v[176:179], v[88:91]
    s_waitcnt lgkmcnt(4)
    v_mfma_f32_16x16x32_bf16 v[84:87], a[44:47], v[180:183], v[84:87]
    v_mfma_f32_16x16x32_bf16 v[88:91], a[108:111], v[180:183], v[88:91]
    s_waitcnt lgkmcnt(3)
    v_mfma_f32_16x16x32_bf16 v[84:87], a[48:51], v[184:187], v[84:87]
    v_mfma_f32_16x16x32_bf16 v[88:91], a[112:115], v[184:187], v[88:91]
    s_waitcnt lgkmcnt(2)
    v_mfma_f32_16x16x32_bf16 v[84:87], a[52:55], v[188:191], v[84:87]
    v_mfma_f32_16x16x32_bf16 v[88:91], a[116:119], v[188:191], v[88:91]
    s_waitcnt lgkmcnt(1)
    v_mfma_f32_16x16x32_bf16 v[84:87], a[56:59], v[192:195], v[84:87]
    v_mfma_f32_16x16x32_bf16 v[88:91], a[120:123], v[192:195], v[88:91]
    s_waitcnt lgkmcnt(0)
    v_mfma_f32_16x16x32_bf16 v[84:87], a[60:63], v[196:199], v[84:87]
    v_mfma_f32_16x16x32_bf16 v[88:91], a[124:127], v[196:199], v[88:91]
    s_nop 6
    v_and_or_b32 v84, v84, s82, v8
    v_and_or_b32 v85, v85, s82, v8
    v_and_or_b32 v86, v86, s82, v8
    v_and_or_b32 v87, v87, s82, v8
    buffer_store_dwordx4 v[84:87], v77, s[48:51], s96 offen sc1
    v_and_or_b32 v88, v88, s82, v8
    v_and_or_b32 v89, v89, s82, v8
    v_and_or_b32 v90, v90, s82, v8
    v_and_or_b32 v91, v91, s82, v8
    buffer_store_dwordx4 v[88:91], v77, s[48:51], s36 offen sc1
    s_cmp_eq_u32 s92, 0
    s_cbranch_scc1 L_prepb
L_hop2:
L_hop2poll:
    buffer_load_dwordx4 v[200:203], v78, s[48:51], s96 offen sc1
    buffer_load_dwordx4 v[204:207], v78, s[48:51], s37 offen sc1
    s_waitcnt vmcnt(0)
    v_xor_b32 v200, s35, v200
    v_xor_b32 v201, s35, v201
    v_xor_b32 v202, s35, v202
    v_xor_b32 v203, s35, v203
    v_xor_b32 v204, s35, v204
    v_xor_b32 v205, s35, v205
    v_xor_b32 v206, s35, v206
    v_xor_b32 v207, s35, v207
    v_or_b32 v4, v200, v201
    v_or3_b32 v4, v4, v202, v203
    v_or3_b32 v4, v4, v204, v205
    v_or3_b32 v4, v4, v206, v207
    v_and_b32 v4, 0xff, v4
    v_cmp_ne_u32 vcc, 0, v4
    v_add_f32 v104, v200, v204
    v_add_f32 v105, v201, v205
    v_add_f32 v106, v202, v206
    v_add_f32 v107, v203, v207
    s_cbranch_vccz L_hop2ok
    s_sub_u32 s84, s84, 1
    s_cmp_lg_u32 s84, 0
    s_cbranch_scc1 L_hop2poll
    s_branch L_end
L_hop2ok:
    v_permlane16_swap_b32 v104, v105
    v_permlane16_swap_b32 v106, v107
    v_add_f32 v104, v104, v105
    v_add_f32 v106, v106, v107
    s_nop 1
    v_permlane32_swap_b32 v104, v106
    v_add_f32 v104, v104, v106
    s_nop 1
    v_add_f32_dpp v104, v104, v104 row_ror:8 row_mask:0xf bank_mask:0xf
    s_nop 1
    v_add_f32_dpp v104, v104, v104 row_ror:4 row_mask:0xf bank_mask:0xf
    v_cvt_pk_bf16_f32 v104, v104, v104
    s_mov_b32 exec_lo, 0xf000f
    s_mov_b32 exec_hi, 0xf000f
    buffer_store_short v104, v79, s[72:75], s97 offen
    s_mov_b64 exec, -1
    s_cmp_lg_u32 s92, 0
    s_cbranch_scc1 L_fin
    s_mov_b32 s92, 1
    s_mov_b32 s96, 786432
    s_mov_b32 s97, 1024
    s_lshl_b32 s38, s32, 15
    s_add_u32 s85, s38, 1048576
    s_lshl_b32 s38, s34, 13
    s_add_u32 s85, s38, s85
    s_branch L_hop1
    v_min_u32 v5, 6, v1
    v_lshlrev_b32 v5, 10, v5
L_light:
    buffer_load_dword v6, v5, s[48:51], s85 offen offset:512 sc1
    s_waitcnt vmcnt(0)
    v_xor_b32 v6, s35, v6
    v_and_b32 v6, 0xff, v6
    v_cmp_ne_u32 vcc, 0, v6
    s_nop 0
    s_and_b32 s36, vcc_lo, 0x7f
    s_bcnt1_i32_b32 s36, s36
    s_cmp_le_u32 s36, 7
    s_cbranch_scc1 L_hop1
    s_sleep 2
    s_sub_u32 s84, s84, 1
    s_cmp_lg_u32 s84, 0
    s_cbranch_scc1 L_light
    s_branch L_end
L_hop1:
    s_mov_b32 s93, 0x7f
    s_mov_b32 s94, 0
    v_mov_b32 v55, 0xff7f0000
    v_mov_b32 v56, 0
    v_mov_b32 v57, 0
    v_mov_b32 v58, 0
    v_mov_b32 v59, 0
    s_and_b32 s94, s94, s93
    s_cselect_b32 s94, s94, s93
    s_ff1_i32_b32 s4, s94
    s_bitset0_b32 s94, s4
    s_lshl_b32 s36, s4, 10
    s_add_u32 s36, s36, s85
    buffer_load_dwordx4 v[20:23], v92, s[48:51], s36 offen sc1
    s_and_b32 s94, s94, s93
    s_cselect_b32 s94, s94, s93
    s_ff1_i32_b32 s5, s94
    s_bitset0_b32 s94, s5
    s_lshl_b32 s36, s5, 10
    s_add_u32 s36, s36, s85
    buffer_load_dwordx4 v[24:27], v92, s[48:51], s36 offen sc1
    s_and_b32 s94, s94, s93
    s_cselect_b32 s94, s94, s93
    s_ff1_i32_b32 s6, s94
    s_bitset0_b32 s94, s6
    s_lshl_b32 s36, s6, 10
    s_add_u32 s36, s36, s85
    buffer_load_dwordx4 v[28:31], v92, s[48:51], s36 offen sc1
    s_and_b32 s94, s94, s93
    s_cselect_b32 s94, s94, s93
    s_ff1_i32_b32 s7, s94
    s_bitset0_b32 s94, s7
    s_lshl_b32 s36, s7, 10
    s_add_u32 s36, s36, s85
    buffer_load_dwordx4 v[32:35], v92, s[48:51], s36 offen sc1
L_hop1poll:
    s_and_b32 s94, s94, s93
    s_cselect_b32 s94, s94, s93
    s_ff1_i32_b32 s8, s94
    s_bitset0_b32 s94, s8
    s_lshl_b32 s36, s8, 10
    s_add_u32 s36, s36, s85
    buffer_load_dwordx4 v[36:39], v92, s[48:51], s36 offen sc1
    s_waitcnt vmcnt(4)
    v_xor_b32 v20, s35, v20
    v_xor_b32 v21, s35, v21
    v_xor_b32 v22, s35, v22
    v_xor_b32 v23, s35, v23
    v_or_b32 v4, v20, v21
    v_or3_b32 v4, v4, v22, v23
    v_and_b32 v4, 0xff, v4
    v_cmp_ne_u32 vcc, 0, v4
    v_max_f32 v5, v55, v20
    s_cbranch_vccnz L_mnext_21
    s_bitcmp1_b32 s93, s4
    s_cbranch_scc0 L_mnext_21
    v_sub_f32 v52, v55, v5
    v_sub_f32 v53, v20, v5
    v_exp_f32 v52, v52
    v_exp_f32 v53, v53
    v_mov_b32 v55, v5
    s_bitset0_b32 s93, s4
    v_mul_f32_dpp v57, v52, v57 row_newbcast:8 row_mask:0xf bank_mask:0xf
    v_mul_f32_dpp v56, v52, v56 row_newbcast:8 row_mask:0xf bank_mask:0xf
    v_mul_f32_dpp v58, v52, v58 row_newbcast:8 row_mask:0xf bank_mask:0xf
    v_mul_f32_dpp v59, v52, v59 row_newbcast:8 row_mask:0xf bank_mask:0xf
    v_fmac_f32_dpp v57, v53, v21 row_newbcast:8 row_mask:0xf bank_mask:0xf
    v_fmac_f32_dpp v56, v53, v20 row_newbcast:8 row_mask:0xf bank_mask:0xf
    v_fmac_f32_dpp v58, v53, v22 row_newbcast:8 row_mask:0xf bank_mask:0xf
    v_fmac_f32_dpp v59, v53, v23 row_newbcast:8 row_mask:0xf bank_mask:0xf
    s_cmp_eq_u32 s93, 0
    s_cbranch_scc1 L_hop1ok
L_mnext_21:
    s_and_b32 s94, s94, s93
    s_cselect_b32 s94, s94, s93
    s_ff1_i32_b32 s4, s94
    s_bitset0_b32 s94, s4
    s_lshl_b32 s36, s4, 10
    s_add_u32 s36, s36, s85
    buffer_load_dwordx4 v[20:23], v92, s[48:51], s36 offen sc1
    s_waitcnt vmcnt(4)
    v_xor_b32 v24, s35, v24
    v_xor_b32 v25, s35, v25
    v_xor_b32 v26, s35, v26
    v_xor_b32 v27, s35, v27
    v_or_b32 v4, v24, v25
    v_or3_b32 v4, v4, v26, v27
    v_and_b32 v4, 0xff, v4
    v_cmp_ne_u32 vcc, 0, v4
    v_max_f32 v5, v55, v24
    s_cbranch_vccnz L_mnext_22
    s_bitcmp1_b32 s93, s5
    s_cbranch_scc0 L_mnext_22
    v_sub_f32 v52, v55, v5
    v_sub_f32 v53, v24, v5
    v_exp_f32 v52, v52
    v_exp_f32 v53, v53
    v_mov_b32 v55, v5
    s_bitset0_b32 s93, s5
    v_mul_f32_dpp v57, v52, v57 row_newbcast:8 row_mask:0xf bank_mask:0xf
    v_mul_f32_dpp v56, v52, v56 row_newbcast:8 row_mask:0xf bank_mask:0xf
    v_mul_f32_dpp v58, v52, v58 row_newbcast:8 row_mask:0xf bank_mask:0xf
    v_mul_f32_dpp v59, v52, v59 row_newbcast:8 row_mask:0xf bank_mask:0xf
    v_fmac_f32_dpp v57, v53, v25 row_newbcast:8 row_mask:0xf bank_mask:0xf
    v_fmac_f32_dpp v56, v53, v24 row_newbcast:8 row_mask:0xf bank_mask:0xf
    v_fmac_f32_dpp v58, v53, v26 row_newbcast:8 row_mask:0xf bank_mask:0xf
    v_fmac_f32_dpp v59, v53, v27 row_newbcast:8 row_mask:0xf bank_mask:0xf
    s_cmp_eq_u32 s93, 0
    s_cbranch_scc1 L_hop1ok
L_mnext_22:
    s_and_b32 s94, s94, s93
    s_cselect_b32 s94, s94, s93
    s_ff1_i32_b32 s5, s94
    s_bitset0_b32 s94, s5
    s_lshl_b32 s36, s5, 10
    s_add_u32 s36, s36, s85
    buffer_load_dwordx4 v[24:27], v92, s[48:51], s36 offen sc1
    s_waitcnt vmcnt(4)
    v_xor_b32 v28, s35, v28
    v_xor_b32 v29, s35, v29
    v_xor_b32 v30, s35, v30
    v_xor_b32 v31, s35, v31
    v_or_b32 v4, v28, v29
    v_or3_b32 v4, v4, v30, v31
    v_and_b32 v4, 0xff, v4
    v_cmp_ne_u32 vcc, 0, v4
    v_max_f32 v5, v55, v28
    s_cbranch_vccnz L_mnext_23
    s_bitcmp1_b32 s93, s6
    s_cbranch_scc0 L_mnext_23
    v_sub_f32 v52, v55, v5
    v_sub_f32 v53, v28, v5
    v_exp_f32 v52, v52
    v_exp_f32 v53, v53
    v_mov_b32 v55, v5
    s_bitset0_b32 s93, s6
    v_mul_f32_dpp v57, v52, v57 row_newbcast:8 row_mask:0xf bank_mask:0xf
    v_mul_f32_dpp v56, v52, v56 row_newbcast:8 row_mask:0xf bank_mask:0xf
    v_mul_f32_dpp v58, v52, v58 row_newbcast:8 row_mask:0xf bank_mask:0xf
    v_mul_f32_dpp v59, v52, v59 row_newbcast:8 row_mask:0xf bank_mask:0xf
    v_fmac_f32_dpp v57, v53, v29 row_newbcast:8 row_mask:0xf bank_mask:0xf
    v_fmac_f32_dpp v56, v53, v28 row_newbcast:8 row_mask:0xf bank_mask:0xf
    v_fmac_f32_dpp v58, v53, v30 row_newbcast:8 row_mask:0xf bank_mask:0xf
    v_fmac_f32_dpp v59, v53, v31 row_newbcast:8 row_mask:0xf bank_mask:0xf
    s_cmp_eq_u32 s93, 0
    s_cbranch_scc1 L_hop1ok
L_mnext_23:
    s_and_b32 s94, s94, s93
    s_cselect_b32 s94, s94, s93
    s_ff1_i32_b32 s6, s94
    s_bitset0_b32 s94, s6
    s_lshl_b32 s36, s6, 10
    s_add_u32 s36, s36, s85
    buffer_load_dwordx4 v[28:31], v92, s[48:51], s36 offen sc1
    s_waitcnt vmcnt(4)
    v_xor_b32 v32, s35, v32
    v_xor_b32 v33, s35, v33
    v_xor_b32 v34, s35, v34
    v_xor_b32 v35, s35, v35
    v_or_b32 v4, v32, v33
    v_or3_b32 v4, v4, v34, v35
    v_and_b32 v4, 0xff, v4
    v_cmp_ne_u32 vcc, 0, v4
    v_max_f32 v5, v55, v32
    s_cbranch_vccnz L_mnext_24
    s_bitcmp1_b32 s93, s7
    s_cbranch_scc0 L_mnext_24
    v_sub_f32 v52, v55, v5
    v_sub_f32 v53, v32, v5
    v_exp_f32 v52, v52
    v_exp_f32 v53, v53
    v_mov_b32 v55, v5
    s_bitset0_b32 s93, s7
    v_mul_f32_dpp v57, v52, v57 row_newbcast:8 row_mask:0xf bank_mask:0xf
    v_mul_f32_dpp v56, v52, v56 row_newbcast:8 row_mask:0xf bank_mask:0xf
    v_mul_f32_dpp v58, v52, v58 row_newbcast:8 row_mask:0xf bank_mask:0xf
    v_mul_f32_dpp v59, v52, v59 row_newbcast:8 row_mask:0xf bank_mask:0xf
    v_fmac_f32_dpp v57, v53, v33 row_newbcast:8 row_mask:0xf bank_mask:0xf
    v_fmac_f32_dpp v56, v53, v32 row_newbcast:8 row_mask:0xf bank_mask:0xf
    v_fmac_f32_dpp v58, v53, v34 row_newbcast:8 row_mask:0xf bank_mask:0xf
    v_fmac_f32_dpp v59, v53, v35 row_newbcast:8 row_mask:0xf bank_mask:0xf
    s_cmp_eq_u32 s93, 0
    s_cbranch_scc1 L_hop1ok
L_mnext_24:
    s_and_b32 s94, s94, s93
    s_cselect_b32 s94, s94, s93
    s_ff1_i32_b32 s7, s94
    s_bitset0_b32 s94, s7
    s_lshl_b32 s36, s7, 10
    s_add_u32 s36, s36, s85
    buffer_load_dwordx4 v[32:35], v92, s[48:51], s36 offen sc1
    s_waitcnt vmcnt(4)
    v_xor_b32 v36, s35, v36
    v_xor_b32 v37, s35, v37
    v_xor_b32 v38, s35, v38
    v_xor_b32 v39, s35, v39
    v_or_b32 v4, v36, v37
    v_or3_b32 v4, v4, v38, v39
    v_and_b32 v4, 0xff, v4
    v_cmp_ne_u32 vcc, 0, v4
    v_max_f32 v5, v55, v36
    s_cbranch_vccnz L_mnext_25
    s_bitcmp1_b32 s93, s8
    s_cbranch_scc0 L_mnext_25
    v_sub_f32 v52, v55, v5
    v_sub_f32 v53, v36, v5
    v_exp_f32 v52, v52
    v_exp_f32 v53, v53
    v_mov_b32 v55, v5
    s_bitset0_b32 s93, s8
    v_mul_f32_dpp v57, v52, v57 row_newbcast:8 row_mask:0xf bank_mask:0xf
    v_mul_f32_dpp v56, v52, v56 row_newbcast:8 row_mask:0xf bank_mask:0xf
    v_mul_f32_dpp v58, v52, v58 row_newbcast:8 row_mask:0xf bank_mask:0xf
    v_mul_f32_dpp v59, v52, v59 row_newbcast:8 row_mask:0xf bank_mask:0xf
    v_fmac_f32_dpp v57, v53, v37 row_newbcast:8 row_mask:0xf bank_mask:0xf
    v_fmac_f32_dpp v56, v53, v36 row_newbcast:8 row_mask:0xf bank_mask:0xf
    v_fmac_f32_dpp v58, v53, v38 row_newbcast:8 row_mask:0xf bank_mask:0xf
    v_fmac_f32_dpp v59, v53, v39 row_newbcast:8 row_mask:0xf bank_mask:0xf
    s_cmp_eq_u32 s93, 0
    s_cbranch_scc1 L_hop1ok
L_mnext_25:
    s_sub_u32 s84, s84, 1
    s_cmp_lg_u32 s84, 0
    s_cbranch_scc1 L_hop1poll
    s_branch L_end
L_hop1ok:
    v_rcp_f32 v55, v57
    s_nop 1
    v_mul_f32_dpp v56, v55, v56 row_newbcast:8 row_mask:0xf bank_mask:0xf
    v_mul_f32_dpp v57, v55, v57 row_newbcast:8 row_mask:0xf bank_mask:0xf
    v_mul_f32_dpp v58, v55, v58 row_newbcast:8 row_mask:0xf bank_mask:0xf
    v_mul_f32_dpp v59, v55, v59 row_newbcast:8 row_mask:0xf bank_mask:0xf
    v_cvt_pk_bf16_f32 v56, v56, v57
    v_cvt_pk_bf16_f32 v58, v58, v59
    s_mov_b32 exec_lo, 0xff00ff
    s_mov_b32 exec_hi, 0xff00ff
    ds_write_b16 v93, v56
    ds_write_b16_d16_hi v93, v56 offset:16
    ds_write_b16 v93, v58 offset:32
    ds_write_b16_d16_hi v93, v58 offset:48
    s_mov_b64 exec, -1
    s_branch L_final
L_prepb:
    v_xor_b32 v4, 0, v95
    ds_read_b64_tr_b16 a[0:1], v4 offset:0
    ds_read_b64_tr_b16 a[4:5], v4 offset:8192
    ds_read_b64_tr_b16 a[8:9], v4 offset:16384
    ds_read_b64_tr_b16 a[12:13], v4 offset:24576
    v_xor_b32 v5, 16, v95
    ds_read_b64_tr_b16 a[2:3], v5 offset:1024
    ds_read_b64_tr_b16 a[6:7], v5 offset:9216
    ds_read_b64_tr_b16 a[10:11], v5 offset:17408
    ds_read_b64_tr_b16 a[14:15], v5 offset:25600
    v_xor_b32 v4, 32, v95
    ds_read_b64_tr_b16 a[16:17], v4 offset:0
    ds_read_b64_tr_b16 a[20:21], v4 offset:8192
    ds_read_b64_tr_b16 a[24:25], v4 offset:16384
    ds_read_b64_tr_b16 a[28:29], v4 offset:24576
    v_xor_b32 v5, 48, v95
    ds_read_b64_tr_b16 a[18:19], v5 offset:1024
    ds_read_b64_tr_b16 a[22:23], v5 offset:9216
    ds_read_b64_tr_b16 a[26:27], v5 offset:17408
    ds_read_b64_tr_b16 a[30:31], v5 offset:25600
    v_xor_b32 v4, 64, v95
    ds_read_b64_tr_b16 a[32:33], v4 offset:0
    ds_read_b64_tr_b16 a[36:37], v4 offset:8192
    ds_read_b64_tr_b16 a[40:41], v4 offset:16384
    ds_read_b64_tr_b16 a[44:45], v4 offset:24576
    v_xor_b32 v5, 80, v95
    ds_read_b64_tr_b16 a[34:35], v5 offset:1024
    ds_read_b64_tr_b16 a[38:39], v5 offset:9216
    ds_read_b64_tr_b16 a[42:43], v5 offset:17408
    ds_read_b64_tr_b16 a[46:47], v5 offset:25600
    v_xor_b32 v4, 96, v95
    ds_read_b64_tr_b16 a[48:49], v4 offset:0
    ds_read_b64_tr_b16 a[52:53], v4 offset:8192
    ds_read_b64_tr_b16 a[56:57], v4 offset:16384
    ds_read_b64_tr_b16 a[60:61], v4 offset:24576
    v_xor_b32 v5, 112, v95
    ds_read_b64_tr_b16 a[50:51], v5 offset:1024
    ds_read_b64_tr_b16 a[54:55], v5 offset:9216
    ds_read_b64_tr_b16 a[58:59], v5 offset:17408
    ds_read_b64_tr_b16 a[62:63], v5 offset:25600
    v_xor_b32 v4, 128, v95
    ds_read_b64_tr_b16 a[64:65], v4 offset:0
    ds_read_b64_tr_b16 a[68:69], v4 offset:8192
    ds_read_b64_tr_b16 a[72:73], v4 offset:16384
    ds_read_b64_tr_b16 a[76:77], v4 offset:24576
    v_xor_b32 v5, 144, v95
    ds_read_b64_tr_b16 a[66:67], v5 offset:1024
    ds_read_b64_tr_b16 a[70:71], v5 offset:9216
    ds_read_b64_tr_b16 a[74:75], v5 offset:17408
    ds_read_b64_tr_b16 a[78:79], v5 offset:25600
    v_xor_b32 v4, 160, v95
    ds_read_b64_tr_b16 a[80:81], v4 offset:0
    ds_read_b64_tr_b16 a[84:85], v4 offset:8192
    ds_read_b64_tr_b16 a[88:89], v4 offset:16384
    ds_read_b64_tr_b16 a[92:93], v4 offset:24576
    v_xor_b32 v5, 176, v95
    ds_read_b64_tr_b16 a[82:83], v5 offset:1024
    ds_read_b64_tr_b16 a[86:87], v5 offset:9216
    ds_read_b64_tr_b16 a[90:91], v5 offset:17408
    ds_read_b64_tr_b16 a[94:95], v5 offset:25600
    v_xor_b32 v4, 192, v95
    ds_read_b64_tr_b16 a[96:97], v4 offset:0
    ds_read_b64_tr_b16 a[100:101], v4 offset:8192
    ds_read_b64_tr_b16 a[104:105], v4 offset:16384
    ds_read_b64_tr_b16 a[108:109], v4 offset:24576
    v_xor_b32 v5, 208, v95
    ds_read_b64_tr_b16 a[98:99], v5 offset:1024
    ds_read_b64_tr_b16 a[102:103], v5 offset:9216
    ds_read_b64_tr_b16 a[106:107], v5 offset:17408
    ds_read_b64_tr_b16 a[110:111], v5 offset:25600
    v_xor_b32 v4, 224, v95
    ds_read_b64_tr_b16 a[112:113], v4 offset:0
    ds_read_b64_tr_b16 a[116:117], v4 offset:8192
    ds_read_b64_tr_b16 a[120:121], v4 offset:16384
    ds_read_b64_tr_b16 a[124:125], v4 offset:24576
    v_xor_b32 v5, 240, v95
    ds_read_b64_tr_b16 a[114:115], v5 offset:1024
    ds_read_b64_tr_b16 a[118:119], v5 offset:9216
    ds_read_b64_tr_b16 a[122:123], v5 offset:17408
    ds_read_b64_tr_b16 a[126:127], v5 offset:25600
    s_waitcnt lgkmcnt(0)
    s_barrier
    s_branch L_hop2
L_fin:
    s_or_b32 s36, s32, s34
    s_cmp_lg_u32 s36, 0
    s_cbranch_scc1 L_end
    s_mov_b64 exec, 1
    buffer_store_dword v8, v100, s[48:51], 0 offen
L_end:
    s_endpgm
.section .rodata,"a"
.p2align 6
.amdhsa_kernel concat_heads__compressed_kv_cla__mha_block_cached__decode_kernel
  .amdhsa_next_free_vgpr 512
  .amdhsa_next_free_sgpr 102
  .amdhsa_accum_offset 256
  .amdhsa_group_segment_fixed_size 0
  .amdhsa_kernarg_size 112
  .amdhsa_user_sgpr_count 2
  .amdhsa_user_sgpr_kernarg_segment_ptr 1
  .amdhsa_system_sgpr_workgroup_id_x 1
.end_amdhsa_kernel
```

```asm
; @launch grid=(256,1,1) block=(256,1,1) lds=163840
    .amdgcn_target "amdgcn-amd-amdhsa--gfx950"
    .text
    .globl concat_heads__compressed_kv_cla__mha_block_cached__decode_kernel
    .p2align 8
    .type concat_heads__compressed_kv_cla__mha_block_cached__decode_kernel,@function
concat_heads__compressed_kv_cla__mha_block_cached__decode_kernel:
    s_cmp_ge_u32 s2, 256
    s_cbranch_scc1 L_end
    s_load_dwordx16 s[4:19], s[0:1], 0
    s_load_dwordx8 s[20:27], s[0:1], 64
    s_load_dwordx4 s[28:31], s[0:1], 96
    v_lshrrev_b32 v4, 6, v0
    v_and_b32 v1, 63, v0
    v_readfirstlane_b32 s34, v4
    s_lshr_b32 s32, s2, 3
    s_sub_u32 s33, s2, s32
    s_sub_u32 s33, s33, 1
    s_and_b32 s33, s33, 7
    v_lshrrev_b32 v2, 4, v1
    v_and_b32 v3, 15, v1
    s_cmp_lt_u32 s33, 2
    s_cbranch_scc1 L_qp
    s_cmp_eq_u32 s33, 2
    s_cbranch_scc1 L_ql
    s_cmp_eq_u32 s33, 7
    s_cbranch_scc1 L_aux
    s_bfe_u32 s38, s2, 0x30000
    s_lshl_b32 s38, s38, 21
    s_add_u32 s36, s38, -393216
    s_lshr_b32 s38, s32, 3
    s_lshl_b32 s38, s38, 19
    s_add_u32 s36, s38, s36
    s_lshl_b32 s38, s33, 17
    s_add_u32 s36, s38, s36
    s_lshl_b32 s38, s34, 12
    s_add_u32 s36, s38, s36
    v_bfe_u32 v5, v1, 0, 5
    v_lshlrev_b32 v4, 7, v5
    v_lshrrev_b32 v5, 5, v1
    v_lshl_add_u32 v4, v5, 15, v4
    s_mov_b32 s42, 16777216
    s_mov_b32 s43, 0x20000
    s_waitcnt lgkmcnt(0)
    s_mov_b64 s[40:41], s[6:7]
    buffer_load_dword v20, v4, s[40:43], s36 offen
    s_add_u32 s36, s36, 16384
    buffer_load_dword v21, v4, s[40:43], s36 offen
    s_add_u32 s36, s36, 49152
    buffer_load_dword v22, v4, s[40:43], s36 offen
    s_add_u32 s36, s36, 16384
    buffer_load_dword v23, v4, s[40:43], s36 offen
    s_load_dword s35, s[30:31], 0
    s_mov_b32 s48, s30
    s_and_b32 s49, s31, 0xffff
    s_mov_b32 s50, 8388608
    s_mov_b32 s51, 0x20000
    s_mov_b32 s82, 0xffffff00
    s_mov_b32 s83, 0x3e0293ee
    s_mov_b32 s84, 2097152
    v_lshrrev_b32 v4, 2, v3
    v_and_b32 v5, 3, v3
    v_lshlrev_b32 v76, 8, v4
    v_lshlrev_b32 v126, 8, v2
    v_lshl_add_u32 v76, v2, 6, v76
    v_lshl_add_u32 v76, v5, 4, v76
    v_lshl_add_u32 v126, v3, 4, v126
    v_xor_b32 v77, 32768, v76
    v_xor_b32 v127, 32768, v126
    s_add_u32 s3, s34, s33
    s_and_b32 s3, s3, 3
    s_lshl_b32 s89, s3, 5
    s_add_u32 s89, s89, s32
    s_lshl_b32 s89, s89, 20
    s_mul_i32 s88, s32, 8
    s_add_u32 s88, s88, s3
    s_lshl_b32 s87, s33, 0
    s_mov_b32 s52, s18
    s_and_b32 s53, s19, 0xffff
    s_mov_b32 s54, 134217728
    s_mov_b32 s55, 0x20000
    s_mov_b32 s56, s20
    s_and_b32 s57, s21, 0xffff
    s_mov_b32 s58, 134217728
    s_mov_b32 s59, 0x20000
    v_and_b32 v4, 1, v1
    v_lshlrev_b32 v4, 4, v4
    v_mov_b32 v5, 0xffff
    v_lshlrev_b32 v4, v4, v5
    v_bfe_u32 v5, v1, 1, 2
    v_cmp_eq_u32 vcc, 0, v5
    s_nop 1
    v_cndmask_b32 v10, 0, v4, vcc
    v_cmp_eq_u32 vcc, 1, v5
    s_nop 1
    v_cndmask_b32 v11, 0, v4, vcc
    v_cmp_eq_u32 vcc, 2, v5
    s_nop 1
    v_cndmask_b32 v12, 0, v4, vcc
    v_cmp_eq_u32 vcc, 3, v5
    s_nop 1
    v_cndmask_b32 v13, 0, v4, vcc
    v_mov_b32 v120, 0xff7f0000
    v_mov_b32 v121, 0
    v_mov_b32 v18, 1
    v_mov_b32 v116, 0
    v_mov_b32 v117, 0
    v_mov_b32 v118, 0
    v_mov_b32 v119, 0
    s_lshl_b32 s38, s32, 10
    s_add_u32 s96, s38, 65536
    s_lshl_b32 s38, s3, 8
    s_add_u32 s96, s38, s96
    v_mov_b32 v9, s96
    s_lshl_b32 s38, s32, 15
    s_add_u32 s96, s38, 1048576
    s_lshl_b32 s38, s3, 13
    s_add_u32 s96, s38, s96
    s_lshl_b32 s38, s33, 10
    s_add_u32 s96, s38, s96
    v_and_b32 v5, 3, v3
    v_lshlrev_b32 v78, 7, v2
    v_lshl_add_u32 v78, v5, 5, v78
    s_lshl_b32 s38, s32, 12
    s_add_u32 s91, s38, 262144
    s_lshl_b32 s38, s3, 9
    s_add_u32 s91, s38, s91
    v_lshlrev_b32 v4, 7, v2
    v_lshl_add_u32 v4, v3, 4, v4
    v_mov_b32 v5, 512
    v_cmp_gt_u32 vcc, 8, v3
    s_nop 1
    v_cndmask_b32 v79, v5, v4, vcc
    s_add_u32 s39, s87, s88
    s_bfe_u32 s37, s39, 0x30000
    s_lshl_b32 s37, s37, 12
    s_add_u32 s85, s37, s89
    s_bfe_u32 s37, s39, 0x10003
    s_lshl_b32 s37, s37, 11
    s_add_u32 s85, s37, s85
    s_bfe_u32 s37, s39, 0x40004
    s_lshl_b32 s37, s37, 16
    s_add_u32 s85, s37, s85
    buffer_load_dwordx4 v[128:131], v76, s[52:55], s85 offen offset:0 nt
    buffer_load_dwordx4 v[132:135], v77, s[52:55], s85 offen offset:0 nt
    buffer_load_dwordx4 v[136:139], v76, s[52:55], s85 offen offset:1024 nt
    buffer_load_dwordx4 v[140:143], v77, s[52:55], s85 offen offset:1024 nt
    s_add_u32 s87, s87, 7
    s_add_u32 s39, s87, s88
    s_bfe_u32 s37, s39, 0x30000
    s_lshl_b32 s37, s37, 12
    s_add_u32 s85, s37, s89
    s_bfe_u32 s37, s39, 0x10003
    s_lshl_b32 s37, s37, 11
    s_add_u32 s85, s37, s85
    s_bfe_u32 s37, s39, 0x40004
    s_lshl_b32 s37, s37, 16
    s_add_u32 s85, s37, s85
    buffer_load_dwordx4 v[144:147], v76, s[52:55], s85 offen offset:0 nt
    buffer_load_dwordx4 v[148:151], v77, s[52:55], s85 offen offset:0 nt
    buffer_load_dwordx4 v[152:155], v76, s[52:55], s85 offen offset:1024 nt
    s_waitcnt vmcnt(6)
    buffer_load_dwordx4 v[156:159], v77, s[52:55], s85 offen offset:1024 nt
    s_add_u32 s87, s87, 7
    s_add_u32 s39, s87, s88
    s_bfe_u32 s37, s39, 0x30000
    s_lshl_b32 s37, s37, 12
    s_add_u32 s85, s37, s89
    s_bfe_u32 s37, s39, 0x10003
    s_lshl_b32 s37, s37, 11
    s_add_u32 s85, s37, s85
    s_bfe_u32 s37, s39, 0x40004
    s_lshl_b32 s37, s37, 16
    s_add_u32 s85, s37, s85
    s_waitcnt vmcnt(6)
    buffer_load_dwordx4 v[160:163], v76, s[52:55], s85 offen offset:0 nt
    s_waitcnt vmcnt(6)
    buffer_load_dwordx4 v[164:167], v77, s[52:55], s85 offen offset:0 nt
    s_waitcnt vmcnt(6)
    buffer_load_dwordx4 v[168:171], v76, s[52:55], s85 offen offset:1024 nt
    s_waitcnt vmcnt(6)
    buffer_load_dwordx4 v[172:175], v77, s[52:55], s85 offen offset:1024 nt
    s_add_u32 s87, s87, 7
    s_add_u32 s39, s87, s88
    s_bfe_u32 s37, s39, 0x30000
    s_lshl_b32 s37, s37, 12
    s_add_u32 s85, s37, s89
    s_bfe_u32 s37, s39, 0x10003
    s_lshl_b32 s37, s37, 11
    s_add_u32 s85, s37, s85
    s_bfe_u32 s37, s39, 0x40004
    s_lshl_b32 s37, s37, 16
    s_add_u32 s85, s37, s85
    s_waitcnt vmcnt(6)
    buffer_load_dwordx4 v[176:179], v76, s[52:55], s85 offen offset:0 nt
    s_waitcnt vmcnt(6)
    buffer_load_dwordx4 v[180:183], v77, s[52:55], s85 offen offset:0 nt
    s_waitcnt vmcnt(6)
    buffer_load_dwordx4 v[184:187], v76, s[52:55], s85 offen offset:1024 nt
    s_waitcnt vmcnt(6)
    buffer_load_dwordx4 v[188:191], v77, s[52:55], s85 offen offset:1024 nt
    s_add_u32 s87, s87, 7
    s_add_u32 s39, s87, s88
    s_bfe_u32 s37, s39, 0x30000
    s_lshl_b32 s37, s37, 12
    s_add_u32 s85, s37, s89
    s_bfe_u32 s37, s39, 0x10003
    s_lshl_b32 s37, s37, 11
    s_add_u32 s85, s37, s85
    s_bfe_u32 s37, s39, 0x40004
    s_lshl_b32 s37, s37, 16
    s_add_u32 s85, s37, s85
    s_waitcnt vmcnt(6)
    buffer_load_dwordx4 v[192:195], v76, s[52:55], s85 offen offset:0 nt
    s_waitcnt vmcnt(6)
    buffer_load_dwordx4 v[196:199], v77, s[52:55], s85 offen offset:0 nt
    s_waitcnt vmcnt(6)
    buffer_load_dwordx4 v[200:203], v76, s[52:55], s85 offen offset:1024 nt
    s_waitcnt vmcnt(6)
    buffer_load_dwordx4 v[204:207], v77, s[52:55], s85 offen offset:1024 nt
    s_add_u32 s87, s87, 7
    s_add_u32 s39, s87, s88
    s_bfe_u32 s37, s39, 0x30000
    s_lshl_b32 s37, s37, 12
    s_add_u32 s85, s37, s89
    s_bfe_u32 s37, s39, 0x10003
    s_lshl_b32 s37, s37, 11
    s_add_u32 s85, s37, s85
    s_bfe_u32 s37, s39, 0x40004
    s_lshl_b32 s37, s37, 16
    s_add_u32 s85, s37, s85
    s_waitcnt vmcnt(6)
    buffer_load_dwordx4 v[208:211], v76, s[52:55], s85 offen offset:0 nt
    s_waitcnt vmcnt(6)
    buffer_load_dwordx4 v[212:215], v77, s[52:55], s85 offen offset:0 nt
    s_waitcnt vmcnt(6)
    buffer_load_dwordx4 v[216:219], v76, s[52:55], s85 offen offset:1024 nt
    s_waitcnt vmcnt(6)
    buffer_load_dwordx4 v[220:223], v77, s[52:55], s85 offen offset:1024 nt
    s_add_u32 s87, s87, 7
    s_add_u32 s39, s87, s88
    s_bfe_u32 s37, s39, 0x30000
    s_lshl_b32 s37, s37, 12
    s_add_u32 s85, s37, s89
    s_bfe_u32 s37, s39, 0x10003
    s_lshl_b32 s37, s37, 11
    s_add_u32 s85, s37, s85
    s_bfe_u32 s37, s39, 0x40004
    s_lshl_b32 s37, s37, 16
    s_add_u32 s85, s37, s85
    s_waitcnt vmcnt(6)
    buffer_load_dwordx4 v[224:227], v76, s[52:55], s85 offen offset:0 nt
    s_waitcnt vmcnt(6)
    buffer_load_dwordx4 v[228:231], v77, s[52:55], s85 offen offset:0 nt
    s_waitcnt vmcnt(6)
    buffer_load_dwordx4 v[232:235], v76, s[52:55], s85 offen offset:1024 nt
    s_waitcnt vmcnt(6)
    buffer_load_dwordx4 v[236:239], v77, s[52:55], s85 offen offset:1024 nt
    s_add_u32 s87, s87, 7
    s_add_u32 s39, s87, s88
    s_bfe_u32 s37, s39, 0x30000
    s_lshl_b32 s37, s37, 12
    s_add_u32 s85, s37, s89
    s_bfe_u32 s37, s39, 0x10003
    s_lshl_b32 s37, s37, 11
    s_add_u32 s85, s37, s85
    s_bfe_u32 s37, s39, 0x40004
    s_lshl_b32 s37, s37, 16
    s_add_u32 s85, s37, s85
    s_waitcnt vmcnt(6)
    buffer_load_dwordx4 v[240:243], v76, s[52:55], s85 offen offset:0 nt
    s_waitcnt vmcnt(6)
    buffer_load_dwordx4 v[244:247], v77, s[52:55], s85 offen offset:0 nt
    s_waitcnt vmcnt(6)
    buffer_load_dwordx4 v[248:251], v76, s[52:55], s85 offen offset:1024 nt
    s_waitcnt vmcnt(6)
    buffer_load_dwordx4 v[252:255], v77, s[52:55], s85 offen offset:1024 nt
    s_add_u32 s87, s87, 7
    s_add_u32 s39, s87, s88
    s_bfe_u32 s37, s39, 0x30000
    s_lshl_b32 s37, s37, 12
    s_add_u32 s85, s37, s89
    s_bfe_u32 s37, s39, 0x10003
    s_lshl_b32 s37, s37, 11
    s_add_u32 s85, s37, s85
    s_bfe_u32 s37, s39, 0x40004
    s_lshl_b32 s37, s37, 16
    s_add_u32 s85, s37, s85
    s_waitcnt vmcnt(6)
    buffer_load_dwordx4 a[0:3], v76, s[52:55], s85 offen offset:0 nt
    s_waitcnt vmcnt(6)
    buffer_load_dwordx4 a[4:7], v77, s[52:55], s85 offen offset:0 nt
    buffer_load_dwordx4 v[68:71], v78, s[48:51], s91 offen offset:0 sc1
    buffer_load_dwordx4 v[72:75], v78, s[48:51], s91 offen offset:16 sc1
    s_waitcnt vmcnt(8)
    buffer_load_dwordx4 a[8:11], v76, s[52:55], s85 offen offset:1024 nt
    s_waitcnt vmcnt(8)
    buffer_load_dwordx4 a[12:15], v77, s[52:55], s85 offen offset:1024 nt
    s_add_u32 s87, s87, 7
    s_add_u32 s39, s87, s88
    s_bfe_u32 s37, s39, 0x30000
    s_lshl_b32 s37, s37, 12
    s_add_u32 s85, s37, s89
    s_bfe_u32 s37, s39, 0x10003
    s_lshl_b32 s37, s37, 11
    s_add_u32 s85, s37, s85
    s_bfe_u32 s37, s39, 0x40004
    s_lshl_b32 s37, s37, 16
    s_add_u32 s85, s37, s85
    s_waitcnt vmcnt(8)
    buffer_load_dwordx4 a[16:19], v76, s[52:55], s85 offen offset:0 nt
    s_waitcnt vmcnt(8)
    buffer_load_dwordx4 a[20:23], v77, s[52:55], s85 offen offset:0 nt
    s_waitcnt vmcnt(8)
    buffer_load_dwordx4 a[24:27], v76, s[52:55], s85 offen offset:1024 nt
    s_waitcnt vmcnt(8)
    buffer_load_dwordx4 a[28:31], v77, s[52:55], s85 offen offset:1024 nt
    s_add_u32 s87, s87, 7
    s_add_u32 s39, s87, s88
    s_bfe_u32 s37, s39, 0x30000
    s_lshl_b32 s37, s37, 12
    s_add_u32 s85, s37, s89
    s_bfe_u32 s37, s39, 0x10003
    s_lshl_b32 s37, s37, 11
    s_add_u32 s85, s37, s85
    s_bfe_u32 s37, s39, 0x40004
    s_lshl_b32 s37, s37, 16
    s_add_u32 s85, s37, s85
    s_waitcnt lgkmcnt(0)
    s_add_u32 s35, s35, 0x5b
    s_and_b32 s35, s35, 0xff
    v_mov_b32 v8, s35
    s_waitcnt vmcnt(6)
L_qcheck_1:
    v_xor_b32 v68, s35, v68
    v_xor_b32 v69, s35, v69
    v_xor_b32 v70, s35, v70
    v_xor_b32 v71, s35, v71
    v_xor_b32 v72, s35, v72
    v_xor_b32 v73, s35, v73
    v_xor_b32 v74, s35, v74
    v_xor_b32 v75, s35, v75
    v_or_b32 v4, v68, v69
    v_or3_b32 v4, v4, v70, v71
    v_or3_b32 v4, v4, v72, v73
    v_or3_b32 v4, v4, v74, v75
    v_and_b32 v4, 0xff, v4
    v_cmp_ne_u32 vcc, 0, v4
    s_cbranch_vccz L_qok_2
    buffer_load_dwordx4 v[68:71], v78, s[48:51], s91 offen offset:0 sc1
    buffer_load_dwordx4 v[72:75], v78, s[48:51], s91 offen offset:16 sc1
    s_waitcnt vmcnt(0)
    s_sub_u32 s84, s84, 1
    s_cmp_lg_u32 s84, 0
    s_cbranch_scc1 L_qcheck_1
    s_branch L_end
L_qok_2:
    v_cvt_pk_bf16_f32 v68, v68, v69
    v_cvt_pk_bf16_f32 v69, v70, v71
    v_cvt_pk_bf16_f32 v70, v72, v73
    v_cvt_pk_bf16_f32 v71, v74, v75
    s_mov_b32 vcc_lo, 0xf000f
    s_mov_b32 vcc_hi, 0xf000f
    v_cndmask_b32 v80, 0, v68, vcc
    v_cndmask_b32 v81, 0, v69, vcc
    v_cndmask_b32 v82, 0, v70, vcc
    v_cndmask_b32 v83, 0, v71, vcc
    s_mov_b32 vcc_lo, 0xf000f0
    s_mov_b32 vcc_hi, 0xf000f0
    v_cndmask_b32 v84, 0, v68, vcc
    v_cndmask_b32 v85, 0, v69, vcc
    v_cndmask_b32 v86, 0, v70, vcc
    v_cndmask_b32 v87, 0, v71, vcc
    s_mov_b32 vcc_lo, 0xf000f00
    s_mov_b32 vcc_hi, 0xf000f00
    v_cndmask_b32 v88, 0, v68, vcc
    v_cndmask_b32 v89, 0, v69, vcc
    v_cndmask_b32 v90, 0, v70, vcc
    v_cndmask_b32 v91, 0, v71, vcc
    s_mov_b32 vcc_lo, 0xf000f000
    s_mov_b32 vcc_hi, 0xf000f000
    v_cndmask_b32 v92, 0, v68, vcc
    v_cndmask_b32 v93, 0, v69, vcc
    v_cndmask_b32 v94, 0, v70, vcc
    v_cndmask_b32 v95, 0, v71, vcc
    v_mov_b32 v65, 0xff7f0000
    s_lshl_b32 s38, s34, 14
    s_add_u32 s38, s38, 16384
    v_lshl_add_u32 v64, v1, 2, s38
    buffer_load_dwordx4 a[32:35], v76, s[52:55], s85 offen offset:0 nt
    v_mfma_f32_16x16x32_bf16 v[112:115], v[128:131], v[80:83], 0
    v_mfma_f32_16x16x32_bf16 v[112:115], v[132:135], v[84:87], v[112:115]
    v_mfma_f32_16x16x32_bf16 v[112:115], v[136:139], v[88:91], v[112:115]
    s_waitcnt vmcnt(6)
    buffer_load_dwordx4 a[36:39], v77, s[52:55], s85 offen offset:0 nt
    v_mfma_f32_16x16x32_bf16 v[112:115], v[140:143], v[92:95], v[112:115]
    v_mfma_f32_16x16x32_bf16 v[96:99], v[144:147], v[80:83], 0
    v_mfma_f32_16x16x32_bf16 v[96:99], v[148:151], v[84:87], v[96:99]
    s_waitcnt vmcnt(6)
    buffer_load_dwordx4 a[40:43], v76, s[52:55], s85 offen offset:1024 nt
    v_mfma_f32_16x16x32_bf16 v[96:99], v[152:155], v[88:91], v[96:99]
    s_nop 2
    v_mov_b32_dpp v122, v112 quad_perm:[0,0,0,0] row_mask:0xf bank_mask:0xf
    v_mov_b32_dpp v124, v114 quad_perm:[2,2,2,2] row_mask:0xf bank_mask:0xf
    s_nop 0
    v_add_f32_dpp v122, v113, v122 quad_perm:[1,1,1,1] row_mask:0xf bank_mask:0xf
    v_add_f32_dpp v124, v115, v124 quad_perm:[3,3,3,3] row_mask:0xf bank_mask:0xf
    v_add_f32 v122, v122, v124
    v_max_f32 v65, v65, v122
    ds_write_b32 v64, v122 offset:0
    v_mfma_f32_16x16x32_bf16 v[96:99], v[156:159], v[92:95], v[96:99]
    v_mfma_f32_16x16x32_bf16 v[112:115], v[160:163], v[80:83], 0
    v_mfma_f32_16x16x32_bf16 v[112:115], v[164:167], v[84:87], v[112:115]
    s_waitcnt vmcnt(6)
    buffer_load_dwordx4 a[44:47], v77, s[52:55], s85 offen offset:1024 nt
    s_add_u32 s87, s87, 7
    s_add_u32 s39, s87, s88
    s_bfe_u32 s37, s39, 0x30000
    s_lshl_b32 s37, s37, 12
    s_add_u32 s85, s37, s89
    s_bfe_u32 s37, s39, 0x10003
    s_lshl_b32 s37, s37, 11
    s_add_u32 s85, s37, s85
    s_bfe_u32 s37, s39, 0x40004
    s_lshl_b32 s37, s37, 16
    s_add_u32 s85, s37, s85
    v_mfma_f32_16x16x32_bf16 v[112:115], v[168:171], v[88:91], v[112:115]
    v_mov_b32_dpp v122, v96 quad_perm:[0,0,0,0] row_mask:0xf bank_mask:0xf
    v_mov_b32_dpp v124, v98 quad_perm:[2,2,2,2] row_mask:0xf bank_mask:0xf
    s_nop 0
    v_add_f32_dpp v122, v97, v122 quad_perm:[1,1,1,1] row_mask:0xf bank_mask:0xf
    v_add_f32_dpp v124, v99, v124 quad_perm:[3,3,3,3] row_mask:0xf bank_mask:0xf
    v_add_f32 v122, v122, v124
    v_max_f32 v65, v65, v122
    ds_write_b32 v64, v122 offset:256
    v_mfma_f32_16x16x32_bf16 v[112:115], v[172:175], v[92:95], v[112:115]
    v_mfma_f32_16x16x32_bf16 v[96:99], v[176:179], v[80:83], 0
    s_waitcnt vmcnt(6)
    buffer_load_dwordx4 a[48:51], v76, s[52:55], s85 offen offset:0 nt
    v_mfma_f32_16x16x32_bf16 v[96:99], v[180:183], v[84:87], v[96:99]
    v_mfma_f32_16x16x32_bf16 v[96:99], v[184:187], v[88:91], v[96:99]
    s_nop 2
    v_mov_b32_dpp v122, v112 quad_perm:[0,0,0,0] row_mask:0xf bank_mask:0xf
    v_mov_b32_dpp v124, v114 quad_perm:[2,2,2,2] row_mask:0xf bank_mask:0xf
    s_nop 0
    v_add_f32_dpp v122, v113, v122 quad_perm:[1,1,1,1] row_mask:0xf bank_mask:0xf
    v_add_f32_dpp v124, v115, v124 quad_perm:[3,3,3,3] row_mask:0xf bank_mask:0xf
    v_add_f32 v122, v122, v124
    v_max_f32 v65, v65, v122
    ds_write_b32 v64, v122 offset:512
    v_mfma_f32_16x16x32_bf16 v[96:99], v[188:191], v[92:95], v[96:99]
    v_mfma_f32_16x16x32_bf16 v[112:115], v[192:195], v[80:83], 0
    s_waitcnt vmcnt(6)
    buffer_load_dwordx4 a[52:55], v77, s[52:55], s85 offen offset:0 nt
    v_mfma_f32_16x16x32_bf16 v[112:115], v[196:199], v[84:87], v[112:115]
    v_mfma_f32_16x16x32_bf16 v[112:115], v[200:203], v[88:91], v[112:115]
    s_nop 2
    v_mov_b32_dpp v122, v96 quad_perm:[0,0,0,0] row_mask:0xf bank_mask:0xf
    v_mov_b32_dpp v124, v98 quad_perm:[2,2,2,2] row_mask:0xf bank_mask:0xf
    s_nop 0
    v_add_f32_dpp v122, v97, v122 quad_perm:[1,1,1,1] row_mask:0xf bank_mask:0xf
    v_add_f32_dpp v124, v99, v124 quad_perm:[3,3,3,3] row_mask:0xf bank_mask:0xf
    v_add_f32 v122, v122, v124
    v_max_f32 v65, v65, v122
    ds_write_b32 v64, v122 offset:768
    v_mfma_f32_16x16x32_bf16 v[112:115], v[204:207], v[92:95], v[112:115]
    s_waitcnt vmcnt(6)
    buffer_load_dwordx4 a[56:59], v76, s[52:55], s85 offen offset:1024 nt
    v_mfma_f32_16x16x32_bf16 v[96:99], v[208:211], v[80:83], 0
    v_mfma_f32_16x16x32_bf16 v[96:99], v[212:215], v[84:87], v[96:99]
    v_mfma_f32_16x16x32_bf16 v[96:99], v[216:219], v[88:91], v[96:99]
    s_nop 2
    v_mov_b32_dpp v122, v112 quad_perm:[0,0,0,0] row_mask:0xf bank_mask:0xf
    v_mov_b32_dpp v124, v114 quad_perm:[2,2,2,2] row_mask:0xf bank_mask:0xf
    s_nop 0
    v_add_f32_dpp v122, v113, v122 quad_perm:[1,1,1,1] row_mask:0xf bank_mask:0xf
    v_add_f32_dpp v124, v115, v124 quad_perm:[3,3,3,3] row_mask:0xf bank_mask:0xf
    v_add_f32 v122, v122, v124
    v_max_f32 v65, v65, v122
    ds_write_b32 v64, v122 offset:1024
    v_mfma_f32_16x16x32_bf16 v[96:99], v[220:223], v[92:95], v[96:99]
    s_waitcnt vmcnt(6)
    buffer_load_dwordx4 a[60:63], v77, s[52:55], s85 offen offset:1024 nt
    s_add_u32 s87, s87, 7
    s_add_u32 s39, s87, s88
    s_bfe_u32 s37, s39, 0x30000
    s_lshl_b32 s37, s37, 12
    s_add_u32 s85, s37, s89
    s_bfe_u32 s37, s39, 0x10003
    s_lshl_b32 s37, s37, 11
    s_add_u32 s85, s37, s85
    s_bfe_u32 s37, s39, 0x40004
    s_lshl_b32 s37, s37, 16
    s_add_u32 s85, s37, s85
    v_mfma_f32_16x16x32_bf16 v[112:115], v[224:227], v[80:83], 0
    v_mfma_f32_16x16x32_bf16 v[112:115], v[228:231], v[84:87], v[112:115]
    v_mfma_f32_16x16x32_bf16 v[112:115], v[232:235], v[88:91], v[112:115]
    v_mov_b32_dpp v122, v96 quad_perm:[0,0,0,0] row_mask:0xf bank_mask:0xf
    v_mov_b32_dpp v124, v98 quad_perm:[2,2,2,2] row_mask:0xf bank_mask:0xf
    s_nop 0
    v_add_f32_dpp v122, v97, v122 quad_perm:[1,1,1,1] row_mask:0xf bank_mask:0xf
    v_add_f32_dpp v124, v99, v124 quad_perm:[3,3,3,3] row_mask:0xf bank_mask:0xf
    v_add_f32 v122, v122, v124
    v_max_f32 v65, v65, v122
    ds_write_b32 v64, v122 offset:1280
    s_waitcnt vmcnt(5)
    buffer_load_dwordx4 v[128:131], v76, s[52:55], s85 offen offset:0 nt
    v_mfma_f32_16x16x32_bf16 v[112:115], v[236:239], v[92:95], v[112:115]
    v_mfma_f32_16x16x32_bf16 v[96:99], v[240:243], v[80:83], 0
    v_mfma_f32_16x16x32_bf16 v[96:99], v[244:247], v[84:87], v[96:99]
    s_waitcnt vmcnt(5)
    buffer_load_dwordx4 v[132:135], v77, s[52:55], s85 offen offset:0 nt
    v_mfma_f32_16x16x32_bf16 v[96:99], v[248:251], v[88:91], v[96:99]
    s_nop 2
    v_mov_b32_dpp v122, v112 quad_perm:[0,0,0,0] row_mask:0xf bank_mask:0xf
    v_mov_b32_dpp v124, v114 quad_perm:[2,2,2,2] row_mask:0xf bank_mask:0xf
    s_nop 0
    v_add_f32_dpp v122, v113, v122 quad_perm:[1,1,1,1] row_mask:0xf bank_mask:0xf
    v_add_f32_dpp v124, v115, v124 quad_perm:[3,3,3,3] row_mask:0xf bank_mask:0xf
    v_add_f32 v122, v122, v124
    v_max_f32 v65, v65, v122
    ds_write_b32 v64, v122 offset:1536
    v_mfma_f32_16x16x32_bf16 v[96:99], v[252:255], v[92:95], v[96:99]
    v_mfma_f32_16x16x32_bf16 v[112:115], a[0:3], v[80:83], 0
    v_mfma_f32_16x16x32_bf16 v[112:115], a[4:7], v[84:87], v[112:115]
    s_waitcnt vmcnt(5)
    buffer_load_dwordx4 v[136:139], v76, s[52:55], s85 offen offset:1024 nt
    v_mfma_f32_16x16x32_bf16 v[112:115], a[8:11], v[88:91], v[112:115]
    s_nop 2
    v_mov_b32_dpp v122, v96 quad_perm:[0,0,0,0] row_mask:0xf bank_mask:0xf
    v_mov_b32_dpp v124, v98 quad_perm:[2,2,2,2] row_mask:0xf bank_mask:0xf
    s_nop 0
    v_add_f32_dpp v122, v97, v122 quad_perm:[1,1,1,1] row_mask:0xf bank_mask:0xf
    v_add_f32_dpp v124, v99, v124 quad_perm:[3,3,3,3] row_mask:0xf bank_mask:0xf
    v_add_f32 v122, v122, v124
    v_max_f32 v65, v65, v122
    ds_write_b32 v64, v122 offset:1792
    v_mfma_f32_16x16x32_bf16 v[112:115], a[12:15], v[92:95], v[112:115]
    v_mfma_f32_16x16x32_bf16 v[96:99], a[16:19], v[80:83], 0
    s_waitcnt vmcnt(5)
    buffer_load_dwordx4 v[140:143], v77, s[52:55], s85 offen offset:1024 nt
    s_add_u32 s87, s87, 7
    s_add_u32 s39, s87, s88
    s_bfe_u32 s37, s39, 0x30000
    s_lshl_b32 s37, s37, 12
    s_add_u32 s85, s37, s89
    s_bfe_u32 s37, s39, 0x10003
    s_lshl_b32 s37, s37, 11
    s_add_u32 s85, s37, s85
    s_bfe_u32 s37, s39, 0x40004
    s_lshl_b32 s37, s37, 16
    s_add_u32 s85, s37, s85
    v_mfma_f32_16x16x32_bf16 v[96:99], a[20:23], v[84:87], v[96:99]
    v_mfma_f32_16x16x32_bf16 v[96:99], a[24:27], v[88:91], v[96:99]
    v_mov_b32_dpp v122, v112 quad_perm:[0,0,0,0] row_mask:0xf bank_mask:0xf
    v_mov_b32_dpp v124, v114 quad_perm:[2,2,2,2] row_mask:0xf bank_mask:0xf
    s_nop 0
    v_add_f32_dpp v122, v113, v122 quad_perm:[1,1,1,1] row_mask:0xf bank_mask:0xf
    v_add_f32_dpp v124, v115, v124 quad_perm:[3,3,3,3] row_mask:0xf bank_mask:0xf
    v_add_f32 v122, v122, v124
    v_max_f32 v65, v65, v122
    ds_write_b32 v64, v122 offset:2048
    v_mfma_f32_16x16x32_bf16 v[96:99], a[28:31], v[92:95], v[96:99]
    v_mfma_f32_16x16x32_bf16 v[112:115], a[32:35], v[80:83], 0
    s_waitcnt vmcnt(5)
    buffer_load_dwordx4 v[144:147], v76, s[52:55], s85 offen offset:0 nt
    v_mfma_f32_16x16x32_bf16 v[112:115], a[36:39], v[84:87], v[112:115]
    v_mfma_f32_16x16x32_bf16 v[112:115], a[40:43], v[88:91], v[112:115]
    s_nop 2
    v_mov_b32_dpp v122, v96 quad_perm:[0,0,0,0] row_mask:0xf bank_mask:0xf
    v_mov_b32_dpp v124, v98 quad_perm:[2,2,2,2] row_mask:0xf bank_mask:0xf
    s_nop 0
    v_add_f32_dpp v122, v97, v122 quad_perm:[1,1,1,1] row_mask:0xf bank_mask:0xf
    v_add_f32_dpp v124, v99, v124 quad_perm:[3,3,3,3] row_mask:0xf bank_mask:0xf
    v_add_f32 v122, v122, v124
    v_max_f32 v65, v65, v122
    ds_write_b32 v64, v122 offset:2304
    v_mfma_f32_16x16x32_bf16 v[112:115], a[44:47], v[92:95], v[112:115]
    s_waitcnt vmcnt(5)
    buffer_load_dwordx4 v[148:151], v77, s[52:55], s85 offen offset:0 nt
    v_mfma_f32_16x16x32_bf16 v[96:99], a[48:51], v[80:83], 0
    v_mfma_f32_16x16x32_bf16 v[96:99], a[52:55], v[84:87], v[96:99]
    v_mfma_f32_16x16x32_bf16 v[96:99], a[56:59], v[88:91], v[96:99]
    s_nop 2
    v_mov_b32_dpp v122, v112 quad_perm:[0,0,0,0] row_mask:0xf bank_mask:0xf
    v_mov_b32_dpp v124, v114 quad_perm:[2,2,2,2] row_mask:0xf bank_mask:0xf
    s_nop 0
    v_add_f32_dpp v122, v113, v122 quad_perm:[1,1,1,1] row_mask:0xf bank_mask:0xf
    v_add_f32_dpp v124, v115, v124 quad_perm:[3,3,3,3] row_mask:0xf bank_mask:0xf
    v_add_f32 v122, v122, v124
    v_max_f32 v65, v65, v122
    ds_write_b32 v64, v122 offset:2560
    v_mfma_f32_16x16x32_bf16 v[96:99], a[60:63], v[92:95], v[96:99]
    v_add_u32 v64, 2816, v64
    s_mov_b32 s97, 10
    s_mov_b32 s86, 32
    s_mov_b32 s66, 134217728
    s_mov_b32 s67, 0x20000
    s_mov_b64 s[64:65], s[52:53]
    v_mov_b32 v62, v76
    v_mov_b32 v63, v77
L_bloop:
    s_waitcnt vmcnt(5)
    buffer_load_dwordx4 v[152:155], v62, s[64:67], s85 offen offset:1024 nt
    v_mfma_f32_16x16x32_bf16 v[112:115], v[128:131], v[80:83], 0
    s_waitcnt vmcnt(5)
    buffer_load_dwordx4 v[156:159], v63, s[64:67], s85 offen offset:1024 nt
    v_mfma_f32_16x16x32_bf16 v[112:115], v[132:135], v[84:87], v[112:115]
    s_add_u32 s87, s87, 7
    s_cmp_lg_u32 s97, 1
    s_cbranch_scc1 L_stayk_3
    s_mov_b64 s[64:65], s[56:57]
    v_mov_b32 v62, v126
    v_mov_b32 v63, v127
    s_mul_i32 s37, s86, 7
    s_sub_u32 s87, s87, s37
L_stayk_3:
    s_add_u32 s39, s87, s88
    s_bfe_u32 s37, s39, 0x30000
    s_lshl_b32 s37, s37, 12
    s_add_u32 s85, s37, s89
    s_bfe_u32 s37, s39, 0x10003
    s_lshl_b32 s37, s37, 11
    s_add_u32 s85, s37, s85
    s_bfe_u32 s37, s39, 0x40004
    s_lshl_b32 s37, s37, 16
    s_add_u32 s85, s37, s85
    v_mov_b32_dpp v122, v96 quad_perm:[0,0,0,0] row_mask:0xf bank_mask:0xf
    v_mov_b32_dpp v124, v98 quad_perm:[2,2,2,2] row_mask:0xf bank_mask:0xf
    s_nop 0
    v_add_f32_dpp v122, v97, v122 quad_perm:[1,1,1,1] row_mask:0xf bank_mask:0xf
    v_add_f32_dpp v124, v99, v124 quad_perm:[3,3,3,3] row_mask:0xf bank_mask:0xf
    v_add_f32 v122, v122, v124
    v_max_f32 v65, v65, v122
    ds_write_b32 v64, v122 offset:0
    s_waitcnt vmcnt(5)
    buffer_load_dwordx4 v[128:131], v62, s[64:67], s85 offen offset:0 nt
    v_mfma_f32_16x16x32_bf16 v[112:115], v[136:139], v[88:91], v[112:115]
    s_waitcnt vmcnt(5)
    buffer_load_dwordx4 v[132:135], v63, s[64:67], s85 offen offset:0 nt
    v_mfma_f32_16x16x32_bf16 v[112:115], v[140:143], v[92:95], v[112:115]
    s_waitcnt vmcnt(5)
    buffer_load_dwordx4 v[136:139], v62, s[64:67], s85 offen offset:1024 nt
    v_mfma_f32_16x16x32_bf16 v[96:99], v[144:147], v[80:83], 0
    s_waitcnt vmcnt(5)
    buffer_load_dwordx4 v[140:143], v63, s[64:67], s85 offen offset:1024 nt
    v_mfma_f32_16x16x32_bf16 v[96:99], v[148:151], v[84:87], v[96:99]
    s_add_u32 s87, s87, 7
    s_add_u32 s39, s87, s88
    s_bfe_u32 s37, s39, 0x30000
    s_lshl_b32 s37, s37, 12
    s_add_u32 s85, s37, s89
    s_bfe_u32 s37, s39, 0x10003
    s_lshl_b32 s37, s37, 11
    s_add_u32 s85, s37, s85
    s_bfe_u32 s37, s39, 0x40004
    s_lshl_b32 s37, s37, 16
    s_add_u32 s85, s37, s85
    v_mov_b32_dpp v122, v112 quad_perm:[0,0,0,0] row_mask:0xf bank_mask:0xf
    v_mov_b32_dpp v124, v114 quad_perm:[2,2,2,2] row_mask:0xf bank_mask:0xf
    s_nop 0
    v_add_f32_dpp v122, v113, v122 quad_perm:[1,1,1,1] row_mask:0xf bank_mask:0xf
    v_add_f32_dpp v124, v115, v124 quad_perm:[3,3,3,3] row_mask:0xf bank_mask:0xf
    v_add_f32 v122, v122, v124
    v_max_f32 v65, v65, v122
    ds_write_b32 v64, v122 offset:256
    s_waitcnt vmcnt(5)
    buffer_load_dwordx4 v[144:147], v62, s[64:67], s85 offen offset:0 nt
    v_mfma_f32_16x16x32_bf16 v[96:99], v[152:155], v[88:91], v[96:99]
    s_waitcnt vmcnt(5)
    buffer_load_dwordx4 v[148:151], v63, s[64:67], s85 offen offset:0 nt
    v_mfma_f32_16x16x32_bf16 v[96:99], v[156:159], v[92:95], v[96:99]
    v_add_u32 v64, 512, v64
    s_sub_u32 s97, s97, 1
    s_cmp_lg_u32 s97, 0
    s_cbranch_scc1 L_bloop
    s_nop 3
    v_mov_b32_dpp v122, v96 quad_perm:[0,0,0,0] row_mask:0xf bank_mask:0xf
    v_mov_b32_dpp v124, v98 quad_perm:[2,2,2,2] row_mask:0xf bank_mask:0xf
    s_nop 0
    v_add_f32_dpp v122, v97, v122 quad_perm:[1,1,1,1] row_mask:0xf bank_mask:0xf
    v_add_f32_dpp v124, v99, v124 quad_perm:[3,3,3,3] row_mask:0xf bank_mask:0xf
    v_add_f32 v122, v122, v124
    v_max_f32 v65, v65, v122
    ds_write_b32 v64, v122 offset:0
    v_mov_b32 v123, 0xff7f0000
    ds_write_b32 v64, v123 offset:256
    s_lshl_b32 s38, s34, 14
    s_add_u32 s38, s38, 16384
    v_lshl_add_u32 v64, v1, 2, s38
    ds_read_b32 v66, v64
    ds_read_b32 v67, v64 offset:256
    v_mul_f32 v65, s83, v65
    s_nop 1
    v_max_f32_dpp v124, v65, v65 row_ror:4 row_mask:0xf bank_mask:0xf
    s_nop 1
    v_max_f32_dpp v124, v124, v124 row_ror:8 row_mask:0xf bank_mask:0xf
    v_mov_b32 v125, v124
    s_nop 1
    v_permlane16_swap_b32 v124, v125
    v_max_f32 v124, v124, v125
    v_mov_b32 v125, v124
    s_nop 1
    v_permlane32_swap_b32 v124, v125
    v_max_f32 v124, v124, v125
    v_and_b32 v120, s82, v124
    s_lshr_b32 s97, s86, 1
    s_waitcnt lgkmcnt(1)
    v_fma_f32 v123, v66, s83, -v120
    v_exp_f32 v123, v123
    ds_read_b32 v66, v64 offset:512
    v_cvt_pk_bf16_f32 v100, v123, v123
    v_add_f32 v121, v121, v123
L_vloop:
    s_nop 0
    v_and_b32_dpp v104, v100, v10 row_newbcast:0 row_mask:0xf bank_mask:0xf
    v_and_b32_dpp v105, v100, v11 row_newbcast:0 row_mask:0xf bank_mask:0xf
    v_and_b32_dpp v106, v100, v12 row_newbcast:0 row_mask:0xf bank_mask:0xf
    v_and_b32_dpp v107, v100, v13 row_newbcast:0 row_mask:0xf bank_mask:0xf
    s_waitcnt vmcnt(5)
    buffer_load_dwordx4 v[152:155], v62, s[64:67], s85 offen offset:1024 nt
    v_mfma_f32_16x16x32_bf16 v[116:119], v[128:131], v[104:107], v[116:119]
    v_and_b32_dpp v108, v100, v10 row_newbcast:4 row_mask:0xf bank_mask:0xf
    v_and_b32_dpp v109, v100, v11 row_newbcast:4 row_mask:0xf bank_mask:0xf
    v_and_b32_dpp v110, v100, v12 row_newbcast:4 row_mask:0xf bank_mask:0xf
    v_and_b32_dpp v111, v100, v13 row_newbcast:4 row_mask:0xf bank_mask:0xf
    s_waitcnt vmcnt(5)
    buffer_load_dwordx4 v[156:159], v63, s[64:67], s85 offen offset:1024 nt
    v_mfma_f32_16x16x32_bf16 v[116:119], v[132:135], v[108:111], v[116:119]
    s_add_u32 s87, s87, 7
    s_cmp_lg_u32 s97, 1
    s_cbranch_scc1 L_stayv_4
    s_mov_b64 s[64:65], s[52:53]
    v_mov_b32 v62, v76
    v_mov_b32 v63, v77
    s_mov_b64 exec, 1
    global_atomic_add v19, v9, v18, s[30:31] sc0 sc1
    s_mov_b64 exec, -1
    s_add_u32 s87, s33, 224
L_stayv_4:
    s_add_u32 s39, s87, s88
    s_bfe_u32 s37, s39, 0x30000
    s_lshl_b32 s37, s37, 12
    s_add_u32 s85, s37, s89
    s_bfe_u32 s37, s39, 0x10003
    s_lshl_b32 s37, s37, 11
    s_add_u32 s85, s37, s85
    s_bfe_u32 s37, s39, 0x40004
    s_lshl_b32 s37, s37, 16
    s_add_u32 s85, s37, s85
    s_waitcnt lgkmcnt(1)
    v_fma_f32 v123, v67, s83, -v120
    v_exp_f32 v123, v123
    ds_read_b32 v67, v64 offset:768
    v_cvt_pk_bf16_f32 v101, v123, v123
    v_add_f32 v121, v121, v123
    v_and_b32_dpp v104, v100, v10 row_newbcast:8 row_mask:0xf bank_mask:0xf
    v_and_b32_dpp v105, v100, v11 row_newbcast:8 row_mask:0xf bank_mask:0xf
    v_and_b32_dpp v106, v100, v12 row_newbcast:8 row_mask:0xf bank_mask:0xf
    v_and_b32_dpp v107, v100, v13 row_newbcast:8 row_mask:0xf bank_mask:0xf
    s_waitcnt vmcnt(5)
    buffer_load_dwordx4 v[128:131], v62, s[64:67], s85 offen offset:0 nt
    v_mfma_f32_16x16x32_bf16 v[116:119], v[136:139], v[104:107], v[116:119]
    v_and_b32_dpp v108, v100, v10 row_newbcast:12 row_mask:0xf bank_mask:0xf
    v_and_b32_dpp v109, v100, v11 row_newbcast:12 row_mask:0xf bank_mask:0xf
    v_and_b32_dpp v110, v100, v12 row_newbcast:12 row_mask:0xf bank_mask:0xf
    v_and_b32_dpp v111, v100, v13 row_newbcast:12 row_mask:0xf bank_mask:0xf
    s_waitcnt vmcnt(5)
    buffer_load_dwordx4 v[132:135], v63, s[64:67], s85 offen offset:0 nt
    v_mfma_f32_16x16x32_bf16 v[116:119], v[140:143], v[108:111], v[116:119]
    v_and_b32_dpp v104, v101, v10 row_newbcast:0 row_mask:0xf bank_mask:0xf
    v_and_b32_dpp v105, v101, v11 row_newbcast:0 row_mask:0xf bank_mask:0xf
    v_and_b32_dpp v106, v101, v12 row_newbcast:0 row_mask:0xf bank_mask:0xf
    v_and_b32_dpp v107, v101, v13 row_newbcast:0 row_mask:0xf bank_mask:0xf
    s_waitcnt vmcnt(5)
    buffer_load_dwordx4 v[136:139], v62, s[64:67], s85 offen offset:1024 nt
    v_mfma_f32_16x16x32_bf16 v[116:119], v[144:147], v[104:107], v[116:119]
    v_and_b32_dpp v108, v101, v10 row_newbcast:4 row_mask:0xf bank_mask:0xf
    v_and_b32_dpp v109, v101, v11 row_newbcast:4 row_mask:0xf bank_mask:0xf
    v_and_b32_dpp v110, v101, v12 row_newbcast:4 row_mask:0xf bank_mask:0xf
    v_and_b32_dpp v111, v101, v13 row_newbcast:4 row_mask:0xf bank_mask:0xf
    s_waitcnt vmcnt(5)
    buffer_load_dwordx4 v[140:143], v63, s[64:67], s85 offen offset:1024 nt
    v_mfma_f32_16x16x32_bf16 v[116:119], v[148:151], v[108:111], v[116:119]
    s_add_u32 s87, s87, 7
    s_cmp_lg_u32 s97, 1
    s_cbranch_scc1 L_stayv_5
    s_mov_b64 s[64:65], s[56:57]
    v_mov_b32 v62, v126
    v_mov_b32 v63, v127
    s_add_u32 s87, s33, 224
L_stayv_5:
    s_add_u32 s39, s87, s88
    s_bfe_u32 s37, s39, 0x30000
    s_lshl_b32 s37, s37, 12
    s_add_u32 s85, s37, s89
    s_bfe_u32 s37, s39, 0x10003
    s_lshl_b32 s37, s37, 11
    s_add_u32 s85, s37, s85
    s_bfe_u32 s37, s39, 0x40004
    s_lshl_b32 s37, s37, 16
    s_add_u32 s85, s37, s85
    v_add_u32 v64, 512, v64
    s_waitcnt lgkmcnt(1)
    v_fma_f32 v123, v66, s83, -v120
    v_exp_f32 v123, v123
    ds_read_b32 v66, v64 offset:512
    v_cvt_pk_bf16_f32 v100, v123, v123
    v_add_f32 v121, v121, v123
    v_and_b32_dpp v104, v101, v10 row_newbcast:8 row_mask:0xf bank_mask:0xf
    v_and_b32_dpp v105, v101, v11 row_newbcast:8 row_mask:0xf bank_mask:0xf
    v_and_b32_dpp v106, v101, v12 row_newbcast:8 row_mask:0xf bank_mask:0xf
    v_and_b32_dpp v107, v101, v13 row_newbcast:8 row_mask:0xf bank_mask:0xf
    s_waitcnt vmcnt(5)
    buffer_load_dwordx4 v[144:147], v62, s[64:67], s85 offen offset:0 nt
    v_mfma_f32_16x16x32_bf16 v[116:119], v[152:155], v[104:107], v[116:119]
    v_and_b32_dpp v108, v101, v10 row_newbcast:12 row_mask:0xf bank_mask:0xf
    v_and_b32_dpp v109, v101, v11 row_newbcast:12 row_mask:0xf bank_mask:0xf
    v_and_b32_dpp v110, v101, v12 row_newbcast:12 row_mask:0xf bank_mask:0xf
    v_and_b32_dpp v111, v101, v13 row_newbcast:12 row_mask:0xf bank_mask:0xf
    s_waitcnt vmcnt(5)
    buffer_load_dwordx4 v[148:151], v63, s[64:67], s85 offen offset:0 nt
    v_mfma_f32_16x16x32_bf16 v[116:119], v[156:159], v[108:111], v[116:119]
    s_sub_u32 s97, s97, 1
    s_cmp_lg_u32 s97, 0
    s_cbranch_scc1 L_vloop
    buffer_load_dwordx4 v[152:155], v126, s[56:59], s85 offen offset:1024 nt
    buffer_load_dwordx4 v[156:159], v127, s[56:59], s85 offen offset:1024 nt
L_dloop:
    s_waitcnt vmcnt(7)
    v_readfirstlane_b32 s93, v19
    s_nop 0
    s_add_u32 s87, s93, 231
    s_add_u32 s39, s87, s88
    s_bfe_u32 s37, s39, 0x30000
    s_lshl_b32 s37, s37, 12
    s_add_u32 s86, s37, s89
    s_bfe_u32 s37, s39, 0x10003
    s_lshl_b32 s37, s37, 11
    s_add_u32 s86, s37, s86
    s_bfe_u32 s37, s39, 0x40004
    s_lshl_b32 s37, s37, 16
    s_add_u32 s86, s37, s86
    s_cmp_ge_u32 s93, 25
    s_cselect_b32 s86, 134217728, s86
    v_mov_b32 v19, 25
    s_cmp_ge_u32 s93, 24
    s_cbranch_scc1 L_noclaim_6
    s_mov_b64 exec, 1
    global_atomic_add v19, v9, v18, s[30:31] sc0 sc1
    s_mov_b64 exec, -1
L_noclaim_6:
    buffer_load_dwordx4 v[160:163], v76, s[52:55], s86 offen offset:0 nt
    v_mfma_f32_16x16x32_bf16 v[112:115], v[128:131], v[80:83], 0
    s_waitcnt vmcnt(7)
    buffer_load_dwordx4 v[164:167], v77, s[52:55], s86 offen offset:0 nt
    v_mfma_f32_16x16x32_bf16 v[112:115], v[132:135], v[84:87], v[112:115]
    s_waitcnt vmcnt(7)
    buffer_load_dwordx4 v[168:171], v76, s[52:55], s86 offen offset:1024 nt
    v_mfma_f32_16x16x32_bf16 v[112:115], v[136:139], v[88:91], v[112:115]
    s_waitcnt vmcnt(7)
    buffer_load_dwordx4 v[172:175], v77, s[52:55], s86 offen offset:1024 nt
    v_mfma_f32_16x16x32_bf16 v[112:115], v[140:143], v[92:95], v[112:115]
    s_nop 7
    v_mov_b32_dpp v122, v112 quad_perm:[0,0,0,0] row_mask:0xf bank_mask:0xf
    v_mov_b32_dpp v124, v114 quad_perm:[2,2,2,2] row_mask:0xf bank_mask:0xf
    s_nop 0
    v_add_f32_dpp v122, v113, v122 quad_perm:[1,1,1,1] row_mask:0xf bank_mask:0xf
    v_add_f32_dpp v124, v115, v124 quad_perm:[3,3,3,3] row_mask:0xf bank_mask:0xf
    v_add_f32 v122, v122, v124
    v_fma_f32 v123, v122, s83, -v120
    v_cmp_lt_f32 vcc, 0, v123
    s_cbranch_vccz L_nomax_7
    v_mul_f32 v122, s83, v122
    s_nop 1
    v_max_f32_dpp v124, v122, v122 row_ror:4 row_mask:0xf bank_mask:0xf
    s_nop 1
    v_max_f32_dpp v124, v124, v124 row_ror:8 row_mask:0xf bank_mask:0xf
    v_mov_b32 v125, v124
    s_nop 1
    v_permlane16_swap_b32 v124, v125
    v_max_f32 v124, v124, v125
    v_mov_b32 v125, v124
    s_nop 1
    v_permlane32_swap_b32 v124, v125
    v_max_f32 v124, v124, v125
    v_and_b32 v124, s82, v124
    v_max_f32 v124, v124, v120
    v_sub_f32 v125, v120, v124
    v_exp_f32 v125, v125
    v_mov_b32 v120, v124
    v_sub_f32 v123, v122, v124
    v_mul_f32 v121, v121, v125
    v_mul_f32 v116, v116, v125
    v_mul_f32 v117, v117, v125
    v_mul_f32 v118, v118, v125
    v_mul_f32 v119, v119, v125
L_nomax_7:
    v_exp_f32 v123, v123
    s_nop 0
    v_cvt_pk_bf16_f32 v124, v123, v123
    v_add_f32 v121, v121, v123
    s_nop 0
    v_and_b32_dpp v96, v124, v10 row_newbcast:0 row_mask:0xf bank_mask:0xf
    v_and_b32_dpp v97, v124, v11 row_newbcast:0 row_mask:0xf bank_mask:0xf
    v_and_b32_dpp v98, v124, v12 row_newbcast:0 row_mask:0xf bank_mask:0xf
    v_and_b32_dpp v99, v124, v13 row_newbcast:0 row_mask:0xf bank_mask:0xf
    v_and_b32_dpp v100, v124, v10 row_newbcast:4 row_mask:0xf bank_mask:0xf
    v_and_b32_dpp v101, v124, v11 row_newbcast:4 row_mask:0xf bank_mask:0xf
    v_and_b32_dpp v102, v124, v12 row_newbcast:4 row_mask:0xf bank_mask:0xf
    v_and_b32_dpp v103, v124, v13 row_newbcast:4 row_mask:0xf bank_mask:0xf
    v_and_b32_dpp v104, v124, v10 row_newbcast:8 row_mask:0xf bank_mask:0xf
    v_and_b32_dpp v105, v124, v11 row_newbcast:8 row_mask:0xf bank_mask:0xf
    v_and_b32_dpp v106, v124, v12 row_newbcast:8 row_mask:0xf bank_mask:0xf
    v_and_b32_dpp v107, v124, v13 row_newbcast:8 row_mask:0xf bank_mask:0xf
    v_and_b32_dpp v108, v124, v10 row_newbcast:12 row_mask:0xf bank_mask:0xf
    v_and_b32_dpp v109, v124, v11 row_newbcast:12 row_mask:0xf bank_mask:0xf
    v_and_b32_dpp v110, v124, v12 row_newbcast:12 row_mask:0xf bank_mask:0xf
    v_and_b32_dpp v111, v124, v13 row_newbcast:12 row_mask:0xf bank_mask:0xf
    s_waitcnt vmcnt(7)
    buffer_load_dwordx4 v[176:179], v126, s[56:59], s86 offen offset:0 nt
    v_mfma_f32_16x16x32_bf16 v[116:119], v[144:147], v[96:99], v[116:119]
    s_waitcnt vmcnt(7)
    buffer_load_dwordx4 v[180:183], v127, s[56:59], s86 offen offset:0 nt
    v_mfma_f32_16x16x32_bf16 v[116:119], v[148:151], v[100:103], v[116:119]
    s_waitcnt vmcnt(7)
    buffer_load_dwordx4 v[184:187], v126, s[56:59], s86 offen offset:1024 nt
    v_mfma_f32_16x16x32_bf16 v[116:119], v[152:155], v[104:107], v[116:119]
    s_waitcnt vmcnt(7)
    buffer_load_dwordx4 v[188:191], v127, s[56:59], s86 offen offset:1024 nt
    v_mfma_f32_16x16x32_bf16 v[116:119], v[156:159], v[108:111], v[116:119]
    s_cmp_ge_u32 s93, 25
    s_cbranch_scc1 L_bdone
    s_waitcnt vmcnt(7)
    v_readfirstlane_b32 s93, v19
    s_nop 0
    s_add_u32 s87, s93, 231
    s_add_u32 s39, s87, s88
    s_bfe_u32 s37, s39, 0x30000
    s_lshl_b32 s37, s37, 12
    s_add_u32 s85, s37, s89
    s_bfe_u32 s37, s39, 0x10003
    s_lshl_b32 s37, s37, 11
    s_add_u32 s85, s37, s85
    s_bfe_u32 s37, s39, 0x40004
    s_lshl_b32 s37, s37, 16
    s_add_u32 s85, s37, s85
    s_cmp_ge_u32 s93, 25
    s_cselect_b32 s85, 134217728, s85
    v_mov_b32 v19, 25
    s_cmp_ge_u32 s93, 24
    s_cbranch_scc1 L_noclaim_8
    s_mov_b64 exec, 1
    global_atomic_add v19, v9, v18, s[30:31] sc0 sc1
    s_mov_b64 exec, -1
L_noclaim_8:
    buffer_load_dwordx4 v[128:131], v76, s[52:55], s85 offen offset:0 nt
    v_mfma_f32_16x16x32_bf16 v[112:115], v[160:163], v[80:83], 0
    s_waitcnt vmcnt(7)
    buffer_load_dwordx4 v[132:135], v77, s[52:55], s85 offen offset:0 nt
    v_mfma_f32_16x16x32_bf16 v[112:115], v[164:167], v[84:87], v[112:115]
    s_waitcnt vmcnt(7)
    buffer_load_dwordx4 v[136:139], v76, s[52:55], s85 offen offset:1024 nt
    v_mfma_f32_16x16x32_bf16 v[112:115], v[168:171], v[88:91], v[112:115]
    s_waitcnt vmcnt(7)
    buffer_load_dwordx4 v[140:143], v77, s[52:55], s85 offen offset:1024 nt
    v_mfma_f32_16x16x32_bf16 v[112:115], v[172:175], v[92:95], v[112:115]
    s_nop 7
    v_mov_b32_dpp v122, v112 quad_perm:[0,0,0,0] row_mask:0xf bank_mask:0xf
    v_mov_b32_dpp v124, v114 quad_perm:[2,2,2,2] row_mask:0xf bank_mask:0xf
    s_nop 0
    v_add_f32_dpp v122, v113, v122 quad_perm:[1,1,1,1] row_mask:0xf bank_mask:0xf
    v_add_f32_dpp v124, v115, v124 quad_perm:[3,3,3,3] row_mask:0xf bank_mask:0xf
    v_add_f32 v122, v122, v124
    v_fma_f32 v123, v122, s83, -v120
    v_cmp_lt_f32 vcc, 0, v123
    s_cbranch_vccz L_nomax_9
    v_mul_f32 v122, s83, v122
    s_nop 1
    v_max_f32_dpp v124, v122, v122 row_ror:4 row_mask:0xf bank_mask:0xf
    s_nop 1
    v_max_f32_dpp v124, v124, v124 row_ror:8 row_mask:0xf bank_mask:0xf
    v_mov_b32 v125, v124
    s_nop 1
    v_permlane16_swap_b32 v124, v125
    v_max_f32 v124, v124, v125
    v_mov_b32 v125, v124
    s_nop 1
    v_permlane32_swap_b32 v124, v125
    v_max_f32 v124, v124, v125
    v_and_b32 v124, s82, v124
    v_max_f32 v124, v124, v120
    v_sub_f32 v125, v120, v124
    v_exp_f32 v125, v125
    v_mov_b32 v120, v124
    v_sub_f32 v123, v122, v124
    v_mul_f32 v121, v121, v125
    v_mul_f32 v116, v116, v125
    v_mul_f32 v117, v117, v125
    v_mul_f32 v118, v118, v125
    v_mul_f32 v119, v119, v125
L_nomax_9:
    v_exp_f32 v123, v123
    s_nop 0
    v_cvt_pk_bf16_f32 v124, v123, v123
    v_add_f32 v121, v121, v123
    s_nop 0
    v_and_b32_dpp v96, v124, v10 row_newbcast:0 row_mask:0xf bank_mask:0xf
    v_and_b32_dpp v97, v124, v11 row_newbcast:0 row_mask:0xf bank_mask:0xf
    v_and_b32_dpp v98, v124, v12 row_newbcast:0 row_mask:0xf bank_mask:0xf
    v_and_b32_dpp v99, v124, v13 row_newbcast:0 row_mask:0xf bank_mask:0xf
    v_and_b32_dpp v100, v124, v10 row_newbcast:4 row_mask:0xf bank_mask:0xf
    v_and_b32_dpp v101, v124, v11 row_newbcast:4 row_mask:0xf bank_mask:0xf
    v_and_b32_dpp v102, v124, v12 row_newbcast:4 row_mask:0xf bank_mask:0xf
    v_and_b32_dpp v103, v124, v13 row_newbcast:4 row_mask:0xf bank_mask:0xf
    v_and_b32_dpp v104, v124, v10 row_newbcast:8 row_mask:0xf bank_mask:0xf
    v_and_b32_dpp v105, v124, v11 row_newbcast:8 row_mask:0xf bank_mask:0xf
    v_and_b32_dpp v106, v124, v12 row_newbcast:8 row_mask:0xf bank_mask:0xf
    v_and_b32_dpp v107, v124, v13 row_newbcast:8 row_mask:0xf bank_mask:0xf
    v_and_b32_dpp v108, v124, v10 row_newbcast:12 row_mask:0xf bank_mask:0xf
    v_and_b32_dpp v109, v124, v11 row_newbcast:12 row_mask:0xf bank_mask:0xf
    v_and_b32_dpp v110, v124, v12 row_newbcast:12 row_mask:0xf bank_mask:0xf
    v_and_b32_dpp v111, v124, v13 row_newbcast:12 row_mask:0xf bank_mask:0xf
    s_waitcnt vmcnt(7)
    buffer_load_dwordx4 v[144:147], v126, s[56:59], s85 offen offset:0 nt
    v_mfma_f32_16x16x32_bf16 v[116:119], v[176:179], v[96:99], v[116:119]
    s_waitcnt vmcnt(7)
    buffer_load_dwordx4 v[148:151], v127, s[56:59], s85 offen offset:0 nt
    v_mfma_f32_16x16x32_bf16 v[116:119], v[180:183], v[100:103], v[116:119]
    s_waitcnt vmcnt(7)
    buffer_load_dwordx4 v[152:155], v126, s[56:59], s85 offen offset:1024 nt
    v_mfma_f32_16x16x32_bf16 v[116:119], v[184:187], v[104:107], v[116:119]
    s_waitcnt vmcnt(7)
    buffer_load_dwordx4 v[156:159], v127, s[56:59], s85 offen offset:1024 nt
    v_mfma_f32_16x16x32_bf16 v[116:119], v[188:191], v[108:111], v[116:119]
    s_cmp_ge_u32 s93, 25
    s_cbranch_scc0 L_dloop
L_bdone:
    v_add_f32_dpp v121, v121, v121 row_ror:8 row_mask:0xf bank_mask:0xf
    s_nop 1
    v_add_f32_dpp v121, v121, v121 row_ror:4 row_mask:0xf bank_mask:0xf
    v_mov_b32 v125, v121
    s_nop 1
    v_permlane16_swap_b32 v121, v125
    v_add_f32 v121, v121, v125
    v_mov_b32 v125, v121
    v_and_or_b32 v118, v118, s82, v8
    v_and_or_b32 v119, v119, s82, v8
    v_permlane32_swap_b32 v121, v125
    s_mov_b32 exec_lo, 0x100
    s_mov_b32 exec_hi, 0x0
    v_add_f32 v117, v121, v125
    v_mov_b32 v116, v120
    s_mov_b32 exec_lo, 0xff01ff
    s_mov_b32 exec_hi, 0xff00ff
    v_and_or_b32 v116, v116, s82, v8
    v_and_or_b32 v117, v117, s82, v8
    buffer_store_dwordx4 v[116:119], v79, s[48:51], s96 offen sc1
    s_endpgm
L_qp:
    v_lshlrev_b32 v4, 18, v2
    v_lshl_add_u32 v14, v3, 4, v4
    v_lshrrev_b32 v5, 3, v3
    v_lshlrev_b32 v5, 10, v5
    v_lshl_add_u32 v15, v2, 6, v5
    s_cmp_eq_u32 s33, 0
    s_cselect_b32 s61, 3, 2
    s_xor_b32 s61, s61, s32
    s_lshl_b32 s86, s34, 8
    s_lshl_b32 s63, s34, 20
    s_lshl_b32 s38, s61, 8
    s_add_u32 s63, s63, s38
    s_mov_b32 s42, 4194304
    s_mov_b32 s43, 0x20000
    s_mov_b32 s46, 4096
    s_mov_b32 s47, 0x20000
    s_cmp_eq_u32 s33, 0
    s_waitcnt lgkmcnt(0)
    s_cselect_b64 s[40:41], s[22:23], s[8:9]
    s_cselect_b64 s[44:45], s[16:17], s[4:5]
    buffer_load_dwordx4 a[128:131], v14, s[40:43], s63 offen nt
    s_add_u32 s63, s63, 8192
    buffer_load_dwordx4 a[132:135], v14, s[40:43], s63 offen nt
    s_add_u32 s63, s63, 8192
    buffer_load_dwordx4 v[20:23], v15, s[44:47], s86 offen offset:0
    buffer_load_dwordx4 v[36:39], v15, s[44:47], s86 offen offset:2048
    buffer_load_dwordx4 a[136:139], v14, s[40:43], s63 offen nt
    s_add_u32 s63, s63, 8192
    buffer_load_dwordx4 a[140:143], v14, s[40:43], s63 offen nt
    s_add_u32 s63, s63, 8192
    buffer_load_dwordx4 a[144:147], v14, s[40:43], s63 offen nt
    s_add_u32 s63, s63, 8192
    buffer_load_dwordx4 a[148:151], v14, s[40:43], s63 offen nt
    s_add_u32 s63, s63, 8192
    buffer_load_dwordx4 a[152:155], v14, s[40:43], s63 offen nt
    s_add_u32 s63, s63, 8192
    buffer_load_dwordx4 a[156:159], v14, s[40:43], s63 offen nt
    s_add_u32 s63, s63, 8192
    s_load_dword s35, s[30:31], 0
    s_mov_b32 s48, s30
    s_and_b32 s49, s31, 0xffff
    s_mov_b32 s50, 8388608
    s_mov_b32 s51, 0x20000
    s_mov_b32 s82, 0xffffff00
    s_mov_b32 s83, 0x3e0293ee
    s_mov_b32 s84, 2097152
    v_and_b32 v4, 1, v1
    v_lshlrev_b32 v4, 4, v4
    v_mov_b32 v5, 0xffff
    v_lshlrev_b32 v4, v4, v5
    v_bfe_u32 v5, v1, 1, 2
    v_cmp_eq_u32 vcc, 0, v5
    s_nop 1
    v_cndmask_b32 v10, 0, v4, vcc
    v_cmp_eq_u32 vcc, 1, v5
    s_nop 1
    v_cndmask_b32 v11, 0, v4, vcc
    v_cmp_eq_u32 vcc, 2, v5
    s_nop 1
    v_cndmask_b32 v12, 0, v4, vcc
    v_cmp_eq_u32 vcc, 3, v5
    s_nop 1
    v_cndmask_b32 v13, 0, v4, vcc
    buffer_load_dwordx4 v[24:27], v15, s[44:47], s86 offen offset:16
    buffer_load_dwordx4 v[40:43], v15, s[44:47], s86 offen offset:2064
    buffer_load_dwordx4 v[28:31], v15, s[44:47], s86 offen offset:32
    buffer_load_dwordx4 v[44:47], v15, s[44:47], s86 offen offset:2080
    buffer_load_dwordx4 v[32:35], v15, s[44:47], s86 offen offset:48
    buffer_load_dwordx4 v[48:51], v15, s[44:47], s86 offen offset:2096
    s_lshl_b32 s38, s61, 10
    s_add_u32 s36, s38, 65536
    s_lshl_b32 s38, s34, 8
    s_add_u32 s36, s38, s36
    v_mov_b32 v19, 0
    s_cmp_eq_u32 s33, 0
    s_cselect_b32 s38, s36, 8388608
    s_mov_b64 exec, 1
    buffer_store_dword v19, v19, s[48:51], s38 offen sc1
    s_mov_b64 exec, -1
    s_mov_b32 s80, 0x01000100
    s_mov_b32 s81, 0x03020302
    s_waitcnt vmcnt(13)
    buffer_load_dwordx4 a[160:163], v14, s[40:43], s63 offen nt
    s_add_u32 s63, s63, 8192
    v_perm_b32 v4, v20, v20, s80
    v_perm_b32 v5, v36, v36, s80
    v_and_b32 v52, v4, v10
    v_and_b32 v53, v4, v11
    v_and_b32 v54, v4, v12
    v_and_b32 v55, v4, v13
    v_and_b32 v56, v5, v10
    v_and_b32 v57, v5, v11
    v_and_b32 v58, v5, v12
    v_and_b32 v59, v5, v13
    v_mfma_f32_16x16x32_bf16 v[60:63], a[128:131], v[52:55], 0
    s_nop 0
    v_mfma_f32_16x16x32_bf16 v[64:67], a[128:131], v[56:59], 0
    buffer_load_dwordx4 a[164:167], v14, s[40:43], s63 offen nt
    s_add_u32 s63, s63, 8192
    v_perm_b32 v4, v20, v20, s81
    v_perm_b32 v5, v36, v36, s81
    v_and_b32 v52, v4, v10
    v_and_b32 v53, v4, v11
    v_and_b32 v54, v4, v12
    v_and_b32 v55, v4, v13
    v_and_b32 v56, v5, v10
    v_and_b32 v57, v5, v11
    v_and_b32 v58, v5, v12
    v_and_b32 v59, v5, v13
    v_mfma_f32_16x16x32_bf16 v[60:63], a[132:135], v[52:55], v[60:63]
    s_nop 0
    v_mfma_f32_16x16x32_bf16 v[64:67], a[132:135], v[56:59], v[64:67]
    s_waitcnt vmcnt(14)
    buffer_load_dwordx4 a[168:171], v14, s[40:43], s63 offen nt
    s_add_u32 s63, s63, 8192
    v_perm_b32 v4, v21, v21, s80
    v_perm_b32 v5, v37, v37, s80
    v_and_b32 v52, v4, v10
    v_and_b32 v53, v4, v11
    v_and_b32 v54, v4, v12
    v_and_b32 v55, v4, v13
    v_and_b32 v56, v5, v10
    v_and_b32 v57, v5, v11
    v_and_b32 v58, v5, v12
    v_and_b32 v59, v5, v13
    v_mfma_f32_16x16x32_bf16 v[60:63], a[136:139], v[52:55], v[60:63]
    s_nop 0
    v_mfma_f32_16x16x32_bf16 v[64:67], a[136:139], v[56:59], v[64:67]
    s_waitcnt vmcnt(14)
    buffer_load_dwordx4 a[172:175], v14, s[40:43], s63 offen nt
    s_add_u32 s63, s63, 8192
    v_perm_b32 v4, v21, v21, s81
    v_perm_b32 v5, v37, v37, s81
    v_and_b32 v52, v4, v10
    v_and_b32 v53, v4, v11
    v_and_b32 v54, v4, v12
    v_and_b32 v55, v4, v13
    v_and_b32 v56, v5, v10
    v_and_b32 v57, v5, v11
    v_and_b32 v58, v5, v12
    v_and_b32 v59, v5, v13
    v_mfma_f32_16x16x32_bf16 v[60:63], a[140:143], v[52:55], v[60:63]
    s_nop 0
    v_mfma_f32_16x16x32_bf16 v[64:67], a[140:143], v[56:59], v[64:67]
    s_waitcnt vmcnt(14)
    buffer_load_dwordx4 a[176:179], v14, s[40:43], s63 offen nt
    s_add_u32 s63, s63, 8192
    v_lshrrev_b32 v4, 2, v3
    v_and_b32 v5, 3, v3
    v_lshlrev_b32 v76, 8, v4
    v_lshlrev_b32 v126, 8, v2
    v_lshl_add_u32 v76, v2, 6, v76
    v_lshl_add_u32 v76, v5, 4, v76
    v_lshl_add_u32 v126, v3, 4, v126
    v_xor_b32 v77, 32768, v76
    v_xor_b32 v127, 32768, v126
    s_add_u32 s3, s34, s33
    s_and_b32 s3, s3, 3
    s_lshl_b32 s89, s3, 5
    s_add_u32 s89, s89, s32
    s_lshl_b32 s89, s89, 20
    s_mul_i32 s88, s32, 8
    s_add_u32 s88, s88, s3
    s_lshl_b32 s87, s33, 0
    v_perm_b32 v4, v22, v22, s80
    v_perm_b32 v5, v38, v38, s80
    v_and_b32 v52, v4, v10
    v_and_b32 v53, v4, v11
    v_and_b32 v54, v4, v12
    v_and_b32 v55, v4, v13
    v_and_b32 v56, v5, v10
    v_and_b32 v57, v5, v11
    v_and_b32 v58, v5, v12
    v_and_b32 v59, v5, v13
    v_mfma_f32_16x16x32_bf16 v[60:63], a[144:147], v[52:55], v[60:63]
    s_nop 0
    v_mfma_f32_16x16x32_bf16 v[64:67], a[144:147], v[56:59], v[64:67]
    s_waitcnt vmcnt(14)
    buffer_load_dwordx4 a[180:183], v14, s[40:43], s63 offen nt
    s_add_u32 s63, s63, 8192
    v_perm_b32 v4, v22, v22, s81
    v_perm_b32 v5, v38, v38, s81
    v_and_b32 v52, v4, v10
    v_and_b32 v53, v4, v11
    v_and_b32 v54, v4, v12
    v_and_b32 v55, v4, v13
    v_and_b32 v56, v5, v10
    v_and_b32 v57, v5, v11
    v_and_b32 v58, v5, v12
    v_and_b32 v59, v5, v13
    v_mfma_f32_16x16x32_bf16 v[60:63], a[148:151], v[52:55], v[60:63]
    s_nop 0
    v_mfma_f32_16x16x32_bf16 v[64:67], a[148:151], v[56:59], v[64:67]
    s_waitcnt vmcnt(14)
    buffer_load_dwordx4 a[184:187], v14, s[40:43], s63 offen nt
    s_add_u32 s63, s63, 8192
    v_perm_b32 v4, v23, v23, s80
    v_perm_b32 v5, v39, v39, s80
    v_and_b32 v52, v4, v10
    v_and_b32 v53, v4, v11
    v_and_b32 v54, v4, v12
    v_and_b32 v55, v4, v13
    v_and_b32 v56, v5, v10
    v_and_b32 v57, v5, v11
    v_and_b32 v58, v5, v12
    v_and_b32 v59, v5, v13
    v_mfma_f32_16x16x32_bf16 v[60:63], a[152:155], v[52:55], v[60:63]
    s_nop 0
    v_mfma_f32_16x16x32_bf16 v[64:67], a[152:155], v[56:59], v[64:67]
    s_waitcnt vmcnt(14)
    buffer_load_dwordx4 a[188:191], v14, s[40:43], s63 offen nt
    s_add_u32 s63, s63, 8192
    v_perm_b32 v4, v23, v23, s81
    v_perm_b32 v5, v39, v39, s81
    v_and_b32 v52, v4, v10
    v_and_b32 v53, v4, v11
    v_and_b32 v54, v4, v12
    v_and_b32 v55, v4, v13
    v_and_b32 v56, v5, v10
    v_and_b32 v57, v5, v11
    v_and_b32 v58, v5, v12
    v_and_b32 v59, v5, v13
    v_mfma_f32_16x16x32_bf16 v[60:63], a[156:159], v[52:55], v[60:63]
    s_nop 0
    v_mfma_f32_16x16x32_bf16 v[64:67], a[156:159], v[56:59], v[64:67]
    s_waitcnt vmcnt(13)
    s_waitcnt vmcnt(7)
    buffer_load_dwordx4 a[192:195], v14, s[40:43], s63 offen nt
    s_add_u32 s63, s63, 8192
    s_mov_b32 s52, s18
    s_and_b32 s53, s19, 0xffff
    s_mov_b32 s54, 134217728
    s_mov_b32 s55, 0x20000
    s_mov_b32 s56, s20
    s_and_b32 s57, s21, 0xffff
    s_mov_b32 s58, 134217728
    s_mov_b32 s59, 0x20000
    v_perm_b32 v4, v24, v24, s80
    v_perm_b32 v5, v40, v40, s80
    v_and_b32 v52, v4, v10
    v_and_b32 v53, v4, v11
    v_and_b32 v54, v4, v12
    v_and_b32 v55, v4, v13
    v_and_b32 v56, v5, v10
    v_and_b32 v57, v5, v11
    v_and_b32 v58, v5, v12
    v_and_b32 v59, v5, v13
    v_mfma_f32_16x16x32_bf16 v[60:63], a[160:163], v[52:55], v[60:63]
    s_nop 0
    v_mfma_f32_16x16x32_bf16 v[64:67], a[160:163], v[56:59], v[64:67]
    s_waitcnt vmcnt(7)
    buffer_load_dwordx4 a[196:199], v14, s[40:43], s63 offen nt
    s_add_u32 s63, s63, 8192
    v_perm_b32 v4, v24, v24, s81
    v_perm_b32 v5, v40, v40, s81
    v_and_b32 v52, v4, v10
    v_and_b32 v53, v4, v11
    v_and_b32 v54, v4, v12
    v_and_b32 v55, v4, v13
    v_and_b32 v56, v5, v10
    v_and_b32 v57, v5, v11
    v_and_b32 v58, v5, v12
    v_and_b32 v59, v5, v13
    v_mfma_f32_16x16x32_bf16 v[60:63], a[164:167], v[52:55], v[60:63]
    s_nop 0
    v_mfma_f32_16x16x32_bf16 v[64:67], a[164:167], v[56:59], v[64:67]
    s_waitcnt vmcnt(7)
    buffer_load_dwordx4 a[200:203], v14, s[40:43], s63 offen nt
    s_add_u32 s63, s63, 8192
    v_perm_b32 v4, v25, v25, s80
    v_perm_b32 v5, v41, v41, s80
    v_and_b32 v52, v4, v10
    v_and_b32 v53, v4, v11
    v_and_b32 v54, v4, v12
    v_and_b32 v55, v4, v13
    v_and_b32 v56, v5, v10
    v_and_b32 v57, v5, v11
    v_and_b32 v58, v5, v12
    v_and_b32 v59, v5, v13
    v_mfma_f32_16x16x32_bf16 v[60:63], a[168:171], v[52:55], v[60:63]
    s_nop 0
    v_mfma_f32_16x16x32_bf16 v[64:67], a[168:171], v[56:59], v[64:67]
    s_waitcnt vmcnt(7)
    buffer_load_dwordx4 a[204:207], v14, s[40:43], s63 offen nt
    s_add_u32 s63, s63, 8192
    v_perm_b32 v4, v25, v25, s81
    v_perm_b32 v5, v41, v41, s81
    v_and_b32 v52, v4, v10
    v_and_b32 v53, v4, v11
    v_and_b32 v54, v4, v12
    v_and_b32 v55, v4, v13
    v_and_b32 v56, v5, v10
    v_and_b32 v57, v5, v11
    v_and_b32 v58, v5, v12
    v_and_b32 v59, v5, v13
    v_mfma_f32_16x16x32_bf16 v[60:63], a[172:175], v[52:55], v[60:63]
    s_nop 0
    v_mfma_f32_16x16x32_bf16 v[64:67], a[172:175], v[56:59], v[64:67]
    s_waitcnt vmcnt(7)
    buffer_load_dwordx4 a[208:211], v14, s[40:43], s63 offen nt
    s_add_u32 s63, s63, 8192
    v_mov_b32 v120, 0xff7f0000
    v_mov_b32 v121, 0
    v_mov_b32 v18, 1
    v_mov_b32 v116, 0
    v_mov_b32 v117, 0
    v_mov_b32 v118, 0
    v_mov_b32 v119, 0
    s_lshl_b32 s38, s32, 10
    s_add_u32 s96, s38, 65536
    s_lshl_b32 s38, s3, 8
    s_add_u32 s96, s38, s96
    v_mov_b32 v9, s96
    s_lshl_b32 s38, s32, 15
    s_add_u32 s96, s38, 1048576
    s_lshl_b32 s38, s3, 13
    s_add_u32 s96, s38, s96
    s_lshl_b32 s38, s33, 10
    s_add_u32 s96, s38, s96
    v_and_b32 v5, 3, v3
    v_lshlrev_b32 v78, 7, v2
    v_lshl_add_u32 v78, v5, 5, v78
    s_lshl_b32 s38, s32, 12
    s_add_u32 s91, s38, 262144
    s_lshl_b32 s38, s3, 9
    s_add_u32 s91, s38, s91
    v_lshlrev_b32 v4, 7, v2
    v_lshl_add_u32 v4, v3, 4, v4
    v_mov_b32 v5, 512
    v_cmp_gt_u32 vcc, 8, v3
    s_nop 1
    v_cndmask_b32 v79, v5, v4, vcc
    v_perm_b32 v4, v26, v26, s80
    v_perm_b32 v5, v42, v42, s80
    v_and_b32 v52, v4, v10
    v_and_b32 v53, v4, v11
    v_and_b32 v54, v4, v12
    v_and_b32 v55, v4, v13
    v_and_b32 v56, v5, v10
    v_and_b32 v57, v5, v11
    v_and_b32 v58, v5, v12
    v_and_b32 v59, v5, v13
    v_mfma_f32_16x16x32_bf16 v[60:63], a[176:179], v[52:55], v[60:63]
    s_nop 0
    v_mfma_f32_16x16x32_bf16 v[64:67], a[176:179], v[56:59], v[64:67]
    s_waitcnt vmcnt(7)
    buffer_load_dwordx4 a[212:215], v14, s[40:43], s63 offen nt
    s_add_u32 s63, s63, 8192
    v_perm_b32 v4, v26, v26, s81
    v_perm_b32 v5, v42, v42, s81
    v_and_b32 v52, v4, v10
    v_and_b32 v53, v4, v11
    v_and_b32 v54, v4, v12
    v_and_b32 v55, v4, v13
    v_and_b32 v56, v5, v10
    v_and_b32 v57, v5, v11
    v_and_b32 v58, v5, v12
    v_and_b32 v59, v5, v13
    v_mfma_f32_16x16x32_bf16 v[60:63], a[180:183], v[52:55], v[60:63]
    s_nop 0
    v_mfma_f32_16x16x32_bf16 v[64:67], a[180:183], v[56:59], v[64:67]
    s_waitcnt vmcnt(7)
    buffer_load_dwordx4 a[216:219], v14, s[40:43], s63 offen nt
    s_add_u32 s63, s63, 8192
    v_perm_b32 v4, v27, v27, s80
    v_perm_b32 v5, v43, v43, s80
    v_and_b32 v52, v4, v10
    v_and_b32 v53, v4, v11
    v_and_b32 v54, v4, v12
    v_and_b32 v55, v4, v13
    v_and_b32 v56, v5, v10
    v_and_b32 v57, v5, v11
    v_and_b32 v58, v5, v12
    v_and_b32 v59, v5, v13
    v_mfma_f32_16x16x32_bf16 v[60:63], a[184:187], v[52:55], v[60:63]
    s_nop 0
    v_mfma_f32_16x16x32_bf16 v[64:67], a[184:187], v[56:59], v[64:67]
    s_waitcnt vmcnt(7)
    buffer_load_dwordx4 a[220:223], v14, s[40:43], s63 offen nt
    s_add_u32 s63, s63, 8192
    v_perm_b32 v4, v27, v27, s81
    v_perm_b32 v5, v43, v43, s81
    v_and_b32 v52, v4, v10
    v_and_b32 v53, v4, v11
    v_and_b32 v54, v4, v12
    v_and_b32 v55, v4, v13
    v_and_b32 v56, v5, v10
    v_and_b32 v57, v5, v11
    v_and_b32 v58, v5, v12
    v_and_b32 v59, v5, v13
    v_mfma_f32_16x16x32_bf16 v[60:63], a[188:191], v[52:55], v[60:63]
    s_nop 0
    v_mfma_f32_16x16x32_bf16 v[64:67], a[188:191], v[56:59], v[64:67]
    s_waitcnt vmcnt(7)
    buffer_load_dwordx4 a[224:227], v14, s[40:43], s63 offen nt
    s_add_u32 s63, s63, 8192
    v_perm_b32 v4, v28, v28, s80
    v_perm_b32 v5, v44, v44, s80
    v_and_b32 v52, v4, v10
    v_and_b32 v53, v4, v11
    v_and_b32 v54, v4, v12
    v_and_b32 v55, v4, v13
    v_and_b32 v56, v5, v10
    v_and_b32 v57, v5, v11
    v_and_b32 v58, v5, v12
    v_and_b32 v59, v5, v13
    v_mfma_f32_16x16x32_bf16 v[60:63], a[192:195], v[52:55], v[60:63]
    s_nop 0
    v_mfma_f32_16x16x32_bf16 v[64:67], a[192:195], v[56:59], v[64:67]
    s_waitcnt vmcnt(7)
    buffer_load_dwordx4 a[228:231], v14, s[40:43], s63 offen nt
    s_add_u32 s63, s63, 8192
    v_perm_b32 v4, v28, v28, s81
    v_perm_b32 v5, v44, v44, s81
    v_and_b32 v52, v4, v10
    v_and_b32 v53, v4, v11
    v_and_b32 v54, v4, v12
    v_and_b32 v55, v4, v13
    v_and_b32 v56, v5, v10
    v_and_b32 v57, v5, v11
    v_and_b32 v58, v5, v12
    v_and_b32 v59, v5, v13
    v_mfma_f32_16x16x32_bf16 v[60:63], a[196:199], v[52:55], v[60:63]
    s_nop 0
    v_mfma_f32_16x16x32_bf16 v[64:67], a[196:199], v[56:59], v[64:67]
    s_waitcnt vmcnt(7)
    buffer_load_dwordx4 a[232:235], v14, s[40:43], s63 offen nt
    s_add_u32 s63, s63, 8192
    v_perm_b32 v4, v29, v29, s80
    v_perm_b32 v5, v45, v45, s80
    v_and_b32 v52, v4, v10
    v_and_b32 v53, v4, v11
    v_and_b32 v54, v4, v12
    v_and_b32 v55, v4, v13
    v_and_b32 v56, v5, v10
    v_and_b32 v57, v5, v11
    v_and_b32 v58, v5, v12
    v_and_b32 v59, v5, v13
    v_mfma_f32_16x16x32_bf16 v[60:63], a[200:203], v[52:55], v[60:63]
    s_nop 0
    v_mfma_f32_16x16x32_bf16 v[64:67], a[200:203], v[56:59], v[64:67]
    s_waitcnt vmcnt(7)
    buffer_load_dwordx4 a[236:239], v14, s[40:43], s63 offen nt
    s_add_u32 s63, s63, 8192
    v_perm_b32 v4, v29, v29, s81
    v_perm_b32 v5, v45, v45, s81
    v_and_b32 v52, v4, v10
    v_and_b32 v53, v4, v11
    v_and_b32 v54, v4, v12
    v_and_b32 v55, v4, v13
    v_and_b32 v56, v5, v10
    v_and_b32 v57, v5, v11
    v_and_b32 v58, v5, v12
    v_and_b32 v59, v5, v13
    v_mfma_f32_16x16x32_bf16 v[60:63], a[204:207], v[52:55], v[60:63]
    s_nop 0
    v_mfma_f32_16x16x32_bf16 v[64:67], a[204:207], v[56:59], v[64:67]
    s_waitcnt vmcnt(7)
    buffer_load_dwordx4 a[240:243], v14, s[40:43], s63 offen nt
    s_add_u32 s63, s63, 8192
    v_perm_b32 v4, v30, v30, s80
    v_perm_b32 v5, v46, v46, s80
    v_and_b32 v52, v4, v10
    v_and_b32 v53, v4, v11
    v_and_b32 v54, v4, v12
    v_and_b32 v55, v4, v13
    v_and_b32 v56, v5, v10
    v_and_b32 v57, v5, v11
    v_and_b32 v58, v5, v12
    v_and_b32 v59, v5, v13
    v_mfma_f32_16x16x32_bf16 v[60:63], a[208:211], v[52:55], v[60:63]
    s_nop 0
    v_mfma_f32_16x16x32_bf16 v[64:67], a[208:211], v[56:59], v[64:67]
    s_waitcnt vmcnt(7)
    buffer_load_dwordx4 a[244:247], v14, s[40:43], s63 offen nt
    s_add_u32 s63, s63, 8192
    v_perm_b32 v4, v30, v30, s81
    v_perm_b32 v5, v46, v46, s81
    v_and_b32 v52, v4, v10
    v_and_b32 v53, v4, v11
    v_and_b32 v54, v4, v12
    v_and_b32 v55, v4, v13
    v_and_b32 v56, v5, v10
    v_and_b32 v57, v5, v11
    v_and_b32 v58, v5, v12
    v_and_b32 v59, v5, v13
    v_mfma_f32_16x16x32_bf16 v[60:63], a[212:215], v[52:55], v[60:63]
    s_nop 0
    v_mfma_f32_16x16x32_bf16 v[64:67], a[212:215], v[56:59], v[64:67]
    s_waitcnt vmcnt(7)
    buffer_load_dwordx4 a[248:251], v14, s[40:43], s63 offen nt
    s_add_u32 s63, s63, 8192
    v_perm_b32 v4, v31, v31, s80
    v_perm_b32 v5, v47, v47, s80
    v_and_b32 v52, v4, v10
    v_and_b32 v53, v4, v11
    v_and_b32 v54, v4, v12
    v_and_b32 v55, v4, v13
    v_and_b32 v56, v5, v10
    v_and_b32 v57, v5, v11
    v_and_b32 v58, v5, v12
    v_and_b32 v59, v5, v13
    v_mfma_f32_16x16x32_bf16 v[60:63], a[216:219], v[52:55], v[60:63]
    s_nop 0
    v_mfma_f32_16x16x32_bf16 v[64:67], a[216:219], v[56:59], v[64:67]
    s_waitcnt vmcnt(7)
    buffer_load_dwordx4 a[252:255], v14, s[40:43], s63 offen nt
    s_add_u32 s63, s63, 8192
    v_perm_b32 v4, v31, v31, s81
    v_perm_b32 v5, v47, v47, s81
    v_and_b32 v52, v4, v10
    v_and_b32 v53, v4, v11
    v_and_b32 v54, v4, v12
    v_and_b32 v55, v4, v13
    v_and_b32 v56, v5, v10
    v_and_b32 v57, v5, v11
    v_and_b32 v58, v5, v12
    v_and_b32 v59, v5, v13
    v_mfma_f32_16x16x32_bf16 v[60:63], a[220:223], v[52:55], v[60:63]
    s_nop 0
    v_mfma_f32_16x16x32_bf16 v[64:67], a[220:223], v[56:59], v[64:67]
    s_waitcnt vmcnt(7)
    v_perm_b32 v4, v32, v32, s80
    v_perm_b32 v5, v48, v48, s80
    v_and_b32 v52, v4, v10
    v_and_b32 v53, v4, v11
    v_and_b32 v54, v4, v12
    v_and_b32 v55, v4, v13
    v_and_b32 v56, v5, v10
    v_and_b32 v57, v5, v11
    v_and_b32 v58, v5, v12
    v_and_b32 v59, v5, v13
    v_mfma_f32_16x16x32_bf16 v[60:63], a[224:227], v[52:55], v[60:63]
    s_nop 0
    v_mfma_f32_16x16x32_bf16 v[64:67], a[224:227], v[56:59], v[64:67]
    s_waitcnt vmcnt(6)
    s_add_u32 s39, s87, s88
    s_bfe_u32 s37, s39, 0x30000
    s_lshl_b32 s37, s37, 12
    s_add_u32 s85, s37, s89
    s_bfe_u32 s37, s39, 0x10003
    s_lshl_b32 s37, s37, 11
    s_add_u32 s85, s37, s85
    s_bfe_u32 s37, s39, 0x40004
    s_lshl_b32 s37, s37, 16
    s_add_u32 s85, s37, s85
    buffer_load_dwordx4 v[128:131], v76, s[52:55], s85 offen offset:0 nt
    v_perm_b32 v4, v32, v32, s81
    v_perm_b32 v5, v48, v48, s81
    v_and_b32 v52, v4, v10
    v_and_b32 v53, v4, v11
    v_and_b32 v54, v4, v12
    v_and_b32 v55, v4, v13
    v_and_b32 v56, v5, v10
    v_and_b32 v57, v5, v11
    v_and_b32 v58, v5, v12
    v_and_b32 v59, v5, v13
    v_mfma_f32_16x16x32_bf16 v[60:63], a[228:231], v[52:55], v[60:63]
    s_nop 0
    v_mfma_f32_16x16x32_bf16 v[64:67], a[228:231], v[56:59], v[64:67]
    s_waitcnt vmcnt(6)
    buffer_load_dwordx4 v[132:135], v77, s[52:55], s85 offen offset:0 nt
    v_perm_b32 v4, v33, v33, s80
    v_perm_b32 v5, v49, v49, s80
    v_and_b32 v52, v4, v10
    v_and_b32 v53, v4, v11
    v_and_b32 v54, v4, v12
    v_and_b32 v55, v4, v13
    v_and_b32 v56, v5, v10
    v_and_b32 v57, v5, v11
    v_and_b32 v58, v5, v12
    v_and_b32 v59, v5, v13
    v_mfma_f32_16x16x32_bf16 v[60:63], a[232:235], v[52:55], v[60:63]
    s_nop 0
    v_mfma_f32_16x16x32_bf16 v[64:67], a[232:235], v[56:59], v[64:67]
    s_waitcnt vmcnt(6)
    buffer_load_dwordx4 v[136:139], v76, s[52:55], s85 offen offset:1024 nt
    v_perm_b32 v4, v33, v33, s81
    v_perm_b32 v5, v49, v49, s81
    v_and_b32 v52, v4, v10
    v_and_b32 v53, v4, v11
    v_and_b32 v54, v4, v12
    v_and_b32 v55, v4, v13
    v_and_b32 v56, v5, v10
    v_and_b32 v57, v5, v11
    v_and_b32 v58, v5, v12
    v_and_b32 v59, v5, v13
    v_mfma_f32_16x16x32_bf16 v[60:63], a[236:239], v[52:55], v[60:63]
    s_nop 0
    v_mfma_f32_16x16x32_bf16 v[64:67], a[236:239], v[56:59], v[64:67]
    s_waitcnt vmcnt(6)
    buffer_load_dwordx4 v[140:143], v77, s[52:55], s85 offen offset:1024 nt
    s_add_u32 s87, s87, 7
    s_add_u32 s39, s87, s88
    s_bfe_u32 s37, s39, 0x30000
    s_lshl_b32 s37, s37, 12
    s_add_u32 s85, s37, s89
    s_bfe_u32 s37, s39, 0x10003
    s_lshl_b32 s37, s37, 11
    s_add_u32 s85, s37, s85
    s_bfe_u32 s37, s39, 0x40004
    s_lshl_b32 s37, s37, 16
    s_add_u32 s85, s37, s85
    v_perm_b32 v4, v34, v34, s80
    v_perm_b32 v5, v50, v50, s80
    v_and_b32 v52, v4, v10
    v_and_b32 v53, v4, v11
    v_and_b32 v54, v4, v12
    v_and_b32 v55, v4, v13
    v_and_b32 v56, v5, v10
    v_and_b32 v57, v5, v11
    v_and_b32 v58, v5, v12
    v_and_b32 v59, v5, v13
    v_mfma_f32_16x16x32_bf16 v[60:63], a[240:243], v[52:55], v[60:63]
    s_nop 0
    v_mfma_f32_16x16x32_bf16 v[64:67], a[240:243], v[56:59], v[64:67]
    s_waitcnt vmcnt(6)
    buffer_load_dwordx4 v[144:147], v76, s[52:55], s85 offen offset:0 nt
    v_perm_b32 v4, v34, v34, s81
    v_perm_b32 v5, v50, v50, s81
    v_and_b32 v52, v4, v10
    v_and_b32 v53, v4, v11
    v_and_b32 v54, v4, v12
    v_and_b32 v55, v4, v13
    v_and_b32 v56, v5, v10
    v_and_b32 v57, v5, v11
    v_and_b32 v58, v5, v12
    v_and_b32 v59, v5, v13
    v_mfma_f32_16x16x32_bf16 v[60:63], a[244:247], v[52:55], v[60:63]
    s_nop 0
    v_mfma_f32_16x16x32_bf16 v[64:67], a[244:247], v[56:59], v[64:67]
    s_waitcnt vmcnt(6)
    buffer_load_dwordx4 v[148:151], v77, s[52:55], s85 offen offset:0 nt
    v_perm_b32 v4, v35, v35, s80
    v_perm_b32 v5, v51, v51, s80
    v_and_b32 v52, v4, v10
    v_and_b32 v53, v4, v11
    v_and_b32 v54, v4, v12
    v_and_b32 v55, v4, v13
    v_and_b32 v56, v5, v10
    v_and_b32 v57, v5, v11
    v_and_b32 v58, v5, v12
    v_and_b32 v59, v5, v13
    v_mfma_f32_16x16x32_bf16 v[60:63], a[248:251], v[52:55], v[60:63]
    s_nop 0
    v_mfma_f32_16x16x32_bf16 v[64:67], a[248:251], v[56:59], v[64:67]
    s_waitcnt vmcnt(6)
    buffer_load_dwordx4 v[152:155], v76, s[52:55], s85 offen offset:1024 nt
    v_perm_b32 v4, v35, v35, s81
    v_perm_b32 v5, v51, v51, s81
    v_and_b32 v52, v4, v10
    v_and_b32 v53, v4, v11
    v_and_b32 v54, v4, v12
    v_and_b32 v55, v4, v13
    v_and_b32 v56, v5, v10
    v_and_b32 v57, v5, v11
    v_and_b32 v58, v5, v12
    v_and_b32 v59, v5, v13
    v_mfma_f32_16x16x32_bf16 v[60:63], a[252:255], v[52:55], v[60:63]
    s_nop 0
    v_mfma_f32_16x16x32_bf16 v[64:67], a[252:255], v[56:59], v[64:67]
    s_lshl_b32 s38, s34, 11
    v_lshrrev_b32 v4, 3, v3
    v_lshlrev_b32 v4, 9, v4
    v_lshl_add_u32 v4, v2, 7, v4
    v_and_b32 v5, 7, v3
    v_lshl_add_u32 v4, v5, 2, v4
    v_add_u32 v4, s38, v4
    ds_write_b32 v4, v60 offset:0
    ds_write_b32 v4, v61 offset:32
    ds_write_b32 v4, v62 offset:64
    ds_write_b32 v4, v63 offset:96
    ds_write_b32 v4, v64 offset:1024
    ds_write_b32 v4, v65 offset:1056
    ds_write_b32 v4, v66 offset:1088
    ds_write_b32 v4, v67 offset:1120
    s_lshl_b32 s38, s34, 9
    v_and_b32 v5, 31, v1
    v_lshl_add_u32 v5, v5, 4, s38
    s_waitcnt lgkmcnt(0)
    s_add_u32 s35, s35, 0x5b
    s_and_b32 s35, s35, 0xff
    v_mov_b32 v8, s35
    s_barrier
    ds_read_b128 v[20:23], v5 offset:0
    ds_read_b128 v[24:27], v5 offset:2048
    ds_read_b128 v[28:31], v5 offset:4096
    ds_read_b128 v[32:35], v5 offset:6144
    s_lshl_b32 s38, s61, 12
    s_add_u32 s36, s38, 262144
    s_lshl_b32 s38, s33, 11
    s_add_u32 s36, s38, s36
    s_waitcnt lgkmcnt(0)
    v_add_f32 v20, v20, v24
    v_add_f32 v28, v28, v32
    v_add_f32 v21, v21, v25
    v_add_f32 v29, v29, v33
    v_add_f32 v22, v22, v26
    v_add_f32 v30, v30, v34
    v_add_f32 v23, v23, v27
    v_add_f32 v31, v31, v35
    v_add_f32 v20, v20, v28
    v_add_f32 v21, v21, v29
    v_add_f32 v22, v22, v30
    v_add_f32 v23, v23, v31
    v_and_or_b32 v20, v20, s82, v8
    v_and_or_b32 v21, v21, s82, v8
    v_and_or_b32 v22, v22, s82, v8
    v_and_or_b32 v23, v23, s82, v8
    s_mov_b32 exec_lo, 0xffffffff
    s_mov_b32 exec_hi, 0x0
    buffer_store_dwordx4 v[20:23], v5, s[48:51], s36 offen sc1
    s_mov_b64 exec, -1
    s_waitcnt vmcnt(7)
    buffer_load_dwordx4 v[156:159], v77, s[52:55], s85 offen offset:1024 nt
    s_add_u32 s87, s87, 7
    s_add_u32 s39, s87, s88
    s_bfe_u32 s37, s39, 0x30000
    s_lshl_b32 s37, s37, 12
    s_add_u32 s85, s37, s89
    s_bfe_u32 s37, s39, 0x10003
    s_lshl_b32 s37, s37, 11
    s_add_u32 s85, s37, s85
    s_bfe_u32 s37, s39, 0x40004
    s_lshl_b32 s37, s37, 16
    s_add_u32 s85, s37, s85
    s_waitcnt vmcnt(7)
    buffer_load_dwordx4 v[160:163], v76, s[52:55], s85 offen offset:0 nt
    s_waitcnt vmcnt(7)
    buffer_load_dwordx4 v[164:167], v77, s[52:55], s85 offen offset:0 nt
    s_waitcnt vmcnt(7)
    buffer_load_dwordx4 v[168:171], v76, s[52:55], s85 offen offset:1024 nt
    s_waitcnt vmcnt(7)
    buffer_load_dwordx4 v[172:175], v77, s[52:55], s85 offen offset:1024 nt
    s_add_u32 s87, s87, 7
    s_add_u32 s39, s87, s88
    s_bfe_u32 s37, s39, 0x30000
    s_lshl_b32 s37, s37, 12
    s_add_u32 s85, s37, s89
    s_bfe_u32 s37, s39, 0x10003
    s_lshl_b32 s37, s37, 11
    s_add_u32 s85, s37, s85
    s_bfe_u32 s37, s39, 0x40004
    s_lshl_b32 s37, s37, 16
    s_add_u32 s85, s37, s85
    s_waitcnt vmcnt(7)
    buffer_load_dwordx4 v[176:179], v76, s[52:55], s85 offen offset:0 nt
    s_waitcnt vmcnt(7)
    buffer_load_dwordx4 v[180:183], v77, s[52:55], s85 offen offset:0 nt
    s_waitcnt vmcnt(6)
    buffer_load_dwordx4 v[184:187], v76, s[52:55], s85 offen offset:1024 nt
    s_waitcnt vmcnt(6)
    buffer_load_dwordx4 v[188:191], v77, s[52:55], s85 offen offset:1024 nt
    s_add_u32 s87, s87, 7
    s_add_u32 s39, s87, s88
    s_bfe_u32 s37, s39, 0x30000
    s_lshl_b32 s37, s37, 12
    s_add_u32 s85, s37, s89
    s_bfe_u32 s37, s39, 0x10003
    s_lshl_b32 s37, s37, 11
    s_add_u32 s85, s37, s85
    s_bfe_u32 s37, s39, 0x40004
    s_lshl_b32 s37, s37, 16
    s_add_u32 s85, s37, s85
    s_waitcnt vmcnt(6)
    buffer_load_dwordx4 v[192:195], v76, s[52:55], s85 offen offset:0 nt
    s_waitcnt vmcnt(6)
    buffer_load_dwordx4 v[196:199], v77, s[52:55], s85 offen offset:0 nt
    s_waitcnt vmcnt(6)
    buffer_load_dwordx4 v[200:203], v76, s[52:55], s85 offen offset:1024 nt
    s_waitcnt vmcnt(6)
    buffer_load_dwordx4 v[204:207], v77, s[52:55], s85 offen offset:1024 nt
    s_add_u32 s87, s87, 7
    s_add_u32 s39, s87, s88
    s_bfe_u32 s37, s39, 0x30000
    s_lshl_b32 s37, s37, 12
    s_add_u32 s85, s37, s89
    s_bfe_u32 s37, s39, 0x10003
    s_lshl_b32 s37, s37, 11
    s_add_u32 s85, s37, s85
    s_bfe_u32 s37, s39, 0x40004
    s_lshl_b32 s37, s37, 16
    s_add_u32 s85, s37, s85
    s_waitcnt vmcnt(6)
    buffer_load_dwordx4 v[208:211], v76, s[52:55], s85 offen offset:0 nt
    s_waitcnt vmcnt(6)
    buffer_load_dwordx4 v[212:215], v77, s[52:55], s85 offen offset:0 nt
    s_waitcnt vmcnt(6)
    buffer_load_dwordx4 v[216:219], v76, s[52:55], s85 offen offset:1024 nt
    s_waitcnt vmcnt(6)
    buffer_load_dwordx4 v[220:223], v77, s[52:55], s85 offen offset:1024 nt
    s_add_u32 s87, s87, 7
    s_add_u32 s39, s87, s88
    s_bfe_u32 s37, s39, 0x30000
    s_lshl_b32 s37, s37, 12
    s_add_u32 s85, s37, s89
    s_bfe_u32 s37, s39, 0x10003
    s_lshl_b32 s37, s37, 11
    s_add_u32 s85, s37, s85
    s_bfe_u32 s37, s39, 0x40004
    s_lshl_b32 s37, s37, 16
    s_add_u32 s85, s37, s85
    s_waitcnt vmcnt(6)
    buffer_load_dwordx4 v[224:227], v76, s[52:55], s85 offen offset:0 nt
    s_waitcnt vmcnt(6)
    buffer_load_dwordx4 v[228:231], v77, s[52:55], s85 offen offset:0 nt
    s_waitcnt vmcnt(6)
    buffer_load_dwordx4 v[232:235], v76, s[52:55], s85 offen offset:1024 nt
    s_waitcnt vmcnt(6)
    buffer_load_dwordx4 v[236:239], v77, s[52:55], s85 offen offset:1024 nt
    s_add_u32 s87, s87, 7
    s_add_u32 s39, s87, s88
    s_bfe_u32 s37, s39, 0x30000
    s_lshl_b32 s37, s37, 12
    s_add_u32 s85, s37, s89
    s_bfe_u32 s37, s39, 0x10003
    s_lshl_b32 s37, s37, 11
    s_add_u32 s85, s37, s85
    s_bfe_u32 s37, s39, 0x40004
    s_lshl_b32 s37, s37, 16
    s_add_u32 s85, s37, s85
    s_waitcnt vmcnt(6)
    buffer_load_dwordx4 v[240:243], v76, s[52:55], s85 offen offset:0 nt
    s_waitcnt vmcnt(6)
    buffer_load_dwordx4 v[244:247], v77, s[52:55], s85 offen offset:0 nt
    s_waitcnt vmcnt(6)
    buffer_load_dwordx4 v[248:251], v76, s[52:55], s85 offen offset:1024 nt
    s_waitcnt vmcnt(6)
    buffer_load_dwordx4 v[252:255], v77, s[52:55], s85 offen offset:1024 nt
    s_add_u32 s87, s87, 7
    s_add_u32 s39, s87, s88
    s_bfe_u32 s37, s39, 0x30000
    s_lshl_b32 s37, s37, 12
    s_add_u32 s85, s37, s89
    s_bfe_u32 s37, s39, 0x10003
    s_lshl_b32 s37, s37, 11
    s_add_u32 s85, s37, s85
    s_bfe_u32 s37, s39, 0x40004
    s_lshl_b32 s37, s37, 16
    s_add_u32 s85, s37, s85
    s_waitcnt vmcnt(6)
    buffer_load_dwordx4 a[0:3], v76, s[52:55], s85 offen offset:0 nt
    s_waitcnt vmcnt(6)
    buffer_load_dwordx4 a[4:7], v77, s[52:55], s85 offen offset:0 nt
    buffer_load_dwordx4 v[68:71], v78, s[48:51], s91 offen offset:0 sc1
    buffer_load_dwordx4 v[72:75], v78, s[48:51], s91 offen offset:16 sc1
    s_waitcnt vmcnt(8)
    buffer_load_dwordx4 a[8:11], v76, s[52:55], s85 offen offset:1024 nt
    s_waitcnt vmcnt(8)
    buffer_load_dwordx4 a[12:15], v77, s[52:55], s85 offen offset:1024 nt
    s_add_u32 s87, s87, 7
    s_add_u32 s39, s87, s88
    s_bfe_u32 s37, s39, 0x30000
    s_lshl_b32 s37, s37, 12
    s_add_u32 s85, s37, s89
    s_bfe_u32 s37, s39, 0x10003
    s_lshl_b32 s37, s37, 11
    s_add_u32 s85, s37, s85
    s_bfe_u32 s37, s39, 0x40004
    s_lshl_b32 s37, s37, 16
    s_add_u32 s85, s37, s85
    s_waitcnt vmcnt(8)
    buffer_load_dwordx4 a[16:19], v76, s[52:55], s85 offen offset:0 nt
    s_waitcnt vmcnt(8)
    buffer_load_dwordx4 a[20:23], v77, s[52:55], s85 offen offset:0 nt
    s_waitcnt vmcnt(8)
    buffer_load_dwordx4 a[24:27], v76, s[52:55], s85 offen offset:1024 nt
    s_waitcnt vmcnt(8)
    buffer_load_dwordx4 a[28:31], v77, s[52:55], s85 offen offset:1024 nt
    s_add_u32 s87, s87, 7
    s_add_u32 s39, s87, s88
    s_bfe_u32 s37, s39, 0x30000
    s_lshl_b32 s37, s37, 12
    s_add_u32 s85, s37, s89
    s_bfe_u32 s37, s39, 0x10003
    s_lshl_b32 s37, s37, 11
    s_add_u32 s85, s37, s85
    s_bfe_u32 s37, s39, 0x40004
    s_lshl_b32 s37, s37, 16
    s_add_u32 s85, s37, s85
    s_waitcnt vmcnt(6)
L_qcheck_10:
    v_xor_b32 v68, s35, v68
    v_xor_b32 v69, s35, v69
    v_xor_b32 v70, s35, v70
    v_xor_b32 v71, s35, v71
    v_xor_b32 v72, s35, v72
    v_xor_b32 v73, s35, v73
    v_xor_b32 v74, s35, v74
    v_xor_b32 v75, s35, v75
    v_or_b32 v4, v68, v69
    v_or3_b32 v4, v4, v70, v71
    v_or3_b32 v4, v4, v72, v73
    v_or3_b32 v4, v4, v74, v75
    v_and_b32 v4, 0xff, v4
    v_cmp_ne_u32 vcc, 0, v4
    s_cbranch_vccz L_qok_11
    buffer_load_dwordx4 v[68:71], v78, s[48:51], s91 offen offset:0 sc1
    buffer_load_dwordx4 v[72:75], v78, s[48:51], s91 offen offset:16 sc1
    s_waitcnt vmcnt(0)
    s_sub_u32 s84, s84, 1
    s_cmp_lg_u32 s84, 0
    s_cbranch_scc1 L_qcheck_10
    s_branch L_end
L_qok_11:
    v_cvt_pk_bf16_f32 v68, v68, v69
    v_cvt_pk_bf16_f32 v69, v70, v71
    v_cvt_pk_bf16_f32 v70, v72, v73
    v_cvt_pk_bf16_f32 v71, v74, v75
    s_mov_b32 vcc_lo, 0xf000f
    s_mov_b32 vcc_hi, 0xf000f
    v_cndmask_b32 v80, 0, v68, vcc
    v_cndmask_b32 v81, 0, v69, vcc
    v_cndmask_b32 v82, 0, v70, vcc
    v_cndmask_b32 v83, 0, v71, vcc
    s_mov_b32 vcc_lo, 0xf000f0
    s_mov_b32 vcc_hi, 0xf000f0
    v_cndmask_b32 v84, 0, v68, vcc
    v_cndmask_b32 v85, 0, v69, vcc
    v_cndmask_b32 v86, 0, v70, vcc
    v_cndmask_b32 v87, 0, v71, vcc
    s_mov_b32 vcc_lo, 0xf000f00
    s_mov_b32 vcc_hi, 0xf000f00
    v_cndmask_b32 v88, 0, v68, vcc
    v_cndmask_b32 v89, 0, v69, vcc
    v_cndmask_b32 v90, 0, v70, vcc
    v_cndmask_b32 v91, 0, v71, vcc
    s_mov_b32 vcc_lo, 0xf000f000
    s_mov_b32 vcc_hi, 0xf000f000
    v_cndmask_b32 v92, 0, v68, vcc
    v_cndmask_b32 v93, 0, v69, vcc
    v_cndmask_b32 v94, 0, v70, vcc
    v_cndmask_b32 v95, 0, v71, vcc
    v_mov_b32 v65, 0xff7f0000
    s_lshl_b32 s38, s34, 14
    s_add_u32 s38, s38, 16384
    v_lshl_add_u32 v64, v1, 2, s38
    buffer_load_dwordx4 a[32:35], v76, s[52:55], s85 offen offset:0 nt
    v_mfma_f32_16x16x32_bf16 v[112:115], v[128:131], v[80:83], 0
    v_mfma_f32_16x16x32_bf16 v[112:115], v[132:135], v[84:87], v[112:115]
    v_mfma_f32_16x16x32_bf16 v[112:115], v[136:139], v[88:91], v[112:115]
    s_waitcnt vmcnt(6)
    buffer_load_dwordx4 a[36:39], v77, s[52:55], s85 offen offset:0 nt
    v_mfma_f32_16x16x32_bf16 v[112:115], v[140:143], v[92:95], v[112:115]
    v_mfma_f32_16x16x32_bf16 v[96:99], v[144:147], v[80:83], 0
    v_mfma_f32_16x16x32_bf16 v[96:99], v[148:151], v[84:87], v[96:99]
    s_waitcnt vmcnt(6)
    buffer_load_dwordx4 a[40:43], v76, s[52:55], s85 offen offset:1024 nt
    v_mfma_f32_16x16x32_bf16 v[96:99], v[152:155], v[88:91], v[96:99]
    s_nop 2
    v_mov_b32_dpp v122, v112 quad_perm:[0,0,0,0] row_mask:0xf bank_mask:0xf
    v_mov_b32_dpp v124, v114 quad_perm:[2,2,2,2] row_mask:0xf bank_mask:0xf
    s_nop 0
    v_add_f32_dpp v122, v113, v122 quad_perm:[1,1,1,1] row_mask:0xf bank_mask:0xf
    v_add_f32_dpp v124, v115, v124 quad_perm:[3,3,3,3] row_mask:0xf bank_mask:0xf
    v_add_f32 v122, v122, v124
    v_max_f32 v65, v65, v122
    ds_write_b32 v64, v122 offset:0
    v_mfma_f32_16x16x32_bf16 v[96:99], v[156:159], v[92:95], v[96:99]
    v_mfma_f32_16x16x32_bf16 v[112:115], v[160:163], v[80:83], 0
    v_mfma_f32_16x16x32_bf16 v[112:115], v[164:167], v[84:87], v[112:115]
    s_waitcnt vmcnt(6)
    buffer_load_dwordx4 a[44:47], v77, s[52:55], s85 offen offset:1024 nt
    s_add_u32 s87, s87, 7
    s_add_u32 s39, s87, s88
    s_bfe_u32 s37, s39, 0x30000
    s_lshl_b32 s37, s37, 12
    s_add_u32 s85, s37, s89
    s_bfe_u32 s37, s39, 0x10003
    s_lshl_b32 s37, s37, 11
    s_add_u32 s85, s37, s85
    s_bfe_u32 s37, s39, 0x40004
    s_lshl_b32 s37, s37, 16
    s_add_u32 s85, s37, s85
    v_mfma_f32_16x16x32_bf16 v[112:115], v[168:171], v[88:91], v[112:115]
    v_mov_b32_dpp v122, v96 quad_perm:[0,0,0,0] row_mask:0xf bank_mask:0xf
    v_mov_b32_dpp v124, v98 quad_perm:[2,2,2,2] row_mask:0xf bank_mask:0xf
    s_nop 0
    v_add_f32_dpp v122, v97, v122 quad_perm:[1,1,1,1] row_mask:0xf bank_mask:0xf
    v_add_f32_dpp v124, v99, v124 quad_perm:[3,3,3,3] row_mask:0xf bank_mask:0xf
    v_add_f32 v122, v122, v124
    v_max_f32 v65, v65, v122
    ds_write_b32 v64, v122 offset:256
    v_mfma_f32_16x16x32_bf16 v[112:115], v[172:175], v[92:95], v[112:115]
    v_mfma_f32_16x16x32_bf16 v[96:99], v[176:179], v[80:83], 0
    s_waitcnt vmcnt(6)
    buffer_load_dwordx4 a[48:51], v76, s[52:55], s85 offen offset:0 nt
    v_mfma_f32_16x16x32_bf16 v[96:99], v[180:183], v[84:87], v[96:99]
    v_mfma_f32_16x16x32_bf16 v[96:99], v[184:187], v[88:91], v[96:99]
    s_nop 2
    v_mov_b32_dpp v122, v112 quad_perm:[0,0,0,0] row_mask:0xf bank_mask:0xf
    v_mov_b32_dpp v124, v114 quad_perm:[2,2,2,2] row_mask:0xf bank_mask:0xf
    s_nop 0
    v_add_f32_dpp v122, v113, v122 quad_perm:[1,1,1,1] row_mask:0xf bank_mask:0xf
    v_add_f32_dpp v124, v115, v124 quad_perm:[3,3,3,3] row_mask:0xf bank_mask:0xf
    v_add_f32 v122, v122, v124
    v_max_f32 v65, v65, v122
    ds_write_b32 v64, v122 offset:512
    v_mfma_f32_16x16x32_bf16 v[96:99], v[188:191], v[92:95], v[96:99]
    v_mfma_f32_16x16x32_bf16 v[112:115], v[192:195], v[80:83], 0
    s_waitcnt vmcnt(6)
    buffer_load_dwordx4 a[52:55], v77, s[52:55], s85 offen offset:0 nt
    v_mfma_f32_16x16x32_bf16 v[112:115], v[196:199], v[84:87], v[112:115]
    v_mfma_f32_16x16x32_bf16 v[112:115], v[200:203], v[88:91], v[112:115]
    s_nop 2
    v_mov_b32_dpp v122, v96 quad_perm:[0,0,0,0] row_mask:0xf bank_mask:0xf
    v_mov_b32_dpp v124, v98 quad_perm:[2,2,2,2] row_mask:0xf bank_mask:0xf
    s_nop 0
    v_add_f32_dpp v122, v97, v122 quad_perm:[1,1,1,1] row_mask:0xf bank_mask:0xf
    v_add_f32_dpp v124, v99, v124 quad_perm:[3,3,3,3] row_mask:0xf bank_mask:0xf
    v_add_f32 v122, v122, v124
    v_max_f32 v65, v65, v122
    ds_write_b32 v64, v122 offset:768
    v_mfma_f32_16x16x32_bf16 v[112:115], v[204:207], v[92:95], v[112:115]
    s_waitcnt vmcnt(6)
    buffer_load_dwordx4 a[56:59], v76, s[52:55], s85 offen offset:1024 nt
    v_mfma_f32_16x16x32_bf16 v[96:99], v[208:211], v[80:83], 0
    v_mfma_f32_16x16x32_bf16 v[96:99], v[212:215], v[84:87], v[96:99]
    v_mfma_f32_16x16x32_bf16 v[96:99], v[216:219], v[88:91], v[96:99]
    s_nop 2
    v_mov_b32_dpp v122, v112 quad_perm:[0,0,0,0] row_mask:0xf bank_mask:0xf
    v_mov_b32_dpp v124, v114 quad_perm:[2,2,2,2] row_mask:0xf bank_mask:0xf
    s_nop 0
    v_add_f32_dpp v122, v113, v122 quad_perm:[1,1,1,1] row_mask:0xf bank_mask:0xf
    v_add_f32_dpp v124, v115, v124 quad_perm:[3,3,3,3] row_mask:0xf bank_mask:0xf
    v_add_f32 v122, v122, v124
    v_max_f32 v65, v65, v122
    ds_write_b32 v64, v122 offset:1024
    v_mfma_f32_16x16x32_bf16 v[96:99], v[220:223], v[92:95], v[96:99]
    s_waitcnt vmcnt(6)
    buffer_load_dwordx4 a[60:63], v77, s[52:55], s85 offen offset:1024 nt
    s_add_u32 s87, s87, 7
    s_add_u32 s39, s87, s88
    s_bfe_u32 s37, s39, 0x30000
    s_lshl_b32 s37, s37, 12
    s_add_u32 s85, s37, s89
    s_bfe_u32 s37, s39, 0x10003
    s_lshl_b32 s37, s37, 11
    s_add_u32 s85, s37, s85
    s_bfe_u32 s37, s39, 0x40004
    s_lshl_b32 s37, s37, 16
    s_add_u32 s85, s37, s85
    v_mfma_f32_16x16x32_bf16 v[112:115], v[224:227], v[80:83], 0
    v_mfma_f32_16x16x32_bf16 v[112:115], v[228:231], v[84:87], v[112:115]
    v_mfma_f32_16x16x32_bf16 v[112:115], v[232:235], v[88:91], v[112:115]
    v_mov_b32_dpp v122, v96 quad_perm:[0,0,0,0] row_mask:0xf bank_mask:0xf
    v_mov_b32_dpp v124, v98 quad_perm:[2,2,2,2] row_mask:0xf bank_mask:0xf
    s_nop 0
    v_add_f32_dpp v122, v97, v122 quad_perm:[1,1,1,1] row_mask:0xf bank_mask:0xf
    v_add_f32_dpp v124, v99, v124 quad_perm:[3,3,3,3] row_mask:0xf bank_mask:0xf
    v_add_f32 v122, v122, v124
    v_max_f32 v65, v65, v122
    ds_write_b32 v64, v122 offset:1280
    s_waitcnt vmcnt(5)
    buffer_load_dwordx4 v[128:131], v76, s[52:55], s85 offen offset:0 nt
    v_mfma_f32_16x16x32_bf16 v[112:115], v[236:239], v[92:95], v[112:115]
    v_mfma_f32_16x16x32_bf16 v[96:99], v[240:243], v[80:83], 0
    v_mfma_f32_16x16x32_bf16 v[96:99], v[244:247], v[84:87], v[96:99]
    s_waitcnt vmcnt(5)
    buffer_load_dwordx4 v[132:135], v77, s[52:55], s85 offen offset:0 nt
    v_mfma_f32_16x16x32_bf16 v[96:99], v[248:251], v[88:91], v[96:99]
    s_nop 2
    v_mov_b32_dpp v122, v112 quad_perm:[0,0,0,0] row_mask:0xf bank_mask:0xf
    v_mov_b32_dpp v124, v114 quad_perm:[2,2,2,2] row_mask:0xf bank_mask:0xf
    s_nop 0
    v_add_f32_dpp v122, v113, v122 quad_perm:[1,1,1,1] row_mask:0xf bank_mask:0xf
    v_add_f32_dpp v124, v115, v124 quad_perm:[3,3,3,3] row_mask:0xf bank_mask:0xf
    v_add_f32 v122, v122, v124
    v_max_f32 v65, v65, v122
    ds_write_b32 v64, v122 offset:1536
    v_mfma_f32_16x16x32_bf16 v[96:99], v[252:255], v[92:95], v[96:99]
    v_mfma_f32_16x16x32_bf16 v[112:115], a[0:3], v[80:83], 0
    v_mfma_f32_16x16x32_bf16 v[112:115], a[4:7], v[84:87], v[112:115]
    s_waitcnt vmcnt(5)
    buffer_load_dwordx4 v[136:139], v76, s[52:55], s85 offen offset:1024 nt
    v_mfma_f32_16x16x32_bf16 v[112:115], a[8:11], v[88:91], v[112:115]
    s_nop 2
    v_mov_b32_dpp v122, v96 quad_perm:[0,0,0,0] row_mask:0xf bank_mask:0xf
    v_mov_b32_dpp v124, v98 quad_perm:[2,2,2,2] row_mask:0xf bank_mask:0xf
    s_nop 0
    v_add_f32_dpp v122, v97, v122 quad_perm:[1,1,1,1] row_mask:0xf bank_mask:0xf
    v_add_f32_dpp v124, v99, v124 quad_perm:[3,3,3,3] row_mask:0xf bank_mask:0xf
    v_add_f32 v122, v122, v124
    v_max_f32 v65, v65, v122
    ds_write_b32 v64, v122 offset:1792
    v_mfma_f32_16x16x32_bf16 v[112:115], a[12:15], v[92:95], v[112:115]
    v_mfma_f32_16x16x32_bf16 v[96:99], a[16:19], v[80:83], 0
    s_waitcnt vmcnt(5)
    buffer_load_dwordx4 v[140:143], v77, s[52:55], s85 offen offset:1024 nt
    s_add_u32 s87, s87, 7
    s_add_u32 s39, s87, s88
    s_bfe_u32 s37, s39, 0x30000
    s_lshl_b32 s37, s37, 12
    s_add_u32 s85, s37, s89
    s_bfe_u32 s37, s39, 0x10003
    s_lshl_b32 s37, s37, 11
    s_add_u32 s85, s37, s85
    s_bfe_u32 s37, s39, 0x40004
    s_lshl_b32 s37, s37, 16
    s_add_u32 s85, s37, s85
    v_mfma_f32_16x16x32_bf16 v[96:99], a[20:23], v[84:87], v[96:99]
    v_mfma_f32_16x16x32_bf16 v[96:99], a[24:27], v[88:91], v[96:99]
    v_mov_b32_dpp v122, v112 quad_perm:[0,0,0,0] row_mask:0xf bank_mask:0xf
    v_mov_b32_dpp v124, v114 quad_perm:[2,2,2,2] row_mask:0xf bank_mask:0xf
    s_nop 0
    v_add_f32_dpp v122, v113, v122 quad_perm:[1,1,1,1] row_mask:0xf bank_mask:0xf
    v_add_f32_dpp v124, v115, v124 quad_perm:[3,3,3,3] row_mask:0xf bank_mask:0xf
    v_add_f32 v122, v122, v124
    v_max_f32 v65, v65, v122
    ds_write_b32 v64, v122 offset:2048
    v_mfma_f32_16x16x32_bf16 v[96:99], a[28:31], v[92:95], v[96:99]
    v_mfma_f32_16x16x32_bf16 v[112:115], a[32:35], v[80:83], 0
    s_waitcnt vmcnt(5)
    buffer_load_dwordx4 v[144:147], v76, s[52:55], s85 offen offset:0 nt
    v_mfma_f32_16x16x32_bf16 v[112:115], a[36:39], v[84:87], v[112:115]
    v_mfma_f32_16x16x32_bf16 v[112:115], a[40:43], v[88:91], v[112:115]
    s_nop 2
    v_mov_b32_dpp v122, v96 quad_perm:[0,0,0,0] row_mask:0xf bank_mask:0xf
    v_mov_b32_dpp v124, v98 quad_perm:[2,2,2,2] row_mask:0xf bank_mask:0xf
    s_nop 0
    v_add_f32_dpp v122, v97, v122 quad_perm:[1,1,1,1] row_mask:0xf bank_mask:0xf
    v_add_f32_dpp v124, v99, v124 quad_perm:[3,3,3,3] row_mask:0xf bank_mask:0xf
    v_add_f32 v122, v122, v124
    v_max_f32 v65, v65, v122
    ds_write_b32 v64, v122 offset:2304
    v_mfma_f32_16x16x32_bf16 v[112:115], a[44:47], v[92:95], v[112:115]
    s_waitcnt vmcnt(5)
    buffer_load_dwordx4 v[148:151], v77, s[52:55], s85 offen offset:0 nt
    v_mfma_f32_16x16x32_bf16 v[96:99], a[48:51], v[80:83], 0
    v_mfma_f32_16x16x32_bf16 v[96:99], a[52:55], v[84:87], v[96:99]
    v_mfma_f32_16x16x32_bf16 v[96:99], a[56:59], v[88:91], v[96:99]
    s_nop 2
    v_mov_b32_dpp v122, v112 quad_perm:[0,0,0,0] row_mask:0xf bank_mask:0xf
    v_mov_b32_dpp v124, v114 quad_perm:[2,2,2,2] row_mask:0xf bank_mask:0xf
    s_nop 0
    v_add_f32_dpp v122, v113, v122 quad_perm:[1,1,1,1] row_mask:0xf bank_mask:0xf
    v_add_f32_dpp v124, v115, v124 quad_perm:[3,3,3,3] row_mask:0xf bank_mask:0xf
    v_add_f32 v122, v122, v124
    v_max_f32 v65, v65, v122
    ds_write_b32 v64, v122 offset:2560
    v_mfma_f32_16x16x32_bf16 v[96:99], a[60:63], v[92:95], v[96:99]
    v_add_u32 v64, 2816, v64
    s_mov_b32 s97, 10
    s_mov_b32 s86, 32
    s_mov_b32 s66, 134217728
    s_mov_b32 s67, 0x20000
    s_mov_b64 s[64:65], s[52:53]
    v_mov_b32 v62, v76
    v_mov_b32 v63, v77
    s_branch L_bloop
L_ql:
    v_lshrrev_b32 v4, 2, v3
    v_and_b32 v5, 3, v3
    v_lshlrev_b32 v19, 6, v2
    v_lshl_add_u32 v19, v5, 4, v19
    v_lshl_add_u32 v14, v4, 18, v19
    s_lshl_b32 s63, s34, 20
    s_lshl_b32 s38, s32, 8
    s_add_u32 s63, s63, s38
    s_mov_b32 s74, 4194304
    s_mov_b32 s75, 0x20000
    s_waitcnt lgkmcnt(0)
    s_mov_b64 s[72:73], s[10:11]
    buffer_load_dwordx4 a[128:131], v14, s[72:75], s63 offen nt
    s_add_u32 s63, s63, 8192
    buffer_load_dwordx4 a[132:135], v14, s[72:75], s63 offen nt
    s_add_u32 s63, s63, 8192
    buffer_load_dwordx4 a[136:139], v14, s[72:75], s63 offen nt
    s_add_u32 s63, s63, 8192
    buffer_load_dwordx4 a[140:143], v14, s[72:75], s63 offen nt
    s_add_u32 s63, s63, 8192
    buffer_load_dwordx4 a[144:147], v14, s[72:75], s63 offen nt
    s_add_u32 s63, s63, 8192
    buffer_load_dwordx4 a[148:151], v14, s[72:75], s63 offen nt
    s_add_u32 s63, s63, 8192
    buffer_load_dwordx4 a[152:155], v14, s[72:75], s63 offen nt
    s_add_u32 s63, s63, 8192
    buffer_load_dwordx4 a[156:159], v14, s[72:75], s63 offen nt
    s_add_u32 s63, s63, 8192
    v_lshlrev_b32 v15, 1, v19
    v_lshl_add_u32 v15, v4, 9, v15
    v_lshl_add_u32 v19, v4, 15, v19
    s_load_dword s35, s[30:31], 0
    s_mov_b32 s48, s30
    s_and_b32 s49, s31, 0xffff
    s_mov_b32 s50, 8388608
    s_mov_b32 s51, 0x20000
    s_mov_b32 s82, 0xffffff00
    s_mov_b32 s83, 0x3e0293ee
    s_mov_b32 s84, 2097152
    s_lshl_b32 s38, s32, 12
    s_add_u32 s95, s38, 264192
    s_lshl_b32 s38, s32, 10
    s_add_u32 s94, s38, 393216
    s_lshl_b32 s38, s34, 8
    s_add_u32 s94, s38, s94
    s_waitcnt vmcnt(7)
    buffer_load_dwordx4 a[160:163], v14, s[72:75], s63 offen nt
    s_add_u32 s63, s63, 8192
    s_waitcnt vmcnt(7)
    buffer_load_dwordx4 a[164:167], v14, s[72:75], s63 offen nt
    s_add_u32 s63, s63, 8192
    s_waitcnt vmcnt(7)
    buffer_load_dwordx4 a[168:171], v14, s[72:75], s63 offen nt
    s_add_u32 s63, s63, 8192
    s_waitcnt vmcnt(7)
    buffer_load_dwordx4 a[172:175], v14, s[72:75], s63 offen nt
    s_add_u32 s63, s63, 8192
    s_waitcnt vmcnt(7)
    buffer_load_dwordx4 a[176:179], v14, s[72:75], s63 offen nt
    s_add_u32 s63, s63, 8192
    v_and_b32 v4, 1, v1
    v_lshlrev_b32 v4, 4, v4
    v_mov_b32 v5, 0xffff
    v_lshlrev_b32 v4, v4, v5
    v_bfe_u32 v5, v1, 1, 2
    v_cmp_eq_u32 vcc, 0, v5
    s_nop 1
    v_cndmask_b32 v10, 0, v4, vcc
    v_cmp_eq_u32 vcc, 1, v5
    s_nop 1
    v_cndmask_b32 v11, 0, v4, vcc
    v_cmp_eq_u32 vcc, 2, v5
    s_nop 1
    v_cndmask_b32 v12, 0, v4, vcc
    v_cmp_eq_u32 vcc, 3, v5
    s_nop 1
    v_cndmask_b32 v13, 0, v4, vcc
    s_waitcnt vmcnt(7)
    buffer_load_dwordx4 a[180:183], v14, s[72:75], s63 offen nt
    s_add_u32 s63, s63, 8192
    s_waitcnt vmcnt(7)
    buffer_load_dwordx4 a[184:187], v14, s[72:75], s63 offen nt
    s_add_u32 s63, s63, 8192
    s_waitcnt vmcnt(7)
    buffer_load_dwordx4 a[188:191], v14, s[72:75], s63 offen nt
    s_add_u32 s63, s63, 8192
    s_waitcnt vmcnt(7)
    buffer_load_dwordx4 a[192:195], v14, s[72:75], s63 offen nt
    s_add_u32 s63, s63, 8192
    v_lshrrev_b32 v4, 2, v3
    v_and_b32 v5, 3, v3
    v_lshlrev_b32 v76, 8, v4
    v_lshlrev_b32 v126, 8, v2
    v_lshl_add_u32 v76, v2, 6, v76
    v_lshl_add_u32 v76, v5, 4, v76
    v_lshl_add_u32 v126, v3, 4, v126
    v_xor_b32 v77, 32768, v76
    v_xor_b32 v127, 32768, v126
    s_add_u32 s3, s34, s33
    s_and_b32 s3, s3, 3
    s_lshl_b32 s89, s3, 5
    s_add_u32 s89, s89, s32
    s_lshl_b32 s89, s89, 20
    s_mul_i32 s88, s32, 8
    s_add_u32 s88, s88, s3
    s_lshl_b32 s87, s33, 0
    s_waitcnt vmcnt(7)
    buffer_load_dwordx4 a[196:199], v14, s[72:75], s63 offen nt
    s_add_u32 s63, s63, 8192
    s_waitcnt vmcnt(7)
    buffer_load_dwordx4 a[200:203], v14, s[72:75], s63 offen nt
    s_add_u32 s63, s63, 8192
    s_waitcnt vmcnt(7)
    buffer_load_dwordx4 a[204:207], v14, s[72:75], s63 offen nt
    s_add_u32 s63, s63, 8192
    s_waitcnt vmcnt(7)
    buffer_load_dwordx4 a[208:211], v14, s[72:75], s63 offen nt
    s_add_u32 s63, s63, 8192
    s_mov_b32 s52, s18
    s_and_b32 s53, s19, 0xffff
    s_mov_b32 s54, 134217728
    s_mov_b32 s55, 0x20000
    s_mov_b32 s56, s20
    s_and_b32 s57, s21, 0xffff
    s_mov_b32 s58, 134217728
    s_mov_b32 s59, 0x20000
    s_waitcnt vmcnt(7)
    buffer_load_dwordx4 a[212:215], v14, s[72:75], s63 offen nt
    s_add_u32 s63, s63, 8192
    s_waitcnt vmcnt(7)
    buffer_load_dwordx4 a[216:219], v14, s[72:75], s63 offen nt
    s_add_u32 s63, s63, 8192
    s_waitcnt vmcnt(7)
    buffer_load_dwordx4 a[220:223], v14, s[72:75], s63 offen nt
    s_add_u32 s63, s63, 8192
    s_waitcnt vmcnt(7)
    buffer_load_dwordx4 a[224:227], v14, s[72:75], s63 offen nt
    s_add_u32 s63, s63, 8192
    v_mov_b32 v120, 0xff7f0000
    v_mov_b32 v121, 0
    v_mov_b32 v18, 1
    v_mov_b32 v116, 0
    v_mov_b32 v117, 0
    v_mov_b32 v118, 0
    v_mov_b32 v119, 0
    s_lshl_b32 s38, s32, 10
    s_add_u32 s96, s38, 65536
    s_lshl_b32 s38, s3, 8
    s_add_u32 s96, s38, s96
    v_mov_b32 v9, s96
    s_lshl_b32 s38, s32, 15
    s_add_u32 s96, s38, 1048576
    s_lshl_b32 s38, s3, 13
    s_add_u32 s96, s38, s96
    s_lshl_b32 s38, s33, 10
    s_add_u32 s96, s38, s96
    v_and_b32 v5, 3, v3
    v_lshlrev_b32 v78, 7, v2
    v_lshl_add_u32 v78, v5, 5, v78
    s_lshl_b32 s38, s32, 12
    s_add_u32 s91, s38, 262144
    s_lshl_b32 s38, s3, 9
    s_add_u32 s91, s38, s91
    v_lshlrev_b32 v4, 7, v2
    v_lshl_add_u32 v4, v3, 4, v4
    v_mov_b32 v5, 512
    v_cmp_gt_u32 vcc, 8, v3
    s_nop 1
    v_cndmask_b32 v79, v5, v4, vcc
    s_waitcnt vmcnt(7)
    buffer_load_dwordx4 a[228:231], v14, s[72:75], s63 offen nt
    s_add_u32 s63, s63, 8192
    s_waitcnt vmcnt(7)
    buffer_load_dwordx4 a[232:235], v14, s[72:75], s63 offen nt
    s_add_u32 s63, s63, 8192
    s_waitcnt vmcnt(7)
    buffer_load_dwordx4 a[236:239], v14, s[72:75], s63 offen nt
    s_add_u32 s63, s63, 8192
    s_waitcnt vmcnt(7)
    buffer_load_dwordx4 a[240:243], v14, s[72:75], s63 offen nt
    s_add_u32 s63, s63, 8192
    s_waitcnt vmcnt(7)
    buffer_load_dwordx4 a[244:247], v14, s[72:75], s63 offen nt
    s_add_u32 s63, s63, 8192
    s_waitcnt vmcnt(7)
    buffer_load_dwordx4 a[248:251], v14, s[72:75], s63 offen nt
    s_add_u32 s63, s63, 8192
    s_waitcnt vmcnt(7)
    buffer_load_dwordx4 a[252:255], v14, s[72:75], s63 offen nt
    s_add_u32 s63, s63, 8192
    s_waitcnt lgkmcnt(0)
    s_add_u32 s35, s35, 0x5b
    s_and_b32 s35, s35, 0xff
    v_mov_b32 v8, s35
    s_or_b32 s68, s35, 0x6b3ac500
    s_waitcnt vmcnt(6)
    s_add_u32 s39, s87, s88
    s_bfe_u32 s37, s39, 0x30000
    s_lshl_b32 s37, s37, 12
    s_add_u32 s85, s37, s89
    s_bfe_u32 s37, s39, 0x10003
    s_lshl_b32 s37, s37, 11
    s_add_u32 s85, s37, s85
    s_bfe_u32 s37, s39, 0x40004
    s_lshl_b32 s37, s37, 16
    s_add_u32 s85, s37, s85
    buffer_load_dwordx4 v[128:131], v76, s[52:55], s85 offen offset:0 nt
    s_waitcnt vmcnt(6)
    buffer_load_dwordx4 v[132:135], v77, s[52:55], s85 offen offset:0 nt
    s_waitcnt vmcnt(6)
    buffer_load_dwordx4 v[136:139], v76, s[52:55], s85 offen offset:1024 nt
    s_waitcnt vmcnt(6)
    buffer_load_dwordx4 v[140:143], v77, s[52:55], s85 offen offset:1024 nt
    s_add_u32 s87, s87, 7
    s_add_u32 s39, s87, s88
    s_bfe_u32 s37, s39, 0x30000
    s_lshl_b32 s37, s37, 12
    s_add_u32 s85, s37, s89
    s_bfe_u32 s37, s39, 0x10003
    s_lshl_b32 s37, s37, 11
    s_add_u32 s85, s37, s85
    s_bfe_u32 s37, s39, 0x40004
    s_lshl_b32 s37, s37, 16
    s_add_u32 s85, s37, s85
    s_waitcnt vmcnt(6)
    buffer_load_dwordx4 v[144:147], v76, s[52:55], s85 offen offset:0 nt
    s_waitcnt vmcnt(6)
    buffer_load_dwordx4 v[148:151], v77, s[52:55], s85 offen offset:0 nt
    s_waitcnt vmcnt(6)
    buffer_load_dwordx4 v[152:155], v76, s[52:55], s85 offen offset:1024 nt
    s_waitcnt vmcnt(6)
    buffer_load_dwordx4 v[156:159], v77, s[52:55], s85 offen offset:1024 nt
    s_add_u32 s87, s87, 7
    s_add_u32 s39, s87, s88
    s_bfe_u32 s37, s39, 0x30000
    s_lshl_b32 s37, s37, 12
    s_add_u32 s85, s37, s89
    s_bfe_u32 s37, s39, 0x10003
    s_lshl_b32 s37, s37, 11
    s_add_u32 s85, s37, s85
    s_bfe_u32 s37, s39, 0x40004
    s_lshl_b32 s37, s37, 16
    s_add_u32 s85, s37, s85
    s_waitcnt vmcnt(6)
    buffer_load_dwordx4 v[160:163], v76, s[52:55], s85 offen offset:0 nt
    s_waitcnt vmcnt(6)
    buffer_load_dwordx4 v[164:167], v77, s[52:55], s85 offen offset:0 nt
    s_waitcnt vmcnt(6)
    buffer_load_dwordx4 v[168:171], v76, s[52:55], s85 offen offset:1024 nt
    s_waitcnt vmcnt(6)
    buffer_load_dwordx4 v[172:175], v77, s[52:55], s85 offen offset:1024 nt
    s_add_u32 s87, s87, 7
    s_add_u32 s39, s87, s88
    s_bfe_u32 s37, s39, 0x30000
    s_lshl_b32 s37, s37, 12
    s_add_u32 s85, s37, s89
    s_bfe_u32 s37, s39, 0x10003
    s_lshl_b32 s37, s37, 11
    s_add_u32 s85, s37, s85
    s_bfe_u32 s37, s39, 0x40004
    s_lshl_b32 s37, s37, 16
    s_add_u32 s85, s37, s85
    s_waitcnt vmcnt(6)
    buffer_load_dwordx4 v[176:179], v76, s[52:55], s85 offen offset:0 nt
    s_waitcnt vmcnt(6)
    buffer_load_dwordx4 v[180:183], v77, s[52:55], s85 offen offset:0 nt
    s_waitcnt vmcnt(6)
    buffer_load_dwordx4 v[184:187], v76, s[52:55], s85 offen offset:1024 nt
    s_waitcnt vmcnt(6)
    buffer_load_dwordx4 v[188:191], v77, s[52:55], s85 offen offset:1024 nt
    s_add_u32 s87, s87, 7
    s_add_u32 s39, s87, s88
    s_bfe_u32 s37, s39, 0x30000
    s_lshl_b32 s37, s37, 12
    s_add_u32 s85, s37, s89
    s_bfe_u32 s37, s39, 0x10003
    s_lshl_b32 s37, s37, 11
    s_add_u32 s85, s37, s85
    s_bfe_u32 s37, s39, 0x40004
    s_lshl_b32 s37, s37, 16
    s_add_u32 s85, s37, s85
    s_waitcnt vmcnt(6)
    buffer_load_dwordx4 v[192:195], v76, s[52:55], s85 offen offset:0 nt
    s_waitcnt vmcnt(6)
    buffer_load_dwordx4 v[196:199], v77, s[52:55], s85 offen offset:0 nt
    s_waitcnt vmcnt(6)
    buffer_load_dwordx4 v[200:203], v76, s[52:55], s85 offen offset:1024 nt
    s_waitcnt vmcnt(6)
    buffer_load_dwordx4 v[204:207], v77, s[52:55], s85 offen offset:1024 nt
    s_add_u32 s87, s87, 7
    s_add_u32 s39, s87, s88
    s_bfe_u32 s37, s39, 0x30000
    s_lshl_b32 s37, s37, 12
    s_add_u32 s85, s37, s89
    s_bfe_u32 s37, s39, 0x10003
    s_lshl_b32 s37, s37, 11
    s_add_u32 s85, s37, s85
    s_bfe_u32 s37, s39, 0x40004
    s_lshl_b32 s37, s37, 16
    s_add_u32 s85, s37, s85
    s_waitcnt vmcnt(6)
    buffer_load_dwordx4 v[208:211], v76, s[52:55], s85 offen offset:0 nt
    s_waitcnt vmcnt(6)
    buffer_load_dwordx4 v[212:215], v77, s[52:55], s85 offen offset:0 nt
    s_waitcnt vmcnt(6)
    buffer_load_dwordx4 v[216:219], v76, s[52:55], s85 offen offset:1024 nt
    s_waitcnt vmcnt(6)
    buffer_load_dwordx4 v[220:223], v77, s[52:55], s85 offen offset:1024 nt
    s_add_u32 s87, s87, 7
    s_add_u32 s39, s87, s88
    s_bfe_u32 s37, s39, 0x30000
    s_lshl_b32 s37, s37, 12
    s_add_u32 s85, s37, s89
    s_bfe_u32 s37, s39, 0x10003
    s_lshl_b32 s37, s37, 11
    s_add_u32 s85, s37, s85
    s_bfe_u32 s37, s39, 0x40004
    s_lshl_b32 s37, s37, 16
    s_add_u32 s85, s37, s85
    buffer_load_dwordx4 v[20:23], v15, s[48:51], s95 offen offset:0 sc1
    buffer_load_dwordx4 v[24:27], v15, s[48:51], s95 offen offset:16 sc1
    s_waitcnt vmcnt(8)
    buffer_load_dwordx4 v[224:227], v76, s[52:55], s85 offen offset:0 nt
    s_waitcnt vmcnt(8)
    buffer_load_dwordx4 v[228:231], v77, s[52:55], s85 offen offset:0 nt
    s_waitcnt vmcnt(8)
    buffer_load_dwordx4 v[232:235], v76, s[52:55], s85 offen offset:1024 nt
    s_waitcnt vmcnt(8)
    buffer_load_dwordx4 v[236:239], v77, s[52:55], s85 offen offset:1024 nt
    s_add_u32 s87, s87, 7
    s_add_u32 s39, s87, s88
    s_bfe_u32 s37, s39, 0x30000
    s_lshl_b32 s37, s37, 12
    s_add_u32 s85, s37, s89
    s_bfe_u32 s37, s39, 0x10003
    s_lshl_b32 s37, s37, 11
    s_add_u32 s85, s37, s85
    s_bfe_u32 s37, s39, 0x40004
    s_lshl_b32 s37, s37, 16
    s_add_u32 s85, s37, s85
    s_waitcnt vmcnt(8)
    buffer_load_dwordx4 v[240:243], v76, s[52:55], s85 offen offset:0 nt
    s_waitcnt vmcnt(8)
    buffer_load_dwordx4 v[244:247], v77, s[52:55], s85 offen offset:0 nt
    s_waitcnt vmcnt(6)
L_qacheck_12:
    v_xor_b32 v20, s35, v20
    v_xor_b32 v21, s35, v21
    v_xor_b32 v22, s35, v22
    v_xor_b32 v23, s35, v23
    v_xor_b32 v24, s35, v24
    v_xor_b32 v25, s35, v25
    v_xor_b32 v26, s35, v26
    v_xor_b32 v27, s35, v27
    v_or_b32 v4, v20, v21
    v_or3_b32 v4, v4, v22, v23
    v_or3_b32 v4, v4, v24, v25
    v_or3_b32 v4, v4, v26, v27
    v_and_b32 v4, 0xff, v4
    v_cmp_ne_u32 vcc, 0, v4
    s_cbranch_vccz L_qaok_13
    buffer_load_dwordx4 v[20:23], v15, s[48:51], s95 offen offset:0 sc1
    buffer_load_dwordx4 v[24:27], v15, s[48:51], s95 offen offset:16 sc1
    s_waitcnt vmcnt(0)
    s_sub_u32 s84, s84, 1
    s_cmp_lg_u32 s84, 0
    s_cbranch_scc1 L_qacheck_12
    s_branch L_end
L_qaok_13:
    buffer_load_dwordx4 v[68:71], v78, s[48:51], s91 offen offset:0 sc1
    buffer_load_dwordx4 v[72:75], v78, s[48:51], s91 offen offset:16 sc1
    v_cvt_pk_bf16_f32 v20, v20, v21
    v_cvt_pk_bf16_f32 v21, v22, v23
    v_cvt_pk_bf16_f32 v22, v24, v25
    v_cvt_pk_bf16_f32 v23, v26, v27
    s_nop 1
    v_mfma_f32_16x16x32_bf16 v[28:31], a[128:131], v[20:23], 0
    v_mfma_f32_16x16x32_bf16 v[32:35], a[132:135], v[20:23], 0
    v_mfma_f32_16x16x32_bf16 v[36:39], a[136:139], v[20:23], 0
    s_nop 5
    v_mov_b32_dpp v60, v28 quad_perm:[0,0,0,0] row_mask:0xf bank_mask:0xf
    v_mov_b32_dpp v4, v30 quad_perm:[2,2,2,2] row_mask:0xf bank_mask:0xf
    s_nop 0
    v_add_f32_dpp v60, v29, v60 quad_perm:[1,1,1,1] row_mask:0xf bank_mask:0xf
    v_add_f32_dpp v4, v31, v4 quad_perm:[3,3,3,3] row_mask:0xf bank_mask:0xf
    v_add_f32 v60, v60, v4
    v_mfma_f32_16x16x32_bf16 v[40:43], a[140:143], v[20:23], 0
    v_mov_b32_dpp v61, v32 quad_perm:[0,0,0,0] row_mask:0xf bank_mask:0xf
    v_mov_b32_dpp v4, v34 quad_perm:[2,2,2,2] row_mask:0xf bank_mask:0xf
    s_nop 0
    v_add_f32_dpp v61, v33, v61 quad_perm:[1,1,1,1] row_mask:0xf bank_mask:0xf
    v_add_f32_dpp v4, v35, v4 quad_perm:[3,3,3,3] row_mask:0xf bank_mask:0xf
    v_add_f32 v61, v61, v4
    v_cvt_pk_bf16_f32 v44, v60, v61
    v_mfma_f32_16x16x32_bf16 v[28:31], a[144:147], v[20:23], 0
    v_mov_b32_dpp v60, v36 quad_perm:[0,0,0,0] row_mask:0xf bank_mask:0xf
    v_mov_b32_dpp v4, v38 quad_perm:[2,2,2,2] row_mask:0xf bank_mask:0xf
    s_nop 0
    v_add_f32_dpp v60, v37, v60 quad_perm:[1,1,1,1] row_mask:0xf bank_mask:0xf
    v_add_f32_dpp v4, v39, v4 quad_perm:[3,3,3,3] row_mask:0xf bank_mask:0xf
    v_add_f32 v60, v60, v4
    buffer_load_dwordx4 v[248:251], v76, s[52:55], s85 offen offset:1024 nt
    v_mfma_f32_16x16x32_bf16 v[32:35], a[148:151], v[20:23], 0
    v_mov_b32_dpp v61, v40 quad_perm:[0,0,0,0] row_mask:0xf bank_mask:0xf
    v_mov_b32_dpp v4, v42 quad_perm:[2,2,2,2] row_mask:0xf bank_mask:0xf
    s_nop 0
    v_add_f32_dpp v61, v41, v61 quad_perm:[1,1,1,1] row_mask:0xf bank_mask:0xf
    v_add_f32_dpp v4, v43, v4 quad_perm:[3,3,3,3] row_mask:0xf bank_mask:0xf
    v_add_f32 v61, v61, v4
    v_cvt_pk_bf16_f32 v45, v60, v61
    v_mfma_f32_16x16x32_bf16 v[36:39], a[152:155], v[20:23], 0
    v_mov_b32_dpp v60, v28 quad_perm:[0,0,0,0] row_mask:0xf bank_mask:0xf
    v_mov_b32_dpp v4, v30 quad_perm:[2,2,2,2] row_mask:0xf bank_mask:0xf
    s_nop 0
    v_add_f32_dpp v60, v29, v60 quad_perm:[1,1,1,1] row_mask:0xf bank_mask:0xf
    v_add_f32_dpp v4, v31, v4 quad_perm:[3,3,3,3] row_mask:0xf bank_mask:0xf
    v_add_f32 v60, v60, v4
    v_mfma_f32_16x16x32_bf16 v[40:43], a[156:159], v[20:23], 0
    v_mov_b32_dpp v61, v32 quad_perm:[0,0,0,0] row_mask:0xf bank_mask:0xf
    v_mov_b32_dpp v4, v34 quad_perm:[2,2,2,2] row_mask:0xf bank_mask:0xf
    s_nop 0
    v_add_f32_dpp v61, v33, v61 quad_perm:[1,1,1,1] row_mask:0xf bank_mask:0xf
    v_add_f32_dpp v4, v35, v4 quad_perm:[3,3,3,3] row_mask:0xf bank_mask:0xf
    v_add_f32 v61, v61, v4
    v_cvt_pk_bf16_f32 v46, v60, v61
    v_mfma_f32_16x16x32_bf16 v[28:31], a[160:163], v[20:23], 0
    v_mov_b32_dpp v60, v36 quad_perm:[0,0,0,0] row_mask:0xf bank_mask:0xf
    v_mov_b32_dpp v4, v38 quad_perm:[2,2,2,2] row_mask:0xf bank_mask:0xf
    s_nop 0
    v_add_f32_dpp v60, v37, v60 quad_perm:[1,1,1,1] row_mask:0xf bank_mask:0xf
    v_add_f32_dpp v4, v39, v4 quad_perm:[3,3,3,3] row_mask:0xf bank_mask:0xf
    v_add_f32 v60, v60, v4
    v_mfma_f32_16x16x32_bf16 v[32:35], a[164:167], v[20:23], 0
    v_mov_b32_dpp v61, v40 quad_perm:[0,0,0,0] row_mask:0xf bank_mask:0xf
    v_mov_b32_dpp v4, v42 quad_perm:[2,2,2,2] row_mask:0xf bank_mask:0xf
    s_nop 0
    v_add_f32_dpp v61, v41, v61 quad_perm:[1,1,1,1] row_mask:0xf bank_mask:0xf
    v_add_f32_dpp v4, v43, v4 quad_perm:[3,3,3,3] row_mask:0xf bank_mask:0xf
    v_add_f32 v61, v61, v4
    v_cvt_pk_bf16_f32 v47, v60, v61
    v_mfma_f32_16x16x32_bf16 v[36:39], a[168:171], v[20:23], 0
    v_mov_b32_dpp v60, v28 quad_perm:[0,0,0,0] row_mask:0xf bank_mask:0xf
    v_mov_b32_dpp v4, v30 quad_perm:[2,2,2,2] row_mask:0xf bank_mask:0xf
    s_nop 0
    v_add_f32_dpp v60, v29, v60 quad_perm:[1,1,1,1] row_mask:0xf bank_mask:0xf
    v_add_f32_dpp v4, v31, v4 quad_perm:[3,3,3,3] row_mask:0xf bank_mask:0xf
    v_add_f32 v60, v60, v4
    v_mfma_f32_16x16x32_bf16 v[40:43], a[172:175], v[20:23], 0
    v_mov_b32_dpp v61, v32 quad_perm:[0,0,0,0] row_mask:0xf bank_mask:0xf
    v_mov_b32_dpp v4, v34 quad_perm:[2,2,2,2] row_mask:0xf bank_mask:0xf
    s_nop 0
    v_add_f32_dpp v61, v33, v61 quad_perm:[1,1,1,1] row_mask:0xf bank_mask:0xf
    v_add_f32_dpp v4, v35, v4 quad_perm:[3,3,3,3] row_mask:0xf bank_mask:0xf
    v_add_f32 v61, v61, v4
    v_cvt_pk_bf16_f32 v48, v60, v61
    v_mfma_f32_16x16x32_bf16 v[28:31], a[176:179], v[20:23], 0
    v_mov_b32_dpp v60, v36 quad_perm:[0,0,0,0] row_mask:0xf bank_mask:0xf
    v_mov_b32_dpp v4, v38 quad_perm:[2,2,2,2] row_mask:0xf bank_mask:0xf
    s_nop 0
    v_add_f32_dpp v60, v37, v60 quad_perm:[1,1,1,1] row_mask:0xf bank_mask:0xf
    v_add_f32_dpp v4, v39, v4 quad_perm:[3,3,3,3] row_mask:0xf bank_mask:0xf
    v_add_f32 v60, v60, v4
    buffer_load_dwordx4 v[252:255], v77, s[52:55], s85 offen offset:1024 nt
    s_add_u32 s87, s87, 7
    s_add_u32 s39, s87, s88
    s_bfe_u32 s37, s39, 0x30000
    s_lshl_b32 s37, s37, 12
    s_add_u32 s85, s37, s89
    s_bfe_u32 s37, s39, 0x10003
    s_lshl_b32 s37, s37, 11
    s_add_u32 s85, s37, s85
    s_bfe_u32 s37, s39, 0x40004
    s_lshl_b32 s37, s37, 16
    s_add_u32 s85, s37, s85
    v_mfma_f32_16x16x32_bf16 v[32:35], a[180:183], v[20:23], 0
    v_mov_b32_dpp v61, v40 quad_perm:[0,0,0,0] row_mask:0xf bank_mask:0xf
    v_mov_b32_dpp v4, v42 quad_perm:[2,2,2,2] row_mask:0xf bank_mask:0xf
    s_nop 0
    v_add_f32_dpp v61, v41, v61 quad_perm:[1,1,1,1] row_mask:0xf bank_mask:0xf
    v_add_f32_dpp v4, v43, v4 quad_perm:[3,3,3,3] row_mask:0xf bank_mask:0xf
    v_add_f32 v61, v61, v4
    v_cvt_pk_bf16_f32 v49, v60, v61
    v_mfma_f32_16x16x32_bf16 v[36:39], a[184:187], v[20:23], 0
    v_mov_b32_dpp v60, v28 quad_perm:[0,0,0,0] row_mask:0xf bank_mask:0xf
    v_mov_b32_dpp v4, v30 quad_perm:[2,2,2,2] row_mask:0xf bank_mask:0xf
    s_nop 0
    v_add_f32_dpp v60, v29, v60 quad_perm:[1,1,1,1] row_mask:0xf bank_mask:0xf
    v_add_f32_dpp v4, v31, v4 quad_perm:[3,3,3,3] row_mask:0xf bank_mask:0xf
    v_add_f32 v60, v60, v4
    v_mfma_f32_16x16x32_bf16 v[40:43], a[188:191], v[20:23], 0
    v_mov_b32_dpp v61, v32 quad_perm:[0,0,0,0] row_mask:0xf bank_mask:0xf
    v_mov_b32_dpp v4, v34 quad_perm:[2,2,2,2] row_mask:0xf bank_mask:0xf
    s_nop 0
    v_add_f32_dpp v61, v33, v61 quad_perm:[1,1,1,1] row_mask:0xf bank_mask:0xf
    v_add_f32_dpp v4, v35, v4 quad_perm:[3,3,3,3] row_mask:0xf bank_mask:0xf
    v_add_f32 v61, v61, v4
    v_cvt_pk_bf16_f32 v50, v60, v61
    v_mfma_f32_16x16x32_bf16 v[28:31], a[192:195], v[20:23], 0
    v_mov_b32_dpp v60, v36 quad_perm:[0,0,0,0] row_mask:0xf bank_mask:0xf
    v_mov_b32_dpp v4, v38 quad_perm:[2,2,2,2] row_mask:0xf bank_mask:0xf
    s_nop 0
    v_add_f32_dpp v60, v37, v60 quad_perm:[1,1,1,1] row_mask:0xf bank_mask:0xf
    v_add_f32_dpp v4, v39, v4 quad_perm:[3,3,3,3] row_mask:0xf bank_mask:0xf
    v_add_f32 v60, v60, v4
    v_mfma_f32_16x16x32_bf16 v[32:35], a[196:199], v[20:23], 0
    v_mov_b32_dpp v61, v40 quad_perm:[0,0,0,0] row_mask:0xf bank_mask:0xf
    v_mov_b32_dpp v4, v42 quad_perm:[2,2,2,2] row_mask:0xf bank_mask:0xf
    s_nop 0
    v_add_f32_dpp v61, v41, v61 quad_perm:[1,1,1,1] row_mask:0xf bank_mask:0xf
    v_add_f32_dpp v4, v43, v4 quad_perm:[3,3,3,3] row_mask:0xf bank_mask:0xf
    v_add_f32 v61, v61, v4
    v_cvt_pk_bf16_f32 v51, v60, v61
    v_mfma_f32_16x16x32_bf16 v[36:39], a[200:203], v[20:23], 0
    v_mov_b32_dpp v60, v28 quad_perm:[0,0,0,0] row_mask:0xf bank_mask:0xf
    v_mov_b32_dpp v4, v30 quad_perm:[2,2,2,2] row_mask:0xf bank_mask:0xf
    s_nop 0
    v_add_f32_dpp v60, v29, v60 quad_perm:[1,1,1,1] row_mask:0xf bank_mask:0xf
    v_add_f32_dpp v4, v31, v4 quad_perm:[3,3,3,3] row_mask:0xf bank_mask:0xf
    v_add_f32 v60, v60, v4
    v_mfma_f32_16x16x32_bf16 v[40:43], a[204:207], v[20:23], 0
    v_mov_b32_dpp v61, v32 quad_perm:[0,0,0,0] row_mask:0xf bank_mask:0xf
    v_mov_b32_dpp v4, v34 quad_perm:[2,2,2,2] row_mask:0xf bank_mask:0xf
    s_nop 0
    v_add_f32_dpp v61, v33, v61 quad_perm:[1,1,1,1] row_mask:0xf bank_mask:0xf
    v_add_f32_dpp v4, v35, v4 quad_perm:[3,3,3,3] row_mask:0xf bank_mask:0xf
    v_add_f32 v61, v61, v4
    v_cvt_pk_bf16_f32 v52, v60, v61
    v_mfma_f32_16x16x32_bf16 v[28:31], a[208:211], v[20:23], 0
    v_mov_b32_dpp v60, v36 quad_perm:[0,0,0,0] row_mask:0xf bank_mask:0xf
    v_mov_b32_dpp v4, v38 quad_perm:[2,2,2,2] row_mask:0xf bank_mask:0xf
    s_nop 0
    v_add_f32_dpp v60, v37, v60 quad_perm:[1,1,1,1] row_mask:0xf bank_mask:0xf
    v_add_f32_dpp v4, v39, v4 quad_perm:[3,3,3,3] row_mask:0xf bank_mask:0xf
    v_add_f32 v60, v60, v4
    buffer_load_dwordx4 a[0:3], v76, s[52:55], s85 offen offset:0 nt
    v_mfma_f32_16x16x32_bf16 v[32:35], a[212:215], v[20:23], 0
    v_mov_b32_dpp v61, v40 quad_perm:[0,0,0,0] row_mask:0xf bank_mask:0xf
    v_mov_b32_dpp v4, v42 quad_perm:[2,2,2,2] row_mask:0xf bank_mask:0xf
    s_nop 0
    v_add_f32_dpp v61, v41, v61 quad_perm:[1,1,1,1] row_mask:0xf bank_mask:0xf
    v_add_f32_dpp v4, v43, v4 quad_perm:[3,3,3,3] row_mask:0xf bank_mask:0xf
    v_add_f32 v61, v61, v4
    v_cvt_pk_bf16_f32 v53, v60, v61
    v_mfma_f32_16x16x32_bf16 v[36:39], a[216:219], v[20:23], 0
    v_mov_b32_dpp v60, v28 quad_perm:[0,0,0,0] row_mask:0xf bank_mask:0xf
    v_mov_b32_dpp v4, v30 quad_perm:[2,2,2,2] row_mask:0xf bank_mask:0xf
    s_nop 0
    v_add_f32_dpp v60, v29, v60 quad_perm:[1,1,1,1] row_mask:0xf bank_mask:0xf
    v_add_f32_dpp v4, v31, v4 quad_perm:[3,3,3,3] row_mask:0xf bank_mask:0xf
    v_add_f32 v60, v60, v4
    v_mfma_f32_16x16x32_bf16 v[40:43], a[220:223], v[20:23], 0
    v_mov_b32_dpp v61, v32 quad_perm:[0,0,0,0] row_mask:0xf bank_mask:0xf
    v_mov_b32_dpp v4, v34 quad_perm:[2,2,2,2] row_mask:0xf bank_mask:0xf
    s_nop 0
    v_add_f32_dpp v61, v33, v61 quad_perm:[1,1,1,1] row_mask:0xf bank_mask:0xf
    v_add_f32_dpp v4, v35, v4 quad_perm:[3,3,3,3] row_mask:0xf bank_mask:0xf
    v_add_f32 v61, v61, v4
    v_cvt_pk_bf16_f32 v54, v60, v61
    v_mfma_f32_16x16x32_bf16 v[28:31], a[224:227], v[20:23], 0
    v_mov_b32_dpp v60, v36 quad_perm:[0,0,0,0] row_mask:0xf bank_mask:0xf
    v_mov_b32_dpp v4, v38 quad_perm:[2,2,2,2] row_mask:0xf bank_mask:0xf
    s_nop 0
    v_add_f32_dpp v60, v37, v60 quad_perm:[1,1,1,1] row_mask:0xf bank_mask:0xf
    v_add_f32_dpp v4, v39, v4 quad_perm:[3,3,3,3] row_mask:0xf bank_mask:0xf
    v_add_f32 v60, v60, v4
    v_mfma_f32_16x16x32_bf16 v[32:35], a[228:231], v[20:23], 0
    v_mov_b32_dpp v61, v40 quad_perm:[0,0,0,0] row_mask:0xf bank_mask:0xf
    v_mov_b32_dpp v4, v42 quad_perm:[2,2,2,2] row_mask:0xf bank_mask:0xf
    s_nop 0
    v_add_f32_dpp v61, v41, v61 quad_perm:[1,1,1,1] row_mask:0xf bank_mask:0xf
    v_add_f32_dpp v4, v43, v4 quad_perm:[3,3,3,3] row_mask:0xf bank_mask:0xf
    v_add_f32 v61, v61, v4
    v_cvt_pk_bf16_f32 v55, v60, v61
    v_mfma_f32_16x16x32_bf16 v[36:39], a[232:235], v[20:23], 0
    v_mov_b32_dpp v60, v28 quad_perm:[0,0,0,0] row_mask:0xf bank_mask:0xf
    v_mov_b32_dpp v4, v30 quad_perm:[2,2,2,2] row_mask:0xf bank_mask:0xf
    s_nop 0
    v_add_f32_dpp v60, v29, v60 quad_perm:[1,1,1,1] row_mask:0xf bank_mask:0xf
    v_add_f32_dpp v4, v31, v4 quad_perm:[3,3,3,3] row_mask:0xf bank_mask:0xf
    v_add_f32 v60, v60, v4
    v_mfma_f32_16x16x32_bf16 v[40:43], a[236:239], v[20:23], 0
    v_mov_b32_dpp v61, v32 quad_perm:[0,0,0,0] row_mask:0xf bank_mask:0xf
    v_mov_b32_dpp v4, v34 quad_perm:[2,2,2,2] row_mask:0xf bank_mask:0xf
    s_nop 0
    v_add_f32_dpp v61, v33, v61 quad_perm:[1,1,1,1] row_mask:0xf bank_mask:0xf
    v_add_f32_dpp v4, v35, v4 quad_perm:[3,3,3,3] row_mask:0xf bank_mask:0xf
    v_add_f32 v61, v61, v4
    v_cvt_pk_bf16_f32 v56, v60, v61
    v_mfma_f32_16x16x32_bf16 v[28:31], a[240:243], v[20:23], 0
    v_mov_b32_dpp v60, v36 quad_perm:[0,0,0,0] row_mask:0xf bank_mask:0xf
    v_mov_b32_dpp v4, v38 quad_perm:[2,2,2,2] row_mask:0xf bank_mask:0xf
    s_nop 0
    v_add_f32_dpp v60, v37, v60 quad_perm:[1,1,1,1] row_mask:0xf bank_mask:0xf
    v_add_f32_dpp v4, v39, v4 quad_perm:[3,3,3,3] row_mask:0xf bank_mask:0xf
    v_add_f32 v60, v60, v4
    buffer_load_dwordx4 a[4:7], v77, s[52:55], s85 offen offset:0 nt
    v_mfma_f32_16x16x32_bf16 v[32:35], a[244:247], v[20:23], 0
    v_mov_b32_dpp v61, v40 quad_perm:[0,0,0,0] row_mask:0xf bank_mask:0xf
    v_mov_b32_dpp v4, v42 quad_perm:[2,2,2,2] row_mask:0xf bank_mask:0xf
    s_nop 0
    v_add_f32_dpp v61, v41, v61 quad_perm:[1,1,1,1] row_mask:0xf bank_mask:0xf
    v_add_f32_dpp v4, v43, v4 quad_perm:[3,3,3,3] row_mask:0xf bank_mask:0xf
    v_add_f32 v61, v61, v4
    v_cvt_pk_bf16_f32 v57, v60, v61
    v_mfma_f32_16x16x32_bf16 v[36:39], a[248:251], v[20:23], 0
    v_mov_b32_dpp v60, v28 quad_perm:[0,0,0,0] row_mask:0xf bank_mask:0xf
    v_mov_b32_dpp v4, v30 quad_perm:[2,2,2,2] row_mask:0xf bank_mask:0xf
    s_nop 0
    v_add_f32_dpp v60, v29, v60 quad_perm:[1,1,1,1] row_mask:0xf bank_mask:0xf
    v_add_f32_dpp v4, v31, v4 quad_perm:[3,3,3,3] row_mask:0xf bank_mask:0xf
    v_add_f32 v60, v60, v4
    v_mfma_f32_16x16x32_bf16 v[40:43], a[252:255], v[20:23], 0
    v_mov_b32_dpp v61, v32 quad_perm:[0,0,0,0] row_mask:0xf bank_mask:0xf
    v_mov_b32_dpp v4, v34 quad_perm:[2,2,2,2] row_mask:0xf bank_mask:0xf
    s_nop 0
    v_add_f32_dpp v61, v33, v61 quad_perm:[1,1,1,1] row_mask:0xf bank_mask:0xf
    v_add_f32_dpp v4, v35, v4 quad_perm:[3,3,3,3] row_mask:0xf bank_mask:0xf
    v_add_f32 v61, v61, v4
    v_cvt_pk_bf16_f32 v58, v60, v61
    v_mov_b32_dpp v60, v36 quad_perm:[0,0,0,0] row_mask:0xf bank_mask:0xf
    v_mov_b32_dpp v4, v38 quad_perm:[2,2,2,2] row_mask:0xf bank_mask:0xf
    s_nop 0
    v_add_f32_dpp v60, v37, v60 quad_perm:[1,1,1,1] row_mask:0xf bank_mask:0xf
    v_add_f32_dpp v4, v39, v4 quad_perm:[3,3,3,3] row_mask:0xf bank_mask:0xf
    v_add_f32 v60, v60, v4
    v_mov_b32_dpp v61, v40 quad_perm:[0,0,0,0] row_mask:0xf bank_mask:0xf
    v_mov_b32_dpp v4, v42 quad_perm:[2,2,2,2] row_mask:0xf bank_mask:0xf
    s_nop 0
    v_add_f32_dpp v61, v41, v61 quad_perm:[1,1,1,1] row_mask:0xf bank_mask:0xf
    v_add_f32_dpp v4, v43, v4 quad_perm:[3,3,3,3] row_mask:0xf bank_mask:0xf
    v_add_f32 v61, v61, v4
    v_cvt_pk_bf16_f32 v59, v60, v61
    s_mov_b32 exec_lo, 0x22222222
    s_mov_b32 exec_hi, 0x22222222
    v_mov_b32 v44, v48
    v_mov_b32 v45, v49
    v_mov_b32 v46, v50
    v_mov_b32 v47, v51
    s_mov_b32 exec_lo, 0x44444444
    s_mov_b32 exec_hi, 0x44444444
    v_mov_b32 v44, v52
    v_mov_b32 v45, v53
    v_mov_b32 v46, v54
    v_mov_b32 v47, v55
    s_mov_b32 exec_lo, 0x88888888
    s_mov_b32 exec_hi, 0x88888888
    v_mov_b32 v44, v56
    v_mov_b32 v45, v57
    v_mov_b32 v46, v58
    v_mov_b32 v47, v59
    s_mov_b64 exec, -1
    buffer_store_dwordx4 v[44:47], v19, s[48:51], s94 offen sc1
    s_waitcnt vmcnt(5)
L_qcheck_14:
    v_xor_b32 v68, s35, v68
    v_xor_b32 v69, s35, v69
    v_xor_b32 v70, s35, v70
    v_xor_b32 v71, s35, v71
    v_xor_b32 v72, s35, v72
    v_xor_b32 v73, s35, v73
    v_xor_b32 v74, s35, v74
    v_xor_b32 v75, s35, v75
    v_or_b32 v4, v68, v69
    v_or3_b32 v4, v4, v70, v71
    v_or3_b32 v4, v4, v72, v73
    v_or3_b32 v4, v4, v74, v75
    v_and_b32 v4, 0xff, v4
    v_cmp_ne_u32 vcc, 0, v4
    s_cbranch_vccz L_qok_15
    buffer_load_dwordx4 v[68:71], v78, s[48:51], s91 offen offset:0 sc1
    buffer_load_dwordx4 v[72:75], v78, s[48:51], s91 offen offset:16 sc1
    s_waitcnt vmcnt(0)
    s_sub_u32 s84, s84, 1
    s_cmp_lg_u32 s84, 0
    s_cbranch_scc1 L_qcheck_14
    s_branch L_end
L_qok_15:
    v_cvt_pk_bf16_f32 v68, v68, v69
    v_cvt_pk_bf16_f32 v69, v70, v71
    v_cvt_pk_bf16_f32 v70, v72, v73
    v_cvt_pk_bf16_f32 v71, v74, v75
    s_mov_b32 vcc_lo, 0xf000f
    s_mov_b32 vcc_hi, 0xf000f
    v_cndmask_b32 v80, 0, v68, vcc
    v_cndmask_b32 v81, 0, v69, vcc
    v_cndmask_b32 v82, 0, v70, vcc
    v_cndmask_b32 v83, 0, v71, vcc
    s_mov_b32 vcc_lo, 0xf000f0
    s_mov_b32 vcc_hi, 0xf000f0
    v_cndmask_b32 v84, 0, v68, vcc
    v_cndmask_b32 v85, 0, v69, vcc
    v_cndmask_b32 v86, 0, v70, vcc
    v_cndmask_b32 v87, 0, v71, vcc
    s_mov_b32 vcc_lo, 0xf000f00
    s_mov_b32 vcc_hi, 0xf000f00
    v_cndmask_b32 v88, 0, v68, vcc
    v_cndmask_b32 v89, 0, v69, vcc
    v_cndmask_b32 v90, 0, v70, vcc
    v_cndmask_b32 v91, 0, v71, vcc
    s_mov_b32 vcc_lo, 0xf000f000
    s_mov_b32 vcc_hi, 0xf000f000
    v_cndmask_b32 v92, 0, v68, vcc
    v_cndmask_b32 v93, 0, v69, vcc
    v_cndmask_b32 v94, 0, v70, vcc
    v_cndmask_b32 v95, 0, v71, vcc
    v_mov_b32 v65, 0xff7f0000
    s_lshl_b32 s38, s34, 14
    s_add_u32 s38, s38, 16384
    v_lshl_add_u32 v64, v1, 2, s38
    buffer_load_dwordx4 a[8:11], v76, s[52:55], s85 offen offset:1024 nt
    v_mfma_f32_16x16x32_bf16 v[112:115], v[128:131], v[80:83], 0
    v_mfma_f32_16x16x32_bf16 v[112:115], v[132:135], v[84:87], v[112:115]
    buffer_load_dwordx4 a[12:15], v77, s[52:55], s85 offen offset:1024 nt
    s_add_u32 s87, s87, 7
    s_add_u32 s39, s87, s88
    s_bfe_u32 s37, s39, 0x30000
    s_lshl_b32 s37, s37, 12
    s_add_u32 s85, s37, s89
    s_bfe_u32 s37, s39, 0x10003
    s_lshl_b32 s37, s37, 11
    s_add_u32 s85, s37, s85
    s_bfe_u32 s37, s39, 0x40004
    s_lshl_b32 s37, s37, 16
    s_add_u32 s85, s37, s85
    v_mfma_f32_16x16x32_bf16 v[112:115], v[136:139], v[88:91], v[112:115]
    v_mfma_f32_16x16x32_bf16 v[112:115], v[140:143], v[92:95], v[112:115]
    buffer_load_dwordx4 a[16:19], v76, s[52:55], s85 offen offset:0 nt
    v_mfma_f32_16x16x32_bf16 v[96:99], v[144:147], v[80:83], 0
    v_mfma_f32_16x16x32_bf16 v[96:99], v[148:151], v[84:87], v[96:99]
    v_mfma_f32_16x16x32_bf16 v[96:99], v[152:155], v[88:91], v[96:99]
    s_nop 3
    v_mov_b32_dpp v122, v112 quad_perm:[0,0,0,0] row_mask:0xf bank_mask:0xf
    v_mov_b32_dpp v124, v114 quad_perm:[2,2,2,2] row_mask:0xf bank_mask:0xf
    s_nop 0
    v_add_f32_dpp v122, v113, v122 quad_perm:[1,1,1,1] row_mask:0xf bank_mask:0xf
    v_add_f32_dpp v124, v115, v124 quad_perm:[3,3,3,3] row_mask:0xf bank_mask:0xf
    v_add_f32 v122, v122, v124
    v_max_f32 v65, v65, v122
    ds_write_b32 v64, v122 offset:0
    s_waitcnt vmcnt(7)
    buffer_load_dwordx4 a[20:23], v77, s[52:55], s85 offen offset:0 nt
    v_mfma_f32_16x16x32_bf16 v[96:99], v[156:159], v[92:95], v[96:99]
    v_mfma_f32_16x16x32_bf16 v[112:115], v[160:163], v[80:83], 0
    s_waitcnt vmcnt(7)
    buffer_load_dwordx4 a[24:27], v76, s[52:55], s85 offen offset:1024 nt
    v_mfma_f32_16x16x32_bf16 v[112:115], v[164:167], v[84:87], v[112:115]
    v_mfma_f32_16x16x32_bf16 v[112:115], v[168:171], v[88:91], v[112:115]
    s_nop 2
    v_mov_b32_dpp v122, v96 quad_perm:[0,0,0,0] row_mask:0xf bank_mask:0xf
    v_mov_b32_dpp v124, v98 quad_perm:[2,2,2,2] row_mask:0xf bank_mask:0xf
    s_nop 0
    v_add_f32_dpp v122, v97, v122 quad_perm:[1,1,1,1] row_mask:0xf bank_mask:0xf
    v_add_f32_dpp v124, v99, v124 quad_perm:[3,3,3,3] row_mask:0xf bank_mask:0xf
    v_add_f32 v122, v122, v124
    v_max_f32 v65, v65, v122
    ds_write_b32 v64, v122 offset:256
    v_mfma_f32_16x16x32_bf16 v[112:115], v[172:175], v[92:95], v[112:115]
    s_waitcnt vmcnt(7)
    buffer_load_dwordx4 a[28:31], v77, s[52:55], s85 offen offset:1024 nt
    s_add_u32 s87, s87, 7
    s_add_u32 s39, s87, s88
    s_bfe_u32 s37, s39, 0x30000
    s_lshl_b32 s37, s37, 12
    s_add_u32 s85, s37, s89
    s_bfe_u32 s37, s39, 0x10003
    s_lshl_b32 s37, s37, 11
    s_add_u32 s85, s37, s85
    s_bfe_u32 s37, s39, 0x40004
    s_lshl_b32 s37, s37, 16
    s_add_u32 s85, s37, s85
    v_mfma_f32_16x16x32_bf16 v[96:99], v[176:179], v[80:83], 0
    v_mfma_f32_16x16x32_bf16 v[96:99], v[180:183], v[84:87], v[96:99]
    s_waitcnt vmcnt(7)
    buffer_load_dwordx4 a[32:35], v76, s[52:55], s85 offen offset:0 nt
    v_mfma_f32_16x16x32_bf16 v[96:99], v[184:187], v[88:91], v[96:99]
    v_mov_b32_dpp v122, v112 quad_perm:[0,0,0,0] row_mask:0xf bank_mask:0xf
    v_mov_b32_dpp v124, v114 quad_perm:[2,2,2,2] row_mask:0xf bank_mask:0xf
    s_nop 0
    v_add_f32_dpp v122, v113, v122 quad_perm:[1,1,1,1] row_mask:0xf bank_mask:0xf
    v_add_f32_dpp v124, v115, v124 quad_perm:[3,3,3,3] row_mask:0xf bank_mask:0xf
    v_add_f32 v122, v122, v124
    v_max_f32 v65, v65, v122
    ds_write_b32 v64, v122 offset:512
    v_mfma_f32_16x16x32_bf16 v[96:99], v[188:191], v[92:95], v[96:99]
    s_lshl_b32 s38, s32, 8
    s_add_u32 s69, s38, 98304
    s_lshl_b32 s38, s34, 13
    s_add_u32 s69, s38, s69
    v_mov_b32 v48, s69
    v_mov_b32 v49, s68
    s_waitcnt vmcnt(7)
    s_mov_b64 exec, 1
    buffer_store_dword v49, v48, s[48:51], 0 offen sc1
    s_mov_b64 exec, -1
    s_waitcnt vmcnt(7)
    buffer_load_dwordx4 a[36:39], v77, s[52:55], s85 offen offset:0 nt
    v_mfma_f32_16x16x32_bf16 v[112:115], v[192:195], v[80:83], 0
    v_mfma_f32_16x16x32_bf16 v[112:115], v[196:199], v[84:87], v[112:115]
    v_mfma_f32_16x16x32_bf16 v[112:115], v[200:203], v[88:91], v[112:115]
    v_mov_b32_dpp v122, v96 quad_perm:[0,0,0,0] row_mask:0xf bank_mask:0xf
    v_mov_b32_dpp v124, v98 quad_perm:[2,2,2,2] row_mask:0xf bank_mask:0xf
    s_nop 0
    v_add_f32_dpp v122, v97, v122 quad_perm:[1,1,1,1] row_mask:0xf bank_mask:0xf
    v_add_f32_dpp v124, v99, v124 quad_perm:[3,3,3,3] row_mask:0xf bank_mask:0xf
    v_add_f32 v122, v122, v124
    v_max_f32 v65, v65, v122
    ds_write_b32 v64, v122 offset:768
    s_waitcnt vmcnt(7)
    buffer_load_dwordx4 a[40:43], v76, s[52:55], s85 offen offset:1024 nt
    v_mfma_f32_16x16x32_bf16 v[112:115], v[204:207], v[92:95], v[112:115]
    v_mfma_f32_16x16x32_bf16 v[96:99], v[208:211], v[80:83], 0
    s_waitcnt vmcnt(7)
    buffer_load_dwordx4 a[44:47], v77, s[52:55], s85 offen offset:1024 nt
    s_add_u32 s87, s87, 7
    s_add_u32 s39, s87, s88
    s_bfe_u32 s37, s39, 0x30000
    s_lshl_b32 s37, s37, 12
    s_add_u32 s85, s37, s89
    s_bfe_u32 s37, s39, 0x10003
    s_lshl_b32 s37, s37, 11
    s_add_u32 s85, s37, s85
    s_bfe_u32 s37, s39, 0x40004
    s_lshl_b32 s37, s37, 16
    s_add_u32 s85, s37, s85
    v_mfma_f32_16x16x32_bf16 v[96:99], v[212:215], v[84:87], v[96:99]
    v_mfma_f32_16x16x32_bf16 v[96:99], v[216:219], v[88:91], v[96:99]
    v_mov_b32_dpp v122, v112 quad_perm:[0,0,0,0] row_mask:0xf bank_mask:0xf
    v_mov_b32_dpp v124, v114 quad_perm:[2,2,2,2] row_mask:0xf bank_mask:0xf
    s_nop 0
    v_add_f32_dpp v122, v113, v122 quad_perm:[1,1,1,1] row_mask:0xf bank_mask:0xf
    v_add_f32_dpp v124, v115, v124 quad_perm:[3,3,3,3] row_mask:0xf bank_mask:0xf
    v_add_f32 v122, v122, v124
    v_max_f32 v65, v65, v122
    ds_write_b32 v64, v122 offset:1024
    v_mfma_f32_16x16x32_bf16 v[96:99], v[220:223], v[92:95], v[96:99]
    s_waitcnt vmcnt(7)
    buffer_load_dwordx4 a[48:51], v76, s[52:55], s85 offen offset:0 nt
    v_mfma_f32_16x16x32_bf16 v[112:115], v[224:227], v[80:83], 0
    v_mfma_f32_16x16x32_bf16 v[112:115], v[228:231], v[84:87], v[112:115]
    s_waitcnt vmcnt(7)
    buffer_load_dwordx4 a[52:55], v77, s[52:55], s85 offen offset:0 nt
    v_mfma_f32_16x16x32_bf16 v[112:115], v[232:235], v[88:91], v[112:115]
    s_nop 0
    v_mov_b32_dpp v122, v96 quad_perm:[0,0,0,0] row_mask:0xf bank_mask:0xf
    v_mov_b32_dpp v124, v98 quad_perm:[2,2,2,2] row_mask:0xf bank_mask:0xf
    s_nop 0
    v_add_f32_dpp v122, v97, v122 quad_perm:[1,1,1,1] row_mask:0xf bank_mask:0xf
    v_add_f32_dpp v124, v99, v124 quad_perm:[3,3,3,3] row_mask:0xf bank_mask:0xf
    v_add_f32 v122, v122, v124
    v_max_f32 v65, v65, v122
    ds_write_b32 v64, v122 offset:1280
    v_mfma_f32_16x16x32_bf16 v[112:115], v[236:239], v[92:95], v[112:115]
    s_waitcnt vmcnt(7)
    buffer_load_dwordx4 a[56:59], v76, s[52:55], s85 offen offset:1024 nt
    v_mfma_f32_16x16x32_bf16 v[96:99], v[240:243], v[80:83], 0
    v_mfma_f32_16x16x32_bf16 v[96:99], v[244:247], v[84:87], v[96:99]
    v_mfma_f32_16x16x32_bf16 v[96:99], v[248:251], v[88:91], v[96:99]
    s_nop 2
    v_mov_b32_dpp v122, v112 quad_perm:[0,0,0,0] row_mask:0xf bank_mask:0xf
    v_mov_b32_dpp v124, v114 quad_perm:[2,2,2,2] row_mask:0xf bank_mask:0xf
    s_nop 0
    v_add_f32_dpp v122, v113, v122 quad_perm:[1,1,1,1] row_mask:0xf bank_mask:0xf
    v_add_f32_dpp v124, v115, v124 quad_perm:[3,3,3,3] row_mask:0xf bank_mask:0xf
    v_add_f32 v122, v122, v124
    v_max_f32 v65, v65, v122
    ds_write_b32 v64, v122 offset:1536
    s_waitcnt vmcnt(7)
    buffer_load_dwordx4 a[60:63], v77, s[52:55], s85 offen offset:1024 nt
    s_add_u32 s87, s87, 7
    s_add_u32 s39, s87, s88
    s_bfe_u32 s37, s39, 0x30000
    s_lshl_b32 s37, s37, 12
    s_add_u32 s85, s37, s89
    s_bfe_u32 s37, s39, 0x10003
    s_lshl_b32 s37, s37, 11
    s_add_u32 s85, s37, s85
    s_bfe_u32 s37, s39, 0x40004
    s_lshl_b32 s37, s37, 16
    s_add_u32 s85, s37, s85
    v_mfma_f32_16x16x32_bf16 v[96:99], v[252:255], v[92:95], v[96:99]
    v_mfma_f32_16x16x32_bf16 v[112:115], a[0:3], v[80:83], 0
    s_waitcnt vmcnt(5)
    buffer_load_dwordx4 v[128:131], v76, s[52:55], s85 offen offset:0 nt
    v_mfma_f32_16x16x32_bf16 v[112:115], a[4:7], v[84:87], v[112:115]
    v_mfma_f32_16x16x32_bf16 v[112:115], a[8:11], v[88:91], v[112:115]
    s_nop 2
    v_mov_b32_dpp v122, v96 quad_perm:[0,0,0,0] row_mask:0xf bank_mask:0xf
    v_mov_b32_dpp v124, v98 quad_perm:[2,2,2,2] row_mask:0xf bank_mask:0xf
    s_nop 0
    v_add_f32_dpp v122, v97, v122 quad_perm:[1,1,1,1] row_mask:0xf bank_mask:0xf
    v_add_f32_dpp v124, v99, v124 quad_perm:[3,3,3,3] row_mask:0xf bank_mask:0xf
    v_add_f32 v122, v122, v124
    v_max_f32 v65, v65, v122
    ds_write_b32 v64, v122 offset:1792
    v_mfma_f32_16x16x32_bf16 v[112:115], a[12:15], v[92:95], v[112:115]
    s_waitcnt vmcnt(5)
    buffer_load_dwordx4 v[132:135], v77, s[52:55], s85 offen offset:0 nt
    v_mfma_f32_16x16x32_bf16 v[96:99], a[16:19], v[80:83], 0
    v_mfma_f32_16x16x32_bf16 v[96:99], a[20:23], v[84:87], v[96:99]
    s_waitcnt vmcnt(5)
    buffer_load_dwordx4 v[136:139], v76, s[52:55], s85 offen offset:1024 nt
    v_mfma_f32_16x16x32_bf16 v[96:99], a[24:27], v[88:91], v[96:99]
    s_nop 0
    v_mov_b32_dpp v122, v112 quad_perm:[0,0,0,0] row_mask:0xf bank_mask:0xf
    v_mov_b32_dpp v124, v114 quad_perm:[2,2,2,2] row_mask:0xf bank_mask:0xf
    s_nop 0
    v_add_f32_dpp v122, v113, v122 quad_perm:[1,1,1,1] row_mask:0xf bank_mask:0xf
    v_add_f32_dpp v124, v115, v124 quad_perm:[3,3,3,3] row_mask:0xf bank_mask:0xf
    v_add_f32 v122, v122, v124
    v_max_f32 v65, v65, v122
    ds_write_b32 v64, v122 offset:2048
    v_mfma_f32_16x16x32_bf16 v[96:99], a[28:31], v[92:95], v[96:99]
    s_waitcnt vmcnt(5)
    buffer_load_dwordx4 v[140:143], v77, s[52:55], s85 offen offset:1024 nt
    s_add_u32 s87, s87, 7
    s_add_u32 s39, s87, s88
    s_bfe_u32 s37, s39, 0x30000
    s_lshl_b32 s37, s37, 12
    s_add_u32 s85, s37, s89
    s_bfe_u32 s37, s39, 0x10003
    s_lshl_b32 s37, s37, 11
    s_add_u32 s85, s37, s85
    s_bfe_u32 s37, s39, 0x40004
    s_lshl_b32 s37, s37, 16
    s_add_u32 s85, s37, s85
    v_mfma_f32_16x16x32_bf16 v[112:115], a[32:35], v[80:83], 0
    v_mfma_f32_16x16x32_bf16 v[112:115], a[36:39], v[84:87], v[112:115]
    v_mfma_f32_16x16x32_bf16 v[112:115], a[40:43], v[88:91], v[112:115]
    v_mov_b32_dpp v122, v96 quad_perm:[0,0,0,0] row_mask:0xf bank_mask:0xf
    v_mov_b32_dpp v124, v98 quad_perm:[2,2,2,2] row_mask:0xf bank_mask:0xf
    s_nop 0
    v_add_f32_dpp v122, v97, v122 quad_perm:[1,1,1,1] row_mask:0xf bank_mask:0xf
    v_add_f32_dpp v124, v99, v124 quad_perm:[3,3,3,3] row_mask:0xf bank_mask:0xf
    v_add_f32 v122, v122, v124
    v_max_f32 v65, v65, v122
    ds_write_b32 v64, v122 offset:2304
    s_waitcnt vmcnt(5)
    buffer_load_dwordx4 v[144:147], v76, s[52:55], s85 offen offset:0 nt
    v_mfma_f32_16x16x32_bf16 v[112:115], a[44:47], v[92:95], v[112:115]
    v_mfma_f32_16x16x32_bf16 v[96:99], a[48:51], v[80:83], 0
    s_waitcnt vmcnt(5)
    buffer_load_dwordx4 v[148:151], v77, s[52:55], s85 offen offset:0 nt
    v_mfma_f32_16x16x32_bf16 v[96:99], a[52:55], v[84:87], v[96:99]
    v_mfma_f32_16x16x32_bf16 v[96:99], a[56:59], v[88:91], v[96:99]
    s_nop 2
    v_mov_b32_dpp v122, v112 quad_perm:[0,0,0,0] row_mask:0xf bank_mask:0xf
    v_mov_b32_dpp v124, v114 quad_perm:[2,2,2,2] row_mask:0xf bank_mask:0xf
    s_nop 0
    v_add_f32_dpp v122, v113, v122 quad_perm:[1,1,1,1] row_mask:0xf bank_mask:0xf
    v_add_f32_dpp v124, v115, v124 quad_perm:[3,3,3,3] row_mask:0xf bank_mask:0xf
    v_add_f32 v122, v122, v124
    v_max_f32 v65, v65, v122
    ds_write_b32 v64, v122 offset:2560
    v_mfma_f32_16x16x32_bf16 v[96:99], a[60:63], v[92:95], v[96:99]
    v_add_u32 v64, 2816, v64
    s_mov_b32 s97, 10
    s_mov_b32 s86, 32
    s_mov_b32 s66, 134217728
    s_mov_b32 s67, 0x20000
    s_mov_b64 s[64:65], s[52:53]
    v_mov_b32 v62, v76
    v_mov_b32 v63, v77
    s_branch L_bloop
L_aux:
    v_lshlrev_b32 v4, 2, v2
    v_xor_b32 v4, v4, v3
    v_xor_b32 v96, 0, v4
    v_lshlrev_b32 v96, 4, v96
    v_lshl_add_u32 v10, v2, 13, v96
    v_xor_b32 v97, 1, v4
    v_lshlrev_b32 v97, 4, v97
    v_lshl_add_u32 v11, v2, 13, v97
    v_add_u32 v11, 31744, v11
    v_xor_b32 v98, 2, v4
    v_lshlrev_b32 v98, 4, v98
    v_lshl_add_u32 v12, v2, 13, v98
    v_add_u32 v12, 63488, v12
    v_xor_b32 v99, 3, v4
    v_lshlrev_b32 v99, 4, v99
    v_lshl_add_u32 v13, v2, 13, v99
    v_add_u32 v13, 95232, v13
    s_lshl_b32 s90, s34, 15
    s_mov_b32 s62, 0
    s_mov_b32 s94, 0
    s_lshl_b32 s95, s34, 20
    s_lshl_b32 s38, s32, 8
    s_add_u32 s95, s95, s38
    s_waitcnt lgkmcnt(0)
    s_mov_b32 s52, s12
    s_and_b32 s53, s13, 0xffff
    s_mov_b32 s54, 4194304
    s_mov_b32 s55, 0x20000
    s_add_u32 s39, s90, s62
    s_mov_b32 m0, s39
    s_add_u32 s62, s62, 4096
    s_and_b32 s62, s62, 0x7fff
    buffer_load_dwordx4 v10, s[52:55], s95 offen offset:0 nt lds
    buffer_load_dwordx4 v11, s[52:55], s95 offen offset:1024 nt lds
    buffer_load_dwordx4 v12, s[52:55], s95 offen offset:2048 nt lds
    buffer_load_dwordx4 v13, s[52:55], s95 offen offset:3072 nt lds
    s_add_u32 s95, s95, 131072
    s_add_u32 s39, s90, s62
    s_mov_b32 m0, s39
    s_add_u32 s62, s62, 4096
    s_and_b32 s62, s62, 0x7fff
    buffer_load_dwordx4 v10, s[52:55], s95 offen offset:0 nt lds
    buffer_load_dwordx4 v11, s[52:55], s95 offen offset:1024 nt lds
    buffer_load_dwordx4 v12, s[52:55], s95 offen offset:2048 nt lds
    buffer_load_dwordx4 v13, s[52:55], s95 offen offset:3072 nt lds
    s_add_u32 s95, s95, 131072
    s_load_dword s35, s[30:31], 0
    s_mov_b32 s48, s30
    s_and_b32 s49, s31, 0xffff
    s_mov_b32 s50, 8388608
    s_mov_b32 s51, 0x20000
    s_mov_b32 s82, 0xffffff00
    s_mov_b32 s83, 0x3e0293ee
    s_mov_b32 s84, 2097152
    s_mov_b32 s72, s26
    s_and_b32 s73, s27, 0xffff
    s_mov_b32 s74, 8192
    s_mov_b32 s75, 0x20000
    v_lshl_add_u32 v76, v2, 10, v96
    v_lshl_add_u32 v96, v2, 8, v96
    v_lshl_add_u32 v77, v2, 10, v97
    v_lshl_add_u32 v97, v2, 8, v97
    v_add_u32 v77, 3072, v77
    v_lshl_add_u32 v78, v2, 10, v98
    v_lshl_add_u32 v98, v2, 8, v98
    v_add_u32 v78, 6144, v78
    v_lshl_add_u32 v79, v2, 10, v99
    v_lshl_add_u32 v99, v2, 8, v99
    v_add_u32 v79, 9216, v79
    v_bfe_u32 v100, v1, 0, 5
    v_lshlrev_b32 v101, 8, v100
    v_mov_b32 v100, 0
    s_lshl_b32 s38, s34, 13
    v_add_u32 v101, s38, v101
    v_lshlrev_b32 v4, 4, v3
    v_lshl_add_u32 v9, v2, 10, v4
    s_lshl_b32 s63, s32, 17
    s_lshl_b32 s38, s34, 8
    s_add_u32 s63, s63, s38
    v_and_b32 v4, 3, v1
    v_bfe_u32 v5, v1, 2, 2
    v_lshrrev_b32 v6, 5, v1
    v_lshl_add_u32 v7, v4, 2, v5
    v_xor_b32 v7, v7, v6
    v_lshlrev_b32 v7, 4, v7
    v_and_b32 v80, 31, v1
    v_lshl_add_u32 v80, v80, 8, v7
    v_lshl_add_u32 v81, v6, 2, v5
    v_lshlrev_b32 v81, 8, v81
    v_lshl_add_u32 v81, v5, 6, v81
    v_bfe_u32 v7, v1, 4, 1
    v_lshlrev_b32 v7, 1, v7
    v_bfe_u32 v82, v1, 1, 1
    v_add_u32 v7, v7, v82
    v_xor_b32 v7, v7, v6
    v_lshl_add_u32 v81, v7, 4, v81
    v_and_b32 v7, 1, v1
    v_lshl_add_u32 v81, v7, 3, v81
    v_lshl_add_u32 v95, v2, 3, v5
    v_lshlrev_b32 v95, 8, v95
    v_lshl_add_u32 v95, v5, 6, v95
    v_bfe_u32 v4, v1, 4, 1
    v_lshl_add_u32 v4, v4, 1, v82
    v_lshl_add_u32 v95, v4, 4, v95
    v_lshl_add_u32 v95, v7, 3, v95
    v_add_u32 v95, s90, v95
    v_xor_b32 v136, 0, v95
    v_xor_b32 v137, 16, v95
    v_xor_b32 v138, 32, v95
    v_xor_b32 v139, 48, v95
    v_xor_b32 v140, 64, v95
    v_xor_b32 v141, 80, v95
    v_xor_b32 v142, 96, v95
    v_xor_b32 v143, 112, v95
    v_xor_b32 v144, 128, v95
    v_xor_b32 v145, 144, v95
    v_xor_b32 v146, 160, v95
    v_xor_b32 v147, 176, v95
    v_xor_b32 v148, 192, v95
    v_xor_b32 v149, 208, v95
    v_xor_b32 v150, 224, v95
    v_xor_b32 v151, 240, v95
    s_lshl_b32 s85, s34, 13
    s_add_u32 s85, s85, 131072
    v_lshl_add_u32 v94, v1, 4, s85
    v_add_u32 v96, s85, v96
    v_add_u32 v97, s85, v97
    v_add_u32 v98, s85, v98
    v_add_u32 v99, s85, v99
    s_add_u32 s39, s90, s62
    s_mov_b32 m0, s39
    s_add_u32 s62, s62, 4096
    s_and_b32 s62, s62, 0x7fff
    buffer_load_dwordx4 v10, s[52:55], s95 offen offset:0 nt lds
    buffer_load_dwordx4 v11, s[52:55], s95 offen offset:1024 nt lds
    buffer_load_dwordx4 v12, s[52:55], s95 offen offset:2048 nt lds
    buffer_load_dwordx4 v13, s[52:55], s95 offen offset:3072 nt lds
    s_add_u32 s95, s95, 131072
    s_add_u32 s39, s90, s62
    s_mov_b32 m0, s39
    s_add_u32 s62, s62, 4096
    s_and_b32 s62, s62, 0x7fff
    buffer_load_dwordx4 v10, s[52:55], s95 offen offset:0 nt lds
    buffer_load_dwordx4 v11, s[52:55], s95 offen offset:1024 nt lds
    buffer_load_dwordx4 v12, s[52:55], s95 offen offset:2048 nt lds
    buffer_load_dwordx4 v13, s[52:55], s95 offen offset:3072 nt lds
    s_add_u32 s95, s95, 131072
    s_add_u32 s39, s90, s62
    s_mov_b32 m0, s39
    s_add_u32 s62, s62, 4096
    s_and_b32 s62, s62, 0x7fff
    buffer_load_dwordx4 v10, s[52:55], s95 offen offset:0 nt lds
    buffer_load_dwordx4 v11, s[52:55], s95 offen offset:1024 nt lds
    buffer_load_dwordx4 v12, s[52:55], s95 offen offset:2048 nt lds
    buffer_load_dwordx4 v13, s[52:55], s95 offen offset:3072 nt lds
    s_add_u32 s95, s95, 131072
    s_add_u32 s39, s90, s62
    s_mov_b32 m0, s39
    s_add_u32 s62, s62, 4096
    s_and_b32 s62, s62, 0x7fff
    buffer_load_dwordx4 v10, s[52:55], s95 offen offset:0 nt lds
    buffer_load_dwordx4 v11, s[52:55], s95 offen offset:1024 nt lds
    buffer_load_dwordx4 v12, s[52:55], s95 offen offset:2048 nt lds
    buffer_load_dwordx4 v13, s[52:55], s95 offen offset:3072 nt lds
    s_add_u32 s95, s95, 131072
    s_add_u32 s39, s90, s62
    s_mov_b32 m0, s39
    s_add_u32 s62, s62, 4096
    s_and_b32 s62, s62, 0x7fff
    buffer_load_dwordx4 v10, s[52:55], s95 offen offset:0 nt lds
    buffer_load_dwordx4 v11, s[52:55], s95 offen offset:1024 nt lds
    buffer_load_dwordx4 v12, s[52:55], s95 offen offset:2048 nt lds
    buffer_load_dwordx4 v13, s[52:55], s95 offen offset:3072 nt lds
    s_add_u32 s95, s95, 131072
    s_add_u32 s39, s90, s62
    s_mov_b32 m0, s39
    s_add_u32 s62, s62, 4096
    s_and_b32 s62, s62, 0x7fff
    buffer_load_dwordx4 v10, s[52:55], s95 offen offset:0 nt lds
    buffer_load_dwordx4 v11, s[52:55], s95 offen offset:1024 nt lds
    buffer_load_dwordx4 v12, s[52:55], s95 offen offset:2048 nt lds
    buffer_load_dwordx4 v13, s[52:55], s95 offen offset:3072 nt lds
    s_add_u32 s95, s95, 131072
    s_waitcnt lgkmcnt(0)
    s_add_u32 s35, s35, 0x5b
    s_and_b32 s35, s35, 0xff
    v_mov_b32 v8, s35
    s_or_b32 s68, s35, 0x6b3ac500
    s_mov_b32 s52, s14
    s_and_b32 s53, s15, 0xffff
    s_mov_b32 s54, 4194304
    s_mov_b32 s55, 0x20000
    s_mov_b32 s95, s63
    s_waitcnt vmcnt(24)
    ds_read_b64_tr_b16 a[128:129], v136 offset:0
    ds_read_b64_tr_b16 a[130:131], v137 offset:1024
    ds_read_b64_tr_b16 a[144:145], v138 offset:0
    ds_read_b64_tr_b16 a[146:147], v139 offset:1024
    ds_read_b64_tr_b16 a[160:161], v140 offset:0
    ds_read_b64_tr_b16 a[162:163], v141 offset:1024
    ds_read_b64_tr_b16 a[176:177], v142 offset:0
    ds_read_b64_tr_b16 a[178:179], v143 offset:1024
    ds_read_b64_tr_b16 a[192:193], v144 offset:0
    ds_read_b64_tr_b16 a[194:195], v145 offset:1024
    ds_read_b64_tr_b16 a[208:209], v146 offset:0
    ds_read_b64_tr_b16 a[210:211], v147 offset:1024
    ds_read_b64_tr_b16 a[224:225], v148 offset:0
    ds_read_b64_tr_b16 a[226:227], v149 offset:1024
    ds_read_b64_tr_b16 a[240:241], v150 offset:0
    ds_read_b64_tr_b16 a[242:243], v151 offset:1024
    s_waitcnt lgkmcnt(0)
    s_add_u32 s39, s90, s62
    s_mov_b32 m0, s39
    s_add_u32 s62, s62, 4096
    s_and_b32 s62, s62, 0x7fff
    buffer_load_dwordx4 v76, s[52:55], s95 offen offset:0 nt lds
    buffer_load_dwordx4 v77, s[52:55], s95 offen offset:1024 nt lds
    buffer_load_dwordx4 v78, s[52:55], s95 offen offset:2048 nt lds
    buffer_load_dwordx4 v79, s[52:55], s95 offen offset:3072 nt lds
    s_add_u32 s95, s95, 16384
    s_add_u32 s39, s90, s62
    s_mov_b32 m0, s39
    s_add_u32 s62, s62, 4096
    s_and_b32 s62, s62, 0x7fff
    buffer_load_dwordx4 v76, s[52:55], s95 offen offset:0 nt lds
    buffer_load_dwordx4 v77, s[52:55], s95 offen offset:1024 nt lds
    buffer_load_dwordx4 v78, s[52:55], s95 offen offset:2048 nt lds
    buffer_load_dwordx4 v79, s[52:55], s95 offen offset:3072 nt lds
    s_add_u32 s95, s95, 16384
    s_waitcnt vmcnt(24)
    ds_read_b64_tr_b16 a[132:133], v136 offset:8192
    ds_read_b64_tr_b16 a[134:135], v137 offset:9216
    ds_read_b64_tr_b16 a[148:149], v138 offset:8192
    ds_read_b64_tr_b16 a[150:151], v139 offset:9216
    ds_read_b64_tr_b16 a[164:165], v140 offset:8192
    ds_read_b64_tr_b16 a[166:167], v141 offset:9216
    ds_read_b64_tr_b16 a[180:181], v142 offset:8192
    ds_read_b64_tr_b16 a[182:183], v143 offset:9216
    ds_read_b64_tr_b16 a[196:197], v144 offset:8192
    ds_read_b64_tr_b16 a[198:199], v145 offset:9216
    ds_read_b64_tr_b16 a[212:213], v146 offset:8192
    ds_read_b64_tr_b16 a[214:215], v147 offset:9216
    ds_read_b64_tr_b16 a[228:229], v148 offset:8192
    ds_read_b64_tr_b16 a[230:231], v149 offset:9216
    ds_read_b64_tr_b16 a[244:245], v150 offset:8192
    ds_read_b64_tr_b16 a[246:247], v151 offset:9216
    s_waitcnt lgkmcnt(0)
    s_add_u32 s39, s90, s62
    s_mov_b32 m0, s39
    s_add_u32 s62, s62, 4096
    s_and_b32 s62, s62, 0x7fff
    buffer_load_dwordx4 v76, s[52:55], s95 offen offset:0 nt lds
    buffer_load_dwordx4 v77, s[52:55], s95 offen offset:1024 nt lds
    buffer_load_dwordx4 v78, s[52:55], s95 offen offset:2048 nt lds
    buffer_load_dwordx4 v79, s[52:55], s95 offen offset:3072 nt lds
    s_add_u32 s95, s95, 16384
    s_add_u32 s39, s90, s62
    s_mov_b32 m0, s39
    s_add_u32 s62, s62, 4096
    s_and_b32 s62, s62, 0x7fff
    buffer_load_dwordx4 v76, s[52:55], s95 offen offset:0 nt lds
    buffer_load_dwordx4 v77, s[52:55], s95 offen offset:1024 nt lds
    buffer_load_dwordx4 v78, s[52:55], s95 offen offset:2048 nt lds
    buffer_load_dwordx4 v79, s[52:55], s95 offen offset:3072 nt lds
    s_add_u32 s95, s95, 16384
    s_waitcnt vmcnt(24)
    ds_read_b64_tr_b16 a[136:137], v136 offset:16384
    ds_read_b64_tr_b16 a[138:139], v137 offset:17408
    ds_read_b64_tr_b16 a[152:153], v138 offset:16384
    ds_read_b64_tr_b16 a[154:155], v139 offset:17408
    ds_read_b64_tr_b16 a[168:169], v140 offset:16384
    ds_read_b64_tr_b16 a[170:171], v141 offset:17408
    ds_read_b64_tr_b16 a[184:185], v142 offset:16384
    ds_read_b64_tr_b16 a[186:187], v143 offset:17408
    ds_read_b64_tr_b16 a[200:201], v144 offset:16384
    ds_read_b64_tr_b16 a[202:203], v145 offset:17408
    ds_read_b64_tr_b16 a[216:217], v146 offset:16384
    ds_read_b64_tr_b16 a[218:219], v147 offset:17408
    ds_read_b64_tr_b16 a[232:233], v148 offset:16384
    ds_read_b64_tr_b16 a[234:235], v149 offset:17408
    ds_read_b64_tr_b16 a[248:249], v150 offset:16384
    ds_read_b64_tr_b16 a[250:251], v151 offset:17408
    s_waitcnt lgkmcnt(0)
    s_add_u32 s39, s90, s62
    s_mov_b32 m0, s39
    s_add_u32 s62, s62, 4096
    s_and_b32 s62, s62, 0x7fff
    buffer_load_dwordx4 v76, s[52:55], s95 offen offset:0 nt lds
    buffer_load_dwordx4 v77, s[52:55], s95 offen offset:1024 nt lds
    buffer_load_dwordx4 v78, s[52:55], s95 offen offset:2048 nt lds
    buffer_load_dwordx4 v79, s[52:55], s95 offen offset:3072 nt lds
    s_add_u32 s95, s95, 16384
    s_add_u32 s39, s90, s62
    s_mov_b32 m0, s39
    s_add_u32 s62, s62, 4096
    s_and_b32 s62, s62, 0x7fff
    buffer_load_dwordx4 v76, s[52:55], s95 offen offset:0 nt lds
    buffer_load_dwordx4 v77, s[52:55], s95 offen offset:1024 nt lds
    buffer_load_dwordx4 v78, s[52:55], s95 offen offset:2048 nt lds
    buffer_load_dwordx4 v79, s[52:55], s95 offen offset:3072 nt lds
    s_add_u32 s95, s95, 16384
    s_waitcnt vmcnt(24)
    ds_read_b64_tr_b16 a[140:141], v136 offset:24576
    ds_read_b64_tr_b16 a[142:143], v137 offset:25600
    ds_read_b64_tr_b16 a[156:157], v138 offset:24576
    ds_read_b64_tr_b16 a[158:159], v139 offset:25600
    ds_read_b64_tr_b16 a[172:173], v140 offset:24576
    ds_read_b64_tr_b16 a[174:175], v141 offset:25600
    ds_read_b64_tr_b16 a[188:189], v142 offset:24576
    ds_read_b64_tr_b16 a[190:191], v143 offset:25600
    ds_read_b64_tr_b16 a[204:205], v144 offset:24576
    ds_read_b64_tr_b16 a[206:207], v145 offset:25600
    ds_read_b64_tr_b16 a[220:221], v146 offset:24576
    ds_read_b64_tr_b16 a[222:223], v147 offset:25600
    ds_read_b64_tr_b16 a[236:237], v148 offset:24576
    ds_read_b64_tr_b16 a[238:239], v149 offset:25600
    ds_read_b64_tr_b16 a[252:253], v150 offset:24576
    ds_read_b64_tr_b16 a[254:255], v151 offset:25600
    s_waitcnt lgkmcnt(0)
    s_add_u32 s39, s90, s62
    s_mov_b32 m0, s39
    s_add_u32 s62, s62, 4096
    s_and_b32 s62, s62, 0x7fff
    buffer_load_dwordx4 v76, s[52:55], s95 offen offset:0 nt lds
    buffer_load_dwordx4 v77, s[52:55], s95 offen offset:1024 nt lds
    buffer_load_dwordx4 v78, s[52:55], s95 offen offset:2048 nt lds
    buffer_load_dwordx4 v79, s[52:55], s95 offen offset:3072 nt lds
    s_add_u32 s95, s95, 16384
    s_add_u32 s39, s90, s62
    s_mov_b32 m0, s39
    s_add_u32 s62, s62, 4096
    s_and_b32 s62, s62, 0x7fff
    buffer_load_dwordx4 v76, s[52:55], s95 offen offset:0 nt lds
    buffer_load_dwordx4 v77, s[52:55], s95 offen offset:1024 nt lds
    buffer_load_dwordx4 v78, s[52:55], s95 offen offset:2048 nt lds
    buffer_load_dwordx4 v79, s[52:55], s95 offen offset:3072 nt lds
    s_add_u32 s95, s95, 16384
    s_mov_b32 s52, s6
    s_and_b32 s53, s7, 0xffff
    s_mov_b32 s54, 16777216
    s_mov_b32 s55, 0x20000
    s_bfe_u32 s38, s32, 0x30000
    s_lshl_b32 s38, s38, 2
    s_add_u32 s3, s38, 0
    s_lshr_b32 s38, s32, 3
    s_lshl_b32 s38, s38, 0
    s_add_u32 s3, s38, s3
    s_lshl_b32 s38, s3, 19
    s_add_u32 s95, s38, 0
    s_lshl_b32 s38, s34, 8
    s_add_u32 s95, s38, s95
    s_waitcnt vmcnt(24)
    ds_read_b64_tr_b16 a[0:1], v136 offset:0
    ds_read_b64_tr_b16 a[2:3], v137 offset:1024
    ds_read_b64_tr_b16 a[16:17], v138 offset:0
    ds_read_b64_tr_b16 a[18:19], v139 offset:1024
    ds_read_b64_tr_b16 a[32:33], v140 offset:0
    ds_read_b64_tr_b16 a[34:35], v141 offset:1024
    ds_read_b64_tr_b16 a[48:49], v142 offset:0
    ds_read_b64_tr_b16 a[50:51], v143 offset:1024
    ds_read_b64_tr_b16 a[64:65], v144 offset:0
    ds_read_b64_tr_b16 a[66:67], v145 offset:1024
    ds_read_b64_tr_b16 a[80:81], v146 offset:0
    ds_read_b64_tr_b16 a[82:83], v147 offset:1024
    ds_read_b64_tr_b16 a[96:97], v148 offset:0
    ds_read_b64_tr_b16 a[98:99], v149 offset:1024
    ds_read_b64_tr_b16 a[112:113], v150 offset:0
    ds_read_b64_tr_b16 a[114:115], v151 offset:1024
    s_waitcnt lgkmcnt(0)
    s_add_u32 s39, s90, s62
    s_mov_b32 m0, s39
    s_add_u32 s62, s62, 4096
    s_and_b32 s62, s62, 0x7fff
    buffer_load_dwordx4 v76, s[52:55], s95 offen offset:0 nt lds
    buffer_load_dwordx4 v77, s[52:55], s95 offen offset:1024 nt lds
    buffer_load_dwordx4 v78, s[52:55], s95 offen offset:2048 nt lds
    buffer_load_dwordx4 v79, s[52:55], s95 offen offset:3072 nt lds
    s_add_u32 s95, s95, 16384
    s_add_u32 s39, s90, s62
    s_mov_b32 m0, s39
    s_add_u32 s62, s62, 4096
    s_and_b32 s62, s62, 0x7fff
    buffer_load_dwordx4 v76, s[52:55], s95 offen offset:0 nt lds
    buffer_load_dwordx4 v77, s[52:55], s95 offen offset:1024 nt lds
    buffer_load_dwordx4 v78, s[52:55], s95 offen offset:2048 nt lds
    buffer_load_dwordx4 v79, s[52:55], s95 offen offset:3072 nt lds
    s_add_u32 s95, s95, 16384
    s_waitcnt vmcnt(24)
    ds_read_b64_tr_b16 a[4:5], v136 offset:8192
    ds_read_b64_tr_b16 a[6:7], v137 offset:9216
    ds_read_b64_tr_b16 a[20:21], v138 offset:8192
    ds_read_b64_tr_b16 a[22:23], v139 offset:9216
    ds_read_b64_tr_b16 a[36:37], v140 offset:8192
    ds_read_b64_tr_b16 a[38:39], v141 offset:9216
    ds_read_b64_tr_b16 a[52:53], v142 offset:8192
    ds_read_b64_tr_b16 a[54:55], v143 offset:9216
    ds_read_b64_tr_b16 a[68:69], v144 offset:8192
    ds_read_b64_tr_b16 a[70:71], v145 offset:9216
    ds_read_b64_tr_b16 a[84:85], v146 offset:8192
    ds_read_b64_tr_b16 a[86:87], v147 offset:9216
    ds_read_b64_tr_b16 a[100:101], v148 offset:8192
    ds_read_b64_tr_b16 a[102:103], v149 offset:9216
    ds_read_b64_tr_b16 a[116:117], v150 offset:8192
    ds_read_b64_tr_b16 a[118:119], v151 offset:9216
    s_waitcnt lgkmcnt(0)
    s_add_u32 s39, s90, s62
    s_mov_b32 m0, s39
    s_add_u32 s62, s62, 4096
    s_and_b32 s62, s62, 0x7fff
    buffer_load_dwordx4 v76, s[52:55], s95 offen offset:0 nt lds
    buffer_load_dwordx4 v77, s[52:55], s95 offen offset:1024 nt lds
    buffer_load_dwordx4 v78, s[52:55], s95 offen offset:2048 nt lds
    buffer_load_dwordx4 v79, s[52:55], s95 offen offset:3072 nt lds
    s_add_u32 s95, s95, 16384
    s_add_u32 s39, s90, s62
    s_mov_b32 m0, s39
    s_add_u32 s62, s62, 4096
    s_and_b32 s62, s62, 0x7fff
    buffer_load_dwordx4 v76, s[52:55], s95 offen offset:0 nt lds
    buffer_load_dwordx4 v77, s[52:55], s95 offen offset:1024 nt lds
    buffer_load_dwordx4 v78, s[52:55], s95 offen offset:2048 nt lds
    buffer_load_dwordx4 v79, s[52:55], s95 offen offset:3072 nt lds
    s_add_u32 s95, s95, 16384
    s_waitcnt vmcnt(24)
    ds_read_b64_tr_b16 a[8:9], v136 offset:16384
    ds_read_b64_tr_b16 a[10:11], v137 offset:17408
    ds_read_b64_tr_b16 a[24:25], v138 offset:16384
    ds_read_b64_tr_b16 a[26:27], v139 offset:17408
    ds_read_b64_tr_b16 a[40:41], v140 offset:16384
    ds_read_b64_tr_b16 a[42:43], v141 offset:17408
    ds_read_b64_tr_b16 a[56:57], v142 offset:16384
    ds_read_b64_tr_b16 a[58:59], v143 offset:17408
    ds_read_b64_tr_b16 a[72:73], v144 offset:16384
    ds_read_b64_tr_b16 a[74:75], v145 offset:17408
    ds_read_b64_tr_b16 a[88:89], v146 offset:16384
    ds_read_b64_tr_b16 a[90:91], v147 offset:17408
    ds_read_b64_tr_b16 a[104:105], v148 offset:16384
    ds_read_b64_tr_b16 a[106:107], v149 offset:17408
    ds_read_b64_tr_b16 a[120:121], v150 offset:16384
    ds_read_b64_tr_b16 a[122:123], v151 offset:17408
    s_waitcnt lgkmcnt(0)
    s_add_u32 s39, s90, s62
    s_mov_b32 m0, s39
    s_add_u32 s62, s62, 4096
    s_and_b32 s62, s62, 0x7fff
    buffer_load_dwordx4 v76, s[52:55], s95 offen offset:0 nt lds
    buffer_load_dwordx4 v77, s[52:55], s95 offen offset:1024 nt lds
    buffer_load_dwordx4 v78, s[52:55], s95 offen offset:2048 nt lds
    buffer_load_dwordx4 v79, s[52:55], s95 offen offset:3072 nt lds
    s_add_u32 s95, s95, 16384
    s_add_u32 s39, s90, s62
    s_mov_b32 m0, s39
    s_add_u32 s62, s62, 4096
    s_and_b32 s62, s62, 0x7fff
    buffer_load_dwordx4 v76, s[52:55], s95 offen offset:0 nt lds
    buffer_load_dwordx4 v77, s[52:55], s95 offen offset:1024 nt lds
    buffer_load_dwordx4 v78, s[52:55], s95 offen offset:2048 nt lds
    buffer_load_dwordx4 v79, s[52:55], s95 offen offset:3072 nt lds
    s_add_u32 s95, s95, 16384
    s_waitcnt vmcnt(24)
    ds_read_b64_tr_b16 a[12:13], v136 offset:24576
    ds_read_b64_tr_b16 a[14:15], v137 offset:25600
    ds_read_b64_tr_b16 a[28:29], v138 offset:24576
    ds_read_b64_tr_b16 a[30:31], v139 offset:25600
    ds_read_b64_tr_b16 a[44:45], v140 offset:24576
    ds_read_b64_tr_b16 a[46:47], v141 offset:25600
    ds_read_b64_tr_b16 a[60:61], v142 offset:24576
    ds_read_b64_tr_b16 a[62:63], v143 offset:25600
    ds_read_b64_tr_b16 a[76:77], v144 offset:24576
    ds_read_b64_tr_b16 a[78:79], v145 offset:25600
    ds_read_b64_tr_b16 a[92:93], v146 offset:24576
    ds_read_b64_tr_b16 a[94:95], v147 offset:25600
    ds_read_b64_tr_b16 a[108:109], v148 offset:24576
    ds_read_b64_tr_b16 a[110:111], v149 offset:25600
    ds_read_b64_tr_b16 a[124:125], v150 offset:24576
    ds_read_b64_tr_b16 a[126:127], v151 offset:25600
    s_waitcnt lgkmcnt(0)
    s_mov_b32 s86, 98304
    buffer_load_dword v7, v101, s[48:51], s86 offen sc1
    s_add_u32 s39, s90, s62
    s_mov_b32 m0, s39
    s_add_u32 s62, s62, 4096
    s_and_b32 s62, s62, 0x7fff
    buffer_load_dwordx4 v76, s[52:55], s95 offen offset:0 nt lds
    buffer_load_dwordx4 v77, s[52:55], s95 offen offset:1024 nt lds
    buffer_load_dwordx4 v78, s[52:55], s95 offen offset:2048 nt lds
    buffer_load_dwordx4 v79, s[52:55], s95 offen offset:3072 nt lds
    s_add_u32 s95, s95, 16384
    s_add_u32 s39, s90, s62
    s_mov_b32 m0, s39
    s_add_u32 s62, s62, 4096
    s_and_b32 s62, s62, 0x7fff
    buffer_load_dwordx4 v76, s[52:55], s95 offen offset:0 nt lds
    v_mov_b32 v136, 0
    v_mov_b32 v137, 0
    v_mov_b32 v138, 0
    v_mov_b32 v139, 0
    v_mov_b32 v140, 0
    v_mov_b32 v141, 0
    v_mov_b32 v142, 0
    v_mov_b32 v143, 0
    v_mov_b32 v144, 0
    v_mov_b32 v145, 0
    v_mov_b32 v146, 0
    v_mov_b32 v147, 0
    v_mov_b32 v148, 0
    v_mov_b32 v149, 0
    v_mov_b32 v150, 0
    v_mov_b32 v151, 0
    v_mov_b32 v152, 0
    v_mov_b32 v153, 0
    v_mov_b32 v154, 0
    v_mov_b32 v155, 0
    v_mov_b32 v156, 0
    v_mov_b32 v157, 0
    v_mov_b32 v158, 0
    v_mov_b32 v159, 0
    v_mov_b32 v160, 0
    v_mov_b32 v161, 0
    v_mov_b32 v162, 0
    v_mov_b32 v163, 0
    v_mov_b32 v164, 0
    v_mov_b32 v165, 0
    v_mov_b32 v166, 0
    v_mov_b32 v167, 0
    v_mov_b32 v168, 0
    v_mov_b32 v169, 0
    v_mov_b32 v170, 0
    v_mov_b32 v171, 0
    v_mov_b32 v172, 0
    v_mov_b32 v173, 0
    v_mov_b32 v174, 0
    v_mov_b32 v175, 0
    v_mov_b32 v176, 0
    v_mov_b32 v177, 0
    v_mov_b32 v178, 0
    v_mov_b32 v179, 0
    v_mov_b32 v180, 0
    v_mov_b32 v181, 0
    v_mov_b32 v182, 0
    v_mov_b32 v183, 0
    v_mov_b32 v184, 0
    v_mov_b32 v185, 0
    v_mov_b32 v186, 0
    v_mov_b32 v187, 0
    v_mov_b32 v188, 0
    v_mov_b32 v189, 0
    v_mov_b32 v190, 0
    v_mov_b32 v191, 0
    v_mov_b32 v192, 0
    v_mov_b32 v193, 0
    v_mov_b32 v194, 0
    v_mov_b32 v195, 0
    v_mov_b32 v196, 0
    v_mov_b32 v197, 0
    v_mov_b32 v198, 0
    v_mov_b32 v199, 0
    v_mov_b32 v90, 0xff7f0000
    s_mov_b32 s93, 0
    v_mov_b32 v102, 0
    v_mov_b32 v103, 0
    s_mov_b32 s60, s83
    s_mov_b32 s61, s83
    v_add_u32 v4, s85, v80
    v_xor_b32 v82, 0, v4
    v_xor_b32 v83, 32, v4
    v_xor_b32 v84, 64, v4
    v_xor_b32 v85, 96, v4
    v_xor_b32 v86, 128, v4
    v_xor_b32 v87, 160, v4
    v_xor_b32 v88, 192, v4
    v_xor_b32 v89, 224, v4
    v_add_u32 v80, s90, v80
    v_add_u32 v81, s90, v81
    s_lshr_b32 s38, s3, 3
    s_lshl_b32 s38, s38, 15
    s_add_u32 s36, s38, 393216
    s_lshl_b32 s38, s34, 8
    s_add_u32 s36, s38, s36
    s_waitcnt vmcnt(5)
L_fcheck_16:
    v_cmp_ne_u32 vcc, s68, v7
    s_cbranch_vccz L_fok_17
    s_sleep 2
    s_mov_b32 s86, 98304
    buffer_load_dword v7, v101, s[48:51], s86 offen sc1
    s_waitcnt vmcnt(0)
    s_sub_u32 s84, s84, 1
    s_cmp_lg_u32 s84, 0
    s_cbranch_scc1 L_fcheck_16
    s_branch L_end
L_fok_17:
    buffer_load_dwordx4 v[20:23], v9, s[48:51], s36 offen sc1
    s_add_u32 s36, s36, 4096
    buffer_load_dwordx4 v[24:27], v9, s[48:51], s36 offen sc1
    s_add_u32 s36, s36, 4096
    buffer_load_dwordx4 v[28:31], v9, s[48:51], s36 offen sc1
    s_add_u32 s36, s36, 4096
    buffer_load_dwordx4 v[32:35], v9, s[48:51], s36 offen sc1
    s_add_u32 s36, s36, 4096
    buffer_load_dwordx4 v[36:39], v9, s[48:51], s36 offen sc1
    s_add_u32 s36, s36, 4096
    buffer_load_dwordx4 v[40:43], v9, s[48:51], s36 offen sc1
    s_add_u32 s36, s36, 4096
    buffer_load_dwordx4 v[44:47], v9, s[48:51], s36 offen sc1
    s_add_u32 s36, s36, 4096
    buffer_load_dwordx4 v[48:51], v9, s[48:51], s36 offen sc1
    s_waitcnt vmcnt(7)
    ds_write_b128 v96, v[20:23] offset:0
    s_waitcnt vmcnt(6)
    ds_write_b128 v97, v[24:27] offset:1024
    s_waitcnt vmcnt(5)
    ds_write_b128 v98, v[28:31] offset:2048
    s_waitcnt vmcnt(4)
    ds_write_b128 v99, v[32:35] offset:3072
    s_waitcnt vmcnt(3)
    ds_write_b128 v96, v[36:39] offset:4096
    s_waitcnt vmcnt(2)
    ds_write_b128 v97, v[40:43] offset:5120
    s_waitcnt vmcnt(1)
    ds_write_b128 v98, v[44:47] offset:6144
    s_waitcnt vmcnt(0)
    ds_write_b128 v99, v[48:51] offset:7168
    s_waitcnt lgkmcnt(0)
    ds_read_b128 v[104:107], v82
    ds_read_b128 v[108:111], v83
    ds_read_b128 v[112:115], v84
    ds_read_b128 v[116:119], v85
    ds_read_b128 v[120:123], v86
    ds_read_b128 v[124:127], v87
    ds_read_b128 v[128:131], v88
    ds_read_b128 v[132:135], v89
    v_xor_b32 v82, 0, v80
    ds_read_b128 v[216:219], v82
    v_xor_b32 v83, 32, v80
    ds_read_b128 v[220:223], v83
    v_xor_b32 v84, 64, v80
    ds_read_b128 v[224:227], v84
    v_xor_b32 v85, 96, v80
    ds_read_b128 v[228:231], v85
    v_xor_b32 v86, 128, v80
    ds_read_b128 v[232:235], v86
    v_xor_b32 v87, 160, v80
    ds_read_b128 v[236:239], v87
    v_xor_b32 v88, 192, v80
    ds_read_b128 v[240:243], v88
    v_xor_b32 v89, 224, v80
    ds_read_b128 v[244:247], v89
L_att:
    v_add_u32 v4, s94, v81
    s_waitcnt lgkmcnt(0)
    v_mfma_f32_32x32x16_bf16 v[200:215], v[216:219], v[104:107], 0
    v_xor_b32 v82, 0, v4
    ds_read_b64_tr_b16 v[20:21], v82 offset:0
    ds_read_b64_tr_b16 v[24:25], v82 offset:4096
    buffer_load_dwordx4 v77, s[52:55], s95 offen offset:1024 nt lds
    v_mfma_f32_32x32x16_bf16 v[200:215], v[220:223], v[108:111], v[200:215]
    v_xor_b32 v83, 32, v4
    ds_read_b64_tr_b16 v[22:23], v83 offset:2048
    ds_read_b64_tr_b16 v[26:27], v83 offset:6144
    v_mfma_f32_32x32x16_bf16 v[200:215], v[224:227], v[112:115], v[200:215]
    v_xor_b32 v84, 64, v4
    ds_read_b64_tr_b16 v[28:29], v84 offset:0
    ds_read_b64_tr_b16 v[32:33], v84 offset:4096
    v_mfma_f32_32x32x16_bf16 v[200:215], v[228:231], v[116:119], v[200:215]
    v_xor_b32 v85, 96, v4
    ds_read_b64_tr_b16 v[30:31], v85 offset:2048
    ds_read_b64_tr_b16 v[34:35], v85 offset:6144
    v_mfma_f32_32x32x16_bf16 v[200:215], v[232:235], v[120:123], v[200:215]
    v_xor_b32 v86, 128, v4
    ds_read_b64_tr_b16 v[36:37], v86 offset:0
    ds_read_b64_tr_b16 v[40:41], v86 offset:4096
    buffer_load_dwordx4 v78, s[52:55], s95 offen offset:2048 nt lds
    v_mfma_f32_32x32x16_bf16 v[200:215], v[236:239], v[124:127], v[200:215]
    v_xor_b32 v87, 160, v4
    ds_read_b64_tr_b16 v[38:39], v87 offset:2048
    ds_read_b64_tr_b16 v[42:43], v87 offset:6144
    v_mfma_f32_32x32x16_bf16 v[200:215], v[240:243], v[128:131], v[200:215]
    v_xor_b32 v88, 192, v4
    ds_read_b64_tr_b16 v[44:45], v88 offset:0
    ds_read_b64_tr_b16 v[48:49], v88 offset:4096
    v_mfma_f32_32x32x16_bf16 v[200:215], v[244:247], v[132:135], v[200:215]
    v_xor_b32 v89, 224, v4
    ds_read_b64_tr_b16 v[46:47], v89 offset:2048
    ds_read_b64_tr_b16 v[50:51], v89 offset:6144
    buffer_load_dwordx4 v79, s[52:55], s95 offen offset:3072 nt lds
    s_add_u32 s95, s95, 16384
    v_xor_b32 v5, 0x2000, v94
    v_xor_b32 v6, 0x4000, v94
    v_xor_b32 v7, 0x6000, v94
    s_cmp_lg_u32 s93, 12
    s_cbranch_scc1 L_noswitch_18
    s_mov_b32 s52, s24
    s_and_b32 s53, s25, 0xffff
    s_mov_b32 s54, 4194304
    s_mov_b32 s55, 0x20000
    s_mov_b32 s95, s63
L_noswitch_18:
    s_nop 1
    ds_write_b128 v94, v[200:203] offset:0
    ds_write_b128 v94, v[204:207] offset:1024
    ds_write_b128 v94, v[208:211] offset:2048
    ds_write_b128 v94, v[212:215] offset:3072
    s_waitcnt lgkmcnt(0)
    s_barrier
    ds_read_b128 v[60:63], v5 offset:0
    ds_read_b128 v[216:219], v6 offset:0
    ds_read_b128 v[232:235], v7 offset:0
    ds_read_b128 v[64:67], v5 offset:1024
    ds_read_b128 v[220:223], v6 offset:1024
    ds_read_b128 v[236:239], v7 offset:1024
    ds_read_b128 v[68:71], v5 offset:2048
    ds_read_b128 v[224:227], v6 offset:2048
    ds_read_b128 v[240:243], v7 offset:2048
    ds_read_b128 v[72:75], v5 offset:3072
    ds_read_b128 v[228:231], v6 offset:3072
    ds_read_b128 v[244:247], v7 offset:3072
    v_xor_b32 v94, 0x1000, v94
    s_add_u32 s39, s90, s62
    s_mov_b32 m0, s39
    s_add_u32 s62, s62, 4096
    s_and_b32 s62, s62, 0x7fff
    buffer_load_dwordx4 v76, s[52:55], s95 offen offset:0 nt lds
    s_add_u32 s94, s94, 8192
    s_and_b32 s94, s94, 0x7fff
    s_waitcnt lgkmcnt(9)
    v_pk_add_f32 v[200:201], v[200:201], v[60:61]
    v_pk_add_f32 v[216:217], v[216:217], v[232:233]
    v_pk_add_f32 v[202:203], v[202:203], v[62:63]
    v_pk_add_f32 v[218:219], v[218:219], v[234:235]
    v_pk_add_f32 v[200:201], v[200:201], v[216:217]
    v_pk_add_f32 v[202:203], v[202:203], v[218:219]
    s_waitcnt lgkmcnt(6)
    v_pk_add_f32 v[204:205], v[204:205], v[64:65]
    v_pk_add_f32 v[220:221], v[220:221], v[236:237]
    v_pk_add_f32 v[206:207], v[206:207], v[66:67]
    v_pk_add_f32 v[222:223], v[222:223], v[238:239]
    v_pk_add_f32 v[204:205], v[204:205], v[220:221]
    v_pk_add_f32 v[206:207], v[206:207], v[222:223]
    s_waitcnt lgkmcnt(3)
    v_pk_add_f32 v[208:209], v[208:209], v[68:69]
    v_pk_add_f32 v[224:225], v[224:225], v[240:241]
    v_pk_add_f32 v[210:211], v[210:211], v[70:71]
    v_pk_add_f32 v[226:227], v[226:227], v[242:243]
    v_pk_add_f32 v[208:209], v[208:209], v[224:225]
    v_pk_add_f32 v[210:211], v[210:211], v[226:227]
    s_waitcnt lgkmcnt(0)
    v_pk_add_f32 v[212:213], v[212:213], v[72:73]
    v_pk_add_f32 v[228:229], v[228:229], v[244:245]
    v_pk_add_f32 v[214:215], v[214:215], v[74:75]
    v_pk_add_f32 v[230:231], v[230:231], v[246:247]
    v_pk_add_f32 v[212:213], v[212:213], v[228:229]
    v_pk_add_f32 v[214:215], v[214:215], v[230:231]
    buffer_load_dwordx4 v77, s[52:55], s95 offen offset:1024 nt lds
    v_max_f32 v4, v200, v201
    v_max3_f32 v4, v4, v202, v203
    v_max3_f32 v4, v4, v204, v205
    v_max3_f32 v4, v4, v206, v207
    v_max3_f32 v4, v4, v208, v209
    v_max3_f32 v4, v4, v210, v211
    v_max3_f32 v4, v4, v212, v213
    v_max3_f32 v4, v4, v214, v215
    v_mov_b32 v5, v4
    s_nop 1
    v_permlane32_swap_b32 v4, v5
    v_max_f32 v4, v4, v5
    v_mul_f32 v4, s83, v4
    v_max_f32 v4, v4, v90
    v_sub_f32 v92, v90, v4
    v_exp_f32 v92, v92
    v_mov_b32 v90, v4
    v_pk_fma_f32 v[200:201], v[200:201], s[60:61], v[90:91] op_sel_hi:[1,1,0] neg_lo:[0,0,1] neg_hi:[0,0,1]
    v_pk_fma_f32 v[202:203], v[202:203], s[60:61], v[90:91] op_sel_hi:[1,1,0] neg_lo:[0,0,1] neg_hi:[0,0,1]
    v_pk_fma_f32 v[204:205], v[204:205], s[60:61], v[90:91] op_sel_hi:[1,1,0] neg_lo:[0,0,1] neg_hi:[0,0,1]
    v_pk_fma_f32 v[206:207], v[206:207], s[60:61], v[90:91] op_sel_hi:[1,1,0] neg_lo:[0,0,1] neg_hi:[0,0,1]
    v_pk_fma_f32 v[208:209], v[208:209], s[60:61], v[90:91] op_sel_hi:[1,1,0] neg_lo:[0,0,1] neg_hi:[0,0,1]
    v_pk_fma_f32 v[210:211], v[210:211], s[60:61], v[90:91] op_sel_hi:[1,1,0] neg_lo:[0,0,1] neg_hi:[0,0,1]
    v_pk_fma_f32 v[212:213], v[212:213], s[60:61], v[90:91] op_sel_hi:[1,1,0] neg_lo:[0,0,1] neg_hi:[0,0,1]
    v_pk_fma_f32 v[214:215], v[214:215], s[60:61], v[90:91] op_sel_hi:[1,1,0] neg_lo:[0,0,1] neg_hi:[0,0,1]
    v_exp_f32 v200, v200
    v_exp_f32 v201, v201
    v_exp_f32 v202, v202
    v_exp_f32 v203, v203
    v_exp_f32 v204, v204
    buffer_load_dwordx4 v78, s[52:55], s95 offen offset:2048 nt lds
    v_exp_f32 v205, v205
    v_exp_f32 v206, v206
    v_exp_f32 v207, v207
    v_exp_f32 v208, v208
    v_exp_f32 v209, v209
    v_exp_f32 v210, v210
    v_exp_f32 v211, v211
    v_exp_f32 v212, v212
    v_exp_f32 v213, v213
    v_exp_f32 v214, v214
    v_exp_f32 v215, v215
    v_add_u32 v4, s94, v80
    v_pk_mul_f32 v[102:103], v[102:103], v[92:93] op_sel_hi:[1,0]
    v_pk_mul_f32 v[136:137], v[136:137], v[92:93] op_sel_hi:[1,0]
    v_pk_mul_f32 v[138:139], v[138:139], v[92:93] op_sel_hi:[1,0]
    v_pk_mul_f32 v[140:141], v[140:141], v[92:93] op_sel_hi:[1,0]
    v_pk_mul_f32 v[142:143], v[142:143], v[92:93] op_sel_hi:[1,0]
    v_pk_mul_f32 v[144:145], v[144:145], v[92:93] op_sel_hi:[1,0]
    v_pk_mul_f32 v[146:147], v[146:147], v[92:93] op_sel_hi:[1,0]
    v_pk_mul_f32 v[148:149], v[148:149], v[92:93] op_sel_hi:[1,0]
    v_pk_mul_f32 v[150:151], v[150:151], v[92:93] op_sel_hi:[1,0]
    v_pk_mul_f32 v[152:153], v[152:153], v[92:93] op_sel_hi:[1,0]
    v_pk_mul_f32 v[154:155], v[154:155], v[92:93] op_sel_hi:[1,0]
    v_pk_mul_f32 v[156:157], v[156:157], v[92:93] op_sel_hi:[1,0]
    v_pk_mul_f32 v[158:159], v[158:159], v[92:93] op_sel_hi:[1,0]
    v_pk_mul_f32 v[160:161], v[160:161], v[92:93] op_sel_hi:[1,0]
    v_pk_mul_f32 v[162:163], v[162:163], v[92:93] op_sel_hi:[1,0]
    v_pk_mul_f32 v[164:165], v[164:165], v[92:93] op_sel_hi:[1,0]
    v_pk_mul_f32 v[166:167], v[166:167], v[92:93] op_sel_hi:[1,0]
    v_pk_mul_f32 v[168:169], v[168:169], v[92:93] op_sel_hi:[1,0]
    v_pk_mul_f32 v[170:171], v[170:171], v[92:93] op_sel_hi:[1,0]
    v_pk_mul_f32 v[172:173], v[172:173], v[92:93] op_sel_hi:[1,0]
    v_pk_mul_f32 v[174:175], v[174:175], v[92:93] op_sel_hi:[1,0]
    v_pk_mul_f32 v[176:177], v[176:177], v[92:93] op_sel_hi:[1,0]
    buffer_load_dwordx4 v79, s[52:55], s95 offen offset:3072 nt lds
    s_add_u32 s95, s95, 16384
    v_pk_mul_f32 v[178:179], v[178:179], v[92:93] op_sel_hi:[1,0]
    v_pk_mul_f32 v[180:181], v[180:181], v[92:93] op_sel_hi:[1,0]
    v_pk_mul_f32 v[182:183], v[182:183], v[92:93] op_sel_hi:[1,0]
    v_pk_mul_f32 v[184:185], v[184:185], v[92:93] op_sel_hi:[1,0]
    v_pk_mul_f32 v[186:187], v[186:187], v[92:93] op_sel_hi:[1,0]
    v_pk_mul_f32 v[188:189], v[188:189], v[92:93] op_sel_hi:[1,0]
    v_pk_mul_f32 v[190:191], v[190:191], v[92:93] op_sel_hi:[1,0]
    v_pk_mul_f32 v[192:193], v[192:193], v[92:93] op_sel_hi:[1,0]
    v_pk_mul_f32 v[194:195], v[194:195], v[92:93] op_sel_hi:[1,0]
    v_pk_mul_f32 v[196:197], v[196:197], v[92:93] op_sel_hi:[1,0]
    v_pk_mul_f32 v[198:199], v[198:199], v[92:93] op_sel_hi:[1,0]
    v_cvt_pk_bf16_f32 v52, v200, v201
    v_pk_add_f32 v[102:103], v[102:103], v[200:201]
    v_cvt_pk_bf16_f32 v53, v202, v203
    v_pk_add_f32 v[102:103], v[102:103], v[202:203]
    v_cvt_pk_bf16_f32 v54, v204, v205
    v_pk_add_f32 v[102:103], v[102:103], v[204:205]
    v_cvt_pk_bf16_f32 v55, v206, v207
    v_pk_add_f32 v[102:103], v[102:103], v[206:207]
    v_cvt_pk_bf16_f32 v56, v208, v209
    v_pk_add_f32 v[102:103], v[102:103], v[208:209]
    v_cvt_pk_bf16_f32 v57, v210, v211
    v_pk_add_f32 v[102:103], v[102:103], v[210:211]
    v_cvt_pk_bf16_f32 v58, v212, v213
    v_pk_add_f32 v[102:103], v[102:103], v[212:213]
    v_cvt_pk_bf16_f32 v59, v214, v215
    v_pk_add_f32 v[102:103], v[102:103], v[214:215]
    s_waitcnt vmcnt(20)
    v_mfma_f32_32x32x16_bf16 v[136:151], v[20:23], v[52:55], v[136:151]
    v_xor_b32 v82, 0, v4
    ds_read_b128 v[216:219], v82
    v_xor_b32 v83, 32, v4
    ds_read_b128 v[220:223], v83
    v_mfma_f32_32x32x16_bf16 v[152:167], v[28:31], v[52:55], v[152:167]
    v_xor_b32 v84, 64, v4
    ds_read_b128 v[224:227], v84
    v_xor_b32 v85, 96, v4
    ds_read_b128 v[228:231], v85
    v_mfma_f32_32x32x16_bf16 v[168:183], v[36:39], v[52:55], v[168:183]
    v_xor_b32 v86, 128, v4
    ds_read_b128 v[232:235], v86
    v_xor_b32 v87, 160, v4
    ds_read_b128 v[236:239], v87
    v_mfma_f32_32x32x16_bf16 v[184:199], v[44:47], v[52:55], v[184:199]
    v_xor_b32 v88, 192, v4
    ds_read_b128 v[240:243], v88
    v_xor_b32 v89, 224, v4
    ds_read_b128 v[244:247], v89
    v_mfma_f32_32x32x16_bf16 v[136:151], v[24:27], v[56:59], v[136:151]
    s_add_u32 s39, s90, s62
    s_mov_b32 m0, s39
    s_add_u32 s62, s62, 4096
    s_and_b32 s62, s62, 0x7fff
    buffer_load_dwordx4 v76, s[52:55], s95 offen offset:0 nt lds
    v_mfma_f32_32x32x16_bf16 v[152:167], v[32:35], v[56:59], v[152:167]
    v_mfma_f32_32x32x16_bf16 v[168:183], v[40:43], v[56:59], v[168:183]
    v_mfma_f32_32x32x16_bf16 v[184:199], v[48:51], v[56:59], v[184:199]
    s_add_u32 s93, s93, 1
    s_cmp_lt_u32 s93, 16
    s_cbranch_scc1 L_att
    v_add_f32 v91, v102, v103
    v_mov_b32 v5, v91
    s_nop 1
    v_permlane32_swap_b32 v91, v5
    v_add_f32 v91, v91, v5
    v_and_b32 v4, 31, v1
    v_lshlrev_b32 v5, 8, v4
    v_lshl_add_u32 v5, v3, 4, v5
    v_lshrrev_b32 v6, 5, v1
    v_lshl_add_u32 v5, v6, 3, v5
    v_add_u32 v5, s85, v5
    s_waitcnt lgkmcnt(0)
    s_barrier
    v_cvt_pk_bf16_f32 v20, v136, v137
    v_cvt_pk_bf16_f32 v21, v138, v139
    v_xor_b32 v82, 0, v5
    ds_write_b64 v82, v[20:21]
    v_cvt_pk_bf16_f32 v22, v140, v141
    v_cvt_pk_bf16_f32 v23, v142, v143
    v_xor_b32 v83, 16, v5
    ds_write_b64 v83, v[22:23]
    v_cvt_pk_bf16_f32 v24, v144, v145
    v_cvt_pk_bf16_f32 v25, v146, v147
    v_xor_b32 v84, 32, v5
    ds_write_b64 v84, v[24:25]
    v_cvt_pk_bf16_f32 v26, v148, v149
    v_cvt_pk_bf16_f32 v27, v150, v151
    v_xor_b32 v85, 48, v5
    ds_write_b64 v85, v[26:27]
    v_cvt_pk_bf16_f32 v28, v152, v153
    v_cvt_pk_bf16_f32 v29, v154, v155
    v_xor_b32 v86, 64, v5
    ds_write_b64 v86, v[28:29]
    v_cvt_pk_bf16_f32 v30, v156, v157
    v_cvt_pk_bf16_f32 v31, v158, v159
    v_xor_b32 v87, 80, v5
    ds_write_b64 v87, v[30:31]
    v_cvt_pk_bf16_f32 v32, v160, v161
    v_cvt_pk_bf16_f32 v33, v162, v163
    v_xor_b32 v88, 96, v5
    ds_write_b64 v88, v[32:33]
    v_cvt_pk_bf16_f32 v34, v164, v165
    v_cvt_pk_bf16_f32 v35, v166, v167
    v_xor_b32 v89, 112, v5
    ds_write_b64 v89, v[34:35]
    v_cvt_pk_bf16_f32 v36, v168, v169
    v_cvt_pk_bf16_f32 v37, v170, v171
    v_xor_b32 v82, 128, v5
    ds_write_b64 v82, v[36:37]
    v_cvt_pk_bf16_f32 v38, v172, v173
    v_cvt_pk_bf16_f32 v39, v174, v175
    v_xor_b32 v83, 144, v5
    ds_write_b64 v83, v[38:39]
    v_cvt_pk_bf16_f32 v40, v176, v177
    v_cvt_pk_bf16_f32 v41, v178, v179
    v_xor_b32 v84, 160, v5
    ds_write_b64 v84, v[40:41]
    v_cvt_pk_bf16_f32 v42, v180, v181
    v_cvt_pk_bf16_f32 v43, v182, v183
    v_xor_b32 v85, 176, v5
    ds_write_b64 v85, v[42:43]
    v_cvt_pk_bf16_f32 v44, v184, v185
    v_cvt_pk_bf16_f32 v45, v186, v187
    v_xor_b32 v86, 192, v5
    ds_write_b64 v86, v[44:45]
    v_cvt_pk_bf16_f32 v46, v188, v189
    v_cvt_pk_bf16_f32 v47, v190, v191
    v_xor_b32 v87, 208, v5
    ds_write_b64 v87, v[46:47]
    v_cvt_pk_bf16_f32 v48, v192, v193
    v_cvt_pk_bf16_f32 v49, v194, v195
    v_xor_b32 v88, 224, v5
    ds_write_b64 v88, v[48:49]
    v_cvt_pk_bf16_f32 v50, v196, v197
    v_cvt_pk_bf16_f32 v51, v198, v199
    v_xor_b32 v89, 240, v5
    ds_write_b64 v89, v[50:51]
    v_xor_b32 v6, v3, v2
    v_lshlrev_b32 v6, 4, v6
    v_lshl_add_u32 v6, v2, 8, v6
    v_add_u32 v6, s85, v6
    v_xor_b32 v82, 0, v6
    v_xor_b32 v83, 64, v6
    v_xor_b32 v84, 128, v6
    v_xor_b32 v85, 192, v6
    v_lshlrev_b32 v7, 4, v3
    v_lshl_add_u32 v7, v2, 15, v7
    s_lshl_b32 s38, s3, 10
    s_add_u32 s36, s38, 2097152
    s_lshl_b32 s38, s34, 8
    s_add_u32 s36, s38, s36
    s_waitcnt lgkmcnt(0)
    ds_read_b128 v[200:203], v82 offset:0
    ds_read_b128 v[204:207], v83 offset:1024
    ds_read_b128 v[208:211], v84 offset:2048
    ds_read_b128 v[212:215], v85 offset:3072
    ds_read_b128 v[216:219], v82 offset:4096
    ds_read_b128 v[220:223], v83 offset:5120
    ds_read_b128 v[224:227], v84 offset:6144
    ds_read_b128 v[228:231], v85 offset:7168
    v_lshlrev_b32 v4, 3, v4
    s_lshl_b32 s38, s3, 8
    s_add_u32 s37, s38, 163840
    s_lshl_b32 s38, s34, 13
    s_add_u32 s37, s38, s37
    s_mov_b32 exec_lo, 0xffffffff
    s_mov_b32 exec_hi, 0x0
    buffer_store_dwordx2 v[90:91], v4, s[48:51], s37 offen sc1
    s_mov_b64 exec, -1
    s_waitcnt lgkmcnt(7)
    buffer_store_dwordx4 v[200:203], v7, s[48:51], s36 offen sc1
    s_add_u32 s36, s36, 131072
    s_waitcnt lgkmcnt(6)
    buffer_store_dwordx4 v[204:207], v7, s[48:51], s36 offen sc1
    s_add_u32 s36, s36, 131072
    s_waitcnt lgkmcnt(5)
    buffer_store_dwordx4 v[208:211], v7, s[48:51], s36 offen sc1
    s_add_u32 s36, s36, 131072
    s_waitcnt lgkmcnt(4)
    buffer_store_dwordx4 v[212:215], v7, s[48:51], s36 offen sc1
    s_add_u32 s36, s36, 131072
    s_waitcnt lgkmcnt(3)
    buffer_store_dwordx4 v[216:219], v7, s[48:51], s36 offen sc1
    s_add_u32 s36, s36, 131072
    s_waitcnt lgkmcnt(2)
    buffer_store_dwordx4 v[220:223], v7, s[48:51], s36 offen sc1
    s_add_u32 s36, s36, 131072
    s_waitcnt lgkmcnt(1)
    buffer_store_dwordx4 v[224:227], v7, s[48:51], s36 offen sc1
    s_add_u32 s36, s36, 131072
    s_waitcnt lgkmcnt(0)
    buffer_store_dwordx4 v[228:231], v7, s[48:51], s36 offen sc1
    buffer_load_dwordx4 v77, s[52:55], s95 offen offset:1024 nt lds
    buffer_load_dwordx4 v78, s[52:55], s95 offen offset:2048 nt lds
    buffer_load_dwordx4 v79, s[52:55], s95 offen offset:3072 nt lds
    s_add_u32 s95, s95, 16384
    v_and_b32 v4, 3, v3
    v_lshrrev_b32 v5, 2, v3
    v_lshlrev_b32 v6, 4, v2
    v_add_u32 v6, 135168, v6
    s_movk_i32 s36, 320
    v_cmp_eq_u32 vcc, 0, v5
    s_nop 1
    v_cndmask_b32 v112, 4, v4, vcc
    v_mad_u32_u24 v112, v112, s36, v6
    v_cmp_eq_u32 vcc, 1, v5
    s_nop 1
    v_cndmask_b32 v113, 4, v4, vcc
    v_mad_u32_u24 v113, v113, s36, v6
    v_cmp_eq_u32 vcc, 2, v5
    s_nop 1
    v_cndmask_b32 v114, 4, v4, vcc
    v_mad_u32_u24 v114, v114, s36, v6
    v_cmp_eq_u32 vcc, 3, v5
    s_nop 1
    v_cndmask_b32 v115, 4, v4, vcc
    v_mad_u32_u24 v115, v115, s36, v6
    s_lshl_b32 s38, s34, 16
    s_add_u32 s36, s38, 0
    s_lshl_b32 s38, s32, 8
    s_add_u32 s36, s38, s36
    v_lshlrev_b32 v77, 4, v3
    v_lshl_add_u32 v77, v2, 13, v77
    v_add_u32 v77, s36, v77
    s_lshl_b32 s38, s32, 13
    s_add_u32 s36, s38, 0
    s_lshl_b32 s38, s34, 6
    s_add_u32 s36, s38, s36
    v_lshrrev_b32 v5, 2, v1
    v_lshlrev_b32 v5, 8, v5
    v_lshl_add_u32 v5, v4, 4, v5
    v_add_u32 v78, s36, v5
    s_lshr_b32 s36, s32, 2
    s_lshl_b32 s36, s36, 7
    s_lshl_b32 s38, s34, 5
    s_add_u32 s36, s36, s38
    s_and_b32 s38, s32, 3
    s_lshl_b32 s38, s38, 3
    s_add_u32 s36, s36, s38
    v_lshlrev_b32 v5, 11, v4
    v_lshl_add_u32 v5, v2, 1, v5
    v_add_u32 v79, s36, v5
    v_bfe_u32 v5, v3, 0, 2
    v_lshlrev_b32 v81, 11, v5
    v_lshrrev_b32 v5, 2, v3
    v_lshl_add_u32 v81, v5, 8, v81
    v_and_b32 v5, 12, v3
    v_xor_b32 v5, v5, v2
    v_and_b32 v6, 1, v3
    v_lshlrev_b32 v6, 1, v6
    v_xor_b32 v5, v5, v6
    v_lshlrev_b32 v80, 4, v5
    v_bfe_u32 v6, v3, 0, 2
    v_lshl_add_u32 v80, v6, 11, v80
    v_lshrrev_b32 v6, 2, v3
    v_lshl_add_u32 v80, v6, 8, v80
    v_add_u32 v80, s85, v80
    v_lshlrev_b32 v4, 9, v4
    v_lshl_add_u32 v4, v2, 4, v4
    v_add_u32 v94, s85, v4
    s_lshl_b32 s38, s34, 9
    s_add_u32 s38, s38, 131072
    v_and_b32 v5, 31, v1
    v_lshl_add_u32 v102, v5, 4, s38
    s_mul_i32 s38, s34, 320
    s_add_u32 s38, s38, 135168
    v_lshl_add_u32 v103, v5, 3, s38
    v_lshlrev_b32 v4, 6, v2
    v_lshl_add_u32 v4, v3, 1, v4
    v_add_u32 v93, s38, v4
    v_lshlrev_b32 v4, 7, v2
    v_lshl_add_u32 v4, v3, 4, v4
    v_mov_b32 v5, 512
    v_cmp_gt_u32 vcc, 8, v3
    s_nop 1
    v_cndmask_b32 v92, v5, v4, vcc
    s_mov_b32 s92, 0
    s_mov_b32 s96, 524288
    s_mov_b32 s97, 0
    s_lshl_b32 s38, s32, 15
    s_add_u32 s36, s38, 2097152
    s_lshl_b32 s38, s34, 8
    s_add_u32 s36, s38, s36
    s_lshl_b32 s38, s32, 3
    s_add_u32 s37, s38, 163840
    s_lshl_b32 s38, s34, 13
    s_add_u32 s37, s38, s37
    s_lshl_b32 s38, s32, 8
    s_add_u32 s69, s38, 131072
    s_lshl_b32 s38, s34, 13
    s_add_u32 s69, s38, s69
    v_mov_b32 v4, s69
    v_mov_b32 v5, s68
    s_waitcnt vmcnt(3)
    s_mov_b64 exec, 1
    buffer_store_dword v5, v4, s[48:51], 0 offen sc1
    s_mov_b64 exec, -1
    s_mov_b32 s86, 131072
    buffer_load_dword v7, v101, s[48:51], s86 offen sc1
    s_waitcnt vmcnt(0)
L_fcheck_19:
    v_cmp_ne_u32 vcc, s68, v7
    s_cbranch_vccz L_fok_20
    s_sleep 2
    s_mov_b32 s86, 131072
    buffer_load_dword v7, v101, s[48:51], s86 offen sc1
    s_waitcnt vmcnt(0)
    s_sub_u32 s84, s84, 1
    s_cmp_lg_u32 s84, 0
    s_cbranch_scc1 L_fcheck_19
    s_branch L_end
L_fok_20:
    buffer_load_dwordx2 v[52:53], v81, s[48:51], s37 offen sc1
    s_add_u32 s37, s37, 1024
    buffer_load_dwordx2 v[54:55], v81, s[48:51], s37 offen sc1
    buffer_load_dwordx4 v[200:203], v9, s[48:51], s36 offen sc1
    s_add_u32 s36, s36, 4096
    buffer_load_dwordx4 v[204:207], v9, s[48:51], s36 offen sc1
    s_add_u32 s36, s36, 4096
    buffer_load_dwordx4 v[208:211], v9, s[48:51], s36 offen sc1
    s_add_u32 s36, s36, 4096
    buffer_load_dwordx4 v[212:215], v9, s[48:51], s36 offen sc1
    s_add_u32 s36, s36, 4096
    buffer_load_dwordx4 v[216:219], v9, s[48:51], s36 offen sc1
    s_add_u32 s36, s36, 4096
    buffer_load_dwordx4 v[220:223], v9, s[48:51], s36 offen sc1
    s_add_u32 s36, s36, 4096
    buffer_load_dwordx4 v[224:227], v9, s[48:51], s36 offen sc1
    s_add_u32 s36, s36, 4096
    buffer_load_dwordx4 v[228:231], v9, s[48:51], s36 offen sc1
    v_xor_b32 v82, 0, v80
    v_xor_b32 v83, 64, v80
    v_xor_b32 v84, 128, v80
    v_xor_b32 v85, 192, v80
    v_xor_b32 v86, 16, v80
    v_xor_b32 v87, 80, v80
    v_xor_b32 v88, 144, v80
    v_xor_b32 v89, 208, v80
    s_waitcnt vmcnt(8)
    v_max_f32 v4, v52, v54
    s_nop 1
    v_max_f32_dpp v4, v4, v4 row_ror:8 row_mask:0xf bank_mask:0xf
    s_nop 1
    v_max_f32_dpp v4, v4, v4 row_ror:4 row_mask:0xf bank_mask:0xf
    v_sub_f32 v52, v52, v4
    v_sub_f32 v54, v54, v4
    v_exp_f32 v52, v52
    v_exp_f32 v54, v54
    v_mul_f32 v5, v52, v53
    v_fmac_f32 v5, v54, v55
    s_nop 1
    v_add_f32_dpp v5, v5, v5 row_ror:8 row_mask:0xf bank_mask:0xf
    s_nop 1
    v_add_f32_dpp v5, v5, v5 row_ror:4 row_mask:0xf bank_mask:0xf
    v_rcp_f32 v5, v5
    s_nop 0
    v_mul_f32 v52, v52, v5
    v_mul_f32 v54, v54, v5
    s_waitcnt vmcnt(7)
    ds_write_b128 v96, v[200:203] offset:0
    s_waitcnt vmcnt(6)
    ds_write_b128 v97, v[204:207] offset:1024
    s_waitcnt vmcnt(5)
    ds_write_b128 v98, v[208:211] offset:2048
    s_waitcnt vmcnt(4)
    ds_write_b128 v99, v[212:215] offset:3072
    s_waitcnt vmcnt(3)
    ds_write_b128 v96, v[216:219] offset:4096
    s_waitcnt vmcnt(2)
    ds_write_b128 v97, v[220:223] offset:5120
    s_waitcnt vmcnt(1)
    ds_write_b128 v98, v[224:227] offset:6144
    s_waitcnt vmcnt(0)
    ds_write_b128 v99, v[228:231] offset:7168
    s_waitcnt lgkmcnt(0)
    ds_read_b128 v[20:23], v82 offset:0
    ds_read_b128 v[24:27], v83 offset:0
    ds_read_b128 v[28:31], v84 offset:0
    ds_read_b128 v[32:35], v85 offset:0
    ds_read_b128 v[36:39], v86 offset:1024
    ds_read_b128 v[40:43], v87 offset:1024
    ds_read_b128 v[44:47], v88 offset:1024
    ds_read_b128 v[48:51], v89 offset:1024
    s_waitcnt lgkmcnt(0)
    v_mfma_f32_16x16x32_bf16 v[60:63], a[128:131], v[20:23], 0
    v_mfma_f32_16x16x32_bf16 v[64:67], a[128:131], v[36:39], 0
    v_mfma_f32_16x16x32_bf16 v[60:63], a[132:135], v[24:27], v[60:63]
    v_mfma_f32_16x16x32_bf16 v[64:67], a[132:135], v[40:43], v[64:67]
    v_mfma_f32_16x16x32_bf16 v[60:63], a[136:139], v[28:31], v[60:63]
    v_mfma_f32_16x16x32_bf16 v[64:67], a[136:139], v[44:47], v[64:67]
    v_mfma_f32_16x16x32_bf16 v[60:63], a[140:143], v[32:35], v[60:63]
    v_mfma_f32_16x16x32_bf16 v[64:67], a[140:143], v[48:51], v[64:67]
    v_mfma_f32_16x16x32_bf16 v[68:71], a[144:147], v[20:23], 0
    v_mfma_f32_16x16x32_bf16 v[72:75], a[144:147], v[36:39], 0
    v_mfma_f32_16x16x32_bf16 v[68:71], a[148:151], v[24:27], v[68:71]
    v_mfma_f32_16x16x32_bf16 v[72:75], a[148:151], v[40:43], v[72:75]
    v_mfma_f32_16x16x32_bf16 v[68:71], a[152:155], v[28:31], v[68:71]
    v_mfma_f32_16x16x32_bf16 v[72:75], a[152:155], v[44:47], v[72:75]
    v_mfma_f32_16x16x32_bf16 v[68:71], a[156:159], v[32:35], v[68:71]
    v_mfma_f32_16x16x32_bf16 v[72:75], a[156:159], v[48:51], v[72:75]
    v_mul_f32 v104, v60, v52
    v_mul_f32 v105, v61, v52
    v_mul_f32 v106, v62, v52
    v_mul_f32 v107, v63, v52
    v_fmac_f32 v104, v64, v54
    v_fmac_f32 v105, v65, v54
    v_fmac_f32 v106, v66, v54
    v_fmac_f32 v107, v67, v54
    v_add_f32_dpp v104, v104, v104 row_ror:8 row_mask:0xf bank_mask:0xf
    v_add_f32_dpp v105, v105, v105 row_ror:8 row_mask:0xf bank_mask:0xf
    v_add_f32_dpp v106, v106, v106 row_ror:8 row_mask:0xf bank_mask:0xf
    v_add_f32_dpp v107, v107, v107 row_ror:8 row_mask:0xf bank_mask:0xf
    v_add_f32_dpp v104, v104, v104 row_ror:4 row_mask:0xf bank_mask:0xf
    v_add_f32_dpp v105, v105, v105 row_ror:4 row_mask:0xf bank_mask:0xf
    v_add_f32_dpp v106, v106, v106 row_ror:4 row_mask:0xf bank_mask:0xf
    v_add_f32_dpp v107, v107, v107 row_ror:4 row_mask:0xf bank_mask:0xf
    ds_write_b128 v94, v[104:107] offset:0
    v_mfma_f32_16x16x32_bf16 v[60:63], a[160:163], v[20:23], 0
    v_mfma_f32_16x16x32_bf16 v[64:67], a[160:163], v[36:39], 0
    v_mfma_f32_16x16x32_bf16 v[60:63], a[164:167], v[24:27], v[60:63]
    v_mfma_f32_16x16x32_bf16 v[64:67], a[164:167], v[40:43], v[64:67]
    v_mfma_f32_16x16x32_bf16 v[60:63], a[168:171], v[28:31], v[60:63]
    v_mfma_f32_16x16x32_bf16 v[64:67], a[168:171], v[44:47], v[64:67]
    v_mfma_f32_16x16x32_bf16 v[60:63], a[172:175], v[32:35], v[60:63]
    v_mfma_f32_16x16x32_bf16 v[64:67], a[172:175], v[48:51], v[64:67]
    v_mul_f32 v108, v68, v52
    v_mul_f32 v109, v69, v52
    v_mul_f32 v110, v70, v52
    v_mul_f32 v111, v71, v52
    v_fmac_f32 v108, v72, v54
    v_fmac_f32 v109, v73, v54
    v_fmac_f32 v110, v74, v54
    v_fmac_f32 v111, v75, v54
    v_add_f32_dpp v108, v108, v108 row_ror:8 row_mask:0xf bank_mask:0xf
    v_add_f32_dpp v109, v109, v109 row_ror:8 row_mask:0xf bank_mask:0xf
    v_add_f32_dpp v110, v110, v110 row_ror:8 row_mask:0xf bank_mask:0xf
    v_add_f32_dpp v111, v111, v111 row_ror:8 row_mask:0xf bank_mask:0xf
    v_add_f32_dpp v108, v108, v108 row_ror:4 row_mask:0xf bank_mask:0xf
    v_add_f32_dpp v109, v109, v109 row_ror:4 row_mask:0xf bank_mask:0xf
    v_add_f32_dpp v110, v110, v110 row_ror:4 row_mask:0xf bank_mask:0xf
    v_add_f32_dpp v111, v111, v111 row_ror:4 row_mask:0xf bank_mask:0xf
    ds_write_b128 v94, v[108:111] offset:64
    v_mfma_f32_16x16x32_bf16 v[68:71], a[176:179], v[20:23], 0
    v_mfma_f32_16x16x32_bf16 v[72:75], a[176:179], v[36:39], 0
    v_mfma_f32_16x16x32_bf16 v[68:71], a[180:183], v[24:27], v[68:71]
    v_mfma_f32_16x16x32_bf16 v[72:75], a[180:183], v[40:43], v[72:75]
    v_mfma_f32_16x16x32_bf16 v[68:71], a[184:187], v[28:31], v[68:71]
    v_mfma_f32_16x16x32_bf16 v[72:75], a[184:187], v[44:47], v[72:75]
    v_mfma_f32_16x16x32_bf16 v[68:71], a[188:191], v[32:35], v[68:71]
    v_mfma_f32_16x16x32_bf16 v[72:75], a[188:191], v[48:51], v[72:75]
    v_mul_f32 v104, v60, v52
    v_mul_f32 v105, v61, v52
    v_mul_f32 v106, v62, v52
    v_mul_f32 v107, v63, v52
    v_fmac_f32 v104, v64, v54
    v_fmac_f32 v105, v65, v54
    v_fmac_f32 v106, v66, v54
    v_fmac_f32 v107, v67, v54
    v_add_f32_dpp v104, v104, v104 row_ror:8 row_mask:0xf bank_mask:0xf
    v_add_f32_dpp v105, v105, v105 row_ror:8 row_mask:0xf bank_mask:0xf
    v_add_f32_dpp v106, v106, v106 row_ror:8 row_mask:0xf bank_mask:0xf
    v_add_f32_dpp v107, v107, v107 row_ror:8 row_mask:0xf bank_mask:0xf
    v_add_f32_dpp v104, v104, v104 row_ror:4 row_mask:0xf bank_mask:0xf
    v_add_f32_dpp v105, v105, v105 row_ror:4 row_mask:0xf bank_mask:0xf
    v_add_f32_dpp v106, v106, v106 row_ror:4 row_mask:0xf bank_mask:0xf
    v_add_f32_dpp v107, v107, v107 row_ror:4 row_mask:0xf bank_mask:0xf
    ds_write_b128 v94, v[104:107] offset:128
    v_mfma_f32_16x16x32_bf16 v[60:63], a[192:195], v[20:23], 0
    v_mfma_f32_16x16x32_bf16 v[64:67], a[192:195], v[36:39], 0
    v_mfma_f32_16x16x32_bf16 v[60:63], a[196:199], v[24:27], v[60:63]
    v_mfma_f32_16x16x32_bf16 v[64:67], a[196:199], v[40:43], v[64:67]
    v_mfma_f32_16x16x32_bf16 v[60:63], a[200:203], v[28:31], v[60:63]
    v_mfma_f32_16x16x32_bf16 v[64:67], a[200:203], v[44:47], v[64:67]
    v_mfma_f32_16x16x32_bf16 v[60:63], a[204:207], v[32:35], v[60:63]
    v_mfma_f32_16x16x32_bf16 v[64:67], a[204:207], v[48:51], v[64:67]
    v_mul_f32 v108, v68, v52
    v_mul_f32 v109, v69, v52
    v_mul_f32 v110, v70, v52
    v_mul_f32 v111, v71, v52
    v_fmac_f32 v108, v72, v54
    v_fmac_f32 v109, v73, v54
    v_fmac_f32 v110, v74, v54
    v_fmac_f32 v111, v75, v54
    v_add_f32_dpp v108, v108, v108 row_ror:8 row_mask:0xf bank_mask:0xf
    v_add_f32_dpp v109, v109, v109 row_ror:8 row_mask:0xf bank_mask:0xf
    v_add_f32_dpp v110, v110, v110 row_ror:8 row_mask:0xf bank_mask:0xf
    v_add_f32_dpp v111, v111, v111 row_ror:8 row_mask:0xf bank_mask:0xf
    v_add_f32_dpp v108, v108, v108 row_ror:4 row_mask:0xf bank_mask:0xf
    v_add_f32_dpp v109, v109, v109 row_ror:4 row_mask:0xf bank_mask:0xf
    v_add_f32_dpp v110, v110, v110 row_ror:4 row_mask:0xf bank_mask:0xf
    v_add_f32_dpp v111, v111, v111 row_ror:4 row_mask:0xf bank_mask:0xf
    ds_write_b128 v94, v[108:111] offset:192
    v_mfma_f32_16x16x32_bf16 v[68:71], a[208:211], v[20:23], 0
    v_mfma_f32_16x16x32_bf16 v[72:75], a[208:211], v[36:39], 0
    v_mfma_f32_16x16x32_bf16 v[68:71], a[212:215], v[24:27], v[68:71]
    v_mfma_f32_16x16x32_bf16 v[72:75], a[212:215], v[40:43], v[72:75]
    v_mfma_f32_16x16x32_bf16 v[68:71], a[216:219], v[28:31], v[68:71]
    v_mfma_f32_16x16x32_bf16 v[72:75], a[216:219], v[44:47], v[72:75]
    v_mfma_f32_16x16x32_bf16 v[68:71], a[220:223], v[32:35], v[68:71]
    v_mfma_f32_16x16x32_bf16 v[72:75], a[220:223], v[48:51], v[72:75]
    v_mul_f32 v104, v60, v52
    v_mul_f32 v105, v61, v52
    v_mul_f32 v106, v62, v52
    v_mul_f32 v107, v63, v52
    v_fmac_f32 v104, v64, v54
    v_fmac_f32 v105, v65, v54
    v_fmac_f32 v106, v66, v54
    v_fmac_f32 v107, v67, v54
    v_add_f32_dpp v104, v104, v104 row_ror:8 row_mask:0xf bank_mask:0xf
    v_add_f32_dpp v105, v105, v105 row_ror:8 row_mask:0xf bank_mask:0xf
    v_add_f32_dpp v106, v106, v106 row_ror:8 row_mask:0xf bank_mask:0xf
    v_add_f32_dpp v107, v107, v107 row_ror:8 row_mask:0xf bank_mask:0xf
    v_add_f32_dpp v104, v104, v104 row_ror:4 row_mask:0xf bank_mask:0xf
    v_add_f32_dpp v105, v105, v105 row_ror:4 row_mask:0xf bank_mask:0xf
    v_add_f32_dpp v106, v106, v106 row_ror:4 row_mask:0xf bank_mask:0xf
    v_add_f32_dpp v107, v107, v107 row_ror:4 row_mask:0xf bank_mask:0xf
    ds_write_b128 v94, v[104:107] offset:256
    v_mfma_f32_16x16x32_bf16 v[60:63], a[224:227], v[20:23], 0
    v_mfma_f32_16x16x32_bf16 v[64:67], a[224:227], v[36:39], 0
    v_mfma_f32_16x16x32_bf16 v[60:63], a[228:231], v[24:27], v[60:63]
    v_mfma_f32_16x16x32_bf16 v[64:67], a[228:231], v[40:43], v[64:67]
    v_mfma_f32_16x16x32_bf16 v[60:63], a[232:235], v[28:31], v[60:63]
    v_mfma_f32_16x16x32_bf16 v[64:67], a[232:235], v[44:47], v[64:67]
    v_mfma_f32_16x16x32_bf16 v[60:63], a[236:239], v[32:35], v[60:63]
    v_mfma_f32_16x16x32_bf16 v[64:67], a[236:239], v[48:51], v[64:67]
    v_mul_f32 v108, v68, v52
    v_mul_f32 v109, v69, v52
    v_mul_f32 v110, v70, v52
    v_mul_f32 v111, v71, v52
    v_fmac_f32 v108, v72, v54
    v_fmac_f32 v109, v73, v54
    v_fmac_f32 v110, v74, v54
    v_fmac_f32 v111, v75, v54
    v_add_f32_dpp v108, v108, v108 row_ror:8 row_mask:0xf bank_mask:0xf
    v_add_f32_dpp v109, v109, v109 row_ror:8 row_mask:0xf bank_mask:0xf
    v_add_f32_dpp v110, v110, v110 row_ror:8 row_mask:0xf bank_mask:0xf
    v_add_f32_dpp v111, v111, v111 row_ror:8 row_mask:0xf bank_mask:0xf
    v_add_f32_dpp v108, v108, v108 row_ror:4 row_mask:0xf bank_mask:0xf
    v_add_f32_dpp v109, v109, v109 row_ror:4 row_mask:0xf bank_mask:0xf
    v_add_f32_dpp v110, v110, v110 row_ror:4 row_mask:0xf bank_mask:0xf
    v_add_f32_dpp v111, v111, v111 row_ror:4 row_mask:0xf bank_mask:0xf
    ds_write_b128 v94, v[108:111] offset:320
    v_mfma_f32_16x16x32_bf16 v[68:71], a[240:243], v[20:23], 0
    v_mfma_f32_16x16x32_bf16 v[72:75], a[240:243], v[36:39], 0
    v_mfma_f32_16x16x32_bf16 v[68:71], a[244:247], v[24:27], v[68:71]
    v_mfma_f32_16x16x32_bf16 v[72:75], a[244:247], v[40:43], v[72:75]
    v_mfma_f32_16x16x32_bf16 v[68:71], a[248:251], v[28:31], v[68:71]
    v_mfma_f32_16x16x32_bf16 v[72:75], a[248:251], v[44:47], v[72:75]
    v_mfma_f32_16x16x32_bf16 v[68:71], a[252:255], v[32:35], v[68:71]
    v_mfma_f32_16x16x32_bf16 v[72:75], a[252:255], v[48:51], v[72:75]
    v_mul_f32 v104, v60, v52
    v_mul_f32 v105, v61, v52
    v_mul_f32 v106, v62, v52
    v_mul_f32 v107, v63, v52
    v_fmac_f32 v104, v64, v54
    v_fmac_f32 v105, v65, v54
    v_fmac_f32 v106, v66, v54
    v_fmac_f32 v107, v67, v54
    v_add_f32_dpp v104, v104, v104 row_ror:8 row_mask:0xf bank_mask:0xf
    v_add_f32_dpp v105, v105, v105 row_ror:8 row_mask:0xf bank_mask:0xf
    v_add_f32_dpp v106, v106, v106 row_ror:8 row_mask:0xf bank_mask:0xf
    v_add_f32_dpp v107, v107, v107 row_ror:8 row_mask:0xf bank_mask:0xf
    v_add_f32_dpp v104, v104, v104 row_ror:4 row_mask:0xf bank_mask:0xf
    v_add_f32_dpp v105, v105, v105 row_ror:4 row_mask:0xf bank_mask:0xf
    v_add_f32_dpp v106, v106, v106 row_ror:4 row_mask:0xf bank_mask:0xf
    v_add_f32_dpp v107, v107, v107 row_ror:4 row_mask:0xf bank_mask:0xf
    ds_write_b128 v94, v[104:107] offset:384
    v_mul_f32 v108, v68, v52
    v_mul_f32 v109, v69, v52
    v_mul_f32 v110, v70, v52
    v_mul_f32 v111, v71, v52
    v_fmac_f32 v108, v72, v54
    v_fmac_f32 v109, v73, v54
    v_fmac_f32 v110, v74, v54
    v_fmac_f32 v111, v75, v54
    v_add_f32_dpp v108, v108, v108 row_ror:8 row_mask:0xf bank_mask:0xf
    v_add_f32_dpp v109, v109, v109 row_ror:8 row_mask:0xf bank_mask:0xf
    v_add_f32_dpp v110, v110, v110 row_ror:8 row_mask:0xf bank_mask:0xf
    v_add_f32_dpp v111, v111, v111 row_ror:8 row_mask:0xf bank_mask:0xf
    v_add_f32_dpp v108, v108, v108 row_ror:4 row_mask:0xf bank_mask:0xf
    v_add_f32_dpp v109, v109, v109 row_ror:4 row_mask:0xf bank_mask:0xf
    v_add_f32_dpp v110, v110, v110 row_ror:4 row_mask:0xf bank_mask:0xf
    v_add_f32_dpp v111, v111, v111 row_ror:4 row_mask:0xf bank_mask:0xf
    ds_write_b128 v94, v[108:111] offset:448
    s_waitcnt lgkmcnt(0)
    s_barrier
    ds_read_b128 v[20:23], v102 offset:0
    ds_read_b128 v[24:27], v102 offset:8192
    ds_read_b128 v[28:31], v102 offset:16384
    ds_read_b128 v[32:35], v102 offset:24576
    s_waitcnt lgkmcnt(0)
    v_add_f32 v20, v20, v24
    v_add_f32 v28, v28, v32
    v_add_f32 v21, v21, v25
    v_add_f32 v29, v29, v33
    v_add_f32 v22, v22, v26
    v_add_f32 v30, v30, v34
    v_add_f32 v23, v23, v27
    v_add_f32 v31, v31, v35
    v_add_f32 v20, v20, v28
    v_add_f32 v21, v21, v29
    v_add_f32 v22, v22, v30
    v_add_f32 v23, v23, v31
    v_cvt_pk_bf16_f32 v20, v20, v21
    v_cvt_pk_bf16_f32 v21, v22, v23
    ds_write_b64 v103, v[20:21]
    v_lshlrev_b32 v4, 2, v1
    v_add_u32 v4, 136448, v4
    ds_write_b32 v4, v100
L_final:
    s_waitcnt lgkmcnt(0)
    s_barrier
    ds_read_b128 v[136:139], v112 offset:0
    ds_read_b128 v[140:143], v112 offset:64
    ds_read_b128 v[144:147], v112 offset:128
    ds_read_b128 v[148:151], v112 offset:192
    ds_read_b128 v[152:155], v113 offset:0
    ds_read_b128 v[156:159], v113 offset:64
    s_add_u32 s36, s96, 32768
    s_add_u32 s37, s96, 4096
    s_waitcnt lgkmcnt(5)
    v_mfma_f32_16x16x32_bf16 v[84:87], a[0:3], v[136:139], 0
    ds_read_b128 v[160:163], v113 offset:128
    v_mfma_f32_16x16x32_bf16 v[88:91], a[64:67], v[136:139], 0
    s_waitcnt lgkmcnt(5)
    v_mfma_f32_16x16x32_bf16 v[84:87], a[4:7], v[140:143], v[84:87]
    ds_read_b128 v[164:167], v113 offset:192
    v_mfma_f32_16x16x32_bf16 v[88:91], a[68:71], v[140:143], v[88:91]
    s_waitcnt lgkmcnt(5)
    v_mfma_f32_16x16x32_bf16 v[84:87], a[8:11], v[144:147], v[84:87]
    ds_read_b128 v[168:171], v114 offset:0
    v_mfma_f32_16x16x32_bf16 v[88:91], a[72:75], v[144:147], v[88:91]
    s_waitcnt lgkmcnt(5)
    v_mfma_f32_16x16x32_bf16 v[84:87], a[12:15], v[148:151], v[84:87]
    ds_read_b128 v[172:175], v114 offset:64
    v_mfma_f32_16x16x32_bf16 v[88:91], a[76:79], v[148:151], v[88:91]
    s_waitcnt lgkmcnt(5)
    v_mfma_f32_16x16x32_bf16 v[84:87], a[16:19], v[152:155], v[84:87]
    ds_read_b128 v[176:179], v114 offset:128
    v_mfma_f32_16x16x32_bf16 v[88:91], a[80:83], v[152:155], v[88:91]
    s_waitcnt lgkmcnt(5)
    v_mfma_f32_16x16x32_bf16 v[84:87], a[20:23], v[156:159], v[84:87]
    ds_read_b128 v[180:183], v114 offset:192
    v_mfma_f32_16x16x32_bf16 v[88:91], a[84:87], v[156:159], v[88:91]
    s_waitcnt lgkmcnt(5)
    v_mfma_f32_16x16x32_bf16 v[84:87], a[24:27], v[160:163], v[84:87]
    ds_read_b128 v[184:187], v115 offset:0
    v_mfma_f32_16x16x32_bf16 v[88:91], a[88:91], v[160:163], v[88:91]
    s_waitcnt lgkmcnt(5)
    v_mfma_f32_16x16x32_bf16 v[84:87], a[28:31], v[164:167], v[84:87]
    ds_read_b128 v[188:191], v115 offset:64
    v_mfma_f32_16x16x32_bf16 v[88:91], a[92:95], v[164:167], v[88:91]
    s_waitcnt lgkmcnt(5)
    v_mfma_f32_16x16x32_bf16 v[84:87], a[32:35], v[168:171], v[84:87]
    ds_read_b128 v[192:195], v115 offset:128
    v_mfma_f32_16x16x32_bf16 v[88:91], a[96:99], v[168:171], v[88:91]
    s_waitcnt lgkmcnt(5)
    v_mfma_f32_16x16x32_bf16 v[84:87], a[36:39], v[172:175], v[84:87]
    ds_read_b128 v[196:199], v115 offset:192
    v_mfma_f32_16x16x32_bf16 v[88:91], a[100:103], v[172:175], v[88:91]
    s_waitcnt lgkmcnt(5)
    v_mfma_f32_16x16x32_bf16 v[84:87], a[40:43], v[176:179], v[84:87]
    v_mfma_f32_16x16x32_bf16 v[88:91], a[104:107], v[176:179], v[88:91]
    s_waitcnt lgkmcnt(4)
    v_mfma_f32_16x16x32_bf16 v[84:87], a[44:47], v[180:183], v[84:87]
    v_mfma_f32_16x16x32_bf16 v[88:91], a[108:111], v[180:183], v[88:91]
    s_waitcnt lgkmcnt(3)
    v_mfma_f32_16x16x32_bf16 v[84:87], a[48:51], v[184:187], v[84:87]
    v_mfma_f32_16x16x32_bf16 v[88:91], a[112:115], v[184:187], v[88:91]
    s_waitcnt lgkmcnt(2)
    v_mfma_f32_16x16x32_bf16 v[84:87], a[52:55], v[188:191], v[84:87]
    v_mfma_f32_16x16x32_bf16 v[88:91], a[116:119], v[188:191], v[88:91]
    s_waitcnt lgkmcnt(1)
    v_mfma_f32_16x16x32_bf16 v[84:87], a[56:59], v[192:195], v[84:87]
    v_mfma_f32_16x16x32_bf16 v[88:91], a[120:123], v[192:195], v[88:91]
    s_waitcnt lgkmcnt(0)
    v_mfma_f32_16x16x32_bf16 v[84:87], a[60:63], v[196:199], v[84:87]
    v_mfma_f32_16x16x32_bf16 v[88:91], a[124:127], v[196:199], v[88:91]
    s_nop 6
    v_and_or_b32 v84, v84, s82, v8
    v_and_or_b32 v85, v85, s82, v8
    v_and_or_b32 v86, v86, s82, v8
    v_and_or_b32 v87, v87, s82, v8
    buffer_store_dwordx4 v[84:87], v77, s[48:51], s96 offen sc1
    v_and_or_b32 v88, v88, s82, v8
    v_and_or_b32 v89, v89, s82, v8
    v_and_or_b32 v90, v90, s82, v8
    v_and_or_b32 v91, v91, s82, v8
    buffer_store_dwordx4 v[88:91], v77, s[48:51], s36 offen sc1
    s_cmp_eq_u32 s92, 0
    s_cbranch_scc1 L_prepb
L_hop2:
    buffer_load_dwordx4 v[200:203], v78, s[48:51], s96 offen sc1
    buffer_load_dwordx4 v[204:207], v78, s[48:51], s37 offen sc1
    s_waitcnt vmcnt(0)
    v_xor_b32 v200, s35, v200
    v_xor_b32 v201, s35, v201
    v_xor_b32 v202, s35, v202
    v_xor_b32 v203, s35, v203
    v_xor_b32 v204, s35, v204
    v_xor_b32 v205, s35, v205
    v_xor_b32 v206, s35, v206
    v_xor_b32 v207, s35, v207
    v_or_b32 v4, v200, v201
    v_or3_b32 v4, v4, v202, v203
    v_or3_b32 v4, v4, v204, v205
    v_or3_b32 v4, v4, v206, v207
    v_and_b32 v4, 0xff, v4
    v_cmp_ne_u32 vcc, 0, v4
    v_add_f32 v104, v200, v204
    v_add_f32 v105, v201, v205
    v_add_f32 v106, v202, v206
    v_add_f32 v107, v203, v207
    s_cbranch_vccz L_hop2ok
    s_sub_u32 s84, s84, 1
    s_cmp_lg_u32 s84, 0
    s_cbranch_scc1 L_hop2
    s_branch L_end
L_hop2ok:
    v_permlane16_swap_b32 v104, v105
    v_permlane16_swap_b32 v106, v107
    v_add_f32 v104, v104, v105
    v_add_f32 v106, v106, v107
    s_nop 1
    v_permlane32_swap_b32 v104, v106
    v_add_f32 v104, v104, v106
    s_nop 1
    v_add_f32_dpp v104, v104, v104 row_ror:8 row_mask:0xf bank_mask:0xf
    s_nop 1
    v_add_f32_dpp v104, v104, v104 row_ror:4 row_mask:0xf bank_mask:0xf
    v_cvt_pk_bf16_f32 v104, v104, v104
    s_mov_b32 exec_lo, 0xf000f
    s_mov_b32 exec_hi, 0xf000f
    buffer_store_short v104, v79, s[72:75], s97 offen
    s_mov_b64 exec, -1
    s_cmp_lg_u32 s92, 0
    s_cbranch_scc1 L_fin
    s_mov_b32 s92, 1
    s_mov_b32 s96, 786432
    s_mov_b32 s97, 1024
    s_lshl_b32 s38, s32, 15
    s_add_u32 s85, s38, 1048576
    s_lshl_b32 s38, s34, 13
    s_add_u32 s85, s38, s85
    s_mov_b32 s93, 0x7f
    s_mov_b32 s94, 0
    v_mov_b32 v55, 0xff7f0000
    v_mov_b32 v56, 0
    v_mov_b32 v57, 0
    v_mov_b32 v58, 0
    v_mov_b32 v59, 0
    s_and_b32 s94, s94, s93
    s_cselect_b32 s94, s94, s93
    s_ff1_i32_b32 s4, s94
    s_bitset0_b32 s94, s4
    s_lshl_b32 s36, s4, 10
    s_add_u32 s36, s36, s85
    buffer_load_dwordx4 v[20:23], v92, s[48:51], s36 offen sc1
    s_and_b32 s94, s94, s93
    s_cselect_b32 s94, s94, s93
    s_ff1_i32_b32 s5, s94
    s_bitset0_b32 s94, s5
    s_lshl_b32 s36, s5, 10
    s_add_u32 s36, s36, s85
    buffer_load_dwordx4 v[24:27], v92, s[48:51], s36 offen sc1
    s_and_b32 s94, s94, s93
    s_cselect_b32 s94, s94, s93
    s_ff1_i32_b32 s6, s94
    s_bitset0_b32 s94, s6
    s_lshl_b32 s36, s6, 10
    s_add_u32 s36, s36, s85
    buffer_load_dwordx4 v[28:31], v92, s[48:51], s36 offen sc1
    s_and_b32 s94, s94, s93
    s_cselect_b32 s94, s94, s93
    s_ff1_i32_b32 s7, s94
    s_bitset0_b32 s94, s7
    s_lshl_b32 s36, s7, 10
    s_add_u32 s36, s36, s85
    buffer_load_dwordx4 v[32:35], v92, s[48:51], s36 offen sc1
L_hop1poll:
    s_and_b32 s94, s94, s93
    s_cselect_b32 s94, s94, s93
    s_ff1_i32_b32 s8, s94
    s_bitset0_b32 s94, s8
    s_lshl_b32 s36, s8, 10
    s_add_u32 s36, s36, s85
    buffer_load_dwordx4 v[36:39], v92, s[48:51], s36 offen sc1
    s_waitcnt vmcnt(4)
    v_xor_b32 v20, s35, v20
    v_xor_b32 v21, s35, v21
    v_xor_b32 v22, s35, v22
    v_xor_b32 v23, s35, v23
    v_or_b32 v4, v20, v21
    v_or3_b32 v4, v4, v22, v23
    v_and_b32 v4, 0xff, v4
    v_cmp_ne_u32 vcc, 0, v4
    v_max_f32 v5, v55, v20
    s_cbranch_vccnz L_mnext_21
    s_bitcmp1_b32 s93, s4
    s_cbranch_scc0 L_mnext_21
    v_sub_f32 v52, v55, v5
    v_sub_f32 v53, v20, v5
    v_exp_f32 v52, v52
    v_exp_f32 v53, v53
    v_mov_b32 v55, v5
    s_bitset0_b32 s93, s4
    v_mul_f32_dpp v57, v52, v57 row_newbcast:8 row_mask:0xf bank_mask:0xf
    v_mul_f32_dpp v56, v52, v56 row_newbcast:8 row_mask:0xf bank_mask:0xf
    v_mul_f32_dpp v58, v52, v58 row_newbcast:8 row_mask:0xf bank_mask:0xf
    v_mul_f32_dpp v59, v52, v59 row_newbcast:8 row_mask:0xf bank_mask:0xf
    v_fmac_f32_dpp v57, v53, v21 row_newbcast:8 row_mask:0xf bank_mask:0xf
    v_fmac_f32_dpp v56, v53, v20 row_newbcast:8 row_mask:0xf bank_mask:0xf
    v_fmac_f32_dpp v58, v53, v22 row_newbcast:8 row_mask:0xf bank_mask:0xf
    v_fmac_f32_dpp v59, v53, v23 row_newbcast:8 row_mask:0xf bank_mask:0xf
    s_cmp_eq_u32 s93, 0
    s_cbranch_scc1 L_hop1ok
L_mnext_21:
    s_and_b32 s94, s94, s93
    s_cselect_b32 s94, s94, s93
    s_ff1_i32_b32 s4, s94
    s_bitset0_b32 s94, s4
    s_lshl_b32 s36, s4, 10
    s_add_u32 s36, s36, s85
    buffer_load_dwordx4 v[20:23], v92, s[48:51], s36 offen sc1
    s_waitcnt vmcnt(4)
    v_xor_b32 v24, s35, v24
    v_xor_b32 v25, s35, v25
    v_xor_b32 v26, s35, v26
    v_xor_b32 v27, s35, v27
    v_or_b32 v4, v24, v25
    v_or3_b32 v4, v4, v26, v27
    v_and_b32 v4, 0xff, v4
    v_cmp_ne_u32 vcc, 0, v4
    v_max_f32 v5, v55, v24
    s_cbranch_vccnz L_mnext_22
    s_bitcmp1_b32 s93, s5
    s_cbranch_scc0 L_mnext_22
    v_sub_f32 v52, v55, v5
    v_sub_f32 v53, v24, v5
    v_exp_f32 v52, v52
    v_exp_f32 v53, v53
    v_mov_b32 v55, v5
    s_bitset0_b32 s93, s5
    v_mul_f32_dpp v57, v52, v57 row_newbcast:8 row_mask:0xf bank_mask:0xf
    v_mul_f32_dpp v56, v52, v56 row_newbcast:8 row_mask:0xf bank_mask:0xf
    v_mul_f32_dpp v58, v52, v58 row_newbcast:8 row_mask:0xf bank_mask:0xf
    v_mul_f32_dpp v59, v52, v59 row_newbcast:8 row_mask:0xf bank_mask:0xf
    v_fmac_f32_dpp v57, v53, v25 row_newbcast:8 row_mask:0xf bank_mask:0xf
    v_fmac_f32_dpp v56, v53, v24 row_newbcast:8 row_mask:0xf bank_mask:0xf
    v_fmac_f32_dpp v58, v53, v26 row_newbcast:8 row_mask:0xf bank_mask:0xf
    v_fmac_f32_dpp v59, v53, v27 row_newbcast:8 row_mask:0xf bank_mask:0xf
    s_cmp_eq_u32 s93, 0
    s_cbranch_scc1 L_hop1ok
L_mnext_22:
    s_and_b32 s94, s94, s93
    s_cselect_b32 s94, s94, s93
    s_ff1_i32_b32 s5, s94
    s_bitset0_b32 s94, s5
    s_lshl_b32 s36, s5, 10
    s_add_u32 s36, s36, s85
    buffer_load_dwordx4 v[24:27], v92, s[48:51], s36 offen sc1
    s_waitcnt vmcnt(4)
    v_xor_b32 v28, s35, v28
    v_xor_b32 v29, s35, v29
    v_xor_b32 v30, s35, v30
    v_xor_b32 v31, s35, v31
    v_or_b32 v4, v28, v29
    v_or3_b32 v4, v4, v30, v31
    v_and_b32 v4, 0xff, v4
    v_cmp_ne_u32 vcc, 0, v4
    v_max_f32 v5, v55, v28
    s_cbranch_vccnz L_mnext_23
    s_bitcmp1_b32 s93, s6
    s_cbranch_scc0 L_mnext_23
    v_sub_f32 v52, v55, v5
    v_sub_f32 v53, v28, v5
    v_exp_f32 v52, v52
    v_exp_f32 v53, v53
    v_mov_b32 v55, v5
    s_bitset0_b32 s93, s6
    v_mul_f32_dpp v57, v52, v57 row_newbcast:8 row_mask:0xf bank_mask:0xf
    v_mul_f32_dpp v56, v52, v56 row_newbcast:8 row_mask:0xf bank_mask:0xf
    v_mul_f32_dpp v58, v52, v58 row_newbcast:8 row_mask:0xf bank_mask:0xf
    v_mul_f32_dpp v59, v52, v59 row_newbcast:8 row_mask:0xf bank_mask:0xf
    v_fmac_f32_dpp v57, v53, v29 row_newbcast:8 row_mask:0xf bank_mask:0xf
    v_fmac_f32_dpp v56, v53, v28 row_newbcast:8 row_mask:0xf bank_mask:0xf
    v_fmac_f32_dpp v58, v53, v30 row_newbcast:8 row_mask:0xf bank_mask:0xf
    v_fmac_f32_dpp v59, v53, v31 row_newbcast:8 row_mask:0xf bank_mask:0xf
    s_cmp_eq_u32 s93, 0
    s_cbranch_scc1 L_hop1ok
L_mnext_23:
    s_and_b32 s94, s94, s93
    s_cselect_b32 s94, s94, s93
    s_ff1_i32_b32 s6, s94
    s_bitset0_b32 s94, s6
    s_lshl_b32 s36, s6, 10
    s_add_u32 s36, s36, s85
    buffer_load_dwordx4 v[28:31], v92, s[48:51], s36 offen sc1
    s_waitcnt vmcnt(4)
    v_xor_b32 v32, s35, v32
    v_xor_b32 v33, s35, v33
    v_xor_b32 v34, s35, v34
    v_xor_b32 v35, s35, v35
    v_or_b32 v4, v32, v33
    v_or3_b32 v4, v4, v34, v35
    v_and_b32 v4, 0xff, v4
    v_cmp_ne_u32 vcc, 0, v4
    v_max_f32 v5, v55, v32
    s_cbranch_vccnz L_mnext_24
    s_bitcmp1_b32 s93, s7
    s_cbranch_scc0 L_mnext_24
    v_sub_f32 v52, v55, v5
    v_sub_f32 v53, v32, v5
    v_exp_f32 v52, v52
    v_exp_f32 v53, v53
    v_mov_b32 v55, v5
    s_bitset0_b32 s93, s7
    v_mul_f32_dpp v57, v52, v57 row_newbcast:8 row_mask:0xf bank_mask:0xf
    v_mul_f32_dpp v56, v52, v56 row_newbcast:8 row_mask:0xf bank_mask:0xf
    v_mul_f32_dpp v58, v52, v58 row_newbcast:8 row_mask:0xf bank_mask:0xf
    v_mul_f32_dpp v59, v52, v59 row_newbcast:8 row_mask:0xf bank_mask:0xf
    v_fmac_f32_dpp v57, v53, v33 row_newbcast:8 row_mask:0xf bank_mask:0xf
    v_fmac_f32_dpp v56, v53, v32 row_newbcast:8 row_mask:0xf bank_mask:0xf
    v_fmac_f32_dpp v58, v53, v34 row_newbcast:8 row_mask:0xf bank_mask:0xf
    v_fmac_f32_dpp v59, v53, v35 row_newbcast:8 row_mask:0xf bank_mask:0xf
    s_cmp_eq_u32 s93, 0
    s_cbranch_scc1 L_hop1ok
L_mnext_24:
    s_and_b32 s94, s94, s93
    s_cselect_b32 s94, s94, s93
    s_ff1_i32_b32 s7, s94
    s_bitset0_b32 s94, s7
    s_lshl_b32 s36, s7, 10
    s_add_u32 s36, s36, s85
    buffer_load_dwordx4 v[32:35], v92, s[48:51], s36 offen sc1
    s_waitcnt vmcnt(4)
    v_xor_b32 v36, s35, v36
    v_xor_b32 v37, s35, v37
    v_xor_b32 v38, s35, v38
    v_xor_b32 v39, s35, v39
    v_or_b32 v4, v36, v37
    v_or3_b32 v4, v4, v38, v39
    v_and_b32 v4, 0xff, v4
    v_cmp_ne_u32 vcc, 0, v4
    v_max_f32 v5, v55, v36
    s_cbranch_vccnz L_mnext_25
    s_bitcmp1_b32 s93, s8
    s_cbranch_scc0 L_mnext_25
    v_sub_f32 v52, v55, v5
    v_sub_f32 v53, v36, v5
    v_exp_f32 v52, v52
    v_exp_f32 v53, v53
    v_mov_b32 v55, v5
    s_bitset0_b32 s93, s8
    v_mul_f32_dpp v57, v52, v57 row_newbcast:8 row_mask:0xf bank_mask:0xf
    v_mul_f32_dpp v56, v52, v56 row_newbcast:8 row_mask:0xf bank_mask:0xf
    v_mul_f32_dpp v58, v52, v58 row_newbcast:8 row_mask:0xf bank_mask:0xf
    v_mul_f32_dpp v59, v52, v59 row_newbcast:8 row_mask:0xf bank_mask:0xf
    v_fmac_f32_dpp v57, v53, v37 row_newbcast:8 row_mask:0xf bank_mask:0xf
    v_fmac_f32_dpp v56, v53, v36 row_newbcast:8 row_mask:0xf bank_mask:0xf
    v_fmac_f32_dpp v58, v53, v38 row_newbcast:8 row_mask:0xf bank_mask:0xf
    v_fmac_f32_dpp v59, v53, v39 row_newbcast:8 row_mask:0xf bank_mask:0xf
    s_cmp_eq_u32 s93, 0
    s_cbranch_scc1 L_hop1ok
L_mnext_25:
    s_sub_u32 s84, s84, 1
    s_cmp_lg_u32 s84, 0
    s_cbranch_scc1 L_hop1poll
    s_branch L_end
L_hop1ok:
    v_rcp_f32 v55, v57
    s_nop 1
    v_mul_f32_dpp v56, v55, v56 row_newbcast:8 row_mask:0xf bank_mask:0xf
    v_mul_f32_dpp v57, v55, v57 row_newbcast:8 row_mask:0xf bank_mask:0xf
    v_mul_f32_dpp v58, v55, v58 row_newbcast:8 row_mask:0xf bank_mask:0xf
    v_mul_f32_dpp v59, v55, v59 row_newbcast:8 row_mask:0xf bank_mask:0xf
    v_cvt_pk_bf16_f32 v56, v56, v57
    v_cvt_pk_bf16_f32 v58, v58, v59
    s_mov_b32 exec_lo, 0xff00ff
    s_mov_b32 exec_hi, 0xff00ff
    ds_write_b16 v93, v56
    ds_write_b16_d16_hi v93, v56 offset:16
    ds_write_b16 v93, v58 offset:32
    ds_write_b16_d16_hi v93, v58 offset:48
    s_mov_b64 exec, -1
    s_branch L_final
L_prepb:
    v_xor_b32 v4, 0, v95
    ds_read_b64_tr_b16 a[0:1], v4 offset:0
    ds_read_b64_tr_b16 a[4:5], v4 offset:8192
    ds_read_b64_tr_b16 a[8:9], v4 offset:16384
    ds_read_b64_tr_b16 a[12:13], v4 offset:24576
    v_xor_b32 v5, 16, v95
    ds_read_b64_tr_b16 a[2:3], v5 offset:1024
    ds_read_b64_tr_b16 a[6:7], v5 offset:9216
    ds_read_b64_tr_b16 a[10:11], v5 offset:17408
    ds_read_b64_tr_b16 a[14:15], v5 offset:25600
    v_xor_b32 v4, 32, v95
    ds_read_b64_tr_b16 a[16:17], v4 offset:0
    ds_read_b64_tr_b16 a[20:21], v4 offset:8192
    ds_read_b64_tr_b16 a[24:25], v4 offset:16384
    ds_read_b64_tr_b16 a[28:29], v4 offset:24576
    v_xor_b32 v5, 48, v95
    ds_read_b64_tr_b16 a[18:19], v5 offset:1024
    ds_read_b64_tr_b16 a[22:23], v5 offset:9216
    ds_read_b64_tr_b16 a[26:27], v5 offset:17408
    ds_read_b64_tr_b16 a[30:31], v5 offset:25600
    v_xor_b32 v4, 64, v95
    ds_read_b64_tr_b16 a[32:33], v4 offset:0
    ds_read_b64_tr_b16 a[36:37], v4 offset:8192
    ds_read_b64_tr_b16 a[40:41], v4 offset:16384
    ds_read_b64_tr_b16 a[44:45], v4 offset:24576
    v_xor_b32 v5, 80, v95
    ds_read_b64_tr_b16 a[34:35], v5 offset:1024
    ds_read_b64_tr_b16 a[38:39], v5 offset:9216
    ds_read_b64_tr_b16 a[42:43], v5 offset:17408
    ds_read_b64_tr_b16 a[46:47], v5 offset:25600
    v_xor_b32 v4, 96, v95
    ds_read_b64_tr_b16 a[48:49], v4 offset:0
    ds_read_b64_tr_b16 a[52:53], v4 offset:8192
    ds_read_b64_tr_b16 a[56:57], v4 offset:16384
    ds_read_b64_tr_b16 a[60:61], v4 offset:24576
    v_xor_b32 v5, 112, v95
    ds_read_b64_tr_b16 a[50:51], v5 offset:1024
    ds_read_b64_tr_b16 a[54:55], v5 offset:9216
    ds_read_b64_tr_b16 a[58:59], v5 offset:17408
    ds_read_b64_tr_b16 a[62:63], v5 offset:25600
    v_xor_b32 v4, 128, v95
    ds_read_b64_tr_b16 a[64:65], v4 offset:0
    ds_read_b64_tr_b16 a[68:69], v4 offset:8192
    ds_read_b64_tr_b16 a[72:73], v4 offset:16384
    ds_read_b64_tr_b16 a[76:77], v4 offset:24576
    v_xor_b32 v5, 144, v95
    ds_read_b64_tr_b16 a[66:67], v5 offset:1024
    ds_read_b64_tr_b16 a[70:71], v5 offset:9216
    ds_read_b64_tr_b16 a[74:75], v5 offset:17408
    ds_read_b64_tr_b16 a[78:79], v5 offset:25600
    v_xor_b32 v4, 160, v95
    ds_read_b64_tr_b16 a[80:81], v4 offset:0
    ds_read_b64_tr_b16 a[84:85], v4 offset:8192
    ds_read_b64_tr_b16 a[88:89], v4 offset:16384
    ds_read_b64_tr_b16 a[92:93], v4 offset:24576
    v_xor_b32 v5, 176, v95
    ds_read_b64_tr_b16 a[82:83], v5 offset:1024
    ds_read_b64_tr_b16 a[86:87], v5 offset:9216
    ds_read_b64_tr_b16 a[90:91], v5 offset:17408
    ds_read_b64_tr_b16 a[94:95], v5 offset:25600
    v_xor_b32 v4, 192, v95
    ds_read_b64_tr_b16 a[96:97], v4 offset:0
    ds_read_b64_tr_b16 a[100:101], v4 offset:8192
    ds_read_b64_tr_b16 a[104:105], v4 offset:16384
    ds_read_b64_tr_b16 a[108:109], v4 offset:24576
    v_xor_b32 v5, 208, v95
    ds_read_b64_tr_b16 a[98:99], v5 offset:1024
    ds_read_b64_tr_b16 a[102:103], v5 offset:9216
    ds_read_b64_tr_b16 a[106:107], v5 offset:17408
    ds_read_b64_tr_b16 a[110:111], v5 offset:25600
    v_xor_b32 v4, 224, v95
    ds_read_b64_tr_b16 a[112:113], v4 offset:0
    ds_read_b64_tr_b16 a[116:117], v4 offset:8192
    ds_read_b64_tr_b16 a[120:121], v4 offset:16384
    ds_read_b64_tr_b16 a[124:125], v4 offset:24576
    v_xor_b32 v5, 240, v95
    ds_read_b64_tr_b16 a[114:115], v5 offset:1024
    ds_read_b64_tr_b16 a[118:119], v5 offset:9216
    ds_read_b64_tr_b16 a[122:123], v5 offset:17408
    ds_read_b64_tr_b16 a[126:127], v5 offset:25600
    s_waitcnt lgkmcnt(0)
    s_barrier
    s_branch L_hop2
L_fin:
    s_or_b32 s36, s32, s34
    s_cmp_lg_u32 s36, 0
    s_cbranch_scc1 L_end
    s_mov_b64 exec, 1
    buffer_store_dword v8, v100, s[48:51], 0 offen
L_end:
    s_endpgm
.section .rodata,"a"
.p2align 6
.amdhsa_kernel concat_heads__compressed_kv_cla__mha_block_cached__decode_kernel
  .amdhsa_next_free_vgpr 512
  .amdhsa_next_free_sgpr 102
  .amdhsa_accum_offset 256
  .amdhsa_group_segment_fixed_size 0
  .amdhsa_kernarg_size 112
  .amdhsa_user_sgpr_count 2
  .amdhsa_user_sgpr_kernarg_segment_ptr 1
  .amdhsa_system_sgpr_workgroup_id_x 1
.end_amdhsa_kernel
```

```asm
; @launch grid=(256,1,1) block=(256,1,1) lds=163840
    .amdgcn_target "amdgcn-amd-amdhsa--gfx950"
    .text
    .globl concat_heads__compressed_kv_cla__mha_block_cached__decode_kernel
    .p2align 8
    .type concat_heads__compressed_kv_cla__mha_block_cached__decode_kernel,@function
concat_heads__compressed_kv_cla__mha_block_cached__decode_kernel:
    s_cmp_ge_u32 s2, 256
    s_cbranch_scc1 L_end
    s_load_dwordx16 s[4:19], s[0:1], 0
    s_load_dwordx8 s[20:27], s[0:1], 64
    s_load_dwordx4 s[28:31], s[0:1], 96
    v_lshrrev_b32 v4, 6, v0
    v_and_b32 v1, 63, v0
    v_readfirstlane_b32 s34, v4
    s_lshr_b32 s32, s2, 3
    s_sub_u32 s33, s2, s32
    s_sub_u32 s33, s33, 1
    s_and_b32 s33, s33, 7
    v_lshrrev_b32 v2, 4, v1
    v_and_b32 v3, 15, v1
    s_cmp_lt_u32 s33, 2
    s_cbranch_scc1 L_qp
    s_cmp_eq_u32 s33, 2
    s_cbranch_scc1 L_ql
    s_cmp_eq_u32 s33, 7
    s_cbranch_scc1 L_aux
    s_bfe_u32 s38, s2, 0x30000
    s_lshl_b32 s38, s38, 21
    s_add_u32 s36, s38, -393216
    s_lshr_b32 s38, s32, 3
    s_lshl_b32 s38, s38, 19
    s_add_u32 s36, s38, s36
    s_lshl_b32 s38, s33, 17
    s_add_u32 s36, s38, s36
    s_lshl_b32 s38, s34, 12
    s_add_u32 s36, s38, s36
    v_bfe_u32 v5, v1, 0, 5
    v_lshlrev_b32 v4, 7, v5
    v_lshrrev_b32 v5, 5, v1
    v_lshl_add_u32 v4, v5, 15, v4
    s_mov_b32 s42, 16777216
    s_mov_b32 s43, 0x20000
    s_waitcnt lgkmcnt(0)
    s_mov_b64 s[40:41], s[6:7]
    buffer_load_dword v20, v4, s[40:43], s36 offen
    s_add_u32 s36, s36, 16384
    buffer_load_dword v21, v4, s[40:43], s36 offen
    s_add_u32 s36, s36, 49152
    buffer_load_dword v22, v4, s[40:43], s36 offen
    s_add_u32 s36, s36, 16384
    buffer_load_dword v23, v4, s[40:43], s36 offen
    s_load_dword s35, s[30:31], 0
    s_mov_b32 s48, s30
    s_and_b32 s49, s31, 0xffff
    s_mov_b32 s50, 8388608
    s_mov_b32 s51, 0x20000
    s_mov_b32 s82, 0xffffff00
    s_mov_b32 s83, 0x3e0293ee
    s_mov_b32 s84, 2097152
    v_lshrrev_b32 v4, 2, v3
    v_and_b32 v5, 3, v3
    v_lshlrev_b32 v76, 8, v4
    v_lshlrev_b32 v126, 8, v2
    v_lshl_add_u32 v76, v2, 6, v76
    v_lshl_add_u32 v76, v5, 4, v76
    v_lshl_add_u32 v126, v3, 4, v126
    v_xor_b32 v77, 32768, v76
    v_xor_b32 v127, 32768, v126
    s_add_u32 s3, s34, s33
    s_and_b32 s3, s3, 3
    s_lshl_b32 s89, s3, 5
    s_add_u32 s89, s89, s32
    s_lshl_b32 s89, s89, 20
    s_mul_i32 s88, s32, 8
    s_add_u32 s88, s88, s3
    s_lshl_b32 s87, s33, 0
    s_mov_b32 s52, s18
    s_and_b32 s53, s19, 0xffff
    s_mov_b32 s54, 134217728
    s_mov_b32 s55, 0x20000
    s_mov_b32 s56, s20
    s_and_b32 s57, s21, 0xffff
    s_mov_b32 s58, 134217728
    s_mov_b32 s59, 0x20000
    v_and_b32 v4, 1, v1
    v_lshlrev_b32 v4, 4, v4
    v_mov_b32 v5, 0xffff
    v_lshlrev_b32 v4, v4, v5
    v_bfe_u32 v5, v1, 1, 2
    v_cmp_eq_u32 vcc, 0, v5
    s_nop 1
    v_cndmask_b32 v10, 0, v4, vcc
    v_cmp_eq_u32 vcc, 1, v5
    s_nop 1
    v_cndmask_b32 v11, 0, v4, vcc
    v_cmp_eq_u32 vcc, 2, v5
    s_nop 1
    v_cndmask_b32 v12, 0, v4, vcc
    v_cmp_eq_u32 vcc, 3, v5
    s_nop 1
    v_cndmask_b32 v13, 0, v4, vcc
    v_mov_b32 v120, 0xff7f0000
    v_mov_b32 v121, 0
    v_mov_b32 v18, 1
    v_mov_b32 v116, 0
    v_mov_b32 v117, 0
    v_mov_b32 v118, 0
    v_mov_b32 v119, 0
    s_lshl_b32 s38, s32, 10
    s_add_u32 s96, s38, 65536
    s_lshl_b32 s38, s3, 8
    s_add_u32 s96, s38, s96
    v_mov_b32 v9, s96
    s_lshl_b32 s38, s32, 15
    s_add_u32 s96, s38, 1048576
    s_lshl_b32 s38, s3, 13
    s_add_u32 s96, s38, s96
    s_lshl_b32 s38, s33, 10
    s_add_u32 s96, s38, s96
    v_and_b32 v5, 3, v3
    v_lshlrev_b32 v78, 7, v2
    v_lshl_add_u32 v78, v5, 5, v78
    s_lshl_b32 s38, s32, 12
    s_add_u32 s91, s38, 262144
    s_lshl_b32 s38, s3, 9
    s_add_u32 s91, s38, s91
    v_lshlrev_b32 v4, 7, v2
    v_lshl_add_u32 v4, v3, 4, v4
    v_mov_b32 v5, 512
    v_cmp_gt_u32 vcc, 8, v3
    s_nop 1
    v_cndmask_b32 v79, v5, v4, vcc
    s_add_u32 s39, s87, s88
    s_bfe_u32 s37, s39, 0x30000
    s_lshl_b32 s37, s37, 12
    s_add_u32 s85, s37, s89
    s_bfe_u32 s37, s39, 0x10003
    s_lshl_b32 s37, s37, 11
    s_add_u32 s85, s37, s85
    s_bfe_u32 s37, s39, 0x40004
    s_lshl_b32 s37, s37, 16
    s_add_u32 s85, s37, s85
    buffer_load_dwordx4 v[128:131], v76, s[52:55], s85 offen offset:0 nt
    buffer_load_dwordx4 v[132:135], v77, s[52:55], s85 offen offset:0 nt
    buffer_load_dwordx4 v[136:139], v76, s[52:55], s85 offen offset:1024 nt
    buffer_load_dwordx4 v[140:143], v77, s[52:55], s85 offen offset:1024 nt
    s_add_u32 s87, s87, 7
    s_add_u32 s39, s87, s88
    s_bfe_u32 s37, s39, 0x30000
    s_lshl_b32 s37, s37, 12
    s_add_u32 s85, s37, s89
    s_bfe_u32 s37, s39, 0x10003
    s_lshl_b32 s37, s37, 11
    s_add_u32 s85, s37, s85
    s_bfe_u32 s37, s39, 0x40004
    s_lshl_b32 s37, s37, 16
    s_add_u32 s85, s37, s85
    buffer_load_dwordx4 v[144:147], v76, s[52:55], s85 offen offset:0 nt
    buffer_load_dwordx4 v[148:151], v77, s[52:55], s85 offen offset:0 nt
    buffer_load_dwordx4 v[152:155], v76, s[52:55], s85 offen offset:1024 nt
    s_waitcnt vmcnt(6)
    buffer_load_dwordx4 v[156:159], v77, s[52:55], s85 offen offset:1024 nt
    s_add_u32 s87, s87, 7
    s_add_u32 s39, s87, s88
    s_bfe_u32 s37, s39, 0x30000
    s_lshl_b32 s37, s37, 12
    s_add_u32 s85, s37, s89
    s_bfe_u32 s37, s39, 0x10003
    s_lshl_b32 s37, s37, 11
    s_add_u32 s85, s37, s85
    s_bfe_u32 s37, s39, 0x40004
    s_lshl_b32 s37, s37, 16
    s_add_u32 s85, s37, s85
    s_waitcnt vmcnt(6)
    buffer_load_dwordx4 v[160:163], v76, s[52:55], s85 offen offset:0 nt
    s_waitcnt vmcnt(6)
    buffer_load_dwordx4 v[164:167], v77, s[52:55], s85 offen offset:0 nt
    s_waitcnt vmcnt(6)
    buffer_load_dwordx4 v[168:171], v76, s[52:55], s85 offen offset:1024 nt
    s_waitcnt vmcnt(6)
    buffer_load_dwordx4 v[172:175], v77, s[52:55], s85 offen offset:1024 nt
    s_add_u32 s87, s87, 7
    s_add_u32 s39, s87, s88
    s_bfe_u32 s37, s39, 0x30000
    s_lshl_b32 s37, s37, 12
    s_add_u32 s85, s37, s89
    s_bfe_u32 s37, s39, 0x10003
    s_lshl_b32 s37, s37, 11
    s_add_u32 s85, s37, s85
    s_bfe_u32 s37, s39, 0x40004
    s_lshl_b32 s37, s37, 16
    s_add_u32 s85, s37, s85
    s_waitcnt vmcnt(6)
    buffer_load_dwordx4 v[176:179], v76, s[52:55], s85 offen offset:0 nt
    s_waitcnt vmcnt(6)
    buffer_load_dwordx4 v[180:183], v77, s[52:55], s85 offen offset:0 nt
    s_waitcnt vmcnt(6)
    buffer_load_dwordx4 v[184:187], v76, s[52:55], s85 offen offset:1024 nt
    s_waitcnt vmcnt(6)
    buffer_load_dwordx4 v[188:191], v77, s[52:55], s85 offen offset:1024 nt
    s_add_u32 s87, s87, 7
    s_add_u32 s39, s87, s88
    s_bfe_u32 s37, s39, 0x30000
    s_lshl_b32 s37, s37, 12
    s_add_u32 s85, s37, s89
    s_bfe_u32 s37, s39, 0x10003
    s_lshl_b32 s37, s37, 11
    s_add_u32 s85, s37, s85
    s_bfe_u32 s37, s39, 0x40004
    s_lshl_b32 s37, s37, 16
    s_add_u32 s85, s37, s85
    s_waitcnt vmcnt(6)
    buffer_load_dwordx4 v[192:195], v76, s[52:55], s85 offen offset:0 nt
    s_waitcnt vmcnt(6)
    buffer_load_dwordx4 v[196:199], v77, s[52:55], s85 offen offset:0 nt
    s_waitcnt vmcnt(6)
    buffer_load_dwordx4 v[200:203], v76, s[52:55], s85 offen offset:1024 nt
    s_waitcnt vmcnt(6)
    buffer_load_dwordx4 v[204:207], v77, s[52:55], s85 offen offset:1024 nt
    s_add_u32 s87, s87, 7
    s_add_u32 s39, s87, s88
    s_bfe_u32 s37, s39, 0x30000
    s_lshl_b32 s37, s37, 12
    s_add_u32 s85, s37, s89
    s_bfe_u32 s37, s39, 0x10003
    s_lshl_b32 s37, s37, 11
    s_add_u32 s85, s37, s85
    s_bfe_u32 s37, s39, 0x40004
    s_lshl_b32 s37, s37, 16
    s_add_u32 s85, s37, s85
    s_waitcnt vmcnt(6)
    buffer_load_dwordx4 v[208:211], v76, s[52:55], s85 offen offset:0 nt
    s_waitcnt vmcnt(6)
    buffer_load_dwordx4 v[212:215], v77, s[52:55], s85 offen offset:0 nt
    s_waitcnt vmcnt(6)
    buffer_load_dwordx4 v[216:219], v76, s[52:55], s85 offen offset:1024 nt
    s_waitcnt vmcnt(6)
    buffer_load_dwordx4 v[220:223], v77, s[52:55], s85 offen offset:1024 nt
    s_add_u32 s87, s87, 7
    s_add_u32 s39, s87, s88
    s_bfe_u32 s37, s39, 0x30000
    s_lshl_b32 s37, s37, 12
    s_add_u32 s85, s37, s89
    s_bfe_u32 s37, s39, 0x10003
    s_lshl_b32 s37, s37, 11
    s_add_u32 s85, s37, s85
    s_bfe_u32 s37, s39, 0x40004
    s_lshl_b32 s37, s37, 16
    s_add_u32 s85, s37, s85
    s_waitcnt vmcnt(6)
    buffer_load_dwordx4 v[224:227], v76, s[52:55], s85 offen offset:0 nt
    s_waitcnt vmcnt(6)
    buffer_load_dwordx4 v[228:231], v77, s[52:55], s85 offen offset:0 nt
    s_waitcnt vmcnt(6)
    buffer_load_dwordx4 v[232:235], v76, s[52:55], s85 offen offset:1024 nt
    s_waitcnt vmcnt(6)
    buffer_load_dwordx4 v[236:239], v77, s[52:55], s85 offen offset:1024 nt
    s_add_u32 s87, s87, 7
    s_add_u32 s39, s87, s88
    s_bfe_u32 s37, s39, 0x30000
    s_lshl_b32 s37, s37, 12
    s_add_u32 s85, s37, s89
    s_bfe_u32 s37, s39, 0x10003
    s_lshl_b32 s37, s37, 11
    s_add_u32 s85, s37, s85
    s_bfe_u32 s37, s39, 0x40004
    s_lshl_b32 s37, s37, 16
    s_add_u32 s85, s37, s85
    s_waitcnt vmcnt(6)
    buffer_load_dwordx4 v[240:243], v76, s[52:55], s85 offen offset:0 nt
    s_waitcnt vmcnt(6)
    buffer_load_dwordx4 v[244:247], v77, s[52:55], s85 offen offset:0 nt
    s_waitcnt vmcnt(6)
    buffer_load_dwordx4 v[248:251], v76, s[52:55], s85 offen offset:1024 nt
    s_waitcnt vmcnt(6)
    buffer_load_dwordx4 v[252:255], v77, s[52:55], s85 offen offset:1024 nt
    s_add_u32 s87, s87, 7
    s_add_u32 s39, s87, s88
    s_bfe_u32 s37, s39, 0x30000
    s_lshl_b32 s37, s37, 12
    s_add_u32 s85, s37, s89
    s_bfe_u32 s37, s39, 0x10003
    s_lshl_b32 s37, s37, 11
    s_add_u32 s85, s37, s85
    s_bfe_u32 s37, s39, 0x40004
    s_lshl_b32 s37, s37, 16
    s_add_u32 s85, s37, s85
    s_waitcnt vmcnt(6)
    buffer_load_dwordx4 a[0:3], v76, s[52:55], s85 offen offset:0 nt
    s_waitcnt vmcnt(6)
    buffer_load_dwordx4 a[4:7], v77, s[52:55], s85 offen offset:0 nt
    buffer_load_dwordx4 v[68:71], v78, s[48:51], s91 offen offset:0 sc1
    buffer_load_dwordx4 v[72:75], v78, s[48:51], s91 offen offset:16 sc1
    s_waitcnt vmcnt(8)
    buffer_load_dwordx4 a[8:11], v76, s[52:55], s85 offen offset:1024 nt
    s_waitcnt vmcnt(8)
    buffer_load_dwordx4 a[12:15], v77, s[52:55], s85 offen offset:1024 nt
    s_add_u32 s87, s87, 7
    s_add_u32 s39, s87, s88
    s_bfe_u32 s37, s39, 0x30000
    s_lshl_b32 s37, s37, 12
    s_add_u32 s85, s37, s89
    s_bfe_u32 s37, s39, 0x10003
    s_lshl_b32 s37, s37, 11
    s_add_u32 s85, s37, s85
    s_bfe_u32 s37, s39, 0x40004
    s_lshl_b32 s37, s37, 16
    s_add_u32 s85, s37, s85
    s_waitcnt vmcnt(8)
    buffer_load_dwordx4 a[16:19], v76, s[52:55], s85 offen offset:0 nt
    s_waitcnt vmcnt(8)
    buffer_load_dwordx4 a[20:23], v77, s[52:55], s85 offen offset:0 nt
    s_waitcnt vmcnt(8)
    buffer_load_dwordx4 a[24:27], v76, s[52:55], s85 offen offset:1024 nt
    s_waitcnt vmcnt(8)
    buffer_load_dwordx4 a[28:31], v77, s[52:55], s85 offen offset:1024 nt
    s_add_u32 s87, s87, 7
    s_add_u32 s39, s87, s88
    s_bfe_u32 s37, s39, 0x30000
    s_lshl_b32 s37, s37, 12
    s_add_u32 s85, s37, s89
    s_bfe_u32 s37, s39, 0x10003
    s_lshl_b32 s37, s37, 11
    s_add_u32 s85, s37, s85
    s_bfe_u32 s37, s39, 0x40004
    s_lshl_b32 s37, s37, 16
    s_add_u32 s85, s37, s85
    s_waitcnt lgkmcnt(0)
    s_add_u32 s35, s35, 0x5b
    s_and_b32 s35, s35, 0xff
    v_mov_b32 v8, s35
    s_waitcnt vmcnt(6)
L_qcheck_1:
    v_xor_b32 v68, s35, v68
    v_xor_b32 v69, s35, v69
    v_xor_b32 v70, s35, v70
    v_xor_b32 v71, s35, v71
    v_xor_b32 v72, s35, v72
    v_xor_b32 v73, s35, v73
    v_xor_b32 v74, s35, v74
    v_xor_b32 v75, s35, v75
    v_or_b32 v4, v68, v69
    v_or3_b32 v4, v4, v70, v71
    v_or3_b32 v4, v4, v72, v73
    v_or3_b32 v4, v4, v74, v75
    v_and_b32 v4, 0xff, v4
    v_cmp_ne_u32 vcc, 0, v4
    s_cbranch_vccz L_qok_2
    buffer_load_dwordx4 v[68:71], v78, s[48:51], s91 offen offset:0 sc1
    buffer_load_dwordx4 v[72:75], v78, s[48:51], s91 offen offset:16 sc1
    s_waitcnt vmcnt(0)
    s_sub_u32 s84, s84, 1
    s_cmp_lg_u32 s84, 0
    s_cbranch_scc1 L_qcheck_1
    s_branch L_end
L_qok_2:
    v_cvt_pk_bf16_f32 v68, v68, v69
    v_cvt_pk_bf16_f32 v69, v70, v71
    v_cvt_pk_bf16_f32 v70, v72, v73
    v_cvt_pk_bf16_f32 v71, v74, v75
    s_mov_b32 vcc_lo, 0xf000f
    s_mov_b32 vcc_hi, 0xf000f
    v_cndmask_b32 v80, 0, v68, vcc
    v_cndmask_b32 v81, 0, v69, vcc
    v_cndmask_b32 v82, 0, v70, vcc
    v_cndmask_b32 v83, 0, v71, vcc
    s_mov_b32 vcc_lo, 0xf000f0
    s_mov_b32 vcc_hi, 0xf000f0
    v_cndmask_b32 v84, 0, v68, vcc
    v_cndmask_b32 v85, 0, v69, vcc
    v_cndmask_b32 v86, 0, v70, vcc
    v_cndmask_b32 v87, 0, v71, vcc
    s_mov_b32 vcc_lo, 0xf000f00
    s_mov_b32 vcc_hi, 0xf000f00
    v_cndmask_b32 v88, 0, v68, vcc
    v_cndmask_b32 v89, 0, v69, vcc
    v_cndmask_b32 v90, 0, v70, vcc
    v_cndmask_b32 v91, 0, v71, vcc
    s_mov_b32 vcc_lo, 0xf000f000
    s_mov_b32 vcc_hi, 0xf000f000
    v_cndmask_b32 v92, 0, v68, vcc
    v_cndmask_b32 v93, 0, v69, vcc
    v_cndmask_b32 v94, 0, v70, vcc
    v_cndmask_b32 v95, 0, v71, vcc
    v_mov_b32 v65, 0xff7f0000
    s_lshl_b32 s38, s34, 14
    s_add_u32 s38, s38, 16384
    v_lshl_add_u32 v64, v1, 2, s38
    buffer_load_dwordx4 a[32:35], v76, s[52:55], s85 offen offset:0 nt
    v_mfma_f32_16x16x32_bf16 v[112:115], v[128:131], v[80:83], 0
    v_mfma_f32_16x16x32_bf16 v[112:115], v[132:135], v[84:87], v[112:115]
    v_mfma_f32_16x16x32_bf16 v[112:115], v[136:139], v[88:91], v[112:115]
    s_waitcnt vmcnt(6)
    buffer_load_dwordx4 a[36:39], v77, s[52:55], s85 offen offset:0 nt
    v_mfma_f32_16x16x32_bf16 v[112:115], v[140:143], v[92:95], v[112:115]
    v_mfma_f32_16x16x32_bf16 v[96:99], v[144:147], v[80:83], 0
    v_mfma_f32_16x16x32_bf16 v[96:99], v[148:151], v[84:87], v[96:99]
    s_waitcnt vmcnt(6)
    buffer_load_dwordx4 a[40:43], v76, s[52:55], s85 offen offset:1024 nt
    v_mfma_f32_16x16x32_bf16 v[96:99], v[152:155], v[88:91], v[96:99]
    s_nop 2
    v_mov_b32_dpp v122, v112 quad_perm:[0,0,0,0] row_mask:0xf bank_mask:0xf
    v_mov_b32_dpp v124, v114 quad_perm:[2,2,2,2] row_mask:0xf bank_mask:0xf
    s_nop 0
    v_add_f32_dpp v122, v113, v122 quad_perm:[1,1,1,1] row_mask:0xf bank_mask:0xf
    v_add_f32_dpp v124, v115, v124 quad_perm:[3,3,3,3] row_mask:0xf bank_mask:0xf
    v_add_f32 v122, v122, v124
    v_max_f32 v65, v65, v122
    ds_write_b32 v64, v122 offset:0
    v_mfma_f32_16x16x32_bf16 v[96:99], v[156:159], v[92:95], v[96:99]
    v_mfma_f32_16x16x32_bf16 v[112:115], v[160:163], v[80:83], 0
    v_mfma_f32_16x16x32_bf16 v[112:115], v[164:167], v[84:87], v[112:115]
    s_waitcnt vmcnt(6)
    buffer_load_dwordx4 a[44:47], v77, s[52:55], s85 offen offset:1024 nt
    s_add_u32 s87, s87, 7
    s_add_u32 s39, s87, s88
    s_bfe_u32 s37, s39, 0x30000
    s_lshl_b32 s37, s37, 12
    s_add_u32 s85, s37, s89
    s_bfe_u32 s37, s39, 0x10003
    s_lshl_b32 s37, s37, 11
    s_add_u32 s85, s37, s85
    s_bfe_u32 s37, s39, 0x40004
    s_lshl_b32 s37, s37, 16
    s_add_u32 s85, s37, s85
    v_mfma_f32_16x16x32_bf16 v[112:115], v[168:171], v[88:91], v[112:115]
    v_mov_b32_dpp v122, v96 quad_perm:[0,0,0,0] row_mask:0xf bank_mask:0xf
    v_mov_b32_dpp v124, v98 quad_perm:[2,2,2,2] row_mask:0xf bank_mask:0xf
    s_nop 0
    v_add_f32_dpp v122, v97, v122 quad_perm:[1,1,1,1] row_mask:0xf bank_mask:0xf
    v_add_f32_dpp v124, v99, v124 quad_perm:[3,3,3,3] row_mask:0xf bank_mask:0xf
    v_add_f32 v122, v122, v124
    v_max_f32 v65, v65, v122
    ds_write_b32 v64, v122 offset:256
    v_mfma_f32_16x16x32_bf16 v[112:115], v[172:175], v[92:95], v[112:115]
    v_mfma_f32_16x16x32_bf16 v[96:99], v[176:179], v[80:83], 0
    s_waitcnt vmcnt(6)
    buffer_load_dwordx4 a[48:51], v76, s[52:55], s85 offen offset:0 nt
    v_mfma_f32_16x16x32_bf16 v[96:99], v[180:183], v[84:87], v[96:99]
    v_mfma_f32_16x16x32_bf16 v[96:99], v[184:187], v[88:91], v[96:99]
    s_nop 2
    v_mov_b32_dpp v122, v112 quad_perm:[0,0,0,0] row_mask:0xf bank_mask:0xf
    v_mov_b32_dpp v124, v114 quad_perm:[2,2,2,2] row_mask:0xf bank_mask:0xf
    s_nop 0
    v_add_f32_dpp v122, v113, v122 quad_perm:[1,1,1,1] row_mask:0xf bank_mask:0xf
    v_add_f32_dpp v124, v115, v124 quad_perm:[3,3,3,3] row_mask:0xf bank_mask:0xf
    v_add_f32 v122, v122, v124
    v_max_f32 v65, v65, v122
    ds_write_b32 v64, v122 offset:512
    v_mfma_f32_16x16x32_bf16 v[96:99], v[188:191], v[92:95], v[96:99]
    v_mfma_f32_16x16x32_bf16 v[112:115], v[192:195], v[80:83], 0
    s_waitcnt vmcnt(6)
    buffer_load_dwordx4 a[52:55], v77, s[52:55], s85 offen offset:0 nt
    v_mfma_f32_16x16x32_bf16 v[112:115], v[196:199], v[84:87], v[112:115]
    v_mfma_f32_16x16x32_bf16 v[112:115], v[200:203], v[88:91], v[112:115]
    s_nop 2
    v_mov_b32_dpp v122, v96 quad_perm:[0,0,0,0] row_mask:0xf bank_mask:0xf
    v_mov_b32_dpp v124, v98 quad_perm:[2,2,2,2] row_mask:0xf bank_mask:0xf
    s_nop 0
    v_add_f32_dpp v122, v97, v122 quad_perm:[1,1,1,1] row_mask:0xf bank_mask:0xf
    v_add_f32_dpp v124, v99, v124 quad_perm:[3,3,3,3] row_mask:0xf bank_mask:0xf
    v_add_f32 v122, v122, v124
    v_max_f32 v65, v65, v122
    ds_write_b32 v64, v122 offset:768
    v_mfma_f32_16x16x32_bf16 v[112:115], v[204:207], v[92:95], v[112:115]
    s_waitcnt vmcnt(6)
    buffer_load_dwordx4 a[56:59], v76, s[52:55], s85 offen offset:1024 nt
    v_mfma_f32_16x16x32_bf16 v[96:99], v[208:211], v[80:83], 0
    v_mfma_f32_16x16x32_bf16 v[96:99], v[212:215], v[84:87], v[96:99]
    v_mfma_f32_16x16x32_bf16 v[96:99], v[216:219], v[88:91], v[96:99]
    s_nop 2
    v_mov_b32_dpp v122, v112 quad_perm:[0,0,0,0] row_mask:0xf bank_mask:0xf
    v_mov_b32_dpp v124, v114 quad_perm:[2,2,2,2] row_mask:0xf bank_mask:0xf
    s_nop 0
    v_add_f32_dpp v122, v113, v122 quad_perm:[1,1,1,1] row_mask:0xf bank_mask:0xf
    v_add_f32_dpp v124, v115, v124 quad_perm:[3,3,3,3] row_mask:0xf bank_mask:0xf
    v_add_f32 v122, v122, v124
    v_max_f32 v65, v65, v122
    ds_write_b32 v64, v122 offset:1024
    v_mfma_f32_16x16x32_bf16 v[96:99], v[220:223], v[92:95], v[96:99]
    s_waitcnt vmcnt(6)
    buffer_load_dwordx4 a[60:63], v77, s[52:55], s85 offen offset:1024 nt
    s_add_u32 s87, s87, 7
    s_add_u32 s39, s87, s88
    s_bfe_u32 s37, s39, 0x30000
    s_lshl_b32 s37, s37, 12
    s_add_u32 s85, s37, s89
    s_bfe_u32 s37, s39, 0x10003
    s_lshl_b32 s37, s37, 11
    s_add_u32 s85, s37, s85
    s_bfe_u32 s37, s39, 0x40004
    s_lshl_b32 s37, s37, 16
    s_add_u32 s85, s37, s85
    v_mfma_f32_16x16x32_bf16 v[112:115], v[224:227], v[80:83], 0
    s_sub_u32 s36, s33, 3
    s_and_b32 s37, s33, 3
    s_cmp_lt_u32 s36, 4
    s_cselect_b64 s[40:41], s[24:25], s[14:15]
    s_cselect_b32 s36, s36, s37
    s_cselect_b32 s45, 262144, 0
    s_cselect_b32 s46, 8388608, 0
    s_add_u32 s45, s45, 524288
    s_add_u32 s46, s46, 196608
    s_mov_b32 s42, 4194304
    s_mov_b32 s43, 0x20000
    s_lshl_b32 s38, s32, 17
    s_add_u32 s44, s38, 0
    s_lshl_b32 s38, s34, 15
    s_add_u32 s44, s38, s44
    s_lshl_b32 s38, s36, 8
    s_add_u32 s44, s38, s44
    s_lshl_b32 s38, s36, 16
    s_add_u32 s45, s38, s45
    s_lshr_b32 s38, s34, 1
    s_lshl_b32 s38, s38, 15
    s_add_u32 s45, s38, s45
    s_lshl_b32 s38, s32, 8
    s_add_u32 s45, s38, s45
    s_bfe_u32 s38, s34, 0x10000
    s_lshl_b32 s38, s38, 7
    s_add_u32 s45, s38, s45
    s_lshl_b32 s38, s32, 11
    s_add_u32 s46, s38, s46
    s_lshl_b32 s38, s34, 9
    s_add_u32 s46, s38, s46
    s_mov_b32 s72, s26
    s_and_b32 s73, s27, 0xffff
    s_mov_b32 s74, 8192
    s_mov_b32 s75, 0x20000
    v_mfma_f32_16x16x32_bf16 v[112:115], v[228:231], v[84:87], v[112:115]
    v_mfma_f32_16x16x32_bf16 v[112:115], v[232:235], v[88:91], v[112:115]
    v_mov_b32_dpp v122, v96 quad_perm:[0,0,0,0] row_mask:0xf bank_mask:0xf
    v_mov_b32_dpp v124, v98 quad_perm:[2,2,2,2] row_mask:0xf bank_mask:0xf
    s_nop 0
    v_add_f32_dpp v122, v97, v122 quad_perm:[1,1,1,1] row_mask:0xf bank_mask:0xf
    v_add_f32_dpp v124, v99, v124 quad_perm:[3,3,3,3] row_mask:0xf bank_mask:0xf
    v_add_f32 v122, v122, v124
    v_max_f32 v65, v65, v122
    ds_write_b32 v64, v122 offset:1280
    s_waitcnt vmcnt(5)
    buffer_load_dwordx4 v[128:131], v76, s[52:55], s85 offen offset:0 nt
    v_mfma_f32_16x16x32_bf16 v[112:115], v[236:239], v[92:95], v[112:115]
    v_mfma_f32_16x16x32_bf16 v[96:99], v[240:243], v[80:83], 0
    v_mfma_f32_16x16x32_bf16 v[96:99], v[244:247], v[84:87], v[96:99]
    s_waitcnt vmcnt(5)
    buffer_load_dwordx4 v[132:135], v77, s[52:55], s85 offen offset:0 nt
    v_mfma_f32_16x16x32_bf16 v[96:99], v[248:251], v[88:91], v[96:99]
    s_nop 2
    v_mov_b32_dpp v122, v112 quad_perm:[0,0,0,0] row_mask:0xf bank_mask:0xf
    v_mov_b32_dpp v124, v114 quad_perm:[2,2,2,2] row_mask:0xf bank_mask:0xf
    s_nop 0
    v_add_f32_dpp v122, v113, v122 quad_perm:[1,1,1,1] row_mask:0xf bank_mask:0xf
    v_add_f32_dpp v124, v115, v124 quad_perm:[3,3,3,3] row_mask:0xf bank_mask:0xf
    v_add_f32 v122, v122, v124
    v_max_f32 v65, v65, v122
    ds_write_b32 v64, v122 offset:1536
    v_lshlrev_b32 v4, 2, v2
    v_xor_b32 v4, v4, v3
    v_xor_b32 v5, 0, v4
    v_lshlrev_b32 v5, 4, v5
    v_lshl_add_u32 v20, v2, 10, v5
    v_xor_b32 v5, 1, v4
    v_lshlrev_b32 v5, 4, v5
    v_lshl_add_u32 v21, v2, 10, v5
    v_add_u32 v21, 3072, v21
    v_xor_b32 v5, 2, v4
    v_lshlrev_b32 v5, 4, v5
    v_lshl_add_u32 v22, v2, 10, v5
    v_add_u32 v22, 6144, v22
    v_xor_b32 v5, 3, v4
    v_lshlrev_b32 v5, 4, v5
    v_lshl_add_u32 v23, v2, 10, v5
    v_add_u32 v23, 9216, v23
    s_lshl_b32 s38, s32, 15
    s_add_u32 s47, s38, 1048576
    s_lshl_b32 s38, s3, 13
    s_add_u32 s47, s38, s47
    s_mul_i32 s38, s3, 320
    s_add_u32 s38, s38, 135168
    v_lshlrev_b32 v4, 6, v2
    v_lshl_add_u32 v4, v3, 1, v4
    v_add_u32 v31, s38, v4
    v_mfma_f32_16x16x32_bf16 v[96:99], v[252:255], v[92:95], v[96:99]
    v_mfma_f32_16x16x32_bf16 v[112:115], a[0:3], v[80:83], 0
    v_mfma_f32_16x16x32_bf16 v[112:115], a[4:7], v[84:87], v[112:115]
    s_waitcnt vmcnt(5)
    buffer_load_dwordx4 v[136:139], v76, s[52:55], s85 offen offset:1024 nt
    v_mfma_f32_16x16x32_bf16 v[112:115], a[8:11], v[88:91], v[112:115]
    s_nop 2
    v_mov_b32_dpp v122, v96 quad_perm:[0,0,0,0] row_mask:0xf bank_mask:0xf
    v_mov_b32_dpp v124, v98 quad_perm:[2,2,2,2] row_mask:0xf bank_mask:0xf
    s_nop 0
    v_add_f32_dpp v122, v97, v122 quad_perm:[1,1,1,1] row_mask:0xf bank_mask:0xf
    v_add_f32_dpp v124, v99, v124 quad_perm:[3,3,3,3] row_mask:0xf bank_mask:0xf
    v_add_f32 v122, v122, v124
    v_max_f32 v65, v65, v122
    ds_write_b32 v64, v122 offset:1792
    v_mfma_f32_16x16x32_bf16 v[112:115], a[12:15], v[92:95], v[112:115]
    v_mfma_f32_16x16x32_bf16 v[96:99], a[16:19], v[80:83], 0
    v_lshlrev_b32 v4, 11, v2
    v_bfe_u32 v5, v1, 2, 2
    v_lshl_add_u32 v4, v5, 8, v4
    v_bfe_u32 v5, v1, 2, 2
    v_lshl_add_u32 v4, v5, 6, v4
    v_bfe_u32 v5, v1, 4, 1
    v_lshl_add_u32 v4, v5, 5, v4
    v_bfe_u32 v5, v1, 1, 1
    v_lshl_add_u32 v4, v5, 4, v4
    v_bfe_u32 v5, v1, 0, 1
    v_lshl_add_u32 v4, v5, 3, v4
    s_lshl_b32 s38, s34, 6
    s_add_u32 s38, s38, 98304
    v_xor_b32 v24, s38, v4
    v_xor_b32 v25, 16, v24
    v_xor_b32 v26, 32, v24
    v_xor_b32 v27, 48, v24
    v_and_b32 v4, 3, v3
    v_lshrrev_b32 v5, 2, v3
    v_lshlrev_b32 v6, 4, v2
    v_add_u32 v6, 135168, v6
    s_movk_i32 s36, 320
    v_cmp_eq_u32 vcc, 0, v5
    s_nop 1
    v_cndmask_b32 v28, 4, v4, vcc
    v_mad_u32_u24 v28, v28, s36, v6
    v_cmp_eq_u32 vcc, 1, v5
    s_nop 1
    v_cndmask_b32 v29, 4, v4, vcc
    v_mad_u32_u24 v29, v29, s36, v6
    v_lshlrev_b32 v5, 2, v1
    v_add_u32 v5, 136448, v5
    v_mov_b32 v6, 0
    ds_write_b32 v5, v6
    s_waitcnt vmcnt(5)
    buffer_load_dwordx4 v[140:143], v77, s[52:55], s85 offen offset:1024 nt
    s_add_u32 s87, s87, 7
    s_add_u32 s39, s87, s88
    s_bfe_u32 s37, s39, 0x30000
    s_lshl_b32 s37, s37, 12
    s_add_u32 s85, s37, s89
    s_bfe_u32 s37, s39, 0x10003
    s_lshl_b32 s37, s37, 11
    s_add_u32 s85, s37, s85
    s_bfe_u32 s37, s39, 0x40004
    s_lshl_b32 s37, s37, 16
    s_add_u32 s85, s37, s85
    v_mfma_f32_16x16x32_bf16 v[96:99], a[20:23], v[84:87], v[96:99]
    v_mfma_f32_16x16x32_bf16 v[96:99], a[24:27], v[88:91], v[96:99]
    v_mov_b32_dpp v122, v112 quad_perm:[0,0,0,0] row_mask:0xf bank_mask:0xf
    v_mov_b32_dpp v124, v114 quad_perm:[2,2,2,2] row_mask:0xf bank_mask:0xf
    s_nop 0
    v_add_f32_dpp v122, v113, v122 quad_perm:[1,1,1,1] row_mask:0xf bank_mask:0xf
    v_add_f32_dpp v124, v115, v124 quad_perm:[3,3,3,3] row_mask:0xf bank_mask:0xf
    v_add_f32 v122, v122, v124
    v_max_f32 v65, v65, v122
    ds_write_b32 v64, v122 offset:2048
    v_mfma_f32_16x16x32_bf16 v[96:99], a[28:31], v[92:95], v[96:99]
    v_mfma_f32_16x16x32_bf16 v[112:115], a[32:35], v[80:83], 0
    s_waitcnt vmcnt(5)
    buffer_load_dwordx4 v[144:147], v76, s[52:55], s85 offen offset:0 nt
    v_mfma_f32_16x16x32_bf16 v[112:115], a[36:39], v[84:87], v[112:115]
    v_mfma_f32_16x16x32_bf16 v[112:115], a[40:43], v[88:91], v[112:115]
    s_nop 2
    v_mov_b32_dpp v122, v96 quad_perm:[0,0,0,0] row_mask:0xf bank_mask:0xf
    v_mov_b32_dpp v124, v98 quad_perm:[2,2,2,2] row_mask:0xf bank_mask:0xf
    s_nop 0
    v_add_f32_dpp v122, v97, v122 quad_perm:[1,1,1,1] row_mask:0xf bank_mask:0xf
    v_add_f32_dpp v124, v99, v124 quad_perm:[3,3,3,3] row_mask:0xf bank_mask:0xf
    v_add_f32 v122, v122, v124
    v_max_f32 v65, v65, v122
    ds_write_b32 v64, v122 offset:2304
    v_lshlrev_b32 v30, 4, v3
    v_lshl_add_u32 v30, v2, 13, v30
    s_lshl_b32 s38, s32, 13
    s_add_u32 s36, s38, 0
    s_lshl_b32 s38, s34, 6
    s_add_u32 s36, s38, s36
    v_lshrrev_b32 v5, 2, v1
    v_lshlrev_b32 v32, 8, v5
    v_bfe_u32 v5, v1, 0, 2
    v_lshl_add_u32 v32, v5, 4, v32
    v_add_u32 v32, s36, v32
    s_lshr_b32 s38, s32, 2
    s_lshl_b32 s38, s38, 7
    s_add_u32 s36, s38, 0
    s_lshl_b32 s38, s34, 5
    s_add_u32 s36, s38, s36
    s_bfe_u32 s38, s32, 0x20000
    s_lshl_b32 s38, s38, 3
    s_add_u32 s36, s38, s36
    v_bfe_u32 v5, v1, 0, 2
    v_lshlrev_b32 v33, 11, v5
    v_lshl_add_u32 v33, v2, 1, v33
    v_add_u32 v33, s36, v33
    v_and_b32 v5, 31, v1
    v_lshlrev_b32 v34, 4, v5
    s_mul_i32 s38, s34, 320
    s_add_u32 s38, s38, 135168
    v_lshl_add_u32 v35, v5, 3, s38
    v_mfma_f32_16x16x32_bf16 v[112:115], a[44:47], v[92:95], v[112:115]
    s_waitcnt vmcnt(5)
    buffer_load_dwordx4 v[148:151], v77, s[52:55], s85 offen offset:0 nt
    v_mfma_f32_16x16x32_bf16 v[96:99], a[48:51], v[80:83], 0
    v_mfma_f32_16x16x32_bf16 v[96:99], a[52:55], v[84:87], v[96:99]
    v_mfma_f32_16x16x32_bf16 v[96:99], a[56:59], v[88:91], v[96:99]
    s_nop 2
    v_mov_b32_dpp v122, v112 quad_perm:[0,0,0,0] row_mask:0xf bank_mask:0xf
    v_mov_b32_dpp v124, v114 quad_perm:[2,2,2,2] row_mask:0xf bank_mask:0xf
    s_nop 0
    v_add_f32_dpp v122, v113, v122 quad_perm:[1,1,1,1] row_mask:0xf bank_mask:0xf
    v_add_f32_dpp v124, v115, v124 quad_perm:[3,3,3,3] row_mask:0xf bank_mask:0xf
    v_add_f32 v122, v122, v124
    v_max_f32 v65, v65, v122
    ds_write_b32 v64, v122 offset:2560
    v_mfma_f32_16x16x32_bf16 v[96:99], a[60:63], v[92:95], v[96:99]
    v_add_u32 v64, 2816, v64
    s_mov_b32 s97, 10
    s_mov_b32 s86, 32
    s_mov_b32 s66, 134217728
    s_mov_b32 s67, 0x20000
    s_mov_b64 s[64:65], s[52:53]
    v_mov_b32 v62, v76
    v_mov_b32 v63, v77
L_bloop:
    s_waitcnt vmcnt(5)
    buffer_load_dwordx4 v[152:155], v62, s[64:67], s85 offen offset:1024 nt
    v_mfma_f32_16x16x32_bf16 v[112:115], v[128:131], v[80:83], 0
    s_waitcnt vmcnt(5)
    buffer_load_dwordx4 v[156:159], v63, s[64:67], s85 offen offset:1024 nt
    v_mfma_f32_16x16x32_bf16 v[112:115], v[132:135], v[84:87], v[112:115]
    s_add_u32 s87, s87, 7
    s_cmp_lg_u32 s97, 1
    s_cbranch_scc1 L_stayk_3
    s_mov_b64 s[64:65], s[56:57]
    v_mov_b32 v62, v126
    v_mov_b32 v63, v127
    s_mul_i32 s37, s86, 7
    s_sub_u32 s87, s87, s37
L_stayk_3:
    s_add_u32 s39, s87, s88
    s_bfe_u32 s37, s39, 0x30000
    s_lshl_b32 s37, s37, 12
    s_add_u32 s85, s37, s89
    s_bfe_u32 s37, s39, 0x10003
    s_lshl_b32 s37, s37, 11
    s_add_u32 s85, s37, s85
    s_bfe_u32 s37, s39, 0x40004
    s_lshl_b32 s37, s37, 16
    s_add_u32 s85, s37, s85
    v_mov_b32_dpp v122, v96 quad_perm:[0,0,0,0] row_mask:0xf bank_mask:0xf
    v_mov_b32_dpp v124, v98 quad_perm:[2,2,2,2] row_mask:0xf bank_mask:0xf
    s_nop 0
    v_add_f32_dpp v122, v97, v122 quad_perm:[1,1,1,1] row_mask:0xf bank_mask:0xf
    v_add_f32_dpp v124, v99, v124 quad_perm:[3,3,3,3] row_mask:0xf bank_mask:0xf
    v_add_f32 v122, v122, v124
    v_max_f32 v65, v65, v122
    ds_write_b32 v64, v122 offset:0
    s_waitcnt vmcnt(5)
    buffer_load_dwordx4 v[128:131], v62, s[64:67], s85 offen offset:0 nt
    v_mfma_f32_16x16x32_bf16 v[112:115], v[136:139], v[88:91], v[112:115]
    s_waitcnt vmcnt(5)
    buffer_load_dwordx4 v[132:135], v63, s[64:67], s85 offen offset:0 nt
    v_mfma_f32_16x16x32_bf16 v[112:115], v[140:143], v[92:95], v[112:115]
    s_waitcnt vmcnt(5)
    buffer_load_dwordx4 v[136:139], v62, s[64:67], s85 offen offset:1024 nt
    v_mfma_f32_16x16x32_bf16 v[96:99], v[144:147], v[80:83], 0
    s_waitcnt vmcnt(5)
    buffer_load_dwordx4 v[140:143], v63, s[64:67], s85 offen offset:1024 nt
    v_mfma_f32_16x16x32_bf16 v[96:99], v[148:151], v[84:87], v[96:99]
    s_add_u32 s87, s87, 7
    s_add_u32 s39, s87, s88
    s_bfe_u32 s37, s39, 0x30000
    s_lshl_b32 s37, s37, 12
    s_add_u32 s85, s37, s89
    s_bfe_u32 s37, s39, 0x10003
    s_lshl_b32 s37, s37, 11
    s_add_u32 s85, s37, s85
    s_bfe_u32 s37, s39, 0x40004
    s_lshl_b32 s37, s37, 16
    s_add_u32 s85, s37, s85
    v_mov_b32_dpp v122, v112 quad_perm:[0,0,0,0] row_mask:0xf bank_mask:0xf
    v_mov_b32_dpp v124, v114 quad_perm:[2,2,2,2] row_mask:0xf bank_mask:0xf
    s_nop 0
    v_add_f32_dpp v122, v113, v122 quad_perm:[1,1,1,1] row_mask:0xf bank_mask:0xf
    v_add_f32_dpp v124, v115, v124 quad_perm:[3,3,3,3] row_mask:0xf bank_mask:0xf
    v_add_f32 v122, v122, v124
    v_max_f32 v65, v65, v122
    ds_write_b32 v64, v122 offset:256
    s_waitcnt vmcnt(5)
    buffer_load_dwordx4 v[144:147], v62, s[64:67], s85 offen offset:0 nt
    v_mfma_f32_16x16x32_bf16 v[96:99], v[152:155], v[88:91], v[96:99]
    s_waitcnt vmcnt(5)
    buffer_load_dwordx4 v[148:151], v63, s[64:67], s85 offen offset:0 nt
    v_mfma_f32_16x16x32_bf16 v[96:99], v[156:159], v[92:95], v[96:99]
    v_add_u32 v64, 512, v64
    s_sub_u32 s97, s97, 1
    s_cmp_lg_u32 s97, 0
    s_cbranch_scc1 L_bloop
    s_nop 3
    v_mov_b32_dpp v122, v96 quad_perm:[0,0,0,0] row_mask:0xf bank_mask:0xf
    v_mov_b32_dpp v124, v98 quad_perm:[2,2,2,2] row_mask:0xf bank_mask:0xf
    s_nop 0
    v_add_f32_dpp v122, v97, v122 quad_perm:[1,1,1,1] row_mask:0xf bank_mask:0xf
    v_add_f32_dpp v124, v99, v124 quad_perm:[3,3,3,3] row_mask:0xf bank_mask:0xf
    v_add_f32 v122, v122, v124
    v_max_f32 v65, v65, v122
    ds_write_b32 v64, v122 offset:0
    v_mov_b32 v123, 0xff7f0000
    ds_write_b32 v64, v123 offset:256
    s_lshl_b32 s38, s34, 14
    s_add_u32 s38, s38, 16384
    v_lshl_add_u32 v64, v1, 2, s38
    ds_read_b32 v66, v64
    ds_read_b32 v67, v64 offset:256
    v_mul_f32 v65, s83, v65
    s_nop 1
    v_max_f32_dpp v124, v65, v65 row_ror:4 row_mask:0xf bank_mask:0xf
    s_nop 1
    v_max_f32_dpp v124, v124, v124 row_ror:8 row_mask:0xf bank_mask:0xf
    v_mov_b32 v125, v124
    s_nop 1
    v_permlane16_swap_b32 v124, v125
    v_max_f32 v124, v124, v125
    v_mov_b32 v125, v124
    s_nop 1
    v_permlane32_swap_b32 v124, v125
    v_max_f32 v124, v124, v125
    v_and_b32 v120, s82, v124
    s_lshr_b32 s97, s86, 1
    s_waitcnt lgkmcnt(1)
    v_fma_f32 v123, v66, s83, -v120
    v_exp_f32 v123, v123
    ds_read_b32 v66, v64 offset:512
    v_cvt_pk_bf16_f32 v100, v123, v123
    v_add_f32 v121, v121, v123
L_vloop:
    s_nop 0
    v_and_b32_dpp v104, v100, v10 row_newbcast:0 row_mask:0xf bank_mask:0xf
    v_and_b32_dpp v105, v100, v11 row_newbcast:0 row_mask:0xf bank_mask:0xf
    v_and_b32_dpp v106, v100, v12 row_newbcast:0 row_mask:0xf bank_mask:0xf
    v_and_b32_dpp v107, v100, v13 row_newbcast:0 row_mask:0xf bank_mask:0xf
    s_waitcnt vmcnt(5)
    buffer_load_dwordx4 v[152:155], v62, s[64:67], s85 offen offset:1024 nt
    v_mfma_f32_16x16x32_bf16 v[116:119], v[128:131], v[104:107], v[116:119]
    v_and_b32_dpp v108, v100, v10 row_newbcast:4 row_mask:0xf bank_mask:0xf
    v_and_b32_dpp v109, v100, v11 row_newbcast:4 row_mask:0xf bank_mask:0xf
    v_and_b32_dpp v110, v100, v12 row_newbcast:4 row_mask:0xf bank_mask:0xf
    v_and_b32_dpp v111, v100, v13 row_newbcast:4 row_mask:0xf bank_mask:0xf
    s_waitcnt vmcnt(5)
    buffer_load_dwordx4 v[156:159], v63, s[64:67], s85 offen offset:1024 nt
    v_mfma_f32_16x16x32_bf16 v[116:119], v[132:135], v[108:111], v[116:119]
    s_add_u32 s87, s87, 7
    s_cmp_lg_u32 s97, 1
    s_cbranch_scc1 L_stayv_4
    s_mov_b64 s[64:65], s[52:53]
    v_mov_b32 v62, v76
    v_mov_b32 v63, v77
    s_mov_b64 exec, 1
    global_atomic_add v19, v9, v18, s[30:31] sc0 sc1
    s_mov_b64 exec, -1
    s_add_u32 s87, s33, 224
L_stayv_4:
    s_add_u32 s39, s87, s88
    s_bfe_u32 s37, s39, 0x30000
    s_lshl_b32 s37, s37, 12
    s_add_u32 s85, s37, s89
    s_bfe_u32 s37, s39, 0x10003
    s_lshl_b32 s37, s37, 11
    s_add_u32 s85, s37, s85
    s_bfe_u32 s37, s39, 0x40004
    s_lshl_b32 s37, s37, 16
    s_add_u32 s85, s37, s85
    s_waitcnt lgkmcnt(1)
    v_fma_f32 v123, v67, s83, -v120
    v_exp_f32 v123, v123
    ds_read_b32 v67, v64 offset:768
    v_cvt_pk_bf16_f32 v101, v123, v123
    v_add_f32 v121, v121, v123
    v_and_b32_dpp v104, v100, v10 row_newbcast:8 row_mask:0xf bank_mask:0xf
    v_and_b32_dpp v105, v100, v11 row_newbcast:8 row_mask:0xf bank_mask:0xf
    v_and_b32_dpp v106, v100, v12 row_newbcast:8 row_mask:0xf bank_mask:0xf
    v_and_b32_dpp v107, v100, v13 row_newbcast:8 row_mask:0xf bank_mask:0xf
    s_waitcnt vmcnt(5)
    buffer_load_dwordx4 v[128:131], v62, s[64:67], s85 offen offset:0 nt
    v_mfma_f32_16x16x32_bf16 v[116:119], v[136:139], v[104:107], v[116:119]
    v_and_b32_dpp v108, v100, v10 row_newbcast:12 row_mask:0xf bank_mask:0xf
    v_and_b32_dpp v109, v100, v11 row_newbcast:12 row_mask:0xf bank_mask:0xf
    v_and_b32_dpp v110, v100, v12 row_newbcast:12 row_mask:0xf bank_mask:0xf
    v_and_b32_dpp v111, v100, v13 row_newbcast:12 row_mask:0xf bank_mask:0xf
    s_waitcnt vmcnt(5)
    buffer_load_dwordx4 v[132:135], v63, s[64:67], s85 offen offset:0 nt
    v_mfma_f32_16x16x32_bf16 v[116:119], v[140:143], v[108:111], v[116:119]
    v_and_b32_dpp v104, v101, v10 row_newbcast:0 row_mask:0xf bank_mask:0xf
    v_and_b32_dpp v105, v101, v11 row_newbcast:0 row_mask:0xf bank_mask:0xf
    v_and_b32_dpp v106, v101, v12 row_newbcast:0 row_mask:0xf bank_mask:0xf
    v_and_b32_dpp v107, v101, v13 row_newbcast:0 row_mask:0xf bank_mask:0xf
    s_waitcnt vmcnt(5)
    buffer_load_dwordx4 v[136:139], v62, s[64:67], s85 offen offset:1024 nt
    v_mfma_f32_16x16x32_bf16 v[116:119], v[144:147], v[104:107], v[116:119]
    v_and_b32_dpp v108, v101, v10 row_newbcast:4 row_mask:0xf bank_mask:0xf
    v_and_b32_dpp v109, v101, v11 row_newbcast:4 row_mask:0xf bank_mask:0xf
    v_and_b32_dpp v110, v101, v12 row_newbcast:4 row_mask:0xf bank_mask:0xf
    v_and_b32_dpp v111, v101, v13 row_newbcast:4 row_mask:0xf bank_mask:0xf
    s_waitcnt vmcnt(5)
    buffer_load_dwordx4 v[140:143], v63, s[64:67], s85 offen offset:1024 nt
    v_mfma_f32_16x16x32_bf16 v[116:119], v[148:151], v[108:111], v[116:119]
    s_add_u32 s87, s87, 7
    s_cmp_lg_u32 s97, 1
    s_cbranch_scc1 L_stayv_5
    s_mov_b64 s[64:65], s[56:57]
    v_mov_b32 v62, v126
    v_mov_b32 v63, v127
    s_add_u32 s87, s33, 224
L_stayv_5:
    s_add_u32 s39, s87, s88
    s_bfe_u32 s37, s39, 0x30000
    s_lshl_b32 s37, s37, 12
    s_add_u32 s85, s37, s89
    s_bfe_u32 s37, s39, 0x10003
    s_lshl_b32 s37, s37, 11
    s_add_u32 s85, s37, s85
    s_bfe_u32 s37, s39, 0x40004
    s_lshl_b32 s37, s37, 16
    s_add_u32 s85, s37, s85
    v_add_u32 v64, 512, v64
    s_waitcnt lgkmcnt(1)
    v_fma_f32 v123, v66, s83, -v120
    v_exp_f32 v123, v123
    ds_read_b32 v66, v64 offset:512
    v_cvt_pk_bf16_f32 v100, v123, v123
    v_add_f32 v121, v121, v123
    v_and_b32_dpp v104, v101, v10 row_newbcast:8 row_mask:0xf bank_mask:0xf
    v_and_b32_dpp v105, v101, v11 row_newbcast:8 row_mask:0xf bank_mask:0xf
    v_and_b32_dpp v106, v101, v12 row_newbcast:8 row_mask:0xf bank_mask:0xf
    v_and_b32_dpp v107, v101, v13 row_newbcast:8 row_mask:0xf bank_mask:0xf
    s_waitcnt vmcnt(5)
    buffer_load_dwordx4 v[144:147], v62, s[64:67], s85 offen offset:0 nt
    v_mfma_f32_16x16x32_bf16 v[116:119], v[152:155], v[104:107], v[116:119]
    v_and_b32_dpp v108, v101, v10 row_newbcast:12 row_mask:0xf bank_mask:0xf
    v_and_b32_dpp v109, v101, v11 row_newbcast:12 row_mask:0xf bank_mask:0xf
    v_and_b32_dpp v110, v101, v12 row_newbcast:12 row_mask:0xf bank_mask:0xf
    v_and_b32_dpp v111, v101, v13 row_newbcast:12 row_mask:0xf bank_mask:0xf
    s_waitcnt vmcnt(5)
    buffer_load_dwordx4 v[148:151], v63, s[64:67], s85 offen offset:0 nt
    v_mfma_f32_16x16x32_bf16 v[116:119], v[156:159], v[108:111], v[116:119]
    s_sub_u32 s97, s97, 1
    s_cmp_lg_u32 s97, 0
    s_cbranch_scc1 L_vloop
    buffer_load_dwordx4 v[152:155], v126, s[56:59], s85 offen offset:1024 nt
    buffer_load_dwordx4 v[156:159], v127, s[56:59], s85 offen offset:1024 nt
L_dloop:
    s_waitcnt vmcnt(7)
    v_readfirstlane_b32 s93, v19
    v_mov_b32 v19, 25
    s_cmp_ge_u32 s93, 25
    s_cbranch_scc1 L_last0
    s_add_u32 s87, s93, 231
    s_add_u32 s39, s87, s88
    s_bfe_u32 s37, s39, 0x30000
    s_lshl_b32 s37, s37, 12
    s_add_u32 s85, s37, s89
    s_bfe_u32 s37, s39, 0x10003
    s_lshl_b32 s37, s37, 11
    s_add_u32 s85, s37, s85
    s_bfe_u32 s37, s39, 0x40004
    s_lshl_b32 s37, s37, 16
    s_add_u32 s85, s37, s85
    s_cmp_ge_u32 s93, 24
    s_cbranch_scc1 L_noclaim_6
    s_mov_b64 exec, 1
    global_atomic_add v19, v9, v18, s[30:31] sc0 sc1
    s_mov_b64 exec, -1
L_noclaim_6:
    buffer_load_dwordx4 v[160:163], v76, s[52:55], s85 offen offset:0 nt
    v_mfma_f32_16x16x32_bf16 v[112:115], v[128:131], v[80:83], 0
    s_waitcnt vmcnt(7)
    buffer_load_dwordx4 v[164:167], v77, s[52:55], s85 offen offset:0 nt
    v_mfma_f32_16x16x32_bf16 v[112:115], v[132:135], v[84:87], v[112:115]
    s_waitcnt vmcnt(7)
    buffer_load_dwordx4 v[168:171], v76, s[52:55], s85 offen offset:1024 nt
    v_mfma_f32_16x16x32_bf16 v[112:115], v[136:139], v[88:91], v[112:115]
    s_waitcnt vmcnt(7)
    buffer_load_dwordx4 v[172:175], v77, s[52:55], s85 offen offset:1024 nt
    v_mfma_f32_16x16x32_bf16 v[112:115], v[140:143], v[92:95], v[112:115]
    s_nop 7
    v_mov_b32_dpp v122, v112 quad_perm:[0,0,0,0] row_mask:0xf bank_mask:0xf
    v_mov_b32_dpp v124, v114 quad_perm:[2,2,2,2] row_mask:0xf bank_mask:0xf
    s_nop 0
    v_add_f32_dpp v122, v113, v122 quad_perm:[1,1,1,1] row_mask:0xf bank_mask:0xf
    v_add_f32_dpp v124, v115, v124 quad_perm:[3,3,3,3] row_mask:0xf bank_mask:0xf
    v_add_f32 v122, v122, v124
    v_fma_f32 v123, v122, s83, -v120
    v_cmp_lt_f32 vcc, 0, v123
    s_cbranch_vccz L_nomax_7
    v_mul_f32 v122, s83, v122
    s_nop 1
    v_max_f32_dpp v124, v122, v122 row_ror:4 row_mask:0xf bank_mask:0xf
    s_nop 1
    v_max_f32_dpp v124, v124, v124 row_ror:8 row_mask:0xf bank_mask:0xf
    v_mov_b32 v125, v124
    s_nop 1
    v_permlane16_swap_b32 v124, v125
    v_max_f32 v124, v124, v125
    v_mov_b32 v125, v124
    s_nop 1
    v_permlane32_swap_b32 v124, v125
    v_max_f32 v124, v124, v125
    v_and_b32 v124, s82, v124
    v_max_f32 v124, v124, v120
    v_sub_f32 v125, v120, v124
    v_exp_f32 v125, v125
    v_mov_b32 v120, v124
    v_sub_f32 v123, v122, v124
    v_mul_f32 v121, v121, v125
    v_mul_f32 v116, v116, v125
    v_mul_f32 v117, v117, v125
    v_mul_f32 v118, v118, v125
    v_mul_f32 v119, v119, v125
L_nomax_7:
    v_exp_f32 v123, v123
    s_nop 0
    v_cvt_pk_bf16_f32 v124, v123, v123
    v_add_f32 v121, v121, v123
    s_nop 0
    v_and_b32_dpp v96, v124, v10 row_newbcast:0 row_mask:0xf bank_mask:0xf
    v_and_b32_dpp v97, v124, v11 row_newbcast:0 row_mask:0xf bank_mask:0xf
    v_and_b32_dpp v98, v124, v12 row_newbcast:0 row_mask:0xf bank_mask:0xf
    v_and_b32_dpp v99, v124, v13 row_newbcast:0 row_mask:0xf bank_mask:0xf
    v_and_b32_dpp v100, v124, v10 row_newbcast:4 row_mask:0xf bank_mask:0xf
    v_and_b32_dpp v101, v124, v11 row_newbcast:4 row_mask:0xf bank_mask:0xf
    v_and_b32_dpp v102, v124, v12 row_newbcast:4 row_mask:0xf bank_mask:0xf
    v_and_b32_dpp v103, v124, v13 row_newbcast:4 row_mask:0xf bank_mask:0xf
    v_and_b32_dpp v104, v124, v10 row_newbcast:8 row_mask:0xf bank_mask:0xf
    v_and_b32_dpp v105, v124, v11 row_newbcast:8 row_mask:0xf bank_mask:0xf
    v_and_b32_dpp v106, v124, v12 row_newbcast:8 row_mask:0xf bank_mask:0xf
    v_and_b32_dpp v107, v124, v13 row_newbcast:8 row_mask:0xf bank_mask:0xf
    v_and_b32_dpp v108, v124, v10 row_newbcast:12 row_mask:0xf bank_mask:0xf
    v_and_b32_dpp v109, v124, v11 row_newbcast:12 row_mask:0xf bank_mask:0xf
    v_and_b32_dpp v110, v124, v12 row_newbcast:12 row_mask:0xf bank_mask:0xf
    v_and_b32_dpp v111, v124, v13 row_newbcast:12 row_mask:0xf bank_mask:0xf
    s_waitcnt vmcnt(7)
    buffer_load_dwordx4 v[176:179], v126, s[56:59], s85 offen offset:0 nt
    v_mfma_f32_16x16x32_bf16 v[116:119], v[144:147], v[96:99], v[116:119]
    s_waitcnt vmcnt(7)
    buffer_load_dwordx4 v[180:183], v127, s[56:59], s85 offen offset:0 nt
    v_mfma_f32_16x16x32_bf16 v[116:119], v[148:151], v[100:103], v[116:119]
    s_waitcnt vmcnt(7)
    buffer_load_dwordx4 v[184:187], v126, s[56:59], s85 offen offset:1024 nt
    v_mfma_f32_16x16x32_bf16 v[116:119], v[152:155], v[104:107], v[116:119]
    s_waitcnt vmcnt(7)
    buffer_load_dwordx4 v[188:191], v127, s[56:59], s85 offen offset:1024 nt
    v_mfma_f32_16x16x32_bf16 v[116:119], v[156:159], v[108:111], v[116:119]
    s_waitcnt vmcnt(7)
    v_readfirstlane_b32 s93, v19
    v_mov_b32 v19, 25
    s_cmp_ge_u32 s93, 25
    s_cbranch_scc1 L_last1
    s_add_u32 s87, s93, 231
    s_add_u32 s39, s87, s88
    s_bfe_u32 s37, s39, 0x30000
    s_lshl_b32 s37, s37, 12
    s_add_u32 s85, s37, s89
    s_bfe_u32 s37, s39, 0x10003
    s_lshl_b32 s37, s37, 11
    s_add_u32 s85, s37, s85
    s_bfe_u32 s37, s39, 0x40004
    s_lshl_b32 s37, s37, 16
    s_add_u32 s85, s37, s85
    s_cmp_ge_u32 s93, 24
    s_cbranch_scc1 L_noclaim_8
    s_mov_b64 exec, 1
    global_atomic_add v19, v9, v18, s[30:31] sc0 sc1
    s_mov_b64 exec, -1
L_noclaim_8:
    buffer_load_dwordx4 v[128:131], v76, s[52:55], s85 offen offset:0 nt
    v_mfma_f32_16x16x32_bf16 v[112:115], v[160:163], v[80:83], 0
    s_waitcnt vmcnt(7)
    buffer_load_dwordx4 v[132:135], v77, s[52:55], s85 offen offset:0 nt
    v_mfma_f32_16x16x32_bf16 v[112:115], v[164:167], v[84:87], v[112:115]
    s_waitcnt vmcnt(7)
    buffer_load_dwordx4 v[136:139], v76, s[52:55], s85 offen offset:1024 nt
    v_mfma_f32_16x16x32_bf16 v[112:115], v[168:171], v[88:91], v[112:115]
    s_waitcnt vmcnt(7)
    buffer_load_dwordx4 v[140:143], v77, s[52:55], s85 offen offset:1024 nt
    v_mfma_f32_16x16x32_bf16 v[112:115], v[172:175], v[92:95], v[112:115]
    s_nop 7
    v_mov_b32_dpp v122, v112 quad_perm:[0,0,0,0] row_mask:0xf bank_mask:0xf
    v_mov_b32_dpp v124, v114 quad_perm:[2,2,2,2] row_mask:0xf bank_mask:0xf
    s_nop 0
    v_add_f32_dpp v122, v113, v122 quad_perm:[1,1,1,1] row_mask:0xf bank_mask:0xf
    v_add_f32_dpp v124, v115, v124 quad_perm:[3,3,3,3] row_mask:0xf bank_mask:0xf
    v_add_f32 v122, v122, v124
    v_fma_f32 v123, v122, s83, -v120
    v_cmp_lt_f32 vcc, 0, v123
    s_cbranch_vccz L_nomax_9
    v_mul_f32 v122, s83, v122
    s_nop 1
    v_max_f32_dpp v124, v122, v122 row_ror:4 row_mask:0xf bank_mask:0xf
    s_nop 1
    v_max_f32_dpp v124, v124, v124 row_ror:8 row_mask:0xf bank_mask:0xf
    v_mov_b32 v125, v124
    s_nop 1
    v_permlane16_swap_b32 v124, v125
    v_max_f32 v124, v124, v125
    v_mov_b32 v125, v124
    s_nop 1
    v_permlane32_swap_b32 v124, v125
    v_max_f32 v124, v124, v125
    v_and_b32 v124, s82, v124
    v_max_f32 v124, v124, v120
    v_sub_f32 v125, v120, v124
    v_exp_f32 v125, v125
    v_mov_b32 v120, v124
    v_sub_f32 v123, v122, v124
    v_mul_f32 v121, v121, v125
    v_mul_f32 v116, v116, v125
    v_mul_f32 v117, v117, v125
    v_mul_f32 v118, v118, v125
    v_mul_f32 v119, v119, v125
L_nomax_9:
    v_exp_f32 v123, v123
    s_nop 0
    v_cvt_pk_bf16_f32 v124, v123, v123
    v_add_f32 v121, v121, v123
    s_nop 0
    v_and_b32_dpp v96, v124, v10 row_newbcast:0 row_mask:0xf bank_mask:0xf
    v_and_b32_dpp v97, v124, v11 row_newbcast:0 row_mask:0xf bank_mask:0xf
    v_and_b32_dpp v98, v124, v12 row_newbcast:0 row_mask:0xf bank_mask:0xf
    v_and_b32_dpp v99, v124, v13 row_newbcast:0 row_mask:0xf bank_mask:0xf
    v_and_b32_dpp v100, v124, v10 row_newbcast:4 row_mask:0xf bank_mask:0xf
    v_and_b32_dpp v101, v124, v11 row_newbcast:4 row_mask:0xf bank_mask:0xf
    v_and_b32_dpp v102, v124, v12 row_newbcast:4 row_mask:0xf bank_mask:0xf
    v_and_b32_dpp v103, v124, v13 row_newbcast:4 row_mask:0xf bank_mask:0xf
    v_and_b32_dpp v104, v124, v10 row_newbcast:8 row_mask:0xf bank_mask:0xf
    v_and_b32_dpp v105, v124, v11 row_newbcast:8 row_mask:0xf bank_mask:0xf
    v_and_b32_dpp v106, v124, v12 row_newbcast:8 row_mask:0xf bank_mask:0xf
    v_and_b32_dpp v107, v124, v13 row_newbcast:8 row_mask:0xf bank_mask:0xf
    v_and_b32_dpp v108, v124, v10 row_newbcast:12 row_mask:0xf bank_mask:0xf
    v_and_b32_dpp v109, v124, v11 row_newbcast:12 row_mask:0xf bank_mask:0xf
    v_and_b32_dpp v110, v124, v12 row_newbcast:12 row_mask:0xf bank_mask:0xf
    v_and_b32_dpp v111, v124, v13 row_newbcast:12 row_mask:0xf bank_mask:0xf
    s_waitcnt vmcnt(7)
    buffer_load_dwordx4 v[144:147], v126, s[56:59], s85 offen offset:0 nt
    v_mfma_f32_16x16x32_bf16 v[116:119], v[176:179], v[96:99], v[116:119]
    s_waitcnt vmcnt(7)
    buffer_load_dwordx4 v[148:151], v127, s[56:59], s85 offen offset:0 nt
    v_mfma_f32_16x16x32_bf16 v[116:119], v[180:183], v[100:103], v[116:119]
    s_waitcnt vmcnt(7)
    buffer_load_dwordx4 v[152:155], v126, s[56:59], s85 offen offset:1024 nt
    v_mfma_f32_16x16x32_bf16 v[116:119], v[184:187], v[104:107], v[116:119]
    s_waitcnt vmcnt(7)
    buffer_load_dwordx4 v[156:159], v127, s[56:59], s85 offen offset:1024 nt
    v_mfma_f32_16x16x32_bf16 v[116:119], v[188:191], v[108:111], v[116:119]
    s_branch L_dloop
L_last1:
    buffer_load_dwordx4 v[224:227], v34, s[48:51], s46 offen sc1
    s_lshl_b32 s39, s34, 13
    s_add_u32 s39, s39, 98304
    s_mov_b32 m0, s39
    s_nop 0
    buffer_load_dwordx4 v20, s[40:43], s44 offen offset:0 nt lds
    v_mfma_f32_16x16x32_bf16 v[112:115], v[160:163], v[80:83], 0
    s_waitcnt vmcnt(8)
    buffer_load_dwordx4 v21, s[40:43], s44 offen offset:1024 nt lds
    v_mfma_f32_16x16x32_bf16 v[112:115], v[164:167], v[84:87], v[112:115]
    s_waitcnt vmcnt(8)
    buffer_load_dwordx4 v22, s[40:43], s44 offen offset:2048 nt lds
    v_mfma_f32_16x16x32_bf16 v[112:115], v[168:171], v[88:91], v[112:115]
    s_waitcnt vmcnt(8)
    buffer_load_dwordx4 v23, s[40:43], s44 offen offset:3072 nt lds
    v_mfma_f32_16x16x32_bf16 v[112:115], v[172:175], v[92:95], v[112:115]
    s_nop 7
    v_mov_b32_dpp v122, v112 quad_perm:[0,0,0,0] row_mask:0xf bank_mask:0xf
    v_mov_b32_dpp v124, v114 quad_perm:[2,2,2,2] row_mask:0xf bank_mask:0xf
    s_nop 0
    v_add_f32_dpp v122, v113, v122 quad_perm:[1,1,1,1] row_mask:0xf bank_mask:0xf
    v_add_f32_dpp v124, v115, v124 quad_perm:[3,3,3,3] row_mask:0xf bank_mask:0xf
    v_add_f32 v122, v122, v124
    v_fma_f32 v123, v122, s83, -v120
    v_cmp_lt_f32 vcc, 0, v123
    s_cbranch_vccz L_nomax_10
    v_mul_f32 v122, s83, v122
    s_nop 1
    v_max_f32_dpp v124, v122, v122 row_ror:4 row_mask:0xf bank_mask:0xf
    s_nop 1
    v_max_f32_dpp v124, v124, v124 row_ror:8 row_mask:0xf bank_mask:0xf
    v_mov_b32 v125, v124
    s_nop 1
    v_permlane16_swap_b32 v124, v125
    v_max_f32 v124, v124, v125
    v_mov_b32 v125, v124
    s_nop 1
    v_permlane32_swap_b32 v124, v125
    v_max_f32 v124, v124, v125
    v_and_b32 v124, s82, v124
    v_max_f32 v124, v124, v120
    v_sub_f32 v125, v120, v124
    v_exp_f32 v125, v125
    v_mov_b32 v120, v124
    v_sub_f32 v123, v122, v124
    v_mul_f32 v121, v121, v125
    v_mul_f32 v116, v116, v125
    v_mul_f32 v117, v117, v125
    v_mul_f32 v118, v118, v125
    v_mul_f32 v119, v119, v125
L_nomax_10:
    v_exp_f32 v123, v123
    s_nop 0
    v_cvt_pk_bf16_f32 v124, v123, v123
    v_add_f32 v121, v121, v123
    s_nop 0
    v_and_b32_dpp v96, v124, v10 row_newbcast:0 row_mask:0xf bank_mask:0xf
    v_and_b32_dpp v97, v124, v11 row_newbcast:0 row_mask:0xf bank_mask:0xf
    v_and_b32_dpp v98, v124, v12 row_newbcast:0 row_mask:0xf bank_mask:0xf
    v_and_b32_dpp v99, v124, v13 row_newbcast:0 row_mask:0xf bank_mask:0xf
    v_and_b32_dpp v100, v124, v10 row_newbcast:4 row_mask:0xf bank_mask:0xf
    v_and_b32_dpp v101, v124, v11 row_newbcast:4 row_mask:0xf bank_mask:0xf
    v_and_b32_dpp v102, v124, v12 row_newbcast:4 row_mask:0xf bank_mask:0xf
    v_and_b32_dpp v103, v124, v13 row_newbcast:4 row_mask:0xf bank_mask:0xf
    v_and_b32_dpp v104, v124, v10 row_newbcast:8 row_mask:0xf bank_mask:0xf
    v_and_b32_dpp v105, v124, v11 row_newbcast:8 row_mask:0xf bank_mask:0xf
    v_and_b32_dpp v106, v124, v12 row_newbcast:8 row_mask:0xf bank_mask:0xf
    v_and_b32_dpp v107, v124, v13 row_newbcast:8 row_mask:0xf bank_mask:0xf
    v_and_b32_dpp v108, v124, v10 row_newbcast:12 row_mask:0xf bank_mask:0xf
    v_and_b32_dpp v109, v124, v11 row_newbcast:12 row_mask:0xf bank_mask:0xf
    v_and_b32_dpp v110, v124, v12 row_newbcast:12 row_mask:0xf bank_mask:0xf
    v_and_b32_dpp v111, v124, v13 row_newbcast:12 row_mask:0xf bank_mask:0xf
    s_waitcnt vmcnt(8)
    s_lshl_b32 s39, s34, 13
    s_add_u32 s39, s39, 102400
    s_mov_b32 m0, s39
    s_add_u32 s44, s44, 16384
    buffer_load_dwordx4 v20, s[40:43], s44 offen offset:0 nt lds
    v_mfma_f32_16x16x32_bf16 v[116:119], v[176:179], v[96:99], v[116:119]
    v_add_f32_dpp v121, v121, v121 row_ror:8 row_mask:0xf bank_mask:0xf
    s_nop 1
    v_add_f32_dpp v121, v121, v121 row_ror:4 row_mask:0xf bank_mask:0xf
    v_mov_b32 v125, v121
    s_nop 1
    v_permlane16_swap_b32 v121, v125
    v_add_f32 v121, v121, v125
    v_mov_b32 v125, v121
    s_nop 1
    v_permlane32_swap_b32 v121, v125
    v_add_f32 v121, v121, v125
    s_mov_b32 vcc_lo, 0xff00ff00
    s_mov_b32 vcc_hi, 0xff00ff00
    s_waitcnt vmcnt(8)
    buffer_load_dwordx4 v21, s[40:43], s44 offen offset:1024 nt lds
    v_mfma_f32_16x16x32_bf16 v[116:119], v[180:183], v[100:103], v[116:119]
    s_waitcnt vmcnt(8)
    buffer_load_dwordx4 v22, s[40:43], s44 offen offset:2048 nt lds
    v_mfma_f32_16x16x32_bf16 v[116:119], v[184:187], v[104:107], v[116:119]
    s_waitcnt vmcnt(8)
    buffer_load_dwordx4 v23, s[40:43], s44 offen offset:3072 nt lds
    v_mfma_f32_16x16x32_bf16 v[116:119], v[188:191], v[108:111], v[116:119]
    s_branch L_bdone
L_last0:
    buffer_load_dwordx4 v[224:227], v34, s[48:51], s46 offen sc1
    s_lshl_b32 s39, s34, 13
    s_add_u32 s39, s39, 98304
    s_mov_b32 m0, s39
    s_nop 0
    buffer_load_dwordx4 v20, s[40:43], s44 offen offset:0 nt lds
    v_mfma_f32_16x16x32_bf16 v[112:115], v[128:131], v[80:83], 0
    s_waitcnt vmcnt(8)
    buffer_load_dwordx4 v21, s[40:43], s44 offen offset:1024 nt lds
    v_mfma_f32_16x16x32_bf16 v[112:115], v[132:135], v[84:87], v[112:115]
    s_waitcnt vmcnt(8)
    buffer_load_dwordx4 v22, s[40:43], s44 offen offset:2048 nt lds
    v_mfma_f32_16x16x32_bf16 v[112:115], v[136:139], v[88:91], v[112:115]
    s_waitcnt vmcnt(8)
    buffer_load_dwordx4 v23, s[40:43], s44 offen offset:3072 nt lds
    v_mfma_f32_16x16x32_bf16 v[112:115], v[140:143], v[92:95], v[112:115]
    s_nop 7
    v_mov_b32_dpp v122, v112 quad_perm:[0,0,0,0] row_mask:0xf bank_mask:0xf
    v_mov_b32_dpp v124, v114 quad_perm:[2,2,2,2] row_mask:0xf bank_mask:0xf
    s_nop 0
    v_add_f32_dpp v122, v113, v122 quad_perm:[1,1,1,1] row_mask:0xf bank_mask:0xf
    v_add_f32_dpp v124, v115, v124 quad_perm:[3,3,3,3] row_mask:0xf bank_mask:0xf
    v_add_f32 v122, v122, v124
    v_fma_f32 v123, v122, s83, -v120
    v_cmp_lt_f32 vcc, 0, v123
    s_cbranch_vccz L_nomax_11
    v_mul_f32 v122, s83, v122
    s_nop 1
    v_max_f32_dpp v124, v122, v122 row_ror:4 row_mask:0xf bank_mask:0xf
    s_nop 1
    v_max_f32_dpp v124, v124, v124 row_ror:8 row_mask:0xf bank_mask:0xf
    v_mov_b32 v125, v124
    s_nop 1
    v_permlane16_swap_b32 v124, v125
    v_max_f32 v124, v124, v125
    v_mov_b32 v125, v124
    s_nop 1
    v_permlane32_swap_b32 v124, v125
    v_max_f32 v124, v124, v125
    v_and_b32 v124, s82, v124
    v_max_f32 v124, v124, v120
    v_sub_f32 v125, v120, v124
    v_exp_f32 v125, v125
    v_mov_b32 v120, v124
    v_sub_f32 v123, v122, v124
    v_mul_f32 v121, v121, v125
    v_mul_f32 v116, v116, v125
    v_mul_f32 v117, v117, v125
    v_mul_f32 v118, v118, v125
    v_mul_f32 v119, v119, v125
L_nomax_11:
    v_exp_f32 v123, v123
    s_nop 0
    v_cvt_pk_bf16_f32 v124, v123, v123
    v_add_f32 v121, v121, v123
    s_nop 0
    v_and_b32_dpp v96, v124, v10 row_newbcast:0 row_mask:0xf bank_mask:0xf
    v_and_b32_dpp v97, v124, v11 row_newbcast:0 row_mask:0xf bank_mask:0xf
    v_and_b32_dpp v98, v124, v12 row_newbcast:0 row_mask:0xf bank_mask:0xf
    v_and_b32_dpp v99, v124, v13 row_newbcast:0 row_mask:0xf bank_mask:0xf
    v_and_b32_dpp v100, v124, v10 row_newbcast:4 row_mask:0xf bank_mask:0xf
    v_and_b32_dpp v101, v124, v11 row_newbcast:4 row_mask:0xf bank_mask:0xf
    v_and_b32_dpp v102, v124, v12 row_newbcast:4 row_mask:0xf bank_mask:0xf
    v_and_b32_dpp v103, v124, v13 row_newbcast:4 row_mask:0xf bank_mask:0xf
    v_and_b32_dpp v104, v124, v10 row_newbcast:8 row_mask:0xf bank_mask:0xf
    v_and_b32_dpp v105, v124, v11 row_newbcast:8 row_mask:0xf bank_mask:0xf
    v_and_b32_dpp v106, v124, v12 row_newbcast:8 row_mask:0xf bank_mask:0xf
    v_and_b32_dpp v107, v124, v13 row_newbcast:8 row_mask:0xf bank_mask:0xf
    v_and_b32_dpp v108, v124, v10 row_newbcast:12 row_mask:0xf bank_mask:0xf
    v_and_b32_dpp v109, v124, v11 row_newbcast:12 row_mask:0xf bank_mask:0xf
    v_and_b32_dpp v110, v124, v12 row_newbcast:12 row_mask:0xf bank_mask:0xf
    v_and_b32_dpp v111, v124, v13 row_newbcast:12 row_mask:0xf bank_mask:0xf
    s_waitcnt vmcnt(8)
    s_lshl_b32 s39, s34, 13
    s_add_u32 s39, s39, 102400
    s_mov_b32 m0, s39
    s_add_u32 s44, s44, 16384
    buffer_load_dwordx4 v20, s[40:43], s44 offen offset:0 nt lds
    v_mfma_f32_16x16x32_bf16 v[116:119], v[144:147], v[96:99], v[116:119]
    v_add_f32_dpp v121, v121, v121 row_ror:8 row_mask:0xf bank_mask:0xf
    s_nop 1
    v_add_f32_dpp v121, v121, v121 row_ror:4 row_mask:0xf bank_mask:0xf
    v_mov_b32 v125, v121
    s_nop 1
    v_permlane16_swap_b32 v121, v125
    v_add_f32 v121, v121, v125
    v_mov_b32 v125, v121
    s_nop 1
    v_permlane32_swap_b32 v121, v125
    v_add_f32 v121, v121, v125
    s_mov_b32 vcc_lo, 0xff00ff00
    s_mov_b32 vcc_hi, 0xff00ff00
    s_waitcnt vmcnt(8)
    buffer_load_dwordx4 v21, s[40:43], s44 offen offset:1024 nt lds
    v_mfma_f32_16x16x32_bf16 v[116:119], v[148:151], v[100:103], v[116:119]
    s_waitcnt vmcnt(8)
    buffer_load_dwordx4 v22, s[40:43], s44 offen offset:2048 nt lds
    v_mfma_f32_16x16x32_bf16 v[116:119], v[152:155], v[104:107], v[116:119]
    s_waitcnt vmcnt(8)
    buffer_load_dwordx4 v23, s[40:43], s44 offen offset:3072 nt lds
    v_mfma_f32_16x16x32_bf16 v[116:119], v[156:159], v[108:111], v[116:119]
L_bdone:
    s_nop 7
    v_cndmask_b32 v116, v116, v120, vcc
    v_cndmask_b32 v117, v117, v121, vcc
    v_and_or_b32 v118, v118, s82, v8
    v_and_or_b32 v119, v119, s82, v8
    v_and_or_b32 v116, v116, s82, v8
    v_and_or_b32 v117, v117, s82, v8
    s_mov_b32 exec_lo, 0xff01ff
    s_mov_b32 exec_hi, 0xff00ff
    buffer_store_dwordx4 v[116:119], v79, s[48:51], s96 offen sc1
    s_mov_b64 exec, -1
    s_cmp_lt_u32 s33, 3
    s_cbranch_scc1 L_ctx
    s_mov_b32 s93, 0x7f
    s_bitset0_b32 s93, s33
    s_mov_b32 s86, 0
    s_and_b32 s86, s86, s93
    s_cselect_b32 s86, s86, s93
    s_ff1_i32_b32 s4, s86
    s_bitset0_b32 s86, s4
    s_lshl_b32 s36, s4, 10
    s_add_u32 s36, s36, s47
    buffer_load_dwordx4 v[192:195], v79, s[48:51], s36 offen sc1
    s_and_b32 s86, s86, s93
    s_cselect_b32 s86, s86, s93
    s_ff1_i32_b32 s5, s86
    s_bitset0_b32 s86, s5
    s_lshl_b32 s36, s5, 10
    s_add_u32 s36, s36, s47
    buffer_load_dwordx4 v[196:199], v79, s[48:51], s36 offen sc1
    s_and_b32 s86, s86, s93
    s_cselect_b32 s86, s86, s93
    s_ff1_i32_b32 s6, s86
    s_bitset0_b32 s86, s6
    s_lshl_b32 s36, s6, 10
    s_add_u32 s36, s36, s47
    buffer_load_dwordx4 v[200:203], v79, s[48:51], s36 offen sc1
    s_and_b32 s86, s86, s93
    s_cselect_b32 s86, s86, s93
    s_ff1_i32_b32 s7, s86
    s_bitset0_b32 s86, s7
    s_lshl_b32 s36, s7, 10
    s_add_u32 s36, s36, s47
    buffer_load_dwordx4 v[204:207], v79, s[48:51], s36 offen sc1
    s_and_b32 s86, s86, s93
    s_cselect_b32 s86, s86, s93
    s_ff1_i32_b32 s8, s86
    s_bitset0_b32 s86, s8
    s_lshl_b32 s36, s8, 10
    s_add_u32 s36, s36, s47
    buffer_load_dwordx4 v[208:211], v79, s[48:51], s36 offen sc1
    v_xor_b32 v104, s35, v116
    v_xor_b32 v105, s35, v117
    v_xor_b32 v106, s35, v118
    v_xor_b32 v107, s35, v119
L_hop1poll:
    s_and_b32 s86, s86, s93
    s_cselect_b32 s86, s86, s93
    s_ff1_i32_b32 s9, s86
    s_bitset0_b32 s86, s9
    s_lshl_b32 s36, s9, 10
    s_add_u32 s36, s36, s47
    buffer_load_dwordx4 v[212:215], v79, s[48:51], s36 offen sc1
    s_waitcnt vmcnt(5)
    v_xor_b32 v192, s35, v192
    v_xor_b32 v193, s35, v193
    v_xor_b32 v194, s35, v194
    v_xor_b32 v195, s35, v195
    v_or_b32 v4, v192, v193
    v_or3_b32 v4, v4, v194, v195
    v_and_b32 v4, 0xff, v4
    v_cmp_ne_u32 vcc, 0, v4
    v_max_f32 v5, v120, v192
    s_cbranch_vccnz L_mnext_12
    s_bitcmp1_b32 s93, s4
    s_cbranch_scc0 L_mnext_12
    v_sub_f32 v122, v120, v5
    v_sub_f32 v123, v192, v5
    v_exp_f32 v122, v122
    v_exp_f32 v123, v123
    v_mov_b32 v120, v5
    s_bitset0_b32 s93, s4
    v_mul_f32_dpp v105, v122, v105 row_newbcast:8 row_mask:0xf bank_mask:0xf
    v_mul_f32_dpp v104, v122, v104 row_newbcast:8 row_mask:0xf bank_mask:0xf
    v_mul_f32_dpp v106, v122, v106 row_newbcast:8 row_mask:0xf bank_mask:0xf
    v_mul_f32_dpp v107, v122, v107 row_newbcast:8 row_mask:0xf bank_mask:0xf
    v_fmac_f32_dpp v105, v123, v193 row_newbcast:8 row_mask:0xf bank_mask:0xf
    v_fmac_f32_dpp v104, v123, v192 row_newbcast:8 row_mask:0xf bank_mask:0xf
    v_fmac_f32_dpp v106, v123, v194 row_newbcast:8 row_mask:0xf bank_mask:0xf
    v_fmac_f32_dpp v107, v123, v195 row_newbcast:8 row_mask:0xf bank_mask:0xf
    s_cmp_eq_u32 s93, 0
    s_cbranch_scc1 L_hop1ok
L_mnext_12:
    s_and_b32 s86, s86, s93
    s_cselect_b32 s86, s86, s93
    s_ff1_i32_b32 s4, s86
    s_bitset0_b32 s86, s4
    s_lshl_b32 s36, s4, 10
    s_add_u32 s36, s36, s47
    buffer_load_dwordx4 v[192:195], v79, s[48:51], s36 offen sc1
    s_waitcnt vmcnt(5)
    v_xor_b32 v196, s35, v196
    v_xor_b32 v197, s35, v197
    v_xor_b32 v198, s35, v198
    v_xor_b32 v199, s35, v199
    v_or_b32 v4, v196, v197
    v_or3_b32 v4, v4, v198, v199
    v_and_b32 v4, 0xff, v4
    v_cmp_ne_u32 vcc, 0, v4
    v_max_f32 v5, v120, v196
    s_cbranch_vccnz L_mnext_13
    s_bitcmp1_b32 s93, s5
    s_cbranch_scc0 L_mnext_13
    v_sub_f32 v122, v120, v5
    v_sub_f32 v123, v196, v5
    v_exp_f32 v122, v122
    v_exp_f32 v123, v123
    v_mov_b32 v120, v5
    s_bitset0_b32 s93, s5
    v_mul_f32_dpp v105, v122, v105 row_newbcast:8 row_mask:0xf bank_mask:0xf
    v_mul_f32_dpp v104, v122, v104 row_newbcast:8 row_mask:0xf bank_mask:0xf
    v_mul_f32_dpp v106, v122, v106 row_newbcast:8 row_mask:0xf bank_mask:0xf
    v_mul_f32_dpp v107, v122, v107 row_newbcast:8 row_mask:0xf bank_mask:0xf
    v_fmac_f32_dpp v105, v123, v197 row_newbcast:8 row_mask:0xf bank_mask:0xf
    v_fmac_f32_dpp v104, v123, v196 row_newbcast:8 row_mask:0xf bank_mask:0xf
    v_fmac_f32_dpp v106, v123, v198 row_newbcast:8 row_mask:0xf bank_mask:0xf
    v_fmac_f32_dpp v107, v123, v199 row_newbcast:8 row_mask:0xf bank_mask:0xf
    s_cmp_eq_u32 s93, 0
    s_cbranch_scc1 L_hop1ok
L_mnext_13:
    s_and_b32 s86, s86, s93
    s_cselect_b32 s86, s86, s93
    s_ff1_i32_b32 s5, s86
    s_bitset0_b32 s86, s5
    s_lshl_b32 s36, s5, 10
    s_add_u32 s36, s36, s47
    buffer_load_dwordx4 v[196:199], v79, s[48:51], s36 offen sc1
    s_waitcnt vmcnt(5)
    v_xor_b32 v200, s35, v200
    v_xor_b32 v201, s35, v201
    v_xor_b32 v202, s35, v202
    v_xor_b32 v203, s35, v203
    v_or_b32 v4, v200, v201
    v_or3_b32 v4, v4, v202, v203
    v_and_b32 v4, 0xff, v4
    v_cmp_ne_u32 vcc, 0, v4
    v_max_f32 v5, v120, v200
    s_cbranch_vccnz L_mnext_14
    s_bitcmp1_b32 s93, s6
    s_cbranch_scc0 L_mnext_14
    v_sub_f32 v122, v120, v5
    v_sub_f32 v123, v200, v5
    v_exp_f32 v122, v122
    v_exp_f32 v123, v123
    v_mov_b32 v120, v5
    s_bitset0_b32 s93, s6
    v_mul_f32_dpp v105, v122, v105 row_newbcast:8 row_mask:0xf bank_mask:0xf
    v_mul_f32_dpp v104, v122, v104 row_newbcast:8 row_mask:0xf bank_mask:0xf
    v_mul_f32_dpp v106, v122, v106 row_newbcast:8 row_mask:0xf bank_mask:0xf
    v_mul_f32_dpp v107, v122, v107 row_newbcast:8 row_mask:0xf bank_mask:0xf
    v_fmac_f32_dpp v105, v123, v201 row_newbcast:8 row_mask:0xf bank_mask:0xf
    v_fmac_f32_dpp v104, v123, v200 row_newbcast:8 row_mask:0xf bank_mask:0xf
    v_fmac_f32_dpp v106, v123, v202 row_newbcast:8 row_mask:0xf bank_mask:0xf
    v_fmac_f32_dpp v107, v123, v203 row_newbcast:8 row_mask:0xf bank_mask:0xf
    s_cmp_eq_u32 s93, 0
    s_cbranch_scc1 L_hop1ok
L_mnext_14:
    s_and_b32 s86, s86, s93
    s_cselect_b32 s86, s86, s93
    s_ff1_i32_b32 s6, s86
    s_bitset0_b32 s86, s6
    s_lshl_b32 s36, s6, 10
    s_add_u32 s36, s36, s47
    buffer_load_dwordx4 v[200:203], v79, s[48:51], s36 offen sc1
    s_waitcnt vmcnt(5)
    v_xor_b32 v204, s35, v204
    v_xor_b32 v205, s35, v205
    v_xor_b32 v206, s35, v206
    v_xor_b32 v207, s35, v207
    v_or_b32 v4, v204, v205
    v_or3_b32 v4, v4, v206, v207
    v_and_b32 v4, 0xff, v4
    v_cmp_ne_u32 vcc, 0, v4
    v_max_f32 v5, v120, v204
    s_cbranch_vccnz L_mnext_15
    s_bitcmp1_b32 s93, s7
    s_cbranch_scc0 L_mnext_15
    v_sub_f32 v122, v120, v5
    v_sub_f32 v123, v204, v5
    v_exp_f32 v122, v122
    v_exp_f32 v123, v123
    v_mov_b32 v120, v5
    s_bitset0_b32 s93, s7
    v_mul_f32_dpp v105, v122, v105 row_newbcast:8 row_mask:0xf bank_mask:0xf
    v_mul_f32_dpp v104, v122, v104 row_newbcast:8 row_mask:0xf bank_mask:0xf
    v_mul_f32_dpp v106, v122, v106 row_newbcast:8 row_mask:0xf bank_mask:0xf
    v_mul_f32_dpp v107, v122, v107 row_newbcast:8 row_mask:0xf bank_mask:0xf
    v_fmac_f32_dpp v105, v123, v205 row_newbcast:8 row_mask:0xf bank_mask:0xf
    v_fmac_f32_dpp v104, v123, v204 row_newbcast:8 row_mask:0xf bank_mask:0xf
    v_fmac_f32_dpp v106, v123, v206 row_newbcast:8 row_mask:0xf bank_mask:0xf
    v_fmac_f32_dpp v107, v123, v207 row_newbcast:8 row_mask:0xf bank_mask:0xf
    s_cmp_eq_u32 s93, 0
    s_cbranch_scc1 L_hop1ok
L_mnext_15:
    s_and_b32 s86, s86, s93
    s_cselect_b32 s86, s86, s93
    s_ff1_i32_b32 s7, s86
    s_bitset0_b32 s86, s7
    s_lshl_b32 s36, s7, 10
    s_add_u32 s36, s36, s47
    buffer_load_dwordx4 v[204:207], v79, s[48:51], s36 offen sc1
    s_waitcnt vmcnt(5)
    v_xor_b32 v208, s35, v208
    v_xor_b32 v209, s35, v209
    v_xor_b32 v210, s35, v210
    v_xor_b32 v211, s35, v211
    v_or_b32 v4, v208, v209
    v_or3_b32 v4, v4, v210, v211
    v_and_b32 v4, 0xff, v4
    v_cmp_ne_u32 vcc, 0, v4
    v_max_f32 v5, v120, v208
    s_cbranch_vccnz L_mnext_16
    s_bitcmp1_b32 s93, s8
    s_cbranch_scc0 L_mnext_16
    v_sub_f32 v122, v120, v5
    v_sub_f32 v123, v208, v5
    v_exp_f32 v122, v122
    v_exp_f32 v123, v123
    v_mov_b32 v120, v5
    s_bitset0_b32 s93, s8
    v_mul_f32_dpp v105, v122, v105 row_newbcast:8 row_mask:0xf bank_mask:0xf
    v_mul_f32_dpp v104, v122, v104 row_newbcast:8 row_mask:0xf bank_mask:0xf
    v_mul_f32_dpp v106, v122, v106 row_newbcast:8 row_mask:0xf bank_mask:0xf
    v_mul_f32_dpp v107, v122, v107 row_newbcast:8 row_mask:0xf bank_mask:0xf
    v_fmac_f32_dpp v105, v123, v209 row_newbcast:8 row_mask:0xf bank_mask:0xf
    v_fmac_f32_dpp v104, v123, v208 row_newbcast:8 row_mask:0xf bank_mask:0xf
    v_fmac_f32_dpp v106, v123, v210 row_newbcast:8 row_mask:0xf bank_mask:0xf
    v_fmac_f32_dpp v107, v123, v211 row_newbcast:8 row_mask:0xf bank_mask:0xf
    s_cmp_eq_u32 s93, 0
    s_cbranch_scc1 L_hop1ok
L_mnext_16:
    s_and_b32 s86, s86, s93
    s_cselect_b32 s86, s86, s93
    s_ff1_i32_b32 s8, s86
    s_bitset0_b32 s86, s8
    s_lshl_b32 s36, s8, 10
    s_add_u32 s36, s36, s47
    buffer_load_dwordx4 v[208:211], v79, s[48:51], s36 offen sc1
    s_waitcnt vmcnt(5)
    v_xor_b32 v212, s35, v212
    v_xor_b32 v213, s35, v213
    v_xor_b32 v214, s35, v214
    v_xor_b32 v215, s35, v215
    v_or_b32 v4, v212, v213
    v_or3_b32 v4, v4, v214, v215
    v_and_b32 v4, 0xff, v4
    v_cmp_ne_u32 vcc, 0, v4
    v_max_f32 v5, v120, v212
    s_cbranch_vccnz L_mnext_17
    s_bitcmp1_b32 s93, s9
    s_cbranch_scc0 L_mnext_17
    v_sub_f32 v122, v120, v5
    v_sub_f32 v123, v212, v5
    v_exp_f32 v122, v122
    v_exp_f32 v123, v123
    v_mov_b32 v120, v5
    s_bitset0_b32 s93, s9
    v_mul_f32_dpp v105, v122, v105 row_newbcast:8 row_mask:0xf bank_mask:0xf
    v_mul_f32_dpp v104, v122, v104 row_newbcast:8 row_mask:0xf bank_mask:0xf
    v_mul_f32_dpp v106, v122, v106 row_newbcast:8 row_mask:0xf bank_mask:0xf
    v_mul_f32_dpp v107, v122, v107 row_newbcast:8 row_mask:0xf bank_mask:0xf
    v_fmac_f32_dpp v105, v123, v213 row_newbcast:8 row_mask:0xf bank_mask:0xf
    v_fmac_f32_dpp v104, v123, v212 row_newbcast:8 row_mask:0xf bank_mask:0xf
    v_fmac_f32_dpp v106, v123, v214 row_newbcast:8 row_mask:0xf bank_mask:0xf
    v_fmac_f32_dpp v107, v123, v215 row_newbcast:8 row_mask:0xf bank_mask:0xf
    s_cmp_eq_u32 s93, 0
    s_cbranch_scc1 L_hop1ok
L_mnext_17:
    s_sub_u32 s84, s84, 1
    s_cmp_lg_u32 s84, 0
    s_cbranch_scc1 L_hop1poll
    s_branch L_end
L_ctx:
    s_waitcnt vmcnt(1)
L_ctxcheck:
    v_xor_b32 v224, s35, v224
    v_xor_b32 v225, s35, v225
    v_xor_b32 v226, s35, v226
    v_xor_b32 v227, s35, v227
    v_or_b32 v4, v224, v225
    v_or3_b32 v4, v4, v226, v227
    v_and_b32 v4, 0xff, v4
    v_cmp_ne_u32 vcc, 0, v4
    s_cbranch_vccz L_ctxok
    buffer_load_dwordx4 v[224:227], v34, s[48:51], s46 offen sc1
    s_waitcnt vmcnt(0)
    s_sub_u32 s84, s84, 1
    s_cmp_lg_u32 s84, 0
    s_cbranch_scc1 L_ctxcheck
    s_branch L_end
L_ctxok:
    v_cvt_pk_bf16_f32 v224, v224, v225
    v_cvt_pk_bf16_f32 v225, v226, v227
    ds_write_b64 v35, v[224:225]
    s_branch L_final
L_hop1ok:
    v_rcp_f32 v122, v105
    s_nop 1
    v_mul_f32_dpp v104, v122, v104 row_newbcast:8 row_mask:0xf bank_mask:0xf
    v_mul_f32_dpp v105, v122, v105 row_newbcast:8 row_mask:0xf bank_mask:0xf
    v_mul_f32_dpp v106, v122, v106 row_newbcast:8 row_mask:0xf bank_mask:0xf
    v_mul_f32_dpp v107, v122, v107 row_newbcast:8 row_mask:0xf bank_mask:0xf
    v_cvt_pk_bf16_f32 v104, v104, v105
    v_cvt_pk_bf16_f32 v106, v106, v107
    s_mov_b32 exec_lo, 0xff00ff
    s_mov_b32 exec_hi, 0xff00ff
    ds_write_b16 v31, v104
    ds_write_b16_d16_hi v31, v104 offset:16
    ds_write_b16 v31, v106 offset:32
    ds_write_b16_d16_hi v31, v106 offset:48
    s_mov_b64 exec, -1
L_final:
    s_waitcnt lgkmcnt(0)
    s_barrier
    ds_read_b64_tr_b16 v[128:129], v24 offset:0
    ds_read_b64_tr_b16 v[130:131], v25 offset:1024
    ds_read_b128 v[160:163], v28 offset:0
    ds_read_b64_tr_b16 v[132:133], v24 offset:8192
    ds_read_b64_tr_b16 v[134:135], v25 offset:9216
    ds_read_b128 v[164:167], v28 offset:64
    ds_read_b64_tr_b16 v[136:137], v24 offset:16384
    ds_read_b64_tr_b16 v[138:139], v25 offset:17408
    ds_read_b128 v[168:171], v28 offset:128
    ds_read_b64_tr_b16 v[140:141], v24 offset:24576
    ds_read_b64_tr_b16 v[142:143], v25 offset:25600
    ds_read_b128 v[172:175], v28 offset:192
    ds_read_b64_tr_b16 v[144:145], v26 offset:0
    ds_read_b64_tr_b16 v[146:147], v27 offset:1024
    ds_read_b128 v[176:179], v29 offset:0
    s_waitcnt lgkmcnt(12)
    v_mfma_f32_16x16x32_bf16 v[112:115], v[128:131], v[160:163], 0
    ds_read_b64_tr_b16 v[148:149], v26 offset:8192
    ds_read_b64_tr_b16 v[150:151], v27 offset:9216
    ds_read_b128 v[180:183], v29 offset:64
    s_waitcnt lgkmcnt(12)
    v_mfma_f32_16x16x32_bf16 v[112:115], v[132:135], v[164:167], v[112:115]
    ds_read_b64_tr_b16 v[152:153], v26 offset:16384
    ds_read_b64_tr_b16 v[154:155], v27 offset:17408
    ds_read_b128 v[184:187], v29 offset:128
    s_waitcnt lgkmcnt(12)
    v_mfma_f32_16x16x32_bf16 v[112:115], v[136:139], v[168:171], v[112:115]
    ds_read_b64_tr_b16 v[156:157], v26 offset:24576
    ds_read_b64_tr_b16 v[158:159], v27 offset:25600
    ds_read_b128 v[188:191], v29 offset:192
    s_waitcnt lgkmcnt(12)
    v_mfma_f32_16x16x32_bf16 v[112:115], v[140:143], v[172:175], v[112:115]
    s_waitcnt lgkmcnt(9)
    v_mfma_f32_16x16x32_bf16 v[112:115], v[144:147], v[176:179], v[112:115]
    s_waitcnt lgkmcnt(6)
    v_mfma_f32_16x16x32_bf16 v[112:115], v[148:151], v[180:183], v[112:115]
    s_waitcnt lgkmcnt(3)
    v_mfma_f32_16x16x32_bf16 v[112:115], v[152:155], v[184:187], v[112:115]
    s_waitcnt lgkmcnt(0)
    v_mfma_f32_16x16x32_bf16 v[112:115], v[156:159], v[188:191], v[112:115]
    s_cmp_eq_u32 s33, 0
    s_cselect_b32 s36, 0, 262144
    s_cselect_b32 s39, 0, 1024
    s_add_u32 s36, s36, 524288
    s_add_u32 s37, s36, 4096
    s_mov_b32 exec_lo, 0xff00ff
    s_mov_b32 exec_hi, 0xff00ff
    s_nop 0
    v_and_or_b32 v112, v112, s82, v8
    v_and_or_b32 v113, v113, s82, v8
    v_and_or_b32 v114, v114, s82, v8
    v_and_or_b32 v115, v115, s82, v8
    buffer_store_dwordx4 v[112:115], v30, s[48:51], s45 offen sc1
    s_mov_b64 exec, -1
    s_sub_u32 s38, s33, 1
    s_cmp_lt_u32 s38, 6
    s_cbranch_scc1 L_done
L_hop2:
    buffer_load_dwordx4 v[224:227], v32, s[48:51], s36 offen sc1
    buffer_load_dwordx4 v[228:231], v32, s[48:51], s37 offen sc1
    s_waitcnt vmcnt(0)
    v_xor_b32 v224, s35, v224
    v_xor_b32 v225, s35, v225
    v_xor_b32 v226, s35, v226
    v_xor_b32 v227, s35, v227
    v_xor_b32 v228, s35, v228
    v_xor_b32 v229, s35, v229
    v_xor_b32 v230, s35, v230
    v_xor_b32 v231, s35, v231
    v_or_b32 v4, v224, v225
    v_or3_b32 v4, v4, v226, v227
    v_or3_b32 v4, v4, v228, v229
    v_or3_b32 v4, v4, v230, v231
    v_and_b32 v4, 0xff, v4
    v_cmp_ne_u32 vcc, 0, v4
    v_add_f32 v232, v224, v228
    v_add_f32 v233, v225, v229
    v_add_f32 v234, v226, v230
    v_add_f32 v235, v227, v231
    s_cbranch_vccz L_hop2ok
    s_sub_u32 s84, s84, 1
    s_cmp_lg_u32 s84, 0
    s_cbranch_scc1 L_hop2
    s_branch L_end
L_hop2ok:
    v_permlane16_swap_b32 v232, v233
    v_permlane16_swap_b32 v234, v235
    v_add_f32 v232, v232, v233
    v_add_f32 v234, v234, v235
    s_nop 1
    v_permlane32_swap_b32 v232, v234
    v_add_f32 v232, v232, v234
    s_nop 1
    v_add_f32_dpp v232, v232, v232 row_ror:8 row_mask:0xf bank_mask:0xf
    s_nop 1
    v_add_f32_dpp v232, v232, v232 row_ror:4 row_mask:0xf bank_mask:0xf
    v_cvt_pk_bf16_f32 v232, v232, v232
    s_mov_b32 exec_lo, 0xf000f
    s_mov_b32 exec_hi, 0xf000f
    buffer_store_short v232, v33, s[72:75], s39 offen
    s_or_b32 s36, s2, s34
    s_cmp_lg_u32 s36, 0
    s_cbranch_scc1 L_done
    v_mov_b32 v4, 0
    s_mov_b64 exec, 1
    buffer_store_dword v8, v4, s[48:51], 0 offen
L_done:
L_end:
    s_endpgm
L_qp:
    v_lshlrev_b32 v4, 18, v2
    v_lshl_add_u32 v14, v3, 4, v4
    v_lshrrev_b32 v5, 3, v3
    v_lshlrev_b32 v5, 10, v5
    v_lshl_add_u32 v15, v2, 6, v5
    s_cmp_eq_u32 s33, 0
    s_cselect_b32 s61, 3, 2
    s_xor_b32 s61, s61, s32
    s_lshl_b32 s86, s34, 8
    s_lshl_b32 s63, s34, 20
    s_lshl_b32 s38, s61, 8
    s_add_u32 s63, s63, s38
    s_mov_b32 s42, 4194304
    s_mov_b32 s43, 0x20000
    s_mov_b32 s46, 4096
    s_mov_b32 s47, 0x20000
    s_cmp_eq_u32 s33, 0
    s_waitcnt lgkmcnt(0)
    s_cselect_b64 s[40:41], s[22:23], s[8:9]
    s_cselect_b64 s[44:45], s[16:17], s[4:5]
    buffer_load_dwordx4 a[128:131], v14, s[40:43], s63 offen nt
    s_add_u32 s63, s63, 8192
    buffer_load_dwordx4 a[132:135], v14, s[40:43], s63 offen nt
    s_add_u32 s63, s63, 8192
    buffer_load_dwordx4 v[20:23], v15, s[44:47], s86 offen offset:0
    buffer_load_dwordx4 v[36:39], v15, s[44:47], s86 offen offset:2048
    buffer_load_dwordx4 a[136:139], v14, s[40:43], s63 offen nt
    s_add_u32 s63, s63, 8192
    buffer_load_dwordx4 a[140:143], v14, s[40:43], s63 offen nt
    s_add_u32 s63, s63, 8192
    buffer_load_dwordx4 a[144:147], v14, s[40:43], s63 offen nt
    s_add_u32 s63, s63, 8192
    buffer_load_dwordx4 a[148:151], v14, s[40:43], s63 offen nt
    s_add_u32 s63, s63, 8192
    buffer_load_dwordx4 a[152:155], v14, s[40:43], s63 offen nt
    s_add_u32 s63, s63, 8192
    buffer_load_dwordx4 a[156:159], v14, s[40:43], s63 offen nt
    s_add_u32 s63, s63, 8192
    s_load_dword s35, s[30:31], 0
    s_mov_b32 s48, s30
    s_and_b32 s49, s31, 0xffff
    s_mov_b32 s50, 8388608
    s_mov_b32 s51, 0x20000
    s_mov_b32 s82, 0xffffff00
    s_mov_b32 s83, 0x3e0293ee
    s_mov_b32 s84, 2097152
    v_and_b32 v4, 1, v1
    v_lshlrev_b32 v4, 4, v4
    v_mov_b32 v5, 0xffff
    v_lshlrev_b32 v4, v4, v5
    v_bfe_u32 v5, v1, 1, 2
    v_cmp_eq_u32 vcc, 0, v5
    s_nop 1
    v_cndmask_b32 v10, 0, v4, vcc
    v_cmp_eq_u32 vcc, 1, v5
    s_nop 1
    v_cndmask_b32 v11, 0, v4, vcc
    v_cmp_eq_u32 vcc, 2, v5
    s_nop 1
    v_cndmask_b32 v12, 0, v4, vcc
    v_cmp_eq_u32 vcc, 3, v5
    s_nop 1
    v_cndmask_b32 v13, 0, v4, vcc
    buffer_load_dwordx4 v[24:27], v15, s[44:47], s86 offen offset:16
    buffer_load_dwordx4 v[40:43], v15, s[44:47], s86 offen offset:2064
    buffer_load_dwordx4 v[28:31], v15, s[44:47], s86 offen offset:32
    buffer_load_dwordx4 v[44:47], v15, s[44:47], s86 offen offset:2080
    buffer_load_dwordx4 v[32:35], v15, s[44:47], s86 offen offset:48
    buffer_load_dwordx4 v[48:51], v15, s[44:47], s86 offen offset:2096
    s_lshl_b32 s38, s61, 10
    s_add_u32 s36, s38, 65536
    s_lshl_b32 s38, s34, 8
    s_add_u32 s36, s38, s36
    v_mov_b32 v19, 0
    s_cmp_eq_u32 s33, 0
    s_cselect_b32 s38, s36, 8388608
    s_mov_b64 exec, 1
    buffer_store_dword v19, v19, s[48:51], s38 offen sc1
    s_mov_b64 exec, -1
    s_mov_b32 s80, 0x01000100
    s_mov_b32 s81, 0x03020302
    s_waitcnt vmcnt(13)
    buffer_load_dwordx4 a[160:163], v14, s[40:43], s63 offen nt
    s_add_u32 s63, s63, 8192
    v_perm_b32 v4, v20, v20, s80
    v_perm_b32 v5, v36, v36, s80
    v_and_b32 v52, v4, v10
    v_and_b32 v53, v4, v11
    v_and_b32 v54, v4, v12
    v_and_b32 v55, v4, v13
    v_and_b32 v56, v5, v10
    v_and_b32 v57, v5, v11
    v_and_b32 v58, v5, v12
    v_and_b32 v59, v5, v13
    v_mfma_f32_16x16x32_bf16 v[60:63], a[128:131], v[52:55], 0
    s_nop 0
    v_mfma_f32_16x16x32_bf16 v[64:67], a[128:131], v[56:59], 0
    buffer_load_dwordx4 a[164:167], v14, s[40:43], s63 offen nt
    s_add_u32 s63, s63, 8192
    v_perm_b32 v4, v20, v20, s81
    v_perm_b32 v5, v36, v36, s81
    v_and_b32 v52, v4, v10
    v_and_b32 v53, v4, v11
    v_and_b32 v54, v4, v12
    v_and_b32 v55, v4, v13
    v_and_b32 v56, v5, v10
    v_and_b32 v57, v5, v11
    v_and_b32 v58, v5, v12
    v_and_b32 v59, v5, v13
    v_mfma_f32_16x16x32_bf16 v[60:63], a[132:135], v[52:55], v[60:63]
    s_nop 0
    v_mfma_f32_16x16x32_bf16 v[64:67], a[132:135], v[56:59], v[64:67]
    s_waitcnt vmcnt(14)
    buffer_load_dwordx4 a[168:171], v14, s[40:43], s63 offen nt
    s_add_u32 s63, s63, 8192
    v_perm_b32 v4, v21, v21, s80
    v_perm_b32 v5, v37, v37, s80
    v_and_b32 v52, v4, v10
    v_and_b32 v53, v4, v11
    v_and_b32 v54, v4, v12
    v_and_b32 v55, v4, v13
    v_and_b32 v56, v5, v10
    v_and_b32 v57, v5, v11
    v_and_b32 v58, v5, v12
    v_and_b32 v59, v5, v13
    v_mfma_f32_16x16x32_bf16 v[60:63], a[136:139], v[52:55], v[60:63]
    s_nop 0
    v_mfma_f32_16x16x32_bf16 v[64:67], a[136:139], v[56:59], v[64:67]
    s_waitcnt vmcnt(14)
    buffer_load_dwordx4 a[172:175], v14, s[40:43], s63 offen nt
    s_add_u32 s63, s63, 8192
    v_perm_b32 v4, v21, v21, s81
    v_perm_b32 v5, v37, v37, s81
    v_and_b32 v52, v4, v10
    v_and_b32 v53, v4, v11
    v_and_b32 v54, v4, v12
    v_and_b32 v55, v4, v13
    v_and_b32 v56, v5, v10
    v_and_b32 v57, v5, v11
    v_and_b32 v58, v5, v12
    v_and_b32 v59, v5, v13
    v_mfma_f32_16x16x32_bf16 v[60:63], a[140:143], v[52:55], v[60:63]
    s_nop 0
    v_mfma_f32_16x16x32_bf16 v[64:67], a[140:143], v[56:59], v[64:67]
    s_waitcnt vmcnt(14)
    buffer_load_dwordx4 a[176:179], v14, s[40:43], s63 offen nt
    s_add_u32 s63, s63, 8192
    v_lshrrev_b32 v4, 2, v3
    v_and_b32 v5, 3, v3
    v_lshlrev_b32 v76, 8, v4
    v_lshlrev_b32 v126, 8, v2
    v_lshl_add_u32 v76, v2, 6, v76
    v_lshl_add_u32 v76, v5, 4, v76
    v_lshl_add_u32 v126, v3, 4, v126
    v_xor_b32 v77, 32768, v76
    v_xor_b32 v127, 32768, v126
    s_add_u32 s3, s34, s33
    s_and_b32 s3, s3, 3
    s_lshl_b32 s89, s3, 5
    s_add_u32 s89, s89, s32
    s_lshl_b32 s89, s89, 20
    s_mul_i32 s88, s32, 8
    s_add_u32 s88, s88, s3
    s_lshl_b32 s87, s33, 0
    v_perm_b32 v4, v22, v22, s80
    v_perm_b32 v5, v38, v38, s80
    v_and_b32 v52, v4, v10
    v_and_b32 v53, v4, v11
    v_and_b32 v54, v4, v12
    v_and_b32 v55, v4, v13
    v_and_b32 v56, v5, v10
    v_and_b32 v57, v5, v11
    v_and_b32 v58, v5, v12
    v_and_b32 v59, v5, v13
    v_mfma_f32_16x16x32_bf16 v[60:63], a[144:147], v[52:55], v[60:63]
    s_nop 0
    v_mfma_f32_16x16x32_bf16 v[64:67], a[144:147], v[56:59], v[64:67]
    s_waitcnt vmcnt(14)
    buffer_load_dwordx4 a[180:183], v14, s[40:43], s63 offen nt
    s_add_u32 s63, s63, 8192
    v_perm_b32 v4, v22, v22, s81
    v_perm_b32 v5, v38, v38, s81
    v_and_b32 v52, v4, v10
    v_and_b32 v53, v4, v11
    v_and_b32 v54, v4, v12
    v_and_b32 v55, v4, v13
    v_and_b32 v56, v5, v10
    v_and_b32 v57, v5, v11
    v_and_b32 v58, v5, v12
    v_and_b32 v59, v5, v13
    v_mfma_f32_16x16x32_bf16 v[60:63], a[148:151], v[52:55], v[60:63]
    s_nop 0
    v_mfma_f32_16x16x32_bf16 v[64:67], a[148:151], v[56:59], v[64:67]
    s_waitcnt vmcnt(14)
    buffer_load_dwordx4 a[184:187], v14, s[40:43], s63 offen nt
    s_add_u32 s63, s63, 8192
    v_perm_b32 v4, v23, v23, s80
    v_perm_b32 v5, v39, v39, s80
    v_and_b32 v52, v4, v10
    v_and_b32 v53, v4, v11
    v_and_b32 v54, v4, v12
    v_and_b32 v55, v4, v13
    v_and_b32 v56, v5, v10
    v_and_b32 v57, v5, v11
    v_and_b32 v58, v5, v12
    v_and_b32 v59, v5, v13
    v_mfma_f32_16x16x32_bf16 v[60:63], a[152:155], v[52:55], v[60:63]
    s_nop 0
    v_mfma_f32_16x16x32_bf16 v[64:67], a[152:155], v[56:59], v[64:67]
    s_waitcnt vmcnt(14)
    buffer_load_dwordx4 a[188:191], v14, s[40:43], s63 offen nt
    s_add_u32 s63, s63, 8192
    v_perm_b32 v4, v23, v23, s81
    v_perm_b32 v5, v39, v39, s81
    v_and_b32 v52, v4, v10
    v_and_b32 v53, v4, v11
    v_and_b32 v54, v4, v12
    v_and_b32 v55, v4, v13
    v_and_b32 v56, v5, v10
    v_and_b32 v57, v5, v11
    v_and_b32 v58, v5, v12
    v_and_b32 v59, v5, v13
    v_mfma_f32_16x16x32_bf16 v[60:63], a[156:159], v[52:55], v[60:63]
    s_nop 0
    v_mfma_f32_16x16x32_bf16 v[64:67], a[156:159], v[56:59], v[64:67]
    s_waitcnt vmcnt(13)
    s_waitcnt vmcnt(7)
    buffer_load_dwordx4 a[192:195], v14, s[40:43], s63 offen nt
    s_add_u32 s63, s63, 8192
    s_mov_b32 s52, s18
    s_and_b32 s53, s19, 0xffff
    s_mov_b32 s54, 134217728
    s_mov_b32 s55, 0x20000
    s_mov_b32 s56, s20
    s_and_b32 s57, s21, 0xffff
    s_mov_b32 s58, 134217728
    s_mov_b32 s59, 0x20000
    v_perm_b32 v4, v24, v24, s80
    v_perm_b32 v5, v40, v40, s80
    v_and_b32 v52, v4, v10
    v_and_b32 v53, v4, v11
    v_and_b32 v54, v4, v12
    v_and_b32 v55, v4, v13
    v_and_b32 v56, v5, v10
    v_and_b32 v57, v5, v11
    v_and_b32 v58, v5, v12
    v_and_b32 v59, v5, v13
    v_mfma_f32_16x16x32_bf16 v[60:63], a[160:163], v[52:55], v[60:63]
    s_nop 0
    v_mfma_f32_16x16x32_bf16 v[64:67], a[160:163], v[56:59], v[64:67]
    s_waitcnt vmcnt(7)
    buffer_load_dwordx4 a[196:199], v14, s[40:43], s63 offen nt
    s_add_u32 s63, s63, 8192
    v_perm_b32 v4, v24, v24, s81
    v_perm_b32 v5, v40, v40, s81
    v_and_b32 v52, v4, v10
    v_and_b32 v53, v4, v11
    v_and_b32 v54, v4, v12
    v_and_b32 v55, v4, v13
    v_and_b32 v56, v5, v10
    v_and_b32 v57, v5, v11
    v_and_b32 v58, v5, v12
    v_and_b32 v59, v5, v13
    v_mfma_f32_16x16x32_bf16 v[60:63], a[164:167], v[52:55], v[60:63]
    s_nop 0
    v_mfma_f32_16x16x32_bf16 v[64:67], a[164:167], v[56:59], v[64:67]
    s_waitcnt vmcnt(7)
    buffer_load_dwordx4 a[200:203], v14, s[40:43], s63 offen nt
    s_add_u32 s63, s63, 8192
    v_perm_b32 v4, v25, v25, s80
    v_perm_b32 v5, v41, v41, s80
    v_and_b32 v52, v4, v10
    v_and_b32 v53, v4, v11
    v_and_b32 v54, v4, v12
    v_and_b32 v55, v4, v13
    v_and_b32 v56, v5, v10
    v_and_b32 v57, v5, v11
    v_and_b32 v58, v5, v12
    v_and_b32 v59, v5, v13
    v_mfma_f32_16x16x32_bf16 v[60:63], a[168:171], v[52:55], v[60:63]
    s_nop 0
    v_mfma_f32_16x16x32_bf16 v[64:67], a[168:171], v[56:59], v[64:67]
    s_waitcnt vmcnt(7)
    buffer_load_dwordx4 a[204:207], v14, s[40:43], s63 offen nt
    s_add_u32 s63, s63, 8192
    v_perm_b32 v4, v25, v25, s81
    v_perm_b32 v5, v41, v41, s81
    v_and_b32 v52, v4, v10
    v_and_b32 v53, v4, v11
    v_and_b32 v54, v4, v12
    v_and_b32 v55, v4, v13
    v_and_b32 v56, v5, v10
    v_and_b32 v57, v5, v11
    v_and_b32 v58, v5, v12
    v_and_b32 v59, v5, v13
    v_mfma_f32_16x16x32_bf16 v[60:63], a[172:175], v[52:55], v[60:63]
    s_nop 0
    v_mfma_f32_16x16x32_bf16 v[64:67], a[172:175], v[56:59], v[64:67]
    s_waitcnt vmcnt(7)
    buffer_load_dwordx4 a[208:211], v14, s[40:43], s63 offen nt
    s_add_u32 s63, s63, 8192
    v_mov_b32 v120, 0xff7f0000
    v_mov_b32 v121, 0
    v_mov_b32 v18, 1
    v_mov_b32 v116, 0
    v_mov_b32 v117, 0
    v_mov_b32 v118, 0
    v_mov_b32 v119, 0
    s_lshl_b32 s38, s32, 10
    s_add_u32 s96, s38, 65536
    s_lshl_b32 s38, s3, 8
    s_add_u32 s96, s38, s96
    v_mov_b32 v9, s96
    s_lshl_b32 s38, s32, 15
    s_add_u32 s96, s38, 1048576
    s_lshl_b32 s38, s3, 13
    s_add_u32 s96, s38, s96
    s_lshl_b32 s38, s33, 10
    s_add_u32 s96, s38, s96
    v_and_b32 v5, 3, v3
    v_lshlrev_b32 v78, 7, v2
    v_lshl_add_u32 v78, v5, 5, v78
    s_lshl_b32 s38, s32, 12
    s_add_u32 s91, s38, 262144
    s_lshl_b32 s38, s3, 9
    s_add_u32 s91, s38, s91
    v_lshlrev_b32 v4, 7, v2
    v_lshl_add_u32 v4, v3, 4, v4
    v_mov_b32 v5, 512
    v_cmp_gt_u32 vcc, 8, v3
    s_nop 1
    v_cndmask_b32 v79, v5, v4, vcc
    v_perm_b32 v4, v26, v26, s80
    v_perm_b32 v5, v42, v42, s80
    v_and_b32 v52, v4, v10
    v_and_b32 v53, v4, v11
    v_and_b32 v54, v4, v12
    v_and_b32 v55, v4, v13
    v_and_b32 v56, v5, v10
    v_and_b32 v57, v5, v11
    v_and_b32 v58, v5, v12
    v_and_b32 v59, v5, v13
    v_mfma_f32_16x16x32_bf16 v[60:63], a[176:179], v[52:55], v[60:63]
    s_nop 0
    v_mfma_f32_16x16x32_bf16 v[64:67], a[176:179], v[56:59], v[64:67]
    s_waitcnt vmcnt(7)
    buffer_load_dwordx4 a[212:215], v14, s[40:43], s63 offen nt
    s_add_u32 s63, s63, 8192
    v_perm_b32 v4, v26, v26, s81
    v_perm_b32 v5, v42, v42, s81
    v_and_b32 v52, v4, v10
    v_and_b32 v53, v4, v11
    v_and_b32 v54, v4, v12
    v_and_b32 v55, v4, v13
    v_and_b32 v56, v5, v10
    v_and_b32 v57, v5, v11
    v_and_b32 v58, v5, v12
    v_and_b32 v59, v5, v13
    v_mfma_f32_16x16x32_bf16 v[60:63], a[180:183], v[52:55], v[60:63]
    s_nop 0
    v_mfma_f32_16x16x32_bf16 v[64:67], a[180:183], v[56:59], v[64:67]
    s_waitcnt vmcnt(7)
    buffer_load_dwordx4 a[216:219], v14, s[40:43], s63 offen nt
    s_add_u32 s63, s63, 8192
    v_perm_b32 v4, v27, v27, s80
    v_perm_b32 v5, v43, v43, s80
    v_and_b32 v52, v4, v10
    v_and_b32 v53, v4, v11
    v_and_b32 v54, v4, v12
    v_and_b32 v55, v4, v13
    v_and_b32 v56, v5, v10
    v_and_b32 v57, v5, v11
    v_and_b32 v58, v5, v12
    v_and_b32 v59, v5, v13
    v_mfma_f32_16x16x32_bf16 v[60:63], a[184:187], v[52:55], v[60:63]
    s_nop 0
    v_mfma_f32_16x16x32_bf16 v[64:67], a[184:187], v[56:59], v[64:67]
    s_waitcnt vmcnt(7)
    buffer_load_dwordx4 a[220:223], v14, s[40:43], s63 offen nt
    s_add_u32 s63, s63, 8192
    v_perm_b32 v4, v27, v27, s81
    v_perm_b32 v5, v43, v43, s81
    v_and_b32 v52, v4, v10
    v_and_b32 v53, v4, v11
    v_and_b32 v54, v4, v12
    v_and_b32 v55, v4, v13
    v_and_b32 v56, v5, v10
    v_and_b32 v57, v5, v11
    v_and_b32 v58, v5, v12
    v_and_b32 v59, v5, v13
    v_mfma_f32_16x16x32_bf16 v[60:63], a[188:191], v[52:55], v[60:63]
    s_nop 0
    v_mfma_f32_16x16x32_bf16 v[64:67], a[188:191], v[56:59], v[64:67]
    s_waitcnt vmcnt(7)
    buffer_load_dwordx4 a[224:227], v14, s[40:43], s63 offen nt
    s_add_u32 s63, s63, 8192
    v_perm_b32 v4, v28, v28, s80
    v_perm_b32 v5, v44, v44, s80
    v_and_b32 v52, v4, v10
    v_and_b32 v53, v4, v11
    v_and_b32 v54, v4, v12
    v_and_b32 v55, v4, v13
    v_and_b32 v56, v5, v10
    v_and_b32 v57, v5, v11
    v_and_b32 v58, v5, v12
    v_and_b32 v59, v5, v13
    v_mfma_f32_16x16x32_bf16 v[60:63], a[192:195], v[52:55], v[60:63]
    s_nop 0
    v_mfma_f32_16x16x32_bf16 v[64:67], a[192:195], v[56:59], v[64:67]
    s_waitcnt vmcnt(7)
    buffer_load_dwordx4 a[228:231], v14, s[40:43], s63 offen nt
    s_add_u32 s63, s63, 8192
    v_perm_b32 v4, v28, v28, s81
    v_perm_b32 v5, v44, v44, s81
    v_and_b32 v52, v4, v10
    v_and_b32 v53, v4, v11
    v_and_b32 v54, v4, v12
    v_and_b32 v55, v4, v13
    v_and_b32 v56, v5, v10
    v_and_b32 v57, v5, v11
    v_and_b32 v58, v5, v12
    v_and_b32 v59, v5, v13
    v_mfma_f32_16x16x32_bf16 v[60:63], a[196:199], v[52:55], v[60:63]
    s_nop 0
    v_mfma_f32_16x16x32_bf16 v[64:67], a[196:199], v[56:59], v[64:67]
    s_waitcnt vmcnt(7)
    buffer_load_dwordx4 a[232:235], v14, s[40:43], s63 offen nt
    s_add_u32 s63, s63, 8192
    v_perm_b32 v4, v29, v29, s80
    v_perm_b32 v5, v45, v45, s80
    v_and_b32 v52, v4, v10
    v_and_b32 v53, v4, v11
    v_and_b32 v54, v4, v12
    v_and_b32 v55, v4, v13
    v_and_b32 v56, v5, v10
    v_and_b32 v57, v5, v11
    v_and_b32 v58, v5, v12
    v_and_b32 v59, v5, v13
    v_mfma_f32_16x16x32_bf16 v[60:63], a[200:203], v[52:55], v[60:63]
    s_nop 0
    v_mfma_f32_16x16x32_bf16 v[64:67], a[200:203], v[56:59], v[64:67]
    s_waitcnt vmcnt(7)
    buffer_load_dwordx4 a[236:239], v14, s[40:43], s63 offen nt
    s_add_u32 s63, s63, 8192
    v_perm_b32 v4, v29, v29, s81
    v_perm_b32 v5, v45, v45, s81
    v_and_b32 v52, v4, v10
    v_and_b32 v53, v4, v11
    v_and_b32 v54, v4, v12
    v_and_b32 v55, v4, v13
    v_and_b32 v56, v5, v10
    v_and_b32 v57, v5, v11
    v_and_b32 v58, v5, v12
    v_and_b32 v59, v5, v13
    v_mfma_f32_16x16x32_bf16 v[60:63], a[204:207], v[52:55], v[60:63]
    s_nop 0
    v_mfma_f32_16x16x32_bf16 v[64:67], a[204:207], v[56:59], v[64:67]
    s_waitcnt vmcnt(7)
    buffer_load_dwordx4 a[240:243], v14, s[40:43], s63 offen nt
    s_add_u32 s63, s63, 8192
    v_perm_b32 v4, v30, v30, s80
    v_perm_b32 v5, v46, v46, s80
    v_and_b32 v52, v4, v10
    v_and_b32 v53, v4, v11
    v_and_b32 v54, v4, v12
    v_and_b32 v55, v4, v13
    v_and_b32 v56, v5, v10
    v_and_b32 v57, v5, v11
    v_and_b32 v58, v5, v12
    v_and_b32 v59, v5, v13
    v_mfma_f32_16x16x32_bf16 v[60:63], a[208:211], v[52:55], v[60:63]
    s_nop 0
    v_mfma_f32_16x16x32_bf16 v[64:67], a[208:211], v[56:59], v[64:67]
    s_waitcnt vmcnt(7)
    buffer_load_dwordx4 a[244:247], v14, s[40:43], s63 offen nt
    s_add_u32 s63, s63, 8192
    v_perm_b32 v4, v30, v30, s81
    v_perm_b32 v5, v46, v46, s81
    v_and_b32 v52, v4, v10
    v_and_b32 v53, v4, v11
    v_and_b32 v54, v4, v12
    v_and_b32 v55, v4, v13
    v_and_b32 v56, v5, v10
    v_and_b32 v57, v5, v11
    v_and_b32 v58, v5, v12
    v_and_b32 v59, v5, v13
    v_mfma_f32_16x16x32_bf16 v[60:63], a[212:215], v[52:55], v[60:63]
    s_nop 0
    v_mfma_f32_16x16x32_bf16 v[64:67], a[212:215], v[56:59], v[64:67]
    s_waitcnt vmcnt(7)
    buffer_load_dwordx4 a[248:251], v14, s[40:43], s63 offen nt
    s_add_u32 s63, s63, 8192
    v_perm_b32 v4, v31, v31, s80
    v_perm_b32 v5, v47, v47, s80
    v_and_b32 v52, v4, v10
    v_and_b32 v53, v4, v11
    v_and_b32 v54, v4, v12
    v_and_b32 v55, v4, v13
    v_and_b32 v56, v5, v10
    v_and_b32 v57, v5, v11
    v_and_b32 v58, v5, v12
    v_and_b32 v59, v5, v13
    v_mfma_f32_16x16x32_bf16 v[60:63], a[216:219], v[52:55], v[60:63]
    s_nop 0
    v_mfma_f32_16x16x32_bf16 v[64:67], a[216:219], v[56:59], v[64:67]
    s_waitcnt vmcnt(7)
    buffer_load_dwordx4 a[252:255], v14, s[40:43], s63 offen nt
    s_add_u32 s63, s63, 8192
    v_perm_b32 v4, v31, v31, s81
    v_perm_b32 v5, v47, v47, s81
    v_and_b32 v52, v4, v10
    v_and_b32 v53, v4, v11
    v_and_b32 v54, v4, v12
    v_and_b32 v55, v4, v13
    v_and_b32 v56, v5, v10
    v_and_b32 v57, v5, v11
    v_and_b32 v58, v5, v12
    v_and_b32 v59, v5, v13
    v_mfma_f32_16x16x32_bf16 v[60:63], a[220:223], v[52:55], v[60:63]
    s_nop 0
    v_mfma_f32_16x16x32_bf16 v[64:67], a[220:223], v[56:59], v[64:67]
    s_waitcnt vmcnt(7)
    v_perm_b32 v4, v32, v32, s80
    v_perm_b32 v5, v48, v48, s80
    v_and_b32 v52, v4, v10
    v_and_b32 v53, v4, v11
    v_and_b32 v54, v4, v12
    v_and_b32 v55, v4, v13
    v_and_b32 v56, v5, v10
    v_and_b32 v57, v5, v11
    v_and_b32 v58, v5, v12
    v_and_b32 v59, v5, v13
    v_mfma_f32_16x16x32_bf16 v[60:63], a[224:227], v[52:55], v[60:63]
    s_nop 0
    v_mfma_f32_16x16x32_bf16 v[64:67], a[224:227], v[56:59], v[64:67]
    s_waitcnt vmcnt(6)
    s_add_u32 s39, s87, s88
    s_bfe_u32 s37, s39, 0x30000
    s_lshl_b32 s37, s37, 12
    s_add_u32 s85, s37, s89
    s_bfe_u32 s37, s39, 0x10003
    s_lshl_b32 s37, s37, 11
    s_add_u32 s85, s37, s85
    s_bfe_u32 s37, s39, 0x40004
    s_lshl_b32 s37, s37, 16
    s_add_u32 s85, s37, s85
    buffer_load_dwordx4 v[128:131], v76, s[52:55], s85 offen offset:0 nt
    v_perm_b32 v4, v32, v32, s81
    v_perm_b32 v5, v48, v48, s81
    v_and_b32 v52, v4, v10
    v_and_b32 v53, v4, v11
    v_and_b32 v54, v4, v12
    v_and_b32 v55, v4, v13
    v_and_b32 v56, v5, v10
    v_and_b32 v57, v5, v11
    v_and_b32 v58, v5, v12
    v_and_b32 v59, v5, v13
    v_mfma_f32_16x16x32_bf16 v[60:63], a[228:231], v[52:55], v[60:63]
    s_nop 0
    v_mfma_f32_16x16x32_bf16 v[64:67], a[228:231], v[56:59], v[64:67]
    s_waitcnt vmcnt(6)
    buffer_load_dwordx4 v[132:135], v77, s[52:55], s85 offen offset:0 nt
    v_perm_b32 v4, v33, v33, s80
    v_perm_b32 v5, v49, v49, s80
    v_and_b32 v52, v4, v10
    v_and_b32 v53, v4, v11
    v_and_b32 v54, v4, v12
    v_and_b32 v55, v4, v13
    v_and_b32 v56, v5, v10
    v_and_b32 v57, v5, v11
    v_and_b32 v58, v5, v12
    v_and_b32 v59, v5, v13
    v_mfma_f32_16x16x32_bf16 v[60:63], a[232:235], v[52:55], v[60:63]
    s_nop 0
    v_mfma_f32_16x16x32_bf16 v[64:67], a[232:235], v[56:59], v[64:67]
    s_waitcnt vmcnt(6)
    buffer_load_dwordx4 v[136:139], v76, s[52:55], s85 offen offset:1024 nt
    v_perm_b32 v4, v33, v33, s81
    v_perm_b32 v5, v49, v49, s81
    v_and_b32 v52, v4, v10
    v_and_b32 v53, v4, v11
    v_and_b32 v54, v4, v12
    v_and_b32 v55, v4, v13
    v_and_b32 v56, v5, v10
    v_and_b32 v57, v5, v11
    v_and_b32 v58, v5, v12
    v_and_b32 v59, v5, v13
    v_mfma_f32_16x16x32_bf16 v[60:63], a[236:239], v[52:55], v[60:63]
    s_nop 0
    v_mfma_f32_16x16x32_bf16 v[64:67], a[236:239], v[56:59], v[64:67]
    s_waitcnt vmcnt(6)
    buffer_load_dwordx4 v[140:143], v77, s[52:55], s85 offen offset:1024 nt
    s_add_u32 s87, s87, 7
    s_add_u32 s39, s87, s88
    s_bfe_u32 s37, s39, 0x30000
    s_lshl_b32 s37, s37, 12
    s_add_u32 s85, s37, s89
    s_bfe_u32 s37, s39, 0x10003
    s_lshl_b32 s37, s37, 11
    s_add_u32 s85, s37, s85
    s_bfe_u32 s37, s39, 0x40004
    s_lshl_b32 s37, s37, 16
    s_add_u32 s85, s37, s85
    v_perm_b32 v4, v34, v34, s80
    v_perm_b32 v5, v50, v50, s80
    v_and_b32 v52, v4, v10
    v_and_b32 v53, v4, v11
    v_and_b32 v54, v4, v12
    v_and_b32 v55, v4, v13
    v_and_b32 v56, v5, v10
    v_and_b32 v57, v5, v11
    v_and_b32 v58, v5, v12
    v_and_b32 v59, v5, v13
    v_mfma_f32_16x16x32_bf16 v[60:63], a[240:243], v[52:55], v[60:63]
    s_nop 0
    v_mfma_f32_16x16x32_bf16 v[64:67], a[240:243], v[56:59], v[64:67]
    s_waitcnt vmcnt(6)
    buffer_load_dwordx4 v[144:147], v76, s[52:55], s85 offen offset:0 nt
    v_perm_b32 v4, v34, v34, s81
    v_perm_b32 v5, v50, v50, s81
    v_and_b32 v52, v4, v10
    v_and_b32 v53, v4, v11
    v_and_b32 v54, v4, v12
    v_and_b32 v55, v4, v13
    v_and_b32 v56, v5, v10
    v_and_b32 v57, v5, v11
    v_and_b32 v58, v5, v12
    v_and_b32 v59, v5, v13
    v_mfma_f32_16x16x32_bf16 v[60:63], a[244:247], v[52:55], v[60:63]
    s_nop 0
    v_mfma_f32_16x16x32_bf16 v[64:67], a[244:247], v[56:59], v[64:67]
    s_waitcnt vmcnt(6)
    buffer_load_dwordx4 v[148:151], v77, s[52:55], s85 offen offset:0 nt
    v_perm_b32 v4, v35, v35, s80
    v_perm_b32 v5, v51, v51, s80
    v_and_b32 v52, v4, v10
    v_and_b32 v53, v4, v11
    v_and_b32 v54, v4, v12
    v_and_b32 v55, v4, v13
    v_and_b32 v56, v5, v10
    v_and_b32 v57, v5, v11
    v_and_b32 v58, v5, v12
    v_and_b32 v59, v5, v13
    v_mfma_f32_16x16x32_bf16 v[60:63], a[248:251], v[52:55], v[60:63]
    s_nop 0
    v_mfma_f32_16x16x32_bf16 v[64:67], a[248:251], v[56:59], v[64:67]
    s_waitcnt vmcnt(6)
    buffer_load_dwordx4 v[152:155], v76, s[52:55], s85 offen offset:1024 nt
    v_perm_b32 v4, v35, v35, s81
    v_perm_b32 v5, v51, v51, s81
    v_and_b32 v52, v4, v10
    v_and_b32 v53, v4, v11
    v_and_b32 v54, v4, v12
    v_and_b32 v55, v4, v13
    v_and_b32 v56, v5, v10
    v_and_b32 v57, v5, v11
    v_and_b32 v58, v5, v12
    v_and_b32 v59, v5, v13
    v_mfma_f32_16x16x32_bf16 v[60:63], a[252:255], v[52:55], v[60:63]
    s_nop 0
    v_mfma_f32_16x16x32_bf16 v[64:67], a[252:255], v[56:59], v[64:67]
    s_lshl_b32 s38, s34, 11
    v_lshrrev_b32 v4, 3, v3
    v_lshlrev_b32 v4, 9, v4
    v_lshl_add_u32 v4, v2, 7, v4
    v_and_b32 v5, 7, v3
    v_lshl_add_u32 v4, v5, 2, v4
    v_add_u32 v4, s38, v4
    ds_write_b32 v4, v60 offset:0
    ds_write_b32 v4, v61 offset:32
    ds_write_b32 v4, v62 offset:64
    ds_write_b32 v4, v63 offset:96
    ds_write_b32 v4, v64 offset:1024
    ds_write_b32 v4, v65 offset:1056
    ds_write_b32 v4, v66 offset:1088
    ds_write_b32 v4, v67 offset:1120
    s_lshl_b32 s38, s34, 9
    v_and_b32 v5, 31, v1
    v_lshl_add_u32 v5, v5, 4, s38
    s_waitcnt lgkmcnt(0)
    s_add_u32 s35, s35, 0x5b
    s_and_b32 s35, s35, 0xff
    v_mov_b32 v8, s35
    s_barrier
    ds_read_b128 v[20:23], v5 offset:0
    ds_read_b128 v[24:27], v5 offset:2048
    ds_read_b128 v[28:31], v5 offset:4096
    ds_read_b128 v[32:35], v5 offset:6144
    s_lshl_b32 s38, s61, 12
    s_add_u32 s36, s38, 262144
    s_lshl_b32 s38, s33, 11
    s_add_u32 s36, s38, s36
    s_waitcnt lgkmcnt(0)
    v_add_f32 v20, v20, v24
    v_add_f32 v28, v28, v32
    v_add_f32 v21, v21, v25
    v_add_f32 v29, v29, v33
    v_add_f32 v22, v22, v26
    v_add_f32 v30, v30, v34
    v_add_f32 v23, v23, v27
    v_add_f32 v31, v31, v35
    v_add_f32 v20, v20, v28
    v_add_f32 v21, v21, v29
    v_add_f32 v22, v22, v30
    v_add_f32 v23, v23, v31
    v_and_or_b32 v20, v20, s82, v8
    v_and_or_b32 v21, v21, s82, v8
    v_and_or_b32 v22, v22, s82, v8
    v_and_or_b32 v23, v23, s82, v8
    s_mov_b32 exec_lo, 0xffffffff
    s_mov_b32 exec_hi, 0x0
    buffer_store_dwordx4 v[20:23], v5, s[48:51], s36 offen sc1
    s_mov_b64 exec, -1
    s_waitcnt vmcnt(7)
    buffer_load_dwordx4 v[156:159], v77, s[52:55], s85 offen offset:1024 nt
    s_add_u32 s87, s87, 7
    s_add_u32 s39, s87, s88
    s_bfe_u32 s37, s39, 0x30000
    s_lshl_b32 s37, s37, 12
    s_add_u32 s85, s37, s89
    s_bfe_u32 s37, s39, 0x10003
    s_lshl_b32 s37, s37, 11
    s_add_u32 s85, s37, s85
    s_bfe_u32 s37, s39, 0x40004
    s_lshl_b32 s37, s37, 16
    s_add_u32 s85, s37, s85
    s_waitcnt vmcnt(7)
    buffer_load_dwordx4 v[160:163], v76, s[52:55], s85 offen offset:0 nt
    s_waitcnt vmcnt(7)
    buffer_load_dwordx4 v[164:167], v77, s[52:55], s85 offen offset:0 nt
    s_waitcnt vmcnt(7)
    buffer_load_dwordx4 v[168:171], v76, s[52:55], s85 offen offset:1024 nt
    s_waitcnt vmcnt(7)
    buffer_load_dwordx4 v[172:175], v77, s[52:55], s85 offen offset:1024 nt
    s_add_u32 s87, s87, 7
    s_add_u32 s39, s87, s88
    s_bfe_u32 s37, s39, 0x30000
    s_lshl_b32 s37, s37, 12
    s_add_u32 s85, s37, s89
    s_bfe_u32 s37, s39, 0x10003
    s_lshl_b32 s37, s37, 11
    s_add_u32 s85, s37, s85
    s_bfe_u32 s37, s39, 0x40004
    s_lshl_b32 s37, s37, 16
    s_add_u32 s85, s37, s85
    s_waitcnt vmcnt(7)
    buffer_load_dwordx4 v[176:179], v76, s[52:55], s85 offen offset:0 nt
    s_waitcnt vmcnt(7)
    buffer_load_dwordx4 v[180:183], v77, s[52:55], s85 offen offset:0 nt
    s_waitcnt vmcnt(6)
    buffer_load_dwordx4 v[184:187], v76, s[52:55], s85 offen offset:1024 nt
    s_waitcnt vmcnt(6)
    buffer_load_dwordx4 v[188:191], v77, s[52:55], s85 offen offset:1024 nt
    s_add_u32 s87, s87, 7
    s_add_u32 s39, s87, s88
    s_bfe_u32 s37, s39, 0x30000
    s_lshl_b32 s37, s37, 12
    s_add_u32 s85, s37, s89
    s_bfe_u32 s37, s39, 0x10003
    s_lshl_b32 s37, s37, 11
    s_add_u32 s85, s37, s85
    s_bfe_u32 s37, s39, 0x40004
    s_lshl_b32 s37, s37, 16
    s_add_u32 s85, s37, s85
    s_waitcnt vmcnt(6)
    buffer_load_dwordx4 v[192:195], v76, s[52:55], s85 offen offset:0 nt
    s_waitcnt vmcnt(6)
    buffer_load_dwordx4 v[196:199], v77, s[52:55], s85 offen offset:0 nt
    s_waitcnt vmcnt(6)
    buffer_load_dwordx4 v[200:203], v76, s[52:55], s85 offen offset:1024 nt
    s_waitcnt vmcnt(6)
    buffer_load_dwordx4 v[204:207], v77, s[52:55], s85 offen offset:1024 nt
    s_add_u32 s87, s87, 7
    s_add_u32 s39, s87, s88
    s_bfe_u32 s37, s39, 0x30000
    s_lshl_b32 s37, s37, 12
    s_add_u32 s85, s37, s89
    s_bfe_u32 s37, s39, 0x10003
    s_lshl_b32 s37, s37, 11
    s_add_u32 s85, s37, s85
    s_bfe_u32 s37, s39, 0x40004
    s_lshl_b32 s37, s37, 16
    s_add_u32 s85, s37, s85
    s_waitcnt vmcnt(6)
    buffer_load_dwordx4 v[208:211], v76, s[52:55], s85 offen offset:0 nt
    s_waitcnt vmcnt(6)
    buffer_load_dwordx4 v[212:215], v77, s[52:55], s85 offen offset:0 nt
    s_waitcnt vmcnt(6)
    buffer_load_dwordx4 v[216:219], v76, s[52:55], s85 offen offset:1024 nt
    s_waitcnt vmcnt(6)
    buffer_load_dwordx4 v[220:223], v77, s[52:55], s85 offen offset:1024 nt
    s_add_u32 s87, s87, 7
    s_add_u32 s39, s87, s88
    s_bfe_u32 s37, s39, 0x30000
    s_lshl_b32 s37, s37, 12
    s_add_u32 s85, s37, s89
    s_bfe_u32 s37, s39, 0x10003
    s_lshl_b32 s37, s37, 11
    s_add_u32 s85, s37, s85
    s_bfe_u32 s37, s39, 0x40004
    s_lshl_b32 s37, s37, 16
    s_add_u32 s85, s37, s85
    s_waitcnt vmcnt(6)
    buffer_load_dwordx4 v[224:227], v76, s[52:55], s85 offen offset:0 nt
    s_waitcnt vmcnt(6)
    buffer_load_dwordx4 v[228:231], v77, s[52:55], s85 offen offset:0 nt
    s_waitcnt vmcnt(6)
    buffer_load_dwordx4 v[232:235], v76, s[52:55], s85 offen offset:1024 nt
    s_waitcnt vmcnt(6)
    buffer_load_dwordx4 v[236:239], v77, s[52:55], s85 offen offset:1024 nt
    s_add_u32 s87, s87, 7
    s_add_u32 s39, s87, s88
    s_bfe_u32 s37, s39, 0x30000
    s_lshl_b32 s37, s37, 12
    s_add_u32 s85, s37, s89
    s_bfe_u32 s37, s39, 0x10003
    s_lshl_b32 s37, s37, 11
    s_add_u32 s85, s37, s85
    s_bfe_u32 s37, s39, 0x40004
    s_lshl_b32 s37, s37, 16
    s_add_u32 s85, s37, s85
    s_waitcnt vmcnt(6)
    buffer_load_dwordx4 v[240:243], v76, s[52:55], s85 offen offset:0 nt
    s_waitcnt vmcnt(6)
    buffer_load_dwordx4 v[244:247], v77, s[52:55], s85 offen offset:0 nt
    s_waitcnt vmcnt(6)
    buffer_load_dwordx4 v[248:251], v76, s[52:55], s85 offen offset:1024 nt
    s_waitcnt vmcnt(6)
    buffer_load_dwordx4 v[252:255], v77, s[52:55], s85 offen offset:1024 nt
    s_add_u32 s87, s87, 7
    s_add_u32 s39, s87, s88
    s_bfe_u32 s37, s39, 0x30000
    s_lshl_b32 s37, s37, 12
    s_add_u32 s85, s37, s89
    s_bfe_u32 s37, s39, 0x10003
    s_lshl_b32 s37, s37, 11
    s_add_u32 s85, s37, s85
    s_bfe_u32 s37, s39, 0x40004
    s_lshl_b32 s37, s37, 16
    s_add_u32 s85, s37, s85
    s_waitcnt vmcnt(6)
    buffer_load_dwordx4 a[0:3], v76, s[52:55], s85 offen offset:0 nt
    s_waitcnt vmcnt(6)
    buffer_load_dwordx4 a[4:7], v77, s[52:55], s85 offen offset:0 nt
    buffer_load_dwordx4 v[68:71], v78, s[48:51], s91 offen offset:0 sc1
    buffer_load_dwordx4 v[72:75], v78, s[48:51], s91 offen offset:16 sc1
    s_waitcnt vmcnt(8)
    buffer_load_dwordx4 a[8:11], v76, s[52:55], s85 offen offset:1024 nt
    s_waitcnt vmcnt(8)
    buffer_load_dwordx4 a[12:15], v77, s[52:55], s85 offen offset:1024 nt
    s_add_u32 s87, s87, 7
    s_add_u32 s39, s87, s88
    s_bfe_u32 s37, s39, 0x30000
    s_lshl_b32 s37, s37, 12
    s_add_u32 s85, s37, s89
    s_bfe_u32 s37, s39, 0x10003
    s_lshl_b32 s37, s37, 11
    s_add_u32 s85, s37, s85
    s_bfe_u32 s37, s39, 0x40004
    s_lshl_b32 s37, s37, 16
    s_add_u32 s85, s37, s85
    s_waitcnt vmcnt(8)
    buffer_load_dwordx4 a[16:19], v76, s[52:55], s85 offen offset:0 nt
    s_waitcnt vmcnt(8)
    buffer_load_dwordx4 a[20:23], v77, s[52:55], s85 offen offset:0 nt
    s_waitcnt vmcnt(8)
    buffer_load_dwordx4 a[24:27], v76, s[52:55], s85 offen offset:1024 nt
    s_waitcnt vmcnt(8)
    buffer_load_dwordx4 a[28:31], v77, s[52:55], s85 offen offset:1024 nt
    s_add_u32 s87, s87, 7
    s_add_u32 s39, s87, s88
    s_bfe_u32 s37, s39, 0x30000
    s_lshl_b32 s37, s37, 12
    s_add_u32 s85, s37, s89
    s_bfe_u32 s37, s39, 0x10003
    s_lshl_b32 s37, s37, 11
    s_add_u32 s85, s37, s85
    s_bfe_u32 s37, s39, 0x40004
    s_lshl_b32 s37, s37, 16
    s_add_u32 s85, s37, s85
    s_waitcnt vmcnt(6)
L_qcheck_18:
    v_xor_b32 v68, s35, v68
    v_xor_b32 v69, s35, v69
    v_xor_b32 v70, s35, v70
    v_xor_b32 v71, s35, v71
    v_xor_b32 v72, s35, v72
    v_xor_b32 v73, s35, v73
    v_xor_b32 v74, s35, v74
    v_xor_b32 v75, s35, v75
    v_or_b32 v4, v68, v69
    v_or3_b32 v4, v4, v70, v71
    v_or3_b32 v4, v4, v72, v73
    v_or3_b32 v4, v4, v74, v75
    v_and_b32 v4, 0xff, v4
    v_cmp_ne_u32 vcc, 0, v4
    s_cbranch_vccz L_qok_19
    buffer_load_dwordx4 v[68:71], v78, s[48:51], s91 offen offset:0 sc1
    buffer_load_dwordx4 v[72:75], v78, s[48:51], s91 offen offset:16 sc1
    s_waitcnt vmcnt(0)
    s_sub_u32 s84, s84, 1
    s_cmp_lg_u32 s84, 0
    s_cbranch_scc1 L_qcheck_18
    s_branch L_end
L_qok_19:
    v_cvt_pk_bf16_f32 v68, v68, v69
    v_cvt_pk_bf16_f32 v69, v70, v71
    v_cvt_pk_bf16_f32 v70, v72, v73
    v_cvt_pk_bf16_f32 v71, v74, v75
    s_mov_b32 vcc_lo, 0xf000f
    s_mov_b32 vcc_hi, 0xf000f
    v_cndmask_b32 v80, 0, v68, vcc
    v_cndmask_b32 v81, 0, v69, vcc
    v_cndmask_b32 v82, 0, v70, vcc
    v_cndmask_b32 v83, 0, v71, vcc
    s_mov_b32 vcc_lo, 0xf000f0
    s_mov_b32 vcc_hi, 0xf000f0
    v_cndmask_b32 v84, 0, v68, vcc
    v_cndmask_b32 v85, 0, v69, vcc
    v_cndmask_b32 v86, 0, v70, vcc
    v_cndmask_b32 v87, 0, v71, vcc
    s_mov_b32 vcc_lo, 0xf000f00
    s_mov_b32 vcc_hi, 0xf000f00
    v_cndmask_b32 v88, 0, v68, vcc
    v_cndmask_b32 v89, 0, v69, vcc
    v_cndmask_b32 v90, 0, v70, vcc
    v_cndmask_b32 v91, 0, v71, vcc
    s_mov_b32 vcc_lo, 0xf000f000
    s_mov_b32 vcc_hi, 0xf000f000
    v_cndmask_b32 v92, 0, v68, vcc
    v_cndmask_b32 v93, 0, v69, vcc
    v_cndmask_b32 v94, 0, v70, vcc
    v_cndmask_b32 v95, 0, v71, vcc
    v_mov_b32 v65, 0xff7f0000
    s_lshl_b32 s38, s34, 14
    s_add_u32 s38, s38, 16384
    v_lshl_add_u32 v64, v1, 2, s38
    buffer_load_dwordx4 a[32:35], v76, s[52:55], s85 offen offset:0 nt
    v_mfma_f32_16x16x32_bf16 v[112:115], v[128:131], v[80:83], 0
    v_mfma_f32_16x16x32_bf16 v[112:115], v[132:135], v[84:87], v[112:115]
    v_mfma_f32_16x16x32_bf16 v[112:115], v[136:139], v[88:91], v[112:115]
    s_waitcnt vmcnt(6)
    buffer_load_dwordx4 a[36:39], v77, s[52:55], s85 offen offset:0 nt
    v_mfma_f32_16x16x32_bf16 v[112:115], v[140:143], v[92:95], v[112:115]
    v_mfma_f32_16x16x32_bf16 v[96:99], v[144:147], v[80:83], 0
    v_mfma_f32_16x16x32_bf16 v[96:99], v[148:151], v[84:87], v[96:99]
    s_waitcnt vmcnt(6)
    buffer_load_dwordx4 a[40:43], v76, s[52:55], s85 offen offset:1024 nt
    v_mfma_f32_16x16x32_bf16 v[96:99], v[152:155], v[88:91], v[96:99]
    s_nop 2
    v_mov_b32_dpp v122, v112 quad_perm:[0,0,0,0] row_mask:0xf bank_mask:0xf
    v_mov_b32_dpp v124, v114 quad_perm:[2,2,2,2] row_mask:0xf bank_mask:0xf
    s_nop 0
    v_add_f32_dpp v122, v113, v122 quad_perm:[1,1,1,1] row_mask:0xf bank_mask:0xf
    v_add_f32_dpp v124, v115, v124 quad_perm:[3,3,3,3] row_mask:0xf bank_mask:0xf
    v_add_f32 v122, v122, v124
    v_max_f32 v65, v65, v122
    ds_write_b32 v64, v122 offset:0
    v_mfma_f32_16x16x32_bf16 v[96:99], v[156:159], v[92:95], v[96:99]
    v_mfma_f32_16x16x32_bf16 v[112:115], v[160:163], v[80:83], 0
    v_mfma_f32_16x16x32_bf16 v[112:115], v[164:167], v[84:87], v[112:115]
    s_waitcnt vmcnt(6)
    buffer_load_dwordx4 a[44:47], v77, s[52:55], s85 offen offset:1024 nt
    s_add_u32 s87, s87, 7
    s_add_u32 s39, s87, s88
    s_bfe_u32 s37, s39, 0x30000
    s_lshl_b32 s37, s37, 12
    s_add_u32 s85, s37, s89
    s_bfe_u32 s37, s39, 0x10003
    s_lshl_b32 s37, s37, 11
    s_add_u32 s85, s37, s85
    s_bfe_u32 s37, s39, 0x40004
    s_lshl_b32 s37, s37, 16
    s_add_u32 s85, s37, s85
    v_mfma_f32_16x16x32_bf16 v[112:115], v[168:171], v[88:91], v[112:115]
    v_mov_b32_dpp v122, v96 quad_perm:[0,0,0,0] row_mask:0xf bank_mask:0xf
    v_mov_b32_dpp v124, v98 quad_perm:[2,2,2,2] row_mask:0xf bank_mask:0xf
    s_nop 0
    v_add_f32_dpp v122, v97, v122 quad_perm:[1,1,1,1] row_mask:0xf bank_mask:0xf
    v_add_f32_dpp v124, v99, v124 quad_perm:[3,3,3,3] row_mask:0xf bank_mask:0xf
    v_add_f32 v122, v122, v124
    v_max_f32 v65, v65, v122
    ds_write_b32 v64, v122 offset:256
    v_mfma_f32_16x16x32_bf16 v[112:115], v[172:175], v[92:95], v[112:115]
    v_mfma_f32_16x16x32_bf16 v[96:99], v[176:179], v[80:83], 0
    s_waitcnt vmcnt(6)
    buffer_load_dwordx4 a[48:51], v76, s[52:55], s85 offen offset:0 nt
    v_mfma_f32_16x16x32_bf16 v[96:99], v[180:183], v[84:87], v[96:99]
    v_mfma_f32_16x16x32_bf16 v[96:99], v[184:187], v[88:91], v[96:99]
    s_nop 2
    v_mov_b32_dpp v122, v112 quad_perm:[0,0,0,0] row_mask:0xf bank_mask:0xf
    v_mov_b32_dpp v124, v114 quad_perm:[2,2,2,2] row_mask:0xf bank_mask:0xf
    s_nop 0
    v_add_f32_dpp v122, v113, v122 quad_perm:[1,1,1,1] row_mask:0xf bank_mask:0xf
    v_add_f32_dpp v124, v115, v124 quad_perm:[3,3,3,3] row_mask:0xf bank_mask:0xf
    v_add_f32 v122, v122, v124
    v_max_f32 v65, v65, v122
    ds_write_b32 v64, v122 offset:512
    v_mfma_f32_16x16x32_bf16 v[96:99], v[188:191], v[92:95], v[96:99]
    v_mfma_f32_16x16x32_bf16 v[112:115], v[192:195], v[80:83], 0
    s_waitcnt vmcnt(6)
    buffer_load_dwordx4 a[52:55], v77, s[52:55], s85 offen offset:0 nt
    v_mfma_f32_16x16x32_bf16 v[112:115], v[196:199], v[84:87], v[112:115]
    v_mfma_f32_16x16x32_bf16 v[112:115], v[200:203], v[88:91], v[112:115]
    s_nop 2
    v_mov_b32_dpp v122, v96 quad_perm:[0,0,0,0] row_mask:0xf bank_mask:0xf
    v_mov_b32_dpp v124, v98 quad_perm:[2,2,2,2] row_mask:0xf bank_mask:0xf
    s_nop 0
    v_add_f32_dpp v122, v97, v122 quad_perm:[1,1,1,1] row_mask:0xf bank_mask:0xf
    v_add_f32_dpp v124, v99, v124 quad_perm:[3,3,3,3] row_mask:0xf bank_mask:0xf
    v_add_f32 v122, v122, v124
    v_max_f32 v65, v65, v122
    ds_write_b32 v64, v122 offset:768
    v_mfma_f32_16x16x32_bf16 v[112:115], v[204:207], v[92:95], v[112:115]
    s_waitcnt vmcnt(6)
    buffer_load_dwordx4 a[56:59], v76, s[52:55], s85 offen offset:1024 nt
    v_mfma_f32_16x16x32_bf16 v[96:99], v[208:211], v[80:83], 0
    v_mfma_f32_16x16x32_bf16 v[96:99], v[212:215], v[84:87], v[96:99]
    v_mfma_f32_16x16x32_bf16 v[96:99], v[216:219], v[88:91], v[96:99]
    s_nop 2
    v_mov_b32_dpp v122, v112 quad_perm:[0,0,0,0] row_mask:0xf bank_mask:0xf
    v_mov_b32_dpp v124, v114 quad_perm:[2,2,2,2] row_mask:0xf bank_mask:0xf
    s_nop 0
    v_add_f32_dpp v122, v113, v122 quad_perm:[1,1,1,1] row_mask:0xf bank_mask:0xf
    v_add_f32_dpp v124, v115, v124 quad_perm:[3,3,3,3] row_mask:0xf bank_mask:0xf
    v_add_f32 v122, v122, v124
    v_max_f32 v65, v65, v122
    ds_write_b32 v64, v122 offset:1024
    v_mfma_f32_16x16x32_bf16 v[96:99], v[220:223], v[92:95], v[96:99]
    s_waitcnt vmcnt(6)
    buffer_load_dwordx4 a[60:63], v77, s[52:55], s85 offen offset:1024 nt
    s_add_u32 s87, s87, 7
    s_add_u32 s39, s87, s88
    s_bfe_u32 s37, s39, 0x30000
    s_lshl_b32 s37, s37, 12
    s_add_u32 s85, s37, s89
    s_bfe_u32 s37, s39, 0x10003
    s_lshl_b32 s37, s37, 11
    s_add_u32 s85, s37, s85
    s_bfe_u32 s37, s39, 0x40004
    s_lshl_b32 s37, s37, 16
    s_add_u32 s85, s37, s85
    v_mfma_f32_16x16x32_bf16 v[112:115], v[224:227], v[80:83], 0
    s_sub_u32 s36, s33, 3
    s_and_b32 s37, s33, 3
    s_cmp_lt_u32 s36, 4
    s_cselect_b64 s[40:41], s[24:25], s[14:15]
    s_cselect_b32 s36, s36, s37
    s_cselect_b32 s45, 262144, 0
    s_cselect_b32 s46, 8388608, 0
    s_add_u32 s45, s45, 524288
    s_add_u32 s46, s46, 196608
    s_mov_b32 s42, 4194304
    s_mov_b32 s43, 0x20000
    s_lshl_b32 s38, s32, 17
    s_add_u32 s44, s38, 0
    s_lshl_b32 s38, s34, 15
    s_add_u32 s44, s38, s44
    s_lshl_b32 s38, s36, 8
    s_add_u32 s44, s38, s44
    s_lshl_b32 s38, s36, 16
    s_add_u32 s45, s38, s45
    s_lshr_b32 s38, s34, 1
    s_lshl_b32 s38, s38, 15
    s_add_u32 s45, s38, s45
    s_lshl_b32 s38, s32, 8
    s_add_u32 s45, s38, s45
    s_bfe_u32 s38, s34, 0x10000
    s_lshl_b32 s38, s38, 7
    s_add_u32 s45, s38, s45
    s_lshl_b32 s38, s32, 11
    s_add_u32 s46, s38, s46
    s_lshl_b32 s38, s34, 9
    s_add_u32 s46, s38, s46
    s_mov_b32 s72, s26
    s_and_b32 s73, s27, 0xffff
    s_mov_b32 s74, 8192
    s_mov_b32 s75, 0x20000
    v_mfma_f32_16x16x32_bf16 v[112:115], v[228:231], v[84:87], v[112:115]
    v_mfma_f32_16x16x32_bf16 v[112:115], v[232:235], v[88:91], v[112:115]
    v_mov_b32_dpp v122, v96 quad_perm:[0,0,0,0] row_mask:0xf bank_mask:0xf
    v_mov_b32_dpp v124, v98 quad_perm:[2,2,2,2] row_mask:0xf bank_mask:0xf
    s_nop 0
    v_add_f32_dpp v122, v97, v122 quad_perm:[1,1,1,1] row_mask:0xf bank_mask:0xf
    v_add_f32_dpp v124, v99, v124 quad_perm:[3,3,3,3] row_mask:0xf bank_mask:0xf
    v_add_f32 v122, v122, v124
    v_max_f32 v65, v65, v122
    ds_write_b32 v64, v122 offset:1280
    s_waitcnt vmcnt(5)
    buffer_load_dwordx4 v[128:131], v76, s[52:55], s85 offen offset:0 nt
    v_mfma_f32_16x16x32_bf16 v[112:115], v[236:239], v[92:95], v[112:115]
    v_mfma_f32_16x16x32_bf16 v[96:99], v[240:243], v[80:83], 0
    v_mfma_f32_16x16x32_bf16 v[96:99], v[244:247], v[84:87], v[96:99]
    s_waitcnt vmcnt(5)
    buffer_load_dwordx4 v[132:135], v77, s[52:55], s85 offen offset:0 nt
    v_mfma_f32_16x16x32_bf16 v[96:99], v[248:251], v[88:91], v[96:99]
    s_nop 2
    v_mov_b32_dpp v122, v112 quad_perm:[0,0,0,0] row_mask:0xf bank_mask:0xf
    v_mov_b32_dpp v124, v114 quad_perm:[2,2,2,2] row_mask:0xf bank_mask:0xf
    s_nop 0
    v_add_f32_dpp v122, v113, v122 quad_perm:[1,1,1,1] row_mask:0xf bank_mask:0xf
    v_add_f32_dpp v124, v115, v124 quad_perm:[3,3,3,3] row_mask:0xf bank_mask:0xf
    v_add_f32 v122, v122, v124
    v_max_f32 v65, v65, v122
    ds_write_b32 v64, v122 offset:1536
    v_lshlrev_b32 v4, 2, v2
    v_xor_b32 v4, v4, v3
    v_xor_b32 v5, 0, v4
    v_lshlrev_b32 v5, 4, v5
    v_lshl_add_u32 v20, v2, 10, v5
    v_xor_b32 v5, 1, v4
    v_lshlrev_b32 v5, 4, v5
    v_lshl_add_u32 v21, v2, 10, v5
    v_add_u32 v21, 3072, v21
    v_xor_b32 v5, 2, v4
    v_lshlrev_b32 v5, 4, v5
    v_lshl_add_u32 v22, v2, 10, v5
    v_add_u32 v22, 6144, v22
    v_xor_b32 v5, 3, v4
    v_lshlrev_b32 v5, 4, v5
    v_lshl_add_u32 v23, v2, 10, v5
    v_add_u32 v23, 9216, v23
    s_lshl_b32 s38, s32, 15
    s_add_u32 s47, s38, 1048576
    s_lshl_b32 s38, s3, 13
    s_add_u32 s47, s38, s47
    s_mul_i32 s38, s3, 320
    s_add_u32 s38, s38, 135168
    v_lshlrev_b32 v4, 6, v2
    v_lshl_add_u32 v4, v3, 1, v4
    v_add_u32 v31, s38, v4
    v_mfma_f32_16x16x32_bf16 v[96:99], v[252:255], v[92:95], v[96:99]
    v_mfma_f32_16x16x32_bf16 v[112:115], a[0:3], v[80:83], 0
    v_mfma_f32_16x16x32_bf16 v[112:115], a[4:7], v[84:87], v[112:115]
    s_waitcnt vmcnt(5)
    buffer_load_dwordx4 v[136:139], v76, s[52:55], s85 offen offset:1024 nt
    v_mfma_f32_16x16x32_bf16 v[112:115], a[8:11], v[88:91], v[112:115]
    s_nop 2
    v_mov_b32_dpp v122, v96 quad_perm:[0,0,0,0] row_mask:0xf bank_mask:0xf
    v_mov_b32_dpp v124, v98 quad_perm:[2,2,2,2] row_mask:0xf bank_mask:0xf
    s_nop 0
    v_add_f32_dpp v122, v97, v122 quad_perm:[1,1,1,1] row_mask:0xf bank_mask:0xf
    v_add_f32_dpp v124, v99, v124 quad_perm:[3,3,3,3] row_mask:0xf bank_mask:0xf
    v_add_f32 v122, v122, v124
    v_max_f32 v65, v65, v122
    ds_write_b32 v64, v122 offset:1792
    v_mfma_f32_16x16x32_bf16 v[112:115], a[12:15], v[92:95], v[112:115]
    v_mfma_f32_16x16x32_bf16 v[96:99], a[16:19], v[80:83], 0
    v_lshlrev_b32 v4, 11, v2
    v_bfe_u32 v5, v1, 2, 2
    v_lshl_add_u32 v4, v5, 8, v4
    v_bfe_u32 v5, v1, 2, 2
    v_lshl_add_u32 v4, v5, 6, v4
    v_bfe_u32 v5, v1, 4, 1
    v_lshl_add_u32 v4, v5, 5, v4
    v_bfe_u32 v5, v1, 1, 1
    v_lshl_add_u32 v4, v5, 4, v4
    v_bfe_u32 v5, v1, 0, 1
    v_lshl_add_u32 v4, v5, 3, v4
    s_lshl_b32 s38, s34, 6
    s_add_u32 s38, s38, 98304
    v_xor_b32 v24, s38, v4
    v_xor_b32 v25, 16, v24
    v_xor_b32 v26, 32, v24
    v_xor_b32 v27, 48, v24
    v_and_b32 v4, 3, v3
    v_lshrrev_b32 v5, 2, v3
    v_lshlrev_b32 v6, 4, v2
    v_add_u32 v6, 135168, v6
    s_movk_i32 s36, 320
    v_cmp_eq_u32 vcc, 0, v5
    s_nop 1
    v_cndmask_b32 v28, 4, v4, vcc
    v_mad_u32_u24 v28, v28, s36, v6
    v_cmp_eq_u32 vcc, 1, v5
    s_nop 1
    v_cndmask_b32 v29, 4, v4, vcc
    v_mad_u32_u24 v29, v29, s36, v6
    v_lshlrev_b32 v5, 2, v1
    v_add_u32 v5, 136448, v5
    v_mov_b32 v6, 0
    ds_write_b32 v5, v6
    s_waitcnt vmcnt(5)
    buffer_load_dwordx4 v[140:143], v77, s[52:55], s85 offen offset:1024 nt
    s_add_u32 s87, s87, 7
    s_add_u32 s39, s87, s88
    s_bfe_u32 s37, s39, 0x30000
    s_lshl_b32 s37, s37, 12
    s_add_u32 s85, s37, s89
    s_bfe_u32 s37, s39, 0x10003
    s_lshl_b32 s37, s37, 11
    s_add_u32 s85, s37, s85
    s_bfe_u32 s37, s39, 0x40004
    s_lshl_b32 s37, s37, 16
    s_add_u32 s85, s37, s85
    v_mfma_f32_16x16x32_bf16 v[96:99], a[20:23], v[84:87], v[96:99]
    v_mfma_f32_16x16x32_bf16 v[96:99], a[24:27], v[88:91], v[96:99]
    v_mov_b32_dpp v122, v112 quad_perm:[0,0,0,0] row_mask:0xf bank_mask:0xf
    v_mov_b32_dpp v124, v114 quad_perm:[2,2,2,2] row_mask:0xf bank_mask:0xf
    s_nop 0
    v_add_f32_dpp v122, v113, v122 quad_perm:[1,1,1,1] row_mask:0xf bank_mask:0xf
    v_add_f32_dpp v124, v115, v124 quad_perm:[3,3,3,3] row_mask:0xf bank_mask:0xf
    v_add_f32 v122, v122, v124
    v_max_f32 v65, v65, v122
    ds_write_b32 v64, v122 offset:2048
    v_mfma_f32_16x16x32_bf16 v[96:99], a[28:31], v[92:95], v[96:99]
    v_mfma_f32_16x16x32_bf16 v[112:115], a[32:35], v[80:83], 0
    s_waitcnt vmcnt(5)
    buffer_load_dwordx4 v[144:147], v76, s[52:55], s85 offen offset:0 nt
    v_mfma_f32_16x16x32_bf16 v[112:115], a[36:39], v[84:87], v[112:115]
    v_mfma_f32_16x16x32_bf16 v[112:115], a[40:43], v[88:91], v[112:115]
    s_nop 2
    v_mov_b32_dpp v122, v96 quad_perm:[0,0,0,0] row_mask:0xf bank_mask:0xf
    v_mov_b32_dpp v124, v98 quad_perm:[2,2,2,2] row_mask:0xf bank_mask:0xf
    s_nop 0
    v_add_f32_dpp v122, v97, v122 quad_perm:[1,1,1,1] row_mask:0xf bank_mask:0xf
    v_add_f32_dpp v124, v99, v124 quad_perm:[3,3,3,3] row_mask:0xf bank_mask:0xf
    v_add_f32 v122, v122, v124
    v_max_f32 v65, v65, v122
    ds_write_b32 v64, v122 offset:2304
    v_lshlrev_b32 v30, 4, v3
    v_lshl_add_u32 v30, v2, 13, v30
    s_lshl_b32 s38, s32, 13
    s_add_u32 s36, s38, 0
    s_lshl_b32 s38, s34, 6
    s_add_u32 s36, s38, s36
    v_lshrrev_b32 v5, 2, v1
    v_lshlrev_b32 v32, 8, v5
    v_bfe_u32 v5, v1, 0, 2
    v_lshl_add_u32 v32, v5, 4, v32
    v_add_u32 v32, s36, v32
    s_lshr_b32 s38, s32, 2
    s_lshl_b32 s38, s38, 7
    s_add_u32 s36, s38, 0
    s_lshl_b32 s38, s34, 5
    s_add_u32 s36, s38, s36
    s_bfe_u32 s38, s32, 0x20000
    s_lshl_b32 s38, s38, 3
    s_add_u32 s36, s38, s36
    v_bfe_u32 v5, v1, 0, 2
    v_lshlrev_b32 v33, 11, v5
    v_lshl_add_u32 v33, v2, 1, v33
    v_add_u32 v33, s36, v33
    v_and_b32 v5, 31, v1
    v_lshlrev_b32 v34, 4, v5
    s_mul_i32 s38, s34, 320
    s_add_u32 s38, s38, 135168
    v_lshl_add_u32 v35, v5, 3, s38
    v_mfma_f32_16x16x32_bf16 v[112:115], a[44:47], v[92:95], v[112:115]
    s_waitcnt vmcnt(5)
    buffer_load_dwordx4 v[148:151], v77, s[52:55], s85 offen offset:0 nt
    v_mfma_f32_16x16x32_bf16 v[96:99], a[48:51], v[80:83], 0
    v_mfma_f32_16x16x32_bf16 v[96:99], a[52:55], v[84:87], v[96:99]
    v_mfma_f32_16x16x32_bf16 v[96:99], a[56:59], v[88:91], v[96:99]
    s_nop 2
    v_mov_b32_dpp v122, v112 quad_perm:[0,0,0,0] row_mask:0xf bank_mask:0xf
    v_mov_b32_dpp v124, v114 quad_perm:[2,2,2,2] row_mask:0xf bank_mask:0xf
    s_nop 0
    v_add_f32_dpp v122, v113, v122 quad_perm:[1,1,1,1] row_mask:0xf bank_mask:0xf
    v_add_f32_dpp v124, v115, v124 quad_perm:[3,3,3,3] row_mask:0xf bank_mask:0xf
    v_add_f32 v122, v122, v124
    v_max_f32 v65, v65, v122
    ds_write_b32 v64, v122 offset:2560
    v_mfma_f32_16x16x32_bf16 v[96:99], a[60:63], v[92:95], v[96:99]
    v_add_u32 v64, 2816, v64
    s_mov_b32 s97, 10
    s_mov_b32 s86, 32
    s_mov_b32 s66, 134217728
    s_mov_b32 s67, 0x20000
    s_mov_b64 s[64:65], s[52:53]
    v_mov_b32 v62, v76
    v_mov_b32 v63, v77
    s_branch L_bloop
L_ql:
    v_lshrrev_b32 v4, 2, v3
    v_and_b32 v5, 3, v3
    v_lshlrev_b32 v19, 6, v2
    v_lshl_add_u32 v19, v5, 4, v19
    v_lshl_add_u32 v14, v4, 18, v19
    s_lshl_b32 s63, s34, 20
    s_lshl_b32 s38, s32, 8
    s_add_u32 s63, s63, s38
    s_mov_b32 s74, 4194304
    s_mov_b32 s75, 0x20000
    s_waitcnt lgkmcnt(0)
    s_mov_b64 s[72:73], s[10:11]
    buffer_load_dwordx4 a[128:131], v14, s[72:75], s63 offen nt
    s_add_u32 s63, s63, 8192
    buffer_load_dwordx4 a[132:135], v14, s[72:75], s63 offen nt
    s_add_u32 s63, s63, 8192
    buffer_load_dwordx4 a[136:139], v14, s[72:75], s63 offen nt
    s_add_u32 s63, s63, 8192
    buffer_load_dwordx4 a[140:143], v14, s[72:75], s63 offen nt
    s_add_u32 s63, s63, 8192
    buffer_load_dwordx4 a[144:147], v14, s[72:75], s63 offen nt
    s_add_u32 s63, s63, 8192
    buffer_load_dwordx4 a[148:151], v14, s[72:75], s63 offen nt
    s_add_u32 s63, s63, 8192
    buffer_load_dwordx4 a[152:155], v14, s[72:75], s63 offen nt
    s_add_u32 s63, s63, 8192
    buffer_load_dwordx4 a[156:159], v14, s[72:75], s63 offen nt
    s_add_u32 s63, s63, 8192
    v_lshlrev_b32 v15, 1, v19
    v_lshl_add_u32 v15, v4, 9, v15
    v_lshl_add_u32 v19, v4, 15, v19
    s_load_dword s35, s[30:31], 0
    s_mov_b32 s48, s30
    s_and_b32 s49, s31, 0xffff
    s_mov_b32 s50, 8388608
    s_mov_b32 s51, 0x20000
    s_mov_b32 s82, 0xffffff00
    s_mov_b32 s83, 0x3e0293ee
    s_mov_b32 s84, 2097152
    s_lshl_b32 s38, s32, 12
    s_add_u32 s95, s38, 264192
    s_lshl_b32 s38, s32, 10
    s_add_u32 s94, s38, 393216
    s_lshl_b32 s38, s34, 8
    s_add_u32 s94, s38, s94
    s_waitcnt vmcnt(7)
    buffer_load_dwordx4 a[160:163], v14, s[72:75], s63 offen nt
    s_add_u32 s63, s63, 8192
    s_waitcnt vmcnt(7)
    buffer_load_dwordx4 a[164:167], v14, s[72:75], s63 offen nt
    s_add_u32 s63, s63, 8192
    s_waitcnt vmcnt(7)
    buffer_load_dwordx4 a[168:171], v14, s[72:75], s63 offen nt
    s_add_u32 s63, s63, 8192
    s_waitcnt vmcnt(7)
    buffer_load_dwordx4 a[172:175], v14, s[72:75], s63 offen nt
    s_add_u32 s63, s63, 8192
    s_waitcnt vmcnt(7)
    buffer_load_dwordx4 a[176:179], v14, s[72:75], s63 offen nt
    s_add_u32 s63, s63, 8192
    v_and_b32 v4, 1, v1
    v_lshlrev_b32 v4, 4, v4
    v_mov_b32 v5, 0xffff
    v_lshlrev_b32 v4, v4, v5
    v_bfe_u32 v5, v1, 1, 2
    v_cmp_eq_u32 vcc, 0, v5
    s_nop 1
    v_cndmask_b32 v10, 0, v4, vcc
    v_cmp_eq_u32 vcc, 1, v5
    s_nop 1
    v_cndmask_b32 v11, 0, v4, vcc
    v_cmp_eq_u32 vcc, 2, v5
    s_nop 1
    v_cndmask_b32 v12, 0, v4, vcc
    v_cmp_eq_u32 vcc, 3, v5
    s_nop 1
    v_cndmask_b32 v13, 0, v4, vcc
    s_waitcnt vmcnt(7)
    buffer_load_dwordx4 a[180:183], v14, s[72:75], s63 offen nt
    s_add_u32 s63, s63, 8192
    s_waitcnt vmcnt(7)
    buffer_load_dwordx4 a[184:187], v14, s[72:75], s63 offen nt
    s_add_u32 s63, s63, 8192
    s_waitcnt vmcnt(7)
    buffer_load_dwordx4 a[188:191], v14, s[72:75], s63 offen nt
    s_add_u32 s63, s63, 8192
    s_waitcnt vmcnt(7)
    buffer_load_dwordx4 a[192:195], v14, s[72:75], s63 offen nt
    s_add_u32 s63, s63, 8192
    v_lshrrev_b32 v4, 2, v3
    v_and_b32 v5, 3, v3
    v_lshlrev_b32 v76, 8, v4
    v_lshlrev_b32 v126, 8, v2
    v_lshl_add_u32 v76, v2, 6, v76
    v_lshl_add_u32 v76, v5, 4, v76
    v_lshl_add_u32 v126, v3, 4, v126
    v_xor_b32 v77, 32768, v76
    v_xor_b32 v127, 32768, v126
    s_add_u32 s3, s34, s33
    s_and_b32 s3, s3, 3
    s_lshl_b32 s89, s3, 5
    s_add_u32 s89, s89, s32
    s_lshl_b32 s89, s89, 20
    s_mul_i32 s88, s32, 8
    s_add_u32 s88, s88, s3
    s_lshl_b32 s87, s33, 0
    s_waitcnt vmcnt(7)
    buffer_load_dwordx4 a[196:199], v14, s[72:75], s63 offen nt
    s_add_u32 s63, s63, 8192
    s_waitcnt vmcnt(7)
    buffer_load_dwordx4 a[200:203], v14, s[72:75], s63 offen nt
    s_add_u32 s63, s63, 8192
    s_waitcnt vmcnt(7)
    buffer_load_dwordx4 a[204:207], v14, s[72:75], s63 offen nt
    s_add_u32 s63, s63, 8192
    s_waitcnt vmcnt(7)
    buffer_load_dwordx4 a[208:211], v14, s[72:75], s63 offen nt
    s_add_u32 s63, s63, 8192
    s_mov_b32 s52, s18
    s_and_b32 s53, s19, 0xffff
    s_mov_b32 s54, 134217728
    s_mov_b32 s55, 0x20000
    s_mov_b32 s56, s20
    s_and_b32 s57, s21, 0xffff
    s_mov_b32 s58, 134217728
    s_mov_b32 s59, 0x20000
    s_waitcnt vmcnt(7)
    buffer_load_dwordx4 a[212:215], v14, s[72:75], s63 offen nt
    s_add_u32 s63, s63, 8192
    s_waitcnt vmcnt(7)
    buffer_load_dwordx4 a[216:219], v14, s[72:75], s63 offen nt
    s_add_u32 s63, s63, 8192
    s_waitcnt vmcnt(7)
    buffer_load_dwordx4 a[220:223], v14, s[72:75], s63 offen nt
    s_add_u32 s63, s63, 8192
    s_waitcnt vmcnt(7)
    buffer_load_dwordx4 a[224:227], v14, s[72:75], s63 offen nt
    s_add_u32 s63, s63, 8192
    v_mov_b32 v120, 0xff7f0000
    v_mov_b32 v121, 0
    v_mov_b32 v18, 1
    v_mov_b32 v116, 0
    v_mov_b32 v117, 0
    v_mov_b32 v118, 0
    v_mov_b32 v119, 0
    s_lshl_b32 s38, s32, 10
    s_add_u32 s96, s38, 65536
    s_lshl_b32 s38, s3, 8
    s_add_u32 s96, s38, s96
    v_mov_b32 v9, s96
    s_lshl_b32 s38, s32, 15
    s_add_u32 s96, s38, 1048576
    s_lshl_b32 s38, s3, 13
    s_add_u32 s96, s38, s96
    s_lshl_b32 s38, s33, 10
    s_add_u32 s96, s38, s96
    v_and_b32 v5, 3, v3
    v_lshlrev_b32 v78, 7, v2
    v_lshl_add_u32 v78, v5, 5, v78
    s_lshl_b32 s38, s32, 12
    s_add_u32 s91, s38, 262144
    s_lshl_b32 s38, s3, 9
    s_add_u32 s91, s38, s91
    v_lshlrev_b32 v4, 7, v2
    v_lshl_add_u32 v4, v3, 4, v4
    v_mov_b32 v5, 512
    v_cmp_gt_u32 vcc, 8, v3
    s_nop 1
    v_cndmask_b32 v79, v5, v4, vcc
    s_waitcnt vmcnt(7)
    buffer_load_dwordx4 a[228:231], v14, s[72:75], s63 offen nt
    s_add_u32 s63, s63, 8192
    s_waitcnt vmcnt(7)
    buffer_load_dwordx4 a[232:235], v14, s[72:75], s63 offen nt
    s_add_u32 s63, s63, 8192
    s_waitcnt vmcnt(7)
    buffer_load_dwordx4 a[236:239], v14, s[72:75], s63 offen nt
    s_add_u32 s63, s63, 8192
    s_waitcnt vmcnt(7)
    buffer_load_dwordx4 a[240:243], v14, s[72:75], s63 offen nt
    s_add_u32 s63, s63, 8192
    s_waitcnt vmcnt(7)
    buffer_load_dwordx4 a[244:247], v14, s[72:75], s63 offen nt
    s_add_u32 s63, s63, 8192
    s_waitcnt vmcnt(7)
    buffer_load_dwordx4 a[248:251], v14, s[72:75], s63 offen nt
    s_add_u32 s63, s63, 8192
    s_waitcnt vmcnt(7)
    buffer_load_dwordx4 a[252:255], v14, s[72:75], s63 offen nt
    s_add_u32 s63, s63, 8192
    s_waitcnt lgkmcnt(0)
    s_add_u32 s35, s35, 0x5b
    s_and_b32 s35, s35, 0xff
    v_mov_b32 v8, s35
    s_or_b32 s68, s35, 0x6b3ac500
    s_waitcnt vmcnt(6)
    s_add_u32 s39, s87, s88
    s_bfe_u32 s37, s39, 0x30000
    s_lshl_b32 s37, s37, 12
    s_add_u32 s85, s37, s89
    s_bfe_u32 s37, s39, 0x10003
    s_lshl_b32 s37, s37, 11
    s_add_u32 s85, s37, s85
    s_bfe_u32 s37, s39, 0x40004
    s_lshl_b32 s37, s37, 16
    s_add_u32 s85, s37, s85
    buffer_load_dwordx4 v[128:131], v76, s[52:55], s85 offen offset:0 nt
    s_waitcnt vmcnt(6)
    buffer_load_dwordx4 v[132:135], v77, s[52:55], s85 offen offset:0 nt
    s_waitcnt vmcnt(6)
    buffer_load_dwordx4 v[136:139], v76, s[52:55], s85 offen offset:1024 nt
    s_waitcnt vmcnt(6)
    buffer_load_dwordx4 v[140:143], v77, s[52:55], s85 offen offset:1024 nt
    s_add_u32 s87, s87, 7
    s_add_u32 s39, s87, s88
    s_bfe_u32 s37, s39, 0x30000
    s_lshl_b32 s37, s37, 12
    s_add_u32 s85, s37, s89
    s_bfe_u32 s37, s39, 0x10003
    s_lshl_b32 s37, s37, 11
    s_add_u32 s85, s37, s85
    s_bfe_u32 s37, s39, 0x40004
    s_lshl_b32 s37, s37, 16
    s_add_u32 s85, s37, s85
    s_waitcnt vmcnt(6)
    buffer_load_dwordx4 v[144:147], v76, s[52:55], s85 offen offset:0 nt
    s_waitcnt vmcnt(6)
    buffer_load_dwordx4 v[148:151], v77, s[52:55], s85 offen offset:0 nt
    s_waitcnt vmcnt(6)
    buffer_load_dwordx4 v[152:155], v76, s[52:55], s85 offen offset:1024 nt
    s_waitcnt vmcnt(6)
    buffer_load_dwordx4 v[156:159], v77, s[52:55], s85 offen offset:1024 nt
    s_add_u32 s87, s87, 7
    s_add_u32 s39, s87, s88
    s_bfe_u32 s37, s39, 0x30000
    s_lshl_b32 s37, s37, 12
    s_add_u32 s85, s37, s89
    s_bfe_u32 s37, s39, 0x10003
    s_lshl_b32 s37, s37, 11
    s_add_u32 s85, s37, s85
    s_bfe_u32 s37, s39, 0x40004
    s_lshl_b32 s37, s37, 16
    s_add_u32 s85, s37, s85
    s_waitcnt vmcnt(6)
    buffer_load_dwordx4 v[160:163], v76, s[52:55], s85 offen offset:0 nt
    s_waitcnt vmcnt(6)
    buffer_load_dwordx4 v[164:167], v77, s[52:55], s85 offen offset:0 nt
    s_waitcnt vmcnt(6)
    buffer_load_dwordx4 v[168:171], v76, s[52:55], s85 offen offset:1024 nt
    s_waitcnt vmcnt(6)
    buffer_load_dwordx4 v[172:175], v77, s[52:55], s85 offen offset:1024 nt
    s_add_u32 s87, s87, 7
    s_add_u32 s39, s87, s88
    s_bfe_u32 s37, s39, 0x30000
    s_lshl_b32 s37, s37, 12
    s_add_u32 s85, s37, s89
    s_bfe_u32 s37, s39, 0x10003
    s_lshl_b32 s37, s37, 11
    s_add_u32 s85, s37, s85
    s_bfe_u32 s37, s39, 0x40004
    s_lshl_b32 s37, s37, 16
    s_add_u32 s85, s37, s85
    s_waitcnt vmcnt(6)
    buffer_load_dwordx4 v[176:179], v76, s[52:55], s85 offen offset:0 nt
    s_waitcnt vmcnt(6)
    buffer_load_dwordx4 v[180:183], v77, s[52:55], s85 offen offset:0 nt
    s_waitcnt vmcnt(6)
    buffer_load_dwordx4 v[184:187], v76, s[52:55], s85 offen offset:1024 nt
    s_waitcnt vmcnt(6)
    buffer_load_dwordx4 v[188:191], v77, s[52:55], s85 offen offset:1024 nt
    s_add_u32 s87, s87, 7
    s_add_u32 s39, s87, s88
    s_bfe_u32 s37, s39, 0x30000
    s_lshl_b32 s37, s37, 12
    s_add_u32 s85, s37, s89
    s_bfe_u32 s37, s39, 0x10003
    s_lshl_b32 s37, s37, 11
    s_add_u32 s85, s37, s85
    s_bfe_u32 s37, s39, 0x40004
    s_lshl_b32 s37, s37, 16
    s_add_u32 s85, s37, s85
    s_waitcnt vmcnt(6)
    buffer_load_dwordx4 v[192:195], v76, s[52:55], s85 offen offset:0 nt
    s_waitcnt vmcnt(6)
    buffer_load_dwordx4 v[196:199], v77, s[52:55], s85 offen offset:0 nt
    s_waitcnt vmcnt(6)
    buffer_load_dwordx4 v[200:203], v76, s[52:55], s85 offen offset:1024 nt
    s_waitcnt vmcnt(6)
    buffer_load_dwordx4 v[204:207], v77, s[52:55], s85 offen offset:1024 nt
    s_add_u32 s87, s87, 7
    s_add_u32 s39, s87, s88
    s_bfe_u32 s37, s39, 0x30000
    s_lshl_b32 s37, s37, 12
    s_add_u32 s85, s37, s89
    s_bfe_u32 s37, s39, 0x10003
    s_lshl_b32 s37, s37, 11
    s_add_u32 s85, s37, s85
    s_bfe_u32 s37, s39, 0x40004
    s_lshl_b32 s37, s37, 16
    s_add_u32 s85, s37, s85
    s_waitcnt vmcnt(6)
    buffer_load_dwordx4 v[208:211], v76, s[52:55], s85 offen offset:0 nt
    s_waitcnt vmcnt(6)
    buffer_load_dwordx4 v[212:215], v77, s[52:55], s85 offen offset:0 nt
    s_waitcnt vmcnt(6)
    buffer_load_dwordx4 v[216:219], v76, s[52:55], s85 offen offset:1024 nt
    s_waitcnt vmcnt(6)
    buffer_load_dwordx4 v[220:223], v77, s[52:55], s85 offen offset:1024 nt
    s_add_u32 s87, s87, 7
    s_add_u32 s39, s87, s88
    s_bfe_u32 s37, s39, 0x30000
    s_lshl_b32 s37, s37, 12
    s_add_u32 s85, s37, s89
    s_bfe_u32 s37, s39, 0x10003
    s_lshl_b32 s37, s37, 11
    s_add_u32 s85, s37, s85
    s_bfe_u32 s37, s39, 0x40004
    s_lshl_b32 s37, s37, 16
    s_add_u32 s85, s37, s85
    buffer_load_dwordx4 v[20:23], v15, s[48:51], s95 offen offset:0 sc1
    buffer_load_dwordx4 v[24:27], v15, s[48:51], s95 offen offset:16 sc1
    s_waitcnt vmcnt(8)
    buffer_load_dwordx4 v[224:227], v76, s[52:55], s85 offen offset:0 nt
    s_waitcnt vmcnt(8)
    buffer_load_dwordx4 v[228:231], v77, s[52:55], s85 offen offset:0 nt
    s_waitcnt vmcnt(8)
    buffer_load_dwordx4 v[232:235], v76, s[52:55], s85 offen offset:1024 nt
    s_waitcnt vmcnt(8)
    buffer_load_dwordx4 v[236:239], v77, s[52:55], s85 offen offset:1024 nt
    s_add_u32 s87, s87, 7
    s_add_u32 s39, s87, s88
    s_bfe_u32 s37, s39, 0x30000
    s_lshl_b32 s37, s37, 12
    s_add_u32 s85, s37, s89
    s_bfe_u32 s37, s39, 0x10003
    s_lshl_b32 s37, s37, 11
    s_add_u32 s85, s37, s85
    s_bfe_u32 s37, s39, 0x40004
    s_lshl_b32 s37, s37, 16
    s_add_u32 s85, s37, s85
    s_waitcnt vmcnt(8)
    buffer_load_dwordx4 v[240:243], v76, s[52:55], s85 offen offset:0 nt
    s_waitcnt vmcnt(8)
    buffer_load_dwordx4 v[244:247], v77, s[52:55], s85 offen offset:0 nt
    s_waitcnt vmcnt(6)
L_qacheck_20:
    v_xor_b32 v20, s35, v20
    v_xor_b32 v21, s35, v21
    v_xor_b32 v22, s35, v22
    v_xor_b32 v23, s35, v23
    v_xor_b32 v24, s35, v24
    v_xor_b32 v25, s35, v25
    v_xor_b32 v26, s35, v26
    v_xor_b32 v27, s35, v27
    v_or_b32 v4, v20, v21
    v_or3_b32 v4, v4, v22, v23
    v_or3_b32 v4, v4, v24, v25
    v_or3_b32 v4, v4, v26, v27
    v_and_b32 v4, 0xff, v4
    v_cmp_ne_u32 vcc, 0, v4
    s_cbranch_vccz L_qaok_21
    buffer_load_dwordx4 v[20:23], v15, s[48:51], s95 offen offset:0 sc1
    buffer_load_dwordx4 v[24:27], v15, s[48:51], s95 offen offset:16 sc1
    s_waitcnt vmcnt(0)
    s_sub_u32 s84, s84, 1
    s_cmp_lg_u32 s84, 0
    s_cbranch_scc1 L_qacheck_20
    s_branch L_end
L_qaok_21:
    buffer_load_dwordx4 v[68:71], v78, s[48:51], s91 offen offset:0 sc1
    buffer_load_dwordx4 v[72:75], v78, s[48:51], s91 offen offset:16 sc1
    v_cvt_pk_bf16_f32 v20, v20, v21
    v_cvt_pk_bf16_f32 v21, v22, v23
    v_cvt_pk_bf16_f32 v22, v24, v25
    v_cvt_pk_bf16_f32 v23, v26, v27
    s_nop 1
    v_mfma_f32_16x16x32_bf16 v[28:31], a[128:131], v[20:23], 0
    v_mfma_f32_16x16x32_bf16 v[32:35], a[132:135], v[20:23], 0
    v_mfma_f32_16x16x32_bf16 v[36:39], a[136:139], v[20:23], 0
    s_nop 5
    v_mov_b32_dpp v60, v28 quad_perm:[0,0,0,0] row_mask:0xf bank_mask:0xf
    v_mov_b32_dpp v4, v30 quad_perm:[2,2,2,2] row_mask:0xf bank_mask:0xf
    s_nop 0
    v_add_f32_dpp v60, v29, v60 quad_perm:[1,1,1,1] row_mask:0xf bank_mask:0xf
    v_add_f32_dpp v4, v31, v4 quad_perm:[3,3,3,3] row_mask:0xf bank_mask:0xf
    v_add_f32 v60, v60, v4
    v_mfma_f32_16x16x32_bf16 v[40:43], a[140:143], v[20:23], 0
    v_mov_b32_dpp v61, v32 quad_perm:[0,0,0,0] row_mask:0xf bank_mask:0xf
    v_mov_b32_dpp v4, v34 quad_perm:[2,2,2,2] row_mask:0xf bank_mask:0xf
    s_nop 0
    v_add_f32_dpp v61, v33, v61 quad_perm:[1,1,1,1] row_mask:0xf bank_mask:0xf
    v_add_f32_dpp v4, v35, v4 quad_perm:[3,3,3,3] row_mask:0xf bank_mask:0xf
    v_add_f32 v61, v61, v4
    v_cvt_pk_bf16_f32 v44, v60, v61
    v_mfma_f32_16x16x32_bf16 v[28:31], a[144:147], v[20:23], 0
    v_mov_b32_dpp v60, v36 quad_perm:[0,0,0,0] row_mask:0xf bank_mask:0xf
    v_mov_b32_dpp v4, v38 quad_perm:[2,2,2,2] row_mask:0xf bank_mask:0xf
    s_nop 0
    v_add_f32_dpp v60, v37, v60 quad_perm:[1,1,1,1] row_mask:0xf bank_mask:0xf
    v_add_f32_dpp v4, v39, v4 quad_perm:[3,3,3,3] row_mask:0xf bank_mask:0xf
    v_add_f32 v60, v60, v4
    buffer_load_dwordx4 v[248:251], v76, s[52:55], s85 offen offset:1024 nt
    v_mfma_f32_16x16x32_bf16 v[32:35], a[148:151], v[20:23], 0
    v_mov_b32_dpp v61, v40 quad_perm:[0,0,0,0] row_mask:0xf bank_mask:0xf
    v_mov_b32_dpp v4, v42 quad_perm:[2,2,2,2] row_mask:0xf bank_mask:0xf
    s_nop 0
    v_add_f32_dpp v61, v41, v61 quad_perm:[1,1,1,1] row_mask:0xf bank_mask:0xf
    v_add_f32_dpp v4, v43, v4 quad_perm:[3,3,3,3] row_mask:0xf bank_mask:0xf
    v_add_f32 v61, v61, v4
    v_cvt_pk_bf16_f32 v45, v60, v61
    v_mfma_f32_16x16x32_bf16 v[36:39], a[152:155], v[20:23], 0
    v_mov_b32_dpp v60, v28 quad_perm:[0,0,0,0] row_mask:0xf bank_mask:0xf
    v_mov_b32_dpp v4, v30 quad_perm:[2,2,2,2] row_mask:0xf bank_mask:0xf
    s_nop 0
    v_add_f32_dpp v60, v29, v60 quad_perm:[1,1,1,1] row_mask:0xf bank_mask:0xf
    v_add_f32_dpp v4, v31, v4 quad_perm:[3,3,3,3] row_mask:0xf bank_mask:0xf
    v_add_f32 v60, v60, v4
    v_mfma_f32_16x16x32_bf16 v[40:43], a[156:159], v[20:23], 0
    v_mov_b32_dpp v61, v32 quad_perm:[0,0,0,0] row_mask:0xf bank_mask:0xf
    v_mov_b32_dpp v4, v34 quad_perm:[2,2,2,2] row_mask:0xf bank_mask:0xf
    s_nop 0
    v_add_f32_dpp v61, v33, v61 quad_perm:[1,1,1,1] row_mask:0xf bank_mask:0xf
    v_add_f32_dpp v4, v35, v4 quad_perm:[3,3,3,3] row_mask:0xf bank_mask:0xf
    v_add_f32 v61, v61, v4
    v_cvt_pk_bf16_f32 v46, v60, v61
    v_mfma_f32_16x16x32_bf16 v[28:31], a[160:163], v[20:23], 0
    v_mov_b32_dpp v60, v36 quad_perm:[0,0,0,0] row_mask:0xf bank_mask:0xf
    v_mov_b32_dpp v4, v38 quad_perm:[2,2,2,2] row_mask:0xf bank_mask:0xf
    s_nop 0
    v_add_f32_dpp v60, v37, v60 quad_perm:[1,1,1,1] row_mask:0xf bank_mask:0xf
    v_add_f32_dpp v4, v39, v4 quad_perm:[3,3,3,3] row_mask:0xf bank_mask:0xf
    v_add_f32 v60, v60, v4
    v_mfma_f32_16x16x32_bf16 v[32:35], a[164:167], v[20:23], 0
    v_mov_b32_dpp v61, v40 quad_perm:[0,0,0,0] row_mask:0xf bank_mask:0xf
    v_mov_b32_dpp v4, v42 quad_perm:[2,2,2,2] row_mask:0xf bank_mask:0xf
    s_nop 0
    v_add_f32_dpp v61, v41, v61 quad_perm:[1,1,1,1] row_mask:0xf bank_mask:0xf
    v_add_f32_dpp v4, v43, v4 quad_perm:[3,3,3,3] row_mask:0xf bank_mask:0xf
    v_add_f32 v61, v61, v4
    v_cvt_pk_bf16_f32 v47, v60, v61
    v_mfma_f32_16x16x32_bf16 v[36:39], a[168:171], v[20:23], 0
    v_mov_b32_dpp v60, v28 quad_perm:[0,0,0,0] row_mask:0xf bank_mask:0xf
    v_mov_b32_dpp v4, v30 quad_perm:[2,2,2,2] row_mask:0xf bank_mask:0xf
    s_nop 0
    v_add_f32_dpp v60, v29, v60 quad_perm:[1,1,1,1] row_mask:0xf bank_mask:0xf
    v_add_f32_dpp v4, v31, v4 quad_perm:[3,3,3,3] row_mask:0xf bank_mask:0xf
    v_add_f32 v60, v60, v4
    v_mfma_f32_16x16x32_bf16 v[40:43], a[172:175], v[20:23], 0
    v_mov_b32_dpp v61, v32 quad_perm:[0,0,0,0] row_mask:0xf bank_mask:0xf
    v_mov_b32_dpp v4, v34 quad_perm:[2,2,2,2] row_mask:0xf bank_mask:0xf
    s_nop 0
    v_add_f32_dpp v61, v33, v61 quad_perm:[1,1,1,1] row_mask:0xf bank_mask:0xf
    v_add_f32_dpp v4, v35, v4 quad_perm:[3,3,3,3] row_mask:0xf bank_mask:0xf
    v_add_f32 v61, v61, v4
    v_cvt_pk_bf16_f32 v48, v60, v61
    v_mfma_f32_16x16x32_bf16 v[28:31], a[176:179], v[20:23], 0
    v_mov_b32_dpp v60, v36 quad_perm:[0,0,0,0] row_mask:0xf bank_mask:0xf
    v_mov_b32_dpp v4, v38 quad_perm:[2,2,2,2] row_mask:0xf bank_mask:0xf
    s_nop 0
    v_add_f32_dpp v60, v37, v60 quad_perm:[1,1,1,1] row_mask:0xf bank_mask:0xf
    v_add_f32_dpp v4, v39, v4 quad_perm:[3,3,3,3] row_mask:0xf bank_mask:0xf
    v_add_f32 v60, v60, v4
    buffer_load_dwordx4 v[252:255], v77, s[52:55], s85 offen offset:1024 nt
    s_add_u32 s87, s87, 7
    s_add_u32 s39, s87, s88
    s_bfe_u32 s37, s39, 0x30000
    s_lshl_b32 s37, s37, 12
    s_add_u32 s85, s37, s89
    s_bfe_u32 s37, s39, 0x10003
    s_lshl_b32 s37, s37, 11
    s_add_u32 s85, s37, s85
    s_bfe_u32 s37, s39, 0x40004
    s_lshl_b32 s37, s37, 16
    s_add_u32 s85, s37, s85
    v_mfma_f32_16x16x32_bf16 v[32:35], a[180:183], v[20:23], 0
    v_mov_b32_dpp v61, v40 quad_perm:[0,0,0,0] row_mask:0xf bank_mask:0xf
    v_mov_b32_dpp v4, v42 quad_perm:[2,2,2,2] row_mask:0xf bank_mask:0xf
    s_nop 0
    v_add_f32_dpp v61, v41, v61 quad_perm:[1,1,1,1] row_mask:0xf bank_mask:0xf
    v_add_f32_dpp v4, v43, v4 quad_perm:[3,3,3,3] row_mask:0xf bank_mask:0xf
    v_add_f32 v61, v61, v4
    v_cvt_pk_bf16_f32 v49, v60, v61
    v_mfma_f32_16x16x32_bf16 v[36:39], a[184:187], v[20:23], 0
    v_mov_b32_dpp v60, v28 quad_perm:[0,0,0,0] row_mask:0xf bank_mask:0xf
    v_mov_b32_dpp v4, v30 quad_perm:[2,2,2,2] row_mask:0xf bank_mask:0xf
    s_nop 0
    v_add_f32_dpp v60, v29, v60 quad_perm:[1,1,1,1] row_mask:0xf bank_mask:0xf
    v_add_f32_dpp v4, v31, v4 quad_perm:[3,3,3,3] row_mask:0xf bank_mask:0xf
    v_add_f32 v60, v60, v4
    v_mfma_f32_16x16x32_bf16 v[40:43], a[188:191], v[20:23], 0
    v_mov_b32_dpp v61, v32 quad_perm:[0,0,0,0] row_mask:0xf bank_mask:0xf
    v_mov_b32_dpp v4, v34 quad_perm:[2,2,2,2] row_mask:0xf bank_mask:0xf
    s_nop 0
    v_add_f32_dpp v61, v33, v61 quad_perm:[1,1,1,1] row_mask:0xf bank_mask:0xf
    v_add_f32_dpp v4, v35, v4 quad_perm:[3,3,3,3] row_mask:0xf bank_mask:0xf
    v_add_f32 v61, v61, v4
    v_cvt_pk_bf16_f32 v50, v60, v61
    v_mfma_f32_16x16x32_bf16 v[28:31], a[192:195], v[20:23], 0
    v_mov_b32_dpp v60, v36 quad_perm:[0,0,0,0] row_mask:0xf bank_mask:0xf
    v_mov_b32_dpp v4, v38 quad_perm:[2,2,2,2] row_mask:0xf bank_mask:0xf
    s_nop 0
    v_add_f32_dpp v60, v37, v60 quad_perm:[1,1,1,1] row_mask:0xf bank_mask:0xf
    v_add_f32_dpp v4, v39, v4 quad_perm:[3,3,3,3] row_mask:0xf bank_mask:0xf
    v_add_f32 v60, v60, v4
    v_mfma_f32_16x16x32_bf16 v[32:35], a[196:199], v[20:23], 0
    v_mov_b32_dpp v61, v40 quad_perm:[0,0,0,0] row_mask:0xf bank_mask:0xf
    v_mov_b32_dpp v4, v42 quad_perm:[2,2,2,2] row_mask:0xf bank_mask:0xf
    s_nop 0
    v_add_f32_dpp v61, v41, v61 quad_perm:[1,1,1,1] row_mask:0xf bank_mask:0xf
    v_add_f32_dpp v4, v43, v4 quad_perm:[3,3,3,3] row_mask:0xf bank_mask:0xf
    v_add_f32 v61, v61, v4
    v_cvt_pk_bf16_f32 v51, v60, v61
    v_mfma_f32_16x16x32_bf16 v[36:39], a[200:203], v[20:23], 0
    v_mov_b32_dpp v60, v28 quad_perm:[0,0,0,0] row_mask:0xf bank_mask:0xf
    v_mov_b32_dpp v4, v30 quad_perm:[2,2,2,2] row_mask:0xf bank_mask:0xf
    s_nop 0
    v_add_f32_dpp v60, v29, v60 quad_perm:[1,1,1,1] row_mask:0xf bank_mask:0xf
    v_add_f32_dpp v4, v31, v4 quad_perm:[3,3,3,3] row_mask:0xf bank_mask:0xf
    v_add_f32 v60, v60, v4
    v_mfma_f32_16x16x32_bf16 v[40:43], a[204:207], v[20:23], 0
    v_mov_b32_dpp v61, v32 quad_perm:[0,0,0,0] row_mask:0xf bank_mask:0xf
    v_mov_b32_dpp v4, v34 quad_perm:[2,2,2,2] row_mask:0xf bank_mask:0xf
    s_nop 0
    v_add_f32_dpp v61, v33, v61 quad_perm:[1,1,1,1] row_mask:0xf bank_mask:0xf
    v_add_f32_dpp v4, v35, v4 quad_perm:[3,3,3,3] row_mask:0xf bank_mask:0xf
    v_add_f32 v61, v61, v4
    v_cvt_pk_bf16_f32 v52, v60, v61
    v_mfma_f32_16x16x32_bf16 v[28:31], a[208:211], v[20:23], 0
    v_mov_b32_dpp v60, v36 quad_perm:[0,0,0,0] row_mask:0xf bank_mask:0xf
    v_mov_b32_dpp v4, v38 quad_perm:[2,2,2,2] row_mask:0xf bank_mask:0xf
    s_nop 0
    v_add_f32_dpp v60, v37, v60 quad_perm:[1,1,1,1] row_mask:0xf bank_mask:0xf
    v_add_f32_dpp v4, v39, v4 quad_perm:[3,3,3,3] row_mask:0xf bank_mask:0xf
    v_add_f32 v60, v60, v4
    buffer_load_dwordx4 a[0:3], v76, s[52:55], s85 offen offset:0 nt
    v_mfma_f32_16x16x32_bf16 v[32:35], a[212:215], v[20:23], 0
    v_mov_b32_dpp v61, v40 quad_perm:[0,0,0,0] row_mask:0xf bank_mask:0xf
    v_mov_b32_dpp v4, v42 quad_perm:[2,2,2,2] row_mask:0xf bank_mask:0xf
    s_nop 0
    v_add_f32_dpp v61, v41, v61 quad_perm:[1,1,1,1] row_mask:0xf bank_mask:0xf
    v_add_f32_dpp v4, v43, v4 quad_perm:[3,3,3,3] row_mask:0xf bank_mask:0xf
    v_add_f32 v61, v61, v4
    v_cvt_pk_bf16_f32 v53, v60, v61
    v_mfma_f32_16x16x32_bf16 v[36:39], a[216:219], v[20:23], 0
    v_mov_b32_dpp v60, v28 quad_perm:[0,0,0,0] row_mask:0xf bank_mask:0xf
    v_mov_b32_dpp v4, v30 quad_perm:[2,2,2,2] row_mask:0xf bank_mask:0xf
    s_nop 0
    v_add_f32_dpp v60, v29, v60 quad_perm:[1,1,1,1] row_mask:0xf bank_mask:0xf
    v_add_f32_dpp v4, v31, v4 quad_perm:[3,3,3,3] row_mask:0xf bank_mask:0xf
    v_add_f32 v60, v60, v4
    v_mfma_f32_16x16x32_bf16 v[40:43], a[220:223], v[20:23], 0
    v_mov_b32_dpp v61, v32 quad_perm:[0,0,0,0] row_mask:0xf bank_mask:0xf
    v_mov_b32_dpp v4, v34 quad_perm:[2,2,2,2] row_mask:0xf bank_mask:0xf
    s_nop 0
    v_add_f32_dpp v61, v33, v61 quad_perm:[1,1,1,1] row_mask:0xf bank_mask:0xf
    v_add_f32_dpp v4, v35, v4 quad_perm:[3,3,3,3] row_mask:0xf bank_mask:0xf
    v_add_f32 v61, v61, v4
    v_cvt_pk_bf16_f32 v54, v60, v61
    v_mfma_f32_16x16x32_bf16 v[28:31], a[224:227], v[20:23], 0
    v_mov_b32_dpp v60, v36 quad_perm:[0,0,0,0] row_mask:0xf bank_mask:0xf
    v_mov_b32_dpp v4, v38 quad_perm:[2,2,2,2] row_mask:0xf bank_mask:0xf
    s_nop 0
    v_add_f32_dpp v60, v37, v60 quad_perm:[1,1,1,1] row_mask:0xf bank_mask:0xf
    v_add_f32_dpp v4, v39, v4 quad_perm:[3,3,3,3] row_mask:0xf bank_mask:0xf
    v_add_f32 v60, v60, v4
    v_mfma_f32_16x16x32_bf16 v[32:35], a[228:231], v[20:23], 0
    v_mov_b32_dpp v61, v40 quad_perm:[0,0,0,0] row_mask:0xf bank_mask:0xf
    v_mov_b32_dpp v4, v42 quad_perm:[2,2,2,2] row_mask:0xf bank_mask:0xf
    s_nop 0
    v_add_f32_dpp v61, v41, v61 quad_perm:[1,1,1,1] row_mask:0xf bank_mask:0xf
    v_add_f32_dpp v4, v43, v4 quad_perm:[3,3,3,3] row_mask:0xf bank_mask:0xf
    v_add_f32 v61, v61, v4
    v_cvt_pk_bf16_f32 v55, v60, v61
    v_mfma_f32_16x16x32_bf16 v[36:39], a[232:235], v[20:23], 0
    v_mov_b32_dpp v60, v28 quad_perm:[0,0,0,0] row_mask:0xf bank_mask:0xf
    v_mov_b32_dpp v4, v30 quad_perm:[2,2,2,2] row_mask:0xf bank_mask:0xf
    s_nop 0
    v_add_f32_dpp v60, v29, v60 quad_perm:[1,1,1,1] row_mask:0xf bank_mask:0xf
    v_add_f32_dpp v4, v31, v4 quad_perm:[3,3,3,3] row_mask:0xf bank_mask:0xf
    v_add_f32 v60, v60, v4
    v_mfma_f32_16x16x32_bf16 v[40:43], a[236:239], v[20:23], 0
    v_mov_b32_dpp v61, v32 quad_perm:[0,0,0,0] row_mask:0xf bank_mask:0xf
    v_mov_b32_dpp v4, v34 quad_perm:[2,2,2,2] row_mask:0xf bank_mask:0xf
    s_nop 0
    v_add_f32_dpp v61, v33, v61 quad_perm:[1,1,1,1] row_mask:0xf bank_mask:0xf
    v_add_f32_dpp v4, v35, v4 quad_perm:[3,3,3,3] row_mask:0xf bank_mask:0xf
    v_add_f32 v61, v61, v4
    v_cvt_pk_bf16_f32 v56, v60, v61
    v_mfma_f32_16x16x32_bf16 v[28:31], a[240:243], v[20:23], 0
    v_mov_b32_dpp v60, v36 quad_perm:[0,0,0,0] row_mask:0xf bank_mask:0xf
    v_mov_b32_dpp v4, v38 quad_perm:[2,2,2,2] row_mask:0xf bank_mask:0xf
    s_nop 0
    v_add_f32_dpp v60, v37, v60 quad_perm:[1,1,1,1] row_mask:0xf bank_mask:0xf
    v_add_f32_dpp v4, v39, v4 quad_perm:[3,3,3,3] row_mask:0xf bank_mask:0xf
    v_add_f32 v60, v60, v4
    buffer_load_dwordx4 a[4:7], v77, s[52:55], s85 offen offset:0 nt
    v_mfma_f32_16x16x32_bf16 v[32:35], a[244:247], v[20:23], 0
    v_mov_b32_dpp v61, v40 quad_perm:[0,0,0,0] row_mask:0xf bank_mask:0xf
    v_mov_b32_dpp v4, v42 quad_perm:[2,2,2,2] row_mask:0xf bank_mask:0xf
    s_nop 0
    v_add_f32_dpp v61, v41, v61 quad_perm:[1,1,1,1] row_mask:0xf bank_mask:0xf
    v_add_f32_dpp v4, v43, v4 quad_perm:[3,3,3,3] row_mask:0xf bank_mask:0xf
    v_add_f32 v61, v61, v4
    v_cvt_pk_bf16_f32 v57, v60, v61
    v_mfma_f32_16x16x32_bf16 v[36:39], a[248:251], v[20:23], 0
    v_mov_b32_dpp v60, v28 quad_perm:[0,0,0,0] row_mask:0xf bank_mask:0xf
    v_mov_b32_dpp v4, v30 quad_perm:[2,2,2,2] row_mask:0xf bank_mask:0xf
    s_nop 0
    v_add_f32_dpp v60, v29, v60 quad_perm:[1,1,1,1] row_mask:0xf bank_mask:0xf
    v_add_f32_dpp v4, v31, v4 quad_perm:[3,3,3,3] row_mask:0xf bank_mask:0xf
    v_add_f32 v60, v60, v4
    v_mfma_f32_16x16x32_bf16 v[40:43], a[252:255], v[20:23], 0
    v_mov_b32_dpp v61, v32 quad_perm:[0,0,0,0] row_mask:0xf bank_mask:0xf
    v_mov_b32_dpp v4, v34 quad_perm:[2,2,2,2] row_mask:0xf bank_mask:0xf
    s_nop 0
    v_add_f32_dpp v61, v33, v61 quad_perm:[1,1,1,1] row_mask:0xf bank_mask:0xf
    v_add_f32_dpp v4, v35, v4 quad_perm:[3,3,3,3] row_mask:0xf bank_mask:0xf
    v_add_f32 v61, v61, v4
    v_cvt_pk_bf16_f32 v58, v60, v61
    v_mov_b32_dpp v60, v36 quad_perm:[0,0,0,0] row_mask:0xf bank_mask:0xf
    v_mov_b32_dpp v4, v38 quad_perm:[2,2,2,2] row_mask:0xf bank_mask:0xf
    s_nop 0
    v_add_f32_dpp v60, v37, v60 quad_perm:[1,1,1,1] row_mask:0xf bank_mask:0xf
    v_add_f32_dpp v4, v39, v4 quad_perm:[3,3,3,3] row_mask:0xf bank_mask:0xf
    v_add_f32 v60, v60, v4
    v_mov_b32_dpp v61, v40 quad_perm:[0,0,0,0] row_mask:0xf bank_mask:0xf
    v_mov_b32_dpp v4, v42 quad_perm:[2,2,2,2] row_mask:0xf bank_mask:0xf
    s_nop 0
    v_add_f32_dpp v61, v41, v61 quad_perm:[1,1,1,1] row_mask:0xf bank_mask:0xf
    v_add_f32_dpp v4, v43, v4 quad_perm:[3,3,3,3] row_mask:0xf bank_mask:0xf
    v_add_f32 v61, v61, v4
    v_cvt_pk_bf16_f32 v59, v60, v61
    s_mov_b32 exec_lo, 0x22222222
    s_mov_b32 exec_hi, 0x22222222
    v_mov_b32 v44, v48
    v_mov_b32 v45, v49
    v_mov_b32 v46, v50
    v_mov_b32 v47, v51
    s_mov_b32 exec_lo, 0x44444444
    s_mov_b32 exec_hi, 0x44444444
    v_mov_b32 v44, v52
    v_mov_b32 v45, v53
    v_mov_b32 v46, v54
    v_mov_b32 v47, v55
    s_mov_b32 exec_lo, 0x88888888
    s_mov_b32 exec_hi, 0x88888888
    v_mov_b32 v44, v56
    v_mov_b32 v45, v57
    v_mov_b32 v46, v58
    v_mov_b32 v47, v59
    s_mov_b64 exec, -1
    buffer_store_dwordx4 v[44:47], v19, s[48:51], s94 offen sc1
    s_waitcnt vmcnt(5)
L_qcheck_22:
    v_xor_b32 v68, s35, v68
    v_xor_b32 v69, s35, v69
    v_xor_b32 v70, s35, v70
    v_xor_b32 v71, s35, v71
    v_xor_b32 v72, s35, v72
    v_xor_b32 v73, s35, v73
    v_xor_b32 v74, s35, v74
    v_xor_b32 v75, s35, v75
    v_or_b32 v4, v68, v69
    v_or3_b32 v4, v4, v70, v71
    v_or3_b32 v4, v4, v72, v73
    v_or3_b32 v4, v4, v74, v75
    v_and_b32 v4, 0xff, v4
    v_cmp_ne_u32 vcc, 0, v4
    s_cbranch_vccz L_qok_23
    buffer_load_dwordx4 v[68:71], v78, s[48:51], s91 offen offset:0 sc1
    buffer_load_dwordx4 v[72:75], v78, s[48:51], s91 offen offset:16 sc1
    s_waitcnt vmcnt(0)
    s_sub_u32 s84, s84, 1
    s_cmp_lg_u32 s84, 0
    s_cbranch_scc1 L_qcheck_22
    s_branch L_end
L_qok_23:
    v_cvt_pk_bf16_f32 v68, v68, v69
    v_cvt_pk_bf16_f32 v69, v70, v71
    v_cvt_pk_bf16_f32 v70, v72, v73
    v_cvt_pk_bf16_f32 v71, v74, v75
    s_mov_b32 vcc_lo, 0xf000f
    s_mov_b32 vcc_hi, 0xf000f
    v_cndmask_b32 v80, 0, v68, vcc
    v_cndmask_b32 v81, 0, v69, vcc
    v_cndmask_b32 v82, 0, v70, vcc
    v_cndmask_b32 v83, 0, v71, vcc
    s_mov_b32 vcc_lo, 0xf000f0
    s_mov_b32 vcc_hi, 0xf000f0
    v_cndmask_b32 v84, 0, v68, vcc
    v_cndmask_b32 v85, 0, v69, vcc
    v_cndmask_b32 v86, 0, v70, vcc
    v_cndmask_b32 v87, 0, v71, vcc
    s_mov_b32 vcc_lo, 0xf000f00
    s_mov_b32 vcc_hi, 0xf000f00
    v_cndmask_b32 v88, 0, v68, vcc
    v_cndmask_b32 v89, 0, v69, vcc
    v_cndmask_b32 v90, 0, v70, vcc
    v_cndmask_b32 v91, 0, v71, vcc
    s_mov_b32 vcc_lo, 0xf000f000
    s_mov_b32 vcc_hi, 0xf000f000
    v_cndmask_b32 v92, 0, v68, vcc
    v_cndmask_b32 v93, 0, v69, vcc
    v_cndmask_b32 v94, 0, v70, vcc
    v_cndmask_b32 v95, 0, v71, vcc
    v_mov_b32 v65, 0xff7f0000
    s_lshl_b32 s38, s34, 14
    s_add_u32 s38, s38, 16384
    v_lshl_add_u32 v64, v1, 2, s38
    buffer_load_dwordx4 a[8:11], v76, s[52:55], s85 offen offset:1024 nt
    v_mfma_f32_16x16x32_bf16 v[112:115], v[128:131], v[80:83], 0
    v_mfma_f32_16x16x32_bf16 v[112:115], v[132:135], v[84:87], v[112:115]
    buffer_load_dwordx4 a[12:15], v77, s[52:55], s85 offen offset:1024 nt
    s_add_u32 s87, s87, 7
    s_add_u32 s39, s87, s88
    s_bfe_u32 s37, s39, 0x30000
    s_lshl_b32 s37, s37, 12
    s_add_u32 s85, s37, s89
    s_bfe_u32 s37, s39, 0x10003
    s_lshl_b32 s37, s37, 11
    s_add_u32 s85, s37, s85
    s_bfe_u32 s37, s39, 0x40004
    s_lshl_b32 s37, s37, 16
    s_add_u32 s85, s37, s85
    v_mfma_f32_16x16x32_bf16 v[112:115], v[136:139], v[88:91], v[112:115]
    v_mfma_f32_16x16x32_bf16 v[112:115], v[140:143], v[92:95], v[112:115]
    buffer_load_dwordx4 a[16:19], v76, s[52:55], s85 offen offset:0 nt
    v_mfma_f32_16x16x32_bf16 v[96:99], v[144:147], v[80:83], 0
    v_mfma_f32_16x16x32_bf16 v[96:99], v[148:151], v[84:87], v[96:99]
    v_mfma_f32_16x16x32_bf16 v[96:99], v[152:155], v[88:91], v[96:99]
    s_nop 3
    v_mov_b32_dpp v122, v112 quad_perm:[0,0,0,0] row_mask:0xf bank_mask:0xf
    v_mov_b32_dpp v124, v114 quad_perm:[2,2,2,2] row_mask:0xf bank_mask:0xf
    s_nop 0
    v_add_f32_dpp v122, v113, v122 quad_perm:[1,1,1,1] row_mask:0xf bank_mask:0xf
    v_add_f32_dpp v124, v115, v124 quad_perm:[3,3,3,3] row_mask:0xf bank_mask:0xf
    v_add_f32 v122, v122, v124
    v_max_f32 v65, v65, v122
    ds_write_b32 v64, v122 offset:0
    s_waitcnt vmcnt(7)
    buffer_load_dwordx4 a[20:23], v77, s[52:55], s85 offen offset:0 nt
    v_mfma_f32_16x16x32_bf16 v[96:99], v[156:159], v[92:95], v[96:99]
    v_mfma_f32_16x16x32_bf16 v[112:115], v[160:163], v[80:83], 0
    s_waitcnt vmcnt(7)
    buffer_load_dwordx4 a[24:27], v76, s[52:55], s85 offen offset:1024 nt
    v_mfma_f32_16x16x32_bf16 v[112:115], v[164:167], v[84:87], v[112:115]
    v_mfma_f32_16x16x32_bf16 v[112:115], v[168:171], v[88:91], v[112:115]
    s_nop 2
    v_mov_b32_dpp v122, v96 quad_perm:[0,0,0,0] row_mask:0xf bank_mask:0xf
    v_mov_b32_dpp v124, v98 quad_perm:[2,2,2,2] row_mask:0xf bank_mask:0xf
    s_nop 0
    v_add_f32_dpp v122, v97, v122 quad_perm:[1,1,1,1] row_mask:0xf bank_mask:0xf
    v_add_f32_dpp v124, v99, v124 quad_perm:[3,3,3,3] row_mask:0xf bank_mask:0xf
    v_add_f32 v122, v122, v124
    v_max_f32 v65, v65, v122
    ds_write_b32 v64, v122 offset:256
    v_mfma_f32_16x16x32_bf16 v[112:115], v[172:175], v[92:95], v[112:115]
    s_waitcnt vmcnt(7)
    buffer_load_dwordx4 a[28:31], v77, s[52:55], s85 offen offset:1024 nt
    s_add_u32 s87, s87, 7
    s_add_u32 s39, s87, s88
    s_bfe_u32 s37, s39, 0x30000
    s_lshl_b32 s37, s37, 12
    s_add_u32 s85, s37, s89
    s_bfe_u32 s37, s39, 0x10003
    s_lshl_b32 s37, s37, 11
    s_add_u32 s85, s37, s85
    s_bfe_u32 s37, s39, 0x40004
    s_lshl_b32 s37, s37, 16
    s_add_u32 s85, s37, s85
    v_mfma_f32_16x16x32_bf16 v[96:99], v[176:179], v[80:83], 0
    v_mfma_f32_16x16x32_bf16 v[96:99], v[180:183], v[84:87], v[96:99]
    s_waitcnt vmcnt(7)
    buffer_load_dwordx4 a[32:35], v76, s[52:55], s85 offen offset:0 nt
    v_mfma_f32_16x16x32_bf16 v[96:99], v[184:187], v[88:91], v[96:99]
    v_mov_b32_dpp v122, v112 quad_perm:[0,0,0,0] row_mask:0xf bank_mask:0xf
    v_mov_b32_dpp v124, v114 quad_perm:[2,2,2,2] row_mask:0xf bank_mask:0xf
    s_nop 0
    v_add_f32_dpp v122, v113, v122 quad_perm:[1,1,1,1] row_mask:0xf bank_mask:0xf
    v_add_f32_dpp v124, v115, v124 quad_perm:[3,3,3,3] row_mask:0xf bank_mask:0xf
    v_add_f32 v122, v122, v124
    v_max_f32 v65, v65, v122
    ds_write_b32 v64, v122 offset:512
    v_mfma_f32_16x16x32_bf16 v[96:99], v[188:191], v[92:95], v[96:99]
    s_lshl_b32 s38, s32, 8
    s_add_u32 s69, s38, 98304
    s_lshl_b32 s38, s34, 13
    s_add_u32 s69, s38, s69
    v_mov_b32 v48, s69
    v_mov_b32 v49, s68
    s_waitcnt vmcnt(7)
    s_mov_b64 exec, 1
    buffer_store_dword v49, v48, s[48:51], 0 offen sc1
    s_mov_b64 exec, -1
    s_waitcnt vmcnt(7)
    buffer_load_dwordx4 a[36:39], v77, s[52:55], s85 offen offset:0 nt
    v_mfma_f32_16x16x32_bf16 v[112:115], v[192:195], v[80:83], 0
    v_mfma_f32_16x16x32_bf16 v[112:115], v[196:199], v[84:87], v[112:115]
    v_mfma_f32_16x16x32_bf16 v[112:115], v[200:203], v[88:91], v[112:115]
    v_mov_b32_dpp v122, v96 quad_perm:[0,0,0,0] row_mask:0xf bank_mask:0xf
    v_mov_b32_dpp v124, v98 quad_perm:[2,2,2,2] row_mask:0xf bank_mask:0xf
    s_nop 0
    v_add_f32_dpp v122, v97, v122 quad_perm:[1,1,1,1] row_mask:0xf bank_mask:0xf
    v_add_f32_dpp v124, v99, v124 quad_perm:[3,3,3,3] row_mask:0xf bank_mask:0xf
    v_add_f32 v122, v122, v124
    v_max_f32 v65, v65, v122
    ds_write_b32 v64, v122 offset:768
    s_waitcnt vmcnt(7)
    buffer_load_dwordx4 a[40:43], v76, s[52:55], s85 offen offset:1024 nt
    v_mfma_f32_16x16x32_bf16 v[112:115], v[204:207], v[92:95], v[112:115]
    v_mfma_f32_16x16x32_bf16 v[96:99], v[208:211], v[80:83], 0
    s_waitcnt vmcnt(7)
    buffer_load_dwordx4 a[44:47], v77, s[52:55], s85 offen offset:1024 nt
    s_add_u32 s87, s87, 7
    s_add_u32 s39, s87, s88
    s_bfe_u32 s37, s39, 0x30000
    s_lshl_b32 s37, s37, 12
    s_add_u32 s85, s37, s89
    s_bfe_u32 s37, s39, 0x10003
    s_lshl_b32 s37, s37, 11
    s_add_u32 s85, s37, s85
    s_bfe_u32 s37, s39, 0x40004
    s_lshl_b32 s37, s37, 16
    s_add_u32 s85, s37, s85
    v_mfma_f32_16x16x32_bf16 v[96:99], v[212:215], v[84:87], v[96:99]
    v_mfma_f32_16x16x32_bf16 v[96:99], v[216:219], v[88:91], v[96:99]
    v_mov_b32_dpp v122, v112 quad_perm:[0,0,0,0] row_mask:0xf bank_mask:0xf
    v_mov_b32_dpp v124, v114 quad_perm:[2,2,2,2] row_mask:0xf bank_mask:0xf
    s_nop 0
    v_add_f32_dpp v122, v113, v122 quad_perm:[1,1,1,1] row_mask:0xf bank_mask:0xf
    v_add_f32_dpp v124, v115, v124 quad_perm:[3,3,3,3] row_mask:0xf bank_mask:0xf
    v_add_f32 v122, v122, v124
    v_max_f32 v65, v65, v122
    ds_write_b32 v64, v122 offset:1024
    v_mfma_f32_16x16x32_bf16 v[96:99], v[220:223], v[92:95], v[96:99]
    s_waitcnt vmcnt(7)
    buffer_load_dwordx4 a[48:51], v76, s[52:55], s85 offen offset:0 nt
    v_mfma_f32_16x16x32_bf16 v[112:115], v[224:227], v[80:83], 0
    s_sub_u32 s36, s33, 3
    s_and_b32 s37, s33, 3
    s_cmp_lt_u32 s36, 4
    s_cselect_b64 s[40:41], s[24:25], s[14:15]
    s_cselect_b32 s36, s36, s37
    s_cselect_b32 s45, 262144, 0
    s_cselect_b32 s46, 8388608, 0
    s_add_u32 s45, s45, 524288
    s_add_u32 s46, s46, 196608
    s_mov_b32 s42, 4194304
    s_mov_b32 s43, 0x20000
    s_lshl_b32 s38, s32, 17
    s_add_u32 s44, s38, 0
    s_lshl_b32 s38, s34, 15
    s_add_u32 s44, s38, s44
    s_lshl_b32 s38, s36, 8
    s_add_u32 s44, s38, s44
    s_lshl_b32 s38, s36, 16
    s_add_u32 s45, s38, s45
    s_lshr_b32 s38, s34, 1
    s_lshl_b32 s38, s38, 15
    s_add_u32 s45, s38, s45
    s_lshl_b32 s38, s32, 8
    s_add_u32 s45, s38, s45
    s_bfe_u32 s38, s34, 0x10000
    s_lshl_b32 s38, s38, 7
    s_add_u32 s45, s38, s45
    s_lshl_b32 s38, s32, 11
    s_add_u32 s46, s38, s46
    s_lshl_b32 s38, s34, 9
    s_add_u32 s46, s38, s46
    s_mov_b32 s72, s26
    s_and_b32 s73, s27, 0xffff
    s_mov_b32 s74, 8192
    s_mov_b32 s75, 0x20000
    v_mfma_f32_16x16x32_bf16 v[112:115], v[228:231], v[84:87], v[112:115]
    s_waitcnt vmcnt(7)
    buffer_load_dwordx4 a[52:55], v77, s[52:55], s85 offen offset:0 nt
    v_mfma_f32_16x16x32_bf16 v[112:115], v[232:235], v[88:91], v[112:115]
    v_mov_b32_dpp v122, v96 quad_perm:[0,0,0,0] row_mask:0xf bank_mask:0xf
    v_mov_b32_dpp v124, v98 quad_perm:[2,2,2,2] row_mask:0xf bank_mask:0xf
    s_nop 0
    v_add_f32_dpp v122, v97, v122 quad_perm:[1,1,1,1] row_mask:0xf bank_mask:0xf
    v_add_f32_dpp v124, v99, v124 quad_perm:[3,3,3,3] row_mask:0xf bank_mask:0xf
    v_add_f32 v122, v122, v124
    v_max_f32 v65, v65, v122
    ds_write_b32 v64, v122 offset:1280
    v_mfma_f32_16x16x32_bf16 v[112:115], v[236:239], v[92:95], v[112:115]
    s_waitcnt vmcnt(7)
    buffer_load_dwordx4 a[56:59], v76, s[52:55], s85 offen offset:1024 nt
    v_mfma_f32_16x16x32_bf16 v[96:99], v[240:243], v[80:83], 0
    v_mfma_f32_16x16x32_bf16 v[96:99], v[244:247], v[84:87], v[96:99]
    v_mfma_f32_16x16x32_bf16 v[96:99], v[248:251], v[88:91], v[96:99]
    s_nop 2
    v_mov_b32_dpp v122, v112 quad_perm:[0,0,0,0] row_mask:0xf bank_mask:0xf
    v_mov_b32_dpp v124, v114 quad_perm:[2,2,2,2] row_mask:0xf bank_mask:0xf
    s_nop 0
    v_add_f32_dpp v122, v113, v122 quad_perm:[1,1,1,1] row_mask:0xf bank_mask:0xf
    v_add_f32_dpp v124, v115, v124 quad_perm:[3,3,3,3] row_mask:0xf bank_mask:0xf
    v_add_f32 v122, v122, v124
    v_max_f32 v65, v65, v122
    ds_write_b32 v64, v122 offset:1536
    v_lshlrev_b32 v4, 2, v2
    v_xor_b32 v4, v4, v3
    v_xor_b32 v5, 0, v4
    v_lshlrev_b32 v5, 4, v5
    v_lshl_add_u32 v20, v2, 10, v5
    v_xor_b32 v5, 1, v4
    v_lshlrev_b32 v5, 4, v5
    v_lshl_add_u32 v21, v2, 10, v5
    v_add_u32 v21, 3072, v21
    v_xor_b32 v5, 2, v4
    v_lshlrev_b32 v5, 4, v5
    v_lshl_add_u32 v22, v2, 10, v5
    v_add_u32 v22, 6144, v22
    v_xor_b32 v5, 3, v4
    v_lshlrev_b32 v5, 4, v5
    v_lshl_add_u32 v23, v2, 10, v5
    v_add_u32 v23, 9216, v23
    s_lshl_b32 s38, s32, 15
    s_add_u32 s47, s38, 1048576
    s_lshl_b32 s38, s3, 13
    s_add_u32 s47, s38, s47
    s_mul_i32 s38, s3, 320
    s_add_u32 s38, s38, 135168
    v_lshlrev_b32 v4, 6, v2
    v_lshl_add_u32 v4, v3, 1, v4
    v_add_u32 v31, s38, v4
    s_waitcnt vmcnt(7)
    buffer_load_dwordx4 a[60:63], v77, s[52:55], s85 offen offset:1024 nt
    s_add_u32 s87, s87, 7
    s_add_u32 s39, s87, s88
    s_bfe_u32 s37, s39, 0x30000
    s_lshl_b32 s37, s37, 12
    s_add_u32 s85, s37, s89
    s_bfe_u32 s37, s39, 0x10003
    s_lshl_b32 s37, s37, 11
    s_add_u32 s85, s37, s85
    s_bfe_u32 s37, s39, 0x40004
    s_lshl_b32 s37, s37, 16
    s_add_u32 s85, s37, s85
    v_mfma_f32_16x16x32_bf16 v[96:99], v[252:255], v[92:95], v[96:99]
    v_mfma_f32_16x16x32_bf16 v[112:115], a[0:3], v[80:83], 0
    s_waitcnt vmcnt(5)
    buffer_load_dwordx4 v[128:131], v76, s[52:55], s85 offen offset:0 nt
    v_mfma_f32_16x16x32_bf16 v[112:115], a[4:7], v[84:87], v[112:115]
    v_mfma_f32_16x16x32_bf16 v[112:115], a[8:11], v[88:91], v[112:115]
    s_nop 2
    v_mov_b32_dpp v122, v96 quad_perm:[0,0,0,0] row_mask:0xf bank_mask:0xf
    v_mov_b32_dpp v124, v98 quad_perm:[2,2,2,2] row_mask:0xf bank_mask:0xf
    s_nop 0
    v_add_f32_dpp v122, v97, v122 quad_perm:[1,1,1,1] row_mask:0xf bank_mask:0xf
    v_add_f32_dpp v124, v99, v124 quad_perm:[3,3,3,3] row_mask:0xf bank_mask:0xf
    v_add_f32 v122, v122, v124
    v_max_f32 v65, v65, v122
    ds_write_b32 v64, v122 offset:1792
    v_mfma_f32_16x16x32_bf16 v[112:115], a[12:15], v[92:95], v[112:115]
    s_waitcnt vmcnt(5)
    buffer_load_dwordx4 v[132:135], v77, s[52:55], s85 offen offset:0 nt
    v_mfma_f32_16x16x32_bf16 v[96:99], a[16:19], v[80:83], 0
    v_lshlrev_b32 v4, 11, v2
    v_bfe_u32 v5, v1, 2, 2
    v_lshl_add_u32 v4, v5, 8, v4
    v_bfe_u32 v5, v1, 2, 2
    v_lshl_add_u32 v4, v5, 6, v4
    v_bfe_u32 v5, v1, 4, 1
    v_lshl_add_u32 v4, v5, 5, v4
    v_bfe_u32 v5, v1, 1, 1
    v_lshl_add_u32 v4, v5, 4, v4
    v_bfe_u32 v5, v1, 0, 1
    v_lshl_add_u32 v4, v5, 3, v4
    s_lshl_b32 s38, s34, 6
    s_add_u32 s38, s38, 98304
    v_xor_b32 v24, s38, v4
    v_xor_b32 v25, 16, v24
    v_xor_b32 v26, 32, v24
    v_xor_b32 v27, 48, v24
    v_and_b32 v4, 3, v3
    v_lshrrev_b32 v5, 2, v3
    v_lshlrev_b32 v6, 4, v2
    v_add_u32 v6, 135168, v6
    s_movk_i32 s36, 320
    v_cmp_eq_u32 vcc, 0, v5
    s_nop 1
    v_cndmask_b32 v28, 4, v4, vcc
    v_mad_u32_u24 v28, v28, s36, v6
    v_cmp_eq_u32 vcc, 1, v5
    s_nop 1
    v_cndmask_b32 v29, 4, v4, vcc
    v_mad_u32_u24 v29, v29, s36, v6
    v_lshlrev_b32 v5, 2, v1
    v_add_u32 v5, 136448, v5
    v_mov_b32 v6, 0
    ds_write_b32 v5, v6
    v_mfma_f32_16x16x32_bf16 v[96:99], a[20:23], v[84:87], v[96:99]
    s_waitcnt vmcnt(5)
    buffer_load_dwordx4 v[136:139], v76, s[52:55], s85 offen offset:1024 nt
    v_mfma_f32_16x16x32_bf16 v[96:99], a[24:27], v[88:91], v[96:99]
    v_mov_b32_dpp v122, v112 quad_perm:[0,0,0,0] row_mask:0xf bank_mask:0xf
    v_mov_b32_dpp v124, v114 quad_perm:[2,2,2,2] row_mask:0xf bank_mask:0xf
    s_nop 0
    v_add_f32_dpp v122, v113, v122 quad_perm:[1,1,1,1] row_mask:0xf bank_mask:0xf
    v_add_f32_dpp v124, v115, v124 quad_perm:[3,3,3,3] row_mask:0xf bank_mask:0xf
    v_add_f32 v122, v122, v124
    v_max_f32 v65, v65, v122
    ds_write_b32 v64, v122 offset:2048
    v_mfma_f32_16x16x32_bf16 v[96:99], a[28:31], v[92:95], v[96:99]
    s_waitcnt vmcnt(5)
    buffer_load_dwordx4 v[140:143], v77, s[52:55], s85 offen offset:1024 nt
    s_add_u32 s87, s87, 7
    s_add_u32 s39, s87, s88
    s_bfe_u32 s37, s39, 0x30000
    s_lshl_b32 s37, s37, 12
    s_add_u32 s85, s37, s89
    s_bfe_u32 s37, s39, 0x10003
    s_lshl_b32 s37, s37, 11
    s_add_u32 s85, s37, s85
    s_bfe_u32 s37, s39, 0x40004
    s_lshl_b32 s37, s37, 16
    s_add_u32 s85, s37, s85
    v_mfma_f32_16x16x32_bf16 v[112:115], a[32:35], v[80:83], 0
    v_mfma_f32_16x16x32_bf16 v[112:115], a[36:39], v[84:87], v[112:115]
    v_mfma_f32_16x16x32_bf16 v[112:115], a[40:43], v[88:91], v[112:115]
    v_mov_b32_dpp v122, v96 quad_perm:[0,0,0,0] row_mask:0xf bank_mask:0xf
    v_mov_b32_dpp v124, v98 quad_perm:[2,2,2,2] row_mask:0xf bank_mask:0xf
    s_nop 0
    v_add_f32_dpp v122, v97, v122 quad_perm:[1,1,1,1] row_mask:0xf bank_mask:0xf
    v_add_f32_dpp v124, v99, v124 quad_perm:[3,3,3,3] row_mask:0xf bank_mask:0xf
    v_add_f32 v122, v122, v124
    v_max_f32 v65, v65, v122
    ds_write_b32 v64, v122 offset:2304
    v_lshlrev_b32 v30, 4, v3
    v_lshl_add_u32 v30, v2, 13, v30
    s_lshl_b32 s38, s32, 13
    s_add_u32 s36, s38, 0
    s_lshl_b32 s38, s34, 6
    s_add_u32 s36, s38, s36
    v_lshrrev_b32 v5, 2, v1
    v_lshlrev_b32 v32, 8, v5
    v_bfe_u32 v5, v1, 0, 2
    v_lshl_add_u32 v32, v5, 4, v32
    v_add_u32 v32, s36, v32
    s_lshr_b32 s38, s32, 2
    s_lshl_b32 s38, s38, 7
    s_add_u32 s36, s38, 0
    s_lshl_b32 s38, s34, 5
    s_add_u32 s36, s38, s36
    s_bfe_u32 s38, s32, 0x20000
    s_lshl_b32 s38, s38, 3
    s_add_u32 s36, s38, s36
    v_bfe_u32 v5, v1, 0, 2
    v_lshlrev_b32 v33, 11, v5
    v_lshl_add_u32 v33, v2, 1, v33
    v_add_u32 v33, s36, v33
    v_and_b32 v5, 31, v1
    v_lshlrev_b32 v34, 4, v5
    s_mul_i32 s38, s34, 320
    s_add_u32 s38, s38, 135168
    v_lshl_add_u32 v35, v5, 3, s38
    s_waitcnt vmcnt(5)
    buffer_load_dwordx4 v[144:147], v76, s[52:55], s85 offen offset:0 nt
    v_mfma_f32_16x16x32_bf16 v[112:115], a[44:47], v[92:95], v[112:115]
    v_mfma_f32_16x16x32_bf16 v[96:99], a[48:51], v[80:83], 0
    s_waitcnt vmcnt(5)
    buffer_load_dwordx4 v[148:151], v77, s[52:55], s85 offen offset:0 nt
    v_mfma_f32_16x16x32_bf16 v[96:99], a[52:55], v[84:87], v[96:99]
    v_mfma_f32_16x16x32_bf16 v[96:99], a[56:59], v[88:91], v[96:99]
    s_nop 2
    v_mov_b32_dpp v122, v112 quad_perm:[0,0,0,0] row_mask:0xf bank_mask:0xf
    v_mov_b32_dpp v124, v114 quad_perm:[2,2,2,2] row_mask:0xf bank_mask:0xf
    s_nop 0
    v_add_f32_dpp v122, v113, v122 quad_perm:[1,1,1,1] row_mask:0xf bank_mask:0xf
    v_add_f32_dpp v124, v115, v124 quad_perm:[3,3,3,3] row_mask:0xf bank_mask:0xf
    v_add_f32 v122, v122, v124
    v_max_f32 v65, v65, v122
    ds_write_b32 v64, v122 offset:2560
    v_mfma_f32_16x16x32_bf16 v[96:99], a[60:63], v[92:95], v[96:99]
    v_add_u32 v64, 2816, v64
    s_mov_b32 s97, 10
    s_mov_b32 s86, 32
    s_mov_b32 s66, 134217728
    s_mov_b32 s67, 0x20000
    s_mov_b64 s[64:65], s[52:53]
    v_mov_b32 v62, v76
    v_mov_b32 v63, v77
    s_branch L_bloop
L_aux:
    v_lshlrev_b32 v4, 2, v2
    v_xor_b32 v4, v4, v3
    v_xor_b32 v96, 0, v4
    v_lshlrev_b32 v96, 4, v96
    v_lshl_add_u32 v10, v2, 13, v96
    v_xor_b32 v97, 1, v4
    v_lshlrev_b32 v97, 4, v97
    v_lshl_add_u32 v11, v2, 13, v97
    v_add_u32 v11, 31744, v11
    v_xor_b32 v98, 2, v4
    v_lshlrev_b32 v98, 4, v98
    v_lshl_add_u32 v12, v2, 13, v98
    v_add_u32 v12, 63488, v12
    v_xor_b32 v99, 3, v4
    v_lshlrev_b32 v99, 4, v99
    v_lshl_add_u32 v13, v2, 13, v99
    v_add_u32 v13, 95232, v13
    s_lshl_b32 s90, s34, 15
    s_mov_b32 s62, 0
    s_mov_b32 s94, 0
    s_lshl_b32 s95, s34, 20
    s_lshl_b32 s38, s32, 8
    s_add_u32 s95, s95, s38
    s_waitcnt lgkmcnt(0)
    s_mov_b32 s52, s12
    s_and_b32 s53, s13, 0xffff
    s_mov_b32 s54, 4194304
    s_mov_b32 s55, 0x20000
    s_add_u32 s39, s90, s62
    s_mov_b32 m0, s39
    s_add_u32 s62, s62, 4096
    s_and_b32 s62, s62, 0x7fff
    buffer_load_dwordx4 v10, s[52:55], s95 offen offset:0 nt lds
    buffer_load_dwordx4 v11, s[52:55], s95 offen offset:1024 nt lds
    buffer_load_dwordx4 v12, s[52:55], s95 offen offset:2048 nt lds
    buffer_load_dwordx4 v13, s[52:55], s95 offen offset:3072 nt lds
    s_add_u32 s95, s95, 131072
    s_add_u32 s39, s90, s62
    s_mov_b32 m0, s39
    s_add_u32 s62, s62, 4096
    s_and_b32 s62, s62, 0x7fff
    buffer_load_dwordx4 v10, s[52:55], s95 offen offset:0 nt lds
    buffer_load_dwordx4 v11, s[52:55], s95 offen offset:1024 nt lds
    buffer_load_dwordx4 v12, s[52:55], s95 offen offset:2048 nt lds
    buffer_load_dwordx4 v13, s[52:55], s95 offen offset:3072 nt lds
    s_add_u32 s95, s95, 131072
    s_load_dword s35, s[30:31], 0
    s_mov_b32 s48, s30
    s_and_b32 s49, s31, 0xffff
    s_mov_b32 s50, 8388608
    s_mov_b32 s51, 0x20000
    s_mov_b32 s82, 0xffffff00
    s_mov_b32 s83, 0x3e0293ee
    s_mov_b32 s84, 2097152
    v_lshl_add_u32 v76, v2, 10, v96
    v_lshl_add_u32 v96, v2, 8, v96
    v_lshl_add_u32 v77, v2, 10, v97
    v_lshl_add_u32 v97, v2, 8, v97
    v_add_u32 v77, 3072, v77
    v_lshl_add_u32 v78, v2, 10, v98
    v_lshl_add_u32 v98, v2, 8, v98
    v_add_u32 v78, 6144, v78
    v_lshl_add_u32 v79, v2, 10, v99
    v_lshl_add_u32 v99, v2, 8, v99
    v_add_u32 v79, 9216, v79
    v_bfe_u32 v100, v1, 0, 5
    v_lshlrev_b32 v101, 8, v100
    v_mov_b32 v100, 0
    s_lshl_b32 s38, s34, 13
    v_add_u32 v101, s38, v101
    v_lshlrev_b32 v4, 4, v3
    v_lshl_add_u32 v9, v2, 10, v4
    v_and_b32 v4, 3, v1
    v_bfe_u32 v5, v1, 2, 2
    v_lshrrev_b32 v6, 5, v1
    v_lshl_add_u32 v7, v4, 2, v5
    v_xor_b32 v7, v7, v6
    v_lshlrev_b32 v7, 4, v7
    v_and_b32 v80, 31, v1
    v_lshl_add_u32 v80, v80, 8, v7
    v_lshl_add_u32 v81, v6, 2, v5
    v_lshlrev_b32 v81, 8, v81
    v_lshl_add_u32 v81, v5, 6, v81
    v_bfe_u32 v7, v1, 4, 1
    v_lshlrev_b32 v7, 1, v7
    v_bfe_u32 v82, v1, 1, 1
    v_add_u32 v7, v7, v82
    v_xor_b32 v7, v7, v6
    v_lshl_add_u32 v81, v7, 4, v81
    v_and_b32 v7, 1, v1
    v_lshl_add_u32 v81, v7, 3, v81
    v_lshl_add_u32 v95, v2, 3, v5
    v_lshlrev_b32 v95, 8, v95
    v_lshl_add_u32 v95, v5, 6, v95
    v_bfe_u32 v4, v1, 4, 1
    v_lshl_add_u32 v4, v4, 1, v82
    v_lshl_add_u32 v95, v4, 4, v95
    v_lshl_add_u32 v95, v7, 3, v95
    v_add_u32 v95, s90, v95
    v_xor_b32 v136, 0, v95
    v_xor_b32 v137, 16, v95
    v_xor_b32 v138, 32, v95
    v_xor_b32 v139, 48, v95
    v_xor_b32 v140, 64, v95
    v_xor_b32 v141, 80, v95
    v_xor_b32 v142, 96, v95
    v_xor_b32 v143, 112, v95
    v_xor_b32 v144, 128, v95
    v_xor_b32 v145, 144, v95
    v_xor_b32 v146, 160, v95
    v_xor_b32 v147, 176, v95
    v_xor_b32 v148, 192, v95
    v_xor_b32 v149, 208, v95
    v_xor_b32 v150, 224, v95
    v_xor_b32 v151, 240, v95
    s_lshl_b32 s85, s34, 13
    s_add_u32 s85, s85, 131072
    v_lshl_add_u32 v94, v1, 4, s85
    v_add_u32 v96, s85, v96
    v_add_u32 v97, s85, v97
    v_add_u32 v98, s85, v98
    v_add_u32 v99, s85, v99
    s_add_u32 s39, s90, s62
    s_mov_b32 m0, s39
    s_add_u32 s62, s62, 4096
    s_and_b32 s62, s62, 0x7fff
    buffer_load_dwordx4 v10, s[52:55], s95 offen offset:0 nt lds
    buffer_load_dwordx4 v11, s[52:55], s95 offen offset:1024 nt lds
    buffer_load_dwordx4 v12, s[52:55], s95 offen offset:2048 nt lds
    buffer_load_dwordx4 v13, s[52:55], s95 offen offset:3072 nt lds
    s_add_u32 s95, s95, 131072
    s_add_u32 s39, s90, s62
    s_mov_b32 m0, s39
    s_add_u32 s62, s62, 4096
    s_and_b32 s62, s62, 0x7fff
    buffer_load_dwordx4 v10, s[52:55], s95 offen offset:0 nt lds
    buffer_load_dwordx4 v11, s[52:55], s95 offen offset:1024 nt lds
    buffer_load_dwordx4 v12, s[52:55], s95 offen offset:2048 nt lds
    buffer_load_dwordx4 v13, s[52:55], s95 offen offset:3072 nt lds
    s_add_u32 s95, s95, 131072
    s_add_u32 s39, s90, s62
    s_mov_b32 m0, s39
    s_add_u32 s62, s62, 4096
    s_and_b32 s62, s62, 0x7fff
    buffer_load_dwordx4 v10, s[52:55], s95 offen offset:0 nt lds
    buffer_load_dwordx4 v11, s[52:55], s95 offen offset:1024 nt lds
    buffer_load_dwordx4 v12, s[52:55], s95 offen offset:2048 nt lds
    buffer_load_dwordx4 v13, s[52:55], s95 offen offset:3072 nt lds
    s_add_u32 s95, s95, 131072
    s_add_u32 s39, s90, s62
    s_mov_b32 m0, s39
    s_add_u32 s62, s62, 4096
    s_and_b32 s62, s62, 0x7fff
    buffer_load_dwordx4 v10, s[52:55], s95 offen offset:0 nt lds
    buffer_load_dwordx4 v11, s[52:55], s95 offen offset:1024 nt lds
    buffer_load_dwordx4 v12, s[52:55], s95 offen offset:2048 nt lds
    buffer_load_dwordx4 v13, s[52:55], s95 offen offset:3072 nt lds
    s_add_u32 s95, s95, 131072
    s_add_u32 s39, s90, s62
    s_mov_b32 m0, s39
    s_add_u32 s62, s62, 4096
    s_and_b32 s62, s62, 0x7fff
    buffer_load_dwordx4 v10, s[52:55], s95 offen offset:0 nt lds
    buffer_load_dwordx4 v11, s[52:55], s95 offen offset:1024 nt lds
    buffer_load_dwordx4 v12, s[52:55], s95 offen offset:2048 nt lds
    buffer_load_dwordx4 v13, s[52:55], s95 offen offset:3072 nt lds
    s_add_u32 s95, s95, 131072
    s_add_u32 s39, s90, s62
    s_mov_b32 m0, s39
    s_add_u32 s62, s62, 4096
    s_and_b32 s62, s62, 0x7fff
    buffer_load_dwordx4 v10, s[52:55], s95 offen offset:0 nt lds
    buffer_load_dwordx4 v11, s[52:55], s95 offen offset:1024 nt lds
    buffer_load_dwordx4 v12, s[52:55], s95 offen offset:2048 nt lds
    buffer_load_dwordx4 v13, s[52:55], s95 offen offset:3072 nt lds
    s_add_u32 s95, s95, 131072
    s_waitcnt lgkmcnt(0)
    s_add_u32 s35, s35, 0x5b
    s_and_b32 s35, s35, 0xff
    v_mov_b32 v8, s35
    s_or_b32 s68, s35, 0x6b3ac500
    s_mov_b32 s52, s6
    s_and_b32 s53, s7, 0xffff
    s_mov_b32 s54, 16777216
    s_mov_b32 s55, 0x20000
    s_bfe_u32 s38, s32, 0x30000
    s_lshl_b32 s38, s38, 2
    s_add_u32 s3, s38, 0
    s_lshr_b32 s38, s32, 3
    s_lshl_b32 s38, s38, 0
    s_add_u32 s3, s38, s3
    s_lshl_b32 s38, s3, 19
    s_add_u32 s95, s38, 0
    s_lshl_b32 s38, s34, 8
    s_add_u32 s95, s38, s95
    s_waitcnt vmcnt(24)
    ds_read_b64_tr_b16 a[128:129], v136 offset:0
    ds_read_b64_tr_b16 a[130:131], v137 offset:1024
    ds_read_b64_tr_b16 a[144:145], v138 offset:0
    ds_read_b64_tr_b16 a[146:147], v139 offset:1024
    ds_read_b64_tr_b16 a[160:161], v140 offset:0
    ds_read_b64_tr_b16 a[162:163], v141 offset:1024
    ds_read_b64_tr_b16 a[176:177], v142 offset:0
    ds_read_b64_tr_b16 a[178:179], v143 offset:1024
    ds_read_b64_tr_b16 a[192:193], v144 offset:0
    ds_read_b64_tr_b16 a[194:195], v145 offset:1024
    ds_read_b64_tr_b16 a[208:209], v146 offset:0
    ds_read_b64_tr_b16 a[210:211], v147 offset:1024
    ds_read_b64_tr_b16 a[224:225], v148 offset:0
    ds_read_b64_tr_b16 a[226:227], v149 offset:1024
    ds_read_b64_tr_b16 a[240:241], v150 offset:0
    ds_read_b64_tr_b16 a[242:243], v151 offset:1024
    s_waitcnt lgkmcnt(0)
    s_add_u32 s39, s90, s62
    s_mov_b32 m0, s39
    s_add_u32 s62, s62, 4096
    s_and_b32 s62, s62, 0x7fff
    buffer_load_dwordx4 v76, s[52:55], s95 offen offset:0 nt lds
    buffer_load_dwordx4 v77, s[52:55], s95 offen offset:1024 nt lds
    buffer_load_dwordx4 v78, s[52:55], s95 offen offset:2048 nt lds
    buffer_load_dwordx4 v79, s[52:55], s95 offen offset:3072 nt lds
    s_add_u32 s95, s95, 16384
    s_add_u32 s39, s90, s62
    s_mov_b32 m0, s39
    s_add_u32 s62, s62, 4096
    s_and_b32 s62, s62, 0x7fff
    buffer_load_dwordx4 v76, s[52:55], s95 offen offset:0 nt lds
    buffer_load_dwordx4 v77, s[52:55], s95 offen offset:1024 nt lds
    buffer_load_dwordx4 v78, s[52:55], s95 offen offset:2048 nt lds
    buffer_load_dwordx4 v79, s[52:55], s95 offen offset:3072 nt lds
    s_add_u32 s95, s95, 16384
    s_waitcnt vmcnt(24)
    ds_read_b64_tr_b16 a[132:133], v136 offset:8192
    ds_read_b64_tr_b16 a[134:135], v137 offset:9216
    ds_read_b64_tr_b16 a[148:149], v138 offset:8192
    ds_read_b64_tr_b16 a[150:151], v139 offset:9216
    ds_read_b64_tr_b16 a[164:165], v140 offset:8192
    ds_read_b64_tr_b16 a[166:167], v141 offset:9216
    ds_read_b64_tr_b16 a[180:181], v142 offset:8192
    ds_read_b64_tr_b16 a[182:183], v143 offset:9216
    ds_read_b64_tr_b16 a[196:197], v144 offset:8192
    ds_read_b64_tr_b16 a[198:199], v145 offset:9216
    ds_read_b64_tr_b16 a[212:213], v146 offset:8192
    ds_read_b64_tr_b16 a[214:215], v147 offset:9216
    ds_read_b64_tr_b16 a[228:229], v148 offset:8192
    ds_read_b64_tr_b16 a[230:231], v149 offset:9216
    ds_read_b64_tr_b16 a[244:245], v150 offset:8192
    ds_read_b64_tr_b16 a[246:247], v151 offset:9216
    s_waitcnt lgkmcnt(0)
    s_add_u32 s39, s90, s62
    s_mov_b32 m0, s39
    s_add_u32 s62, s62, 4096
    s_and_b32 s62, s62, 0x7fff
    buffer_load_dwordx4 v76, s[52:55], s95 offen offset:0 nt lds
    buffer_load_dwordx4 v77, s[52:55], s95 offen offset:1024 nt lds
    buffer_load_dwordx4 v78, s[52:55], s95 offen offset:2048 nt lds
    buffer_load_dwordx4 v79, s[52:55], s95 offen offset:3072 nt lds
    s_add_u32 s95, s95, 16384
    s_add_u32 s39, s90, s62
    s_mov_b32 m0, s39
    s_add_u32 s62, s62, 4096
    s_and_b32 s62, s62, 0x7fff
    buffer_load_dwordx4 v76, s[52:55], s95 offen offset:0 nt lds
    buffer_load_dwordx4 v77, s[52:55], s95 offen offset:1024 nt lds
    buffer_load_dwordx4 v78, s[52:55], s95 offen offset:2048 nt lds
    buffer_load_dwordx4 v79, s[52:55], s95 offen offset:3072 nt lds
    s_add_u32 s95, s95, 16384
    s_waitcnt vmcnt(24)
    ds_read_b64_tr_b16 a[136:137], v136 offset:16384
    ds_read_b64_tr_b16 a[138:139], v137 offset:17408
    ds_read_b64_tr_b16 a[152:153], v138 offset:16384
    ds_read_b64_tr_b16 a[154:155], v139 offset:17408
    ds_read_b64_tr_b16 a[168:169], v140 offset:16384
    ds_read_b64_tr_b16 a[170:171], v141 offset:17408
    ds_read_b64_tr_b16 a[184:185], v142 offset:16384
    ds_read_b64_tr_b16 a[186:187], v143 offset:17408
    ds_read_b64_tr_b16 a[200:201], v144 offset:16384
    ds_read_b64_tr_b16 a[202:203], v145 offset:17408
    ds_read_b64_tr_b16 a[216:217], v146 offset:16384
    ds_read_b64_tr_b16 a[218:219], v147 offset:17408
    ds_read_b64_tr_b16 a[232:233], v148 offset:16384
    ds_read_b64_tr_b16 a[234:235], v149 offset:17408
    ds_read_b64_tr_b16 a[248:249], v150 offset:16384
    ds_read_b64_tr_b16 a[250:251], v151 offset:17408
    s_waitcnt lgkmcnt(0)
    s_add_u32 s39, s90, s62
    s_mov_b32 m0, s39
    s_add_u32 s62, s62, 4096
    s_and_b32 s62, s62, 0x7fff
    buffer_load_dwordx4 v76, s[52:55], s95 offen offset:0 nt lds
    buffer_load_dwordx4 v77, s[52:55], s95 offen offset:1024 nt lds
    buffer_load_dwordx4 v78, s[52:55], s95 offen offset:2048 nt lds
    buffer_load_dwordx4 v79, s[52:55], s95 offen offset:3072 nt lds
    s_add_u32 s95, s95, 16384
    s_add_u32 s39, s90, s62
    s_mov_b32 m0, s39
    s_add_u32 s62, s62, 4096
    s_and_b32 s62, s62, 0x7fff
    buffer_load_dwordx4 v76, s[52:55], s95 offen offset:0 nt lds
    buffer_load_dwordx4 v77, s[52:55], s95 offen offset:1024 nt lds
    buffer_load_dwordx4 v78, s[52:55], s95 offen offset:2048 nt lds
    buffer_load_dwordx4 v79, s[52:55], s95 offen offset:3072 nt lds
    s_add_u32 s95, s95, 16384
    s_waitcnt vmcnt(24)
    ds_read_b64_tr_b16 a[140:141], v136 offset:24576
    ds_read_b64_tr_b16 a[142:143], v137 offset:25600
    ds_read_b64_tr_b16 a[156:157], v138 offset:24576
    ds_read_b64_tr_b16 a[158:159], v139 offset:25600
    ds_read_b64_tr_b16 a[172:173], v140 offset:24576
    ds_read_b64_tr_b16 a[174:175], v141 offset:25600
    ds_read_b64_tr_b16 a[188:189], v142 offset:24576
    ds_read_b64_tr_b16 a[190:191], v143 offset:25600
    ds_read_b64_tr_b16 a[204:205], v144 offset:24576
    ds_read_b64_tr_b16 a[206:207], v145 offset:25600
    ds_read_b64_tr_b16 a[220:221], v146 offset:24576
    ds_read_b64_tr_b16 a[222:223], v147 offset:25600
    ds_read_b64_tr_b16 a[236:237], v148 offset:24576
    ds_read_b64_tr_b16 a[238:239], v149 offset:25600
    ds_read_b64_tr_b16 a[252:253], v150 offset:24576
    ds_read_b64_tr_b16 a[254:255], v151 offset:25600
    s_waitcnt lgkmcnt(0)
    s_mov_b32 s86, 98304
    buffer_load_dword v7, v101, s[48:51], s86 offen sc1
    s_add_u32 s39, s90, s62
    s_mov_b32 m0, s39
    s_add_u32 s62, s62, 4096
    s_and_b32 s62, s62, 0x7fff
    buffer_load_dwordx4 v76, s[52:55], s95 offen offset:0 nt lds
    buffer_load_dwordx4 v77, s[52:55], s95 offen offset:1024 nt lds
    buffer_load_dwordx4 v78, s[52:55], s95 offen offset:2048 nt lds
    buffer_load_dwordx4 v79, s[52:55], s95 offen offset:3072 nt lds
    s_add_u32 s95, s95, 16384
    s_add_u32 s39, s90, s62
    s_mov_b32 m0, s39
    s_add_u32 s62, s62, 4096
    s_and_b32 s62, s62, 0x7fff
    buffer_load_dwordx4 v76, s[52:55], s95 offen offset:0 nt lds
    v_mov_b32 v136, 0
    v_mov_b32 v137, 0
    v_mov_b32 v138, 0
    v_mov_b32 v139, 0
    v_mov_b32 v140, 0
    v_mov_b32 v141, 0
    v_mov_b32 v142, 0
    v_mov_b32 v143, 0
    v_mov_b32 v144, 0
    v_mov_b32 v145, 0
    v_mov_b32 v146, 0
    v_mov_b32 v147, 0
    v_mov_b32 v148, 0
    v_mov_b32 v149, 0
    v_mov_b32 v150, 0
    v_mov_b32 v151, 0
    v_mov_b32 v152, 0
    v_mov_b32 v153, 0
    v_mov_b32 v154, 0
    v_mov_b32 v155, 0
    v_mov_b32 v156, 0
    v_mov_b32 v157, 0
    v_mov_b32 v158, 0
    v_mov_b32 v159, 0
    v_mov_b32 v160, 0
    v_mov_b32 v161, 0
    v_mov_b32 v162, 0
    v_mov_b32 v163, 0
    v_mov_b32 v164, 0
    v_mov_b32 v165, 0
    v_mov_b32 v166, 0
    v_mov_b32 v167, 0
    v_mov_b32 v168, 0
    v_mov_b32 v169, 0
    v_mov_b32 v170, 0
    v_mov_b32 v171, 0
    v_mov_b32 v172, 0
    v_mov_b32 v173, 0
    v_mov_b32 v174, 0
    v_mov_b32 v175, 0
    v_mov_b32 v176, 0
    v_mov_b32 v177, 0
    v_mov_b32 v178, 0
    v_mov_b32 v179, 0
    v_mov_b32 v180, 0
    v_mov_b32 v181, 0
    v_mov_b32 v182, 0
    v_mov_b32 v183, 0
    v_mov_b32 v184, 0
    v_mov_b32 v185, 0
    v_mov_b32 v186, 0
    v_mov_b32 v187, 0
    v_mov_b32 v188, 0
    v_mov_b32 v189, 0
    v_mov_b32 v190, 0
    v_mov_b32 v191, 0
    v_mov_b32 v192, 0
    v_mov_b32 v193, 0
    v_mov_b32 v194, 0
    v_mov_b32 v195, 0
    v_mov_b32 v196, 0
    v_mov_b32 v197, 0
    v_mov_b32 v198, 0
    v_mov_b32 v199, 0
    v_mov_b32 v90, 0xff7f0000
    s_mov_b32 s93, 0
    v_mov_b32 v102, 0
    v_mov_b32 v103, 0
    s_mov_b32 s60, s83
    s_mov_b32 s61, s83
    v_add_u32 v4, s85, v80
    v_xor_b32 v82, 0, v4
    v_xor_b32 v83, 32, v4
    v_xor_b32 v84, 64, v4
    v_xor_b32 v85, 96, v4
    v_xor_b32 v86, 128, v4
    v_xor_b32 v87, 160, v4
    v_xor_b32 v88, 192, v4
    v_xor_b32 v89, 224, v4
    v_add_u32 v80, s90, v80
    v_add_u32 v81, s90, v81
    s_lshr_b32 s38, s3, 3
    s_lshl_b32 s38, s38, 15
    s_add_u32 s36, s38, 393216
    s_lshl_b32 s38, s34, 8
    s_add_u32 s36, s38, s36
    s_waitcnt vmcnt(5)
L_fcheck_24:
    v_cmp_ne_u32 vcc, s68, v7
    s_cbranch_vccz L_fok_25
    s_sleep 2
    s_mov_b32 s86, 98304
    buffer_load_dword v7, v101, s[48:51], s86 offen sc1
    s_waitcnt vmcnt(0)
    s_sub_u32 s84, s84, 1
    s_cmp_lg_u32 s84, 0
    s_cbranch_scc1 L_fcheck_24
    s_branch L_end
L_fok_25:
    buffer_load_dwordx4 v[20:23], v9, s[48:51], s36 offen sc1
    s_add_u32 s36, s36, 4096
    buffer_load_dwordx4 v[24:27], v9, s[48:51], s36 offen sc1
    s_add_u32 s36, s36, 4096
    buffer_load_dwordx4 v[28:31], v9, s[48:51], s36 offen sc1
    s_add_u32 s36, s36, 4096
    buffer_load_dwordx4 v[32:35], v9, s[48:51], s36 offen sc1
    s_add_u32 s36, s36, 4096
    buffer_load_dwordx4 v[36:39], v9, s[48:51], s36 offen sc1
    s_add_u32 s36, s36, 4096
    buffer_load_dwordx4 v[40:43], v9, s[48:51], s36 offen sc1
    s_add_u32 s36, s36, 4096
    buffer_load_dwordx4 v[44:47], v9, s[48:51], s36 offen sc1
    s_add_u32 s36, s36, 4096
    buffer_load_dwordx4 v[48:51], v9, s[48:51], s36 offen sc1
    s_waitcnt vmcnt(7)
    ds_write_b128 v96, v[20:23] offset:0
    s_waitcnt vmcnt(6)
    ds_write_b128 v97, v[24:27] offset:1024
    s_waitcnt vmcnt(5)
    ds_write_b128 v98, v[28:31] offset:2048
    s_waitcnt vmcnt(4)
    ds_write_b128 v99, v[32:35] offset:3072
    s_waitcnt vmcnt(3)
    ds_write_b128 v96, v[36:39] offset:4096
    s_waitcnt vmcnt(2)
    ds_write_b128 v97, v[40:43] offset:5120
    s_waitcnt vmcnt(1)
    ds_write_b128 v98, v[44:47] offset:6144
    s_waitcnt vmcnt(0)
    ds_write_b128 v99, v[48:51] offset:7168
    s_waitcnt lgkmcnt(0)
    ds_read_b128 v[104:107], v82
    ds_read_b128 v[108:111], v83
    ds_read_b128 v[112:115], v84
    ds_read_b128 v[116:119], v85
    ds_read_b128 v[120:123], v86
    ds_read_b128 v[124:127], v87
    ds_read_b128 v[128:131], v88
    ds_read_b128 v[132:135], v89
    v_xor_b32 v82, 0, v80
    ds_read_b128 v[216:219], v82
    v_xor_b32 v83, 32, v80
    ds_read_b128 v[220:223], v83
    v_xor_b32 v84, 64, v80
    ds_read_b128 v[224:227], v84
    v_xor_b32 v85, 96, v80
    ds_read_b128 v[228:231], v85
    v_xor_b32 v86, 128, v80
    ds_read_b128 v[232:235], v86
    v_xor_b32 v87, 160, v80
    ds_read_b128 v[236:239], v87
    v_xor_b32 v88, 192, v80
    ds_read_b128 v[240:243], v88
    v_xor_b32 v89, 224, v80
    ds_read_b128 v[244:247], v89
L_att:
    v_add_u32 v4, s94, v81
    s_waitcnt lgkmcnt(0)
    v_mfma_f32_32x32x16_bf16 v[200:215], v[216:219], v[104:107], 0
    v_xor_b32 v82, 0, v4
    ds_read_b64_tr_b16 v[20:21], v82 offset:0
    ds_read_b64_tr_b16 v[24:25], v82 offset:4096
    buffer_load_dwordx4 v77, s[52:55], s95 offen offset:1024 nt lds
    v_mfma_f32_32x32x16_bf16 v[200:215], v[220:223], v[108:111], v[200:215]
    v_xor_b32 v83, 32, v4
    ds_read_b64_tr_b16 v[22:23], v83 offset:2048
    ds_read_b64_tr_b16 v[26:27], v83 offset:6144
    v_mfma_f32_32x32x16_bf16 v[200:215], v[224:227], v[112:115], v[200:215]
    v_xor_b32 v84, 64, v4
    ds_read_b64_tr_b16 v[28:29], v84 offset:0
    ds_read_b64_tr_b16 v[32:33], v84 offset:4096
    v_mfma_f32_32x32x16_bf16 v[200:215], v[228:231], v[116:119], v[200:215]
    v_xor_b32 v85, 96, v4
    ds_read_b64_tr_b16 v[30:31], v85 offset:2048
    ds_read_b64_tr_b16 v[34:35], v85 offset:6144
    v_mfma_f32_32x32x16_bf16 v[200:215], v[232:235], v[120:123], v[200:215]
    v_xor_b32 v86, 128, v4
    ds_read_b64_tr_b16 v[36:37], v86 offset:0
    ds_read_b64_tr_b16 v[40:41], v86 offset:4096
    buffer_load_dwordx4 v78, s[52:55], s95 offen offset:2048 nt lds
    v_mfma_f32_32x32x16_bf16 v[200:215], v[236:239], v[124:127], v[200:215]
    v_xor_b32 v87, 160, v4
    ds_read_b64_tr_b16 v[38:39], v87 offset:2048
    ds_read_b64_tr_b16 v[42:43], v87 offset:6144
    v_mfma_f32_32x32x16_bf16 v[200:215], v[240:243], v[128:131], v[200:215]
    v_xor_b32 v88, 192, v4
    ds_read_b64_tr_b16 v[44:45], v88 offset:0
    ds_read_b64_tr_b16 v[48:49], v88 offset:4096
    v_mfma_f32_32x32x16_bf16 v[200:215], v[244:247], v[132:135], v[200:215]
    v_xor_b32 v89, 224, v4
    ds_read_b64_tr_b16 v[46:47], v89 offset:2048
    ds_read_b64_tr_b16 v[50:51], v89 offset:6144
    buffer_load_dwordx4 v79, s[52:55], s95 offen offset:3072 nt lds
    s_add_u32 s95, s95, 16384
    v_xor_b32 v5, 0x2000, v94
    v_xor_b32 v6, 0x4000, v94
    v_xor_b32 v7, 0x6000, v94
    s_cmp_eq_u32 s93, 12
    s_cselect_b32 s95, 16777216, s95
    s_nop 1
    ds_write_b128 v94, v[200:203] offset:0
    ds_write_b128 v94, v[204:207] offset:1024
    ds_write_b128 v94, v[208:211] offset:2048
    ds_write_b128 v94, v[212:215] offset:3072
    s_waitcnt lgkmcnt(0)
    s_barrier
    ds_read_b128 v[60:63], v5 offset:0
    ds_read_b128 v[216:219], v6 offset:0
    ds_read_b128 v[232:235], v7 offset:0
    ds_read_b128 v[64:67], v5 offset:1024
    ds_read_b128 v[220:223], v6 offset:1024
    ds_read_b128 v[236:239], v7 offset:1024
    ds_read_b128 v[68:71], v5 offset:2048
    ds_read_b128 v[224:227], v6 offset:2048
    ds_read_b128 v[240:243], v7 offset:2048
    ds_read_b128 v[72:75], v5 offset:3072
    ds_read_b128 v[228:231], v6 offset:3072
    ds_read_b128 v[244:247], v7 offset:3072
    v_xor_b32 v94, 0x1000, v94
    s_add_u32 s39, s90, s62
    s_mov_b32 m0, s39
    s_add_u32 s62, s62, 4096
    s_and_b32 s62, s62, 0x7fff
    buffer_load_dwordx4 v76, s[52:55], s95 offen offset:0 nt lds
    s_add_u32 s94, s94, 8192
    s_and_b32 s94, s94, 0x7fff
    s_waitcnt lgkmcnt(9)
    v_pk_add_f32 v[200:201], v[200:201], v[60:61]
    v_pk_add_f32 v[216:217], v[216:217], v[232:233]
    v_pk_add_f32 v[202:203], v[202:203], v[62:63]
    v_pk_add_f32 v[218:219], v[218:219], v[234:235]
    v_pk_add_f32 v[200:201], v[200:201], v[216:217]
    v_pk_add_f32 v[202:203], v[202:203], v[218:219]
    s_waitcnt lgkmcnt(6)
    v_pk_add_f32 v[204:205], v[204:205], v[64:65]
    v_pk_add_f32 v[220:221], v[220:221], v[236:237]
    v_pk_add_f32 v[206:207], v[206:207], v[66:67]
    v_pk_add_f32 v[222:223], v[222:223], v[238:239]
    v_pk_add_f32 v[204:205], v[204:205], v[220:221]
    v_pk_add_f32 v[206:207], v[206:207], v[222:223]
    s_waitcnt lgkmcnt(3)
    v_pk_add_f32 v[208:209], v[208:209], v[68:69]
    v_pk_add_f32 v[224:225], v[224:225], v[240:241]
    v_pk_add_f32 v[210:211], v[210:211], v[70:71]
    v_pk_add_f32 v[226:227], v[226:227], v[242:243]
    v_pk_add_f32 v[208:209], v[208:209], v[224:225]
    v_pk_add_f32 v[210:211], v[210:211], v[226:227]
    s_waitcnt lgkmcnt(0)
    v_pk_add_f32 v[212:213], v[212:213], v[72:73]
    v_pk_add_f32 v[228:229], v[228:229], v[244:245]
    v_pk_add_f32 v[214:215], v[214:215], v[74:75]
    v_pk_add_f32 v[230:231], v[230:231], v[246:247]
    v_pk_add_f32 v[212:213], v[212:213], v[228:229]
    v_pk_add_f32 v[214:215], v[214:215], v[230:231]
    buffer_load_dwordx4 v77, s[52:55], s95 offen offset:1024 nt lds
    v_max_f32 v4, v200, v201
    v_max3_f32 v4, v4, v202, v203
    v_max3_f32 v4, v4, v204, v205
    v_max3_f32 v4, v4, v206, v207
    v_max3_f32 v4, v4, v208, v209
    v_max3_f32 v4, v4, v210, v211
    v_max3_f32 v4, v4, v212, v213
    v_max3_f32 v4, v4, v214, v215
    v_mov_b32 v5, v4
    s_nop 1
    v_permlane32_swap_b32 v4, v5
    v_max_f32 v4, v4, v5
    v_mul_f32 v4, s83, v4
    v_max_f32 v4, v4, v90
    v_sub_f32 v92, v90, v4
    v_exp_f32 v92, v92
    v_mov_b32 v90, v4
    v_pk_fma_f32 v[200:201], v[200:201], s[60:61], v[90:91] op_sel_hi:[1,1,0] neg_lo:[0,0,1] neg_hi:[0,0,1]
    v_pk_fma_f32 v[202:203], v[202:203], s[60:61], v[90:91] op_sel_hi:[1,1,0] neg_lo:[0,0,1] neg_hi:[0,0,1]
    v_pk_fma_f32 v[204:205], v[204:205], s[60:61], v[90:91] op_sel_hi:[1,1,0] neg_lo:[0,0,1] neg_hi:[0,0,1]
    v_pk_fma_f32 v[206:207], v[206:207], s[60:61], v[90:91] op_sel_hi:[1,1,0] neg_lo:[0,0,1] neg_hi:[0,0,1]
    v_pk_fma_f32 v[208:209], v[208:209], s[60:61], v[90:91] op_sel_hi:[1,1,0] neg_lo:[0,0,1] neg_hi:[0,0,1]
    v_pk_fma_f32 v[210:211], v[210:211], s[60:61], v[90:91] op_sel_hi:[1,1,0] neg_lo:[0,0,1] neg_hi:[0,0,1]
    v_pk_fma_f32 v[212:213], v[212:213], s[60:61], v[90:91] op_sel_hi:[1,1,0] neg_lo:[0,0,1] neg_hi:[0,0,1]
    v_pk_fma_f32 v[214:215], v[214:215], s[60:61], v[90:91] op_sel_hi:[1,1,0] neg_lo:[0,0,1] neg_hi:[0,0,1]
    v_exp_f32 v200, v200
    v_exp_f32 v201, v201
    v_exp_f32 v202, v202
    v_exp_f32 v203, v203
    v_exp_f32 v204, v204
    buffer_load_dwordx4 v78, s[52:55], s95 offen offset:2048 nt lds
    v_exp_f32 v205, v205
    v_exp_f32 v206, v206
    v_exp_f32 v207, v207
    v_exp_f32 v208, v208
    v_exp_f32 v209, v209
    v_exp_f32 v210, v210
    v_exp_f32 v211, v211
    v_exp_f32 v212, v212
    v_exp_f32 v213, v213
    v_exp_f32 v214, v214
    v_exp_f32 v215, v215
    v_add_u32 v4, s94, v80
    v_pk_mul_f32 v[102:103], v[102:103], v[92:93] op_sel_hi:[1,0]
    v_pk_mul_f32 v[136:137], v[136:137], v[92:93] op_sel_hi:[1,0]
    v_pk_mul_f32 v[138:139], v[138:139], v[92:93] op_sel_hi:[1,0]
    v_pk_mul_f32 v[140:141], v[140:141], v[92:93] op_sel_hi:[1,0]
    v_pk_mul_f32 v[142:143], v[142:143], v[92:93] op_sel_hi:[1,0]
    v_pk_mul_f32 v[144:145], v[144:145], v[92:93] op_sel_hi:[1,0]
    v_pk_mul_f32 v[146:147], v[146:147], v[92:93] op_sel_hi:[1,0]
    v_pk_mul_f32 v[148:149], v[148:149], v[92:93] op_sel_hi:[1,0]
    v_pk_mul_f32 v[150:151], v[150:151], v[92:93] op_sel_hi:[1,0]
    v_pk_mul_f32 v[152:153], v[152:153], v[92:93] op_sel_hi:[1,0]
    v_pk_mul_f32 v[154:155], v[154:155], v[92:93] op_sel_hi:[1,0]
    v_pk_mul_f32 v[156:157], v[156:157], v[92:93] op_sel_hi:[1,0]
    v_pk_mul_f32 v[158:159], v[158:159], v[92:93] op_sel_hi:[1,0]
    v_pk_mul_f32 v[160:161], v[160:161], v[92:93] op_sel_hi:[1,0]
    v_pk_mul_f32 v[162:163], v[162:163], v[92:93] op_sel_hi:[1,0]
    v_pk_mul_f32 v[164:165], v[164:165], v[92:93] op_sel_hi:[1,0]
    v_pk_mul_f32 v[166:167], v[166:167], v[92:93] op_sel_hi:[1,0]
    v_pk_mul_f32 v[168:169], v[168:169], v[92:93] op_sel_hi:[1,0]
    v_pk_mul_f32 v[170:171], v[170:171], v[92:93] op_sel_hi:[1,0]
    v_pk_mul_f32 v[172:173], v[172:173], v[92:93] op_sel_hi:[1,0]
    v_pk_mul_f32 v[174:175], v[174:175], v[92:93] op_sel_hi:[1,0]
    v_pk_mul_f32 v[176:177], v[176:177], v[92:93] op_sel_hi:[1,0]
    buffer_load_dwordx4 v79, s[52:55], s95 offen offset:3072 nt lds
    s_add_u32 s95, s95, 16384
    v_pk_mul_f32 v[178:179], v[178:179], v[92:93] op_sel_hi:[1,0]
    v_pk_mul_f32 v[180:181], v[180:181], v[92:93] op_sel_hi:[1,0]
    v_pk_mul_f32 v[182:183], v[182:183], v[92:93] op_sel_hi:[1,0]
    v_pk_mul_f32 v[184:185], v[184:185], v[92:93] op_sel_hi:[1,0]
    v_pk_mul_f32 v[186:187], v[186:187], v[92:93] op_sel_hi:[1,0]
    v_pk_mul_f32 v[188:189], v[188:189], v[92:93] op_sel_hi:[1,0]
    v_pk_mul_f32 v[190:191], v[190:191], v[92:93] op_sel_hi:[1,0]
    v_pk_mul_f32 v[192:193], v[192:193], v[92:93] op_sel_hi:[1,0]
    v_pk_mul_f32 v[194:195], v[194:195], v[92:93] op_sel_hi:[1,0]
    v_pk_mul_f32 v[196:197], v[196:197], v[92:93] op_sel_hi:[1,0]
    v_pk_mul_f32 v[198:199], v[198:199], v[92:93] op_sel_hi:[1,0]
    v_cvt_pk_bf16_f32 v52, v200, v201
    v_pk_add_f32 v[102:103], v[102:103], v[200:201]
    v_cvt_pk_bf16_f32 v53, v202, v203
    v_pk_add_f32 v[102:103], v[102:103], v[202:203]
    v_cvt_pk_bf16_f32 v54, v204, v205
    v_pk_add_f32 v[102:103], v[102:103], v[204:205]
    v_cvt_pk_bf16_f32 v55, v206, v207
    v_pk_add_f32 v[102:103], v[102:103], v[206:207]
    v_cvt_pk_bf16_f32 v56, v208, v209
    v_pk_add_f32 v[102:103], v[102:103], v[208:209]
    v_cvt_pk_bf16_f32 v57, v210, v211
    v_pk_add_f32 v[102:103], v[102:103], v[210:211]
    v_cvt_pk_bf16_f32 v58, v212, v213
    v_pk_add_f32 v[102:103], v[102:103], v[212:213]
    v_cvt_pk_bf16_f32 v59, v214, v215
    v_pk_add_f32 v[102:103], v[102:103], v[214:215]
    s_waitcnt vmcnt(20)
    v_mfma_f32_32x32x16_bf16 v[136:151], v[20:23], v[52:55], v[136:151]
    v_xor_b32 v82, 0, v4
    ds_read_b128 v[216:219], v82
    v_xor_b32 v83, 32, v4
    ds_read_b128 v[220:223], v83
    v_mfma_f32_32x32x16_bf16 v[152:167], v[28:31], v[52:55], v[152:167]
    v_xor_b32 v84, 64, v4
    ds_read_b128 v[224:227], v84
    v_xor_b32 v85, 96, v4
    ds_read_b128 v[228:231], v85
    v_mfma_f32_32x32x16_bf16 v[168:183], v[36:39], v[52:55], v[168:183]
    v_xor_b32 v86, 128, v4
    ds_read_b128 v[232:235], v86
    v_xor_b32 v87, 160, v4
    ds_read_b128 v[236:239], v87
    v_mfma_f32_32x32x16_bf16 v[184:199], v[44:47], v[52:55], v[184:199]
    v_xor_b32 v88, 192, v4
    ds_read_b128 v[240:243], v88
    v_xor_b32 v89, 224, v4
    ds_read_b128 v[244:247], v89
    v_mfma_f32_32x32x16_bf16 v[136:151], v[24:27], v[56:59], v[136:151]
    s_add_u32 s39, s90, s62
    s_mov_b32 m0, s39
    s_add_u32 s62, s62, 4096
    s_and_b32 s62, s62, 0x7fff
    buffer_load_dwordx4 v76, s[52:55], s95 offen offset:0 nt lds
    v_mfma_f32_32x32x16_bf16 v[152:167], v[32:35], v[56:59], v[152:167]
    v_mfma_f32_32x32x16_bf16 v[168:183], v[40:43], v[56:59], v[168:183]
    v_mfma_f32_32x32x16_bf16 v[184:199], v[48:51], v[56:59], v[184:199]
    s_add_u32 s93, s93, 1
    s_cmp_lt_u32 s93, 16
    s_cbranch_scc1 L_att
    v_add_f32 v91, v102, v103
    v_mov_b32 v5, v91
    s_nop 1
    v_permlane32_swap_b32 v91, v5
    v_add_f32 v91, v91, v5
    v_and_b32 v4, 31, v1
    v_lshlrev_b32 v5, 8, v4
    v_lshl_add_u32 v5, v3, 4, v5
    v_lshrrev_b32 v6, 5, v1
    v_lshl_add_u32 v5, v6, 3, v5
    v_add_u32 v5, s85, v5
    s_waitcnt vmcnt(0) lgkmcnt(0)
    s_barrier
    v_cvt_pk_bf16_f32 v20, v136, v137
    v_cvt_pk_bf16_f32 v21, v138, v139
    v_xor_b32 v82, 0, v5
    ds_write_b64 v82, v[20:21]
    v_cvt_pk_bf16_f32 v22, v140, v141
    v_cvt_pk_bf16_f32 v23, v142, v143
    v_xor_b32 v83, 16, v5
    ds_write_b64 v83, v[22:23]
    v_cvt_pk_bf16_f32 v24, v144, v145
    v_cvt_pk_bf16_f32 v25, v146, v147
    v_xor_b32 v84, 32, v5
    ds_write_b64 v84, v[24:25]
    v_cvt_pk_bf16_f32 v26, v148, v149
    v_cvt_pk_bf16_f32 v27, v150, v151
    v_xor_b32 v85, 48, v5
    ds_write_b64 v85, v[26:27]
    v_cvt_pk_bf16_f32 v28, v152, v153
    v_cvt_pk_bf16_f32 v29, v154, v155
    v_xor_b32 v86, 64, v5
    ds_write_b64 v86, v[28:29]
    v_cvt_pk_bf16_f32 v30, v156, v157
    v_cvt_pk_bf16_f32 v31, v158, v159
    v_xor_b32 v87, 80, v5
    ds_write_b64 v87, v[30:31]
    v_cvt_pk_bf16_f32 v32, v160, v161
    v_cvt_pk_bf16_f32 v33, v162, v163
    v_xor_b32 v88, 96, v5
    ds_write_b64 v88, v[32:33]
    v_cvt_pk_bf16_f32 v34, v164, v165
    v_cvt_pk_bf16_f32 v35, v166, v167
    v_xor_b32 v89, 112, v5
    ds_write_b64 v89, v[34:35]
    v_cvt_pk_bf16_f32 v36, v168, v169
    v_cvt_pk_bf16_f32 v37, v170, v171
    v_xor_b32 v82, 128, v5
    ds_write_b64 v82, v[36:37]
    v_cvt_pk_bf16_f32 v38, v172, v173
    v_cvt_pk_bf16_f32 v39, v174, v175
    v_xor_b32 v83, 144, v5
    ds_write_b64 v83, v[38:39]
    v_cvt_pk_bf16_f32 v40, v176, v177
    v_cvt_pk_bf16_f32 v41, v178, v179
    v_xor_b32 v84, 160, v5
    ds_write_b64 v84, v[40:41]
    v_cvt_pk_bf16_f32 v42, v180, v181
    v_cvt_pk_bf16_f32 v43, v182, v183
    v_xor_b32 v85, 176, v5
    ds_write_b64 v85, v[42:43]
    v_cvt_pk_bf16_f32 v44, v184, v185
    v_cvt_pk_bf16_f32 v45, v186, v187
    v_xor_b32 v86, 192, v5
    ds_write_b64 v86, v[44:45]
    v_cvt_pk_bf16_f32 v46, v188, v189
    v_cvt_pk_bf16_f32 v47, v190, v191
    v_xor_b32 v87, 208, v5
    ds_write_b64 v87, v[46:47]
    v_cvt_pk_bf16_f32 v48, v192, v193
    v_cvt_pk_bf16_f32 v49, v194, v195
    v_xor_b32 v88, 224, v5
    ds_write_b64 v88, v[48:49]
    v_cvt_pk_bf16_f32 v50, v196, v197
    v_cvt_pk_bf16_f32 v51, v198, v199
    v_xor_b32 v89, 240, v5
    ds_write_b64 v89, v[50:51]
    v_xor_b32 v6, v3, v2
    v_lshlrev_b32 v6, 4, v6
    v_lshl_add_u32 v6, v2, 8, v6
    v_add_u32 v6, s85, v6
    v_xor_b32 v82, 0, v6
    v_xor_b32 v83, 64, v6
    v_xor_b32 v84, 128, v6
    v_xor_b32 v85, 192, v6
    v_lshlrev_b32 v7, 4, v3
    v_lshl_add_u32 v7, v2, 15, v7
    s_lshl_b32 s38, s3, 10
    s_add_u32 s36, s38, 2097152
    s_lshl_b32 s38, s34, 8
    s_add_u32 s36, s38, s36
    s_waitcnt lgkmcnt(0)
    ds_read_b128 v[200:203], v82 offset:0
    ds_read_b128 v[204:207], v83 offset:1024
    ds_read_b128 v[208:211], v84 offset:2048
    ds_read_b128 v[212:215], v85 offset:3072
    ds_read_b128 v[216:219], v82 offset:4096
    ds_read_b128 v[220:223], v83 offset:5120
    ds_read_b128 v[224:227], v84 offset:6144
    ds_read_b128 v[228:231], v85 offset:7168
    v_lshlrev_b32 v4, 3, v4
    s_lshl_b32 s38, s3, 8
    s_add_u32 s37, s38, 163840
    s_lshl_b32 s38, s34, 13
    s_add_u32 s37, s38, s37
    s_mov_b32 exec_lo, 0xffffffff
    s_mov_b32 exec_hi, 0x0
    buffer_store_dwordx2 v[90:91], v4, s[48:51], s37 offen sc1
    s_mov_b64 exec, -1
    s_waitcnt lgkmcnt(7)
    buffer_store_dwordx4 v[200:203], v7, s[48:51], s36 offen sc1
    s_add_u32 s36, s36, 131072
    s_waitcnt lgkmcnt(6)
    buffer_store_dwordx4 v[204:207], v7, s[48:51], s36 offen sc1
    s_add_u32 s36, s36, 131072
    s_waitcnt lgkmcnt(5)
    buffer_store_dwordx4 v[208:211], v7, s[48:51], s36 offen sc1
    s_add_u32 s36, s36, 131072
    s_waitcnt lgkmcnt(4)
    buffer_store_dwordx4 v[212:215], v7, s[48:51], s36 offen sc1
    s_add_u32 s36, s36, 131072
    s_waitcnt lgkmcnt(3)
    buffer_store_dwordx4 v[216:219], v7, s[48:51], s36 offen sc1
    s_add_u32 s36, s36, 131072
    s_waitcnt lgkmcnt(2)
    buffer_store_dwordx4 v[220:223], v7, s[48:51], s36 offen sc1
    s_add_u32 s36, s36, 131072
    s_waitcnt lgkmcnt(1)
    buffer_store_dwordx4 v[224:227], v7, s[48:51], s36 offen sc1
    s_add_u32 s36, s36, 131072
    s_waitcnt lgkmcnt(0)
    buffer_store_dwordx4 v[228:231], v7, s[48:51], s36 offen sc1
    s_sub_u32 s36, s33, 3
    s_and_b32 s37, s33, 3
    s_cmp_lt_u32 s36, 4
    s_cselect_b64 s[40:41], s[24:25], s[14:15]
    s_cselect_b32 s36, s36, s37
    s_cselect_b32 s45, 262144, 0
    s_cselect_b32 s46, 8388608, 0
    s_add_u32 s45, s45, 524288
    s_add_u32 s46, s46, 196608
    s_mov_b32 s42, 4194304
    s_mov_b32 s43, 0x20000
    s_lshl_b32 s38, s32, 17
    s_add_u32 s44, s38, 0
    s_lshl_b32 s38, s34, 15
    s_add_u32 s44, s38, s44
    s_lshl_b32 s38, s36, 8
    s_add_u32 s44, s38, s44
    s_lshl_b32 s38, s36, 16
    s_add_u32 s45, s38, s45
    s_lshr_b32 s38, s34, 1
    s_lshl_b32 s38, s38, 15
    s_add_u32 s45, s38, s45
    s_lshl_b32 s38, s32, 8
    s_add_u32 s45, s38, s45
    s_bfe_u32 s38, s34, 0x10000
    s_lshl_b32 s38, s38, 7
    s_add_u32 s45, s38, s45
    s_lshl_b32 s38, s32, 11
    s_add_u32 s46, s38, s46
    s_lshl_b32 s38, s34, 9
    s_add_u32 s46, s38, s46
    s_mov_b32 s72, s26
    s_and_b32 s73, s27, 0xffff
    s_mov_b32 s74, 8192
    s_mov_b32 s75, 0x20000
    s_lshl_b32 s39, s34, 13
    s_add_u32 s39, s39, 98304
    s_mov_b32 m0, s39
    s_nop 0
    buffer_load_dwordx4 v76, s[40:43], s44 offen offset:0 nt lds
    buffer_load_dwordx4 v77, s[40:43], s44 offen offset:1024 nt lds
    buffer_load_dwordx4 v78, s[40:43], s44 offen offset:2048 nt lds
    buffer_load_dwordx4 v79, s[40:43], s44 offen offset:3072 nt lds
    s_lshl_b32 s39, s34, 13
    s_add_u32 s39, s39, 102400
    s_mov_b32 m0, s39
    s_add_u32 s44, s44, 16384
    buffer_load_dwordx4 v76, s[40:43], s44 offen offset:0 nt lds
    buffer_load_dwordx4 v77, s[40:43], s44 offen offset:1024 nt lds
    buffer_load_dwordx4 v78, s[40:43], s44 offen offset:2048 nt lds
    buffer_load_dwordx4 v79, s[40:43], s44 offen offset:3072 nt lds
    v_lshlrev_b32 v30, 4, v3
    v_lshl_add_u32 v30, v2, 13, v30
    s_lshl_b32 s38, s32, 13
    s_add_u32 s36, s38, 0
    s_lshl_b32 s38, s34, 6
    s_add_u32 s36, s38, s36
    v_lshrrev_b32 v5, 2, v1
    v_lshlrev_b32 v32, 8, v5
    v_bfe_u32 v5, v1, 0, 2
    v_lshl_add_u32 v32, v5, 4, v32
    v_add_u32 v32, s36, v32
    s_lshr_b32 s38, s32, 2
    s_lshl_b32 s38, s38, 7
    s_add_u32 s36, s38, 0
    s_lshl_b32 s38, s34, 5
    s_add_u32 s36, s38, s36
    s_bfe_u32 s38, s32, 0x20000
    s_lshl_b32 s38, s38, 3
    s_add_u32 s36, s38, s36
    v_bfe_u32 v5, v1, 0, 2
    v_lshlrev_b32 v33, 11, v5
    v_lshl_add_u32 v33, v2, 1, v33
    v_add_u32 v33, s36, v33
    v_and_b32 v5, 31, v1
    v_lshlrev_b32 v34, 4, v5
    s_mul_i32 s38, s34, 320
    s_add_u32 s38, s38, 135168
    v_lshl_add_u32 v35, v5, 3, s38
    v_and_b32 v4, 3, v3
    v_bfe_u32 v5, v3, 0, 2
    v_lshlrev_b32 v81, 11, v5
    v_lshrrev_b32 v5, 2, v3
    v_lshl_add_u32 v81, v5, 8, v81
    v_and_b32 v5, 12, v3
    v_xor_b32 v5, v5, v2
    v_and_b32 v6, 1, v3
    v_lshlrev_b32 v6, 1, v6
    v_xor_b32 v5, v5, v6
    v_lshlrev_b32 v80, 4, v5
    v_bfe_u32 v6, v3, 0, 2
    v_lshl_add_u32 v80, v6, 11, v80
    v_lshrrev_b32 v6, 2, v3
    v_lshl_add_u32 v80, v6, 8, v80
    v_add_u32 v80, s85, v80
    v_lshlrev_b32 v4, 9, v4
    v_lshl_add_u32 v4, v2, 4, v4
    v_add_u32 v94, s85, v4
    s_lshl_b32 s38, s34, 9
    s_add_u32 s38, s38, 131072
    v_and_b32 v5, 31, v1
    v_lshl_add_u32 v102, v5, 4, s38
    s_lshl_b32 s38, s32, 15
    s_add_u32 s36, s38, 2097152
    s_lshl_b32 s38, s34, 8
    s_add_u32 s36, s38, s36
    s_lshl_b32 s38, s32, 3
    s_add_u32 s37, s38, 163840
    s_lshl_b32 s38, s34, 13
    s_add_u32 s37, s38, s37
    s_lshl_b32 s38, s32, 8
    s_add_u32 s69, s38, 131072
    s_lshl_b32 s38, s34, 13
    s_add_u32 s69, s38, s69
    v_mov_b32 v4, s69
    v_mov_b32 v5, s68
    s_waitcnt vmcnt(8)
    s_mov_b64 exec, 1
    buffer_store_dword v5, v4, s[48:51], 0 offen sc1
    s_mov_b64 exec, -1
    s_mov_b32 s86, 131072
    buffer_load_dword v7, v101, s[48:51], s86 offen sc1
    s_waitcnt vmcnt(0)
L_fcheck_26:
    v_cmp_ne_u32 vcc, s68, v7
    s_cbranch_vccz L_fok_27
    s_sleep 2
    s_mov_b32 s86, 131072
    buffer_load_dword v7, v101, s[48:51], s86 offen sc1
    s_waitcnt vmcnt(0)
    s_sub_u32 s84, s84, 1
    s_cmp_lg_u32 s84, 0
    s_cbranch_scc1 L_fcheck_26
    s_branch L_end
L_fok_27:
    buffer_load_dwordx2 v[52:53], v81, s[48:51], s37 offen sc1
    s_add_u32 s37, s37, 1024
    buffer_load_dwordx2 v[54:55], v81, s[48:51], s37 offen sc1
    buffer_load_dwordx4 v[200:203], v9, s[48:51], s36 offen sc1
    s_add_u32 s36, s36, 4096
    buffer_load_dwordx4 v[204:207], v9, s[48:51], s36 offen sc1
    s_add_u32 s36, s36, 4096
    buffer_load_dwordx4 v[208:211], v9, s[48:51], s36 offen sc1
    s_add_u32 s36, s36, 4096
    buffer_load_dwordx4 v[212:215], v9, s[48:51], s36 offen sc1
    s_add_u32 s36, s36, 4096
    buffer_load_dwordx4 v[216:219], v9, s[48:51], s36 offen sc1
    s_add_u32 s36, s36, 4096
    buffer_load_dwordx4 v[220:223], v9, s[48:51], s36 offen sc1
    s_add_u32 s36, s36, 4096
    buffer_load_dwordx4 v[224:227], v9, s[48:51], s36 offen sc1
    s_add_u32 s36, s36, 4096
    buffer_load_dwordx4 v[228:231], v9, s[48:51], s36 offen sc1
    v_xor_b32 v82, 0, v80
    v_xor_b32 v83, 64, v80
    v_xor_b32 v84, 128, v80
    v_xor_b32 v85, 192, v80
    v_xor_b32 v86, 16, v80
    v_xor_b32 v87, 80, v80
    v_xor_b32 v88, 144, v80
    v_xor_b32 v89, 208, v80
    s_waitcnt vmcnt(8)
    v_max_f32 v4, v52, v54
    s_nop 1
    v_max_f32_dpp v4, v4, v4 row_ror:8 row_mask:0xf bank_mask:0xf
    s_nop 1
    v_max_f32_dpp v4, v4, v4 row_ror:4 row_mask:0xf bank_mask:0xf
    v_sub_f32 v52, v52, v4
    v_sub_f32 v54, v54, v4
    v_exp_f32 v52, v52
    v_exp_f32 v54, v54
    v_mul_f32 v5, v52, v53
    v_fmac_f32 v5, v54, v55
    s_nop 1
    v_add_f32_dpp v5, v5, v5 row_ror:8 row_mask:0xf bank_mask:0xf
    s_nop 1
    v_add_f32_dpp v5, v5, v5 row_ror:4 row_mask:0xf bank_mask:0xf
    v_rcp_f32 v5, v5
    s_nop 0
    v_mul_f32 v52, v52, v5
    v_mul_f32 v54, v54, v5
    s_waitcnt vmcnt(7)
    ds_write_b128 v96, v[200:203] offset:0
    s_waitcnt vmcnt(6)
    ds_write_b128 v97, v[204:207] offset:1024
    s_waitcnt vmcnt(5)
    ds_write_b128 v98, v[208:211] offset:2048
    s_waitcnt vmcnt(4)
    ds_write_b128 v99, v[212:215] offset:3072
    s_waitcnt vmcnt(3)
    ds_write_b128 v96, v[216:219] offset:4096
    s_waitcnt vmcnt(2)
    ds_write_b128 v97, v[220:223] offset:5120
    s_waitcnt vmcnt(1)
    ds_write_b128 v98, v[224:227] offset:6144
    s_waitcnt vmcnt(0)
    ds_write_b128 v99, v[228:231] offset:7168
    s_waitcnt lgkmcnt(0)
    ds_read_b128 v[136:139], v82 offset:0
    ds_read_b128 v[140:143], v83 offset:0
    ds_read_b128 v[144:147], v84 offset:0
    ds_read_b128 v[148:151], v85 offset:0
    ds_read_b128 v[152:155], v86 offset:1024
    ds_read_b128 v[156:159], v87 offset:1024
    ds_read_b128 v[160:163], v88 offset:1024
    ds_read_b128 v[164:167], v89 offset:1024
    s_waitcnt lgkmcnt(0)
    v_mfma_f32_16x16x32_bf16 v[60:63], a[128:131], v[136:139], 0
    v_mfma_f32_16x16x32_bf16 v[64:67], a[128:131], v[152:155], 0
    v_mfma_f32_16x16x32_bf16 v[60:63], a[132:135], v[140:143], v[60:63]
    v_mfma_f32_16x16x32_bf16 v[64:67], a[132:135], v[156:159], v[64:67]
    v_mfma_f32_16x16x32_bf16 v[60:63], a[136:139], v[144:147], v[60:63]
    v_mfma_f32_16x16x32_bf16 v[64:67], a[136:139], v[160:163], v[64:67]
    v_mfma_f32_16x16x32_bf16 v[60:63], a[140:143], v[148:151], v[60:63]
    v_mfma_f32_16x16x32_bf16 v[64:67], a[140:143], v[164:167], v[64:67]
    v_mfma_f32_16x16x32_bf16 v[68:71], a[144:147], v[136:139], 0
    v_mfma_f32_16x16x32_bf16 v[72:75], a[144:147], v[152:155], 0
    v_mfma_f32_16x16x32_bf16 v[68:71], a[148:151], v[140:143], v[68:71]
    v_mfma_f32_16x16x32_bf16 v[72:75], a[148:151], v[156:159], v[72:75]
    v_mfma_f32_16x16x32_bf16 v[68:71], a[152:155], v[144:147], v[68:71]
    v_mfma_f32_16x16x32_bf16 v[72:75], a[152:155], v[160:163], v[72:75]
    v_mfma_f32_16x16x32_bf16 v[68:71], a[156:159], v[148:151], v[68:71]
    v_mfma_f32_16x16x32_bf16 v[72:75], a[156:159], v[164:167], v[72:75]
    v_mul_f32 v104, v60, v52
    v_mul_f32 v105, v61, v52
    v_mul_f32 v106, v62, v52
    v_mul_f32 v107, v63, v52
    v_fmac_f32 v104, v64, v54
    v_fmac_f32 v105, v65, v54
    v_fmac_f32 v106, v66, v54
    v_fmac_f32 v107, v67, v54
    v_add_f32_dpp v104, v104, v104 row_ror:8 row_mask:0xf bank_mask:0xf
    v_add_f32_dpp v105, v105, v105 row_ror:8 row_mask:0xf bank_mask:0xf
    v_add_f32_dpp v106, v106, v106 row_ror:8 row_mask:0xf bank_mask:0xf
    v_add_f32_dpp v107, v107, v107 row_ror:8 row_mask:0xf bank_mask:0xf
    v_add_f32_dpp v104, v104, v104 row_ror:4 row_mask:0xf bank_mask:0xf
    v_add_f32_dpp v105, v105, v105 row_ror:4 row_mask:0xf bank_mask:0xf
    v_add_f32_dpp v106, v106, v106 row_ror:4 row_mask:0xf bank_mask:0xf
    v_add_f32_dpp v107, v107, v107 row_ror:4 row_mask:0xf bank_mask:0xf
    ds_write_b128 v94, v[104:107] offset:0
    v_mfma_f32_16x16x32_bf16 v[60:63], a[160:163], v[136:139], 0
    v_mfma_f32_16x16x32_bf16 v[64:67], a[160:163], v[152:155], 0
    v_mfma_f32_16x16x32_bf16 v[60:63], a[164:167], v[140:143], v[60:63]
    v_mfma_f32_16x16x32_bf16 v[64:67], a[164:167], v[156:159], v[64:67]
    v_mfma_f32_16x16x32_bf16 v[60:63], a[168:171], v[144:147], v[60:63]
    v_mfma_f32_16x16x32_bf16 v[64:67], a[168:171], v[160:163], v[64:67]
    v_mfma_f32_16x16x32_bf16 v[60:63], a[172:175], v[148:151], v[60:63]
    v_mfma_f32_16x16x32_bf16 v[64:67], a[172:175], v[164:167], v[64:67]
    v_mul_f32 v108, v68, v52
    v_mul_f32 v109, v69, v52
    v_mul_f32 v110, v70, v52
    v_mul_f32 v111, v71, v52
    v_fmac_f32 v108, v72, v54
    v_fmac_f32 v109, v73, v54
    v_fmac_f32 v110, v74, v54
    v_fmac_f32 v111, v75, v54
    v_add_f32_dpp v108, v108, v108 row_ror:8 row_mask:0xf bank_mask:0xf
    v_add_f32_dpp v109, v109, v109 row_ror:8 row_mask:0xf bank_mask:0xf
    v_add_f32_dpp v110, v110, v110 row_ror:8 row_mask:0xf bank_mask:0xf
    v_add_f32_dpp v111, v111, v111 row_ror:8 row_mask:0xf bank_mask:0xf
    v_add_f32_dpp v108, v108, v108 row_ror:4 row_mask:0xf bank_mask:0xf
    v_add_f32_dpp v109, v109, v109 row_ror:4 row_mask:0xf bank_mask:0xf
    v_add_f32_dpp v110, v110, v110 row_ror:4 row_mask:0xf bank_mask:0xf
    v_add_f32_dpp v111, v111, v111 row_ror:4 row_mask:0xf bank_mask:0xf
    ds_write_b128 v94, v[108:111] offset:64
    v_mfma_f32_16x16x32_bf16 v[68:71], a[176:179], v[136:139], 0
    v_mfma_f32_16x16x32_bf16 v[72:75], a[176:179], v[152:155], 0
    v_mfma_f32_16x16x32_bf16 v[68:71], a[180:183], v[140:143], v[68:71]
    v_mfma_f32_16x16x32_bf16 v[72:75], a[180:183], v[156:159], v[72:75]
    v_mfma_f32_16x16x32_bf16 v[68:71], a[184:187], v[144:147], v[68:71]
    v_mfma_f32_16x16x32_bf16 v[72:75], a[184:187], v[160:163], v[72:75]
    v_mfma_f32_16x16x32_bf16 v[68:71], a[188:191], v[148:151], v[68:71]
    v_mfma_f32_16x16x32_bf16 v[72:75], a[188:191], v[164:167], v[72:75]
    v_mul_f32 v104, v60, v52
    v_mul_f32 v105, v61, v52
    v_mul_f32 v106, v62, v52
    v_mul_f32 v107, v63, v52
    v_fmac_f32 v104, v64, v54
    v_fmac_f32 v105, v65, v54
    v_fmac_f32 v106, v66, v54
    v_fmac_f32 v107, v67, v54
    v_add_f32_dpp v104, v104, v104 row_ror:8 row_mask:0xf bank_mask:0xf
    v_add_f32_dpp v105, v105, v105 row_ror:8 row_mask:0xf bank_mask:0xf
    v_add_f32_dpp v106, v106, v106 row_ror:8 row_mask:0xf bank_mask:0xf
    v_add_f32_dpp v107, v107, v107 row_ror:8 row_mask:0xf bank_mask:0xf
    v_add_f32_dpp v104, v104, v104 row_ror:4 row_mask:0xf bank_mask:0xf
    v_add_f32_dpp v105, v105, v105 row_ror:4 row_mask:0xf bank_mask:0xf
    v_add_f32_dpp v106, v106, v106 row_ror:4 row_mask:0xf bank_mask:0xf
    v_add_f32_dpp v107, v107, v107 row_ror:4 row_mask:0xf bank_mask:0xf
    ds_write_b128 v94, v[104:107] offset:128
    v_mfma_f32_16x16x32_bf16 v[60:63], a[192:195], v[136:139], 0
    v_mfma_f32_16x16x32_bf16 v[64:67], a[192:195], v[152:155], 0
    v_mfma_f32_16x16x32_bf16 v[60:63], a[196:199], v[140:143], v[60:63]
    v_mfma_f32_16x16x32_bf16 v[64:67], a[196:199], v[156:159], v[64:67]
    v_mfma_f32_16x16x32_bf16 v[60:63], a[200:203], v[144:147], v[60:63]
    v_mfma_f32_16x16x32_bf16 v[64:67], a[200:203], v[160:163], v[64:67]
    v_mfma_f32_16x16x32_bf16 v[60:63], a[204:207], v[148:151], v[60:63]
    v_mfma_f32_16x16x32_bf16 v[64:67], a[204:207], v[164:167], v[64:67]
    v_mul_f32 v108, v68, v52
    v_mul_f32 v109, v69, v52
    v_mul_f32 v110, v70, v52
    v_mul_f32 v111, v71, v52
    v_fmac_f32 v108, v72, v54
    v_fmac_f32 v109, v73, v54
    v_fmac_f32 v110, v74, v54
    v_fmac_f32 v111, v75, v54
    v_add_f32_dpp v108, v108, v108 row_ror:8 row_mask:0xf bank_mask:0xf
    v_add_f32_dpp v109, v109, v109 row_ror:8 row_mask:0xf bank_mask:0xf
    v_add_f32_dpp v110, v110, v110 row_ror:8 row_mask:0xf bank_mask:0xf
    v_add_f32_dpp v111, v111, v111 row_ror:8 row_mask:0xf bank_mask:0xf
    v_add_f32_dpp v108, v108, v108 row_ror:4 row_mask:0xf bank_mask:0xf
    v_add_f32_dpp v109, v109, v109 row_ror:4 row_mask:0xf bank_mask:0xf
    v_add_f32_dpp v110, v110, v110 row_ror:4 row_mask:0xf bank_mask:0xf
    v_add_f32_dpp v111, v111, v111 row_ror:4 row_mask:0xf bank_mask:0xf
    ds_write_b128 v94, v[108:111] offset:192
    v_mfma_f32_16x16x32_bf16 v[68:71], a[208:211], v[136:139], 0
    v_mfma_f32_16x16x32_bf16 v[72:75], a[208:211], v[152:155], 0
    v_mfma_f32_16x16x32_bf16 v[68:71], a[212:215], v[140:143], v[68:71]
    v_mfma_f32_16x16x32_bf16 v[72:75], a[212:215], v[156:159], v[72:75]
    v_mfma_f32_16x16x32_bf16 v[68:71], a[216:219], v[144:147], v[68:71]
    v_mfma_f32_16x16x32_bf16 v[72:75], a[216:219], v[160:163], v[72:75]
    v_mfma_f32_16x16x32_bf16 v[68:71], a[220:223], v[148:151], v[68:71]
    v_mfma_f32_16x16x32_bf16 v[72:75], a[220:223], v[164:167], v[72:75]
    v_mul_f32 v104, v60, v52
    v_mul_f32 v105, v61, v52
    v_mul_f32 v106, v62, v52
    v_mul_f32 v107, v63, v52
    v_fmac_f32 v104, v64, v54
    v_fmac_f32 v105, v65, v54
    v_fmac_f32 v106, v66, v54
    v_fmac_f32 v107, v67, v54
    v_add_f32_dpp v104, v104, v104 row_ror:8 row_mask:0xf bank_mask:0xf
    v_add_f32_dpp v105, v105, v105 row_ror:8 row_mask:0xf bank_mask:0xf
    v_add_f32_dpp v106, v106, v106 row_ror:8 row_mask:0xf bank_mask:0xf
    v_add_f32_dpp v107, v107, v107 row_ror:8 row_mask:0xf bank_mask:0xf
    v_add_f32_dpp v104, v104, v104 row_ror:4 row_mask:0xf bank_mask:0xf
    v_add_f32_dpp v105, v105, v105 row_ror:4 row_mask:0xf bank_mask:0xf
    v_add_f32_dpp v106, v106, v106 row_ror:4 row_mask:0xf bank_mask:0xf
    v_add_f32_dpp v107, v107, v107 row_ror:4 row_mask:0xf bank_mask:0xf
    ds_write_b128 v94, v[104:107] offset:256
    v_mfma_f32_16x16x32_bf16 v[60:63], a[224:227], v[136:139], 0
    v_mfma_f32_16x16x32_bf16 v[64:67], a[224:227], v[152:155], 0
    v_mfma_f32_16x16x32_bf16 v[60:63], a[228:231], v[140:143], v[60:63]
    v_mfma_f32_16x16x32_bf16 v[64:67], a[228:231], v[156:159], v[64:67]
    v_mfma_f32_16x16x32_bf16 v[60:63], a[232:235], v[144:147], v[60:63]
    v_mfma_f32_16x16x32_bf16 v[64:67], a[232:235], v[160:163], v[64:67]
    v_mfma_f32_16x16x32_bf16 v[60:63], a[236:239], v[148:151], v[60:63]
    v_mfma_f32_16x16x32_bf16 v[64:67], a[236:239], v[164:167], v[64:67]
    v_mul_f32 v108, v68, v52
    v_mul_f32 v109, v69, v52
    v_mul_f32 v110, v70, v52
    v_mul_f32 v111, v71, v52
    v_fmac_f32 v108, v72, v54
    v_fmac_f32 v109, v73, v54
    v_fmac_f32 v110, v74, v54
    v_fmac_f32 v111, v75, v54
    v_add_f32_dpp v108, v108, v108 row_ror:8 row_mask:0xf bank_mask:0xf
    v_add_f32_dpp v109, v109, v109 row_ror:8 row_mask:0xf bank_mask:0xf
    v_add_f32_dpp v110, v110, v110 row_ror:8 row_mask:0xf bank_mask:0xf
    v_add_f32_dpp v111, v111, v111 row_ror:8 row_mask:0xf bank_mask:0xf
    v_add_f32_dpp v108, v108, v108 row_ror:4 row_mask:0xf bank_mask:0xf
    v_add_f32_dpp v109, v109, v109 row_ror:4 row_mask:0xf bank_mask:0xf
    v_add_f32_dpp v110, v110, v110 row_ror:4 row_mask:0xf bank_mask:0xf
    v_add_f32_dpp v111, v111, v111 row_ror:4 row_mask:0xf bank_mask:0xf
    ds_write_b128 v94, v[108:111] offset:320
    v_mfma_f32_16x16x32_bf16 v[68:71], a[240:243], v[136:139], 0
    v_mfma_f32_16x16x32_bf16 v[72:75], a[240:243], v[152:155], 0
    v_mfma_f32_16x16x32_bf16 v[68:71], a[244:247], v[140:143], v[68:71]
    v_mfma_f32_16x16x32_bf16 v[72:75], a[244:247], v[156:159], v[72:75]
    v_mfma_f32_16x16x32_bf16 v[68:71], a[248:251], v[144:147], v[68:71]
    v_mfma_f32_16x16x32_bf16 v[72:75], a[248:251], v[160:163], v[72:75]
    v_mfma_f32_16x16x32_bf16 v[68:71], a[252:255], v[148:151], v[68:71]
    v_mfma_f32_16x16x32_bf16 v[72:75], a[252:255], v[164:167], v[72:75]
    v_mul_f32 v104, v60, v52
    v_mul_f32 v105, v61, v52
    v_mul_f32 v106, v62, v52
    v_mul_f32 v107, v63, v52
    v_fmac_f32 v104, v64, v54
    v_fmac_f32 v105, v65, v54
    v_fmac_f32 v106, v66, v54
    v_fmac_f32 v107, v67, v54
    v_add_f32_dpp v104, v104, v104 row_ror:8 row_mask:0xf bank_mask:0xf
    v_add_f32_dpp v105, v105, v105 row_ror:8 row_mask:0xf bank_mask:0xf
    v_add_f32_dpp v106, v106, v106 row_ror:8 row_mask:0xf bank_mask:0xf
    v_add_f32_dpp v107, v107, v107 row_ror:8 row_mask:0xf bank_mask:0xf
    v_add_f32_dpp v104, v104, v104 row_ror:4 row_mask:0xf bank_mask:0xf
    v_add_f32_dpp v105, v105, v105 row_ror:4 row_mask:0xf bank_mask:0xf
    v_add_f32_dpp v106, v106, v106 row_ror:4 row_mask:0xf bank_mask:0xf
    v_add_f32_dpp v107, v107, v107 row_ror:4 row_mask:0xf bank_mask:0xf
    ds_write_b128 v94, v[104:107] offset:384
    v_mul_f32 v108, v68, v52
    v_mul_f32 v109, v69, v52
    v_mul_f32 v110, v70, v52
    v_mul_f32 v111, v71, v52
    v_fmac_f32 v108, v72, v54
    v_fmac_f32 v109, v73, v54
    v_fmac_f32 v110, v74, v54
    v_fmac_f32 v111, v75, v54
    v_add_f32_dpp v108, v108, v108 row_ror:8 row_mask:0xf bank_mask:0xf
    v_add_f32_dpp v109, v109, v109 row_ror:8 row_mask:0xf bank_mask:0xf
    v_add_f32_dpp v110, v110, v110 row_ror:8 row_mask:0xf bank_mask:0xf
    v_add_f32_dpp v111, v111, v111 row_ror:8 row_mask:0xf bank_mask:0xf
    v_add_f32_dpp v108, v108, v108 row_ror:4 row_mask:0xf bank_mask:0xf
    v_add_f32_dpp v109, v109, v109 row_ror:4 row_mask:0xf bank_mask:0xf
    v_add_f32_dpp v110, v110, v110 row_ror:4 row_mask:0xf bank_mask:0xf
    v_add_f32_dpp v111, v111, v111 row_ror:4 row_mask:0xf bank_mask:0xf
    ds_write_b128 v94, v[108:111] offset:448
    s_waitcnt lgkmcnt(0)
    s_barrier
    ds_read_b128 v[136:139], v102 offset:0
    ds_read_b128 v[140:143], v102 offset:8192
    ds_read_b128 v[144:147], v102 offset:16384
    ds_read_b128 v[148:151], v102 offset:24576
    s_waitcnt lgkmcnt(0)
    v_add_f32 v136, v136, v140
    v_add_f32 v144, v144, v148
    v_add_f32 v137, v137, v141
    v_add_f32 v145, v145, v149
    v_add_f32 v138, v138, v142
    v_add_f32 v146, v146, v150
    v_add_f32 v139, v139, v143
    v_add_f32 v147, v147, v151
    v_add_f32 v136, v136, v144
    v_add_f32 v137, v137, v145
    v_add_f32 v138, v138, v146
    v_add_f32 v139, v139, v147
    v_and_or_b32 v136, v136, s82, v8
    v_and_or_b32 v137, v137, s82, v8
    v_and_or_b32 v138, v138, s82, v8
    v_and_or_b32 v139, v139, s82, v8
    s_mov_b32 exec_lo, 0xffffffff
    s_mov_b32 exec_hi, 0x0
    buffer_store_dwordx4 v[136:139], v34, s[48:51], s46 offen sc1
    s_mov_b64 exec, -1
    v_xor_b32 v224, s35, v136
    v_xor_b32 v225, s35, v137
    v_xor_b32 v226, s35, v138
    v_xor_b32 v227, s35, v139
    v_lshlrev_b32 v4, 11, v2
    v_bfe_u32 v5, v1, 2, 2
    v_lshl_add_u32 v4, v5, 8, v4
    v_bfe_u32 v5, v1, 2, 2
    v_lshl_add_u32 v4, v5, 6, v4
    v_bfe_u32 v5, v1, 4, 1
    v_lshl_add_u32 v4, v5, 5, v4
    v_bfe_u32 v5, v1, 1, 1
    v_lshl_add_u32 v4, v5, 4, v4
    v_bfe_u32 v5, v1, 0, 1
    v_lshl_add_u32 v4, v5, 3, v4
    s_lshl_b32 s38, s34, 6
    s_add_u32 s38, s38, 98304
    v_xor_b32 v24, s38, v4
    v_xor_b32 v25, 16, v24
    v_xor_b32 v26, 32, v24
    v_xor_b32 v27, 48, v24
    v_and_b32 v4, 3, v3
    v_lshrrev_b32 v5, 2, v3
    v_lshlrev_b32 v6, 4, v2
    v_add_u32 v6, 135168, v6
    s_movk_i32 s36, 320
    v_cmp_eq_u32 vcc, 0, v5
    s_nop 1
    v_cndmask_b32 v28, 4, v4, vcc
    v_mad_u32_u24 v28, v28, s36, v6
    v_cmp_eq_u32 vcc, 1, v5
    s_nop 1
    v_cndmask_b32 v29, 4, v4, vcc
    v_mad_u32_u24 v29, v29, s36, v6
    v_lshlrev_b32 v5, 2, v1
    v_add_u32 v5, 136448, v5
    v_mov_b32 v6, 0
    ds_write_b32 v5, v6
    s_branch L_ctxok
.section .rodata,"a"
.p2align 6
.amdhsa_kernel concat_heads__compressed_kv_cla__mha_block_cached__decode_kernel
  .amdhsa_next_free_vgpr 512
  .amdhsa_next_free_sgpr 102
  .amdhsa_accum_offset 256
  .amdhsa_group_segment_fixed_size 0
  .amdhsa_kernarg_size 112
  .amdhsa_user_sgpr_count 2
  .amdhsa_user_sgpr_kernarg_segment_ptr 1
  .amdhsa_system_sgpr_workgroup_id_x 1
.end_amdhsa_kernel
```

```asm
; @launch grid=(256,1,1) block=(256,1,1) lds=163840
    .amdgcn_target "amdgcn-amd-amdhsa--gfx950"
    .text
    .globl concat_heads__compressed_kv_cla__mha_block_cached__decode_kernel
    .p2align 8
    .type concat_heads__compressed_kv_cla__mha_block_cached__decode_kernel,@function
concat_heads__compressed_kv_cla__mha_block_cached__decode_kernel:
    s_cmp_ge_u32 s2, 256
    s_cbranch_scc1 L_end
    s_load_dwordx16 s[4:19], s[0:1], 0
    s_load_dwordx8 s[20:27], s[0:1], 64
    s_load_dwordx4 s[28:31], s[0:1], 96
    v_lshrrev_b32 v4, 6, v0
    v_and_b32 v1, 63, v0
    v_readfirstlane_b32 s34, v4
    s_lshr_b32 s32, s2, 3
    s_sub_u32 s33, s2, s32
    s_sub_u32 s33, s33, 1
    s_and_b32 s33, s33, 7
    v_lshrrev_b32 v2, 4, v1
    v_and_b32 v3, 15, v1
    s_cmp_lt_u32 s33, 2
    s_cbranch_scc1 L_qp
    s_cmp_eq_u32 s33, 2
    s_cbranch_scc1 L_ql
    s_cmp_eq_u32 s33, 7
    s_cbranch_scc1 L_aux
    s_bfe_u32 s38, s2, 0x30000
    s_lshl_b32 s38, s38, 21
    s_add_u32 s36, s38, -393216
    s_lshr_b32 s38, s32, 3
    s_lshl_b32 s38, s38, 19
    s_add_u32 s36, s38, s36
    s_lshl_b32 s38, s33, 17
    s_add_u32 s36, s38, s36
    s_lshl_b32 s38, s34, 12
    s_add_u32 s36, s38, s36
    v_bfe_u32 v5, v1, 0, 5
    v_lshlrev_b32 v4, 7, v5
    v_lshrrev_b32 v5, 5, v1
    v_lshl_add_u32 v4, v5, 15, v4
    s_mov_b32 s42, 16777216
    s_mov_b32 s43, 0x20000
    s_waitcnt lgkmcnt(0)
    s_mov_b64 s[40:41], s[6:7]
    buffer_load_dword v20, v4, s[40:43], s36 offen
    s_add_u32 s36, s36, 16384
    buffer_load_dword v21, v4, s[40:43], s36 offen
    s_add_u32 s36, s36, 49152
    buffer_load_dword v22, v4, s[40:43], s36 offen
    s_add_u32 s36, s36, 16384
    buffer_load_dword v23, v4, s[40:43], s36 offen
    s_load_dword s35, s[30:31], 0
    s_mov_b32 s48, s30
    s_and_b32 s49, s31, 0xffff
    s_mov_b32 s50, 8388608
    s_mov_b32 s51, 0x20000
    s_mov_b32 s82, 0xffffff00
    s_mov_b32 s83, 0x3e0293ee
    s_mov_b32 s84, 2097152
    v_lshrrev_b32 v4, 2, v3
    v_and_b32 v5, 3, v3
    v_lshlrev_b32 v76, 8, v4
    v_lshlrev_b32 v126, 8, v2
    v_lshl_add_u32 v76, v2, 6, v76
    v_lshl_add_u32 v76, v5, 4, v76
    v_lshl_add_u32 v126, v3, 4, v126
    v_xor_b32 v77, 32768, v76
    v_xor_b32 v127, 32768, v126
    s_add_u32 s3, s34, s33
    s_and_b32 s3, s3, 3
    s_lshl_b32 s89, s3, 5
    s_add_u32 s89, s89, s32
    s_lshl_b32 s89, s89, 20
    s_mul_i32 s88, s32, 8
    s_add_u32 s88, s88, s3
    s_lshl_b32 s87, s33, 0
    s_mov_b32 s52, s18
    s_and_b32 s53, s19, 0xffff
    s_mov_b32 s54, 134217728
    s_mov_b32 s55, 0x20000
    s_mov_b32 s56, s20
    s_and_b32 s57, s21, 0xffff
    s_mov_b32 s58, 134217728
    s_mov_b32 s59, 0x20000
    v_and_b32 v4, 1, v1
    v_lshlrev_b32 v4, 4, v4
    v_mov_b32 v5, 0xffff
    v_lshlrev_b32 v4, v4, v5
    v_bfe_u32 v5, v1, 1, 2
    v_cmp_eq_u32 vcc, 0, v5
    s_nop 1
    v_cndmask_b32 v10, 0, v4, vcc
    v_cmp_eq_u32 vcc, 1, v5
    s_nop 1
    v_cndmask_b32 v11, 0, v4, vcc
    v_cmp_eq_u32 vcc, 2, v5
    s_nop 1
    v_cndmask_b32 v12, 0, v4, vcc
    v_cmp_eq_u32 vcc, 3, v5
    s_nop 1
    v_cndmask_b32 v13, 0, v4, vcc
    v_mov_b32 v120, 0xff7f0000
    v_mov_b32 v121, 0
    v_mov_b32 v18, 1
    v_mov_b32 v116, 0
    v_mov_b32 v117, 0
    v_mov_b32 v118, 0
    v_mov_b32 v119, 0
    s_lshl_b32 s38, s32, 10
    s_add_u32 s96, s38, 65536
    s_lshl_b32 s38, s3, 8
    s_add_u32 s96, s38, s96
    v_mov_b32 v9, s96
    s_lshl_b32 s38, s32, 15
    s_add_u32 s96, s38, 1048576
    s_lshl_b32 s38, s3, 13
    s_add_u32 s96, s38, s96
    s_lshl_b32 s38, s33, 10
    s_add_u32 s96, s38, s96
    v_and_b32 v5, 3, v3
    v_lshlrev_b32 v78, 7, v2
    v_lshl_add_u32 v78, v5, 5, v78
    s_lshl_b32 s38, s32, 12
    s_add_u32 s91, s38, 262144
    s_lshl_b32 s38, s3, 9
    s_add_u32 s91, s38, s91
    v_lshlrev_b32 v4, 7, v2
    v_lshl_add_u32 v4, v3, 4, v4
    v_mov_b32 v5, 512
    v_cmp_gt_u32 vcc, 8, v3
    s_nop 1
    v_cndmask_b32 v79, v5, v4, vcc
    s_add_u32 s39, s87, s88
    s_bfe_u32 s37, s39, 0x30000
    s_lshl_b32 s37, s37, 12
    s_add_u32 s85, s37, s89
    s_bfe_u32 s37, s39, 0x10003
    s_lshl_b32 s37, s37, 11
    s_add_u32 s85, s37, s85
    s_bfe_u32 s37, s39, 0x40004
    s_lshl_b32 s37, s37, 16
    s_add_u32 s85, s37, s85
    buffer_load_dwordx4 v[128:131], v76, s[52:55], s85 offen offset:0 nt
    buffer_load_dwordx4 v[132:135], v77, s[52:55], s85 offen offset:0 nt
    buffer_load_dwordx4 v[136:139], v76, s[52:55], s85 offen offset:1024 nt
    buffer_load_dwordx4 v[140:143], v77, s[52:55], s85 offen offset:1024 nt
    s_add_u32 s87, s87, 7
    s_add_u32 s39, s87, s88
    s_bfe_u32 s37, s39, 0x30000
    s_lshl_b32 s37, s37, 12
    s_add_u32 s85, s37, s89
    s_bfe_u32 s37, s39, 0x10003
    s_lshl_b32 s37, s37, 11
    s_add_u32 s85, s37, s85
    s_bfe_u32 s37, s39, 0x40004
    s_lshl_b32 s37, s37, 16
    s_add_u32 s85, s37, s85
    buffer_load_dwordx4 v[144:147], v76, s[52:55], s85 offen offset:0 nt
    buffer_load_dwordx4 v[148:151], v77, s[52:55], s85 offen offset:0 nt
    buffer_load_dwordx4 v[152:155], v76, s[52:55], s85 offen offset:1024 nt
    s_waitcnt vmcnt(6)
    buffer_load_dwordx4 v[156:159], v77, s[52:55], s85 offen offset:1024 nt
    s_add_u32 s87, s87, 7
    s_add_u32 s39, s87, s88
    s_bfe_u32 s37, s39, 0x30000
    s_lshl_b32 s37, s37, 12
    s_add_u32 s85, s37, s89
    s_bfe_u32 s37, s39, 0x10003
    s_lshl_b32 s37, s37, 11
    s_add_u32 s85, s37, s85
    s_bfe_u32 s37, s39, 0x40004
    s_lshl_b32 s37, s37, 16
    s_add_u32 s85, s37, s85
    s_waitcnt vmcnt(6)
    buffer_load_dwordx4 v[160:163], v76, s[52:55], s85 offen offset:0 nt
    s_waitcnt vmcnt(6)
    buffer_load_dwordx4 v[164:167], v77, s[52:55], s85 offen offset:0 nt
    s_waitcnt vmcnt(6)
    buffer_load_dwordx4 v[168:171], v76, s[52:55], s85 offen offset:1024 nt
    s_waitcnt vmcnt(6)
    buffer_load_dwordx4 v[172:175], v77, s[52:55], s85 offen offset:1024 nt
    s_add_u32 s87, s87, 7
    s_add_u32 s39, s87, s88
    s_bfe_u32 s37, s39, 0x30000
    s_lshl_b32 s37, s37, 12
    s_add_u32 s85, s37, s89
    s_bfe_u32 s37, s39, 0x10003
    s_lshl_b32 s37, s37, 11
    s_add_u32 s85, s37, s85
    s_bfe_u32 s37, s39, 0x40004
    s_lshl_b32 s37, s37, 16
    s_add_u32 s85, s37, s85
    s_waitcnt vmcnt(6)
    buffer_load_dwordx4 v[176:179], v76, s[52:55], s85 offen offset:0 nt
    s_waitcnt vmcnt(6)
    buffer_load_dwordx4 v[180:183], v77, s[52:55], s85 offen offset:0 nt
    s_waitcnt vmcnt(6)
    buffer_load_dwordx4 v[184:187], v76, s[52:55], s85 offen offset:1024 nt
    s_waitcnt vmcnt(6)
    buffer_load_dwordx4 v[188:191], v77, s[52:55], s85 offen offset:1024 nt
    s_add_u32 s87, s87, 7
    s_add_u32 s39, s87, s88
    s_bfe_u32 s37, s39, 0x30000
    s_lshl_b32 s37, s37, 12
    s_add_u32 s85, s37, s89
    s_bfe_u32 s37, s39, 0x10003
    s_lshl_b32 s37, s37, 11
    s_add_u32 s85, s37, s85
    s_bfe_u32 s37, s39, 0x40004
    s_lshl_b32 s37, s37, 16
    s_add_u32 s85, s37, s85
    s_waitcnt vmcnt(6)
    buffer_load_dwordx4 v[192:195], v76, s[52:55], s85 offen offset:0 nt
    s_waitcnt vmcnt(6)
    buffer_load_dwordx4 v[196:199], v77, s[52:55], s85 offen offset:0 nt
    s_waitcnt vmcnt(6)
    buffer_load_dwordx4 v[200:203], v76, s[52:55], s85 offen offset:1024 nt
    s_waitcnt vmcnt(6)
    buffer_load_dwordx4 v[204:207], v77, s[52:55], s85 offen offset:1024 nt
    s_add_u32 s87, s87, 7
    s_add_u32 s39, s87, s88
    s_bfe_u32 s37, s39, 0x30000
    s_lshl_b32 s37, s37, 12
    s_add_u32 s85, s37, s89
    s_bfe_u32 s37, s39, 0x10003
    s_lshl_b32 s37, s37, 11
    s_add_u32 s85, s37, s85
    s_bfe_u32 s37, s39, 0x40004
    s_lshl_b32 s37, s37, 16
    s_add_u32 s85, s37, s85
    s_waitcnt vmcnt(6)
    buffer_load_dwordx4 v[208:211], v76, s[52:55], s85 offen offset:0 nt
    s_waitcnt vmcnt(6)
    buffer_load_dwordx4 v[212:215], v77, s[52:55], s85 offen offset:0 nt
    s_waitcnt vmcnt(6)
    buffer_load_dwordx4 v[216:219], v76, s[52:55], s85 offen offset:1024 nt
    s_waitcnt vmcnt(6)
    buffer_load_dwordx4 v[220:223], v77, s[52:55], s85 offen offset:1024 nt
    s_add_u32 s87, s87, 7
    s_add_u32 s39, s87, s88
    s_bfe_u32 s37, s39, 0x30000
    s_lshl_b32 s37, s37, 12
    s_add_u32 s85, s37, s89
    s_bfe_u32 s37, s39, 0x10003
    s_lshl_b32 s37, s37, 11
    s_add_u32 s85, s37, s85
    s_bfe_u32 s37, s39, 0x40004
    s_lshl_b32 s37, s37, 16
    s_add_u32 s85, s37, s85
    s_waitcnt vmcnt(6)
    buffer_load_dwordx4 v[224:227], v76, s[52:55], s85 offen offset:0 nt
    s_waitcnt vmcnt(6)
    buffer_load_dwordx4 v[228:231], v77, s[52:55], s85 offen offset:0 nt
    s_waitcnt vmcnt(6)
    buffer_load_dwordx4 v[232:235], v76, s[52:55], s85 offen offset:1024 nt
    s_waitcnt vmcnt(6)
    buffer_load_dwordx4 v[236:239], v77, s[52:55], s85 offen offset:1024 nt
    s_add_u32 s87, s87, 7
    s_add_u32 s39, s87, s88
    s_bfe_u32 s37, s39, 0x30000
    s_lshl_b32 s37, s37, 12
    s_add_u32 s85, s37, s89
    s_bfe_u32 s37, s39, 0x10003
    s_lshl_b32 s37, s37, 11
    s_add_u32 s85, s37, s85
    s_bfe_u32 s37, s39, 0x40004
    s_lshl_b32 s37, s37, 16
    s_add_u32 s85, s37, s85
    s_waitcnt vmcnt(6)
    buffer_load_dwordx4 v[240:243], v76, s[52:55], s85 offen offset:0 nt
    s_waitcnt vmcnt(6)
    buffer_load_dwordx4 v[244:247], v77, s[52:55], s85 offen offset:0 nt
    s_waitcnt vmcnt(6)
    buffer_load_dwordx4 v[248:251], v76, s[52:55], s85 offen offset:1024 nt
    s_waitcnt vmcnt(6)
    buffer_load_dwordx4 v[252:255], v77, s[52:55], s85 offen offset:1024 nt
    s_add_u32 s87, s87, 7
    s_add_u32 s39, s87, s88
    s_bfe_u32 s37, s39, 0x30000
    s_lshl_b32 s37, s37, 12
    s_add_u32 s85, s37, s89
    s_bfe_u32 s37, s39, 0x10003
    s_lshl_b32 s37, s37, 11
    s_add_u32 s85, s37, s85
    s_bfe_u32 s37, s39, 0x40004
    s_lshl_b32 s37, s37, 16
    s_add_u32 s85, s37, s85
    s_waitcnt vmcnt(6)
    buffer_load_dwordx4 a[0:3], v76, s[52:55], s85 offen offset:0 nt
    s_waitcnt vmcnt(6)
    buffer_load_dwordx4 a[4:7], v77, s[52:55], s85 offen offset:0 nt
    buffer_load_dwordx4 v[68:71], v78, s[48:51], s91 offen offset:0 sc1
    buffer_load_dwordx4 v[72:75], v78, s[48:51], s91 offen offset:16 sc1
    s_waitcnt vmcnt(8)
    buffer_load_dwordx4 a[8:11], v76, s[52:55], s85 offen offset:1024 nt
    s_waitcnt vmcnt(8)
    buffer_load_dwordx4 a[12:15], v77, s[52:55], s85 offen offset:1024 nt
    s_add_u32 s87, s87, 7
    s_add_u32 s39, s87, s88
    s_bfe_u32 s37, s39, 0x30000
    s_lshl_b32 s37, s37, 12
    s_add_u32 s85, s37, s89
    s_bfe_u32 s37, s39, 0x10003
    s_lshl_b32 s37, s37, 11
    s_add_u32 s85, s37, s85
    s_bfe_u32 s37, s39, 0x40004
    s_lshl_b32 s37, s37, 16
    s_add_u32 s85, s37, s85
    s_waitcnt vmcnt(8)
    buffer_load_dwordx4 a[16:19], v76, s[52:55], s85 offen offset:0 nt
    s_waitcnt vmcnt(8)
    buffer_load_dwordx4 a[20:23], v77, s[52:55], s85 offen offset:0 nt
    s_waitcnt vmcnt(8)
    buffer_load_dwordx4 a[24:27], v76, s[52:55], s85 offen offset:1024 nt
    s_waitcnt vmcnt(8)
    buffer_load_dwordx4 a[28:31], v77, s[52:55], s85 offen offset:1024 nt
    s_add_u32 s87, s87, 7
    s_add_u32 s39, s87, s88
    s_bfe_u32 s37, s39, 0x30000
    s_lshl_b32 s37, s37, 12
    s_add_u32 s85, s37, s89
    s_bfe_u32 s37, s39, 0x10003
    s_lshl_b32 s37, s37, 11
    s_add_u32 s85, s37, s85
    s_bfe_u32 s37, s39, 0x40004
    s_lshl_b32 s37, s37, 16
    s_add_u32 s85, s37, s85
    s_waitcnt lgkmcnt(0)
    s_add_u32 s35, s35, 0x5b
    s_and_b32 s35, s35, 0xff
    v_mov_b32 v8, s35
    s_waitcnt vmcnt(6)
L_qcheck_1:
    v_xor_b32 v68, s35, v68
    v_xor_b32 v69, s35, v69
    v_xor_b32 v70, s35, v70
    v_xor_b32 v71, s35, v71
    v_xor_b32 v72, s35, v72
    v_xor_b32 v73, s35, v73
    v_xor_b32 v74, s35, v74
    v_xor_b32 v75, s35, v75
    v_or_b32 v4, v68, v69
    v_or3_b32 v4, v4, v70, v71
    v_or3_b32 v4, v4, v72, v73
    v_or3_b32 v4, v4, v74, v75
    v_and_b32 v4, 0xff, v4
    v_cmp_ne_u32 vcc, 0, v4
    s_cbranch_vccz L_qok_2
    buffer_load_dwordx4 v[68:71], v78, s[48:51], s91 offen offset:0 sc1
    buffer_load_dwordx4 v[72:75], v78, s[48:51], s91 offen offset:16 sc1
    s_waitcnt vmcnt(0)
    s_sub_u32 s84, s84, 1
    s_cmp_lg_u32 s84, 0
    s_cbranch_scc1 L_qcheck_1
    s_branch L_end
L_qok_2:
    v_cvt_pk_bf16_f32 v68, v68, v69
    v_cvt_pk_bf16_f32 v69, v70, v71
    v_cvt_pk_bf16_f32 v70, v72, v73
    v_cvt_pk_bf16_f32 v71, v74, v75
    s_mov_b32 vcc_lo, 0xf000f
    s_mov_b32 vcc_hi, 0xf000f
    v_cndmask_b32 v80, 0, v68, vcc
    v_cndmask_b32 v81, 0, v69, vcc
    v_cndmask_b32 v82, 0, v70, vcc
    v_cndmask_b32 v83, 0, v71, vcc
    s_mov_b32 vcc_lo, 0xf000f0
    s_mov_b32 vcc_hi, 0xf000f0
    v_cndmask_b32 v84, 0, v68, vcc
    v_cndmask_b32 v85, 0, v69, vcc
    v_cndmask_b32 v86, 0, v70, vcc
    v_cndmask_b32 v87, 0, v71, vcc
    s_mov_b32 vcc_lo, 0xf000f00
    s_mov_b32 vcc_hi, 0xf000f00
    v_cndmask_b32 v88, 0, v68, vcc
    v_cndmask_b32 v89, 0, v69, vcc
    v_cndmask_b32 v90, 0, v70, vcc
    v_cndmask_b32 v91, 0, v71, vcc
    s_mov_b32 vcc_lo, 0xf000f000
    s_mov_b32 vcc_hi, 0xf000f000
    v_cndmask_b32 v92, 0, v68, vcc
    v_cndmask_b32 v93, 0, v69, vcc
    v_cndmask_b32 v94, 0, v70, vcc
    v_cndmask_b32 v95, 0, v71, vcc
    v_mov_b32 v65, 0xff7f0000
    s_lshl_b32 s38, s34, 14
    s_add_u32 s38, s38, 16384
    v_lshl_add_u32 v64, v1, 2, s38
    buffer_load_dwordx4 a[32:35], v76, s[52:55], s85 offen offset:0 nt
    v_mfma_f32_16x16x32_bf16 v[112:115], v[128:131], v[80:83], 0
    v_mfma_f32_16x16x32_bf16 v[112:115], v[132:135], v[84:87], v[112:115]
    v_mfma_f32_16x16x32_bf16 v[112:115], v[136:139], v[88:91], v[112:115]
    s_waitcnt vmcnt(6)
    buffer_load_dwordx4 a[36:39], v77, s[52:55], s85 offen offset:0 nt
    v_mfma_f32_16x16x32_bf16 v[112:115], v[140:143], v[92:95], v[112:115]
    v_mfma_f32_16x16x32_bf16 v[96:99], v[144:147], v[80:83], 0
    v_mfma_f32_16x16x32_bf16 v[96:99], v[148:151], v[84:87], v[96:99]
    s_waitcnt vmcnt(6)
    buffer_load_dwordx4 a[40:43], v76, s[52:55], s85 offen offset:1024 nt
    v_mfma_f32_16x16x32_bf16 v[96:99], v[152:155], v[88:91], v[96:99]
    s_nop 2
    v_mov_b32_dpp v122, v112 quad_perm:[0,0,0,0] row_mask:0xf bank_mask:0xf
    v_mov_b32_dpp v124, v114 quad_perm:[2,2,2,2] row_mask:0xf bank_mask:0xf
    s_nop 0
    v_add_f32_dpp v122, v113, v122 quad_perm:[1,1,1,1] row_mask:0xf bank_mask:0xf
    v_add_f32_dpp v124, v115, v124 quad_perm:[3,3,3,3] row_mask:0xf bank_mask:0xf
    v_add_f32 v122, v122, v124
    v_max_f32 v65, v65, v122
    ds_write_b32 v64, v122 offset:0
    v_mfma_f32_16x16x32_bf16 v[96:99], v[156:159], v[92:95], v[96:99]
    v_mfma_f32_16x16x32_bf16 v[112:115], v[160:163], v[80:83], 0
    v_mfma_f32_16x16x32_bf16 v[112:115], v[164:167], v[84:87], v[112:115]
    s_waitcnt vmcnt(6)
    buffer_load_dwordx4 a[44:47], v77, s[52:55], s85 offen offset:1024 nt
    s_add_u32 s87, s87, 7
    s_add_u32 s39, s87, s88
    s_bfe_u32 s37, s39, 0x30000
    s_lshl_b32 s37, s37, 12
    s_add_u32 s85, s37, s89
    s_bfe_u32 s37, s39, 0x10003
    s_lshl_b32 s37, s37, 11
    s_add_u32 s85, s37, s85
    s_bfe_u32 s37, s39, 0x40004
    s_lshl_b32 s37, s37, 16
    s_add_u32 s85, s37, s85
    v_mfma_f32_16x16x32_bf16 v[112:115], v[168:171], v[88:91], v[112:115]
    v_mov_b32_dpp v122, v96 quad_perm:[0,0,0,0] row_mask:0xf bank_mask:0xf
    v_mov_b32_dpp v124, v98 quad_perm:[2,2,2,2] row_mask:0xf bank_mask:0xf
    s_nop 0
    v_add_f32_dpp v122, v97, v122 quad_perm:[1,1,1,1] row_mask:0xf bank_mask:0xf
    v_add_f32_dpp v124, v99, v124 quad_perm:[3,3,3,3] row_mask:0xf bank_mask:0xf
    v_add_f32 v122, v122, v124
    v_max_f32 v65, v65, v122
    ds_write_b32 v64, v122 offset:256
    v_mfma_f32_16x16x32_bf16 v[112:115], v[172:175], v[92:95], v[112:115]
    v_mfma_f32_16x16x32_bf16 v[96:99], v[176:179], v[80:83], 0
    s_waitcnt vmcnt(6)
    buffer_load_dwordx4 a[48:51], v76, s[52:55], s85 offen offset:0 nt
    v_mfma_f32_16x16x32_bf16 v[96:99], v[180:183], v[84:87], v[96:99]
    v_mfma_f32_16x16x32_bf16 v[96:99], v[184:187], v[88:91], v[96:99]
    s_nop 2
    v_mov_b32_dpp v122, v112 quad_perm:[0,0,0,0] row_mask:0xf bank_mask:0xf
    v_mov_b32_dpp v124, v114 quad_perm:[2,2,2,2] row_mask:0xf bank_mask:0xf
    s_nop 0
    v_add_f32_dpp v122, v113, v122 quad_perm:[1,1,1,1] row_mask:0xf bank_mask:0xf
    v_add_f32_dpp v124, v115, v124 quad_perm:[3,3,3,3] row_mask:0xf bank_mask:0xf
    v_add_f32 v122, v122, v124
    v_max_f32 v65, v65, v122
    ds_write_b32 v64, v122 offset:512
    v_mfma_f32_16x16x32_bf16 v[96:99], v[188:191], v[92:95], v[96:99]
    v_mfma_f32_16x16x32_bf16 v[112:115], v[192:195], v[80:83], 0
    s_waitcnt vmcnt(6)
    buffer_load_dwordx4 a[52:55], v77, s[52:55], s85 offen offset:0 nt
    v_mfma_f32_16x16x32_bf16 v[112:115], v[196:199], v[84:87], v[112:115]
    v_mfma_f32_16x16x32_bf16 v[112:115], v[200:203], v[88:91], v[112:115]
    s_nop 2
    v_mov_b32_dpp v122, v96 quad_perm:[0,0,0,0] row_mask:0xf bank_mask:0xf
    v_mov_b32_dpp v124, v98 quad_perm:[2,2,2,2] row_mask:0xf bank_mask:0xf
    s_nop 0
    v_add_f32_dpp v122, v97, v122 quad_perm:[1,1,1,1] row_mask:0xf bank_mask:0xf
    v_add_f32_dpp v124, v99, v124 quad_perm:[3,3,3,3] row_mask:0xf bank_mask:0xf
    v_add_f32 v122, v122, v124
    v_max_f32 v65, v65, v122
    ds_write_b32 v64, v122 offset:768
    v_mfma_f32_16x16x32_bf16 v[112:115], v[204:207], v[92:95], v[112:115]
    s_waitcnt vmcnt(6)
    buffer_load_dwordx4 a[56:59], v76, s[52:55], s85 offen offset:1024 nt
    v_mfma_f32_16x16x32_bf16 v[96:99], v[208:211], v[80:83], 0
    v_mfma_f32_16x16x32_bf16 v[96:99], v[212:215], v[84:87], v[96:99]
    v_mfma_f32_16x16x32_bf16 v[96:99], v[216:219], v[88:91], v[96:99]
    s_nop 2
    v_mov_b32_dpp v122, v112 quad_perm:[0,0,0,0] row_mask:0xf bank_mask:0xf
    v_mov_b32_dpp v124, v114 quad_perm:[2,2,2,2] row_mask:0xf bank_mask:0xf
    s_nop 0
    v_add_f32_dpp v122, v113, v122 quad_perm:[1,1,1,1] row_mask:0xf bank_mask:0xf
    v_add_f32_dpp v124, v115, v124 quad_perm:[3,3,3,3] row_mask:0xf bank_mask:0xf
    v_add_f32 v122, v122, v124
    v_max_f32 v65, v65, v122
    ds_write_b32 v64, v122 offset:1024
    v_mfma_f32_16x16x32_bf16 v[96:99], v[220:223], v[92:95], v[96:99]
    s_waitcnt vmcnt(6)
    buffer_load_dwordx4 a[60:63], v77, s[52:55], s85 offen offset:1024 nt
    s_add_u32 s87, s87, 7
    s_add_u32 s39, s87, s88
    s_bfe_u32 s37, s39, 0x30000
    s_lshl_b32 s37, s37, 12
    s_add_u32 s85, s37, s89
    s_bfe_u32 s37, s39, 0x10003
    s_lshl_b32 s37, s37, 11
    s_add_u32 s85, s37, s85
    s_bfe_u32 s37, s39, 0x40004
    s_lshl_b32 s37, s37, 16
    s_add_u32 s85, s37, s85
    v_mfma_f32_16x16x32_bf16 v[112:115], v[224:227], v[80:83], 0
    s_sub_u32 s36, s33, 3
    s_and_b32 s37, s33, 3
    s_cmp_lt_u32 s36, 4
    s_cselect_b64 s[40:41], s[24:25], s[14:15]
    s_cselect_b32 s36, s36, s37
    s_cselect_b32 s92, 24, 24
    s_cselect_b32 s45, 262144, 0
    s_cselect_b32 s46, 8388608, 0
    s_add_u32 s45, s45, 524288
    s_add_u32 s46, s46, 196608
    s_mov_b32 s42, 4194304
    s_mov_b32 s43, 0x20000
    s_lshl_b32 s38, s32, 17
    s_add_u32 s44, s38, 0
    s_lshl_b32 s38, s34, 15
    s_add_u32 s44, s38, s44
    s_lshl_b32 s38, s36, 8
    s_add_u32 s44, s38, s44
    s_lshl_b32 s38, s36, 16
    s_add_u32 s45, s38, s45
    s_lshr_b32 s38, s34, 1
    s_lshl_b32 s38, s38, 15
    s_add_u32 s45, s38, s45
    s_lshl_b32 s38, s32, 8
    s_add_u32 s45, s38, s45
    s_bfe_u32 s38, s34, 0x10000
    s_lshl_b32 s38, s38, 7
    s_add_u32 s45, s38, s45
    s_lshl_b32 s38, s32, 11
    s_add_u32 s46, s38, s46
    s_lshl_b32 s38, s34, 9
    s_add_u32 s46, s38, s46
    s_mov_b32 s72, s26
    s_and_b32 s73, s27, 0xffff
    s_mov_b32 s74, 8192
    s_mov_b32 s75, 0x20000
    v_mfma_f32_16x16x32_bf16 v[112:115], v[228:231], v[84:87], v[112:115]
    v_mfma_f32_16x16x32_bf16 v[112:115], v[232:235], v[88:91], v[112:115]
    v_mov_b32_dpp v122, v96 quad_perm:[0,0,0,0] row_mask:0xf bank_mask:0xf
    v_mov_b32_dpp v124, v98 quad_perm:[2,2,2,2] row_mask:0xf bank_mask:0xf
    s_nop 0
    v_add_f32_dpp v122, v97, v122 quad_perm:[1,1,1,1] row_mask:0xf bank_mask:0xf
    v_add_f32_dpp v124, v99, v124 quad_perm:[3,3,3,3] row_mask:0xf bank_mask:0xf
    v_add_f32 v122, v122, v124
    v_max_f32 v65, v65, v122
    ds_write_b32 v64, v122 offset:1280
    s_waitcnt vmcnt(5)
    buffer_load_dwordx4 v[128:131], v76, s[52:55], s85 offen offset:0 nt
    v_mfma_f32_16x16x32_bf16 v[112:115], v[236:239], v[92:95], v[112:115]
    v_mfma_f32_16x16x32_bf16 v[96:99], v[240:243], v[80:83], 0
    v_mfma_f32_16x16x32_bf16 v[96:99], v[244:247], v[84:87], v[96:99]
    s_waitcnt vmcnt(5)
    buffer_load_dwordx4 v[132:135], v77, s[52:55], s85 offen offset:0 nt
    v_mfma_f32_16x16x32_bf16 v[96:99], v[248:251], v[88:91], v[96:99]
    s_nop 2
    v_mov_b32_dpp v122, v112 quad_perm:[0,0,0,0] row_mask:0xf bank_mask:0xf
    v_mov_b32_dpp v124, v114 quad_perm:[2,2,2,2] row_mask:0xf bank_mask:0xf
    s_nop 0
    v_add_f32_dpp v122, v113, v122 quad_perm:[1,1,1,1] row_mask:0xf bank_mask:0xf
    v_add_f32_dpp v124, v115, v124 quad_perm:[3,3,3,3] row_mask:0xf bank_mask:0xf
    v_add_f32 v122, v122, v124
    v_max_f32 v65, v65, v122
    ds_write_b32 v64, v122 offset:1536
    v_lshlrev_b32 v4, 2, v2
    v_xor_b32 v4, v4, v3
    v_xor_b32 v5, 0, v4
    v_lshlrev_b32 v5, 4, v5
    v_lshl_add_u32 v20, v2, 10, v5
    v_xor_b32 v5, 1, v4
    v_lshlrev_b32 v5, 4, v5
    v_lshl_add_u32 v21, v2, 10, v5
    v_add_u32 v21, 3072, v21
    v_xor_b32 v5, 2, v4
    v_lshlrev_b32 v5, 4, v5
    v_lshl_add_u32 v22, v2, 10, v5
    v_add_u32 v22, 6144, v22
    v_xor_b32 v5, 3, v4
    v_lshlrev_b32 v5, 4, v5
    v_lshl_add_u32 v23, v2, 10, v5
    v_add_u32 v23, 9216, v23
    s_lshl_b32 s38, s32, 15
    s_add_u32 s47, s38, 1048576
    s_lshl_b32 s38, s3, 13
    s_add_u32 s47, s38, s47
    s_mul_i32 s38, s3, 320
    s_add_u32 s38, s38, 135168
    v_lshlrev_b32 v4, 6, v2
    v_lshl_add_u32 v4, v3, 1, v4
    v_add_u32 v31, s38, v4
    v_mfma_f32_16x16x32_bf16 v[96:99], v[252:255], v[92:95], v[96:99]
    v_mfma_f32_16x16x32_bf16 v[112:115], a[0:3], v[80:83], 0
    v_mfma_f32_16x16x32_bf16 v[112:115], a[4:7], v[84:87], v[112:115]
    s_waitcnt vmcnt(5)
    buffer_load_dwordx4 v[136:139], v76, s[52:55], s85 offen offset:1024 nt
    v_mfma_f32_16x16x32_bf16 v[112:115], a[8:11], v[88:91], v[112:115]
    s_nop 2
    v_mov_b32_dpp v122, v96 quad_perm:[0,0,0,0] row_mask:0xf bank_mask:0xf
    v_mov_b32_dpp v124, v98 quad_perm:[2,2,2,2] row_mask:0xf bank_mask:0xf
    s_nop 0
    v_add_f32_dpp v122, v97, v122 quad_perm:[1,1,1,1] row_mask:0xf bank_mask:0xf
    v_add_f32_dpp v124, v99, v124 quad_perm:[3,3,3,3] row_mask:0xf bank_mask:0xf
    v_add_f32 v122, v122, v124
    v_max_f32 v65, v65, v122
    ds_write_b32 v64, v122 offset:1792
    v_mfma_f32_16x16x32_bf16 v[112:115], a[12:15], v[92:95], v[112:115]
    v_mfma_f32_16x16x32_bf16 v[96:99], a[16:19], v[80:83], 0
    v_lshlrev_b32 v4, 11, v2
    v_bfe_u32 v5, v1, 2, 2
    v_lshl_add_u32 v4, v5, 8, v4
    v_bfe_u32 v5, v1, 2, 2
    v_lshl_add_u32 v4, v5, 6, v4
    v_bfe_u32 v5, v1, 4, 1
    v_lshl_add_u32 v4, v5, 5, v4
    v_bfe_u32 v5, v1, 1, 1
    v_lshl_add_u32 v4, v5, 4, v4
    v_bfe_u32 v5, v1, 0, 1
    v_lshl_add_u32 v4, v5, 3, v4
    s_lshl_b32 s38, s34, 6
    s_add_u32 s38, s38, 98304
    v_xor_b32 v24, s38, v4
    v_xor_b32 v25, 16, v24
    v_xor_b32 v26, 32, v24
    v_xor_b32 v27, 48, v24
    v_and_b32 v4, 3, v3
    v_lshrrev_b32 v5, 2, v3
    v_lshlrev_b32 v6, 4, v2
    v_add_u32 v6, 135168, v6
    s_movk_i32 s36, 320
    v_cmp_eq_u32 vcc, 0, v5
    s_nop 1
    v_cndmask_b32 v28, 4, v4, vcc
    v_mad_u32_u24 v28, v28, s36, v6
    v_cmp_eq_u32 vcc, 1, v5
    s_nop 1
    v_cndmask_b32 v29, 4, v4, vcc
    v_mad_u32_u24 v29, v29, s36, v6
    v_lshlrev_b32 v5, 2, v1
    v_add_u32 v5, 136448, v5
    v_mov_b32 v6, 0
    ds_write_b32 v5, v6
    s_waitcnt vmcnt(5)
    buffer_load_dwordx4 v[140:143], v77, s[52:55], s85 offen offset:1024 nt
    s_add_u32 s87, s87, 7
    s_add_u32 s39, s87, s88
    s_bfe_u32 s37, s39, 0x30000
    s_lshl_b32 s37, s37, 12
    s_add_u32 s85, s37, s89
    s_bfe_u32 s37, s39, 0x10003
    s_lshl_b32 s37, s37, 11
    s_add_u32 s85, s37, s85
    s_bfe_u32 s37, s39, 0x40004
    s_lshl_b32 s37, s37, 16
    s_add_u32 s85, s37, s85
    v_mfma_f32_16x16x32_bf16 v[96:99], a[20:23], v[84:87], v[96:99]
    v_mfma_f32_16x16x32_bf16 v[96:99], a[24:27], v[88:91], v[96:99]
    v_mov_b32_dpp v122, v112 quad_perm:[0,0,0,0] row_mask:0xf bank_mask:0xf
    v_mov_b32_dpp v124, v114 quad_perm:[2,2,2,2] row_mask:0xf bank_mask:0xf
    s_nop 0
    v_add_f32_dpp v122, v113, v122 quad_perm:[1,1,1,1] row_mask:0xf bank_mask:0xf
    v_add_f32_dpp v124, v115, v124 quad_perm:[3,3,3,3] row_mask:0xf bank_mask:0xf
    v_add_f32 v122, v122, v124
    v_max_f32 v65, v65, v122
    ds_write_b32 v64, v122 offset:2048
    v_mfma_f32_16x16x32_bf16 v[96:99], a[28:31], v[92:95], v[96:99]
    v_mfma_f32_16x16x32_bf16 v[112:115], a[32:35], v[80:83], 0
    s_waitcnt vmcnt(5)
    buffer_load_dwordx4 v[144:147], v76, s[52:55], s85 offen offset:0 nt
    v_mfma_f32_16x16x32_bf16 v[112:115], a[36:39], v[84:87], v[112:115]
    v_mfma_f32_16x16x32_bf16 v[112:115], a[40:43], v[88:91], v[112:115]
    s_nop 2
    v_mov_b32_dpp v122, v96 quad_perm:[0,0,0,0] row_mask:0xf bank_mask:0xf
    v_mov_b32_dpp v124, v98 quad_perm:[2,2,2,2] row_mask:0xf bank_mask:0xf
    s_nop 0
    v_add_f32_dpp v122, v97, v122 quad_perm:[1,1,1,1] row_mask:0xf bank_mask:0xf
    v_add_f32_dpp v124, v99, v124 quad_perm:[3,3,3,3] row_mask:0xf bank_mask:0xf
    v_add_f32 v122, v122, v124
    v_max_f32 v65, v65, v122
    ds_write_b32 v64, v122 offset:2304
    v_lshlrev_b32 v30, 4, v3
    v_lshl_add_u32 v30, v2, 13, v30
    s_lshl_b32 s38, s32, 13
    s_add_u32 s36, s38, 0
    s_lshl_b32 s38, s34, 6
    s_add_u32 s36, s38, s36
    v_lshrrev_b32 v5, 2, v1
    v_lshlrev_b32 v32, 8, v5
    v_bfe_u32 v5, v1, 0, 2
    v_lshl_add_u32 v32, v5, 4, v32
    v_add_u32 v32, s36, v32
    s_lshr_b32 s38, s32, 2
    s_lshl_b32 s38, s38, 7
    s_add_u32 s36, s38, 0
    s_lshl_b32 s38, s34, 5
    s_add_u32 s36, s38, s36
    s_bfe_u32 s38, s32, 0x20000
    s_lshl_b32 s38, s38, 3
    s_add_u32 s36, s38, s36
    v_bfe_u32 v5, v1, 0, 2
    v_lshlrev_b32 v33, 11, v5
    v_lshl_add_u32 v33, v2, 1, v33
    v_add_u32 v33, s36, v33
    v_and_b32 v5, 31, v1
    v_lshlrev_b32 v34, 4, v5
    s_mul_i32 s38, s34, 320
    s_add_u32 s38, s38, 135168
    v_lshl_add_u32 v35, v5, 3, s38
    v_mfma_f32_16x16x32_bf16 v[112:115], a[44:47], v[92:95], v[112:115]
    s_waitcnt vmcnt(5)
    buffer_load_dwordx4 v[148:151], v77, s[52:55], s85 offen offset:0 nt
    v_mfma_f32_16x16x32_bf16 v[96:99], a[48:51], v[80:83], 0
    v_mfma_f32_16x16x32_bf16 v[96:99], a[52:55], v[84:87], v[96:99]
    v_mfma_f32_16x16x32_bf16 v[96:99], a[56:59], v[88:91], v[96:99]
    s_nop 2
    v_mov_b32_dpp v122, v112 quad_perm:[0,0,0,0] row_mask:0xf bank_mask:0xf
    v_mov_b32_dpp v124, v114 quad_perm:[2,2,2,2] row_mask:0xf bank_mask:0xf
    s_nop 0
    v_add_f32_dpp v122, v113, v122 quad_perm:[1,1,1,1] row_mask:0xf bank_mask:0xf
    v_add_f32_dpp v124, v115, v124 quad_perm:[3,3,3,3] row_mask:0xf bank_mask:0xf
    v_add_f32 v122, v122, v124
    v_max_f32 v65, v65, v122
    ds_write_b32 v64, v122 offset:2560
    v_mfma_f32_16x16x32_bf16 v[96:99], a[60:63], v[92:95], v[96:99]
    v_add_u32 v64, 2816, v64
    s_mov_b32 s97, 10
    s_mov_b32 s86, 32
    s_mov_b32 s66, 134217728
    s_mov_b32 s67, 0x20000
    s_mov_b64 s[64:65], s[52:53]
    v_mov_b32 v62, v76
    v_mov_b32 v63, v77
L_bloop:
    s_waitcnt vmcnt(5)
    buffer_load_dwordx4 v[152:155], v62, s[64:67], s85 offen offset:1024 nt
    v_mfma_f32_16x16x32_bf16 v[112:115], v[128:131], v[80:83], 0
    s_waitcnt vmcnt(5)
    buffer_load_dwordx4 v[156:159], v63, s[64:67], s85 offen offset:1024 nt
    v_mfma_f32_16x16x32_bf16 v[112:115], v[132:135], v[84:87], v[112:115]
    s_add_u32 s87, s87, 7
    s_cmp_lg_u32 s97, 1
    s_cbranch_scc1 L_stayk_3
    s_mov_b64 s[64:65], s[56:57]
    v_mov_b32 v62, v126
    v_mov_b32 v63, v127
    s_mul_i32 s37, s86, 7
    s_sub_u32 s87, s87, s37
L_stayk_3:
    s_add_u32 s39, s87, s88
    s_bfe_u32 s37, s39, 0x30000
    s_lshl_b32 s37, s37, 12
    s_add_u32 s85, s37, s89
    s_bfe_u32 s37, s39, 0x10003
    s_lshl_b32 s37, s37, 11
    s_add_u32 s85, s37, s85
    s_bfe_u32 s37, s39, 0x40004
    s_lshl_b32 s37, s37, 16
    s_add_u32 s85, s37, s85
    v_mov_b32_dpp v122, v96 quad_perm:[0,0,0,0] row_mask:0xf bank_mask:0xf
    v_mov_b32_dpp v124, v98 quad_perm:[2,2,2,2] row_mask:0xf bank_mask:0xf
    s_nop 0
    v_add_f32_dpp v122, v97, v122 quad_perm:[1,1,1,1] row_mask:0xf bank_mask:0xf
    v_add_f32_dpp v124, v99, v124 quad_perm:[3,3,3,3] row_mask:0xf bank_mask:0xf
    v_add_f32 v122, v122, v124
    v_max_f32 v65, v65, v122
    ds_write_b32 v64, v122 offset:0
    s_waitcnt vmcnt(5)
    buffer_load_dwordx4 v[128:131], v62, s[64:67], s85 offen offset:0 nt
    v_mfma_f32_16x16x32_bf16 v[112:115], v[136:139], v[88:91], v[112:115]
    s_waitcnt vmcnt(5)
    buffer_load_dwordx4 v[132:135], v63, s[64:67], s85 offen offset:0 nt
    v_mfma_f32_16x16x32_bf16 v[112:115], v[140:143], v[92:95], v[112:115]
    s_waitcnt vmcnt(5)
    buffer_load_dwordx4 v[136:139], v62, s[64:67], s85 offen offset:1024 nt
    v_mfma_f32_16x16x32_bf16 v[96:99], v[144:147], v[80:83], 0
    s_waitcnt vmcnt(5)
    buffer_load_dwordx4 v[140:143], v63, s[64:67], s85 offen offset:1024 nt
    v_mfma_f32_16x16x32_bf16 v[96:99], v[148:151], v[84:87], v[96:99]
    s_add_u32 s87, s87, 7
    s_add_u32 s39, s87, s88
    s_bfe_u32 s37, s39, 0x30000
    s_lshl_b32 s37, s37, 12
    s_add_u32 s85, s37, s89
    s_bfe_u32 s37, s39, 0x10003
    s_lshl_b32 s37, s37, 11
    s_add_u32 s85, s37, s85
    s_bfe_u32 s37, s39, 0x40004
    s_lshl_b32 s37, s37, 16
    s_add_u32 s85, s37, s85
    v_mov_b32_dpp v122, v112 quad_perm:[0,0,0,0] row_mask:0xf bank_mask:0xf
    v_mov_b32_dpp v124, v114 quad_perm:[2,2,2,2] row_mask:0xf bank_mask:0xf
    s_nop 0
    v_add_f32_dpp v122, v113, v122 quad_perm:[1,1,1,1] row_mask:0xf bank_mask:0xf
    v_add_f32_dpp v124, v115, v124 quad_perm:[3,3,3,3] row_mask:0xf bank_mask:0xf
    v_add_f32 v122, v122, v124
    v_max_f32 v65, v65, v122
    ds_write_b32 v64, v122 offset:256
    s_waitcnt vmcnt(5)
    buffer_load_dwordx4 v[144:147], v62, s[64:67], s85 offen offset:0 nt
    v_mfma_f32_16x16x32_bf16 v[96:99], v[152:155], v[88:91], v[96:99]
    s_waitcnt vmcnt(5)
    buffer_load_dwordx4 v[148:151], v63, s[64:67], s85 offen offset:0 nt
    v_mfma_f32_16x16x32_bf16 v[96:99], v[156:159], v[92:95], v[96:99]
    v_add_u32 v64, 512, v64
    s_sub_u32 s97, s97, 1
    s_cmp_lg_u32 s97, 0
    s_cbranch_scc1 L_bloop
    s_nop 3
    v_mov_b32_dpp v122, v96 quad_perm:[0,0,0,0] row_mask:0xf bank_mask:0xf
    v_mov_b32_dpp v124, v98 quad_perm:[2,2,2,2] row_mask:0xf bank_mask:0xf
    s_nop 0
    v_add_f32_dpp v122, v97, v122 quad_perm:[1,1,1,1] row_mask:0xf bank_mask:0xf
    v_add_f32_dpp v124, v99, v124 quad_perm:[3,3,3,3] row_mask:0xf bank_mask:0xf
    v_add_f32 v122, v122, v124
    v_max_f32 v65, v65, v122
    ds_write_b32 v64, v122 offset:0
    v_mov_b32 v123, 0xff7f0000
    ds_write_b32 v64, v123 offset:256
    s_lshl_b32 s38, s34, 14
    s_add_u32 s38, s38, 16384
    v_lshl_add_u32 v64, v1, 2, s38
    ds_read_b32 v66, v64
    ds_read_b32 v67, v64 offset:256
    v_mul_f32 v65, s83, v65
    s_nop 1
    v_max_f32_dpp v124, v65, v65 row_ror:4 row_mask:0xf bank_mask:0xf
    s_nop 1
    v_max_f32_dpp v124, v124, v124 row_ror:8 row_mask:0xf bank_mask:0xf
    v_mov_b32 v125, v124
    s_nop 1
    v_permlane16_swap_b32 v124, v125
    v_max_f32 v124, v124, v125
    v_mov_b32 v125, v124
    s_nop 1
    v_permlane32_swap_b32 v124, v125
    v_max_f32 v124, v124, v125
    v_mov_b32 v120, v124
    s_lshr_b32 s97, s86, 1
    s_waitcnt lgkmcnt(1)
    v_fma_f32 v123, v66, s83, -v120
    v_exp_f32 v123, v123
    ds_read_b32 v66, v64 offset:512
    v_cvt_pk_bf16_f32 v100, v123, v123
    v_add_f32 v121, v121, v123
L_vloop:
    s_nop 0
    v_and_b32_dpp v104, v100, v10 row_newbcast:0 row_mask:0xf bank_mask:0xf
    v_and_b32_dpp v105, v100, v11 row_newbcast:0 row_mask:0xf bank_mask:0xf
    v_and_b32_dpp v106, v100, v12 row_newbcast:0 row_mask:0xf bank_mask:0xf
    v_and_b32_dpp v107, v100, v13 row_newbcast:0 row_mask:0xf bank_mask:0xf
    s_waitcnt vmcnt(5)
    buffer_load_dwordx4 v[152:155], v62, s[64:67], s85 offen offset:1024 nt
    v_mfma_f32_16x16x32_bf16 v[116:119], v[128:131], v[104:107], v[116:119]
    v_and_b32_dpp v108, v100, v10 row_newbcast:4 row_mask:0xf bank_mask:0xf
    v_and_b32_dpp v109, v100, v11 row_newbcast:4 row_mask:0xf bank_mask:0xf
    v_and_b32_dpp v110, v100, v12 row_newbcast:4 row_mask:0xf bank_mask:0xf
    v_and_b32_dpp v111, v100, v13 row_newbcast:4 row_mask:0xf bank_mask:0xf
    s_waitcnt vmcnt(5)
    buffer_load_dwordx4 v[156:159], v63, s[64:67], s85 offen offset:1024 nt
    v_mfma_f32_16x16x32_bf16 v[116:119], v[132:135], v[108:111], v[116:119]
    s_add_u32 s87, s87, 7
    s_cmp_lg_u32 s97, 1
    s_cbranch_scc1 L_stayv_4
    s_mov_b64 s[64:65], s[52:53]
    v_mov_b32 v62, v76
    v_mov_b32 v63, v77
    s_mov_b64 exec, 1
    global_atomic_add v19, v9, v18, s[30:31] sc0 sc1
    s_mov_b64 exec, -1
    s_add_u32 s87, s33, 224
L_stayv_4:
    s_add_u32 s39, s87, s88
    s_bfe_u32 s37, s39, 0x30000
    s_lshl_b32 s37, s37, 12
    s_add_u32 s85, s37, s89
    s_bfe_u32 s37, s39, 0x10003
    s_lshl_b32 s37, s37, 11
    s_add_u32 s85, s37, s85
    s_bfe_u32 s37, s39, 0x40004
    s_lshl_b32 s37, s37, 16
    s_add_u32 s85, s37, s85
    s_waitcnt lgkmcnt(1)
    v_fma_f32 v123, v67, s83, -v120
    v_exp_f32 v123, v123
    ds_read_b32 v67, v64 offset:768
    v_cvt_pk_bf16_f32 v101, v123, v123
    v_add_f32 v121, v121, v123
    v_and_b32_dpp v104, v100, v10 row_newbcast:8 row_mask:0xf bank_mask:0xf
    v_and_b32_dpp v105, v100, v11 row_newbcast:8 row_mask:0xf bank_mask:0xf
    v_and_b32_dpp v106, v100, v12 row_newbcast:8 row_mask:0xf bank_mask:0xf
    v_and_b32_dpp v107, v100, v13 row_newbcast:8 row_mask:0xf bank_mask:0xf
    s_waitcnt vmcnt(5)
    buffer_load_dwordx4 v[128:131], v62, s[64:67], s85 offen offset:0 nt
    v_mfma_f32_16x16x32_bf16 v[116:119], v[136:139], v[104:107], v[116:119]
    v_and_b32_dpp v108, v100, v10 row_newbcast:12 row_mask:0xf bank_mask:0xf
    v_and_b32_dpp v109, v100, v11 row_newbcast:12 row_mask:0xf bank_mask:0xf
    v_and_b32_dpp v110, v100, v12 row_newbcast:12 row_mask:0xf bank_mask:0xf
    v_and_b32_dpp v111, v100, v13 row_newbcast:12 row_mask:0xf bank_mask:0xf
    s_waitcnt vmcnt(5)
    buffer_load_dwordx4 v[132:135], v63, s[64:67], s85 offen offset:0 nt
    v_mfma_f32_16x16x32_bf16 v[116:119], v[140:143], v[108:111], v[116:119]
    v_and_b32_dpp v104, v101, v10 row_newbcast:0 row_mask:0xf bank_mask:0xf
    v_and_b32_dpp v105, v101, v11 row_newbcast:0 row_mask:0xf bank_mask:0xf
    v_and_b32_dpp v106, v101, v12 row_newbcast:0 row_mask:0xf bank_mask:0xf
    v_and_b32_dpp v107, v101, v13 row_newbcast:0 row_mask:0xf bank_mask:0xf
    s_waitcnt vmcnt(5)
    buffer_load_dwordx4 v[136:139], v62, s[64:67], s85 offen offset:1024 nt
    v_mfma_f32_16x16x32_bf16 v[116:119], v[144:147], v[104:107], v[116:119]
    v_and_b32_dpp v108, v101, v10 row_newbcast:4 row_mask:0xf bank_mask:0xf
    v_and_b32_dpp v109, v101, v11 row_newbcast:4 row_mask:0xf bank_mask:0xf
    v_and_b32_dpp v110, v101, v12 row_newbcast:4 row_mask:0xf bank_mask:0xf
    v_and_b32_dpp v111, v101, v13 row_newbcast:4 row_mask:0xf bank_mask:0xf
    s_waitcnt vmcnt(5)
    buffer_load_dwordx4 v[140:143], v63, s[64:67], s85 offen offset:1024 nt
    v_mfma_f32_16x16x32_bf16 v[116:119], v[148:151], v[108:111], v[116:119]
    s_add_u32 s87, s87, 7
    s_cmp_lg_u32 s97, 1
    s_cbranch_scc1 L_stayv_5
    s_mov_b64 s[64:65], s[56:57]
    v_mov_b32 v62, v126
    v_mov_b32 v63, v127
    s_add_u32 s87, s33, 224
L_stayv_5:
    s_add_u32 s39, s87, s88
    s_bfe_u32 s37, s39, 0x30000
    s_lshl_b32 s37, s37, 12
    s_add_u32 s85, s37, s89
    s_bfe_u32 s37, s39, 0x10003
    s_lshl_b32 s37, s37, 11
    s_add_u32 s85, s37, s85
    s_bfe_u32 s37, s39, 0x40004
    s_lshl_b32 s37, s37, 16
    s_add_u32 s85, s37, s85
    v_add_u32 v64, 512, v64
    s_waitcnt lgkmcnt(1)
    v_fma_f32 v123, v66, s83, -v120
    v_exp_f32 v123, v123
    ds_read_b32 v66, v64 offset:512
    v_cvt_pk_bf16_f32 v100, v123, v123
    v_add_f32 v121, v121, v123
    v_and_b32_dpp v104, v101, v10 row_newbcast:8 row_mask:0xf bank_mask:0xf
    v_and_b32_dpp v105, v101, v11 row_newbcast:8 row_mask:0xf bank_mask:0xf
    v_and_b32_dpp v106, v101, v12 row_newbcast:8 row_mask:0xf bank_mask:0xf
    v_and_b32_dpp v107, v101, v13 row_newbcast:8 row_mask:0xf bank_mask:0xf
    s_waitcnt vmcnt(5)
    buffer_load_dwordx4 v[144:147], v62, s[64:67], s85 offen offset:0 nt
    v_mfma_f32_16x16x32_bf16 v[116:119], v[152:155], v[104:107], v[116:119]
    v_and_b32_dpp v108, v101, v10 row_newbcast:12 row_mask:0xf bank_mask:0xf
    v_and_b32_dpp v109, v101, v11 row_newbcast:12 row_mask:0xf bank_mask:0xf
    v_and_b32_dpp v110, v101, v12 row_newbcast:12 row_mask:0xf bank_mask:0xf
    v_and_b32_dpp v111, v101, v13 row_newbcast:12 row_mask:0xf bank_mask:0xf
    s_waitcnt vmcnt(5)
    buffer_load_dwordx4 v[148:151], v63, s[64:67], s85 offen offset:0 nt
    v_mfma_f32_16x16x32_bf16 v[116:119], v[156:159], v[108:111], v[116:119]
    s_sub_u32 s97, s97, 1
    s_cmp_lg_u32 s97, 0
    s_cbranch_scc1 L_vloop
    buffer_load_dwordx4 v[152:155], v126, s[56:59], s85 offen offset:1024 nt
    buffer_load_dwordx4 v[156:159], v127, s[56:59], s85 offen offset:1024 nt
L_dloop:
    s_waitcnt vmcnt(7)
    v_readfirstlane_b32 s93, v19
    v_mov_b32 v19, 25
    s_cmp_ge_u32 s93, 25
    s_cbranch_scc1 L_last0
    s_add_u32 s87, s93, 231
    s_add_u32 s39, s87, s88
    s_bfe_u32 s37, s39, 0x30000
    s_lshl_b32 s37, s37, 12
    s_add_u32 s85, s37, s89
    s_bfe_u32 s37, s39, 0x10003
    s_lshl_b32 s37, s37, 11
    s_add_u32 s85, s37, s85
    s_bfe_u32 s37, s39, 0x40004
    s_lshl_b32 s37, s37, 16
    s_add_u32 s85, s37, s85
    s_cmp_ge_u32 s93, s92
    s_cbranch_scc1 L_noclaim_6
    s_mov_b64 exec, 1
    global_atomic_add v19, v9, v18, s[30:31] sc0 sc1
    s_mov_b64 exec, -1
L_noclaim_6:
    buffer_load_dwordx4 v[160:163], v76, s[52:55], s85 offen offset:0 nt
    v_mfma_f32_16x16x32_bf16 v[112:115], v[128:131], v[80:83], 0
    s_waitcnt vmcnt(7)
    buffer_load_dwordx4 v[164:167], v77, s[52:55], s85 offen offset:0 nt
    v_mfma_f32_16x16x32_bf16 v[112:115], v[132:135], v[84:87], v[112:115]
    s_waitcnt vmcnt(7)
    buffer_load_dwordx4 v[168:171], v76, s[52:55], s85 offen offset:1024 nt
    v_mfma_f32_16x16x32_bf16 v[112:115], v[136:139], v[88:91], v[112:115]
    s_waitcnt vmcnt(7)
    buffer_load_dwordx4 v[172:175], v77, s[52:55], s85 offen offset:1024 nt
    v_mfma_f32_16x16x32_bf16 v[112:115], v[140:143], v[92:95], v[112:115]
    s_nop 7
    v_mov_b32_dpp v122, v112 quad_perm:[0,0,0,0] row_mask:0xf bank_mask:0xf
    v_mov_b32_dpp v124, v114 quad_perm:[2,2,2,2] row_mask:0xf bank_mask:0xf
    s_nop 0
    v_add_f32_dpp v122, v113, v122 quad_perm:[1,1,1,1] row_mask:0xf bank_mask:0xf
    v_add_f32_dpp v124, v115, v124 quad_perm:[3,3,3,3] row_mask:0xf bank_mask:0xf
    v_add_f32 v122, v122, v124
    v_fma_f32 v123, v122, s83, -v120
    v_cmp_lt_f32 vcc, 0, v123
    s_cbranch_vccz L_nomax_7
    v_mul_f32 v122, s83, v122
    s_nop 1
    v_max_f32_dpp v124, v122, v122 row_ror:4 row_mask:0xf bank_mask:0xf
    s_nop 1
    v_max_f32_dpp v124, v124, v124 row_ror:8 row_mask:0xf bank_mask:0xf
    v_mov_b32 v125, v124
    s_nop 1
    v_permlane16_swap_b32 v124, v125
    v_max_f32 v124, v124, v125
    v_mov_b32 v125, v124
    s_nop 1
    v_permlane32_swap_b32 v124, v125
    v_max_f32 v124, v124, v125
    v_max_f32 v124, v124, v120
    v_sub_f32 v125, v120, v124
    v_exp_f32 v125, v125
    v_mov_b32 v120, v124
    v_sub_f32 v123, v122, v124
    v_mul_f32 v121, v121, v125
    v_mul_f32 v116, v116, v125
    v_mul_f32 v117, v117, v125
    v_mul_f32 v118, v118, v125
    v_mul_f32 v119, v119, v125
L_nomax_7:
    v_exp_f32 v123, v123
    s_nop 0
    v_cvt_pk_bf16_f32 v124, v123, v123
    v_add_f32 v121, v121, v123
    s_nop 0
    v_and_b32_dpp v96, v124, v10 row_newbcast:0 row_mask:0xf bank_mask:0xf
    v_and_b32_dpp v97, v124, v11 row_newbcast:0 row_mask:0xf bank_mask:0xf
    v_and_b32_dpp v98, v124, v12 row_newbcast:0 row_mask:0xf bank_mask:0xf
    v_and_b32_dpp v99, v124, v13 row_newbcast:0 row_mask:0xf bank_mask:0xf
    v_and_b32_dpp v100, v124, v10 row_newbcast:4 row_mask:0xf bank_mask:0xf
    v_and_b32_dpp v101, v124, v11 row_newbcast:4 row_mask:0xf bank_mask:0xf
    v_and_b32_dpp v102, v124, v12 row_newbcast:4 row_mask:0xf bank_mask:0xf
    v_and_b32_dpp v103, v124, v13 row_newbcast:4 row_mask:0xf bank_mask:0xf
    v_and_b32_dpp v104, v124, v10 row_newbcast:8 row_mask:0xf bank_mask:0xf
    v_and_b32_dpp v105, v124, v11 row_newbcast:8 row_mask:0xf bank_mask:0xf
    v_and_b32_dpp v106, v124, v12 row_newbcast:8 row_mask:0xf bank_mask:0xf
    v_and_b32_dpp v107, v124, v13 row_newbcast:8 row_mask:0xf bank_mask:0xf
    v_and_b32_dpp v108, v124, v10 row_newbcast:12 row_mask:0xf bank_mask:0xf
    v_and_b32_dpp v109, v124, v11 row_newbcast:12 row_mask:0xf bank_mask:0xf
    v_and_b32_dpp v110, v124, v12 row_newbcast:12 row_mask:0xf bank_mask:0xf
    v_and_b32_dpp v111, v124, v13 row_newbcast:12 row_mask:0xf bank_mask:0xf
    s_waitcnt vmcnt(7)
    buffer_load_dwordx4 v[176:179], v126, s[56:59], s85 offen offset:0 nt
    v_mfma_f32_16x16x32_bf16 v[116:119], v[144:147], v[96:99], v[116:119]
    s_waitcnt vmcnt(7)
    buffer_load_dwordx4 v[180:183], v127, s[56:59], s85 offen offset:0 nt
    v_mfma_f32_16x16x32_bf16 v[116:119], v[148:151], v[100:103], v[116:119]
    s_waitcnt vmcnt(7)
    buffer_load_dwordx4 v[184:187], v126, s[56:59], s85 offen offset:1024 nt
    v_mfma_f32_16x16x32_bf16 v[116:119], v[152:155], v[104:107], v[116:119]
    s_waitcnt vmcnt(7)
    buffer_load_dwordx4 v[188:191], v127, s[56:59], s85 offen offset:1024 nt
    v_mfma_f32_16x16x32_bf16 v[116:119], v[156:159], v[108:111], v[116:119]
    s_waitcnt vmcnt(7)
    v_readfirstlane_b32 s93, v19
    v_mov_b32 v19, 25
    s_cmp_ge_u32 s93, 25
    s_cbranch_scc1 L_last1
    s_add_u32 s87, s93, 231
    s_add_u32 s39, s87, s88
    s_bfe_u32 s37, s39, 0x30000
    s_lshl_b32 s37, s37, 12
    s_add_u32 s85, s37, s89
    s_bfe_u32 s37, s39, 0x10003
    s_lshl_b32 s37, s37, 11
    s_add_u32 s85, s37, s85
    s_bfe_u32 s37, s39, 0x40004
    s_lshl_b32 s37, s37, 16
    s_add_u32 s85, s37, s85
    s_cmp_ge_u32 s93, s92
    s_cbranch_scc1 L_noclaim_8
    s_mov_b64 exec, 1
    global_atomic_add v19, v9, v18, s[30:31] sc0 sc1
    s_mov_b64 exec, -1
L_noclaim_8:
    buffer_load_dwordx4 v[128:131], v76, s[52:55], s85 offen offset:0 nt
    v_mfma_f32_16x16x32_bf16 v[112:115], v[160:163], v[80:83], 0
    s_waitcnt vmcnt(7)
    buffer_load_dwordx4 v[132:135], v77, s[52:55], s85 offen offset:0 nt
    v_mfma_f32_16x16x32_bf16 v[112:115], v[164:167], v[84:87], v[112:115]
    s_waitcnt vmcnt(7)
    buffer_load_dwordx4 v[136:139], v76, s[52:55], s85 offen offset:1024 nt
    v_mfma_f32_16x16x32_bf16 v[112:115], v[168:171], v[88:91], v[112:115]
    s_waitcnt vmcnt(7)
    buffer_load_dwordx4 v[140:143], v77, s[52:55], s85 offen offset:1024 nt
    v_mfma_f32_16x16x32_bf16 v[112:115], v[172:175], v[92:95], v[112:115]
    s_nop 7
    v_mov_b32_dpp v122, v112 quad_perm:[0,0,0,0] row_mask:0xf bank_mask:0xf
    v_mov_b32_dpp v124, v114 quad_perm:[2,2,2,2] row_mask:0xf bank_mask:0xf
    s_nop 0
    v_add_f32_dpp v122, v113, v122 quad_perm:[1,1,1,1] row_mask:0xf bank_mask:0xf
    v_add_f32_dpp v124, v115, v124 quad_perm:[3,3,3,3] row_mask:0xf bank_mask:0xf
    v_add_f32 v122, v122, v124
    v_fma_f32 v123, v122, s83, -v120
    v_cmp_lt_f32 vcc, 0, v123
    s_cbranch_vccz L_nomax_9
    v_mul_f32 v122, s83, v122
    s_nop 1
    v_max_f32_dpp v124, v122, v122 row_ror:4 row_mask:0xf bank_mask:0xf
    s_nop 1
    v_max_f32_dpp v124, v124, v124 row_ror:8 row_mask:0xf bank_mask:0xf
    v_mov_b32 v125, v124
    s_nop 1
    v_permlane16_swap_b32 v124, v125
    v_max_f32 v124, v124, v125
    v_mov_b32 v125, v124
    s_nop 1
    v_permlane32_swap_b32 v124, v125
    v_max_f32 v124, v124, v125
    v_max_f32 v124, v124, v120
    v_sub_f32 v125, v120, v124
    v_exp_f32 v125, v125
    v_mov_b32 v120, v124
    v_sub_f32 v123, v122, v124
    v_mul_f32 v121, v121, v125
    v_mul_f32 v116, v116, v125
    v_mul_f32 v117, v117, v125
    v_mul_f32 v118, v118, v125
    v_mul_f32 v119, v119, v125
L_nomax_9:
    v_exp_f32 v123, v123
    s_nop 0
    v_cvt_pk_bf16_f32 v124, v123, v123
    v_add_f32 v121, v121, v123
    s_nop 0
    v_and_b32_dpp v96, v124, v10 row_newbcast:0 row_mask:0xf bank_mask:0xf
    v_and_b32_dpp v97, v124, v11 row_newbcast:0 row_mask:0xf bank_mask:0xf
    v_and_b32_dpp v98, v124, v12 row_newbcast:0 row_mask:0xf bank_mask:0xf
    v_and_b32_dpp v99, v124, v13 row_newbcast:0 row_mask:0xf bank_mask:0xf
    v_and_b32_dpp v100, v124, v10 row_newbcast:4 row_mask:0xf bank_mask:0xf
    v_and_b32_dpp v101, v124, v11 row_newbcast:4 row_mask:0xf bank_mask:0xf
    v_and_b32_dpp v102, v124, v12 row_newbcast:4 row_mask:0xf bank_mask:0xf
    v_and_b32_dpp v103, v124, v13 row_newbcast:4 row_mask:0xf bank_mask:0xf
    v_and_b32_dpp v104, v124, v10 row_newbcast:8 row_mask:0xf bank_mask:0xf
    v_and_b32_dpp v105, v124, v11 row_newbcast:8 row_mask:0xf bank_mask:0xf
    v_and_b32_dpp v106, v124, v12 row_newbcast:8 row_mask:0xf bank_mask:0xf
    v_and_b32_dpp v107, v124, v13 row_newbcast:8 row_mask:0xf bank_mask:0xf
    v_and_b32_dpp v108, v124, v10 row_newbcast:12 row_mask:0xf bank_mask:0xf
    v_and_b32_dpp v109, v124, v11 row_newbcast:12 row_mask:0xf bank_mask:0xf
    v_and_b32_dpp v110, v124, v12 row_newbcast:12 row_mask:0xf bank_mask:0xf
    v_and_b32_dpp v111, v124, v13 row_newbcast:12 row_mask:0xf bank_mask:0xf
    s_waitcnt vmcnt(7)
    buffer_load_dwordx4 v[144:147], v126, s[56:59], s85 offen offset:0 nt
    v_mfma_f32_16x16x32_bf16 v[116:119], v[176:179], v[96:99], v[116:119]
    s_waitcnt vmcnt(7)
    buffer_load_dwordx4 v[148:151], v127, s[56:59], s85 offen offset:0 nt
    v_mfma_f32_16x16x32_bf16 v[116:119], v[180:183], v[100:103], v[116:119]
    s_waitcnt vmcnt(7)
    buffer_load_dwordx4 v[152:155], v126, s[56:59], s85 offen offset:1024 nt
    v_mfma_f32_16x16x32_bf16 v[116:119], v[184:187], v[104:107], v[116:119]
    s_waitcnt vmcnt(7)
    buffer_load_dwordx4 v[156:159], v127, s[56:59], s85 offen offset:1024 nt
    v_mfma_f32_16x16x32_bf16 v[116:119], v[188:191], v[108:111], v[116:119]
    s_branch L_dloop
L_last1:
    buffer_load_dwordx4 v[224:227], v34, s[48:51], s46 offen sc1
    s_lshl_b32 s39, s34, 13
    s_add_u32 s39, s39, 98304
    s_mov_b32 m0, s39
    s_nop 0
    buffer_load_dwordx4 v20, s[40:43], s44 offen offset:0 nt lds
    v_mfma_f32_16x16x32_bf16 v[112:115], v[160:163], v[80:83], 0
    s_waitcnt vmcnt(8)
    buffer_load_dwordx4 v21, s[40:43], s44 offen offset:1024 nt lds
    v_mfma_f32_16x16x32_bf16 v[112:115], v[164:167], v[84:87], v[112:115]
    s_waitcnt vmcnt(8)
    buffer_load_dwordx4 v22, s[40:43], s44 offen offset:2048 nt lds
    v_mfma_f32_16x16x32_bf16 v[112:115], v[168:171], v[88:91], v[112:115]
    s_waitcnt vmcnt(8)
    buffer_load_dwordx4 v23, s[40:43], s44 offen offset:3072 nt lds
    v_mfma_f32_16x16x32_bf16 v[112:115], v[172:175], v[92:95], v[112:115]
    s_nop 7
    v_mov_b32_dpp v122, v112 quad_perm:[0,0,0,0] row_mask:0xf bank_mask:0xf
    v_mov_b32_dpp v124, v114 quad_perm:[2,2,2,2] row_mask:0xf bank_mask:0xf
    s_nop 0
    v_add_f32_dpp v122, v113, v122 quad_perm:[1,1,1,1] row_mask:0xf bank_mask:0xf
    v_add_f32_dpp v124, v115, v124 quad_perm:[3,3,3,3] row_mask:0xf bank_mask:0xf
    v_add_f32 v122, v122, v124
    v_fma_f32 v123, v122, s83, -v120
    v_cmp_lt_f32 vcc, 0, v123
    s_cbranch_vccz L_nomax_10
    v_mul_f32 v122, s83, v122
    s_nop 1
    v_max_f32_dpp v124, v122, v122 row_ror:4 row_mask:0xf bank_mask:0xf
    s_nop 1
    v_max_f32_dpp v124, v124, v124 row_ror:8 row_mask:0xf bank_mask:0xf
    v_mov_b32 v125, v124
    s_nop 1
    v_permlane16_swap_b32 v124, v125
    v_max_f32 v124, v124, v125
    v_mov_b32 v125, v124
    s_nop 1
    v_permlane32_swap_b32 v124, v125
    v_max_f32 v124, v124, v125
    v_max_f32 v124, v124, v120
    v_sub_f32 v125, v120, v124
    v_exp_f32 v125, v125
    v_mov_b32 v120, v124
    v_sub_f32 v123, v122, v124
    v_mul_f32 v121, v121, v125
    v_mul_f32 v116, v116, v125
    v_mul_f32 v117, v117, v125
    v_mul_f32 v118, v118, v125
    v_mul_f32 v119, v119, v125
L_nomax_10:
    v_exp_f32 v123, v123
    s_nop 0
    v_cvt_pk_bf16_f32 v124, v123, v123
    v_add_f32 v121, v121, v123
    s_nop 0
    v_and_b32_dpp v96, v124, v10 row_newbcast:0 row_mask:0xf bank_mask:0xf
    v_and_b32_dpp v97, v124, v11 row_newbcast:0 row_mask:0xf bank_mask:0xf
    v_and_b32_dpp v98, v124, v12 row_newbcast:0 row_mask:0xf bank_mask:0xf
    v_and_b32_dpp v99, v124, v13 row_newbcast:0 row_mask:0xf bank_mask:0xf
    v_and_b32_dpp v100, v124, v10 row_newbcast:4 row_mask:0xf bank_mask:0xf
    v_and_b32_dpp v101, v124, v11 row_newbcast:4 row_mask:0xf bank_mask:0xf
    v_and_b32_dpp v102, v124, v12 row_newbcast:4 row_mask:0xf bank_mask:0xf
    v_and_b32_dpp v103, v124, v13 row_newbcast:4 row_mask:0xf bank_mask:0xf
    v_and_b32_dpp v104, v124, v10 row_newbcast:8 row_mask:0xf bank_mask:0xf
    v_and_b32_dpp v105, v124, v11 row_newbcast:8 row_mask:0xf bank_mask:0xf
    v_and_b32_dpp v106, v124, v12 row_newbcast:8 row_mask:0xf bank_mask:0xf
    v_and_b32_dpp v107, v124, v13 row_newbcast:8 row_mask:0xf bank_mask:0xf
    v_and_b32_dpp v108, v124, v10 row_newbcast:12 row_mask:0xf bank_mask:0xf
    v_and_b32_dpp v109, v124, v11 row_newbcast:12 row_mask:0xf bank_mask:0xf
    v_and_b32_dpp v110, v124, v12 row_newbcast:12 row_mask:0xf bank_mask:0xf
    v_and_b32_dpp v111, v124, v13 row_newbcast:12 row_mask:0xf bank_mask:0xf
    s_waitcnt vmcnt(8)
    s_lshl_b32 s39, s34, 13
    s_add_u32 s39, s39, 102400
    s_mov_b32 m0, s39
    s_add_u32 s44, s44, 16384
    buffer_load_dwordx4 v20, s[40:43], s44 offen offset:0 nt lds
    v_mfma_f32_16x16x32_bf16 v[116:119], v[176:179], v[96:99], v[116:119]
    v_add_f32_dpp v121, v121, v121 row_ror:8 row_mask:0xf bank_mask:0xf
    s_nop 1
    v_add_f32_dpp v121, v121, v121 row_ror:4 row_mask:0xf bank_mask:0xf
    v_mov_b32 v125, v121
    s_nop 1
    v_permlane16_swap_b32 v121, v125
    v_add_f32 v121, v121, v125
    v_mov_b32 v125, v121
    s_nop 1
    v_permlane32_swap_b32 v121, v125
    v_add_f32 v121, v121, v125
    v_and_b32 v125, s82, v120
    v_sub_f32 v125, v120, v125
    s_mov_b32 vcc_lo, 0xff00ff00
    s_mov_b32 vcc_hi, 0xff00ff00
    s_waitcnt vmcnt(8)
    buffer_load_dwordx4 v21, s[40:43], s44 offen offset:1024 nt lds
    v_mfma_f32_16x16x32_bf16 v[116:119], v[180:183], v[100:103], v[116:119]
    s_waitcnt vmcnt(8)
    buffer_load_dwordx4 v22, s[40:43], s44 offen offset:2048 nt lds
    v_mfma_f32_16x16x32_bf16 v[116:119], v[184:187], v[104:107], v[116:119]
    s_waitcnt vmcnt(8)
    buffer_load_dwordx4 v23, s[40:43], s44 offen offset:3072 nt lds
    v_mfma_f32_16x16x32_bf16 v[116:119], v[188:191], v[108:111], v[116:119]
    s_branch L_bdone
L_last0:
    buffer_load_dwordx4 v[224:227], v34, s[48:51], s46 offen sc1
    s_lshl_b32 s39, s34, 13
    s_add_u32 s39, s39, 98304
    s_mov_b32 m0, s39
    s_nop 0
    buffer_load_dwordx4 v20, s[40:43], s44 offen offset:0 nt lds
    v_mfma_f32_16x16x32_bf16 v[112:115], v[128:131], v[80:83], 0
    s_waitcnt vmcnt(8)
    buffer_load_dwordx4 v21, s[40:43], s44 offen offset:1024 nt lds
    v_mfma_f32_16x16x32_bf16 v[112:115], v[132:135], v[84:87], v[112:115]
    s_waitcnt vmcnt(8)
    buffer_load_dwordx4 v22, s[40:43], s44 offen offset:2048 nt lds
    v_mfma_f32_16x16x32_bf16 v[112:115], v[136:139], v[88:91], v[112:115]
    s_waitcnt vmcnt(8)
    buffer_load_dwordx4 v23, s[40:43], s44 offen offset:3072 nt lds
    v_mfma_f32_16x16x32_bf16 v[112:115], v[140:143], v[92:95], v[112:115]
    s_nop 7
    v_mov_b32_dpp v122, v112 quad_perm:[0,0,0,0] row_mask:0xf bank_mask:0xf
    v_mov_b32_dpp v124, v114 quad_perm:[2,2,2,2] row_mask:0xf bank_mask:0xf
    s_nop 0
    v_add_f32_dpp v122, v113, v122 quad_perm:[1,1,1,1] row_mask:0xf bank_mask:0xf
    v_add_f32_dpp v124, v115, v124 quad_perm:[3,3,3,3] row_mask:0xf bank_mask:0xf
    v_add_f32 v122, v122, v124
    v_fma_f32 v123, v122, s83, -v120
    v_cmp_lt_f32 vcc, 0, v123
    s_cbranch_vccz L_nomax_11
    v_mul_f32 v122, s83, v122
    s_nop 1
    v_max_f32_dpp v124, v122, v122 row_ror:4 row_mask:0xf bank_mask:0xf
    s_nop 1
    v_max_f32_dpp v124, v124, v124 row_ror:8 row_mask:0xf bank_mask:0xf
    v_mov_b32 v125, v124
    s_nop 1
    v_permlane16_swap_b32 v124, v125
    v_max_f32 v124, v124, v125
    v_mov_b32 v125, v124
    s_nop 1
    v_permlane32_swap_b32 v124, v125
    v_max_f32 v124, v124, v125
    v_max_f32 v124, v124, v120
    v_sub_f32 v125, v120, v124
    v_exp_f32 v125, v125
    v_mov_b32 v120, v124
    v_sub_f32 v123, v122, v124
    v_mul_f32 v121, v121, v125
    v_mul_f32 v116, v116, v125
    v_mul_f32 v117, v117, v125
    v_mul_f32 v118, v118, v125
    v_mul_f32 v119, v119, v125
L_nomax_11:
    v_exp_f32 v123, v123
    s_nop 0
    v_cvt_pk_bf16_f32 v124, v123, v123
    v_add_f32 v121, v121, v123
    s_nop 0
    v_and_b32_dpp v96, v124, v10 row_newbcast:0 row_mask:0xf bank_mask:0xf
    v_and_b32_dpp v97, v124, v11 row_newbcast:0 row_mask:0xf bank_mask:0xf
    v_and_b32_dpp v98, v124, v12 row_newbcast:0 row_mask:0xf bank_mask:0xf
    v_and_b32_dpp v99, v124, v13 row_newbcast:0 row_mask:0xf bank_mask:0xf
    v_and_b32_dpp v100, v124, v10 row_newbcast:4 row_mask:0xf bank_mask:0xf
    v_and_b32_dpp v101, v124, v11 row_newbcast:4 row_mask:0xf bank_mask:0xf
    v_and_b32_dpp v102, v124, v12 row_newbcast:4 row_mask:0xf bank_mask:0xf
    v_and_b32_dpp v103, v124, v13 row_newbcast:4 row_mask:0xf bank_mask:0xf
    v_and_b32_dpp v104, v124, v10 row_newbcast:8 row_mask:0xf bank_mask:0xf
    v_and_b32_dpp v105, v124, v11 row_newbcast:8 row_mask:0xf bank_mask:0xf
    v_and_b32_dpp v106, v124, v12 row_newbcast:8 row_mask:0xf bank_mask:0xf
    v_and_b32_dpp v107, v124, v13 row_newbcast:8 row_mask:0xf bank_mask:0xf
    v_and_b32_dpp v108, v124, v10 row_newbcast:12 row_mask:0xf bank_mask:0xf
    v_and_b32_dpp v109, v124, v11 row_newbcast:12 row_mask:0xf bank_mask:0xf
    v_and_b32_dpp v110, v124, v12 row_newbcast:12 row_mask:0xf bank_mask:0xf
    v_and_b32_dpp v111, v124, v13 row_newbcast:12 row_mask:0xf bank_mask:0xf
    s_waitcnt vmcnt(8)
    s_lshl_b32 s39, s34, 13
    s_add_u32 s39, s39, 102400
    s_mov_b32 m0, s39
    s_add_u32 s44, s44, 16384
    buffer_load_dwordx4 v20, s[40:43], s44 offen offset:0 nt lds
    v_mfma_f32_16x16x32_bf16 v[116:119], v[144:147], v[96:99], v[116:119]
    v_add_f32_dpp v121, v121, v121 row_ror:8 row_mask:0xf bank_mask:0xf
    s_nop 1
    v_add_f32_dpp v121, v121, v121 row_ror:4 row_mask:0xf bank_mask:0xf
    v_mov_b32 v125, v121
    s_nop 1
    v_permlane16_swap_b32 v121, v125
    v_add_f32 v121, v121, v125
    v_mov_b32 v125, v121
    s_nop 1
    v_permlane32_swap_b32 v121, v125
    v_add_f32 v121, v121, v125
    v_and_b32 v125, s82, v120
    v_sub_f32 v125, v120, v125
    s_mov_b32 vcc_lo, 0xff00ff00
    s_mov_b32 vcc_hi, 0xff00ff00
    s_waitcnt vmcnt(8)
    buffer_load_dwordx4 v21, s[40:43], s44 offen offset:1024 nt lds
    v_mfma_f32_16x16x32_bf16 v[116:119], v[148:151], v[100:103], v[116:119]
    s_waitcnt vmcnt(8)
    buffer_load_dwordx4 v22, s[40:43], s44 offen offset:2048 nt lds
    v_mfma_f32_16x16x32_bf16 v[116:119], v[152:155], v[104:107], v[116:119]
    s_waitcnt vmcnt(8)
    buffer_load_dwordx4 v23, s[40:43], s44 offen offset:3072 nt lds
    v_mfma_f32_16x16x32_bf16 v[116:119], v[156:159], v[108:111], v[116:119]
L_bdone:
    s_nop 7
    v_cndmask_b32 v116, v116, v120, vcc
    v_cndmask_b32 v117, v117, v121, vcc
    v_cndmask_b32 v118, v118, v125, vcc
    v_and_or_b32 v119, v119, s82, v8
    v_and_or_b32 v116, v116, s82, v8
    v_and_or_b32 v117, v117, s82, v8
    v_and_or_b32 v118, v118, s82, v8
    s_mov_b32 exec_lo, 0xff01ff
    s_mov_b32 exec_hi, 0xff00ff
    buffer_store_dwordx4 v[116:119], v79, s[48:51], s96 offen sc1
    s_mov_b64 exec, -1
    s_cmp_lt_u32 s33, 3
    s_cbranch_scc1 L_ctx
    s_mov_b32 s93, 0x7f
    s_bitset0_b32 s93, s33
    s_mov_b32 s86, 0
    s_and_b32 s86, s86, s93
    s_cselect_b32 s86, s86, s93
    s_ff1_i32_b32 s4, s86
    s_bitset0_b32 s86, s4
    s_lshl_b32 s36, s4, 10
    s_add_u32 s36, s36, s47
    buffer_load_dwordx4 v[192:195], v79, s[48:51], s36 offen sc1
    s_and_b32 s86, s86, s93
    s_cselect_b32 s86, s86, s93
    s_ff1_i32_b32 s5, s86
    s_bitset0_b32 s86, s5
    s_lshl_b32 s36, s5, 10
    s_add_u32 s36, s36, s47
    buffer_load_dwordx4 v[196:199], v79, s[48:51], s36 offen sc1
    s_and_b32 s86, s86, s93
    s_cselect_b32 s86, s86, s93
    s_ff1_i32_b32 s6, s86
    s_bitset0_b32 s86, s6
    s_lshl_b32 s36, s6, 10
    s_add_u32 s36, s36, s47
    buffer_load_dwordx4 v[200:203], v79, s[48:51], s36 offen sc1
    s_and_b32 s86, s86, s93
    s_cselect_b32 s86, s86, s93
    s_ff1_i32_b32 s7, s86
    s_bitset0_b32 s86, s7
    s_lshl_b32 s36, s7, 10
    s_add_u32 s36, s36, s47
    buffer_load_dwordx4 v[204:207], v79, s[48:51], s36 offen sc1
    v_xor_b32 v104, s35, v116
    v_xor_b32 v105, s35, v117
    v_xor_b32 v106, s35, v118
    v_xor_b32 v107, s35, v119
L_hop1poll:
    s_and_b32 s86, s86, s93
    s_cselect_b32 s86, s86, s93
    s_ff1_i32_b32 s8, s86
    s_bitset0_b32 s86, s8
    s_lshl_b32 s36, s8, 10
    s_add_u32 s36, s36, s47
    buffer_load_dwordx4 v[208:211], v79, s[48:51], s36 offen sc1
    s_waitcnt vmcnt(4)
    v_xor_b32 v192, s35, v192
    v_xor_b32 v193, s35, v193
    v_xor_b32 v194, s35, v194
    v_xor_b32 v195, s35, v195
    v_or_b32 v4, v192, v193
    v_or3_b32 v4, v4, v194, v195
    v_and_b32 v4, 0xff, v4
    v_cmp_ne_u32 vcc, 0, v4
    v_add_f32 v6, v192, v194
    v_max_f32 v5, v120, v6
    s_cbranch_vccnz L_mnext_12
    s_bitcmp1_b32 s93, s4
    s_cbranch_scc0 L_mnext_12
    v_sub_f32 v122, v120, v5
    v_sub_f32 v123, v6, v5
    v_exp_f32 v122, v122
    v_exp_f32 v123, v123
    v_mov_b32 v120, v5
    s_bitset0_b32 s93, s4
    v_mul_f32_dpp v105, v122, v105 row_newbcast:8 row_mask:0xf bank_mask:0xf
    v_mul_f32_dpp v104, v122, v104 row_newbcast:8 row_mask:0xf bank_mask:0xf
    v_mul_f32_dpp v106, v122, v106 row_newbcast:8 row_mask:0xf bank_mask:0xf
    v_mul_f32_dpp v107, v122, v107 row_newbcast:8 row_mask:0xf bank_mask:0xf
    v_fmac_f32_dpp v105, v123, v193 row_newbcast:8 row_mask:0xf bank_mask:0xf
    v_fmac_f32_dpp v104, v123, v192 row_newbcast:8 row_mask:0xf bank_mask:0xf
    v_fmac_f32_dpp v106, v123, v194 row_newbcast:8 row_mask:0xf bank_mask:0xf
    v_fmac_f32_dpp v107, v123, v195 row_newbcast:8 row_mask:0xf bank_mask:0xf
    s_cmp_eq_u32 s93, 0
    s_cbranch_scc1 L_hop1ok
L_mnext_12:
    s_and_b32 s86, s86, s93
    s_cselect_b32 s86, s86, s93
    s_ff1_i32_b32 s4, s86
    s_bitset0_b32 s86, s4
    s_lshl_b32 s36, s4, 10
    s_add_u32 s36, s36, s47
    buffer_load_dwordx4 v[192:195], v79, s[48:51], s36 offen sc1
    s_waitcnt vmcnt(4)
    v_xor_b32 v196, s35, v196
    v_xor_b32 v197, s35, v197
    v_xor_b32 v198, s35, v198
    v_xor_b32 v199, s35, v199
    v_or_b32 v4, v196, v197
    v_or3_b32 v4, v4, v198, v199
    v_and_b32 v4, 0xff, v4
    v_cmp_ne_u32 vcc, 0, v4
    v_add_f32 v6, v196, v198
    v_max_f32 v5, v120, v6
    s_cbranch_vccnz L_mnext_13
    s_bitcmp1_b32 s93, s5
    s_cbranch_scc0 L_mnext_13
    v_sub_f32 v122, v120, v5
    v_sub_f32 v123, v6, v5
    v_exp_f32 v122, v122
    v_exp_f32 v123, v123
    v_mov_b32 v120, v5
    s_bitset0_b32 s93, s5
    v_mul_f32_dpp v105, v122, v105 row_newbcast:8 row_mask:0xf bank_mask:0xf
    v_mul_f32_dpp v104, v122, v104 row_newbcast:8 row_mask:0xf bank_mask:0xf
    v_mul_f32_dpp v106, v122, v106 row_newbcast:8 row_mask:0xf bank_mask:0xf
    v_mul_f32_dpp v107, v122, v107 row_newbcast:8 row_mask:0xf bank_mask:0xf
    v_fmac_f32_dpp v105, v123, v197 row_newbcast:8 row_mask:0xf bank_mask:0xf
    v_fmac_f32_dpp v104, v123, v196 row_newbcast:8 row_mask:0xf bank_mask:0xf
    v_fmac_f32_dpp v106, v123, v198 row_newbcast:8 row_mask:0xf bank_mask:0xf
    v_fmac_f32_dpp v107, v123, v199 row_newbcast:8 row_mask:0xf bank_mask:0xf
    s_cmp_eq_u32 s93, 0
    s_cbranch_scc1 L_hop1ok
L_mnext_13:
    s_and_b32 s86, s86, s93
    s_cselect_b32 s86, s86, s93
    s_ff1_i32_b32 s5, s86
    s_bitset0_b32 s86, s5
    s_lshl_b32 s36, s5, 10
    s_add_u32 s36, s36, s47
    buffer_load_dwordx4 v[196:199], v79, s[48:51], s36 offen sc1
    s_waitcnt vmcnt(4)
    v_xor_b32 v200, s35, v200
    v_xor_b32 v201, s35, v201
    v_xor_b32 v202, s35, v202
    v_xor_b32 v203, s35, v203
    v_or_b32 v4, v200, v201
    v_or3_b32 v4, v4, v202, v203
    v_and_b32 v4, 0xff, v4
    v_cmp_ne_u32 vcc, 0, v4
    v_add_f32 v6, v200, v202
    v_max_f32 v5, v120, v6
    s_cbranch_vccnz L_mnext_14
    s_bitcmp1_b32 s93, s6
    s_cbranch_scc0 L_mnext_14
    v_sub_f32 v122, v120, v5
    v_sub_f32 v123, v6, v5
    v_exp_f32 v122, v122
    v_exp_f32 v123, v123
    v_mov_b32 v120, v5
    s_bitset0_b32 s93, s6
    v_mul_f32_dpp v105, v122, v105 row_newbcast:8 row_mask:0xf bank_mask:0xf
    v_mul_f32_dpp v104, v122, v104 row_newbcast:8 row_mask:0xf bank_mask:0xf
    v_mul_f32_dpp v106, v122, v106 row_newbcast:8 row_mask:0xf bank_mask:0xf
    v_mul_f32_dpp v107, v122, v107 row_newbcast:8 row_mask:0xf bank_mask:0xf
    v_fmac_f32_dpp v105, v123, v201 row_newbcast:8 row_mask:0xf bank_mask:0xf
    v_fmac_f32_dpp v104, v123, v200 row_newbcast:8 row_mask:0xf bank_mask:0xf
    v_fmac_f32_dpp v106, v123, v202 row_newbcast:8 row_mask:0xf bank_mask:0xf
    v_fmac_f32_dpp v107, v123, v203 row_newbcast:8 row_mask:0xf bank_mask:0xf
    s_cmp_eq_u32 s93, 0
    s_cbranch_scc1 L_hop1ok
L_mnext_14:
    s_and_b32 s86, s86, s93
    s_cselect_b32 s86, s86, s93
    s_ff1_i32_b32 s6, s86
    s_bitset0_b32 s86, s6
    s_lshl_b32 s36, s6, 10
    s_add_u32 s36, s36, s47
    buffer_load_dwordx4 v[200:203], v79, s[48:51], s36 offen sc1
    s_waitcnt vmcnt(4)
    v_xor_b32 v204, s35, v204
    v_xor_b32 v205, s35, v205
    v_xor_b32 v206, s35, v206
    v_xor_b32 v207, s35, v207
    v_or_b32 v4, v204, v205
    v_or3_b32 v4, v4, v206, v207
    v_and_b32 v4, 0xff, v4
    v_cmp_ne_u32 vcc, 0, v4
    v_add_f32 v6, v204, v206
    v_max_f32 v5, v120, v6
    s_cbranch_vccnz L_mnext_15
    s_bitcmp1_b32 s93, s7
    s_cbranch_scc0 L_mnext_15
    v_sub_f32 v122, v120, v5
    v_sub_f32 v123, v6, v5
    v_exp_f32 v122, v122
    v_exp_f32 v123, v123
    v_mov_b32 v120, v5
    s_bitset0_b32 s93, s7
    v_mul_f32_dpp v105, v122, v105 row_newbcast:8 row_mask:0xf bank_mask:0xf
    v_mul_f32_dpp v104, v122, v104 row_newbcast:8 row_mask:0xf bank_mask:0xf
    v_mul_f32_dpp v106, v122, v106 row_newbcast:8 row_mask:0xf bank_mask:0xf
    v_mul_f32_dpp v107, v122, v107 row_newbcast:8 row_mask:0xf bank_mask:0xf
    v_fmac_f32_dpp v105, v123, v205 row_newbcast:8 row_mask:0xf bank_mask:0xf
    v_fmac_f32_dpp v104, v123, v204 row_newbcast:8 row_mask:0xf bank_mask:0xf
    v_fmac_f32_dpp v106, v123, v206 row_newbcast:8 row_mask:0xf bank_mask:0xf
    v_fmac_f32_dpp v107, v123, v207 row_newbcast:8 row_mask:0xf bank_mask:0xf
    s_cmp_eq_u32 s93, 0
    s_cbranch_scc1 L_hop1ok
L_mnext_15:
    s_and_b32 s86, s86, s93
    s_cselect_b32 s86, s86, s93
    s_ff1_i32_b32 s7, s86
    s_bitset0_b32 s86, s7
    s_lshl_b32 s36, s7, 10
    s_add_u32 s36, s36, s47
    buffer_load_dwordx4 v[204:207], v79, s[48:51], s36 offen sc1
    s_waitcnt vmcnt(4)
    v_xor_b32 v208, s35, v208
    v_xor_b32 v209, s35, v209
    v_xor_b32 v210, s35, v210
    v_xor_b32 v211, s35, v211
    v_or_b32 v4, v208, v209
    v_or3_b32 v4, v4, v210, v211
    v_and_b32 v4, 0xff, v4
    v_cmp_ne_u32 vcc, 0, v4
    v_add_f32 v6, v208, v210
    v_max_f32 v5, v120, v6
    s_cbranch_vccnz L_mnext_16
    s_bitcmp1_b32 s93, s8
    s_cbranch_scc0 L_mnext_16
    v_sub_f32 v122, v120, v5
    v_sub_f32 v123, v6, v5
    v_exp_f32 v122, v122
    v_exp_f32 v123, v123
    v_mov_b32 v120, v5
    s_bitset0_b32 s93, s8
    v_mul_f32_dpp v105, v122, v105 row_newbcast:8 row_mask:0xf bank_mask:0xf
    v_mul_f32_dpp v104, v122, v104 row_newbcast:8 row_mask:0xf bank_mask:0xf
    v_mul_f32_dpp v106, v122, v106 row_newbcast:8 row_mask:0xf bank_mask:0xf
    v_mul_f32_dpp v107, v122, v107 row_newbcast:8 row_mask:0xf bank_mask:0xf
    v_fmac_f32_dpp v105, v123, v209 row_newbcast:8 row_mask:0xf bank_mask:0xf
    v_fmac_f32_dpp v104, v123, v208 row_newbcast:8 row_mask:0xf bank_mask:0xf
    v_fmac_f32_dpp v106, v123, v210 row_newbcast:8 row_mask:0xf bank_mask:0xf
    v_fmac_f32_dpp v107, v123, v211 row_newbcast:8 row_mask:0xf bank_mask:0xf
    s_cmp_eq_u32 s93, 0
    s_cbranch_scc1 L_hop1ok
L_mnext_16:
    s_sub_u32 s84, s84, 1
    s_cmp_lg_u32 s84, 0
    s_cbranch_scc1 L_hop1poll
    s_branch L_end
L_ctx:
    s_waitcnt vmcnt(1)
L_ctxcheck:
    v_xor_b32 v224, s35, v224
    v_xor_b32 v225, s35, v225
    v_xor_b32 v226, s35, v226
    v_xor_b32 v227, s35, v227
    v_or_b32 v4, v224, v225
    v_or3_b32 v4, v4, v226, v227
    v_and_b32 v4, 0xff, v4
    v_cmp_ne_u32 vcc, 0, v4
    s_cbranch_vccz L_ctxok
    buffer_load_dwordx4 v[224:227], v34, s[48:51], s46 offen sc1
    s_waitcnt vmcnt(0)
    s_sub_u32 s84, s84, 1
    s_cmp_lg_u32 s84, 0
    s_cbranch_scc1 L_ctxcheck
    s_branch L_end
L_ctxok:
    v_cvt_pk_bf16_f32 v224, v224, v225
    v_cvt_pk_bf16_f32 v225, v226, v227
    ds_write_b64 v35, v[224:225]
    s_branch L_final
L_hop1ok:
    v_rcp_f32 v122, v105
    s_nop 1
    v_mul_f32_dpp v104, v122, v104 row_newbcast:8 row_mask:0xf bank_mask:0xf
    v_mul_f32_dpp v105, v122, v105 row_newbcast:8 row_mask:0xf bank_mask:0xf
    v_mul_f32_dpp v106, v122, v106 row_newbcast:8 row_mask:0xf bank_mask:0xf
    v_mul_f32_dpp v107, v122, v107 row_newbcast:8 row_mask:0xf bank_mask:0xf
    v_cvt_pk_bf16_f32 v104, v104, v105
    v_cvt_pk_bf16_f32 v106, v106, v107
    s_mov_b32 exec_lo, 0xff00ff
    s_mov_b32 exec_hi, 0xff00ff
    ds_write_b16 v31, v104
    ds_write_b16_d16_hi v31, v104 offset:16
    ds_write_b16 v31, v106 offset:32
    ds_write_b16_d16_hi v31, v106 offset:48
    s_mov_b64 exec, -1
L_final:
    s_waitcnt lgkmcnt(0)
    s_barrier
    ds_read_b64_tr_b16 v[128:129], v24 offset:0
    ds_read_b64_tr_b16 v[130:131], v25 offset:1024
    ds_read_b128 v[160:163], v28 offset:0
    ds_read_b64_tr_b16 v[132:133], v24 offset:8192
    ds_read_b64_tr_b16 v[134:135], v25 offset:9216
    ds_read_b128 v[164:167], v28 offset:64
    ds_read_b64_tr_b16 v[136:137], v24 offset:16384
    ds_read_b64_tr_b16 v[138:139], v25 offset:17408
    ds_read_b128 v[168:171], v28 offset:128
    ds_read_b64_tr_b16 v[140:141], v24 offset:24576
    ds_read_b64_tr_b16 v[142:143], v25 offset:25600
    ds_read_b128 v[172:175], v28 offset:192
    ds_read_b64_tr_b16 v[144:145], v26 offset:0
    ds_read_b64_tr_b16 v[146:147], v27 offset:1024
    ds_read_b128 v[176:179], v29 offset:0
    s_waitcnt lgkmcnt(12)
    v_mfma_f32_16x16x32_bf16 v[112:115], v[128:131], v[160:163], 0
    ds_read_b64_tr_b16 v[148:149], v26 offset:8192
    ds_read_b64_tr_b16 v[150:151], v27 offset:9216
    ds_read_b128 v[180:183], v29 offset:64
    s_waitcnt lgkmcnt(12)
    v_mfma_f32_16x16x32_bf16 v[112:115], v[132:135], v[164:167], v[112:115]
    ds_read_b64_tr_b16 v[152:153], v26 offset:16384
    ds_read_b64_tr_b16 v[154:155], v27 offset:17408
    ds_read_b128 v[184:187], v29 offset:128
    s_waitcnt lgkmcnt(12)
    v_mfma_f32_16x16x32_bf16 v[112:115], v[136:139], v[168:171], v[112:115]
    ds_read_b64_tr_b16 v[156:157], v26 offset:24576
    ds_read_b64_tr_b16 v[158:159], v27 offset:25600
    ds_read_b128 v[188:191], v29 offset:192
    s_waitcnt lgkmcnt(12)
    v_mfma_f32_16x16x32_bf16 v[112:115], v[140:143], v[172:175], v[112:115]
    s_waitcnt lgkmcnt(9)
    v_mfma_f32_16x16x32_bf16 v[112:115], v[144:147], v[176:179], v[112:115]
    s_waitcnt lgkmcnt(6)
    v_mfma_f32_16x16x32_bf16 v[112:115], v[148:151], v[180:183], v[112:115]
    s_waitcnt lgkmcnt(3)
    v_mfma_f32_16x16x32_bf16 v[112:115], v[152:155], v[184:187], v[112:115]
    s_waitcnt lgkmcnt(0)
    v_mfma_f32_16x16x32_bf16 v[112:115], v[156:159], v[188:191], v[112:115]
    s_cmp_eq_u32 s33, 0
    s_cselect_b32 s36, 0, 262144
    s_cselect_b32 s39, 0, 1024
    s_add_u32 s36, s36, 524288
    s_add_u32 s37, s36, 4096
    s_mov_b32 exec_lo, 0xff00ff
    s_mov_b32 exec_hi, 0xff00ff
    s_nop 0
    v_and_or_b32 v112, v112, s82, v8
    v_and_or_b32 v113, v113, s82, v8
    v_and_or_b32 v114, v114, s82, v8
    v_and_or_b32 v115, v115, s82, v8
    buffer_store_dwordx4 v[112:115], v30, s[48:51], s45 offen sc1
    s_mov_b64 exec, -1
    s_sub_u32 s38, s33, 1
    s_cmp_lt_u32 s38, 6
    s_cbranch_scc1 L_done
L_hop2:
    buffer_load_dwordx4 v[224:227], v32, s[48:51], s36 offen sc1
    buffer_load_dwordx4 v[228:231], v32, s[48:51], s37 offen sc1
    s_waitcnt vmcnt(0)
    v_xor_b32 v224, s35, v224
    v_xor_b32 v225, s35, v225
    v_xor_b32 v226, s35, v226
    v_xor_b32 v227, s35, v227
    v_xor_b32 v228, s35, v228
    v_xor_b32 v229, s35, v229
    v_xor_b32 v230, s35, v230
    v_xor_b32 v231, s35, v231
    v_or_b32 v4, v224, v225
    v_or3_b32 v4, v4, v226, v227
    v_or3_b32 v4, v4, v228, v229
    v_or3_b32 v4, v4, v230, v231
    v_and_b32 v4, 0xff, v4
    v_cmp_ne_u32 vcc, 0, v4
    v_add_f32 v232, v224, v228
    v_add_f32 v233, v225, v229
    v_add_f32 v234, v226, v230
    v_add_f32 v235, v227, v231
    s_cbranch_vccz L_hop2ok
    s_sub_u32 s84, s84, 1
    s_cmp_lg_u32 s84, 0
    s_cbranch_scc1 L_hop2
    s_branch L_end
L_hop2ok:
    v_permlane16_swap_b32 v232, v233
    v_permlane16_swap_b32 v234, v235
    v_add_f32 v232, v232, v233
    v_add_f32 v234, v234, v235
    s_nop 1
    v_permlane32_swap_b32 v232, v234
    v_add_f32 v232, v232, v234
    s_nop 1
    v_add_f32_dpp v232, v232, v232 row_ror:8 row_mask:0xf bank_mask:0xf
    s_nop 1
    v_add_f32_dpp v232, v232, v232 row_ror:4 row_mask:0xf bank_mask:0xf
    v_cvt_pk_bf16_f32 v232, v232, v232
    s_mov_b32 exec_lo, 0xf000f
    s_mov_b32 exec_hi, 0xf000f
    buffer_store_short v232, v33, s[72:75], s39 offen
    s_or_b32 s36, s2, s34
    s_cmp_lg_u32 s36, 0
    s_cbranch_scc1 L_done
    v_mov_b32 v4, 0
    s_mov_b64 exec, 1
    buffer_store_dword v8, v4, s[48:51], 0 offen
L_done:
L_end:
    s_endpgm
L_qp:
    v_lshlrev_b32 v4, 18, v2
    v_lshl_add_u32 v14, v3, 4, v4
    v_lshrrev_b32 v5, 3, v3
    v_lshlrev_b32 v5, 10, v5
    v_lshl_add_u32 v15, v2, 6, v5
    s_cmp_eq_u32 s33, 0
    s_cselect_b32 s61, 3, 2
    s_xor_b32 s61, s61, s32
    s_lshl_b32 s86, s34, 8
    s_lshl_b32 s63, s34, 20
    s_lshl_b32 s38, s61, 8
    s_add_u32 s63, s63, s38
    s_mov_b32 s42, 4194304
    s_mov_b32 s43, 0x20000
    s_mov_b32 s46, 4096
    s_mov_b32 s47, 0x20000
    s_cmp_eq_u32 s33, 0
    s_waitcnt lgkmcnt(0)
    s_cselect_b64 s[40:41], s[22:23], s[8:9]
    s_cselect_b64 s[44:45], s[16:17], s[4:5]
    buffer_load_dwordx4 a[128:131], v14, s[40:43], s63 offen nt
    s_add_u32 s63, s63, 8192
    buffer_load_dwordx4 a[132:135], v14, s[40:43], s63 offen nt
    s_add_u32 s63, s63, 8192
    buffer_load_dwordx4 v[20:23], v15, s[44:47], s86 offen offset:0
    buffer_load_dwordx4 v[36:39], v15, s[44:47], s86 offen offset:2048
    buffer_load_dwordx4 a[136:139], v14, s[40:43], s63 offen nt
    s_add_u32 s63, s63, 8192
    buffer_load_dwordx4 a[140:143], v14, s[40:43], s63 offen nt
    s_add_u32 s63, s63, 8192
    buffer_load_dwordx4 a[144:147], v14, s[40:43], s63 offen nt
    s_add_u32 s63, s63, 8192
    buffer_load_dwordx4 a[148:151], v14, s[40:43], s63 offen nt
    s_add_u32 s63, s63, 8192
    buffer_load_dwordx4 a[152:155], v14, s[40:43], s63 offen nt
    s_add_u32 s63, s63, 8192
    buffer_load_dwordx4 a[156:159], v14, s[40:43], s63 offen nt
    s_add_u32 s63, s63, 8192
    s_load_dword s35, s[30:31], 0
    s_mov_b32 s48, s30
    s_and_b32 s49, s31, 0xffff
    s_mov_b32 s50, 8388608
    s_mov_b32 s51, 0x20000
    s_mov_b32 s82, 0xffffff00
    s_mov_b32 s83, 0x3e0293ee
    s_mov_b32 s84, 2097152
    v_and_b32 v4, 1, v1
    v_lshlrev_b32 v4, 4, v4
    v_mov_b32 v5, 0xffff
    v_lshlrev_b32 v4, v4, v5
    v_bfe_u32 v5, v1, 1, 2
    v_cmp_eq_u32 vcc, 0, v5
    s_nop 1
    v_cndmask_b32 v10, 0, v4, vcc
    v_cmp_eq_u32 vcc, 1, v5
    s_nop 1
    v_cndmask_b32 v11, 0, v4, vcc
    v_cmp_eq_u32 vcc, 2, v5
    s_nop 1
    v_cndmask_b32 v12, 0, v4, vcc
    v_cmp_eq_u32 vcc, 3, v5
    s_nop 1
    v_cndmask_b32 v13, 0, v4, vcc
    buffer_load_dwordx4 v[24:27], v15, s[44:47], s86 offen offset:16
    buffer_load_dwordx4 v[40:43], v15, s[44:47], s86 offen offset:2064
    buffer_load_dwordx4 v[28:31], v15, s[44:47], s86 offen offset:32
    buffer_load_dwordx4 v[44:47], v15, s[44:47], s86 offen offset:2080
    buffer_load_dwordx4 v[32:35], v15, s[44:47], s86 offen offset:48
    buffer_load_dwordx4 v[48:51], v15, s[44:47], s86 offen offset:2096
    s_lshl_b32 s38, s61, 10
    s_add_u32 s36, s38, 65536
    s_lshl_b32 s38, s34, 8
    s_add_u32 s36, s38, s36
    v_mov_b32 v19, 0
    s_cmp_eq_u32 s33, 0
    s_cselect_b32 s38, s36, 8388608
    s_mov_b64 exec, 1
    buffer_store_dword v19, v19, s[48:51], s38 offen sc1
    s_mov_b64 exec, -1
    s_mov_b32 s80, 0x01000100
    s_mov_b32 s81, 0x03020302
    s_waitcnt vmcnt(13)
    buffer_load_dwordx4 a[160:163], v14, s[40:43], s63 offen nt
    s_add_u32 s63, s63, 8192
    v_perm_b32 v4, v20, v20, s80
    v_perm_b32 v5, v36, v36, s80
    v_and_b32 v52, v4, v10
    v_and_b32 v53, v4, v11
    v_and_b32 v54, v4, v12
    v_and_b32 v55, v4, v13
    v_and_b32 v56, v5, v10
    v_and_b32 v57, v5, v11
    v_and_b32 v58, v5, v12
    v_and_b32 v59, v5, v13
    v_mfma_f32_16x16x32_bf16 v[60:63], a[128:131], v[52:55], 0
    s_nop 0
    v_mfma_f32_16x16x32_bf16 v[64:67], a[128:131], v[56:59], 0
    buffer_load_dwordx4 a[164:167], v14, s[40:43], s63 offen nt
    s_add_u32 s63, s63, 8192
    v_perm_b32 v4, v20, v20, s81
    v_perm_b32 v5, v36, v36, s81
    v_and_b32 v52, v4, v10
    v_and_b32 v53, v4, v11
    v_and_b32 v54, v4, v12
    v_and_b32 v55, v4, v13
    v_and_b32 v56, v5, v10
    v_and_b32 v57, v5, v11
    v_and_b32 v58, v5, v12
    v_and_b32 v59, v5, v13
    v_mfma_f32_16x16x32_bf16 v[60:63], a[132:135], v[52:55], v[60:63]
    s_nop 0
    v_mfma_f32_16x16x32_bf16 v[64:67], a[132:135], v[56:59], v[64:67]
    s_waitcnt vmcnt(14)
    buffer_load_dwordx4 a[168:171], v14, s[40:43], s63 offen nt
    s_add_u32 s63, s63, 8192
    v_perm_b32 v4, v21, v21, s80
    v_perm_b32 v5, v37, v37, s80
    v_and_b32 v52, v4, v10
    v_and_b32 v53, v4, v11
    v_and_b32 v54, v4, v12
    v_and_b32 v55, v4, v13
    v_and_b32 v56, v5, v10
    v_and_b32 v57, v5, v11
    v_and_b32 v58, v5, v12
    v_and_b32 v59, v5, v13
    v_mfma_f32_16x16x32_bf16 v[60:63], a[136:139], v[52:55], v[60:63]
    s_nop 0
    v_mfma_f32_16x16x32_bf16 v[64:67], a[136:139], v[56:59], v[64:67]
    s_waitcnt vmcnt(14)
    buffer_load_dwordx4 a[172:175], v14, s[40:43], s63 offen nt
    s_add_u32 s63, s63, 8192
    v_perm_b32 v4, v21, v21, s81
    v_perm_b32 v5, v37, v37, s81
    v_and_b32 v52, v4, v10
    v_and_b32 v53, v4, v11
    v_and_b32 v54, v4, v12
    v_and_b32 v55, v4, v13
    v_and_b32 v56, v5, v10
    v_and_b32 v57, v5, v11
    v_and_b32 v58, v5, v12
    v_and_b32 v59, v5, v13
    v_mfma_f32_16x16x32_bf16 v[60:63], a[140:143], v[52:55], v[60:63]
    s_nop 0
    v_mfma_f32_16x16x32_bf16 v[64:67], a[140:143], v[56:59], v[64:67]
    s_waitcnt vmcnt(14)
    buffer_load_dwordx4 a[176:179], v14, s[40:43], s63 offen nt
    s_add_u32 s63, s63, 8192
    v_lshrrev_b32 v4, 2, v3
    v_and_b32 v5, 3, v3
    v_lshlrev_b32 v76, 8, v4
    v_lshlrev_b32 v126, 8, v2
    v_lshl_add_u32 v76, v2, 6, v76
    v_lshl_add_u32 v76, v5, 4, v76
    v_lshl_add_u32 v126, v3, 4, v126
    v_xor_b32 v77, 32768, v76
    v_xor_b32 v127, 32768, v126
    s_add_u32 s3, s34, s33
    s_and_b32 s3, s3, 3
    s_lshl_b32 s89, s3, 5
    s_add_u32 s89, s89, s32
    s_lshl_b32 s89, s89, 20
    s_mul_i32 s88, s32, 8
    s_add_u32 s88, s88, s3
    s_lshl_b32 s87, s33, 0
    v_perm_b32 v4, v22, v22, s80
    v_perm_b32 v5, v38, v38, s80
    v_and_b32 v52, v4, v10
    v_and_b32 v53, v4, v11
    v_and_b32 v54, v4, v12
    v_and_b32 v55, v4, v13
    v_and_b32 v56, v5, v10
    v_and_b32 v57, v5, v11
    v_and_b32 v58, v5, v12
    v_and_b32 v59, v5, v13
    v_mfma_f32_16x16x32_bf16 v[60:63], a[144:147], v[52:55], v[60:63]
    s_nop 0
    v_mfma_f32_16x16x32_bf16 v[64:67], a[144:147], v[56:59], v[64:67]
    s_waitcnt vmcnt(14)
    buffer_load_dwordx4 a[180:183], v14, s[40:43], s63 offen nt
    s_add_u32 s63, s63, 8192
    v_perm_b32 v4, v22, v22, s81
    v_perm_b32 v5, v38, v38, s81
    v_and_b32 v52, v4, v10
    v_and_b32 v53, v4, v11
    v_and_b32 v54, v4, v12
    v_and_b32 v55, v4, v13
    v_and_b32 v56, v5, v10
    v_and_b32 v57, v5, v11
    v_and_b32 v58, v5, v12
    v_and_b32 v59, v5, v13
    v_mfma_f32_16x16x32_bf16 v[60:63], a[148:151], v[52:55], v[60:63]
    s_nop 0
    v_mfma_f32_16x16x32_bf16 v[64:67], a[148:151], v[56:59], v[64:67]
    s_waitcnt vmcnt(14)
    buffer_load_dwordx4 a[184:187], v14, s[40:43], s63 offen nt
    s_add_u32 s63, s63, 8192
    v_perm_b32 v4, v23, v23, s80
    v_perm_b32 v5, v39, v39, s80
    v_and_b32 v52, v4, v10
    v_and_b32 v53, v4, v11
    v_and_b32 v54, v4, v12
    v_and_b32 v55, v4, v13
    v_and_b32 v56, v5, v10
    v_and_b32 v57, v5, v11
    v_and_b32 v58, v5, v12
    v_and_b32 v59, v5, v13
    v_mfma_f32_16x16x32_bf16 v[60:63], a[152:155], v[52:55], v[60:63]
    s_nop 0
    v_mfma_f32_16x16x32_bf16 v[64:67], a[152:155], v[56:59], v[64:67]
    s_waitcnt vmcnt(14)
    buffer_load_dwordx4 a[188:191], v14, s[40:43], s63 offen nt
    s_add_u32 s63, s63, 8192
    v_perm_b32 v4, v23, v23, s81
    v_perm_b32 v5, v39, v39, s81
    v_and_b32 v52, v4, v10
    v_and_b32 v53, v4, v11
    v_and_b32 v54, v4, v12
    v_and_b32 v55, v4, v13
    v_and_b32 v56, v5, v10
    v_and_b32 v57, v5, v11
    v_and_b32 v58, v5, v12
    v_and_b32 v59, v5, v13
    v_mfma_f32_16x16x32_bf16 v[60:63], a[156:159], v[52:55], v[60:63]
    s_nop 0
    v_mfma_f32_16x16x32_bf16 v[64:67], a[156:159], v[56:59], v[64:67]
    s_waitcnt vmcnt(13)
    s_waitcnt vmcnt(7)
    buffer_load_dwordx4 a[192:195], v14, s[40:43], s63 offen nt
    s_add_u32 s63, s63, 8192
    s_mov_b32 s52, s18
    s_and_b32 s53, s19, 0xffff
    s_mov_b32 s54, 134217728
    s_mov_b32 s55, 0x20000
    s_mov_b32 s56, s20
    s_and_b32 s57, s21, 0xffff
    s_mov_b32 s58, 134217728
    s_mov_b32 s59, 0x20000
    v_perm_b32 v4, v24, v24, s80
    v_perm_b32 v5, v40, v40, s80
    v_and_b32 v52, v4, v10
    v_and_b32 v53, v4, v11
    v_and_b32 v54, v4, v12
    v_and_b32 v55, v4, v13
    v_and_b32 v56, v5, v10
    v_and_b32 v57, v5, v11
    v_and_b32 v58, v5, v12
    v_and_b32 v59, v5, v13
    v_mfma_f32_16x16x32_bf16 v[60:63], a[160:163], v[52:55], v[60:63]
    s_nop 0
    v_mfma_f32_16x16x32_bf16 v[64:67], a[160:163], v[56:59], v[64:67]
    s_waitcnt vmcnt(7)
    buffer_load_dwordx4 a[196:199], v14, s[40:43], s63 offen nt
    s_add_u32 s63, s63, 8192
    v_perm_b32 v4, v24, v24, s81
    v_perm_b32 v5, v40, v40, s81
    v_and_b32 v52, v4, v10
    v_and_b32 v53, v4, v11
    v_and_b32 v54, v4, v12
    v_and_b32 v55, v4, v13
    v_and_b32 v56, v5, v10
    v_and_b32 v57, v5, v11
    v_and_b32 v58, v5, v12
    v_and_b32 v59, v5, v13
    v_mfma_f32_16x16x32_bf16 v[60:63], a[164:167], v[52:55], v[60:63]
    s_nop 0
    v_mfma_f32_16x16x32_bf16 v[64:67], a[164:167], v[56:59], v[64:67]
    s_waitcnt vmcnt(7)
    buffer_load_dwordx4 a[200:203], v14, s[40:43], s63 offen nt
    s_add_u32 s63, s63, 8192
    v_perm_b32 v4, v25, v25, s80
    v_perm_b32 v5, v41, v41, s80
    v_and_b32 v52, v4, v10
    v_and_b32 v53, v4, v11
    v_and_b32 v54, v4, v12
    v_and_b32 v55, v4, v13
    v_and_b32 v56, v5, v10
    v_and_b32 v57, v5, v11
    v_and_b32 v58, v5, v12
    v_and_b32 v59, v5, v13
    v_mfma_f32_16x16x32_bf16 v[60:63], a[168:171], v[52:55], v[60:63]
    s_nop 0
    v_mfma_f32_16x16x32_bf16 v[64:67], a[168:171], v[56:59], v[64:67]
    s_waitcnt vmcnt(7)
    buffer_load_dwordx4 a[204:207], v14, s[40:43], s63 offen nt
    s_add_u32 s63, s63, 8192
    v_perm_b32 v4, v25, v25, s81
    v_perm_b32 v5, v41, v41, s81
    v_and_b32 v52, v4, v10
    v_and_b32 v53, v4, v11
    v_and_b32 v54, v4, v12
    v_and_b32 v55, v4, v13
    v_and_b32 v56, v5, v10
    v_and_b32 v57, v5, v11
    v_and_b32 v58, v5, v12
    v_and_b32 v59, v5, v13
    v_mfma_f32_16x16x32_bf16 v[60:63], a[172:175], v[52:55], v[60:63]
    s_nop 0
    v_mfma_f32_16x16x32_bf16 v[64:67], a[172:175], v[56:59], v[64:67]
    s_waitcnt vmcnt(7)
    buffer_load_dwordx4 a[208:211], v14, s[40:43], s63 offen nt
    s_add_u32 s63, s63, 8192
    v_mov_b32 v120, 0xff7f0000
    v_mov_b32 v121, 0
    v_mov_b32 v18, 1
    v_mov_b32 v116, 0
    v_mov_b32 v117, 0
    v_mov_b32 v118, 0
    v_mov_b32 v119, 0
    s_lshl_b32 s38, s32, 10
    s_add_u32 s96, s38, 65536
    s_lshl_b32 s38, s3, 8
    s_add_u32 s96, s38, s96
    v_mov_b32 v9, s96
    s_lshl_b32 s38, s32, 15
    s_add_u32 s96, s38, 1048576
    s_lshl_b32 s38, s3, 13
    s_add_u32 s96, s38, s96
    s_lshl_b32 s38, s33, 10
    s_add_u32 s96, s38, s96
    v_and_b32 v5, 3, v3
    v_lshlrev_b32 v78, 7, v2
    v_lshl_add_u32 v78, v5, 5, v78
    s_lshl_b32 s38, s32, 12
    s_add_u32 s91, s38, 262144
    s_lshl_b32 s38, s3, 9
    s_add_u32 s91, s38, s91
    v_lshlrev_b32 v4, 7, v2
    v_lshl_add_u32 v4, v3, 4, v4
    v_mov_b32 v5, 512
    v_cmp_gt_u32 vcc, 8, v3
    s_nop 1
    v_cndmask_b32 v79, v5, v4, vcc
    v_perm_b32 v4, v26, v26, s80
    v_perm_b32 v5, v42, v42, s80
    v_and_b32 v52, v4, v10
    v_and_b32 v53, v4, v11
    v_and_b32 v54, v4, v12
    v_and_b32 v55, v4, v13
    v_and_b32 v56, v5, v10
    v_and_b32 v57, v5, v11
    v_and_b32 v58, v5, v12
    v_and_b32 v59, v5, v13
    v_mfma_f32_16x16x32_bf16 v[60:63], a[176:179], v[52:55], v[60:63]
    s_nop 0
    v_mfma_f32_16x16x32_bf16 v[64:67], a[176:179], v[56:59], v[64:67]
    s_waitcnt vmcnt(7)
    buffer_load_dwordx4 a[212:215], v14, s[40:43], s63 offen nt
    s_add_u32 s63, s63, 8192
    v_perm_b32 v4, v26, v26, s81
    v_perm_b32 v5, v42, v42, s81
    v_and_b32 v52, v4, v10
    v_and_b32 v53, v4, v11
    v_and_b32 v54, v4, v12
    v_and_b32 v55, v4, v13
    v_and_b32 v56, v5, v10
    v_and_b32 v57, v5, v11
    v_and_b32 v58, v5, v12
    v_and_b32 v59, v5, v13
    v_mfma_f32_16x16x32_bf16 v[60:63], a[180:183], v[52:55], v[60:63]
    s_nop 0
    v_mfma_f32_16x16x32_bf16 v[64:67], a[180:183], v[56:59], v[64:67]
    s_waitcnt vmcnt(7)
    buffer_load_dwordx4 a[216:219], v14, s[40:43], s63 offen nt
    s_add_u32 s63, s63, 8192
    v_perm_b32 v4, v27, v27, s80
    v_perm_b32 v5, v43, v43, s80
    v_and_b32 v52, v4, v10
    v_and_b32 v53, v4, v11
    v_and_b32 v54, v4, v12
    v_and_b32 v55, v4, v13
    v_and_b32 v56, v5, v10
    v_and_b32 v57, v5, v11
    v_and_b32 v58, v5, v12
    v_and_b32 v59, v5, v13
    v_mfma_f32_16x16x32_bf16 v[60:63], a[184:187], v[52:55], v[60:63]
    s_nop 0
    v_mfma_f32_16x16x32_bf16 v[64:67], a[184:187], v[56:59], v[64:67]
    s_waitcnt vmcnt(7)
    buffer_load_dwordx4 a[220:223], v14, s[40:43], s63 offen nt
    s_add_u32 s63, s63, 8192
    v_perm_b32 v4, v27, v27, s81
    v_perm_b32 v5, v43, v43, s81
    v_and_b32 v52, v4, v10
    v_and_b32 v53, v4, v11
    v_and_b32 v54, v4, v12
    v_and_b32 v55, v4, v13
    v_and_b32 v56, v5, v10
    v_and_b32 v57, v5, v11
    v_and_b32 v58, v5, v12
    v_and_b32 v59, v5, v13
    v_mfma_f32_16x16x32_bf16 v[60:63], a[188:191], v[52:55], v[60:63]
    s_nop 0
    v_mfma_f32_16x16x32_bf16 v[64:67], a[188:191], v[56:59], v[64:67]
    s_waitcnt vmcnt(7)
    buffer_load_dwordx4 a[224:227], v14, s[40:43], s63 offen nt
    s_add_u32 s63, s63, 8192
    v_perm_b32 v4, v28, v28, s80
    v_perm_b32 v5, v44, v44, s80
    v_and_b32 v52, v4, v10
    v_and_b32 v53, v4, v11
    v_and_b32 v54, v4, v12
    v_and_b32 v55, v4, v13
    v_and_b32 v56, v5, v10
    v_and_b32 v57, v5, v11
    v_and_b32 v58, v5, v12
    v_and_b32 v59, v5, v13
    v_mfma_f32_16x16x32_bf16 v[60:63], a[192:195], v[52:55], v[60:63]
    s_nop 0
    v_mfma_f32_16x16x32_bf16 v[64:67], a[192:195], v[56:59], v[64:67]
    s_waitcnt vmcnt(7)
    buffer_load_dwordx4 a[228:231], v14, s[40:43], s63 offen nt
    s_add_u32 s63, s63, 8192
    v_perm_b32 v4, v28, v28, s81
    v_perm_b32 v5, v44, v44, s81
    v_and_b32 v52, v4, v10
    v_and_b32 v53, v4, v11
    v_and_b32 v54, v4, v12
    v_and_b32 v55, v4, v13
    v_and_b32 v56, v5, v10
    v_and_b32 v57, v5, v11
    v_and_b32 v58, v5, v12
    v_and_b32 v59, v5, v13
    v_mfma_f32_16x16x32_bf16 v[60:63], a[196:199], v[52:55], v[60:63]
    s_nop 0
    v_mfma_f32_16x16x32_bf16 v[64:67], a[196:199], v[56:59], v[64:67]
    s_waitcnt vmcnt(7)
    buffer_load_dwordx4 a[232:235], v14, s[40:43], s63 offen nt
    s_add_u32 s63, s63, 8192
    v_perm_b32 v4, v29, v29, s80
    v_perm_b32 v5, v45, v45, s80
    v_and_b32 v52, v4, v10
    v_and_b32 v53, v4, v11
    v_and_b32 v54, v4, v12
    v_and_b32 v55, v4, v13
    v_and_b32 v56, v5, v10
    v_and_b32 v57, v5, v11
    v_and_b32 v58, v5, v12
    v_and_b32 v59, v5, v13
    v_mfma_f32_16x16x32_bf16 v[60:63], a[200:203], v[52:55], v[60:63]
    s_nop 0
    v_mfma_f32_16x16x32_bf16 v[64:67], a[200:203], v[56:59], v[64:67]
    s_waitcnt vmcnt(7)
    buffer_load_dwordx4 a[236:239], v14, s[40:43], s63 offen nt
    s_add_u32 s63, s63, 8192
    v_perm_b32 v4, v29, v29, s81
    v_perm_b32 v5, v45, v45, s81
    v_and_b32 v52, v4, v10
    v_and_b32 v53, v4, v11
    v_and_b32 v54, v4, v12
    v_and_b32 v55, v4, v13
    v_and_b32 v56, v5, v10
    v_and_b32 v57, v5, v11
    v_and_b32 v58, v5, v12
    v_and_b32 v59, v5, v13
    v_mfma_f32_16x16x32_bf16 v[60:63], a[204:207], v[52:55], v[60:63]
    s_nop 0
    v_mfma_f32_16x16x32_bf16 v[64:67], a[204:207], v[56:59], v[64:67]
    s_waitcnt vmcnt(7)
    buffer_load_dwordx4 a[240:243], v14, s[40:43], s63 offen nt
    s_add_u32 s63, s63, 8192
    v_perm_b32 v4, v30, v30, s80
    v_perm_b32 v5, v46, v46, s80
    v_and_b32 v52, v4, v10
    v_and_b32 v53, v4, v11
    v_and_b32 v54, v4, v12
    v_and_b32 v55, v4, v13
    v_and_b32 v56, v5, v10
    v_and_b32 v57, v5, v11
    v_and_b32 v58, v5, v12
    v_and_b32 v59, v5, v13
    v_mfma_f32_16x16x32_bf16 v[60:63], a[208:211], v[52:55], v[60:63]
    s_nop 0
    v_mfma_f32_16x16x32_bf16 v[64:67], a[208:211], v[56:59], v[64:67]
    s_waitcnt vmcnt(7)
    buffer_load_dwordx4 a[244:247], v14, s[40:43], s63 offen nt
    s_add_u32 s63, s63, 8192
    v_perm_b32 v4, v30, v30, s81
    v_perm_b32 v5, v46, v46, s81
    v_and_b32 v52, v4, v10
    v_and_b32 v53, v4, v11
    v_and_b32 v54, v4, v12
    v_and_b32 v55, v4, v13
    v_and_b32 v56, v5, v10
    v_and_b32 v57, v5, v11
    v_and_b32 v58, v5, v12
    v_and_b32 v59, v5, v13
    v_mfma_f32_16x16x32_bf16 v[60:63], a[212:215], v[52:55], v[60:63]
    s_nop 0
    v_mfma_f32_16x16x32_bf16 v[64:67], a[212:215], v[56:59], v[64:67]
    s_waitcnt vmcnt(7)
    buffer_load_dwordx4 a[248:251], v14, s[40:43], s63 offen nt
    s_add_u32 s63, s63, 8192
    v_perm_b32 v4, v31, v31, s80
    v_perm_b32 v5, v47, v47, s80
    v_and_b32 v52, v4, v10
    v_and_b32 v53, v4, v11
    v_and_b32 v54, v4, v12
    v_and_b32 v55, v4, v13
    v_and_b32 v56, v5, v10
    v_and_b32 v57, v5, v11
    v_and_b32 v58, v5, v12
    v_and_b32 v59, v5, v13
    v_mfma_f32_16x16x32_bf16 v[60:63], a[216:219], v[52:55], v[60:63]
    s_nop 0
    v_mfma_f32_16x16x32_bf16 v[64:67], a[216:219], v[56:59], v[64:67]
    s_waitcnt vmcnt(7)
    buffer_load_dwordx4 a[252:255], v14, s[40:43], s63 offen nt
    s_add_u32 s63, s63, 8192
    v_perm_b32 v4, v31, v31, s81
    v_perm_b32 v5, v47, v47, s81
    v_and_b32 v52, v4, v10
    v_and_b32 v53, v4, v11
    v_and_b32 v54, v4, v12
    v_and_b32 v55, v4, v13
    v_and_b32 v56, v5, v10
    v_and_b32 v57, v5, v11
    v_and_b32 v58, v5, v12
    v_and_b32 v59, v5, v13
    v_mfma_f32_16x16x32_bf16 v[60:63], a[220:223], v[52:55], v[60:63]
    s_nop 0
    v_mfma_f32_16x16x32_bf16 v[64:67], a[220:223], v[56:59], v[64:67]
    s_waitcnt vmcnt(7)
    v_perm_b32 v4, v32, v32, s80
    v_perm_b32 v5, v48, v48, s80
    v_and_b32 v52, v4, v10
    v_and_b32 v53, v4, v11
    v_and_b32 v54, v4, v12
    v_and_b32 v55, v4, v13
    v_and_b32 v56, v5, v10
    v_and_b32 v57, v5, v11
    v_and_b32 v58, v5, v12
    v_and_b32 v59, v5, v13
    v_mfma_f32_16x16x32_bf16 v[60:63], a[224:227], v[52:55], v[60:63]
    s_nop 0
    v_mfma_f32_16x16x32_bf16 v[64:67], a[224:227], v[56:59], v[64:67]
    s_waitcnt vmcnt(6)
    s_add_u32 s39, s87, s88
    s_bfe_u32 s37, s39, 0x30000
    s_lshl_b32 s37, s37, 12
    s_add_u32 s85, s37, s89
    s_bfe_u32 s37, s39, 0x10003
    s_lshl_b32 s37, s37, 11
    s_add_u32 s85, s37, s85
    s_bfe_u32 s37, s39, 0x40004
    s_lshl_b32 s37, s37, 16
    s_add_u32 s85, s37, s85
    buffer_load_dwordx4 v[128:131], v76, s[52:55], s85 offen offset:0 nt
    v_perm_b32 v4, v32, v32, s81
    v_perm_b32 v5, v48, v48, s81
    v_and_b32 v52, v4, v10
    v_and_b32 v53, v4, v11
    v_and_b32 v54, v4, v12
    v_and_b32 v55, v4, v13
    v_and_b32 v56, v5, v10
    v_and_b32 v57, v5, v11
    v_and_b32 v58, v5, v12
    v_and_b32 v59, v5, v13
    v_mfma_f32_16x16x32_bf16 v[60:63], a[228:231], v[52:55], v[60:63]
    s_nop 0
    v_mfma_f32_16x16x32_bf16 v[64:67], a[228:231], v[56:59], v[64:67]
    s_waitcnt vmcnt(6)
    buffer_load_dwordx4 v[132:135], v77, s[52:55], s85 offen offset:0 nt
    v_perm_b32 v4, v33, v33, s80
    v_perm_b32 v5, v49, v49, s80
    v_and_b32 v52, v4, v10
    v_and_b32 v53, v4, v11
    v_and_b32 v54, v4, v12
    v_and_b32 v55, v4, v13
    v_and_b32 v56, v5, v10
    v_and_b32 v57, v5, v11
    v_and_b32 v58, v5, v12
    v_and_b32 v59, v5, v13
    v_mfma_f32_16x16x32_bf16 v[60:63], a[232:235], v[52:55], v[60:63]
    s_nop 0
    v_mfma_f32_16x16x32_bf16 v[64:67], a[232:235], v[56:59], v[64:67]
    s_waitcnt vmcnt(6)
    buffer_load_dwordx4 v[136:139], v76, s[52:55], s85 offen offset:1024 nt
    v_perm_b32 v4, v33, v33, s81
    v_perm_b32 v5, v49, v49, s81
    v_and_b32 v52, v4, v10
    v_and_b32 v53, v4, v11
    v_and_b32 v54, v4, v12
    v_and_b32 v55, v4, v13
    v_and_b32 v56, v5, v10
    v_and_b32 v57, v5, v11
    v_and_b32 v58, v5, v12
    v_and_b32 v59, v5, v13
    v_mfma_f32_16x16x32_bf16 v[60:63], a[236:239], v[52:55], v[60:63]
    s_nop 0
    v_mfma_f32_16x16x32_bf16 v[64:67], a[236:239], v[56:59], v[64:67]
    s_waitcnt vmcnt(6)
    buffer_load_dwordx4 v[140:143], v77, s[52:55], s85 offen offset:1024 nt
    s_add_u32 s87, s87, 7
    s_add_u32 s39, s87, s88
    s_bfe_u32 s37, s39, 0x30000
    s_lshl_b32 s37, s37, 12
    s_add_u32 s85, s37, s89
    s_bfe_u32 s37, s39, 0x10003
    s_lshl_b32 s37, s37, 11
    s_add_u32 s85, s37, s85
    s_bfe_u32 s37, s39, 0x40004
    s_lshl_b32 s37, s37, 16
    s_add_u32 s85, s37, s85
    v_perm_b32 v4, v34, v34, s80
    v_perm_b32 v5, v50, v50, s80
    v_and_b32 v52, v4, v10
    v_and_b32 v53, v4, v11
    v_and_b32 v54, v4, v12
    v_and_b32 v55, v4, v13
    v_and_b32 v56, v5, v10
    v_and_b32 v57, v5, v11
    v_and_b32 v58, v5, v12
    v_and_b32 v59, v5, v13
    v_mfma_f32_16x16x32_bf16 v[60:63], a[240:243], v[52:55], v[60:63]
    s_nop 0
    v_mfma_f32_16x16x32_bf16 v[64:67], a[240:243], v[56:59], v[64:67]
    s_waitcnt vmcnt(6)
    buffer_load_dwordx4 v[144:147], v76, s[52:55], s85 offen offset:0 nt
    v_perm_b32 v4, v34, v34, s81
    v_perm_b32 v5, v50, v50, s81
    v_and_b32 v52, v4, v10
    v_and_b32 v53, v4, v11
    v_and_b32 v54, v4, v12
    v_and_b32 v55, v4, v13
    v_and_b32 v56, v5, v10
    v_and_b32 v57, v5, v11
    v_and_b32 v58, v5, v12
    v_and_b32 v59, v5, v13
    v_mfma_f32_16x16x32_bf16 v[60:63], a[244:247], v[52:55], v[60:63]
    s_nop 0
    v_mfma_f32_16x16x32_bf16 v[64:67], a[244:247], v[56:59], v[64:67]
    s_waitcnt vmcnt(6)
    buffer_load_dwordx4 v[148:151], v77, s[52:55], s85 offen offset:0 nt
    v_perm_b32 v4, v35, v35, s80
    v_perm_b32 v5, v51, v51, s80
    v_and_b32 v52, v4, v10
    v_and_b32 v53, v4, v11
    v_and_b32 v54, v4, v12
    v_and_b32 v55, v4, v13
    v_and_b32 v56, v5, v10
    v_and_b32 v57, v5, v11
    v_and_b32 v58, v5, v12
    v_and_b32 v59, v5, v13
    v_mfma_f32_16x16x32_bf16 v[60:63], a[248:251], v[52:55], v[60:63]
    s_nop 0
    v_mfma_f32_16x16x32_bf16 v[64:67], a[248:251], v[56:59], v[64:67]
    s_waitcnt vmcnt(6)
    buffer_load_dwordx4 v[152:155], v76, s[52:55], s85 offen offset:1024 nt
    v_perm_b32 v4, v35, v35, s81
    v_perm_b32 v5, v51, v51, s81
    v_and_b32 v52, v4, v10
    v_and_b32 v53, v4, v11
    v_and_b32 v54, v4, v12
    v_and_b32 v55, v4, v13
    v_and_b32 v56, v5, v10
    v_and_b32 v57, v5, v11
    v_and_b32 v58, v5, v12
    v_and_b32 v59, v5, v13
    v_mfma_f32_16x16x32_bf16 v[60:63], a[252:255], v[52:55], v[60:63]
    s_nop 0
    v_mfma_f32_16x16x32_bf16 v[64:67], a[252:255], v[56:59], v[64:67]
    s_lshl_b32 s38, s34, 11
    v_lshrrev_b32 v4, 3, v3
    v_lshlrev_b32 v4, 9, v4
    v_lshl_add_u32 v4, v2, 7, v4
    v_and_b32 v5, 7, v3
    v_lshl_add_u32 v4, v5, 2, v4
    v_add_u32 v4, s38, v4
    ds_write_b32 v4, v60 offset:0
    ds_write_b32 v4, v61 offset:32
    ds_write_b32 v4, v62 offset:64
    ds_write_b32 v4, v63 offset:96
    ds_write_b32 v4, v64 offset:1024
    ds_write_b32 v4, v65 offset:1056
    ds_write_b32 v4, v66 offset:1088
    ds_write_b32 v4, v67 offset:1120
    s_lshl_b32 s38, s34, 9
    v_and_b32 v5, 31, v1
    v_lshl_add_u32 v5, v5, 4, s38
    s_waitcnt lgkmcnt(0)
    s_add_u32 s35, s35, 0x5b
    s_and_b32 s35, s35, 0xff
    v_mov_b32 v8, s35
    s_barrier
    ds_read_b128 v[20:23], v5 offset:0
    ds_read_b128 v[24:27], v5 offset:2048
    ds_read_b128 v[28:31], v5 offset:4096
    ds_read_b128 v[32:35], v5 offset:6144
    s_lshl_b32 s38, s61, 12
    s_add_u32 s36, s38, 262144
    s_lshl_b32 s38, s33, 11
    s_add_u32 s36, s38, s36
    s_waitcnt lgkmcnt(0)
    v_add_f32 v20, v20, v24
    v_add_f32 v28, v28, v32
    v_add_f32 v21, v21, v25
    v_add_f32 v29, v29, v33
    v_add_f32 v22, v22, v26
    v_add_f32 v30, v30, v34
    v_add_f32 v23, v23, v27
    v_add_f32 v31, v31, v35
    v_add_f32 v20, v20, v28
    v_add_f32 v21, v21, v29
    v_add_f32 v22, v22, v30
    v_add_f32 v23, v23, v31
    s_mov_b32 s38, 0xffff0000
    v_cvt_pk_bf16_f32 v20, v20, v20
    v_cvt_pk_bf16_f32 v21, v21, v21
    v_cvt_pk_bf16_f32 v22, v22, v22
    v_cvt_pk_bf16_f32 v23, v23, v23
    v_and_or_b32 v20, v20, s38, v8
    v_and_or_b32 v21, v21, s38, v8
    v_and_or_b32 v22, v22, s38, v8
    v_and_or_b32 v23, v23, s38, v8
    s_mov_b32 exec_lo, 0xffffffff
    s_mov_b32 exec_hi, 0x0
    buffer_store_dwordx4 v[20:23], v5, s[48:51], s36 offen sc1
    s_mov_b64 exec, -1
    s_waitcnt vmcnt(7)
    buffer_load_dwordx4 v[156:159], v77, s[52:55], s85 offen offset:1024 nt
    s_add_u32 s87, s87, 7
    s_add_u32 s39, s87, s88
    s_bfe_u32 s37, s39, 0x30000
    s_lshl_b32 s37, s37, 12
    s_add_u32 s85, s37, s89
    s_bfe_u32 s37, s39, 0x10003
    s_lshl_b32 s37, s37, 11
    s_add_u32 s85, s37, s85
    s_bfe_u32 s37, s39, 0x40004
    s_lshl_b32 s37, s37, 16
    s_add_u32 s85, s37, s85
    s_waitcnt vmcnt(7)
    buffer_load_dwordx4 v[160:163], v76, s[52:55], s85 offen offset:0 nt
    s_waitcnt vmcnt(7)
    buffer_load_dwordx4 v[164:167], v77, s[52:55], s85 offen offset:0 nt
    s_waitcnt vmcnt(7)
    buffer_load_dwordx4 v[168:171], v76, s[52:55], s85 offen offset:1024 nt
    s_waitcnt vmcnt(7)
    buffer_load_dwordx4 v[172:175], v77, s[52:55], s85 offen offset:1024 nt
    s_add_u32 s87, s87, 7
    s_add_u32 s39, s87, s88
    s_bfe_u32 s37, s39, 0x30000
    s_lshl_b32 s37, s37, 12
    s_add_u32 s85, s37, s89
    s_bfe_u32 s37, s39, 0x10003
    s_lshl_b32 s37, s37, 11
    s_add_u32 s85, s37, s85
    s_bfe_u32 s37, s39, 0x40004
    s_lshl_b32 s37, s37, 16
    s_add_u32 s85, s37, s85
    s_waitcnt vmcnt(7)
    buffer_load_dwordx4 v[176:179], v76, s[52:55], s85 offen offset:0 nt
    s_waitcnt vmcnt(7)
    buffer_load_dwordx4 v[180:183], v77, s[52:55], s85 offen offset:0 nt
    s_waitcnt vmcnt(6)
    buffer_load_dwordx4 v[184:187], v76, s[52:55], s85 offen offset:1024 nt
    s_waitcnt vmcnt(6)
    buffer_load_dwordx4 v[188:191], v77, s[52:55], s85 offen offset:1024 nt
    s_add_u32 s87, s87, 7
    s_add_u32 s39, s87, s88
    s_bfe_u32 s37, s39, 0x30000
    s_lshl_b32 s37, s37, 12
    s_add_u32 s85, s37, s89
    s_bfe_u32 s37, s39, 0x10003
    s_lshl_b32 s37, s37, 11
    s_add_u32 s85, s37, s85
    s_bfe_u32 s37, s39, 0x40004
    s_lshl_b32 s37, s37, 16
    s_add_u32 s85, s37, s85
    s_waitcnt vmcnt(6)
    buffer_load_dwordx4 v[192:195], v76, s[52:55], s85 offen offset:0 nt
    s_waitcnt vmcnt(6)
    buffer_load_dwordx4 v[196:199], v77, s[52:55], s85 offen offset:0 nt
    s_waitcnt vmcnt(6)
    buffer_load_dwordx4 v[200:203], v76, s[52:55], s85 offen offset:1024 nt
    s_waitcnt vmcnt(6)
    buffer_load_dwordx4 v[204:207], v77, s[52:55], s85 offen offset:1024 nt
    s_add_u32 s87, s87, 7
    s_add_u32 s39, s87, s88
    s_bfe_u32 s37, s39, 0x30000
    s_lshl_b32 s37, s37, 12
    s_add_u32 s85, s37, s89
    s_bfe_u32 s37, s39, 0x10003
    s_lshl_b32 s37, s37, 11
    s_add_u32 s85, s37, s85
    s_bfe_u32 s37, s39, 0x40004
    s_lshl_b32 s37, s37, 16
    s_add_u32 s85, s37, s85
    s_waitcnt vmcnt(6)
    buffer_load_dwordx4 v[208:211], v76, s[52:55], s85 offen offset:0 nt
    s_waitcnt vmcnt(6)
    buffer_load_dwordx4 v[212:215], v77, s[52:55], s85 offen offset:0 nt
    s_waitcnt vmcnt(6)
    buffer_load_dwordx4 v[216:219], v76, s[52:55], s85 offen offset:1024 nt
    s_waitcnt vmcnt(6)
    buffer_load_dwordx4 v[220:223], v77, s[52:55], s85 offen offset:1024 nt
    s_add_u32 s87, s87, 7
    s_add_u32 s39, s87, s88
    s_bfe_u32 s37, s39, 0x30000
    s_lshl_b32 s37, s37, 12
    s_add_u32 s85, s37, s89
    s_bfe_u32 s37, s39, 0x10003
    s_lshl_b32 s37, s37, 11
    s_add_u32 s85, s37, s85
    s_bfe_u32 s37, s39, 0x40004
    s_lshl_b32 s37, s37, 16
    s_add_u32 s85, s37, s85
    s_waitcnt vmcnt(6)
    buffer_load_dwordx4 v[224:227], v76, s[52:55], s85 offen offset:0 nt
    s_waitcnt vmcnt(6)
    buffer_load_dwordx4 v[228:231], v77, s[52:55], s85 offen offset:0 nt
    s_waitcnt vmcnt(6)
    buffer_load_dwordx4 v[232:235], v76, s[52:55], s85 offen offset:1024 nt
    s_waitcnt vmcnt(6)
    buffer_load_dwordx4 v[236:239], v77, s[52:55], s85 offen offset:1024 nt
    s_add_u32 s87, s87, 7
    s_add_u32 s39, s87, s88
    s_bfe_u32 s37, s39, 0x30000
    s_lshl_b32 s37, s37, 12
    s_add_u32 s85, s37, s89
    s_bfe_u32 s37, s39, 0x10003
    s_lshl_b32 s37, s37, 11
    s_add_u32 s85, s37, s85
    s_bfe_u32 s37, s39, 0x40004
    s_lshl_b32 s37, s37, 16
    s_add_u32 s85, s37, s85
    s_waitcnt vmcnt(6)
    buffer_load_dwordx4 v[240:243], v76, s[52:55], s85 offen offset:0 nt
    s_waitcnt vmcnt(6)
    buffer_load_dwordx4 v[244:247], v77, s[52:55], s85 offen offset:0 nt
    s_waitcnt vmcnt(6)
    buffer_load_dwordx4 v[248:251], v76, s[52:55], s85 offen offset:1024 nt
    s_waitcnt vmcnt(6)
    buffer_load_dwordx4 v[252:255], v77, s[52:55], s85 offen offset:1024 nt
    s_add_u32 s87, s87, 7
    s_add_u32 s39, s87, s88
    s_bfe_u32 s37, s39, 0x30000
    s_lshl_b32 s37, s37, 12
    s_add_u32 s85, s37, s89
    s_bfe_u32 s37, s39, 0x10003
    s_lshl_b32 s37, s37, 11
    s_add_u32 s85, s37, s85
    s_bfe_u32 s37, s39, 0x40004
    s_lshl_b32 s37, s37, 16
    s_add_u32 s85, s37, s85
    s_waitcnt vmcnt(6)
    buffer_load_dwordx4 a[0:3], v76, s[52:55], s85 offen offset:0 nt
    s_waitcnt vmcnt(6)
    buffer_load_dwordx4 a[4:7], v77, s[52:55], s85 offen offset:0 nt
    buffer_load_dwordx4 v[68:71], v78, s[48:51], s91 offen offset:0 sc1
    buffer_load_dwordx4 v[72:75], v78, s[48:51], s91 offen offset:16 sc1
    s_waitcnt vmcnt(8)
    buffer_load_dwordx4 a[8:11], v76, s[52:55], s85 offen offset:1024 nt
    s_waitcnt vmcnt(8)
    buffer_load_dwordx4 a[12:15], v77, s[52:55], s85 offen offset:1024 nt
    s_add_u32 s87, s87, 7
    s_add_u32 s39, s87, s88
    s_bfe_u32 s37, s39, 0x30000
    s_lshl_b32 s37, s37, 12
    s_add_u32 s85, s37, s89
    s_bfe_u32 s37, s39, 0x10003
    s_lshl_b32 s37, s37, 11
    s_add_u32 s85, s37, s85
    s_bfe_u32 s37, s39, 0x40004
    s_lshl_b32 s37, s37, 16
    s_add_u32 s85, s37, s85
    s_waitcnt vmcnt(8)
    buffer_load_dwordx4 a[16:19], v76, s[52:55], s85 offen offset:0 nt
    s_waitcnt vmcnt(8)
    buffer_load_dwordx4 a[20:23], v77, s[52:55], s85 offen offset:0 nt
    s_waitcnt vmcnt(8)
    buffer_load_dwordx4 a[24:27], v76, s[52:55], s85 offen offset:1024 nt
    s_waitcnt vmcnt(8)
    buffer_load_dwordx4 a[28:31], v77, s[52:55], s85 offen offset:1024 nt
    s_add_u32 s87, s87, 7
    s_add_u32 s39, s87, s88
    s_bfe_u32 s37, s39, 0x30000
    s_lshl_b32 s37, s37, 12
    s_add_u32 s85, s37, s89
    s_bfe_u32 s37, s39, 0x10003
    s_lshl_b32 s37, s37, 11
    s_add_u32 s85, s37, s85
    s_bfe_u32 s37, s39, 0x40004
    s_lshl_b32 s37, s37, 16
    s_add_u32 s85, s37, s85
    s_waitcnt vmcnt(6)
L_qcheck_17:
    v_xor_b32 v68, s35, v68
    v_xor_b32 v69, s35, v69
    v_xor_b32 v70, s35, v70
    v_xor_b32 v71, s35, v71
    v_xor_b32 v72, s35, v72
    v_xor_b32 v73, s35, v73
    v_xor_b32 v74, s35, v74
    v_xor_b32 v75, s35, v75
    v_or_b32 v4, v68, v69
    v_or3_b32 v4, v4, v70, v71
    v_or3_b32 v4, v4, v72, v73
    v_or3_b32 v4, v4, v74, v75
    v_and_b32 v4, 0xff, v4
    v_cmp_ne_u32 vcc, 0, v4
    s_cbranch_vccz L_qok_18
    buffer_load_dwordx4 v[68:71], v78, s[48:51], s91 offen offset:0 sc1
    buffer_load_dwordx4 v[72:75], v78, s[48:51], s91 offen offset:16 sc1
    s_waitcnt vmcnt(0)
    s_sub_u32 s84, s84, 1
    s_cmp_lg_u32 s84, 0
    s_cbranch_scc1 L_qcheck_17
    s_branch L_end
L_qok_18:
    v_cvt_pk_bf16_f32 v68, v68, v69
    v_cvt_pk_bf16_f32 v69, v70, v71
    v_cvt_pk_bf16_f32 v70, v72, v73
    v_cvt_pk_bf16_f32 v71, v74, v75
    s_mov_b32 vcc_lo, 0xf000f
    s_mov_b32 vcc_hi, 0xf000f
    v_cndmask_b32 v80, 0, v68, vcc
    v_cndmask_b32 v81, 0, v69, vcc
    v_cndmask_b32 v82, 0, v70, vcc
    v_cndmask_b32 v83, 0, v71, vcc
    s_mov_b32 vcc_lo, 0xf000f0
    s_mov_b32 vcc_hi, 0xf000f0
    v_cndmask_b32 v84, 0, v68, vcc
    v_cndmask_b32 v85, 0, v69, vcc
    v_cndmask_b32 v86, 0, v70, vcc
    v_cndmask_b32 v87, 0, v71, vcc
    s_mov_b32 vcc_lo, 0xf000f00
    s_mov_b32 vcc_hi, 0xf000f00
    v_cndmask_b32 v88, 0, v68, vcc
    v_cndmask_b32 v89, 0, v69, vcc
    v_cndmask_b32 v90, 0, v70, vcc
    v_cndmask_b32 v91, 0, v71, vcc
    s_mov_b32 vcc_lo, 0xf000f000
    s_mov_b32 vcc_hi, 0xf000f000
    v_cndmask_b32 v92, 0, v68, vcc
    v_cndmask_b32 v93, 0, v69, vcc
    v_cndmask_b32 v94, 0, v70, vcc
    v_cndmask_b32 v95, 0, v71, vcc
    v_mov_b32 v65, 0xff7f0000
    s_lshl_b32 s38, s34, 14
    s_add_u32 s38, s38, 16384
    v_lshl_add_u32 v64, v1, 2, s38
    buffer_load_dwordx4 a[32:35], v76, s[52:55], s85 offen offset:0 nt
    v_mfma_f32_16x16x32_bf16 v[112:115], v[128:131], v[80:83], 0
    v_mfma_f32_16x16x32_bf16 v[112:115], v[132:135], v[84:87], v[112:115]
    v_mfma_f32_16x16x32_bf16 v[112:115], v[136:139], v[88:91], v[112:115]
    s_waitcnt vmcnt(6)
    buffer_load_dwordx4 a[36:39], v77, s[52:55], s85 offen offset:0 nt
    v_mfma_f32_16x16x32_bf16 v[112:115], v[140:143], v[92:95], v[112:115]
    v_mfma_f32_16x16x32_bf16 v[96:99], v[144:147], v[80:83], 0
    v_mfma_f32_16x16x32_bf16 v[96:99], v[148:151], v[84:87], v[96:99]
    s_waitcnt vmcnt(6)
    buffer_load_dwordx4 a[40:43], v76, s[52:55], s85 offen offset:1024 nt
    v_mfma_f32_16x16x32_bf16 v[96:99], v[152:155], v[88:91], v[96:99]
    s_nop 2
    v_mov_b32_dpp v122, v112 quad_perm:[0,0,0,0] row_mask:0xf bank_mask:0xf
    v_mov_b32_dpp v124, v114 quad_perm:[2,2,2,2] row_mask:0xf bank_mask:0xf
    s_nop 0
    v_add_f32_dpp v122, v113, v122 quad_perm:[1,1,1,1] row_mask:0xf bank_mask:0xf
    v_add_f32_dpp v124, v115, v124 quad_perm:[3,3,3,3] row_mask:0xf bank_mask:0xf
    v_add_f32 v122, v122, v124
    v_max_f32 v65, v65, v122
    ds_write_b32 v64, v122 offset:0
    v_mfma_f32_16x16x32_bf16 v[96:99], v[156:159], v[92:95], v[96:99]
    v_mfma_f32_16x16x32_bf16 v[112:115], v[160:163], v[80:83], 0
    v_mfma_f32_16x16x32_bf16 v[112:115], v[164:167], v[84:87], v[112:115]
    s_waitcnt vmcnt(6)
    buffer_load_dwordx4 a[44:47], v77, s[52:55], s85 offen offset:1024 nt
    s_add_u32 s87, s87, 7
    s_add_u32 s39, s87, s88
    s_bfe_u32 s37, s39, 0x30000
    s_lshl_b32 s37, s37, 12
    s_add_u32 s85, s37, s89
    s_bfe_u32 s37, s39, 0x10003
    s_lshl_b32 s37, s37, 11
    s_add_u32 s85, s37, s85
    s_bfe_u32 s37, s39, 0x40004
    s_lshl_b32 s37, s37, 16
    s_add_u32 s85, s37, s85
    v_mfma_f32_16x16x32_bf16 v[112:115], v[168:171], v[88:91], v[112:115]
    v_mov_b32_dpp v122, v96 quad_perm:[0,0,0,0] row_mask:0xf bank_mask:0xf
    v_mov_b32_dpp v124, v98 quad_perm:[2,2,2,2] row_mask:0xf bank_mask:0xf
    s_nop 0
    v_add_f32_dpp v122, v97, v122 quad_perm:[1,1,1,1] row_mask:0xf bank_mask:0xf
    v_add_f32_dpp v124, v99, v124 quad_perm:[3,3,3,3] row_mask:0xf bank_mask:0xf
    v_add_f32 v122, v122, v124
    v_max_f32 v65, v65, v122
    ds_write_b32 v64, v122 offset:256
    v_mfma_f32_16x16x32_bf16 v[112:115], v[172:175], v[92:95], v[112:115]
    v_mfma_f32_16x16x32_bf16 v[96:99], v[176:179], v[80:83], 0
    s_waitcnt vmcnt(6)
    buffer_load_dwordx4 a[48:51], v76, s[52:55], s85 offen offset:0 nt
    v_mfma_f32_16x16x32_bf16 v[96:99], v[180:183], v[84:87], v[96:99]
    v_mfma_f32_16x16x32_bf16 v[96:99], v[184:187], v[88:91], v[96:99]
    s_nop 2
    v_mov_b32_dpp v122, v112 quad_perm:[0,0,0,0] row_mask:0xf bank_mask:0xf
    v_mov_b32_dpp v124, v114 quad_perm:[2,2,2,2] row_mask:0xf bank_mask:0xf
    s_nop 0
    v_add_f32_dpp v122, v113, v122 quad_perm:[1,1,1,1] row_mask:0xf bank_mask:0xf
    v_add_f32_dpp v124, v115, v124 quad_perm:[3,3,3,3] row_mask:0xf bank_mask:0xf
    v_add_f32 v122, v122, v124
    v_max_f32 v65, v65, v122
    ds_write_b32 v64, v122 offset:512
    v_mfma_f32_16x16x32_bf16 v[96:99], v[188:191], v[92:95], v[96:99]
    v_mfma_f32_16x16x32_bf16 v[112:115], v[192:195], v[80:83], 0
    s_waitcnt vmcnt(6)
    buffer_load_dwordx4 a[52:55], v77, s[52:55], s85 offen offset:0 nt
    v_mfma_f32_16x16x32_bf16 v[112:115], v[196:199], v[84:87], v[112:115]
    v_mfma_f32_16x16x32_bf16 v[112:115], v[200:203], v[88:91], v[112:115]
    s_nop 2
    v_mov_b32_dpp v122, v96 quad_perm:[0,0,0,0] row_mask:0xf bank_mask:0xf
    v_mov_b32_dpp v124, v98 quad_perm:[2,2,2,2] row_mask:0xf bank_mask:0xf
    s_nop 0
    v_add_f32_dpp v122, v97, v122 quad_perm:[1,1,1,1] row_mask:0xf bank_mask:0xf
    v_add_f32_dpp v124, v99, v124 quad_perm:[3,3,3,3] row_mask:0xf bank_mask:0xf
    v_add_f32 v122, v122, v124
    v_max_f32 v65, v65, v122
    ds_write_b32 v64, v122 offset:768
    v_mfma_f32_16x16x32_bf16 v[112:115], v[204:207], v[92:95], v[112:115]
    s_waitcnt vmcnt(6)
    buffer_load_dwordx4 a[56:59], v76, s[52:55], s85 offen offset:1024 nt
    v_mfma_f32_16x16x32_bf16 v[96:99], v[208:211], v[80:83], 0
    v_mfma_f32_16x16x32_bf16 v[96:99], v[212:215], v[84:87], v[96:99]
    v_mfma_f32_16x16x32_bf16 v[96:99], v[216:219], v[88:91], v[96:99]
    s_nop 2
    v_mov_b32_dpp v122, v112 quad_perm:[0,0,0,0] row_mask:0xf bank_mask:0xf
    v_mov_b32_dpp v124, v114 quad_perm:[2,2,2,2] row_mask:0xf bank_mask:0xf
    s_nop 0
    v_add_f32_dpp v122, v113, v122 quad_perm:[1,1,1,1] row_mask:0xf bank_mask:0xf
    v_add_f32_dpp v124, v115, v124 quad_perm:[3,3,3,3] row_mask:0xf bank_mask:0xf
    v_add_f32 v122, v122, v124
    v_max_f32 v65, v65, v122
    ds_write_b32 v64, v122 offset:1024
    v_mfma_f32_16x16x32_bf16 v[96:99], v[220:223], v[92:95], v[96:99]
    s_waitcnt vmcnt(6)
    buffer_load_dwordx4 a[60:63], v77, s[52:55], s85 offen offset:1024 nt
    s_add_u32 s87, s87, 7
    s_add_u32 s39, s87, s88
    s_bfe_u32 s37, s39, 0x30000
    s_lshl_b32 s37, s37, 12
    s_add_u32 s85, s37, s89
    s_bfe_u32 s37, s39, 0x10003
    s_lshl_b32 s37, s37, 11
    s_add_u32 s85, s37, s85
    s_bfe_u32 s37, s39, 0x40004
    s_lshl_b32 s37, s37, 16
    s_add_u32 s85, s37, s85
    v_mfma_f32_16x16x32_bf16 v[112:115], v[224:227], v[80:83], 0
    s_sub_u32 s36, s33, 3
    s_and_b32 s37, s33, 3
    s_cmp_lt_u32 s36, 4
    s_cselect_b64 s[40:41], s[24:25], s[14:15]
    s_cselect_b32 s36, s36, s37
    s_cselect_b32 s92, 24, 24
    s_cselect_b32 s45, 262144, 0
    s_cselect_b32 s46, 8388608, 0
    s_add_u32 s45, s45, 524288
    s_add_u32 s46, s46, 196608
    s_mov_b32 s42, 4194304
    s_mov_b32 s43, 0x20000
    s_lshl_b32 s38, s32, 17
    s_add_u32 s44, s38, 0
    s_lshl_b32 s38, s34, 15
    s_add_u32 s44, s38, s44
    s_lshl_b32 s38, s36, 8
    s_add_u32 s44, s38, s44
    s_lshl_b32 s38, s36, 16
    s_add_u32 s45, s38, s45
    s_lshr_b32 s38, s34, 1
    s_lshl_b32 s38, s38, 15
    s_add_u32 s45, s38, s45
    s_lshl_b32 s38, s32, 8
    s_add_u32 s45, s38, s45
    s_bfe_u32 s38, s34, 0x10000
    s_lshl_b32 s38, s38, 7
    s_add_u32 s45, s38, s45
    s_lshl_b32 s38, s32, 11
    s_add_u32 s46, s38, s46
    s_lshl_b32 s38, s34, 9
    s_add_u32 s46, s38, s46
    s_mov_b32 s72, s26
    s_and_b32 s73, s27, 0xffff
    s_mov_b32 s74, 8192
    s_mov_b32 s75, 0x20000
    v_mfma_f32_16x16x32_bf16 v[112:115], v[228:231], v[84:87], v[112:115]
    v_mfma_f32_16x16x32_bf16 v[112:115], v[232:235], v[88:91], v[112:115]
    v_mov_b32_dpp v122, v96 quad_perm:[0,0,0,0] row_mask:0xf bank_mask:0xf
    v_mov_b32_dpp v124, v98 quad_perm:[2,2,2,2] row_mask:0xf bank_mask:0xf
    s_nop 0
    v_add_f32_dpp v122, v97, v122 quad_perm:[1,1,1,1] row_mask:0xf bank_mask:0xf
    v_add_f32_dpp v124, v99, v124 quad_perm:[3,3,3,3] row_mask:0xf bank_mask:0xf
    v_add_f32 v122, v122, v124
    v_max_f32 v65, v65, v122
    ds_write_b32 v64, v122 offset:1280
    s_waitcnt vmcnt(5)
    buffer_load_dwordx4 v[128:131], v76, s[52:55], s85 offen offset:0 nt
    v_mfma_f32_16x16x32_bf16 v[112:115], v[236:239], v[92:95], v[112:115]
    v_mfma_f32_16x16x32_bf16 v[96:99], v[240:243], v[80:83], 0
    v_mfma_f32_16x16x32_bf16 v[96:99], v[244:247], v[84:87], v[96:99]
    s_waitcnt vmcnt(5)
    buffer_load_dwordx4 v[132:135], v77, s[52:55], s85 offen offset:0 nt
    v_mfma_f32_16x16x32_bf16 v[96:99], v[248:251], v[88:91], v[96:99]
    s_nop 2
    v_mov_b32_dpp v122, v112 quad_perm:[0,0,0,0] row_mask:0xf bank_mask:0xf
    v_mov_b32_dpp v124, v114 quad_perm:[2,2,2,2] row_mask:0xf bank_mask:0xf
    s_nop 0
    v_add_f32_dpp v122, v113, v122 quad_perm:[1,1,1,1] row_mask:0xf bank_mask:0xf
    v_add_f32_dpp v124, v115, v124 quad_perm:[3,3,3,3] row_mask:0xf bank_mask:0xf
    v_add_f32 v122, v122, v124
    v_max_f32 v65, v65, v122
    ds_write_b32 v64, v122 offset:1536
    v_lshlrev_b32 v4, 2, v2
    v_xor_b32 v4, v4, v3
    v_xor_b32 v5, 0, v4
    v_lshlrev_b32 v5, 4, v5
    v_lshl_add_u32 v20, v2, 10, v5
    v_xor_b32 v5, 1, v4
    v_lshlrev_b32 v5, 4, v5
    v_lshl_add_u32 v21, v2, 10, v5
    v_add_u32 v21, 3072, v21
    v_xor_b32 v5, 2, v4
    v_lshlrev_b32 v5, 4, v5
    v_lshl_add_u32 v22, v2, 10, v5
    v_add_u32 v22, 6144, v22
    v_xor_b32 v5, 3, v4
    v_lshlrev_b32 v5, 4, v5
    v_lshl_add_u32 v23, v2, 10, v5
    v_add_u32 v23, 9216, v23
    s_lshl_b32 s38, s32, 15
    s_add_u32 s47, s38, 1048576
    s_lshl_b32 s38, s3, 13
    s_add_u32 s47, s38, s47
    s_mul_i32 s38, s3, 320
    s_add_u32 s38, s38, 135168
    v_lshlrev_b32 v4, 6, v2
    v_lshl_add_u32 v4, v3, 1, v4
    v_add_u32 v31, s38, v4
    v_mfma_f32_16x16x32_bf16 v[96:99], v[252:255], v[92:95], v[96:99]
    v_mfma_f32_16x16x32_bf16 v[112:115], a[0:3], v[80:83], 0
    v_mfma_f32_16x16x32_bf16 v[112:115], a[4:7], v[84:87], v[112:115]
    s_waitcnt vmcnt(5)
    buffer_load_dwordx4 v[136:139], v76, s[52:55], s85 offen offset:1024 nt
    v_mfma_f32_16x16x32_bf16 v[112:115], a[8:11], v[88:91], v[112:115]
    s_nop 2
    v_mov_b32_dpp v122, v96 quad_perm:[0,0,0,0] row_mask:0xf bank_mask:0xf
    v_mov_b32_dpp v124, v98 quad_perm:[2,2,2,2] row_mask:0xf bank_mask:0xf
    s_nop 0
    v_add_f32_dpp v122, v97, v122 quad_perm:[1,1,1,1] row_mask:0xf bank_mask:0xf
    v_add_f32_dpp v124, v99, v124 quad_perm:[3,3,3,3] row_mask:0xf bank_mask:0xf
    v_add_f32 v122, v122, v124
    v_max_f32 v65, v65, v122
    ds_write_b32 v64, v122 offset:1792
    v_mfma_f32_16x16x32_bf16 v[112:115], a[12:15], v[92:95], v[112:115]
    v_mfma_f32_16x16x32_bf16 v[96:99], a[16:19], v[80:83], 0
    v_lshlrev_b32 v4, 11, v2
    v_bfe_u32 v5, v1, 2, 2
    v_lshl_add_u32 v4, v5, 8, v4
    v_bfe_u32 v5, v1, 2, 2
    v_lshl_add_u32 v4, v5, 6, v4
    v_bfe_u32 v5, v1, 4, 1
    v_lshl_add_u32 v4, v5, 5, v4
    v_bfe_u32 v5, v1, 1, 1
    v_lshl_add_u32 v4, v5, 4, v4
    v_bfe_u32 v5, v1, 0, 1
    v_lshl_add_u32 v4, v5, 3, v4
    s_lshl_b32 s38, s34, 6
    s_add_u32 s38, s38, 98304
    v_xor_b32 v24, s38, v4
    v_xor_b32 v25, 16, v24
    v_xor_b32 v26, 32, v24
    v_xor_b32 v27, 48, v24
    v_and_b32 v4, 3, v3
    v_lshrrev_b32 v5, 2, v3
    v_lshlrev_b32 v6, 4, v2
    v_add_u32 v6, 135168, v6
    s_movk_i32 s36, 320
    v_cmp_eq_u32 vcc, 0, v5
    s_nop 1
    v_cndmask_b32 v28, 4, v4, vcc
    v_mad_u32_u24 v28, v28, s36, v6
    v_cmp_eq_u32 vcc, 1, v5
    s_nop 1
    v_cndmask_b32 v29, 4, v4, vcc
    v_mad_u32_u24 v29, v29, s36, v6
    v_lshlrev_b32 v5, 2, v1
    v_add_u32 v5, 136448, v5
    v_mov_b32 v6, 0
    ds_write_b32 v5, v6
    s_waitcnt vmcnt(5)
    buffer_load_dwordx4 v[140:143], v77, s[52:55], s85 offen offset:1024 nt
    s_add_u32 s87, s87, 7
    s_add_u32 s39, s87, s88
    s_bfe_u32 s37, s39, 0x30000
    s_lshl_b32 s37, s37, 12
    s_add_u32 s85, s37, s89
    s_bfe_u32 s37, s39, 0x10003
    s_lshl_b32 s37, s37, 11
    s_add_u32 s85, s37, s85
    s_bfe_u32 s37, s39, 0x40004
    s_lshl_b32 s37, s37, 16
    s_add_u32 s85, s37, s85
    v_mfma_f32_16x16x32_bf16 v[96:99], a[20:23], v[84:87], v[96:99]
    v_mfma_f32_16x16x32_bf16 v[96:99], a[24:27], v[88:91], v[96:99]
    v_mov_b32_dpp v122, v112 quad_perm:[0,0,0,0] row_mask:0xf bank_mask:0xf
    v_mov_b32_dpp v124, v114 quad_perm:[2,2,2,2] row_mask:0xf bank_mask:0xf
    s_nop 0
    v_add_f32_dpp v122, v113, v122 quad_perm:[1,1,1,1] row_mask:0xf bank_mask:0xf
    v_add_f32_dpp v124, v115, v124 quad_perm:[3,3,3,3] row_mask:0xf bank_mask:0xf
    v_add_f32 v122, v122, v124
    v_max_f32 v65, v65, v122
    ds_write_b32 v64, v122 offset:2048
    v_mfma_f32_16x16x32_bf16 v[96:99], a[28:31], v[92:95], v[96:99]
    v_mfma_f32_16x16x32_bf16 v[112:115], a[32:35], v[80:83], 0
    s_waitcnt vmcnt(5)
    buffer_load_dwordx4 v[144:147], v76, s[52:55], s85 offen offset:0 nt
    v_mfma_f32_16x16x32_bf16 v[112:115], a[36:39], v[84:87], v[112:115]
    v_mfma_f32_16x16x32_bf16 v[112:115], a[40:43], v[88:91], v[112:115]
    s_nop 2
    v_mov_b32_dpp v122, v96 quad_perm:[0,0,0,0] row_mask:0xf bank_mask:0xf
    v_mov_b32_dpp v124, v98 quad_perm:[2,2,2,2] row_mask:0xf bank_mask:0xf
    s_nop 0
    v_add_f32_dpp v122, v97, v122 quad_perm:[1,1,1,1] row_mask:0xf bank_mask:0xf
    v_add_f32_dpp v124, v99, v124 quad_perm:[3,3,3,3] row_mask:0xf bank_mask:0xf
    v_add_f32 v122, v122, v124
    v_max_f32 v65, v65, v122
    ds_write_b32 v64, v122 offset:2304
    v_lshlrev_b32 v30, 4, v3
    v_lshl_add_u32 v30, v2, 13, v30
    s_lshl_b32 s38, s32, 13
    s_add_u32 s36, s38, 0
    s_lshl_b32 s38, s34, 6
    s_add_u32 s36, s38, s36
    v_lshrrev_b32 v5, 2, v1
    v_lshlrev_b32 v32, 8, v5
    v_bfe_u32 v5, v1, 0, 2
    v_lshl_add_u32 v32, v5, 4, v32
    v_add_u32 v32, s36, v32
    s_lshr_b32 s38, s32, 2
    s_lshl_b32 s38, s38, 7
    s_add_u32 s36, s38, 0
    s_lshl_b32 s38, s34, 5
    s_add_u32 s36, s38, s36
    s_bfe_u32 s38, s32, 0x20000
    s_lshl_b32 s38, s38, 3
    s_add_u32 s36, s38, s36
    v_bfe_u32 v5, v1, 0, 2
    v_lshlrev_b32 v33, 11, v5
    v_lshl_add_u32 v33, v2, 1, v33
    v_add_u32 v33, s36, v33
    v_and_b32 v5, 31, v1
    v_lshlrev_b32 v34, 4, v5
    s_mul_i32 s38, s34, 320
    s_add_u32 s38, s38, 135168
    v_lshl_add_u32 v35, v5, 3, s38
    v_mfma_f32_16x16x32_bf16 v[112:115], a[44:47], v[92:95], v[112:115]
    s_waitcnt vmcnt(5)
    buffer_load_dwordx4 v[148:151], v77, s[52:55], s85 offen offset:0 nt
    v_mfma_f32_16x16x32_bf16 v[96:99], a[48:51], v[80:83], 0
    v_mfma_f32_16x16x32_bf16 v[96:99], a[52:55], v[84:87], v[96:99]
    v_mfma_f32_16x16x32_bf16 v[96:99], a[56:59], v[88:91], v[96:99]
    s_nop 2
    v_mov_b32_dpp v122, v112 quad_perm:[0,0,0,0] row_mask:0xf bank_mask:0xf
    v_mov_b32_dpp v124, v114 quad_perm:[2,2,2,2] row_mask:0xf bank_mask:0xf
    s_nop 0
    v_add_f32_dpp v122, v113, v122 quad_perm:[1,1,1,1] row_mask:0xf bank_mask:0xf
    v_add_f32_dpp v124, v115, v124 quad_perm:[3,3,3,3] row_mask:0xf bank_mask:0xf
    v_add_f32 v122, v122, v124
    v_max_f32 v65, v65, v122
    ds_write_b32 v64, v122 offset:2560
    v_mfma_f32_16x16x32_bf16 v[96:99], a[60:63], v[92:95], v[96:99]
    v_add_u32 v64, 2816, v64
    s_mov_b32 s97, 10
    s_mov_b32 s86, 32
    s_mov_b32 s66, 134217728
    s_mov_b32 s67, 0x20000
    s_mov_b64 s[64:65], s[52:53]
    v_mov_b32 v62, v76
    v_mov_b32 v63, v77
    s_branch L_bloop
L_ql:
    v_lshrrev_b32 v4, 2, v3
    v_and_b32 v5, 3, v3
    v_lshlrev_b32 v19, 6, v2
    v_lshl_add_u32 v19, v5, 4, v19
    v_lshl_add_u32 v14, v4, 18, v19
    s_lshl_b32 s63, s34, 20
    s_lshl_b32 s38, s32, 8
    s_add_u32 s63, s63, s38
    s_mov_b32 s74, 4194304
    s_mov_b32 s75, 0x20000
    s_waitcnt lgkmcnt(0)
    s_mov_b64 s[72:73], s[10:11]
    buffer_load_dwordx4 a[128:131], v14, s[72:75], s63 offen nt
    s_add_u32 s63, s63, 8192
    buffer_load_dwordx4 a[132:135], v14, s[72:75], s63 offen nt
    s_add_u32 s63, s63, 8192
    buffer_load_dwordx4 a[136:139], v14, s[72:75], s63 offen nt
    s_add_u32 s63, s63, 8192
    buffer_load_dwordx4 a[140:143], v14, s[72:75], s63 offen nt
    s_add_u32 s63, s63, 8192
    buffer_load_dwordx4 a[144:147], v14, s[72:75], s63 offen nt
    s_add_u32 s63, s63, 8192
    buffer_load_dwordx4 a[148:151], v14, s[72:75], s63 offen nt
    s_add_u32 s63, s63, 8192
    buffer_load_dwordx4 a[152:155], v14, s[72:75], s63 offen nt
    s_add_u32 s63, s63, 8192
    buffer_load_dwordx4 a[156:159], v14, s[72:75], s63 offen nt
    s_add_u32 s63, s63, 8192
    v_lshlrev_b32 v15, 1, v19
    v_lshl_add_u32 v15, v4, 9, v15
    v_lshl_add_u32 v19, v4, 15, v19
    s_load_dword s35, s[30:31], 0
    s_mov_b32 s48, s30
    s_and_b32 s49, s31, 0xffff
    s_mov_b32 s50, 8388608
    s_mov_b32 s51, 0x20000
    s_mov_b32 s82, 0xffffff00
    s_mov_b32 s83, 0x3e0293ee
    s_mov_b32 s84, 2097152
    s_lshl_b32 s38, s32, 12
    s_add_u32 s95, s38, 264192
    s_lshl_b32 s38, s32, 10
    s_add_u32 s94, s38, 393216
    s_lshl_b32 s38, s34, 8
    s_add_u32 s94, s38, s94
    s_waitcnt vmcnt(7)
    buffer_load_dwordx4 a[160:163], v14, s[72:75], s63 offen nt
    s_add_u32 s63, s63, 8192
    s_waitcnt vmcnt(7)
    buffer_load_dwordx4 a[164:167], v14, s[72:75], s63 offen nt
    s_add_u32 s63, s63, 8192
    s_waitcnt vmcnt(7)
    buffer_load_dwordx4 a[168:171], v14, s[72:75], s63 offen nt
    s_add_u32 s63, s63, 8192
    s_waitcnt vmcnt(7)
    buffer_load_dwordx4 a[172:175], v14, s[72:75], s63 offen nt
    s_add_u32 s63, s63, 8192
    s_waitcnt vmcnt(7)
    buffer_load_dwordx4 a[176:179], v14, s[72:75], s63 offen nt
    s_add_u32 s63, s63, 8192
    v_and_b32 v4, 1, v1
    v_lshlrev_b32 v4, 4, v4
    v_mov_b32 v5, 0xffff
    v_lshlrev_b32 v4, v4, v5
    v_bfe_u32 v5, v1, 1, 2
    v_cmp_eq_u32 vcc, 0, v5
    s_nop 1
    v_cndmask_b32 v10, 0, v4, vcc
    v_cmp_eq_u32 vcc, 1, v5
    s_nop 1
    v_cndmask_b32 v11, 0, v4, vcc
    v_cmp_eq_u32 vcc, 2, v5
    s_nop 1
    v_cndmask_b32 v12, 0, v4, vcc
    v_cmp_eq_u32 vcc, 3, v5
    s_nop 1
    v_cndmask_b32 v13, 0, v4, vcc
    s_waitcnt vmcnt(7)
    buffer_load_dwordx4 a[180:183], v14, s[72:75], s63 offen nt
    s_add_u32 s63, s63, 8192
    s_waitcnt vmcnt(7)
    buffer_load_dwordx4 a[184:187], v14, s[72:75], s63 offen nt
    s_add_u32 s63, s63, 8192
    s_waitcnt vmcnt(7)
    buffer_load_dwordx4 a[188:191], v14, s[72:75], s63 offen nt
    s_add_u32 s63, s63, 8192
    s_waitcnt vmcnt(7)
    buffer_load_dwordx4 a[192:195], v14, s[72:75], s63 offen nt
    s_add_u32 s63, s63, 8192
    v_lshrrev_b32 v4, 2, v3
    v_and_b32 v5, 3, v3
    v_lshlrev_b32 v76, 8, v4
    v_lshlrev_b32 v126, 8, v2
    v_lshl_add_u32 v76, v2, 6, v76
    v_lshl_add_u32 v76, v5, 4, v76
    v_lshl_add_u32 v126, v3, 4, v126
    v_xor_b32 v77, 32768, v76
    v_xor_b32 v127, 32768, v126
    s_add_u32 s3, s34, s33
    s_and_b32 s3, s3, 3
    s_lshl_b32 s89, s3, 5
    s_add_u32 s89, s89, s32
    s_lshl_b32 s89, s89, 20
    s_mul_i32 s88, s32, 8
    s_add_u32 s88, s88, s3
    s_lshl_b32 s87, s33, 0
    s_waitcnt vmcnt(7)
    buffer_load_dwordx4 a[196:199], v14, s[72:75], s63 offen nt
    s_add_u32 s63, s63, 8192
    s_waitcnt vmcnt(7)
    buffer_load_dwordx4 a[200:203], v14, s[72:75], s63 offen nt
    s_add_u32 s63, s63, 8192
    s_waitcnt vmcnt(7)
    buffer_load_dwordx4 a[204:207], v14, s[72:75], s63 offen nt
    s_add_u32 s63, s63, 8192
    s_waitcnt vmcnt(7)
    buffer_load_dwordx4 a[208:211], v14, s[72:75], s63 offen nt
    s_add_u32 s63, s63, 8192
    s_mov_b32 s52, s18
    s_and_b32 s53, s19, 0xffff
    s_mov_b32 s54, 134217728
    s_mov_b32 s55, 0x20000
    s_mov_b32 s56, s20
    s_and_b32 s57, s21, 0xffff
    s_mov_b32 s58, 134217728
    s_mov_b32 s59, 0x20000
    s_waitcnt vmcnt(7)
    buffer_load_dwordx4 a[212:215], v14, s[72:75], s63 offen nt
    s_add_u32 s63, s63, 8192
    s_waitcnt vmcnt(7)
    buffer_load_dwordx4 a[216:219], v14, s[72:75], s63 offen nt
    s_add_u32 s63, s63, 8192
    s_waitcnt vmcnt(7)
    buffer_load_dwordx4 a[220:223], v14, s[72:75], s63 offen nt
    s_add_u32 s63, s63, 8192
    s_waitcnt vmcnt(7)
    buffer_load_dwordx4 a[224:227], v14, s[72:75], s63 offen nt
    s_add_u32 s63, s63, 8192
    v_mov_b32 v120, 0xff7f0000
    v_mov_b32 v121, 0
    v_mov_b32 v18, 1
    v_mov_b32 v116, 0
    v_mov_b32 v117, 0
    v_mov_b32 v118, 0
    v_mov_b32 v119, 0
    s_lshl_b32 s38, s32, 10
    s_add_u32 s96, s38, 65536
    s_lshl_b32 s38, s3, 8
    s_add_u32 s96, s38, s96
    v_mov_b32 v9, s96
    s_lshl_b32 s38, s32, 15
    s_add_u32 s96, s38, 1048576
    s_lshl_b32 s38, s3, 13
    s_add_u32 s96, s38, s96
    s_lshl_b32 s38, s33, 10
    s_add_u32 s96, s38, s96
    v_and_b32 v5, 3, v3
    v_lshlrev_b32 v78, 7, v2
    v_lshl_add_u32 v78, v5, 5, v78
    s_lshl_b32 s38, s32, 12
    s_add_u32 s91, s38, 262144
    s_lshl_b32 s38, s3, 9
    s_add_u32 s91, s38, s91
    v_lshlrev_b32 v4, 7, v2
    v_lshl_add_u32 v4, v3, 4, v4
    v_mov_b32 v5, 512
    v_cmp_gt_u32 vcc, 8, v3
    s_nop 1
    v_cndmask_b32 v79, v5, v4, vcc
    s_waitcnt vmcnt(7)
    buffer_load_dwordx4 a[228:231], v14, s[72:75], s63 offen nt
    s_add_u32 s63, s63, 8192
    s_waitcnt vmcnt(7)
    buffer_load_dwordx4 a[232:235], v14, s[72:75], s63 offen nt
    s_add_u32 s63, s63, 8192
    s_waitcnt vmcnt(7)
    buffer_load_dwordx4 a[236:239], v14, s[72:75], s63 offen nt
    s_add_u32 s63, s63, 8192
    s_waitcnt vmcnt(7)
    buffer_load_dwordx4 a[240:243], v14, s[72:75], s63 offen nt
    s_add_u32 s63, s63, 8192
    s_waitcnt vmcnt(7)
    buffer_load_dwordx4 a[244:247], v14, s[72:75], s63 offen nt
    s_add_u32 s63, s63, 8192
    s_waitcnt vmcnt(7)
    buffer_load_dwordx4 a[248:251], v14, s[72:75], s63 offen nt
    s_add_u32 s63, s63, 8192
    s_waitcnt vmcnt(7)
    buffer_load_dwordx4 a[252:255], v14, s[72:75], s63 offen nt
    s_add_u32 s63, s63, 8192
    s_waitcnt lgkmcnt(0)
    s_add_u32 s35, s35, 0x5b
    s_and_b32 s35, s35, 0xff
    v_mov_b32 v8, s35
    s_or_b32 s68, s35, 0x6b3ac500
    s_waitcnt vmcnt(6)
    s_add_u32 s39, s87, s88
    s_bfe_u32 s37, s39, 0x30000
    s_lshl_b32 s37, s37, 12
    s_add_u32 s85, s37, s89
    s_bfe_u32 s37, s39, 0x10003
    s_lshl_b32 s37, s37, 11
    s_add_u32 s85, s37, s85
    s_bfe_u32 s37, s39, 0x40004
    s_lshl_b32 s37, s37, 16
    s_add_u32 s85, s37, s85
    buffer_load_dwordx4 v[128:131], v76, s[52:55], s85 offen offset:0 nt
    s_waitcnt vmcnt(6)
    buffer_load_dwordx4 v[132:135], v77, s[52:55], s85 offen offset:0 nt
    s_waitcnt vmcnt(6)
    buffer_load_dwordx4 v[136:139], v76, s[52:55], s85 offen offset:1024 nt
    s_waitcnt vmcnt(6)
    buffer_load_dwordx4 v[140:143], v77, s[52:55], s85 offen offset:1024 nt
    s_add_u32 s87, s87, 7
    s_add_u32 s39, s87, s88
    s_bfe_u32 s37, s39, 0x30000
    s_lshl_b32 s37, s37, 12
    s_add_u32 s85, s37, s89
    s_bfe_u32 s37, s39, 0x10003
    s_lshl_b32 s37, s37, 11
    s_add_u32 s85, s37, s85
    s_bfe_u32 s37, s39, 0x40004
    s_lshl_b32 s37, s37, 16
    s_add_u32 s85, s37, s85
    s_waitcnt vmcnt(6)
    buffer_load_dwordx4 v[144:147], v76, s[52:55], s85 offen offset:0 nt
    s_waitcnt vmcnt(6)
    buffer_load_dwordx4 v[148:151], v77, s[52:55], s85 offen offset:0 nt
    s_waitcnt vmcnt(6)
    buffer_load_dwordx4 v[152:155], v76, s[52:55], s85 offen offset:1024 nt
    s_waitcnt vmcnt(6)
    buffer_load_dwordx4 v[156:159], v77, s[52:55], s85 offen offset:1024 nt
    s_add_u32 s87, s87, 7
    s_add_u32 s39, s87, s88
    s_bfe_u32 s37, s39, 0x30000
    s_lshl_b32 s37, s37, 12
    s_add_u32 s85, s37, s89
    s_bfe_u32 s37, s39, 0x10003
    s_lshl_b32 s37, s37, 11
    s_add_u32 s85, s37, s85
    s_bfe_u32 s37, s39, 0x40004
    s_lshl_b32 s37, s37, 16
    s_add_u32 s85, s37, s85
    s_waitcnt vmcnt(6)
    buffer_load_dwordx4 v[160:163], v76, s[52:55], s85 offen offset:0 nt
    s_waitcnt vmcnt(6)
    buffer_load_dwordx4 v[164:167], v77, s[52:55], s85 offen offset:0 nt
    s_waitcnt vmcnt(6)
    buffer_load_dwordx4 v[168:171], v76, s[52:55], s85 offen offset:1024 nt
    s_waitcnt vmcnt(6)
    buffer_load_dwordx4 v[172:175], v77, s[52:55], s85 offen offset:1024 nt
    s_add_u32 s87, s87, 7
    s_add_u32 s39, s87, s88
    s_bfe_u32 s37, s39, 0x30000
    s_lshl_b32 s37, s37, 12
    s_add_u32 s85, s37, s89
    s_bfe_u32 s37, s39, 0x10003
    s_lshl_b32 s37, s37, 11
    s_add_u32 s85, s37, s85
    s_bfe_u32 s37, s39, 0x40004
    s_lshl_b32 s37, s37, 16
    s_add_u32 s85, s37, s85
    s_waitcnt vmcnt(6)
    buffer_load_dwordx4 v[176:179], v76, s[52:55], s85 offen offset:0 nt
    s_waitcnt vmcnt(6)
    buffer_load_dwordx4 v[180:183], v77, s[52:55], s85 offen offset:0 nt
    s_waitcnt vmcnt(6)
    buffer_load_dwordx4 v[184:187], v76, s[52:55], s85 offen offset:1024 nt
    s_waitcnt vmcnt(6)
    buffer_load_dwordx4 v[188:191], v77, s[52:55], s85 offen offset:1024 nt
    s_add_u32 s87, s87, 7
    s_add_u32 s39, s87, s88
    s_bfe_u32 s37, s39, 0x30000
    s_lshl_b32 s37, s37, 12
    s_add_u32 s85, s37, s89
    s_bfe_u32 s37, s39, 0x10003
    s_lshl_b32 s37, s37, 11
    s_add_u32 s85, s37, s85
    s_bfe_u32 s37, s39, 0x40004
    s_lshl_b32 s37, s37, 16
    s_add_u32 s85, s37, s85
    s_waitcnt vmcnt(6)
    buffer_load_dwordx4 v[192:195], v76, s[52:55], s85 offen offset:0 nt
    s_waitcnt vmcnt(6)
    buffer_load_dwordx4 v[196:199], v77, s[52:55], s85 offen offset:0 nt
    s_waitcnt vmcnt(6)
    buffer_load_dwordx4 v[200:203], v76, s[52:55], s85 offen offset:1024 nt
    s_waitcnt vmcnt(6)
    buffer_load_dwordx4 v[204:207], v77, s[52:55], s85 offen offset:1024 nt
    s_add_u32 s87, s87, 7
    s_add_u32 s39, s87, s88
    s_bfe_u32 s37, s39, 0x30000
    s_lshl_b32 s37, s37, 12
    s_add_u32 s85, s37, s89
    s_bfe_u32 s37, s39, 0x10003
    s_lshl_b32 s37, s37, 11
    s_add_u32 s85, s37, s85
    s_bfe_u32 s37, s39, 0x40004
    s_lshl_b32 s37, s37, 16
    s_add_u32 s85, s37, s85
    s_waitcnt vmcnt(6)
    buffer_load_dwordx4 v[208:211], v76, s[52:55], s85 offen offset:0 nt
    s_waitcnt vmcnt(6)
    buffer_load_dwordx4 v[212:215], v77, s[52:55], s85 offen offset:0 nt
    s_waitcnt vmcnt(6)
    buffer_load_dwordx4 v[216:219], v76, s[52:55], s85 offen offset:1024 nt
    s_waitcnt vmcnt(6)
    buffer_load_dwordx4 v[220:223], v77, s[52:55], s85 offen offset:1024 nt
    s_add_u32 s87, s87, 7
    s_add_u32 s39, s87, s88
    s_bfe_u32 s37, s39, 0x30000
    s_lshl_b32 s37, s37, 12
    s_add_u32 s85, s37, s89
    s_bfe_u32 s37, s39, 0x10003
    s_lshl_b32 s37, s37, 11
    s_add_u32 s85, s37, s85
    s_bfe_u32 s37, s39, 0x40004
    s_lshl_b32 s37, s37, 16
    s_add_u32 s85, s37, s85
    buffer_load_dwordx4 v[20:23], v15, s[48:51], s95 offen offset:0 sc1
    buffer_load_dwordx4 v[24:27], v15, s[48:51], s95 offen offset:16 sc1
    s_waitcnt vmcnt(8)
    buffer_load_dwordx4 v[224:227], v76, s[52:55], s85 offen offset:0 nt
    s_waitcnt vmcnt(8)
    buffer_load_dwordx4 v[228:231], v77, s[52:55], s85 offen offset:0 nt
    s_waitcnt vmcnt(8)
    buffer_load_dwordx4 v[232:235], v76, s[52:55], s85 offen offset:1024 nt
    s_waitcnt vmcnt(8)
    buffer_load_dwordx4 v[236:239], v77, s[52:55], s85 offen offset:1024 nt
    s_add_u32 s87, s87, 7
    s_add_u32 s39, s87, s88
    s_bfe_u32 s37, s39, 0x30000
    s_lshl_b32 s37, s37, 12
    s_add_u32 s85, s37, s89
    s_bfe_u32 s37, s39, 0x10003
    s_lshl_b32 s37, s37, 11
    s_add_u32 s85, s37, s85
    s_bfe_u32 s37, s39, 0x40004
    s_lshl_b32 s37, s37, 16
    s_add_u32 s85, s37, s85
    s_waitcnt vmcnt(8)
    buffer_load_dwordx4 v[240:243], v76, s[52:55], s85 offen offset:0 nt
    s_waitcnt vmcnt(8)
    buffer_load_dwordx4 v[244:247], v77, s[52:55], s85 offen offset:0 nt
    s_waitcnt vmcnt(6)
L_qacheck_19:
    v_xor_b32 v20, s35, v20
    v_xor_b32 v21, s35, v21
    v_xor_b32 v22, s35, v22
    v_xor_b32 v23, s35, v23
    v_xor_b32 v24, s35, v24
    v_xor_b32 v25, s35, v25
    v_xor_b32 v26, s35, v26
    v_xor_b32 v27, s35, v27
    v_or_b32 v4, v20, v21
    v_or3_b32 v4, v4, v22, v23
    v_or3_b32 v4, v4, v24, v25
    v_or3_b32 v4, v4, v26, v27
    v_and_b32 v4, 0xff, v4
    v_cmp_ne_u32 vcc, 0, v4
    s_cbranch_vccz L_qaok_20
    buffer_load_dwordx4 v[20:23], v15, s[48:51], s95 offen offset:0 sc1
    buffer_load_dwordx4 v[24:27], v15, s[48:51], s95 offen offset:16 sc1
    s_waitcnt vmcnt(0)
    s_sub_u32 s84, s84, 1
    s_cmp_lg_u32 s84, 0
    s_cbranch_scc1 L_qacheck_19
    s_branch L_end
L_qaok_20:
    buffer_load_dwordx4 v[68:71], v78, s[48:51], s91 offen offset:0 sc1
    buffer_load_dwordx4 v[72:75], v78, s[48:51], s91 offen offset:16 sc1
    v_cvt_pk_bf16_f32 v20, v20, v21
    v_cvt_pk_bf16_f32 v21, v22, v23
    v_cvt_pk_bf16_f32 v22, v24, v25
    v_cvt_pk_bf16_f32 v23, v26, v27
    s_nop 1
    v_mfma_f32_16x16x32_bf16 v[28:31], a[128:131], v[20:23], 0
    v_mfma_f32_16x16x32_bf16 v[32:35], a[132:135], v[20:23], 0
    v_mfma_f32_16x16x32_bf16 v[36:39], a[136:139], v[20:23], 0
    s_nop 5
    v_mov_b32_dpp v60, v28 quad_perm:[0,0,0,0] row_mask:0xf bank_mask:0xf
    v_mov_b32_dpp v4, v30 quad_perm:[2,2,2,2] row_mask:0xf bank_mask:0xf
    s_nop 0
    v_add_f32_dpp v60, v29, v60 quad_perm:[1,1,1,1] row_mask:0xf bank_mask:0xf
    v_add_f32_dpp v4, v31, v4 quad_perm:[3,3,3,3] row_mask:0xf bank_mask:0xf
    v_add_f32 v60, v60, v4
    v_mfma_f32_16x16x32_bf16 v[40:43], a[140:143], v[20:23], 0
    v_mov_b32_dpp v61, v32 quad_perm:[0,0,0,0] row_mask:0xf bank_mask:0xf
    v_mov_b32_dpp v4, v34 quad_perm:[2,2,2,2] row_mask:0xf bank_mask:0xf
    s_nop 0
    v_add_f32_dpp v61, v33, v61 quad_perm:[1,1,1,1] row_mask:0xf bank_mask:0xf
    v_add_f32_dpp v4, v35, v4 quad_perm:[3,3,3,3] row_mask:0xf bank_mask:0xf
    v_add_f32 v61, v61, v4
    v_cvt_pk_bf16_f32 v44, v60, v61
    v_mfma_f32_16x16x32_bf16 v[28:31], a[144:147], v[20:23], 0
    v_mov_b32_dpp v60, v36 quad_perm:[0,0,0,0] row_mask:0xf bank_mask:0xf
    v_mov_b32_dpp v4, v38 quad_perm:[2,2,2,2] row_mask:0xf bank_mask:0xf
    s_nop 0
    v_add_f32_dpp v60, v37, v60 quad_perm:[1,1,1,1] row_mask:0xf bank_mask:0xf
    v_add_f32_dpp v4, v39, v4 quad_perm:[3,3,3,3] row_mask:0xf bank_mask:0xf
    v_add_f32 v60, v60, v4
    buffer_load_dwordx4 v[248:251], v76, s[52:55], s85 offen offset:1024 nt
    v_mfma_f32_16x16x32_bf16 v[32:35], a[148:151], v[20:23], 0
    v_mov_b32_dpp v61, v40 quad_perm:[0,0,0,0] row_mask:0xf bank_mask:0xf
    v_mov_b32_dpp v4, v42 quad_perm:[2,2,2,2] row_mask:0xf bank_mask:0xf
    s_nop 0
    v_add_f32_dpp v61, v41, v61 quad_perm:[1,1,1,1] row_mask:0xf bank_mask:0xf
    v_add_f32_dpp v4, v43, v4 quad_perm:[3,3,3,3] row_mask:0xf bank_mask:0xf
    v_add_f32 v61, v61, v4
    v_cvt_pk_bf16_f32 v45, v60, v61
    v_mfma_f32_16x16x32_bf16 v[36:39], a[152:155], v[20:23], 0
    v_mov_b32_dpp v60, v28 quad_perm:[0,0,0,0] row_mask:0xf bank_mask:0xf
    v_mov_b32_dpp v4, v30 quad_perm:[2,2,2,2] row_mask:0xf bank_mask:0xf
    s_nop 0
    v_add_f32_dpp v60, v29, v60 quad_perm:[1,1,1,1] row_mask:0xf bank_mask:0xf
    v_add_f32_dpp v4, v31, v4 quad_perm:[3,3,3,3] row_mask:0xf bank_mask:0xf
    v_add_f32 v60, v60, v4
    v_mfma_f32_16x16x32_bf16 v[40:43], a[156:159], v[20:23], 0
    v_mov_b32_dpp v61, v32 quad_perm:[0,0,0,0] row_mask:0xf bank_mask:0xf
    v_mov_b32_dpp v4, v34 quad_perm:[2,2,2,2] row_mask:0xf bank_mask:0xf
    s_nop 0
    v_add_f32_dpp v61, v33, v61 quad_perm:[1,1,1,1] row_mask:0xf bank_mask:0xf
    v_add_f32_dpp v4, v35, v4 quad_perm:[3,3,3,3] row_mask:0xf bank_mask:0xf
    v_add_f32 v61, v61, v4
    v_cvt_pk_bf16_f32 v46, v60, v61
    v_mfma_f32_16x16x32_bf16 v[28:31], a[160:163], v[20:23], 0
    v_mov_b32_dpp v60, v36 quad_perm:[0,0,0,0] row_mask:0xf bank_mask:0xf
    v_mov_b32_dpp v4, v38 quad_perm:[2,2,2,2] row_mask:0xf bank_mask:0xf
    s_nop 0
    v_add_f32_dpp v60, v37, v60 quad_perm:[1,1,1,1] row_mask:0xf bank_mask:0xf
    v_add_f32_dpp v4, v39, v4 quad_perm:[3,3,3,3] row_mask:0xf bank_mask:0xf
    v_add_f32 v60, v60, v4
    v_mfma_f32_16x16x32_bf16 v[32:35], a[164:167], v[20:23], 0
    v_mov_b32_dpp v61, v40 quad_perm:[0,0,0,0] row_mask:0xf bank_mask:0xf
    v_mov_b32_dpp v4, v42 quad_perm:[2,2,2,2] row_mask:0xf bank_mask:0xf
    s_nop 0
    v_add_f32_dpp v61, v41, v61 quad_perm:[1,1,1,1] row_mask:0xf bank_mask:0xf
    v_add_f32_dpp v4, v43, v4 quad_perm:[3,3,3,3] row_mask:0xf bank_mask:0xf
    v_add_f32 v61, v61, v4
    v_cvt_pk_bf16_f32 v47, v60, v61
    v_mfma_f32_16x16x32_bf16 v[36:39], a[168:171], v[20:23], 0
    v_mov_b32_dpp v60, v28 quad_perm:[0,0,0,0] row_mask:0xf bank_mask:0xf
    v_mov_b32_dpp v4, v30 quad_perm:[2,2,2,2] row_mask:0xf bank_mask:0xf
    s_nop 0
    v_add_f32_dpp v60, v29, v60 quad_perm:[1,1,1,1] row_mask:0xf bank_mask:0xf
    v_add_f32_dpp v4, v31, v4 quad_perm:[3,3,3,3] row_mask:0xf bank_mask:0xf
    v_add_f32 v60, v60, v4
    v_mfma_f32_16x16x32_bf16 v[40:43], a[172:175], v[20:23], 0
    v_mov_b32_dpp v61, v32 quad_perm:[0,0,0,0] row_mask:0xf bank_mask:0xf
    v_mov_b32_dpp v4, v34 quad_perm:[2,2,2,2] row_mask:0xf bank_mask:0xf
    s_nop 0
    v_add_f32_dpp v61, v33, v61 quad_perm:[1,1,1,1] row_mask:0xf bank_mask:0xf
    v_add_f32_dpp v4, v35, v4 quad_perm:[3,3,3,3] row_mask:0xf bank_mask:0xf
    v_add_f32 v61, v61, v4
    v_cvt_pk_bf16_f32 v48, v60, v61
    v_mfma_f32_16x16x32_bf16 v[28:31], a[176:179], v[20:23], 0
    v_mov_b32_dpp v60, v36 quad_perm:[0,0,0,0] row_mask:0xf bank_mask:0xf
    v_mov_b32_dpp v4, v38 quad_perm:[2,2,2,2] row_mask:0xf bank_mask:0xf
    s_nop 0
    v_add_f32_dpp v60, v37, v60 quad_perm:[1,1,1,1] row_mask:0xf bank_mask:0xf
    v_add_f32_dpp v4, v39, v4 quad_perm:[3,3,3,3] row_mask:0xf bank_mask:0xf
    v_add_f32 v60, v60, v4
    buffer_load_dwordx4 v[252:255], v77, s[52:55], s85 offen offset:1024 nt
    s_add_u32 s87, s87, 7
    s_add_u32 s39, s87, s88
    s_bfe_u32 s37, s39, 0x30000
    s_lshl_b32 s37, s37, 12
    s_add_u32 s85, s37, s89
    s_bfe_u32 s37, s39, 0x10003
    s_lshl_b32 s37, s37, 11
    s_add_u32 s85, s37, s85
    s_bfe_u32 s37, s39, 0x40004
    s_lshl_b32 s37, s37, 16
    s_add_u32 s85, s37, s85
    v_mfma_f32_16x16x32_bf16 v[32:35], a[180:183], v[20:23], 0
    v_mov_b32_dpp v61, v40 quad_perm:[0,0,0,0] row_mask:0xf bank_mask:0xf
    v_mov_b32_dpp v4, v42 quad_perm:[2,2,2,2] row_mask:0xf bank_mask:0xf
    s_nop 0
    v_add_f32_dpp v61, v41, v61 quad_perm:[1,1,1,1] row_mask:0xf bank_mask:0xf
    v_add_f32_dpp v4, v43, v4 quad_perm:[3,3,3,3] row_mask:0xf bank_mask:0xf
    v_add_f32 v61, v61, v4
    v_cvt_pk_bf16_f32 v49, v60, v61
    v_mfma_f32_16x16x32_bf16 v[36:39], a[184:187], v[20:23], 0
    v_mov_b32_dpp v60, v28 quad_perm:[0,0,0,0] row_mask:0xf bank_mask:0xf
    v_mov_b32_dpp v4, v30 quad_perm:[2,2,2,2] row_mask:0xf bank_mask:0xf
    s_nop 0
    v_add_f32_dpp v60, v29, v60 quad_perm:[1,1,1,1] row_mask:0xf bank_mask:0xf
    v_add_f32_dpp v4, v31, v4 quad_perm:[3,3,3,3] row_mask:0xf bank_mask:0xf
    v_add_f32 v60, v60, v4
    v_mfma_f32_16x16x32_bf16 v[40:43], a[188:191], v[20:23], 0
    v_mov_b32_dpp v61, v32 quad_perm:[0,0,0,0] row_mask:0xf bank_mask:0xf
    v_mov_b32_dpp v4, v34 quad_perm:[2,2,2,2] row_mask:0xf bank_mask:0xf
    s_nop 0
    v_add_f32_dpp v61, v33, v61 quad_perm:[1,1,1,1] row_mask:0xf bank_mask:0xf
    v_add_f32_dpp v4, v35, v4 quad_perm:[3,3,3,3] row_mask:0xf bank_mask:0xf
    v_add_f32 v61, v61, v4
    v_cvt_pk_bf16_f32 v50, v60, v61
    v_mfma_f32_16x16x32_bf16 v[28:31], a[192:195], v[20:23], 0
    v_mov_b32_dpp v60, v36 quad_perm:[0,0,0,0] row_mask:0xf bank_mask:0xf
    v_mov_b32_dpp v4, v38 quad_perm:[2,2,2,2] row_mask:0xf bank_mask:0xf
    s_nop 0
    v_add_f32_dpp v60, v37, v60 quad_perm:[1,1,1,1] row_mask:0xf bank_mask:0xf
    v_add_f32_dpp v4, v39, v4 quad_perm:[3,3,3,3] row_mask:0xf bank_mask:0xf
    v_add_f32 v60, v60, v4
    v_mfma_f32_16x16x32_bf16 v[32:35], a[196:199], v[20:23], 0
    v_mov_b32_dpp v61, v40 quad_perm:[0,0,0,0] row_mask:0xf bank_mask:0xf
    v_mov_b32_dpp v4, v42 quad_perm:[2,2,2,2] row_mask:0xf bank_mask:0xf
    s_nop 0
    v_add_f32_dpp v61, v41, v61 quad_perm:[1,1,1,1] row_mask:0xf bank_mask:0xf
    v_add_f32_dpp v4, v43, v4 quad_perm:[3,3,3,3] row_mask:0xf bank_mask:0xf
    v_add_f32 v61, v61, v4
    v_cvt_pk_bf16_f32 v51, v60, v61
    v_mfma_f32_16x16x32_bf16 v[36:39], a[200:203], v[20:23], 0
    v_mov_b32_dpp v60, v28 quad_perm:[0,0,0,0] row_mask:0xf bank_mask:0xf
    v_mov_b32_dpp v4, v30 quad_perm:[2,2,2,2] row_mask:0xf bank_mask:0xf
    s_nop 0
    v_add_f32_dpp v60, v29, v60 quad_perm:[1,1,1,1] row_mask:0xf bank_mask:0xf
    v_add_f32_dpp v4, v31, v4 quad_perm:[3,3,3,3] row_mask:0xf bank_mask:0xf
    v_add_f32 v60, v60, v4
    v_mfma_f32_16x16x32_bf16 v[40:43], a[204:207], v[20:23], 0
    v_mov_b32_dpp v61, v32 quad_perm:[0,0,0,0] row_mask:0xf bank_mask:0xf
    v_mov_b32_dpp v4, v34 quad_perm:[2,2,2,2] row_mask:0xf bank_mask:0xf
    s_nop 0
    v_add_f32_dpp v61, v33, v61 quad_perm:[1,1,1,1] row_mask:0xf bank_mask:0xf
    v_add_f32_dpp v4, v35, v4 quad_perm:[3,3,3,3] row_mask:0xf bank_mask:0xf
    v_add_f32 v61, v61, v4
    v_cvt_pk_bf16_f32 v52, v60, v61
    v_mfma_f32_16x16x32_bf16 v[28:31], a[208:211], v[20:23], 0
    v_mov_b32_dpp v60, v36 quad_perm:[0,0,0,0] row_mask:0xf bank_mask:0xf
    v_mov_b32_dpp v4, v38 quad_perm:[2,2,2,2] row_mask:0xf bank_mask:0xf
    s_nop 0
    v_add_f32_dpp v60, v37, v60 quad_perm:[1,1,1,1] row_mask:0xf bank_mask:0xf
    v_add_f32_dpp v4, v39, v4 quad_perm:[3,3,3,3] row_mask:0xf bank_mask:0xf
    v_add_f32 v60, v60, v4
    buffer_load_dwordx4 a[0:3], v76, s[52:55], s85 offen offset:0 nt
    v_mfma_f32_16x16x32_bf16 v[32:35], a[212:215], v[20:23], 0
    v_mov_b32_dpp v61, v40 quad_perm:[0,0,0,0] row_mask:0xf bank_mask:0xf
    v_mov_b32_dpp v4, v42 quad_perm:[2,2,2,2] row_mask:0xf bank_mask:0xf
    s_nop 0
    v_add_f32_dpp v61, v41, v61 quad_perm:[1,1,1,1] row_mask:0xf bank_mask:0xf
    v_add_f32_dpp v4, v43, v4 quad_perm:[3,3,3,3] row_mask:0xf bank_mask:0xf
    v_add_f32 v61, v61, v4
    v_cvt_pk_bf16_f32 v53, v60, v61
    v_mfma_f32_16x16x32_bf16 v[36:39], a[216:219], v[20:23], 0
    v_mov_b32_dpp v60, v28 quad_perm:[0,0,0,0] row_mask:0xf bank_mask:0xf
    v_mov_b32_dpp v4, v30 quad_perm:[2,2,2,2] row_mask:0xf bank_mask:0xf
    s_nop 0
    v_add_f32_dpp v60, v29, v60 quad_perm:[1,1,1,1] row_mask:0xf bank_mask:0xf
    v_add_f32_dpp v4, v31, v4 quad_perm:[3,3,3,3] row_mask:0xf bank_mask:0xf
    v_add_f32 v60, v60, v4
    v_mfma_f32_16x16x32_bf16 v[40:43], a[220:223], v[20:23], 0
    v_mov_b32_dpp v61, v32 quad_perm:[0,0,0,0] row_mask:0xf bank_mask:0xf
    v_mov_b32_dpp v4, v34 quad_perm:[2,2,2,2] row_mask:0xf bank_mask:0xf
    s_nop 0
    v_add_f32_dpp v61, v33, v61 quad_perm:[1,1,1,1] row_mask:0xf bank_mask:0xf
    v_add_f32_dpp v4, v35, v4 quad_perm:[3,3,3,3] row_mask:0xf bank_mask:0xf
    v_add_f32 v61, v61, v4
    v_cvt_pk_bf16_f32 v54, v60, v61
    v_mfma_f32_16x16x32_bf16 v[28:31], a[224:227], v[20:23], 0
    v_mov_b32_dpp v60, v36 quad_perm:[0,0,0,0] row_mask:0xf bank_mask:0xf
    v_mov_b32_dpp v4, v38 quad_perm:[2,2,2,2] row_mask:0xf bank_mask:0xf
    s_nop 0
    v_add_f32_dpp v60, v37, v60 quad_perm:[1,1,1,1] row_mask:0xf bank_mask:0xf
    v_add_f32_dpp v4, v39, v4 quad_perm:[3,3,3,3] row_mask:0xf bank_mask:0xf
    v_add_f32 v60, v60, v4
    v_mfma_f32_16x16x32_bf16 v[32:35], a[228:231], v[20:23], 0
    v_mov_b32_dpp v61, v40 quad_perm:[0,0,0,0] row_mask:0xf bank_mask:0xf
    v_mov_b32_dpp v4, v42 quad_perm:[2,2,2,2] row_mask:0xf bank_mask:0xf
    s_nop 0
    v_add_f32_dpp v61, v41, v61 quad_perm:[1,1,1,1] row_mask:0xf bank_mask:0xf
    v_add_f32_dpp v4, v43, v4 quad_perm:[3,3,3,3] row_mask:0xf bank_mask:0xf
    v_add_f32 v61, v61, v4
    v_cvt_pk_bf16_f32 v55, v60, v61
    v_mfma_f32_16x16x32_bf16 v[36:39], a[232:235], v[20:23], 0
    v_mov_b32_dpp v60, v28 quad_perm:[0,0,0,0] row_mask:0xf bank_mask:0xf
    v_mov_b32_dpp v4, v30 quad_perm:[2,2,2,2] row_mask:0xf bank_mask:0xf
    s_nop 0
    v_add_f32_dpp v60, v29, v60 quad_perm:[1,1,1,1] row_mask:0xf bank_mask:0xf
    v_add_f32_dpp v4, v31, v4 quad_perm:[3,3,3,3] row_mask:0xf bank_mask:0xf
    v_add_f32 v60, v60, v4
    v_mfma_f32_16x16x32_bf16 v[40:43], a[236:239], v[20:23], 0
    v_mov_b32_dpp v61, v32 quad_perm:[0,0,0,0] row_mask:0xf bank_mask:0xf
    v_mov_b32_dpp v4, v34 quad_perm:[2,2,2,2] row_mask:0xf bank_mask:0xf
    s_nop 0
    v_add_f32_dpp v61, v33, v61 quad_perm:[1,1,1,1] row_mask:0xf bank_mask:0xf
    v_add_f32_dpp v4, v35, v4 quad_perm:[3,3,3,3] row_mask:0xf bank_mask:0xf
    v_add_f32 v61, v61, v4
    v_cvt_pk_bf16_f32 v56, v60, v61
    v_mfma_f32_16x16x32_bf16 v[28:31], a[240:243], v[20:23], 0
    v_mov_b32_dpp v60, v36 quad_perm:[0,0,0,0] row_mask:0xf bank_mask:0xf
    v_mov_b32_dpp v4, v38 quad_perm:[2,2,2,2] row_mask:0xf bank_mask:0xf
    s_nop 0
    v_add_f32_dpp v60, v37, v60 quad_perm:[1,1,1,1] row_mask:0xf bank_mask:0xf
    v_add_f32_dpp v4, v39, v4 quad_perm:[3,3,3,3] row_mask:0xf bank_mask:0xf
    v_add_f32 v60, v60, v4
    buffer_load_dwordx4 a[4:7], v77, s[52:55], s85 offen offset:0 nt
    v_mfma_f32_16x16x32_bf16 v[32:35], a[244:247], v[20:23], 0
    v_mov_b32_dpp v61, v40 quad_perm:[0,0,0,0] row_mask:0xf bank_mask:0xf
    v_mov_b32_dpp v4, v42 quad_perm:[2,2,2,2] row_mask:0xf bank_mask:0xf
    s_nop 0
    v_add_f32_dpp v61, v41, v61 quad_perm:[1,1,1,1] row_mask:0xf bank_mask:0xf
    v_add_f32_dpp v4, v43, v4 quad_perm:[3,3,3,3] row_mask:0xf bank_mask:0xf
    v_add_f32 v61, v61, v4
    v_cvt_pk_bf16_f32 v57, v60, v61
    v_mfma_f32_16x16x32_bf16 v[36:39], a[248:251], v[20:23], 0
    v_mov_b32_dpp v60, v28 quad_perm:[0,0,0,0] row_mask:0xf bank_mask:0xf
    v_mov_b32_dpp v4, v30 quad_perm:[2,2,2,2] row_mask:0xf bank_mask:0xf
    s_nop 0
    v_add_f32_dpp v60, v29, v60 quad_perm:[1,1,1,1] row_mask:0xf bank_mask:0xf
    v_add_f32_dpp v4, v31, v4 quad_perm:[3,3,3,3] row_mask:0xf bank_mask:0xf
    v_add_f32 v60, v60, v4
    v_mfma_f32_16x16x32_bf16 v[40:43], a[252:255], v[20:23], 0
    v_mov_b32_dpp v61, v32 quad_perm:[0,0,0,0] row_mask:0xf bank_mask:0xf
    v_mov_b32_dpp v4, v34 quad_perm:[2,2,2,2] row_mask:0xf bank_mask:0xf
    s_nop 0
    v_add_f32_dpp v61, v33, v61 quad_perm:[1,1,1,1] row_mask:0xf bank_mask:0xf
    v_add_f32_dpp v4, v35, v4 quad_perm:[3,3,3,3] row_mask:0xf bank_mask:0xf
    v_add_f32 v61, v61, v4
    v_cvt_pk_bf16_f32 v58, v60, v61
    v_mov_b32_dpp v60, v36 quad_perm:[0,0,0,0] row_mask:0xf bank_mask:0xf
    v_mov_b32_dpp v4, v38 quad_perm:[2,2,2,2] row_mask:0xf bank_mask:0xf
    s_nop 0
    v_add_f32_dpp v60, v37, v60 quad_perm:[1,1,1,1] row_mask:0xf bank_mask:0xf
    v_add_f32_dpp v4, v39, v4 quad_perm:[3,3,3,3] row_mask:0xf bank_mask:0xf
    v_add_f32 v60, v60, v4
    v_mov_b32_dpp v61, v40 quad_perm:[0,0,0,0] row_mask:0xf bank_mask:0xf
    v_mov_b32_dpp v4, v42 quad_perm:[2,2,2,2] row_mask:0xf bank_mask:0xf
    s_nop 0
    v_add_f32_dpp v61, v41, v61 quad_perm:[1,1,1,1] row_mask:0xf bank_mask:0xf
    v_add_f32_dpp v4, v43, v4 quad_perm:[3,3,3,3] row_mask:0xf bank_mask:0xf
    v_add_f32 v61, v61, v4
    v_cvt_pk_bf16_f32 v59, v60, v61
    s_mov_b32 exec_lo, 0x22222222
    s_mov_b32 exec_hi, 0x22222222
    v_mov_b32 v44, v48
    v_mov_b32 v45, v49
    v_mov_b32 v46, v50
    v_mov_b32 v47, v51
    s_mov_b32 exec_lo, 0x44444444
    s_mov_b32 exec_hi, 0x44444444
    v_mov_b32 v44, v52
    v_mov_b32 v45, v53
    v_mov_b32 v46, v54
    v_mov_b32 v47, v55
    s_mov_b32 exec_lo, 0x88888888
    s_mov_b32 exec_hi, 0x88888888
    v_mov_b32 v44, v56
    v_mov_b32 v45, v57
    v_mov_b32 v46, v58
    v_mov_b32 v47, v59
    s_mov_b64 exec, -1
    buffer_store_dwordx4 v[44:47], v19, s[48:51], s94 offen sc1
    s_waitcnt vmcnt(5)
L_qcheck_21:
    v_xor_b32 v68, s35, v68
    v_xor_b32 v69, s35, v69
    v_xor_b32 v70, s35, v70
    v_xor_b32 v71, s35, v71
    v_xor_b32 v72, s35, v72
    v_xor_b32 v73, s35, v73
    v_xor_b32 v74, s35, v74
    v_xor_b32 v75, s35, v75
    v_or_b32 v4, v68, v69
    v_or3_b32 v4, v4, v70, v71
    v_or3_b32 v4, v4, v72, v73
    v_or3_b32 v4, v4, v74, v75
    v_and_b32 v4, 0xff, v4
    v_cmp_ne_u32 vcc, 0, v4
    s_cbranch_vccz L_qok_22
    buffer_load_dwordx4 v[68:71], v78, s[48:51], s91 offen offset:0 sc1
    buffer_load_dwordx4 v[72:75], v78, s[48:51], s91 offen offset:16 sc1
    s_waitcnt vmcnt(0)
    s_sub_u32 s84, s84, 1
    s_cmp_lg_u32 s84, 0
    s_cbranch_scc1 L_qcheck_21
    s_branch L_end
L_qok_22:
    v_cvt_pk_bf16_f32 v68, v68, v69
    v_cvt_pk_bf16_f32 v69, v70, v71
    v_cvt_pk_bf16_f32 v70, v72, v73
    v_cvt_pk_bf16_f32 v71, v74, v75
    s_mov_b32 vcc_lo, 0xf000f
    s_mov_b32 vcc_hi, 0xf000f
    v_cndmask_b32 v80, 0, v68, vcc
    v_cndmask_b32 v81, 0, v69, vcc
    v_cndmask_b32 v82, 0, v70, vcc
    v_cndmask_b32 v83, 0, v71, vcc
    s_mov_b32 vcc_lo, 0xf000f0
    s_mov_b32 vcc_hi, 0xf000f0
    v_cndmask_b32 v84, 0, v68, vcc
    v_cndmask_b32 v85, 0, v69, vcc
    v_cndmask_b32 v86, 0, v70, vcc
    v_cndmask_b32 v87, 0, v71, vcc
    s_mov_b32 vcc_lo, 0xf000f00
    s_mov_b32 vcc_hi, 0xf000f00
    v_cndmask_b32 v88, 0, v68, vcc
    v_cndmask_b32 v89, 0, v69, vcc
    v_cndmask_b32 v90, 0, v70, vcc
    v_cndmask_b32 v91, 0, v71, vcc
    s_mov_b32 vcc_lo, 0xf000f000
    s_mov_b32 vcc_hi, 0xf000f000
    v_cndmask_b32 v92, 0, v68, vcc
    v_cndmask_b32 v93, 0, v69, vcc
    v_cndmask_b32 v94, 0, v70, vcc
    v_cndmask_b32 v95, 0, v71, vcc
    v_mov_b32 v65, 0xff7f0000
    s_lshl_b32 s38, s34, 14
    s_add_u32 s38, s38, 16384
    v_lshl_add_u32 v64, v1, 2, s38
    buffer_load_dwordx4 a[8:11], v76, s[52:55], s85 offen offset:1024 nt
    v_mfma_f32_16x16x32_bf16 v[112:115], v[128:131], v[80:83], 0
    v_mfma_f32_16x16x32_bf16 v[112:115], v[132:135], v[84:87], v[112:115]
    buffer_load_dwordx4 a[12:15], v77, s[52:55], s85 offen offset:1024 nt
    s_add_u32 s87, s87, 7
    s_add_u32 s39, s87, s88
    s_bfe_u32 s37, s39, 0x30000
    s_lshl_b32 s37, s37, 12
    s_add_u32 s85, s37, s89
    s_bfe_u32 s37, s39, 0x10003
    s_lshl_b32 s37, s37, 11
    s_add_u32 s85, s37, s85
    s_bfe_u32 s37, s39, 0x40004
    s_lshl_b32 s37, s37, 16
    s_add_u32 s85, s37, s85
    v_mfma_f32_16x16x32_bf16 v[112:115], v[136:139], v[88:91], v[112:115]
    v_mfma_f32_16x16x32_bf16 v[112:115], v[140:143], v[92:95], v[112:115]
    buffer_load_dwordx4 a[16:19], v76, s[52:55], s85 offen offset:0 nt
    v_mfma_f32_16x16x32_bf16 v[96:99], v[144:147], v[80:83], 0
    v_mfma_f32_16x16x32_bf16 v[96:99], v[148:151], v[84:87], v[96:99]
    v_mfma_f32_16x16x32_bf16 v[96:99], v[152:155], v[88:91], v[96:99]
    s_nop 3
    v_mov_b32_dpp v122, v112 quad_perm:[0,0,0,0] row_mask:0xf bank_mask:0xf
    v_mov_b32_dpp v124, v114 quad_perm:[2,2,2,2] row_mask:0xf bank_mask:0xf
    s_nop 0
    v_add_f32_dpp v122, v113, v122 quad_perm:[1,1,1,1] row_mask:0xf bank_mask:0xf
    v_add_f32_dpp v124, v115, v124 quad_perm:[3,3,3,3] row_mask:0xf bank_mask:0xf
    v_add_f32 v122, v122, v124
    v_max_f32 v65, v65, v122
    ds_write_b32 v64, v122 offset:0
    s_waitcnt vmcnt(7)
    buffer_load_dwordx4 a[20:23], v77, s[52:55], s85 offen offset:0 nt
    v_mfma_f32_16x16x32_bf16 v[96:99], v[156:159], v[92:95], v[96:99]
    v_mfma_f32_16x16x32_bf16 v[112:115], v[160:163], v[80:83], 0
    s_waitcnt vmcnt(7)
    buffer_load_dwordx4 a[24:27], v76, s[52:55], s85 offen offset:1024 nt
    v_mfma_f32_16x16x32_bf16 v[112:115], v[164:167], v[84:87], v[112:115]
    v_mfma_f32_16x16x32_bf16 v[112:115], v[168:171], v[88:91], v[112:115]
    s_nop 2
    v_mov_b32_dpp v122, v96 quad_perm:[0,0,0,0] row_mask:0xf bank_mask:0xf
    v_mov_b32_dpp v124, v98 quad_perm:[2,2,2,2] row_mask:0xf bank_mask:0xf
    s_nop 0
    v_add_f32_dpp v122, v97, v122 quad_perm:[1,1,1,1] row_mask:0xf bank_mask:0xf
    v_add_f32_dpp v124, v99, v124 quad_perm:[3,3,3,3] row_mask:0xf bank_mask:0xf
    v_add_f32 v122, v122, v124
    v_max_f32 v65, v65, v122
    ds_write_b32 v64, v122 offset:256
    v_mfma_f32_16x16x32_bf16 v[112:115], v[172:175], v[92:95], v[112:115]
    s_waitcnt vmcnt(7)
    buffer_load_dwordx4 a[28:31], v77, s[52:55], s85 offen offset:1024 nt
    s_add_u32 s87, s87, 7
    s_add_u32 s39, s87, s88
    s_bfe_u32 s37, s39, 0x30000
    s_lshl_b32 s37, s37, 12
    s_add_u32 s85, s37, s89
    s_bfe_u32 s37, s39, 0x10003
    s_lshl_b32 s37, s37, 11
    s_add_u32 s85, s37, s85
    s_bfe_u32 s37, s39, 0x40004
    s_lshl_b32 s37, s37, 16
    s_add_u32 s85, s37, s85
    v_mfma_f32_16x16x32_bf16 v[96:99], v[176:179], v[80:83], 0
    v_mfma_f32_16x16x32_bf16 v[96:99], v[180:183], v[84:87], v[96:99]
    s_waitcnt vmcnt(7)
    buffer_load_dwordx4 a[32:35], v76, s[52:55], s85 offen offset:0 nt
    v_mfma_f32_16x16x32_bf16 v[96:99], v[184:187], v[88:91], v[96:99]
    v_mov_b32_dpp v122, v112 quad_perm:[0,0,0,0] row_mask:0xf bank_mask:0xf
    v_mov_b32_dpp v124, v114 quad_perm:[2,2,2,2] row_mask:0xf bank_mask:0xf
    s_nop 0
    v_add_f32_dpp v122, v113, v122 quad_perm:[1,1,1,1] row_mask:0xf bank_mask:0xf
    v_add_f32_dpp v124, v115, v124 quad_perm:[3,3,3,3] row_mask:0xf bank_mask:0xf
    v_add_f32 v122, v122, v124
    v_max_f32 v65, v65, v122
    ds_write_b32 v64, v122 offset:512
    v_mfma_f32_16x16x32_bf16 v[96:99], v[188:191], v[92:95], v[96:99]
    s_lshl_b32 s38, s32, 8
    s_add_u32 s69, s38, 98304
    s_lshl_b32 s38, s34, 13
    s_add_u32 s69, s38, s69
    v_mov_b32 v48, s69
    v_mov_b32 v49, s68
    s_waitcnt vmcnt(7)
    s_mov_b64 exec, 1
    buffer_store_dword v49, v48, s[48:51], 0 offen sc1
    s_mov_b64 exec, -1
    s_waitcnt vmcnt(7)
    buffer_load_dwordx4 a[36:39], v77, s[52:55], s85 offen offset:0 nt
    v_mfma_f32_16x16x32_bf16 v[112:115], v[192:195], v[80:83], 0
    v_mfma_f32_16x16x32_bf16 v[112:115], v[196:199], v[84:87], v[112:115]
    v_mfma_f32_16x16x32_bf16 v[112:115], v[200:203], v[88:91], v[112:115]
    v_mov_b32_dpp v122, v96 quad_perm:[0,0,0,0] row_mask:0xf bank_mask:0xf
    v_mov_b32_dpp v124, v98 quad_perm:[2,2,2,2] row_mask:0xf bank_mask:0xf
    s_nop 0
    v_add_f32_dpp v122, v97, v122 quad_perm:[1,1,1,1] row_mask:0xf bank_mask:0xf
    v_add_f32_dpp v124, v99, v124 quad_perm:[3,3,3,3] row_mask:0xf bank_mask:0xf
    v_add_f32 v122, v122, v124
    v_max_f32 v65, v65, v122
    ds_write_b32 v64, v122 offset:768
    s_waitcnt vmcnt(7)
    buffer_load_dwordx4 a[40:43], v76, s[52:55], s85 offen offset:1024 nt
    v_mfma_f32_16x16x32_bf16 v[112:115], v[204:207], v[92:95], v[112:115]
    v_mfma_f32_16x16x32_bf16 v[96:99], v[208:211], v[80:83], 0
    s_waitcnt vmcnt(7)
    buffer_load_dwordx4 a[44:47], v77, s[52:55], s85 offen offset:1024 nt
    s_add_u32 s87, s87, 7
    s_add_u32 s39, s87, s88
    s_bfe_u32 s37, s39, 0x30000
    s_lshl_b32 s37, s37, 12
    s_add_u32 s85, s37, s89
    s_bfe_u32 s37, s39, 0x10003
    s_lshl_b32 s37, s37, 11
    s_add_u32 s85, s37, s85
    s_bfe_u32 s37, s39, 0x40004
    s_lshl_b32 s37, s37, 16
    s_add_u32 s85, s37, s85
    v_mfma_f32_16x16x32_bf16 v[96:99], v[212:215], v[84:87], v[96:99]
    v_mfma_f32_16x16x32_bf16 v[96:99], v[216:219], v[88:91], v[96:99]
    v_mov_b32_dpp v122, v112 quad_perm:[0,0,0,0] row_mask:0xf bank_mask:0xf
    v_mov_b32_dpp v124, v114 quad_perm:[2,2,2,2] row_mask:0xf bank_mask:0xf
    s_nop 0
    v_add_f32_dpp v122, v113, v122 quad_perm:[1,1,1,1] row_mask:0xf bank_mask:0xf
    v_add_f32_dpp v124, v115, v124 quad_perm:[3,3,3,3] row_mask:0xf bank_mask:0xf
    v_add_f32 v122, v122, v124
    v_max_f32 v65, v65, v122
    ds_write_b32 v64, v122 offset:1024
    v_mfma_f32_16x16x32_bf16 v[96:99], v[220:223], v[92:95], v[96:99]
    s_waitcnt vmcnt(7)
    buffer_load_dwordx4 a[48:51], v76, s[52:55], s85 offen offset:0 nt
    v_mfma_f32_16x16x32_bf16 v[112:115], v[224:227], v[80:83], 0
    s_sub_u32 s36, s33, 3
    s_and_b32 s37, s33, 3
    s_cmp_lt_u32 s36, 4
    s_cselect_b64 s[40:41], s[24:25], s[14:15]
    s_cselect_b32 s36, s36, s37
    s_cselect_b32 s92, 24, 24
    s_cselect_b32 s45, 262144, 0
    s_cselect_b32 s46, 8388608, 0
    s_add_u32 s45, s45, 524288
    s_add_u32 s46, s46, 196608
    s_mov_b32 s42, 4194304
    s_mov_b32 s43, 0x20000
    s_lshl_b32 s38, s32, 17
    s_add_u32 s44, s38, 0
    s_lshl_b32 s38, s34, 15
    s_add_u32 s44, s38, s44
    s_lshl_b32 s38, s36, 8
    s_add_u32 s44, s38, s44
    s_lshl_b32 s38, s36, 16
    s_add_u32 s45, s38, s45
    s_lshr_b32 s38, s34, 1
    s_lshl_b32 s38, s38, 15
    s_add_u32 s45, s38, s45
    s_lshl_b32 s38, s32, 8
    s_add_u32 s45, s38, s45
    s_bfe_u32 s38, s34, 0x10000
    s_lshl_b32 s38, s38, 7
    s_add_u32 s45, s38, s45
    s_lshl_b32 s38, s32, 11
    s_add_u32 s46, s38, s46
    s_lshl_b32 s38, s34, 9
    s_add_u32 s46, s38, s46
    s_mov_b32 s72, s26
    s_and_b32 s73, s27, 0xffff
    s_mov_b32 s74, 8192
    s_mov_b32 s75, 0x20000
    v_mfma_f32_16x16x32_bf16 v[112:115], v[228:231], v[84:87], v[112:115]
    s_waitcnt vmcnt(7)
    buffer_load_dwordx4 a[52:55], v77, s[52:55], s85 offen offset:0 nt
    v_mfma_f32_16x16x32_bf16 v[112:115], v[232:235], v[88:91], v[112:115]
    v_mov_b32_dpp v122, v96 quad_perm:[0,0,0,0] row_mask:0xf bank_mask:0xf
    v_mov_b32_dpp v124, v98 quad_perm:[2,2,2,2] row_mask:0xf bank_mask:0xf
    s_nop 0
    v_add_f32_dpp v122, v97, v122 quad_perm:[1,1,1,1] row_mask:0xf bank_mask:0xf
    v_add_f32_dpp v124, v99, v124 quad_perm:[3,3,3,3] row_mask:0xf bank_mask:0xf
    v_add_f32 v122, v122, v124
    v_max_f32 v65, v65, v122
    ds_write_b32 v64, v122 offset:1280
    v_mfma_f32_16x16x32_bf16 v[112:115], v[236:239], v[92:95], v[112:115]
    s_waitcnt vmcnt(7)
    buffer_load_dwordx4 a[56:59], v76, s[52:55], s85 offen offset:1024 nt
    v_mfma_f32_16x16x32_bf16 v[96:99], v[240:243], v[80:83], 0
    v_mfma_f32_16x16x32_bf16 v[96:99], v[244:247], v[84:87], v[96:99]
    v_mfma_f32_16x16x32_bf16 v[96:99], v[248:251], v[88:91], v[96:99]
    s_nop 2
    v_mov_b32_dpp v122, v112 quad_perm:[0,0,0,0] row_mask:0xf bank_mask:0xf
    v_mov_b32_dpp v124, v114 quad_perm:[2,2,2,2] row_mask:0xf bank_mask:0xf
    s_nop 0
    v_add_f32_dpp v122, v113, v122 quad_perm:[1,1,1,1] row_mask:0xf bank_mask:0xf
    v_add_f32_dpp v124, v115, v124 quad_perm:[3,3,3,3] row_mask:0xf bank_mask:0xf
    v_add_f32 v122, v122, v124
    v_max_f32 v65, v65, v122
    ds_write_b32 v64, v122 offset:1536
    v_lshlrev_b32 v4, 2, v2
    v_xor_b32 v4, v4, v3
    v_xor_b32 v5, 0, v4
    v_lshlrev_b32 v5, 4, v5
    v_lshl_add_u32 v20, v2, 10, v5
    v_xor_b32 v5, 1, v4
    v_lshlrev_b32 v5, 4, v5
    v_lshl_add_u32 v21, v2, 10, v5
    v_add_u32 v21, 3072, v21
    v_xor_b32 v5, 2, v4
    v_lshlrev_b32 v5, 4, v5
    v_lshl_add_u32 v22, v2, 10, v5
    v_add_u32 v22, 6144, v22
    v_xor_b32 v5, 3, v4
    v_lshlrev_b32 v5, 4, v5
    v_lshl_add_u32 v23, v2, 10, v5
    v_add_u32 v23, 9216, v23
    s_lshl_b32 s38, s32, 15
    s_add_u32 s47, s38, 1048576
    s_lshl_b32 s38, s3, 13
    s_add_u32 s47, s38, s47
    s_mul_i32 s38, s3, 320
    s_add_u32 s38, s38, 135168
    v_lshlrev_b32 v4, 6, v2
    v_lshl_add_u32 v4, v3, 1, v4
    v_add_u32 v31, s38, v4
    s_waitcnt vmcnt(7)
    buffer_load_dwordx4 a[60:63], v77, s[52:55], s85 offen offset:1024 nt
    s_add_u32 s87, s87, 7
    s_add_u32 s39, s87, s88
    s_bfe_u32 s37, s39, 0x30000
    s_lshl_b32 s37, s37, 12
    s_add_u32 s85, s37, s89
    s_bfe_u32 s37, s39, 0x10003
    s_lshl_b32 s37, s37, 11
    s_add_u32 s85, s37, s85
    s_bfe_u32 s37, s39, 0x40004
    s_lshl_b32 s37, s37, 16
    s_add_u32 s85, s37, s85
    v_mfma_f32_16x16x32_bf16 v[96:99], v[252:255], v[92:95], v[96:99]
    v_mfma_f32_16x16x32_bf16 v[112:115], a[0:3], v[80:83], 0
    s_waitcnt vmcnt(5)
    buffer_load_dwordx4 v[128:131], v76, s[52:55], s85 offen offset:0 nt
    v_mfma_f32_16x16x32_bf16 v[112:115], a[4:7], v[84:87], v[112:115]
    v_mfma_f32_16x16x32_bf16 v[112:115], a[8:11], v[88:91], v[112:115]
    s_nop 2
    v_mov_b32_dpp v122, v96 quad_perm:[0,0,0,0] row_mask:0xf bank_mask:0xf
    v_mov_b32_dpp v124, v98 quad_perm:[2,2,2,2] row_mask:0xf bank_mask:0xf
    s_nop 0
    v_add_f32_dpp v122, v97, v122 quad_perm:[1,1,1,1] row_mask:0xf bank_mask:0xf
    v_add_f32_dpp v124, v99, v124 quad_perm:[3,3,3,3] row_mask:0xf bank_mask:0xf
    v_add_f32 v122, v122, v124
    v_max_f32 v65, v65, v122
    ds_write_b32 v64, v122 offset:1792
    v_mfma_f32_16x16x32_bf16 v[112:115], a[12:15], v[92:95], v[112:115]
    s_waitcnt vmcnt(5)
    buffer_load_dwordx4 v[132:135], v77, s[52:55], s85 offen offset:0 nt
    v_mfma_f32_16x16x32_bf16 v[96:99], a[16:19], v[80:83], 0
    v_lshlrev_b32 v4, 11, v2
    v_bfe_u32 v5, v1, 2, 2
    v_lshl_add_u32 v4, v5, 8, v4
    v_bfe_u32 v5, v1, 2, 2
    v_lshl_add_u32 v4, v5, 6, v4
    v_bfe_u32 v5, v1, 4, 1
    v_lshl_add_u32 v4, v5, 5, v4
    v_bfe_u32 v5, v1, 1, 1
    v_lshl_add_u32 v4, v5, 4, v4
    v_bfe_u32 v5, v1, 0, 1
    v_lshl_add_u32 v4, v5, 3, v4
    s_lshl_b32 s38, s34, 6
    s_add_u32 s38, s38, 98304
    v_xor_b32 v24, s38, v4
    v_xor_b32 v25, 16, v24
    v_xor_b32 v26, 32, v24
    v_xor_b32 v27, 48, v24
    v_and_b32 v4, 3, v3
    v_lshrrev_b32 v5, 2, v3
    v_lshlrev_b32 v6, 4, v2
    v_add_u32 v6, 135168, v6
    s_movk_i32 s36, 320
    v_cmp_eq_u32 vcc, 0, v5
    s_nop 1
    v_cndmask_b32 v28, 4, v4, vcc
    v_mad_u32_u24 v28, v28, s36, v6
    v_cmp_eq_u32 vcc, 1, v5
    s_nop 1
    v_cndmask_b32 v29, 4, v4, vcc
    v_mad_u32_u24 v29, v29, s36, v6
    v_lshlrev_b32 v5, 2, v1
    v_add_u32 v5, 136448, v5
    v_mov_b32 v6, 0
    ds_write_b32 v5, v6
    v_mfma_f32_16x16x32_bf16 v[96:99], a[20:23], v[84:87], v[96:99]
    s_waitcnt vmcnt(5)
    buffer_load_dwordx4 v[136:139], v76, s[52:55], s85 offen offset:1024 nt
    v_mfma_f32_16x16x32_bf16 v[96:99], a[24:27], v[88:91], v[96:99]
    v_mov_b32_dpp v122, v112 quad_perm:[0,0,0,0] row_mask:0xf bank_mask:0xf
    v_mov_b32_dpp v124, v114 quad_perm:[2,2,2,2] row_mask:0xf bank_mask:0xf
    s_nop 0
    v_add_f32_dpp v122, v113, v122 quad_perm:[1,1,1,1] row_mask:0xf bank_mask:0xf
    v_add_f32_dpp v124, v115, v124 quad_perm:[3,3,3,3] row_mask:0xf bank_mask:0xf
    v_add_f32 v122, v122, v124
    v_max_f32 v65, v65, v122
    ds_write_b32 v64, v122 offset:2048
    v_mfma_f32_16x16x32_bf16 v[96:99], a[28:31], v[92:95], v[96:99]
    s_waitcnt vmcnt(5)
    buffer_load_dwordx4 v[140:143], v77, s[52:55], s85 offen offset:1024 nt
    s_add_u32 s87, s87, 7
    s_add_u32 s39, s87, s88
    s_bfe_u32 s37, s39, 0x30000
    s_lshl_b32 s37, s37, 12
    s_add_u32 s85, s37, s89
    s_bfe_u32 s37, s39, 0x10003
    s_lshl_b32 s37, s37, 11
    s_add_u32 s85, s37, s85
    s_bfe_u32 s37, s39, 0x40004
    s_lshl_b32 s37, s37, 16
    s_add_u32 s85, s37, s85
    v_mfma_f32_16x16x32_bf16 v[112:115], a[32:35], v[80:83], 0
    v_mfma_f32_16x16x32_bf16 v[112:115], a[36:39], v[84:87], v[112:115]
    v_mfma_f32_16x16x32_bf16 v[112:115], a[40:43], v[88:91], v[112:115]
    v_mov_b32_dpp v122, v96 quad_perm:[0,0,0,0] row_mask:0xf bank_mask:0xf
    v_mov_b32_dpp v124, v98 quad_perm:[2,2,2,2] row_mask:0xf bank_mask:0xf
    s_nop 0
    v_add_f32_dpp v122, v97, v122 quad_perm:[1,1,1,1] row_mask:0xf bank_mask:0xf
    v_add_f32_dpp v124, v99, v124 quad_perm:[3,3,3,3] row_mask:0xf bank_mask:0xf
    v_add_f32 v122, v122, v124
    v_max_f32 v65, v65, v122
    ds_write_b32 v64, v122 offset:2304
    v_lshlrev_b32 v30, 4, v3
    v_lshl_add_u32 v30, v2, 13, v30
    s_lshl_b32 s38, s32, 13
    s_add_u32 s36, s38, 0
    s_lshl_b32 s38, s34, 6
    s_add_u32 s36, s38, s36
    v_lshrrev_b32 v5, 2, v1
    v_lshlrev_b32 v32, 8, v5
    v_bfe_u32 v5, v1, 0, 2
    v_lshl_add_u32 v32, v5, 4, v32
    v_add_u32 v32, s36, v32
    s_lshr_b32 s38, s32, 2
    s_lshl_b32 s38, s38, 7
    s_add_u32 s36, s38, 0
    s_lshl_b32 s38, s34, 5
    s_add_u32 s36, s38, s36
    s_bfe_u32 s38, s32, 0x20000
    s_lshl_b32 s38, s38, 3
    s_add_u32 s36, s38, s36
    v_bfe_u32 v5, v1, 0, 2
    v_lshlrev_b32 v33, 11, v5
    v_lshl_add_u32 v33, v2, 1, v33
    v_add_u32 v33, s36, v33
    v_and_b32 v5, 31, v1
    v_lshlrev_b32 v34, 4, v5
    s_mul_i32 s38, s34, 320
    s_add_u32 s38, s38, 135168
    v_lshl_add_u32 v35, v5, 3, s38
    s_waitcnt vmcnt(5)
    buffer_load_dwordx4 v[144:147], v76, s[52:55], s85 offen offset:0 nt
    v_mfma_f32_16x16x32_bf16 v[112:115], a[44:47], v[92:95], v[112:115]
    v_mfma_f32_16x16x32_bf16 v[96:99], a[48:51], v[80:83], 0
    s_waitcnt vmcnt(5)
    buffer_load_dwordx4 v[148:151], v77, s[52:55], s85 offen offset:0 nt
    v_mfma_f32_16x16x32_bf16 v[96:99], a[52:55], v[84:87], v[96:99]
    v_mfma_f32_16x16x32_bf16 v[96:99], a[56:59], v[88:91], v[96:99]
    s_nop 2
    v_mov_b32_dpp v122, v112 quad_perm:[0,0,0,0] row_mask:0xf bank_mask:0xf
    v_mov_b32_dpp v124, v114 quad_perm:[2,2,2,2] row_mask:0xf bank_mask:0xf
    s_nop 0
    v_add_f32_dpp v122, v113, v122 quad_perm:[1,1,1,1] row_mask:0xf bank_mask:0xf
    v_add_f32_dpp v124, v115, v124 quad_perm:[3,3,3,3] row_mask:0xf bank_mask:0xf
    v_add_f32 v122, v122, v124
    v_max_f32 v65, v65, v122
    ds_write_b32 v64, v122 offset:2560
    v_mfma_f32_16x16x32_bf16 v[96:99], a[60:63], v[92:95], v[96:99]
    v_add_u32 v64, 2816, v64
    s_mov_b32 s97, 10
    s_mov_b32 s86, 32
    s_mov_b32 s66, 134217728
    s_mov_b32 s67, 0x20000
    s_mov_b64 s[64:65], s[52:53]
    v_mov_b32 v62, v76
    v_mov_b32 v63, v77
    s_branch L_bloop
L_aux:
    v_lshlrev_b32 v4, 2, v2
    v_xor_b32 v4, v4, v3
    v_xor_b32 v96, 0, v4
    v_lshlrev_b32 v96, 4, v96
    v_lshl_add_u32 v10, v2, 13, v96
    v_xor_b32 v97, 1, v4
    v_lshlrev_b32 v97, 4, v97
    v_lshl_add_u32 v11, v2, 13, v97
    v_add_u32 v11, 31744, v11
    v_xor_b32 v98, 2, v4
    v_lshlrev_b32 v98, 4, v98
    v_lshl_add_u32 v12, v2, 13, v98
    v_add_u32 v12, 63488, v12
    v_xor_b32 v99, 3, v4
    v_lshlrev_b32 v99, 4, v99
    v_lshl_add_u32 v13, v2, 13, v99
    v_add_u32 v13, 95232, v13
    s_lshl_b32 s90, s34, 15
    s_mov_b32 s62, 0
    s_mov_b32 s94, 0
    s_lshl_b32 s95, s34, 20
    s_lshl_b32 s38, s32, 8
    s_add_u32 s95, s95, s38
    s_waitcnt lgkmcnt(0)
    s_mov_b32 s52, s12
    s_and_b32 s53, s13, 0xffff
    s_mov_b32 s54, 4194304
    s_mov_b32 s55, 0x20000
    s_add_u32 s39, s90, s62
    s_mov_b32 m0, s39
    s_add_u32 s62, s62, 4096
    s_and_b32 s62, s62, 0x7fff
    buffer_load_dwordx4 v10, s[52:55], s95 offen offset:0 nt lds
    buffer_load_dwordx4 v11, s[52:55], s95 offen offset:1024 nt lds
    buffer_load_dwordx4 v12, s[52:55], s95 offen offset:2048 nt lds
    buffer_load_dwordx4 v13, s[52:55], s95 offen offset:3072 nt lds
    s_add_u32 s95, s95, 131072
    s_add_u32 s39, s90, s62
    s_mov_b32 m0, s39
    s_add_u32 s62, s62, 4096
    s_and_b32 s62, s62, 0x7fff
    buffer_load_dwordx4 v10, s[52:55], s95 offen offset:0 nt lds
    buffer_load_dwordx4 v11, s[52:55], s95 offen offset:1024 nt lds
    buffer_load_dwordx4 v12, s[52:55], s95 offen offset:2048 nt lds
    buffer_load_dwordx4 v13, s[52:55], s95 offen offset:3072 nt lds
    s_add_u32 s95, s95, 131072
    s_load_dword s35, s[30:31], 0
    s_mov_b32 s48, s30
    s_and_b32 s49, s31, 0xffff
    s_mov_b32 s50, 8388608
    s_mov_b32 s51, 0x20000
    s_mov_b32 s82, 0xffffff00
    s_mov_b32 s83, 0x3e0293ee
    s_mov_b32 s84, 2097152
    v_lshl_add_u32 v76, v2, 10, v96
    v_lshl_add_u32 v96, v2, 8, v96
    v_lshl_add_u32 v77, v2, 10, v97
    v_lshl_add_u32 v97, v2, 8, v97
    v_add_u32 v77, 3072, v77
    v_lshl_add_u32 v78, v2, 10, v98
    v_lshl_add_u32 v98, v2, 8, v98
    v_add_u32 v78, 6144, v78
    v_lshl_add_u32 v79, v2, 10, v99
    v_lshl_add_u32 v99, v2, 8, v99
    v_add_u32 v79, 9216, v79
    v_bfe_u32 v100, v1, 0, 5
    v_lshlrev_b32 v101, 8, v100
    v_mov_b32 v100, 0
    s_lshl_b32 s38, s34, 13
    v_add_u32 v101, s38, v101
    v_lshlrev_b32 v4, 4, v3
    v_lshl_add_u32 v9, v2, 10, v4
    v_and_b32 v4, 3, v1
    v_bfe_u32 v5, v1, 2, 2
    v_lshrrev_b32 v6, 5, v1
    v_lshl_add_u32 v7, v4, 2, v5
    v_xor_b32 v7, v7, v6
    v_lshlrev_b32 v7, 4, v7
    v_and_b32 v80, 31, v1
    v_lshl_add_u32 v80, v80, 8, v7
    v_lshl_add_u32 v81, v6, 2, v5
    v_lshlrev_b32 v81, 8, v81
    v_lshl_add_u32 v81, v5, 6, v81
    v_bfe_u32 v7, v1, 4, 1
    v_lshlrev_b32 v7, 1, v7
    v_bfe_u32 v82, v1, 1, 1
    v_add_u32 v7, v7, v82
    v_xor_b32 v7, v7, v6
    v_lshl_add_u32 v81, v7, 4, v81
    v_and_b32 v7, 1, v1
    v_lshl_add_u32 v81, v7, 3, v81
    v_lshl_add_u32 v95, v2, 3, v5
    v_lshlrev_b32 v95, 8, v95
    v_lshl_add_u32 v95, v5, 6, v95
    v_bfe_u32 v4, v1, 4, 1
    v_lshl_add_u32 v4, v4, 1, v82
    v_lshl_add_u32 v95, v4, 4, v95
    v_lshl_add_u32 v95, v7, 3, v95
    v_add_u32 v95, s90, v95
    v_xor_b32 v136, 0, v95
    v_xor_b32 v137, 16, v95
    v_xor_b32 v138, 32, v95
    v_xor_b32 v139, 48, v95
    v_xor_b32 v140, 64, v95
    v_xor_b32 v141, 80, v95
    v_xor_b32 v142, 96, v95
    v_xor_b32 v143, 112, v95
    v_xor_b32 v144, 128, v95
    v_xor_b32 v145, 144, v95
    v_xor_b32 v146, 160, v95
    v_xor_b32 v147, 176, v95
    v_xor_b32 v148, 192, v95
    v_xor_b32 v149, 208, v95
    v_xor_b32 v150, 224, v95
    v_xor_b32 v151, 240, v95
    s_lshl_b32 s85, s34, 13
    s_add_u32 s85, s85, 131072
    v_lshl_add_u32 v94, v1, 4, s85
    v_add_u32 v96, s85, v96
    v_add_u32 v97, s85, v97
    v_add_u32 v98, s85, v98
    v_add_u32 v99, s85, v99
    s_add_u32 s39, s90, s62
    s_mov_b32 m0, s39
    s_add_u32 s62, s62, 4096
    s_and_b32 s62, s62, 0x7fff
    buffer_load_dwordx4 v10, s[52:55], s95 offen offset:0 nt lds
    buffer_load_dwordx4 v11, s[52:55], s95 offen offset:1024 nt lds
    buffer_load_dwordx4 v12, s[52:55], s95 offen offset:2048 nt lds
    buffer_load_dwordx4 v13, s[52:55], s95 offen offset:3072 nt lds
    s_add_u32 s95, s95, 131072
    s_add_u32 s39, s90, s62
    s_mov_b32 m0, s39
    s_add_u32 s62, s62, 4096
    s_and_b32 s62, s62, 0x7fff
    buffer_load_dwordx4 v10, s[52:55], s95 offen offset:0 nt lds
    buffer_load_dwordx4 v11, s[52:55], s95 offen offset:1024 nt lds
    buffer_load_dwordx4 v12, s[52:55], s95 offen offset:2048 nt lds
    buffer_load_dwordx4 v13, s[52:55], s95 offen offset:3072 nt lds
    s_add_u32 s95, s95, 131072
    s_add_u32 s39, s90, s62
    s_mov_b32 m0, s39
    s_add_u32 s62, s62, 4096
    s_and_b32 s62, s62, 0x7fff
    buffer_load_dwordx4 v10, s[52:55], s95 offen offset:0 nt lds
    buffer_load_dwordx4 v11, s[52:55], s95 offen offset:1024 nt lds
    buffer_load_dwordx4 v12, s[52:55], s95 offen offset:2048 nt lds
    buffer_load_dwordx4 v13, s[52:55], s95 offen offset:3072 nt lds
    s_add_u32 s95, s95, 131072
    s_add_u32 s39, s90, s62
    s_mov_b32 m0, s39
    s_add_u32 s62, s62, 4096
    s_and_b32 s62, s62, 0x7fff
    buffer_load_dwordx4 v10, s[52:55], s95 offen offset:0 nt lds
    buffer_load_dwordx4 v11, s[52:55], s95 offen offset:1024 nt lds
    buffer_load_dwordx4 v12, s[52:55], s95 offen offset:2048 nt lds
    buffer_load_dwordx4 v13, s[52:55], s95 offen offset:3072 nt lds
    s_add_u32 s95, s95, 131072
    s_add_u32 s39, s90, s62
    s_mov_b32 m0, s39
    s_add_u32 s62, s62, 4096
    s_and_b32 s62, s62, 0x7fff
    buffer_load_dwordx4 v10, s[52:55], s95 offen offset:0 nt lds
    buffer_load_dwordx4 v11, s[52:55], s95 offen offset:1024 nt lds
    buffer_load_dwordx4 v12, s[52:55], s95 offen offset:2048 nt lds
    buffer_load_dwordx4 v13, s[52:55], s95 offen offset:3072 nt lds
    s_add_u32 s95, s95, 131072
    s_add_u32 s39, s90, s62
    s_mov_b32 m0, s39
    s_add_u32 s62, s62, 4096
    s_and_b32 s62, s62, 0x7fff
    buffer_load_dwordx4 v10, s[52:55], s95 offen offset:0 nt lds
    buffer_load_dwordx4 v11, s[52:55], s95 offen offset:1024 nt lds
    buffer_load_dwordx4 v12, s[52:55], s95 offen offset:2048 nt lds
    buffer_load_dwordx4 v13, s[52:55], s95 offen offset:3072 nt lds
    s_add_u32 s95, s95, 131072
    s_waitcnt lgkmcnt(0)
    s_add_u32 s35, s35, 0x5b
    s_and_b32 s35, s35, 0xff
    v_mov_b32 v8, s35
    s_or_b32 s68, s35, 0x6b3ac500
    s_mov_b32 s52, s6
    s_and_b32 s53, s7, 0xffff
    s_mov_b32 s54, 16777216
    s_mov_b32 s55, 0x20000
    s_bfe_u32 s38, s32, 0x30000
    s_lshl_b32 s38, s38, 2
    s_add_u32 s3, s38, 0
    s_lshr_b32 s38, s32, 3
    s_lshl_b32 s38, s38, 0
    s_add_u32 s3, s38, s3
    s_lshl_b32 s38, s3, 19
    s_add_u32 s95, s38, 0
    s_lshl_b32 s38, s34, 8
    s_add_u32 s95, s38, s95
    s_waitcnt vmcnt(24)
    ds_read_b64_tr_b16 a[128:129], v136 offset:0
    ds_read_b64_tr_b16 a[130:131], v137 offset:1024
    ds_read_b64_tr_b16 a[144:145], v138 offset:0
    ds_read_b64_tr_b16 a[146:147], v139 offset:1024
    ds_read_b64_tr_b16 a[160:161], v140 offset:0
    ds_read_b64_tr_b16 a[162:163], v141 offset:1024
    ds_read_b64_tr_b16 a[176:177], v142 offset:0
    ds_read_b64_tr_b16 a[178:179], v143 offset:1024
    ds_read_b64_tr_b16 a[192:193], v144 offset:0
    ds_read_b64_tr_b16 a[194:195], v145 offset:1024
    ds_read_b64_tr_b16 a[208:209], v146 offset:0
    ds_read_b64_tr_b16 a[210:211], v147 offset:1024
    ds_read_b64_tr_b16 a[224:225], v148 offset:0
    ds_read_b64_tr_b16 a[226:227], v149 offset:1024
    ds_read_b64_tr_b16 a[240:241], v150 offset:0
    ds_read_b64_tr_b16 a[242:243], v151 offset:1024
    s_waitcnt lgkmcnt(0)
    s_add_u32 s39, s90, s62
    s_mov_b32 m0, s39
    s_add_u32 s62, s62, 4096
    s_and_b32 s62, s62, 0x7fff
    buffer_load_dwordx4 v76, s[52:55], s95 offen offset:0 nt lds
    buffer_load_dwordx4 v77, s[52:55], s95 offen offset:1024 nt lds
    buffer_load_dwordx4 v78, s[52:55], s95 offen offset:2048 nt lds
    buffer_load_dwordx4 v79, s[52:55], s95 offen offset:3072 nt lds
    s_add_u32 s95, s95, 16384
    s_add_u32 s39, s90, s62
    s_mov_b32 m0, s39
    s_add_u32 s62, s62, 4096
    s_and_b32 s62, s62, 0x7fff
    buffer_load_dwordx4 v76, s[52:55], s95 offen offset:0 nt lds
    buffer_load_dwordx4 v77, s[52:55], s95 offen offset:1024 nt lds
    buffer_load_dwordx4 v78, s[52:55], s95 offen offset:2048 nt lds
    buffer_load_dwordx4 v79, s[52:55], s95 offen offset:3072 nt lds
    s_add_u32 s95, s95, 16384
    s_waitcnt vmcnt(24)
    ds_read_b64_tr_b16 a[132:133], v136 offset:8192
    ds_read_b64_tr_b16 a[134:135], v137 offset:9216
    ds_read_b64_tr_b16 a[148:149], v138 offset:8192
    ds_read_b64_tr_b16 a[150:151], v139 offset:9216
    ds_read_b64_tr_b16 a[164:165], v140 offset:8192
    ds_read_b64_tr_b16 a[166:167], v141 offset:9216
    ds_read_b64_tr_b16 a[180:181], v142 offset:8192
    ds_read_b64_tr_b16 a[182:183], v143 offset:9216
    ds_read_b64_tr_b16 a[196:197], v144 offset:8192
    ds_read_b64_tr_b16 a[198:199], v145 offset:9216
    ds_read_b64_tr_b16 a[212:213], v146 offset:8192
    ds_read_b64_tr_b16 a[214:215], v147 offset:9216
    ds_read_b64_tr_b16 a[228:229], v148 offset:8192
    ds_read_b64_tr_b16 a[230:231], v149 offset:9216
    ds_read_b64_tr_b16 a[244:245], v150 offset:8192
    ds_read_b64_tr_b16 a[246:247], v151 offset:9216
    s_waitcnt lgkmcnt(0)
    s_add_u32 s39, s90, s62
    s_mov_b32 m0, s39
    s_add_u32 s62, s62, 4096
    s_and_b32 s62, s62, 0x7fff
    buffer_load_dwordx4 v76, s[52:55], s95 offen offset:0 nt lds
    buffer_load_dwordx4 v77, s[52:55], s95 offen offset:1024 nt lds
    buffer_load_dwordx4 v78, s[52:55], s95 offen offset:2048 nt lds
    buffer_load_dwordx4 v79, s[52:55], s95 offen offset:3072 nt lds
    s_add_u32 s95, s95, 16384
    s_add_u32 s39, s90, s62
    s_mov_b32 m0, s39
    s_add_u32 s62, s62, 4096
    s_and_b32 s62, s62, 0x7fff
    buffer_load_dwordx4 v76, s[52:55], s95 offen offset:0 nt lds
    buffer_load_dwordx4 v77, s[52:55], s95 offen offset:1024 nt lds
    buffer_load_dwordx4 v78, s[52:55], s95 offen offset:2048 nt lds
    buffer_load_dwordx4 v79, s[52:55], s95 offen offset:3072 nt lds
    s_add_u32 s95, s95, 16384
    s_waitcnt vmcnt(24)
    ds_read_b64_tr_b16 a[136:137], v136 offset:16384
    ds_read_b64_tr_b16 a[138:139], v137 offset:17408
    ds_read_b64_tr_b16 a[152:153], v138 offset:16384
    ds_read_b64_tr_b16 a[154:155], v139 offset:17408
    ds_read_b64_tr_b16 a[168:169], v140 offset:16384
    ds_read_b64_tr_b16 a[170:171], v141 offset:17408
    ds_read_b64_tr_b16 a[184:185], v142 offset:16384
    ds_read_b64_tr_b16 a[186:187], v143 offset:17408
    ds_read_b64_tr_b16 a[200:201], v144 offset:16384
    ds_read_b64_tr_b16 a[202:203], v145 offset:17408
    ds_read_b64_tr_b16 a[216:217], v146 offset:16384
    ds_read_b64_tr_b16 a[218:219], v147 offset:17408
    ds_read_b64_tr_b16 a[232:233], v148 offset:16384
    ds_read_b64_tr_b16 a[234:235], v149 offset:17408
    ds_read_b64_tr_b16 a[248:249], v150 offset:16384
    ds_read_b64_tr_b16 a[250:251], v151 offset:17408
    s_waitcnt lgkmcnt(0)
    s_add_u32 s39, s90, s62
    s_mov_b32 m0, s39
    s_add_u32 s62, s62, 4096
    s_and_b32 s62, s62, 0x7fff
    buffer_load_dwordx4 v76, s[52:55], s95 offen offset:0 nt lds
    buffer_load_dwordx4 v77, s[52:55], s95 offen offset:1024 nt lds
    buffer_load_dwordx4 v78, s[52:55], s95 offen offset:2048 nt lds
    buffer_load_dwordx4 v79, s[52:55], s95 offen offset:3072 nt lds
    s_add_u32 s95, s95, 16384
    s_add_u32 s39, s90, s62
    s_mov_b32 m0, s39
    s_add_u32 s62, s62, 4096
    s_and_b32 s62, s62, 0x7fff
    buffer_load_dwordx4 v76, s[52:55], s95 offen offset:0 nt lds
    buffer_load_dwordx4 v77, s[52:55], s95 offen offset:1024 nt lds
    buffer_load_dwordx4 v78, s[52:55], s95 offen offset:2048 nt lds
    buffer_load_dwordx4 v79, s[52:55], s95 offen offset:3072 nt lds
    s_add_u32 s95, s95, 16384
    s_waitcnt vmcnt(24)
    ds_read_b64_tr_b16 a[140:141], v136 offset:24576
    ds_read_b64_tr_b16 a[142:143], v137 offset:25600
    ds_read_b64_tr_b16 a[156:157], v138 offset:24576
    ds_read_b64_tr_b16 a[158:159], v139 offset:25600
    ds_read_b64_tr_b16 a[172:173], v140 offset:24576
    ds_read_b64_tr_b16 a[174:175], v141 offset:25600
    ds_read_b64_tr_b16 a[188:189], v142 offset:24576
    ds_read_b64_tr_b16 a[190:191], v143 offset:25600
    ds_read_b64_tr_b16 a[204:205], v144 offset:24576
    ds_read_b64_tr_b16 a[206:207], v145 offset:25600
    ds_read_b64_tr_b16 a[220:221], v146 offset:24576
    ds_read_b64_tr_b16 a[222:223], v147 offset:25600
    ds_read_b64_tr_b16 a[236:237], v148 offset:24576
    ds_read_b64_tr_b16 a[238:239], v149 offset:25600
    ds_read_b64_tr_b16 a[252:253], v150 offset:24576
    ds_read_b64_tr_b16 a[254:255], v151 offset:25600
    s_waitcnt lgkmcnt(0)
    s_mov_b32 s86, 98304
    buffer_load_dword v7, v101, s[48:51], s86 offen sc1
    s_add_u32 s39, s90, s62
    s_mov_b32 m0, s39
    s_add_u32 s62, s62, 4096
    s_and_b32 s62, s62, 0x7fff
    buffer_load_dwordx4 v76, s[52:55], s95 offen offset:0 nt lds
    buffer_load_dwordx4 v77, s[52:55], s95 offen offset:1024 nt lds
    buffer_load_dwordx4 v78, s[52:55], s95 offen offset:2048 nt lds
    buffer_load_dwordx4 v79, s[52:55], s95 offen offset:3072 nt lds
    s_add_u32 s95, s95, 16384
    s_add_u32 s39, s90, s62
    s_mov_b32 m0, s39
    s_add_u32 s62, s62, 4096
    s_and_b32 s62, s62, 0x7fff
    buffer_load_dwordx4 v76, s[52:55], s95 offen offset:0 nt lds
    v_mov_b32 v136, 0
    v_mov_b32 v137, 0
    v_mov_b32 v138, 0
    v_mov_b32 v139, 0
    v_mov_b32 v140, 0
    v_mov_b32 v141, 0
    v_mov_b32 v142, 0
    v_mov_b32 v143, 0
    v_mov_b32 v144, 0
    v_mov_b32 v145, 0
    v_mov_b32 v146, 0
    v_mov_b32 v147, 0
    v_mov_b32 v148, 0
    v_mov_b32 v149, 0
    v_mov_b32 v150, 0
    v_mov_b32 v151, 0
    v_mov_b32 v152, 0
    v_mov_b32 v153, 0
    v_mov_b32 v154, 0
    v_mov_b32 v155, 0
    v_mov_b32 v156, 0
    v_mov_b32 v157, 0
    v_mov_b32 v158, 0
    v_mov_b32 v159, 0
    v_mov_b32 v160, 0
    v_mov_b32 v161, 0
    v_mov_b32 v162, 0
    v_mov_b32 v163, 0
    v_mov_b32 v164, 0
    v_mov_b32 v165, 0
    v_mov_b32 v166, 0
    v_mov_b32 v167, 0
    v_mov_b32 v168, 0
    v_mov_b32 v169, 0
    v_mov_b32 v170, 0
    v_mov_b32 v171, 0
    v_mov_b32 v172, 0
    v_mov_b32 v173, 0
    v_mov_b32 v174, 0
    v_mov_b32 v175, 0
    v_mov_b32 v176, 0
    v_mov_b32 v177, 0
    v_mov_b32 v178, 0
    v_mov_b32 v179, 0
    v_mov_b32 v180, 0
    v_mov_b32 v181, 0
    v_mov_b32 v182, 0
    v_mov_b32 v183, 0
    v_mov_b32 v184, 0
    v_mov_b32 v185, 0
    v_mov_b32 v186, 0
    v_mov_b32 v187, 0
    v_mov_b32 v188, 0
    v_mov_b32 v189, 0
    v_mov_b32 v190, 0
    v_mov_b32 v191, 0
    v_mov_b32 v192, 0
    v_mov_b32 v193, 0
    v_mov_b32 v194, 0
    v_mov_b32 v195, 0
    v_mov_b32 v196, 0
    v_mov_b32 v197, 0
    v_mov_b32 v198, 0
    v_mov_b32 v199, 0
    v_mov_b32 v90, 0xff7f0000
    s_mov_b32 s93, 0
    v_mov_b32 v102, 0
    v_mov_b32 v103, 0
    s_mov_b32 s60, s83
    s_mov_b32 s61, s83
    v_add_u32 v4, s85, v80
    v_xor_b32 v82, 0, v4
    v_xor_b32 v83, 32, v4
    v_xor_b32 v84, 64, v4
    v_xor_b32 v85, 96, v4
    v_xor_b32 v86, 128, v4
    v_xor_b32 v87, 160, v4
    v_xor_b32 v88, 192, v4
    v_xor_b32 v89, 224, v4
    v_add_u32 v80, s90, v80
    v_add_u32 v81, s90, v81
    s_lshr_b32 s38, s3, 3
    s_lshl_b32 s38, s38, 15
    s_add_u32 s36, s38, 393216
    s_lshl_b32 s38, s34, 8
    s_add_u32 s36, s38, s36
    s_waitcnt vmcnt(5)
L_fcheck_23:
    v_cmp_ne_u32 vcc, s68, v7
    s_cbranch_vccz L_fok_24
    s_sleep 2
    s_mov_b32 s86, 98304
    buffer_load_dword v7, v101, s[48:51], s86 offen sc1
    s_waitcnt vmcnt(0)
    s_sub_u32 s84, s84, 1
    s_cmp_lg_u32 s84, 0
    s_cbranch_scc1 L_fcheck_23
    s_branch L_end
L_fok_24:
    buffer_load_dwordx4 v[20:23], v9, s[48:51], s36 offen sc1
    s_add_u32 s36, s36, 4096
    buffer_load_dwordx4 v[24:27], v9, s[48:51], s36 offen sc1
    s_add_u32 s36, s36, 4096
    buffer_load_dwordx4 v[28:31], v9, s[48:51], s36 offen sc1
    s_add_u32 s36, s36, 4096
    buffer_load_dwordx4 v[32:35], v9, s[48:51], s36 offen sc1
    s_add_u32 s36, s36, 4096
    buffer_load_dwordx4 v[36:39], v9, s[48:51], s36 offen sc1
    s_add_u32 s36, s36, 4096
    buffer_load_dwordx4 v[40:43], v9, s[48:51], s36 offen sc1
    s_add_u32 s36, s36, 4096
    buffer_load_dwordx4 v[44:47], v9, s[48:51], s36 offen sc1
    s_add_u32 s36, s36, 4096
    buffer_load_dwordx4 v[48:51], v9, s[48:51], s36 offen sc1
    s_waitcnt vmcnt(7)
    ds_write_b128 v96, v[20:23] offset:0
    s_waitcnt vmcnt(6)
    ds_write_b128 v97, v[24:27] offset:1024
    s_waitcnt vmcnt(5)
    ds_write_b128 v98, v[28:31] offset:2048
    s_waitcnt vmcnt(4)
    ds_write_b128 v99, v[32:35] offset:3072
    s_waitcnt vmcnt(3)
    ds_write_b128 v96, v[36:39] offset:4096
    s_waitcnt vmcnt(2)
    ds_write_b128 v97, v[40:43] offset:5120
    s_waitcnt vmcnt(1)
    ds_write_b128 v98, v[44:47] offset:6144
    s_waitcnt vmcnt(0)
    ds_write_b128 v99, v[48:51] offset:7168
    s_waitcnt lgkmcnt(0)
    ds_read_b128 v[104:107], v82
    ds_read_b128 v[108:111], v83
    ds_read_b128 v[112:115], v84
    ds_read_b128 v[116:119], v85
    ds_read_b128 v[120:123], v86
    ds_read_b128 v[124:127], v87
    ds_read_b128 v[128:131], v88
    ds_read_b128 v[132:135], v89
    v_xor_b32 v82, 0, v80
    ds_read_b128 v[216:219], v82
    v_xor_b32 v83, 32, v80
    ds_read_b128 v[220:223], v83
    v_xor_b32 v84, 64, v80
    ds_read_b128 v[224:227], v84
    v_xor_b32 v85, 96, v80
    ds_read_b128 v[228:231], v85
    v_xor_b32 v86, 128, v80
    ds_read_b128 v[232:235], v86
    v_xor_b32 v87, 160, v80
    ds_read_b128 v[236:239], v87
    v_xor_b32 v88, 192, v80
    ds_read_b128 v[240:243], v88
    v_xor_b32 v89, 224, v80
    ds_read_b128 v[244:247], v89
L_att:
    v_add_u32 v4, s94, v81
    s_waitcnt lgkmcnt(0)
    v_mfma_f32_32x32x16_bf16 v[200:215], v[216:219], v[104:107], 0
    v_xor_b32 v82, 0, v4
    ds_read_b64_tr_b16 v[20:21], v82 offset:0
    ds_read_b64_tr_b16 v[24:25], v82 offset:4096
    buffer_load_dwordx4 v77, s[52:55], s95 offen offset:1024 nt lds
    v_mfma_f32_32x32x16_bf16 v[200:215], v[220:223], v[108:111], v[200:215]
    v_xor_b32 v83, 32, v4
    ds_read_b64_tr_b16 v[22:23], v83 offset:2048
    ds_read_b64_tr_b16 v[26:27], v83 offset:6144
    v_mfma_f32_32x32x16_bf16 v[200:215], v[224:227], v[112:115], v[200:215]
    v_xor_b32 v84, 64, v4
    ds_read_b64_tr_b16 v[28:29], v84 offset:0
    ds_read_b64_tr_b16 v[32:33], v84 offset:4096
    v_mfma_f32_32x32x16_bf16 v[200:215], v[228:231], v[116:119], v[200:215]
    v_xor_b32 v85, 96, v4
    ds_read_b64_tr_b16 v[30:31], v85 offset:2048
    ds_read_b64_tr_b16 v[34:35], v85 offset:6144
    v_mfma_f32_32x32x16_bf16 v[200:215], v[232:235], v[120:123], v[200:215]
    v_xor_b32 v86, 128, v4
    ds_read_b64_tr_b16 v[36:37], v86 offset:0
    ds_read_b64_tr_b16 v[40:41], v86 offset:4096
    buffer_load_dwordx4 v78, s[52:55], s95 offen offset:2048 nt lds
    v_mfma_f32_32x32x16_bf16 v[200:215], v[236:239], v[124:127], v[200:215]
    v_xor_b32 v87, 160, v4
    ds_read_b64_tr_b16 v[38:39], v87 offset:2048
    ds_read_b64_tr_b16 v[42:43], v87 offset:6144
    v_mfma_f32_32x32x16_bf16 v[200:215], v[240:243], v[128:131], v[200:215]
    v_xor_b32 v88, 192, v4
    ds_read_b64_tr_b16 v[44:45], v88 offset:0
    ds_read_b64_tr_b16 v[48:49], v88 offset:4096
    v_mfma_f32_32x32x16_bf16 v[200:215], v[244:247], v[132:135], v[200:215]
    v_xor_b32 v89, 224, v4
    ds_read_b64_tr_b16 v[46:47], v89 offset:2048
    ds_read_b64_tr_b16 v[50:51], v89 offset:6144
    buffer_load_dwordx4 v79, s[52:55], s95 offen offset:3072 nt lds
    s_add_u32 s95, s95, 16384
    v_xor_b32 v5, 0x2000, v94
    v_xor_b32 v6, 0x4000, v94
    v_xor_b32 v7, 0x6000, v94
    s_cmp_eq_u32 s93, 12
    s_cselect_b32 s95, 16777216, s95
    s_nop 1
    ds_write_b128 v94, v[200:203] offset:0
    ds_write_b128 v94, v[204:207] offset:1024
    ds_write_b128 v94, v[208:211] offset:2048
    ds_write_b128 v94, v[212:215] offset:3072
    s_waitcnt lgkmcnt(0)
    s_barrier
    ds_read_b128 v[60:63], v5 offset:0
    ds_read_b128 v[216:219], v6 offset:0
    ds_read_b128 v[232:235], v7 offset:0
    ds_read_b128 v[64:67], v5 offset:1024
    ds_read_b128 v[220:223], v6 offset:1024
    ds_read_b128 v[236:239], v7 offset:1024
    ds_read_b128 v[68:71], v5 offset:2048
    ds_read_b128 v[224:227], v6 offset:2048
    ds_read_b128 v[240:243], v7 offset:2048
    ds_read_b128 v[72:75], v5 offset:3072
    ds_read_b128 v[228:231], v6 offset:3072
    ds_read_b128 v[244:247], v7 offset:3072
    v_xor_b32 v94, 0x1000, v94
    s_add_u32 s39, s90, s62
    s_mov_b32 m0, s39
    s_add_u32 s62, s62, 4096
    s_and_b32 s62, s62, 0x7fff
    buffer_load_dwordx4 v76, s[52:55], s95 offen offset:0 nt lds
    s_add_u32 s94, s94, 8192
    s_and_b32 s94, s94, 0x7fff
    s_waitcnt lgkmcnt(9)
    v_pk_add_f32 v[200:201], v[200:201], v[60:61]
    v_pk_add_f32 v[216:217], v[216:217], v[232:233]
    v_pk_add_f32 v[202:203], v[202:203], v[62:63]
    v_pk_add_f32 v[218:219], v[218:219], v[234:235]
    v_pk_add_f32 v[200:201], v[200:201], v[216:217]
    v_pk_add_f32 v[202:203], v[202:203], v[218:219]
    s_waitcnt lgkmcnt(6)
    v_pk_add_f32 v[204:205], v[204:205], v[64:65]
    v_pk_add_f32 v[220:221], v[220:221], v[236:237]
    v_pk_add_f32 v[206:207], v[206:207], v[66:67]
    v_pk_add_f32 v[222:223], v[222:223], v[238:239]
    v_pk_add_f32 v[204:205], v[204:205], v[220:221]
    v_pk_add_f32 v[206:207], v[206:207], v[222:223]
    s_waitcnt lgkmcnt(3)
    v_pk_add_f32 v[208:209], v[208:209], v[68:69]
    v_pk_add_f32 v[224:225], v[224:225], v[240:241]
    v_pk_add_f32 v[210:211], v[210:211], v[70:71]
    v_pk_add_f32 v[226:227], v[226:227], v[242:243]
    v_pk_add_f32 v[208:209], v[208:209], v[224:225]
    v_pk_add_f32 v[210:211], v[210:211], v[226:227]
    s_waitcnt lgkmcnt(0)
    v_pk_add_f32 v[212:213], v[212:213], v[72:73]
    v_pk_add_f32 v[228:229], v[228:229], v[244:245]
    v_pk_add_f32 v[214:215], v[214:215], v[74:75]
    v_pk_add_f32 v[230:231], v[230:231], v[246:247]
    v_pk_add_f32 v[212:213], v[212:213], v[228:229]
    v_pk_add_f32 v[214:215], v[214:215], v[230:231]
    buffer_load_dwordx4 v77, s[52:55], s95 offen offset:1024 nt lds
    v_max_f32 v4, v200, v201
    v_max3_f32 v4, v4, v202, v203
    v_max3_f32 v4, v4, v204, v205
    v_max3_f32 v4, v4, v206, v207
    v_max3_f32 v4, v4, v208, v209
    v_max3_f32 v4, v4, v210, v211
    v_max3_f32 v4, v4, v212, v213
    v_max3_f32 v4, v4, v214, v215
    v_mov_b32 v5, v4
    s_nop 1
    v_permlane32_swap_b32 v4, v5
    v_max_f32 v4, v4, v5
    v_mul_f32 v4, s83, v4
    v_max_f32 v4, v4, v90
    v_sub_f32 v92, v90, v4
    v_exp_f32 v92, v92
    v_mov_b32 v90, v4
    v_pk_fma_f32 v[200:201], v[200:201], s[60:61], v[90:91] op_sel_hi:[1,1,0] neg_lo:[0,0,1] neg_hi:[0,0,1]
    v_pk_fma_f32 v[202:203], v[202:203], s[60:61], v[90:91] op_sel_hi:[1,1,0] neg_lo:[0,0,1] neg_hi:[0,0,1]
    v_pk_fma_f32 v[204:205], v[204:205], s[60:61], v[90:91] op_sel_hi:[1,1,0] neg_lo:[0,0,1] neg_hi:[0,0,1]
    v_pk_fma_f32 v[206:207], v[206:207], s[60:61], v[90:91] op_sel_hi:[1,1,0] neg_lo:[0,0,1] neg_hi:[0,0,1]
    v_pk_fma_f32 v[208:209], v[208:209], s[60:61], v[90:91] op_sel_hi:[1,1,0] neg_lo:[0,0,1] neg_hi:[0,0,1]
    v_pk_fma_f32 v[210:211], v[210:211], s[60:61], v[90:91] op_sel_hi:[1,1,0] neg_lo:[0,0,1] neg_hi:[0,0,1]
    v_pk_fma_f32 v[212:213], v[212:213], s[60:61], v[90:91] op_sel_hi:[1,1,0] neg_lo:[0,0,1] neg_hi:[0,0,1]
    v_pk_fma_f32 v[214:215], v[214:215], s[60:61], v[90:91] op_sel_hi:[1,1,0] neg_lo:[0,0,1] neg_hi:[0,0,1]
    v_exp_f32 v200, v200
    v_exp_f32 v201, v201
    v_exp_f32 v202, v202
    v_exp_f32 v203, v203
    v_exp_f32 v204, v204
    buffer_load_dwordx4 v78, s[52:55], s95 offen offset:2048 nt lds
    v_exp_f32 v205, v205
    v_exp_f32 v206, v206
    v_exp_f32 v207, v207
    v_exp_f32 v208, v208
    v_exp_f32 v209, v209
    v_exp_f32 v210, v210
    v_exp_f32 v211, v211
    v_exp_f32 v212, v212
    v_exp_f32 v213, v213
    v_exp_f32 v214, v214
    v_exp_f32 v215, v215
    v_add_u32 v4, s94, v80
    v_pk_mul_f32 v[102:103], v[102:103], v[92:93] op_sel_hi:[1,0]
    v_pk_mul_f32 v[136:137], v[136:137], v[92:93] op_sel_hi:[1,0]
    v_pk_mul_f32 v[138:139], v[138:139], v[92:93] op_sel_hi:[1,0]
    v_pk_mul_f32 v[140:141], v[140:141], v[92:93] op_sel_hi:[1,0]
    v_pk_mul_f32 v[142:143], v[142:143], v[92:93] op_sel_hi:[1,0]
    v_pk_mul_f32 v[144:145], v[144:145], v[92:93] op_sel_hi:[1,0]
    v_pk_mul_f32 v[146:147], v[146:147], v[92:93] op_sel_hi:[1,0]
    v_pk_mul_f32 v[148:149], v[148:149], v[92:93] op_sel_hi:[1,0]
    v_pk_mul_f32 v[150:151], v[150:151], v[92:93] op_sel_hi:[1,0]
    v_pk_mul_f32 v[152:153], v[152:153], v[92:93] op_sel_hi:[1,0]
    v_pk_mul_f32 v[154:155], v[154:155], v[92:93] op_sel_hi:[1,0]
    v_pk_mul_f32 v[156:157], v[156:157], v[92:93] op_sel_hi:[1,0]
    v_pk_mul_f32 v[158:159], v[158:159], v[92:93] op_sel_hi:[1,0]
    v_pk_mul_f32 v[160:161], v[160:161], v[92:93] op_sel_hi:[1,0]
    v_pk_mul_f32 v[162:163], v[162:163], v[92:93] op_sel_hi:[1,0]
    v_pk_mul_f32 v[164:165], v[164:165], v[92:93] op_sel_hi:[1,0]
    v_pk_mul_f32 v[166:167], v[166:167], v[92:93] op_sel_hi:[1,0]
    v_pk_mul_f32 v[168:169], v[168:169], v[92:93] op_sel_hi:[1,0]
    v_pk_mul_f32 v[170:171], v[170:171], v[92:93] op_sel_hi:[1,0]
    v_pk_mul_f32 v[172:173], v[172:173], v[92:93] op_sel_hi:[1,0]
    v_pk_mul_f32 v[174:175], v[174:175], v[92:93] op_sel_hi:[1,0]
    v_pk_mul_f32 v[176:177], v[176:177], v[92:93] op_sel_hi:[1,0]
    buffer_load_dwordx4 v79, s[52:55], s95 offen offset:3072 nt lds
    s_add_u32 s95, s95, 16384
    v_pk_mul_f32 v[178:179], v[178:179], v[92:93] op_sel_hi:[1,0]
    v_pk_mul_f32 v[180:181], v[180:181], v[92:93] op_sel_hi:[1,0]
    v_pk_mul_f32 v[182:183], v[182:183], v[92:93] op_sel_hi:[1,0]
    v_pk_mul_f32 v[184:185], v[184:185], v[92:93] op_sel_hi:[1,0]
    v_pk_mul_f32 v[186:187], v[186:187], v[92:93] op_sel_hi:[1,0]
    v_pk_mul_f32 v[188:189], v[188:189], v[92:93] op_sel_hi:[1,0]
    v_pk_mul_f32 v[190:191], v[190:191], v[92:93] op_sel_hi:[1,0]
    v_pk_mul_f32 v[192:193], v[192:193], v[92:93] op_sel_hi:[1,0]
    v_pk_mul_f32 v[194:195], v[194:195], v[92:93] op_sel_hi:[1,0]
    v_pk_mul_f32 v[196:197], v[196:197], v[92:93] op_sel_hi:[1,0]
    v_pk_mul_f32 v[198:199], v[198:199], v[92:93] op_sel_hi:[1,0]
    v_cvt_pk_bf16_f32 v52, v200, v201
    v_pk_add_f32 v[102:103], v[102:103], v[200:201]
    v_cvt_pk_bf16_f32 v53, v202, v203
    v_pk_add_f32 v[102:103], v[102:103], v[202:203]
    v_cvt_pk_bf16_f32 v54, v204, v205
    v_pk_add_f32 v[102:103], v[102:103], v[204:205]
    v_cvt_pk_bf16_f32 v55, v206, v207
    v_pk_add_f32 v[102:103], v[102:103], v[206:207]
    v_cvt_pk_bf16_f32 v56, v208, v209
    v_pk_add_f32 v[102:103], v[102:103], v[208:209]
    v_cvt_pk_bf16_f32 v57, v210, v211
    v_pk_add_f32 v[102:103], v[102:103], v[210:211]
    v_cvt_pk_bf16_f32 v58, v212, v213
    v_pk_add_f32 v[102:103], v[102:103], v[212:213]
    v_cvt_pk_bf16_f32 v59, v214, v215
    v_pk_add_f32 v[102:103], v[102:103], v[214:215]
    s_waitcnt vmcnt(20)
    v_mfma_f32_32x32x16_bf16 v[136:151], v[20:23], v[52:55], v[136:151]
    v_xor_b32 v82, 0, v4
    ds_read_b128 v[216:219], v82
    v_xor_b32 v83, 32, v4
    ds_read_b128 v[220:223], v83
    v_mfma_f32_32x32x16_bf16 v[152:167], v[28:31], v[52:55], v[152:167]
    v_xor_b32 v84, 64, v4
    ds_read_b128 v[224:227], v84
    v_xor_b32 v85, 96, v4
    ds_read_b128 v[228:231], v85
    v_mfma_f32_32x32x16_bf16 v[168:183], v[36:39], v[52:55], v[168:183]
    v_xor_b32 v86, 128, v4
    ds_read_b128 v[232:235], v86
    v_xor_b32 v87, 160, v4
    ds_read_b128 v[236:239], v87
    v_mfma_f32_32x32x16_bf16 v[184:199], v[44:47], v[52:55], v[184:199]
    v_xor_b32 v88, 192, v4
    ds_read_b128 v[240:243], v88
    v_xor_b32 v89, 224, v4
    ds_read_b128 v[244:247], v89
    v_mfma_f32_32x32x16_bf16 v[136:151], v[24:27], v[56:59], v[136:151]
    s_add_u32 s39, s90, s62
    s_mov_b32 m0, s39
    s_add_u32 s62, s62, 4096
    s_and_b32 s62, s62, 0x7fff
    buffer_load_dwordx4 v76, s[52:55], s95 offen offset:0 nt lds
    v_mfma_f32_32x32x16_bf16 v[152:167], v[32:35], v[56:59], v[152:167]
    v_mfma_f32_32x32x16_bf16 v[168:183], v[40:43], v[56:59], v[168:183]
    v_mfma_f32_32x32x16_bf16 v[184:199], v[48:51], v[56:59], v[184:199]
    s_add_u32 s93, s93, 1
    s_cmp_lt_u32 s93, 16
    s_cbranch_scc1 L_att
    v_add_f32 v91, v102, v103
    v_mov_b32 v5, v91
    s_nop 1
    v_permlane32_swap_b32 v91, v5
    v_add_f32 v91, v91, v5
    v_and_b32 v4, 31, v1
    v_lshlrev_b32 v5, 8, v4
    v_lshl_add_u32 v5, v3, 4, v5
    v_lshrrev_b32 v6, 5, v1
    v_lshl_add_u32 v5, v6, 3, v5
    v_add_u32 v5, s85, v5
    s_waitcnt vmcnt(0) lgkmcnt(0)
    s_barrier
    v_cvt_pk_bf16_f32 v20, v136, v137
    v_cvt_pk_bf16_f32 v21, v138, v139
    v_xor_b32 v82, 0, v5
    ds_write_b64 v82, v[20:21]
    v_cvt_pk_bf16_f32 v22, v140, v141
    v_cvt_pk_bf16_f32 v23, v142, v143
    v_xor_b32 v83, 16, v5
    ds_write_b64 v83, v[22:23]
    v_cvt_pk_bf16_f32 v24, v144, v145
    v_cvt_pk_bf16_f32 v25, v146, v147
    v_xor_b32 v84, 32, v5
    ds_write_b64 v84, v[24:25]
    v_cvt_pk_bf16_f32 v26, v148, v149
    v_cvt_pk_bf16_f32 v27, v150, v151
    v_xor_b32 v85, 48, v5
    ds_write_b64 v85, v[26:27]
    v_cvt_pk_bf16_f32 v28, v152, v153
    v_cvt_pk_bf16_f32 v29, v154, v155
    v_xor_b32 v86, 64, v5
    ds_write_b64 v86, v[28:29]
    v_cvt_pk_bf16_f32 v30, v156, v157
    v_cvt_pk_bf16_f32 v31, v158, v159
    v_xor_b32 v87, 80, v5
    ds_write_b64 v87, v[30:31]
    v_cvt_pk_bf16_f32 v32, v160, v161
    v_cvt_pk_bf16_f32 v33, v162, v163
    v_xor_b32 v88, 96, v5
    ds_write_b64 v88, v[32:33]
    v_cvt_pk_bf16_f32 v34, v164, v165
    v_cvt_pk_bf16_f32 v35, v166, v167
    v_xor_b32 v89, 112, v5
    ds_write_b64 v89, v[34:35]
    v_cvt_pk_bf16_f32 v36, v168, v169
    v_cvt_pk_bf16_f32 v37, v170, v171
    v_xor_b32 v82, 128, v5
    ds_write_b64 v82, v[36:37]
    v_cvt_pk_bf16_f32 v38, v172, v173
    v_cvt_pk_bf16_f32 v39, v174, v175
    v_xor_b32 v83, 144, v5
    ds_write_b64 v83, v[38:39]
    v_cvt_pk_bf16_f32 v40, v176, v177
    v_cvt_pk_bf16_f32 v41, v178, v179
    v_xor_b32 v84, 160, v5
    ds_write_b64 v84, v[40:41]
    v_cvt_pk_bf16_f32 v42, v180, v181
    v_cvt_pk_bf16_f32 v43, v182, v183
    v_xor_b32 v85, 176, v5
    ds_write_b64 v85, v[42:43]
    v_cvt_pk_bf16_f32 v44, v184, v185
    v_cvt_pk_bf16_f32 v45, v186, v187
    v_xor_b32 v86, 192, v5
    ds_write_b64 v86, v[44:45]
    v_cvt_pk_bf16_f32 v46, v188, v189
    v_cvt_pk_bf16_f32 v47, v190, v191
    v_xor_b32 v87, 208, v5
    ds_write_b64 v87, v[46:47]
    v_cvt_pk_bf16_f32 v48, v192, v193
    v_cvt_pk_bf16_f32 v49, v194, v195
    v_xor_b32 v88, 224, v5
    ds_write_b64 v88, v[48:49]
    v_cvt_pk_bf16_f32 v50, v196, v197
    v_cvt_pk_bf16_f32 v51, v198, v199
    v_xor_b32 v89, 240, v5
    ds_write_b64 v89, v[50:51]
    v_xor_b32 v6, v3, v2
    v_lshlrev_b32 v6, 4, v6
    v_lshl_add_u32 v6, v2, 8, v6
    v_add_u32 v6, s85, v6
    v_xor_b32 v82, 0, v6
    v_xor_b32 v83, 64, v6
    v_xor_b32 v84, 128, v6
    v_xor_b32 v85, 192, v6
    v_lshlrev_b32 v7, 4, v3
    v_lshl_add_u32 v7, v2, 15, v7
    s_lshl_b32 s38, s3, 10
    s_add_u32 s36, s38, 2097152
    s_lshl_b32 s38, s34, 8
    s_add_u32 s36, s38, s36
    s_waitcnt lgkmcnt(0)
    ds_read_b128 v[200:203], v82 offset:0
    ds_read_b128 v[204:207], v83 offset:1024
    ds_read_b128 v[208:211], v84 offset:2048
    ds_read_b128 v[212:215], v85 offset:3072
    ds_read_b128 v[216:219], v82 offset:4096
    ds_read_b128 v[220:223], v83 offset:5120
    ds_read_b128 v[224:227], v84 offset:6144
    ds_read_b128 v[228:231], v85 offset:7168
    v_lshlrev_b32 v4, 3, v4
    s_lshl_b32 s38, s3, 8
    s_add_u32 s37, s38, 163840
    s_lshl_b32 s38, s34, 13
    s_add_u32 s37, s38, s37
    s_mov_b32 exec_lo, 0xffffffff
    s_mov_b32 exec_hi, 0x0
    buffer_store_dwordx2 v[90:91], v4, s[48:51], s37 offen sc1
    s_mov_b64 exec, -1
    s_waitcnt lgkmcnt(7)
    buffer_store_dwordx4 v[200:203], v7, s[48:51], s36 offen sc1
    s_add_u32 s36, s36, 131072
    s_waitcnt lgkmcnt(6)
    buffer_store_dwordx4 v[204:207], v7, s[48:51], s36 offen sc1
    s_add_u32 s36, s36, 131072
    s_waitcnt lgkmcnt(5)
    buffer_store_dwordx4 v[208:211], v7, s[48:51], s36 offen sc1
    s_add_u32 s36, s36, 131072
    s_waitcnt lgkmcnt(4)
    buffer_store_dwordx4 v[212:215], v7, s[48:51], s36 offen sc1
    s_add_u32 s36, s36, 131072
    s_waitcnt lgkmcnt(3)
    buffer_store_dwordx4 v[216:219], v7, s[48:51], s36 offen sc1
    s_add_u32 s36, s36, 131072
    s_waitcnt lgkmcnt(2)
    buffer_store_dwordx4 v[220:223], v7, s[48:51], s36 offen sc1
    s_add_u32 s36, s36, 131072
    s_waitcnt lgkmcnt(1)
    buffer_store_dwordx4 v[224:227], v7, s[48:51], s36 offen sc1
    s_add_u32 s36, s36, 131072
    s_waitcnt lgkmcnt(0)
    buffer_store_dwordx4 v[228:231], v7, s[48:51], s36 offen sc1
    s_sub_u32 s36, s33, 3
    s_and_b32 s37, s33, 3
    s_cmp_lt_u32 s36, 4
    s_cselect_b64 s[40:41], s[24:25], s[14:15]
    s_cselect_b32 s36, s36, s37
    s_cselect_b32 s92, 24, 24
    s_cselect_b32 s45, 262144, 0
    s_cselect_b32 s46, 8388608, 0
    s_add_u32 s45, s45, 524288
    s_add_u32 s46, s46, 196608
    s_mov_b32 s42, 4194304
    s_mov_b32 s43, 0x20000
    s_lshl_b32 s38, s32, 17
    s_add_u32 s44, s38, 0
    s_lshl_b32 s38, s34, 15
    s_add_u32 s44, s38, s44
    s_lshl_b32 s38, s36, 8
    s_add_u32 s44, s38, s44
    s_lshl_b32 s38, s36, 16
    s_add_u32 s45, s38, s45
    s_lshr_b32 s38, s34, 1
    s_lshl_b32 s38, s38, 15
    s_add_u32 s45, s38, s45
    s_lshl_b32 s38, s32, 8
    s_add_u32 s45, s38, s45
    s_bfe_u32 s38, s34, 0x10000
    s_lshl_b32 s38, s38, 7
    s_add_u32 s45, s38, s45
    s_lshl_b32 s38, s32, 11
    s_add_u32 s46, s38, s46
    s_lshl_b32 s38, s34, 9
    s_add_u32 s46, s38, s46
    s_mov_b32 s72, s26
    s_and_b32 s73, s27, 0xffff
    s_mov_b32 s74, 8192
    s_mov_b32 s75, 0x20000
    s_lshl_b32 s39, s34, 13
    s_add_u32 s39, s39, 98304
    s_mov_b32 m0, s39
    s_nop 0
    buffer_load_dwordx4 v76, s[40:43], s44 offen offset:0 nt lds
    buffer_load_dwordx4 v77, s[40:43], s44 offen offset:1024 nt lds
    buffer_load_dwordx4 v78, s[40:43], s44 offen offset:2048 nt lds
    buffer_load_dwordx4 v79, s[40:43], s44 offen offset:3072 nt lds
    s_lshl_b32 s39, s34, 13
    s_add_u32 s39, s39, 102400
    s_mov_b32 m0, s39
    s_add_u32 s44, s44, 16384
    buffer_load_dwordx4 v76, s[40:43], s44 offen offset:0 nt lds
    buffer_load_dwordx4 v77, s[40:43], s44 offen offset:1024 nt lds
    buffer_load_dwordx4 v78, s[40:43], s44 offen offset:2048 nt lds
    buffer_load_dwordx4 v79, s[40:43], s44 offen offset:3072 nt lds
    v_lshlrev_b32 v30, 4, v3
    v_lshl_add_u32 v30, v2, 13, v30
    s_lshl_b32 s38, s32, 13
    s_add_u32 s36, s38, 0
    s_lshl_b32 s38, s34, 6
    s_add_u32 s36, s38, s36
    v_lshrrev_b32 v5, 2, v1
    v_lshlrev_b32 v32, 8, v5
    v_bfe_u32 v5, v1, 0, 2
    v_lshl_add_u32 v32, v5, 4, v32
    v_add_u32 v32, s36, v32
    s_lshr_b32 s38, s32, 2
    s_lshl_b32 s38, s38, 7
    s_add_u32 s36, s38, 0
    s_lshl_b32 s38, s34, 5
    s_add_u32 s36, s38, s36
    s_bfe_u32 s38, s32, 0x20000
    s_lshl_b32 s38, s38, 3
    s_add_u32 s36, s38, s36
    v_bfe_u32 v5, v1, 0, 2
    v_lshlrev_b32 v33, 11, v5
    v_lshl_add_u32 v33, v2, 1, v33
    v_add_u32 v33, s36, v33
    v_and_b32 v5, 31, v1
    v_lshlrev_b32 v34, 4, v5
    s_mul_i32 s38, s34, 320
    s_add_u32 s38, s38, 135168
    v_lshl_add_u32 v35, v5, 3, s38
    v_and_b32 v4, 3, v3
    v_bfe_u32 v5, v3, 0, 2
    v_lshlrev_b32 v81, 11, v5
    v_lshrrev_b32 v5, 2, v3
    v_lshl_add_u32 v81, v5, 8, v81
    v_and_b32 v5, 12, v3
    v_xor_b32 v5, v5, v2
    v_and_b32 v6, 1, v3
    v_lshlrev_b32 v6, 1, v6
    v_xor_b32 v5, v5, v6
    v_lshlrev_b32 v80, 4, v5
    v_bfe_u32 v6, v3, 0, 2
    v_lshl_add_u32 v80, v6, 11, v80
    v_lshrrev_b32 v6, 2, v3
    v_lshl_add_u32 v80, v6, 8, v80
    v_add_u32 v80, s85, v80
    v_lshlrev_b32 v4, 9, v4
    v_lshl_add_u32 v4, v2, 4, v4
    v_add_u32 v94, s85, v4
    s_lshl_b32 s38, s34, 9
    s_add_u32 s38, s38, 131072
    v_and_b32 v5, 31, v1
    v_lshl_add_u32 v102, v5, 4, s38
    s_lshl_b32 s38, s32, 15
    s_add_u32 s36, s38, 2097152
    s_lshl_b32 s38, s34, 8
    s_add_u32 s36, s38, s36
    s_lshl_b32 s38, s32, 3
    s_add_u32 s37, s38, 163840
    s_lshl_b32 s38, s34, 13
    s_add_u32 s37, s38, s37
    s_lshl_b32 s38, s32, 8
    s_add_u32 s69, s38, 131072
    s_lshl_b32 s38, s34, 13
    s_add_u32 s69, s38, s69
    v_mov_b32 v4, s69
    v_mov_b32 v5, s68
    s_waitcnt vmcnt(8)
    s_mov_b64 exec, 1
    buffer_store_dword v5, v4, s[48:51], 0 offen sc1
    s_mov_b64 exec, -1
    s_mov_b32 s86, 131072
    buffer_load_dword v7, v101, s[48:51], s86 offen sc1
    s_waitcnt vmcnt(0)
L_fcheck_25:
    v_cmp_ne_u32 vcc, s68, v7
    s_cbranch_vccz L_fok_26
    s_sleep 2
    s_mov_b32 s86, 131072
    buffer_load_dword v7, v101, s[48:51], s86 offen sc1
    s_waitcnt vmcnt(0)
    s_sub_u32 s84, s84, 1
    s_cmp_lg_u32 s84, 0
    s_cbranch_scc1 L_fcheck_25
    s_branch L_end
L_fok_26:
    buffer_load_dwordx2 v[52:53], v81, s[48:51], s37 offen sc1
    s_add_u32 s37, s37, 1024
    buffer_load_dwordx2 v[54:55], v81, s[48:51], s37 offen sc1
    buffer_load_dwordx4 v[200:203], v9, s[48:51], s36 offen sc1
    s_add_u32 s36, s36, 4096
    buffer_load_dwordx4 v[204:207], v9, s[48:51], s36 offen sc1
    s_add_u32 s36, s36, 4096
    buffer_load_dwordx4 v[208:211], v9, s[48:51], s36 offen sc1
    s_add_u32 s36, s36, 4096
    buffer_load_dwordx4 v[212:215], v9, s[48:51], s36 offen sc1
    s_add_u32 s36, s36, 4096
    buffer_load_dwordx4 v[216:219], v9, s[48:51], s36 offen sc1
    s_add_u32 s36, s36, 4096
    buffer_load_dwordx4 v[220:223], v9, s[48:51], s36 offen sc1
    s_add_u32 s36, s36, 4096
    buffer_load_dwordx4 v[224:227], v9, s[48:51], s36 offen sc1
    s_add_u32 s36, s36, 4096
    buffer_load_dwordx4 v[228:231], v9, s[48:51], s36 offen sc1
    v_xor_b32 v82, 0, v80
    v_xor_b32 v83, 64, v80
    v_xor_b32 v84, 128, v80
    v_xor_b32 v85, 192, v80
    v_xor_b32 v86, 16, v80
    v_xor_b32 v87, 80, v80
    v_xor_b32 v88, 144, v80
    v_xor_b32 v89, 208, v80
    s_waitcnt vmcnt(8)
    v_max_f32 v4, v52, v54
    s_nop 1
    v_max_f32_dpp v4, v4, v4 row_ror:8 row_mask:0xf bank_mask:0xf
    s_nop 1
    v_max_f32_dpp v4, v4, v4 row_ror:4 row_mask:0xf bank_mask:0xf
    v_sub_f32 v52, v52, v4
    v_sub_f32 v54, v54, v4
    v_exp_f32 v52, v52
    v_exp_f32 v54, v54
    v_mul_f32 v5, v52, v53
    v_fmac_f32 v5, v54, v55
    s_nop 1
    v_add_f32_dpp v5, v5, v5 row_ror:8 row_mask:0xf bank_mask:0xf
    s_nop 1
    v_add_f32_dpp v5, v5, v5 row_ror:4 row_mask:0xf bank_mask:0xf
    v_rcp_f32 v5, v5
    s_nop 0
    v_mul_f32 v52, v52, v5
    v_mul_f32 v54, v54, v5
    s_waitcnt vmcnt(7)
    ds_write_b128 v96, v[200:203] offset:0
    s_waitcnt vmcnt(6)
    ds_write_b128 v97, v[204:207] offset:1024
    s_waitcnt vmcnt(5)
    ds_write_b128 v98, v[208:211] offset:2048
    s_waitcnt vmcnt(4)
    ds_write_b128 v99, v[212:215] offset:3072
    s_waitcnt vmcnt(3)
    ds_write_b128 v96, v[216:219] offset:4096
    s_waitcnt vmcnt(2)
    ds_write_b128 v97, v[220:223] offset:5120
    s_waitcnt vmcnt(1)
    ds_write_b128 v98, v[224:227] offset:6144
    s_waitcnt vmcnt(0)
    ds_write_b128 v99, v[228:231] offset:7168
    s_waitcnt lgkmcnt(0)
    ds_read_b128 v[136:139], v82 offset:0
    ds_read_b128 v[140:143], v83 offset:0
    ds_read_b128 v[144:147], v84 offset:0
    ds_read_b128 v[148:151], v85 offset:0
    ds_read_b128 v[152:155], v86 offset:1024
    ds_read_b128 v[156:159], v87 offset:1024
    ds_read_b128 v[160:163], v88 offset:1024
    ds_read_b128 v[164:167], v89 offset:1024
    s_waitcnt lgkmcnt(0)
    v_mfma_f32_16x16x32_bf16 v[60:63], a[128:131], v[136:139], 0
    v_mfma_f32_16x16x32_bf16 v[64:67], a[128:131], v[152:155], 0
    v_mfma_f32_16x16x32_bf16 v[60:63], a[132:135], v[140:143], v[60:63]
    v_mfma_f32_16x16x32_bf16 v[64:67], a[132:135], v[156:159], v[64:67]
    v_mfma_f32_16x16x32_bf16 v[60:63], a[136:139], v[144:147], v[60:63]
    v_mfma_f32_16x16x32_bf16 v[64:67], a[136:139], v[160:163], v[64:67]
    v_mfma_f32_16x16x32_bf16 v[60:63], a[140:143], v[148:151], v[60:63]
    v_mfma_f32_16x16x32_bf16 v[64:67], a[140:143], v[164:167], v[64:67]
    v_mfma_f32_16x16x32_bf16 v[68:71], a[144:147], v[136:139], 0
    v_mfma_f32_16x16x32_bf16 v[72:75], a[144:147], v[152:155], 0
    v_mfma_f32_16x16x32_bf16 v[68:71], a[148:151], v[140:143], v[68:71]
    v_mfma_f32_16x16x32_bf16 v[72:75], a[148:151], v[156:159], v[72:75]
    v_mfma_f32_16x16x32_bf16 v[68:71], a[152:155], v[144:147], v[68:71]
    v_mfma_f32_16x16x32_bf16 v[72:75], a[152:155], v[160:163], v[72:75]
    v_mfma_f32_16x16x32_bf16 v[68:71], a[156:159], v[148:151], v[68:71]
    v_mfma_f32_16x16x32_bf16 v[72:75], a[156:159], v[164:167], v[72:75]
    v_mul_f32 v104, v60, v52
    v_mul_f32 v105, v61, v52
    v_mul_f32 v106, v62, v52
    v_mul_f32 v107, v63, v52
    v_fmac_f32 v104, v64, v54
    v_fmac_f32 v105, v65, v54
    v_fmac_f32 v106, v66, v54
    v_fmac_f32 v107, v67, v54
    v_add_f32_dpp v104, v104, v104 row_ror:8 row_mask:0xf bank_mask:0xf
    v_add_f32_dpp v105, v105, v105 row_ror:8 row_mask:0xf bank_mask:0xf
    v_add_f32_dpp v106, v106, v106 row_ror:8 row_mask:0xf bank_mask:0xf
    v_add_f32_dpp v107, v107, v107 row_ror:8 row_mask:0xf bank_mask:0xf
    v_add_f32_dpp v104, v104, v104 row_ror:4 row_mask:0xf bank_mask:0xf
    v_add_f32_dpp v105, v105, v105 row_ror:4 row_mask:0xf bank_mask:0xf
    v_add_f32_dpp v106, v106, v106 row_ror:4 row_mask:0xf bank_mask:0xf
    v_add_f32_dpp v107, v107, v107 row_ror:4 row_mask:0xf bank_mask:0xf
    ds_write_b128 v94, v[104:107] offset:0
    v_mfma_f32_16x16x32_bf16 v[60:63], a[160:163], v[136:139], 0
    v_mfma_f32_16x16x32_bf16 v[64:67], a[160:163], v[152:155], 0
    v_mfma_f32_16x16x32_bf16 v[60:63], a[164:167], v[140:143], v[60:63]
    v_mfma_f32_16x16x32_bf16 v[64:67], a[164:167], v[156:159], v[64:67]
    v_mfma_f32_16x16x32_bf16 v[60:63], a[168:171], v[144:147], v[60:63]
    v_mfma_f32_16x16x32_bf16 v[64:67], a[168:171], v[160:163], v[64:67]
    v_mfma_f32_16x16x32_bf16 v[60:63], a[172:175], v[148:151], v[60:63]
    v_mfma_f32_16x16x32_bf16 v[64:67], a[172:175], v[164:167], v[64:67]
    v_mul_f32 v108, v68, v52
    v_mul_f32 v109, v69, v52
    v_mul_f32 v110, v70, v52
    v_mul_f32 v111, v71, v52
    v_fmac_f32 v108, v72, v54
    v_fmac_f32 v109, v73, v54
    v_fmac_f32 v110, v74, v54
    v_fmac_f32 v111, v75, v54
    v_add_f32_dpp v108, v108, v108 row_ror:8 row_mask:0xf bank_mask:0xf
    v_add_f32_dpp v109, v109, v109 row_ror:8 row_mask:0xf bank_mask:0xf
    v_add_f32_dpp v110, v110, v110 row_ror:8 row_mask:0xf bank_mask:0xf
    v_add_f32_dpp v111, v111, v111 row_ror:8 row_mask:0xf bank_mask:0xf
    v_add_f32_dpp v108, v108, v108 row_ror:4 row_mask:0xf bank_mask:0xf
    v_add_f32_dpp v109, v109, v109 row_ror:4 row_mask:0xf bank_mask:0xf
    v_add_f32_dpp v110, v110, v110 row_ror:4 row_mask:0xf bank_mask:0xf
    v_add_f32_dpp v111, v111, v111 row_ror:4 row_mask:0xf bank_mask:0xf
    ds_write_b128 v94, v[108:111] offset:64
    v_mfma_f32_16x16x32_bf16 v[68:71], a[176:179], v[136:139], 0
    v_mfma_f32_16x16x32_bf16 v[72:75], a[176:179], v[152:155], 0
    v_mfma_f32_16x16x32_bf16 v[68:71], a[180:183], v[140:143], v[68:71]
    v_mfma_f32_16x16x32_bf16 v[72:75], a[180:183], v[156:159], v[72:75]
    v_mfma_f32_16x16x32_bf16 v[68:71], a[184:187], v[144:147], v[68:71]
    v_mfma_f32_16x16x32_bf16 v[72:75], a[184:187], v[160:163], v[72:75]
    v_mfma_f32_16x16x32_bf16 v[68:71], a[188:191], v[148:151], v[68:71]
    v_mfma_f32_16x16x32_bf16 v[72:75], a[188:191], v[164:167], v[72:75]
    v_mul_f32 v104, v60, v52
    v_mul_f32 v105, v61, v52
    v_mul_f32 v106, v62, v52
    v_mul_f32 v107, v63, v52
    v_fmac_f32 v104, v64, v54
    v_fmac_f32 v105, v65, v54
    v_fmac_f32 v106, v66, v54
    v_fmac_f32 v107, v67, v54
    v_add_f32_dpp v104, v104, v104 row_ror:8 row_mask:0xf bank_mask:0xf
    v_add_f32_dpp v105, v105, v105 row_ror:8 row_mask:0xf bank_mask:0xf
    v_add_f32_dpp v106, v106, v106 row_ror:8 row_mask:0xf bank_mask:0xf
    v_add_f32_dpp v107, v107, v107 row_ror:8 row_mask:0xf bank_mask:0xf
    v_add_f32_dpp v104, v104, v104 row_ror:4 row_mask:0xf bank_mask:0xf
    v_add_f32_dpp v105, v105, v105 row_ror:4 row_mask:0xf bank_mask:0xf
    v_add_f32_dpp v106, v106, v106 row_ror:4 row_mask:0xf bank_mask:0xf
    v_add_f32_dpp v107, v107, v107 row_ror:4 row_mask:0xf bank_mask:0xf
    ds_write_b128 v94, v[104:107] offset:128
    v_mfma_f32_16x16x32_bf16 v[60:63], a[192:195], v[136:139], 0
    v_mfma_f32_16x16x32_bf16 v[64:67], a[192:195], v[152:155], 0
    v_mfma_f32_16x16x32_bf16 v[60:63], a[196:199], v[140:143], v[60:63]
    v_mfma_f32_16x16x32_bf16 v[64:67], a[196:199], v[156:159], v[64:67]
    v_mfma_f32_16x16x32_bf16 v[60:63], a[200:203], v[144:147], v[60:63]
    v_mfma_f32_16x16x32_bf16 v[64:67], a[200:203], v[160:163], v[64:67]
    v_mfma_f32_16x16x32_bf16 v[60:63], a[204:207], v[148:151], v[60:63]
    v_mfma_f32_16x16x32_bf16 v[64:67], a[204:207], v[164:167], v[64:67]
    v_mul_f32 v108, v68, v52
    v_mul_f32 v109, v69, v52
    v_mul_f32 v110, v70, v52
    v_mul_f32 v111, v71, v52
    v_fmac_f32 v108, v72, v54
    v_fmac_f32 v109, v73, v54
    v_fmac_f32 v110, v74, v54
    v_fmac_f32 v111, v75, v54
    v_add_f32_dpp v108, v108, v108 row_ror:8 row_mask:0xf bank_mask:0xf
    v_add_f32_dpp v109, v109, v109 row_ror:8 row_mask:0xf bank_mask:0xf
    v_add_f32_dpp v110, v110, v110 row_ror:8 row_mask:0xf bank_mask:0xf
    v_add_f32_dpp v111, v111, v111 row_ror:8 row_mask:0xf bank_mask:0xf
    v_add_f32_dpp v108, v108, v108 row_ror:4 row_mask:0xf bank_mask:0xf
    v_add_f32_dpp v109, v109, v109 row_ror:4 row_mask:0xf bank_mask:0xf
    v_add_f32_dpp v110, v110, v110 row_ror:4 row_mask:0xf bank_mask:0xf
    v_add_f32_dpp v111, v111, v111 row_ror:4 row_mask:0xf bank_mask:0xf
    ds_write_b128 v94, v[108:111] offset:192
    v_mfma_f32_16x16x32_bf16 v[68:71], a[208:211], v[136:139], 0
    v_mfma_f32_16x16x32_bf16 v[72:75], a[208:211], v[152:155], 0
    v_mfma_f32_16x16x32_bf16 v[68:71], a[212:215], v[140:143], v[68:71]
    v_mfma_f32_16x16x32_bf16 v[72:75], a[212:215], v[156:159], v[72:75]
    v_mfma_f32_16x16x32_bf16 v[68:71], a[216:219], v[144:147], v[68:71]
    v_mfma_f32_16x16x32_bf16 v[72:75], a[216:219], v[160:163], v[72:75]
    v_mfma_f32_16x16x32_bf16 v[68:71], a[220:223], v[148:151], v[68:71]
    v_mfma_f32_16x16x32_bf16 v[72:75], a[220:223], v[164:167], v[72:75]
    v_mul_f32 v104, v60, v52
    v_mul_f32 v105, v61, v52
    v_mul_f32 v106, v62, v52
    v_mul_f32 v107, v63, v52
    v_fmac_f32 v104, v64, v54
    v_fmac_f32 v105, v65, v54
    v_fmac_f32 v106, v66, v54
    v_fmac_f32 v107, v67, v54
    v_add_f32_dpp v104, v104, v104 row_ror:8 row_mask:0xf bank_mask:0xf
    v_add_f32_dpp v105, v105, v105 row_ror:8 row_mask:0xf bank_mask:0xf
    v_add_f32_dpp v106, v106, v106 row_ror:8 row_mask:0xf bank_mask:0xf
    v_add_f32_dpp v107, v107, v107 row_ror:8 row_mask:0xf bank_mask:0xf
    v_add_f32_dpp v104, v104, v104 row_ror:4 row_mask:0xf bank_mask:0xf
    v_add_f32_dpp v105, v105, v105 row_ror:4 row_mask:0xf bank_mask:0xf
    v_add_f32_dpp v106, v106, v106 row_ror:4 row_mask:0xf bank_mask:0xf
    v_add_f32_dpp v107, v107, v107 row_ror:4 row_mask:0xf bank_mask:0xf
    ds_write_b128 v94, v[104:107] offset:256
    v_mfma_f32_16x16x32_bf16 v[60:63], a[224:227], v[136:139], 0
    v_mfma_f32_16x16x32_bf16 v[64:67], a[224:227], v[152:155], 0
    v_mfma_f32_16x16x32_bf16 v[60:63], a[228:231], v[140:143], v[60:63]
    v_mfma_f32_16x16x32_bf16 v[64:67], a[228:231], v[156:159], v[64:67]
    v_mfma_f32_16x16x32_bf16 v[60:63], a[232:235], v[144:147], v[60:63]
    v_mfma_f32_16x16x32_bf16 v[64:67], a[232:235], v[160:163], v[64:67]
    v_mfma_f32_16x16x32_bf16 v[60:63], a[236:239], v[148:151], v[60:63]
    v_mfma_f32_16x16x32_bf16 v[64:67], a[236:239], v[164:167], v[64:67]
    v_mul_f32 v108, v68, v52
    v_mul_f32 v109, v69, v52
    v_mul_f32 v110, v70, v52
    v_mul_f32 v111, v71, v52
    v_fmac_f32 v108, v72, v54
    v_fmac_f32 v109, v73, v54
    v_fmac_f32 v110, v74, v54
    v_fmac_f32 v111, v75, v54
    v_add_f32_dpp v108, v108, v108 row_ror:8 row_mask:0xf bank_mask:0xf
    v_add_f32_dpp v109, v109, v109 row_ror:8 row_mask:0xf bank_mask:0xf
    v_add_f32_dpp v110, v110, v110 row_ror:8 row_mask:0xf bank_mask:0xf
    v_add_f32_dpp v111, v111, v111 row_ror:8 row_mask:0xf bank_mask:0xf
    v_add_f32_dpp v108, v108, v108 row_ror:4 row_mask:0xf bank_mask:0xf
    v_add_f32_dpp v109, v109, v109 row_ror:4 row_mask:0xf bank_mask:0xf
    v_add_f32_dpp v110, v110, v110 row_ror:4 row_mask:0xf bank_mask:0xf
    v_add_f32_dpp v111, v111, v111 row_ror:4 row_mask:0xf bank_mask:0xf
    ds_write_b128 v94, v[108:111] offset:320
    v_mfma_f32_16x16x32_bf16 v[68:71], a[240:243], v[136:139], 0
    v_mfma_f32_16x16x32_bf16 v[72:75], a[240:243], v[152:155], 0
    v_mfma_f32_16x16x32_bf16 v[68:71], a[244:247], v[140:143], v[68:71]
    v_mfma_f32_16x16x32_bf16 v[72:75], a[244:247], v[156:159], v[72:75]
    v_mfma_f32_16x16x32_bf16 v[68:71], a[248:251], v[144:147], v[68:71]
    v_mfma_f32_16x16x32_bf16 v[72:75], a[248:251], v[160:163], v[72:75]
    v_mfma_f32_16x16x32_bf16 v[68:71], a[252:255], v[148:151], v[68:71]
    v_mfma_f32_16x16x32_bf16 v[72:75], a[252:255], v[164:167], v[72:75]
    v_mul_f32 v104, v60, v52
    v_mul_f32 v105, v61, v52
    v_mul_f32 v106, v62, v52
    v_mul_f32 v107, v63, v52
    v_fmac_f32 v104, v64, v54
    v_fmac_f32 v105, v65, v54
    v_fmac_f32 v106, v66, v54
    v_fmac_f32 v107, v67, v54
    v_add_f32_dpp v104, v104, v104 row_ror:8 row_mask:0xf bank_mask:0xf
    v_add_f32_dpp v105, v105, v105 row_ror:8 row_mask:0xf bank_mask:0xf
    v_add_f32_dpp v106, v106, v106 row_ror:8 row_mask:0xf bank_mask:0xf
    v_add_f32_dpp v107, v107, v107 row_ror:8 row_mask:0xf bank_mask:0xf
    v_add_f32_dpp v104, v104, v104 row_ror:4 row_mask:0xf bank_mask:0xf
    v_add_f32_dpp v105, v105, v105 row_ror:4 row_mask:0xf bank_mask:0xf
    v_add_f32_dpp v106, v106, v106 row_ror:4 row_mask:0xf bank_mask:0xf
    v_add_f32_dpp v107, v107, v107 row_ror:4 row_mask:0xf bank_mask:0xf
    ds_write_b128 v94, v[104:107] offset:384
    v_mul_f32 v108, v68, v52
    v_mul_f32 v109, v69, v52
    v_mul_f32 v110, v70, v52
    v_mul_f32 v111, v71, v52
    v_fmac_f32 v108, v72, v54
    v_fmac_f32 v109, v73, v54
    v_fmac_f32 v110, v74, v54
    v_fmac_f32 v111, v75, v54
    v_add_f32_dpp v108, v108, v108 row_ror:8 row_mask:0xf bank_mask:0xf
    v_add_f32_dpp v109, v109, v109 row_ror:8 row_mask:0xf bank_mask:0xf
    v_add_f32_dpp v110, v110, v110 row_ror:8 row_mask:0xf bank_mask:0xf
    v_add_f32_dpp v111, v111, v111 row_ror:8 row_mask:0xf bank_mask:0xf
    v_add_f32_dpp v108, v108, v108 row_ror:4 row_mask:0xf bank_mask:0xf
    v_add_f32_dpp v109, v109, v109 row_ror:4 row_mask:0xf bank_mask:0xf
    v_add_f32_dpp v110, v110, v110 row_ror:4 row_mask:0xf bank_mask:0xf
    v_add_f32_dpp v111, v111, v111 row_ror:4 row_mask:0xf bank_mask:0xf
    ds_write_b128 v94, v[108:111] offset:448
    s_waitcnt lgkmcnt(0)
    s_barrier
    ds_read_b128 v[136:139], v102 offset:0
    ds_read_b128 v[140:143], v102 offset:8192
    ds_read_b128 v[144:147], v102 offset:16384
    ds_read_b128 v[148:151], v102 offset:24576
    s_waitcnt lgkmcnt(0)
    v_add_f32 v136, v136, v140
    v_add_f32 v144, v144, v148
    v_add_f32 v137, v137, v141
    v_add_f32 v145, v145, v149
    v_add_f32 v138, v138, v142
    v_add_f32 v146, v146, v150
    v_add_f32 v139, v139, v143
    v_add_f32 v147, v147, v151
    v_add_f32 v136, v136, v144
    v_add_f32 v137, v137, v145
    v_add_f32 v138, v138, v146
    v_add_f32 v139, v139, v147
    s_mov_b32 s38, 0xffff0000
    v_cvt_pk_bf16_f32 v136, v136, v136
    v_cvt_pk_bf16_f32 v137, v137, v137
    v_cvt_pk_bf16_f32 v138, v138, v138
    v_cvt_pk_bf16_f32 v139, v139, v139
    v_and_or_b32 v136, v136, s38, v8
    v_and_or_b32 v137, v137, s38, v8
    v_and_or_b32 v138, v138, s38, v8
    v_and_or_b32 v139, v139, s38, v8
    s_mov_b32 exec_lo, 0xffffffff
    s_mov_b32 exec_hi, 0x0
    buffer_store_dwordx4 v[136:139], v34, s[48:51], s46 offen sc1
    s_mov_b64 exec, -1
    v_xor_b32 v224, s35, v136
    v_xor_b32 v225, s35, v137
    v_xor_b32 v226, s35, v138
    v_xor_b32 v227, s35, v139
    v_lshlrev_b32 v4, 11, v2
    v_bfe_u32 v5, v1, 2, 2
    v_lshl_add_u32 v4, v5, 8, v4
    v_bfe_u32 v5, v1, 2, 2
    v_lshl_add_u32 v4, v5, 6, v4
    v_bfe_u32 v5, v1, 4, 1
    v_lshl_add_u32 v4, v5, 5, v4
    v_bfe_u32 v5, v1, 1, 1
    v_lshl_add_u32 v4, v5, 4, v4
    v_bfe_u32 v5, v1, 0, 1
    v_lshl_add_u32 v4, v5, 3, v4
    s_lshl_b32 s38, s34, 6
    s_add_u32 s38, s38, 98304
    v_xor_b32 v24, s38, v4
    v_xor_b32 v25, 16, v24
    v_xor_b32 v26, 32, v24
    v_xor_b32 v27, 48, v24
    v_and_b32 v4, 3, v3
    v_lshrrev_b32 v5, 2, v3
    v_lshlrev_b32 v6, 4, v2
    v_add_u32 v6, 135168, v6
    s_movk_i32 s36, 320
    v_cmp_eq_u32 vcc, 0, v5
    s_nop 1
    v_cndmask_b32 v28, 4, v4, vcc
    v_mad_u32_u24 v28, v28, s36, v6
    v_cmp_eq_u32 vcc, 1, v5
    s_nop 1
    v_cndmask_b32 v29, 4, v4, vcc
    v_mad_u32_u24 v29, v29, s36, v6
    v_lshlrev_b32 v5, 2, v1
    v_add_u32 v5, 136448, v5
    v_mov_b32 v6, 0
    ds_write_b32 v5, v6
    s_branch L_ctxok
.section .rodata,"a"
.p2align 6
.amdhsa_kernel concat_heads__compressed_kv_cla__mha_block_cached__decode_kernel
  .amdhsa_next_free_vgpr 512
  .amdhsa_next_free_sgpr 102
  .amdhsa_accum_offset 256
  .amdhsa_group_segment_fixed_size 0
  .amdhsa_kernarg_size 112
  .amdhsa_user_sgpr_count 2
  .amdhsa_user_sgpr_kernarg_segment_ptr 1
  .amdhsa_system_sgpr_workgroup_id_x 1
.end_amdhsa_kernel
```

```asm
; @launch grid=(256,1,1) block=(256,1,1) lds=163840
    .amdgcn_target "amdgcn-amd-amdhsa--gfx950"
    .text
    .globl concat_heads__compressed_kv_cla__mha_block_cached__decode_kernel
    .p2align 8
    .type concat_heads__compressed_kv_cla__mha_block_cached__decode_kernel,@function
concat_heads__compressed_kv_cla__mha_block_cached__decode_kernel:
    s_cmp_ge_u32 s2, 256
    s_cbranch_scc1 L_end
    s_load_dwordx16 s[4:19], s[0:1], 0
    s_load_dwordx8 s[20:27], s[0:1], 64
    s_load_dwordx4 s[28:31], s[0:1], 96
    v_lshrrev_b32 v4, 6, v0
    v_and_b32 v1, 63, v0
    v_readfirstlane_b32 s34, v4
    s_lshr_b32 s32, s2, 3
    s_sub_u32 s33, s2, s32
    s_sub_u32 s33, s33, 1
    s_and_b32 s33, s33, 7
    v_lshrrev_b32 v2, 4, v1
    v_and_b32 v3, 15, v1
    s_cmp_lt_u32 s33, 2
    s_cbranch_scc1 L_qp
    s_cmp_eq_u32 s33, 2
    s_cbranch_scc1 L_ql
    s_cmp_eq_u32 s33, 7
    s_cbranch_scc1 L_aux
    s_bfe_u32 s38, s2, 0x30000
    s_lshl_b32 s38, s38, 21
    s_add_u32 s36, s38, -393216
    s_lshr_b32 s38, s32, 3
    s_lshl_b32 s38, s38, 19
    s_add_u32 s36, s38, s36
    s_lshl_b32 s38, s33, 17
    s_add_u32 s36, s38, s36
    s_lshl_b32 s38, s34, 12
    s_add_u32 s36, s38, s36
    v_bfe_u32 v5, v1, 0, 5
    v_lshlrev_b32 v4, 7, v5
    v_lshrrev_b32 v5, 5, v1
    v_lshl_add_u32 v4, v5, 15, v4
    s_mov_b32 s42, 16777216
    s_mov_b32 s43, 0x20000
    s_waitcnt lgkmcnt(0)
    s_mov_b64 s[40:41], s[6:7]
    buffer_load_dword v20, v4, s[40:43], s36 offen
    s_add_u32 s36, s36, 16384
    buffer_load_dword v21, v4, s[40:43], s36 offen
    s_add_u32 s36, s36, 49152
    buffer_load_dword v22, v4, s[40:43], s36 offen
    s_add_u32 s36, s36, 16384
    buffer_load_dword v23, v4, s[40:43], s36 offen
    s_load_dword s35, s[30:31], 0
    s_mov_b32 s48, s30
    s_and_b32 s49, s31, 0xffff
    s_mov_b32 s50, 8388608
    s_mov_b32 s51, 0x20000
    s_mov_b32 s82, 0xffffff00
    s_mov_b32 s83, 0x3e0293ee
    s_mov_b32 s84, 2097152
    v_lshrrev_b32 v4, 2, v3
    v_and_b32 v5, 3, v3
    v_lshlrev_b32 v76, 8, v4
    v_lshlrev_b32 v126, 8, v2
    v_lshl_add_u32 v76, v2, 6, v76
    v_lshl_add_u32 v76, v5, 4, v76
    v_lshl_add_u32 v126, v3, 4, v126
    v_xor_b32 v77, 32768, v76
    v_xor_b32 v127, 32768, v126
    s_add_u32 s3, s34, s33
    s_and_b32 s3, s3, 3
    s_lshl_b32 s89, s3, 5
    s_add_u32 s89, s89, s32
    s_lshl_b32 s89, s89, 20
    s_mul_i32 s88, s32, 8
    s_add_u32 s88, s88, s3
    s_lshl_b32 s87, s33, 0
    s_mov_b32 s52, s18
    s_and_b32 s53, s19, 0xffff
    s_mov_b32 s54, 134217728
    s_mov_b32 s55, 0x20000
    s_mov_b32 s56, s20
    s_and_b32 s57, s21, 0xffff
    s_mov_b32 s58, 134217728
    s_mov_b32 s59, 0x20000
    v_and_b32 v4, 1, v1
    v_lshlrev_b32 v4, 4, v4
    v_mov_b32 v5, 0xffff
    v_lshlrev_b32 v4, v4, v5
    v_bfe_u32 v5, v1, 1, 2
    v_cmp_eq_u32 vcc, 0, v5
    s_nop 1
    v_cndmask_b32 v10, 0, v4, vcc
    v_cmp_eq_u32 vcc, 1, v5
    s_nop 1
    v_cndmask_b32 v11, 0, v4, vcc
    v_cmp_eq_u32 vcc, 2, v5
    s_nop 1
    v_cndmask_b32 v12, 0, v4, vcc
    v_cmp_eq_u32 vcc, 3, v5
    s_nop 1
    v_cndmask_b32 v13, 0, v4, vcc
    v_mov_b32 v120, 0xff7f0000
    v_mov_b32 v121, 0
    v_mov_b32 v18, 1
    v_mov_b32 v116, 0
    v_mov_b32 v117, 0
    v_mov_b32 v118, 0
    v_mov_b32 v119, 0
    s_lshl_b32 s38, s32, 10
    s_add_u32 s96, s38, 65536
    s_lshl_b32 s38, s3, 8
    s_add_u32 s96, s38, s96
    v_mov_b32 v9, s96
    s_lshl_b32 s38, s32, 15
    s_add_u32 s96, s38, 1048576
    s_lshl_b32 s38, s3, 13
    s_add_u32 s96, s38, s96
    s_lshl_b32 s38, s33, 10
    s_add_u32 s96, s38, s96
    v_and_b32 v5, 3, v3
    v_lshlrev_b32 v78, 7, v2
    v_lshl_add_u32 v78, v5, 5, v78
    s_lshl_b32 s38, s32, 12
    s_add_u32 s91, s38, 262144
    s_lshl_b32 s38, s3, 9
    s_add_u32 s91, s38, s91
    v_lshlrev_b32 v4, 7, v2
    v_lshl_add_u32 v4, v3, 4, v4
    v_mov_b32 v5, 512
    v_cmp_gt_u32 vcc, 8, v3
    s_nop 1
    v_cndmask_b32 v79, v5, v4, vcc
    s_add_u32 s39, s87, s88
    s_bfe_u32 s37, s39, 0x30000
    s_lshl_b32 s37, s37, 12
    s_add_u32 s85, s37, s89
    s_bfe_u32 s37, s39, 0x10003
    s_lshl_b32 s37, s37, 11
    s_add_u32 s85, s37, s85
    s_bfe_u32 s37, s39, 0x40004
    s_lshl_b32 s37, s37, 16
    s_add_u32 s85, s37, s85
    buffer_load_dwordx4 v[128:131], v76, s[52:55], s85 offen offset:0 nt
    buffer_load_dwordx4 v[132:135], v77, s[52:55], s85 offen offset:0 nt
    buffer_load_dwordx4 v[136:139], v76, s[52:55], s85 offen offset:1024 nt
    buffer_load_dwordx4 v[140:143], v77, s[52:55], s85 offen offset:1024 nt
    s_add_u32 s87, s87, 7
    s_add_u32 s39, s87, s88
    s_bfe_u32 s37, s39, 0x30000
    s_lshl_b32 s37, s37, 12
    s_add_u32 s85, s37, s89
    s_bfe_u32 s37, s39, 0x10003
    s_lshl_b32 s37, s37, 11
    s_add_u32 s85, s37, s85
    s_bfe_u32 s37, s39, 0x40004
    s_lshl_b32 s37, s37, 16
    s_add_u32 s85, s37, s85
    buffer_load_dwordx4 v[144:147], v76, s[52:55], s85 offen offset:0 nt
    buffer_load_dwordx4 v[148:151], v77, s[52:55], s85 offen offset:0 nt
    buffer_load_dwordx4 v[152:155], v76, s[52:55], s85 offen offset:1024 nt
    s_waitcnt vmcnt(6)
    buffer_load_dwordx4 v[156:159], v77, s[52:55], s85 offen offset:1024 nt
    s_add_u32 s87, s87, 7
    s_add_u32 s39, s87, s88
    s_bfe_u32 s37, s39, 0x30000
    s_lshl_b32 s37, s37, 12
    s_add_u32 s85, s37, s89
    s_bfe_u32 s37, s39, 0x10003
    s_lshl_b32 s37, s37, 11
    s_add_u32 s85, s37, s85
    s_bfe_u32 s37, s39, 0x40004
    s_lshl_b32 s37, s37, 16
    s_add_u32 s85, s37, s85
    s_waitcnt vmcnt(6)
    buffer_load_dwordx4 v[160:163], v76, s[52:55], s85 offen offset:0 nt
    s_waitcnt vmcnt(6)
    buffer_load_dwordx4 v[164:167], v77, s[52:55], s85 offen offset:0 nt
    s_waitcnt vmcnt(6)
    buffer_load_dwordx4 v[168:171], v76, s[52:55], s85 offen offset:1024 nt
    s_waitcnt vmcnt(6)
    buffer_load_dwordx4 v[172:175], v77, s[52:55], s85 offen offset:1024 nt
    s_add_u32 s87, s87, 7
    s_add_u32 s39, s87, s88
    s_bfe_u32 s37, s39, 0x30000
    s_lshl_b32 s37, s37, 12
    s_add_u32 s85, s37, s89
    s_bfe_u32 s37, s39, 0x10003
    s_lshl_b32 s37, s37, 11
    s_add_u32 s85, s37, s85
    s_bfe_u32 s37, s39, 0x40004
    s_lshl_b32 s37, s37, 16
    s_add_u32 s85, s37, s85
    s_waitcnt vmcnt(6)
    buffer_load_dwordx4 v[176:179], v76, s[52:55], s85 offen offset:0 nt
    s_waitcnt vmcnt(6)
    buffer_load_dwordx4 v[180:183], v77, s[52:55], s85 offen offset:0 nt
    s_waitcnt vmcnt(6)
    buffer_load_dwordx4 v[184:187], v76, s[52:55], s85 offen offset:1024 nt
    s_waitcnt vmcnt(6)
    buffer_load_dwordx4 v[188:191], v77, s[52:55], s85 offen offset:1024 nt
    s_add_u32 s87, s87, 7
    s_add_u32 s39, s87, s88
    s_bfe_u32 s37, s39, 0x30000
    s_lshl_b32 s37, s37, 12
    s_add_u32 s85, s37, s89
    s_bfe_u32 s37, s39, 0x10003
    s_lshl_b32 s37, s37, 11
    s_add_u32 s85, s37, s85
    s_bfe_u32 s37, s39, 0x40004
    s_lshl_b32 s37, s37, 16
    s_add_u32 s85, s37, s85
    s_waitcnt vmcnt(6)
    buffer_load_dwordx4 v[192:195], v76, s[52:55], s85 offen offset:0 nt
    s_waitcnt vmcnt(6)
    buffer_load_dwordx4 v[196:199], v77, s[52:55], s85 offen offset:0 nt
    s_waitcnt vmcnt(6)
    buffer_load_dwordx4 v[200:203], v76, s[52:55], s85 offen offset:1024 nt
    s_waitcnt vmcnt(6)
    buffer_load_dwordx4 v[204:207], v77, s[52:55], s85 offen offset:1024 nt
    s_add_u32 s87, s87, 7
    s_add_u32 s39, s87, s88
    s_bfe_u32 s37, s39, 0x30000
    s_lshl_b32 s37, s37, 12
    s_add_u32 s85, s37, s89
    s_bfe_u32 s37, s39, 0x10003
    s_lshl_b32 s37, s37, 11
    s_add_u32 s85, s37, s85
    s_bfe_u32 s37, s39, 0x40004
    s_lshl_b32 s37, s37, 16
    s_add_u32 s85, s37, s85
    s_waitcnt vmcnt(6)
    buffer_load_dwordx4 v[208:211], v76, s[52:55], s85 offen offset:0 nt
    s_waitcnt vmcnt(6)
    buffer_load_dwordx4 v[212:215], v77, s[52:55], s85 offen offset:0 nt
    s_waitcnt vmcnt(6)
    buffer_load_dwordx4 v[216:219], v76, s[52:55], s85 offen offset:1024 nt
    s_waitcnt vmcnt(6)
    buffer_load_dwordx4 v[220:223], v77, s[52:55], s85 offen offset:1024 nt
    s_add_u32 s87, s87, 7
    s_add_u32 s39, s87, s88
    s_bfe_u32 s37, s39, 0x30000
    s_lshl_b32 s37, s37, 12
    s_add_u32 s85, s37, s89
    s_bfe_u32 s37, s39, 0x10003
    s_lshl_b32 s37, s37, 11
    s_add_u32 s85, s37, s85
    s_bfe_u32 s37, s39, 0x40004
    s_lshl_b32 s37, s37, 16
    s_add_u32 s85, s37, s85
    s_waitcnt vmcnt(6)
    buffer_load_dwordx4 v[224:227], v76, s[52:55], s85 offen offset:0 nt
    s_waitcnt vmcnt(6)
    buffer_load_dwordx4 v[228:231], v77, s[52:55], s85 offen offset:0 nt
    s_waitcnt vmcnt(6)
    buffer_load_dwordx4 v[232:235], v76, s[52:55], s85 offen offset:1024 nt
    s_waitcnt vmcnt(6)
    buffer_load_dwordx4 v[236:239], v77, s[52:55], s85 offen offset:1024 nt
    s_add_u32 s87, s87, 7
    s_add_u32 s39, s87, s88
    s_bfe_u32 s37, s39, 0x30000
    s_lshl_b32 s37, s37, 12
    s_add_u32 s85, s37, s89
    s_bfe_u32 s37, s39, 0x10003
    s_lshl_b32 s37, s37, 11
    s_add_u32 s85, s37, s85
    s_bfe_u32 s37, s39, 0x40004
    s_lshl_b32 s37, s37, 16
    s_add_u32 s85, s37, s85
    s_waitcnt vmcnt(6)
    buffer_load_dwordx4 v[240:243], v76, s[52:55], s85 offen offset:0 nt
    s_waitcnt vmcnt(6)
    buffer_load_dwordx4 v[244:247], v77, s[52:55], s85 offen offset:0 nt
    s_waitcnt vmcnt(6)
    buffer_load_dwordx4 v[248:251], v76, s[52:55], s85 offen offset:1024 nt
    s_waitcnt vmcnt(6)
    buffer_load_dwordx4 v[252:255], v77, s[52:55], s85 offen offset:1024 nt
    s_add_u32 s87, s87, 7
    s_add_u32 s39, s87, s88
    s_bfe_u32 s37, s39, 0x30000
    s_lshl_b32 s37, s37, 12
    s_add_u32 s85, s37, s89
    s_bfe_u32 s37, s39, 0x10003
    s_lshl_b32 s37, s37, 11
    s_add_u32 s85, s37, s85
    s_bfe_u32 s37, s39, 0x40004
    s_lshl_b32 s37, s37, 16
    s_add_u32 s85, s37, s85
    s_waitcnt vmcnt(6)
    buffer_load_dwordx4 a[0:3], v76, s[52:55], s85 offen offset:0 nt
    s_waitcnt vmcnt(6)
    buffer_load_dwordx4 a[4:7], v77, s[52:55], s85 offen offset:0 nt
    buffer_load_dwordx4 v[68:71], v78, s[48:51], s91 offen offset:0 sc1
    buffer_load_dwordx4 v[72:75], v78, s[48:51], s91 offen offset:16 sc1
    s_waitcnt vmcnt(8)
    buffer_load_dwordx4 a[8:11], v76, s[52:55], s85 offen offset:1024 nt
    s_waitcnt vmcnt(8)
    buffer_load_dwordx4 a[12:15], v77, s[52:55], s85 offen offset:1024 nt
    s_add_u32 s87, s87, 7
    s_add_u32 s39, s87, s88
    s_bfe_u32 s37, s39, 0x30000
    s_lshl_b32 s37, s37, 12
    s_add_u32 s85, s37, s89
    s_bfe_u32 s37, s39, 0x10003
    s_lshl_b32 s37, s37, 11
    s_add_u32 s85, s37, s85
    s_bfe_u32 s37, s39, 0x40004
    s_lshl_b32 s37, s37, 16
    s_add_u32 s85, s37, s85
    s_waitcnt vmcnt(8)
    buffer_load_dwordx4 a[16:19], v76, s[52:55], s85 offen offset:0 nt
    s_waitcnt vmcnt(8)
    buffer_load_dwordx4 a[20:23], v77, s[52:55], s85 offen offset:0 nt
    s_waitcnt vmcnt(8)
    buffer_load_dwordx4 a[24:27], v76, s[52:55], s85 offen offset:1024 nt
    s_waitcnt vmcnt(8)
    buffer_load_dwordx4 a[28:31], v77, s[52:55], s85 offen offset:1024 nt
    s_add_u32 s87, s87, 7
    s_add_u32 s39, s87, s88
    s_bfe_u32 s37, s39, 0x30000
    s_lshl_b32 s37, s37, 12
    s_add_u32 s85, s37, s89
    s_bfe_u32 s37, s39, 0x10003
    s_lshl_b32 s37, s37, 11
    s_add_u32 s85, s37, s85
    s_bfe_u32 s37, s39, 0x40004
    s_lshl_b32 s37, s37, 16
    s_add_u32 s85, s37, s85
    s_waitcnt lgkmcnt(0)
    s_add_u32 s35, s35, 0x5b
    s_and_b32 s35, s35, 0xff
    v_mov_b32 v8, s35
    s_waitcnt vmcnt(6)
L_qcheck_1:
    v_xor_b32 v68, s35, v68
    v_xor_b32 v69, s35, v69
    v_xor_b32 v70, s35, v70
    v_xor_b32 v71, s35, v71
    v_xor_b32 v72, s35, v72
    v_xor_b32 v73, s35, v73
    v_xor_b32 v74, s35, v74
    v_xor_b32 v75, s35, v75
    v_or_b32 v4, v68, v69
    v_or3_b32 v4, v4, v70, v71
    v_or3_b32 v4, v4, v72, v73
    v_or3_b32 v4, v4, v74, v75
    v_and_b32 v4, 0xff, v4
    v_cmp_ne_u32 vcc, 0, v4
    s_cbranch_vccz L_qok_2
    buffer_load_dwordx4 v[68:71], v78, s[48:51], s91 offen offset:0 sc1
    buffer_load_dwordx4 v[72:75], v78, s[48:51], s91 offen offset:16 sc1
    s_waitcnt vmcnt(0)
    s_sub_u32 s84, s84, 1
    s_cmp_lg_u32 s84, 0
    s_cbranch_scc1 L_qcheck_1
    s_branch L_end
L_qok_2:
    v_cvt_pk_bf16_f32 v68, v68, v69
    v_cvt_pk_bf16_f32 v69, v70, v71
    v_cvt_pk_bf16_f32 v70, v72, v73
    v_cvt_pk_bf16_f32 v71, v74, v75
    s_mov_b32 vcc_lo, 0xf000f
    s_mov_b32 vcc_hi, 0xf000f
    v_cndmask_b32 v80, 0, v68, vcc
    v_cndmask_b32 v81, 0, v69, vcc
    v_cndmask_b32 v82, 0, v70, vcc
    v_cndmask_b32 v83, 0, v71, vcc
    s_mov_b32 vcc_lo, 0xf000f0
    s_mov_b32 vcc_hi, 0xf000f0
    v_cndmask_b32 v84, 0, v68, vcc
    v_cndmask_b32 v85, 0, v69, vcc
    v_cndmask_b32 v86, 0, v70, vcc
    v_cndmask_b32 v87, 0, v71, vcc
    s_mov_b32 vcc_lo, 0xf000f00
    s_mov_b32 vcc_hi, 0xf000f00
    v_cndmask_b32 v88, 0, v68, vcc
    v_cndmask_b32 v89, 0, v69, vcc
    v_cndmask_b32 v90, 0, v70, vcc
    v_cndmask_b32 v91, 0, v71, vcc
    s_mov_b32 vcc_lo, 0xf000f000
    s_mov_b32 vcc_hi, 0xf000f000
    v_cndmask_b32 v92, 0, v68, vcc
    v_cndmask_b32 v93, 0, v69, vcc
    v_cndmask_b32 v94, 0, v70, vcc
    v_cndmask_b32 v95, 0, v71, vcc
    v_mov_b32 v65, 0xff7f0000
    s_lshl_b32 s38, s34, 14
    s_add_u32 s38, s38, 16384
    v_lshl_add_u32 v64, v1, 2, s38
    buffer_load_dwordx4 a[32:35], v76, s[52:55], s85 offen offset:0 nt
    v_mfma_f32_16x16x32_bf16 v[112:115], v[128:131], v[80:83], 0
    v_mfma_f32_16x16x32_bf16 v[112:115], v[132:135], v[84:87], v[112:115]
    v_mfma_f32_16x16x32_bf16 v[112:115], v[136:139], v[88:91], v[112:115]
    s_waitcnt vmcnt(6)
    buffer_load_dwordx4 a[36:39], v77, s[52:55], s85 offen offset:0 nt
    v_mfma_f32_16x16x32_bf16 v[112:115], v[140:143], v[92:95], v[112:115]
    v_mfma_f32_16x16x32_bf16 v[96:99], v[144:147], v[80:83], 0
    v_mfma_f32_16x16x32_bf16 v[96:99], v[148:151], v[84:87], v[96:99]
    s_waitcnt vmcnt(6)
    buffer_load_dwordx4 a[40:43], v76, s[52:55], s85 offen offset:1024 nt
    v_mfma_f32_16x16x32_bf16 v[96:99], v[152:155], v[88:91], v[96:99]
    s_nop 2
    v_mov_b32_dpp v122, v112 quad_perm:[0,0,0,0] row_mask:0xf bank_mask:0xf
    v_mov_b32_dpp v124, v114 quad_perm:[2,2,2,2] row_mask:0xf bank_mask:0xf
    s_nop 0
    v_add_f32_dpp v122, v113, v122 quad_perm:[1,1,1,1] row_mask:0xf bank_mask:0xf
    v_add_f32_dpp v124, v115, v124 quad_perm:[3,3,3,3] row_mask:0xf bank_mask:0xf
    v_add_f32 v122, v122, v124
    v_max_f32 v65, v65, v122
    ds_write_b32 v64, v122 offset:0
    v_mfma_f32_16x16x32_bf16 v[96:99], v[156:159], v[92:95], v[96:99]
    v_mfma_f32_16x16x32_bf16 v[112:115], v[160:163], v[80:83], 0
    v_mfma_f32_16x16x32_bf16 v[112:115], v[164:167], v[84:87], v[112:115]
    s_waitcnt vmcnt(6)
    buffer_load_dwordx4 a[44:47], v77, s[52:55], s85 offen offset:1024 nt
    s_add_u32 s87, s87, 7
    s_add_u32 s39, s87, s88
    s_bfe_u32 s37, s39, 0x30000
    s_lshl_b32 s37, s37, 12
    s_add_u32 s85, s37, s89
    s_bfe_u32 s37, s39, 0x10003
    s_lshl_b32 s37, s37, 11
    s_add_u32 s85, s37, s85
    s_bfe_u32 s37, s39, 0x40004
    s_lshl_b32 s37, s37, 16
    s_add_u32 s85, s37, s85
    v_mfma_f32_16x16x32_bf16 v[112:115], v[168:171], v[88:91], v[112:115]
    v_mov_b32_dpp v122, v96 quad_perm:[0,0,0,0] row_mask:0xf bank_mask:0xf
    v_mov_b32_dpp v124, v98 quad_perm:[2,2,2,2] row_mask:0xf bank_mask:0xf
    s_nop 0
    v_add_f32_dpp v122, v97, v122 quad_perm:[1,1,1,1] row_mask:0xf bank_mask:0xf
    v_add_f32_dpp v124, v99, v124 quad_perm:[3,3,3,3] row_mask:0xf bank_mask:0xf
    v_add_f32 v122, v122, v124
    v_max_f32 v65, v65, v122
    ds_write_b32 v64, v122 offset:256
    v_mfma_f32_16x16x32_bf16 v[112:115], v[172:175], v[92:95], v[112:115]
    v_mfma_f32_16x16x32_bf16 v[96:99], v[176:179], v[80:83], 0
    s_waitcnt vmcnt(6)
    buffer_load_dwordx4 a[48:51], v76, s[52:55], s85 offen offset:0 nt
    v_mfma_f32_16x16x32_bf16 v[96:99], v[180:183], v[84:87], v[96:99]
    v_mfma_f32_16x16x32_bf16 v[96:99], v[184:187], v[88:91], v[96:99]
    s_nop 2
    v_mov_b32_dpp v122, v112 quad_perm:[0,0,0,0] row_mask:0xf bank_mask:0xf
    v_mov_b32_dpp v124, v114 quad_perm:[2,2,2,2] row_mask:0xf bank_mask:0xf
    s_nop 0
    v_add_f32_dpp v122, v113, v122 quad_perm:[1,1,1,1] row_mask:0xf bank_mask:0xf
    v_add_f32_dpp v124, v115, v124 quad_perm:[3,3,3,3] row_mask:0xf bank_mask:0xf
    v_add_f32 v122, v122, v124
    v_max_f32 v65, v65, v122
    ds_write_b32 v64, v122 offset:512
    v_mfma_f32_16x16x32_bf16 v[96:99], v[188:191], v[92:95], v[96:99]
    v_mfma_f32_16x16x32_bf16 v[112:115], v[192:195], v[80:83], 0
    s_waitcnt vmcnt(6)
    buffer_load_dwordx4 a[52:55], v77, s[52:55], s85 offen offset:0 nt
    v_mfma_f32_16x16x32_bf16 v[112:115], v[196:199], v[84:87], v[112:115]
    v_mfma_f32_16x16x32_bf16 v[112:115], v[200:203], v[88:91], v[112:115]
    s_nop 2
    v_mov_b32_dpp v122, v96 quad_perm:[0,0,0,0] row_mask:0xf bank_mask:0xf
    v_mov_b32_dpp v124, v98 quad_perm:[2,2,2,2] row_mask:0xf bank_mask:0xf
    s_nop 0
    v_add_f32_dpp v122, v97, v122 quad_perm:[1,1,1,1] row_mask:0xf bank_mask:0xf
    v_add_f32_dpp v124, v99, v124 quad_perm:[3,3,3,3] row_mask:0xf bank_mask:0xf
    v_add_f32 v122, v122, v124
    v_max_f32 v65, v65, v122
    ds_write_b32 v64, v122 offset:768
    v_mfma_f32_16x16x32_bf16 v[112:115], v[204:207], v[92:95], v[112:115]
    s_waitcnt vmcnt(6)
    buffer_load_dwordx4 a[56:59], v76, s[52:55], s85 offen offset:1024 nt
    v_mfma_f32_16x16x32_bf16 v[96:99], v[208:211], v[80:83], 0
    v_mfma_f32_16x16x32_bf16 v[96:99], v[212:215], v[84:87], v[96:99]
    v_mfma_f32_16x16x32_bf16 v[96:99], v[216:219], v[88:91], v[96:99]
    s_nop 2
    v_mov_b32_dpp v122, v112 quad_perm:[0,0,0,0] row_mask:0xf bank_mask:0xf
    v_mov_b32_dpp v124, v114 quad_perm:[2,2,2,2] row_mask:0xf bank_mask:0xf
    s_nop 0
    v_add_f32_dpp v122, v113, v122 quad_perm:[1,1,1,1] row_mask:0xf bank_mask:0xf
    v_add_f32_dpp v124, v115, v124 quad_perm:[3,3,3,3] row_mask:0xf bank_mask:0xf
    v_add_f32 v122, v122, v124
    v_max_f32 v65, v65, v122
    ds_write_b32 v64, v122 offset:1024
    v_mfma_f32_16x16x32_bf16 v[96:99], v[220:223], v[92:95], v[96:99]
    s_waitcnt vmcnt(6)
    buffer_load_dwordx4 a[60:63], v77, s[52:55], s85 offen offset:1024 nt
    s_add_u32 s87, s87, 7
    s_add_u32 s39, s87, s88
    s_bfe_u32 s37, s39, 0x30000
    s_lshl_b32 s37, s37, 12
    s_add_u32 s85, s37, s89
    s_bfe_u32 s37, s39, 0x10003
    s_lshl_b32 s37, s37, 11
    s_add_u32 s85, s37, s85
    s_bfe_u32 s37, s39, 0x40004
    s_lshl_b32 s37, s37, 16
    s_add_u32 s85, s37, s85
    v_mfma_f32_16x16x32_bf16 v[112:115], v[224:227], v[80:83], 0
    s_sub_u32 s36, s33, 3
    s_and_b32 s37, s33, 3
    s_cmp_lt_u32 s36, 4
    s_cselect_b64 s[40:41], s[24:25], s[14:15]
    s_cselect_b32 s36, s36, s37
    s_cselect_b32 s45, 262144, 0
    s_cselect_b32 s46, 8388608, 0
    s_add_u32 s45, s45, 524288
    s_add_u32 s46, s46, 196608
    s_mov_b32 s42, 4194304
    s_mov_b32 s43, 0x20000
    s_lshl_b32 s38, s32, 17
    s_add_u32 s44, s38, 0
    s_lshl_b32 s38, s34, 15
    s_add_u32 s44, s38, s44
    s_lshl_b32 s38, s36, 8
    s_add_u32 s44, s38, s44
    s_lshl_b32 s38, s36, 16
    s_add_u32 s45, s38, s45
    s_lshr_b32 s38, s34, 1
    s_lshl_b32 s38, s38, 15
    s_add_u32 s45, s38, s45
    s_lshl_b32 s38, s32, 8
    s_add_u32 s45, s38, s45
    s_bfe_u32 s38, s34, 0x10000
    s_lshl_b32 s38, s38, 7
    s_add_u32 s45, s38, s45
    s_lshl_b32 s38, s32, 11
    s_add_u32 s46, s38, s46
    s_lshl_b32 s38, s34, 9
    s_add_u32 s46, s38, s46
    s_mov_b32 s72, s26
    s_and_b32 s73, s27, 0xffff
    s_mov_b32 s74, 8192
    s_mov_b32 s75, 0x20000
    v_mfma_f32_16x16x32_bf16 v[112:115], v[228:231], v[84:87], v[112:115]
    v_mfma_f32_16x16x32_bf16 v[112:115], v[232:235], v[88:91], v[112:115]
    v_mov_b32_dpp v122, v96 quad_perm:[0,0,0,0] row_mask:0xf bank_mask:0xf
    v_mov_b32_dpp v124, v98 quad_perm:[2,2,2,2] row_mask:0xf bank_mask:0xf
    s_nop 0
    v_add_f32_dpp v122, v97, v122 quad_perm:[1,1,1,1] row_mask:0xf bank_mask:0xf
    v_add_f32_dpp v124, v99, v124 quad_perm:[3,3,3,3] row_mask:0xf bank_mask:0xf
    v_add_f32 v122, v122, v124
    v_max_f32 v65, v65, v122
    ds_write_b32 v64, v122 offset:1280
    s_waitcnt vmcnt(5)
    buffer_load_dwordx4 v[128:131], v76, s[52:55], s85 offen offset:0 nt
    v_mfma_f32_16x16x32_bf16 v[112:115], v[236:239], v[92:95], v[112:115]
    v_mfma_f32_16x16x32_bf16 v[96:99], v[240:243], v[80:83], 0
    v_mfma_f32_16x16x32_bf16 v[96:99], v[244:247], v[84:87], v[96:99]
    s_waitcnt vmcnt(5)
    buffer_load_dwordx4 v[132:135], v77, s[52:55], s85 offen offset:0 nt
    v_mfma_f32_16x16x32_bf16 v[96:99], v[248:251], v[88:91], v[96:99]
    s_nop 2
    v_mov_b32_dpp v122, v112 quad_perm:[0,0,0,0] row_mask:0xf bank_mask:0xf
    v_mov_b32_dpp v124, v114 quad_perm:[2,2,2,2] row_mask:0xf bank_mask:0xf
    s_nop 0
    v_add_f32_dpp v122, v113, v122 quad_perm:[1,1,1,1] row_mask:0xf bank_mask:0xf
    v_add_f32_dpp v124, v115, v124 quad_perm:[3,3,3,3] row_mask:0xf bank_mask:0xf
    v_add_f32 v122, v122, v124
    v_max_f32 v65, v65, v122
    ds_write_b32 v64, v122 offset:1536
    v_lshlrev_b32 v4, 2, v2
    v_xor_b32 v4, v4, v3
    v_xor_b32 v5, 0, v4
    v_lshlrev_b32 v5, 4, v5
    v_lshl_add_u32 v20, v2, 10, v5
    v_xor_b32 v5, 1, v4
    v_lshlrev_b32 v5, 4, v5
    v_lshl_add_u32 v21, v2, 10, v5
    v_add_u32 v21, 3072, v21
    v_xor_b32 v5, 2, v4
    v_lshlrev_b32 v5, 4, v5
    v_lshl_add_u32 v22, v2, 10, v5
    v_add_u32 v22, 6144, v22
    v_xor_b32 v5, 3, v4
    v_lshlrev_b32 v5, 4, v5
    v_lshl_add_u32 v23, v2, 10, v5
    v_add_u32 v23, 9216, v23
    s_lshl_b32 s38, s32, 15
    s_add_u32 s47, s38, 1048576
    s_lshl_b32 s38, s3, 13
    s_add_u32 s47, s38, s47
    s_mul_i32 s38, s3, 320
    s_add_u32 s38, s38, 135168
    v_lshlrev_b32 v4, 6, v2
    v_lshl_add_u32 v4, v3, 1, v4
    v_add_u32 v31, s38, v4
    v_mfma_f32_16x16x32_bf16 v[96:99], v[252:255], v[92:95], v[96:99]
    v_mfma_f32_16x16x32_bf16 v[112:115], a[0:3], v[80:83], 0
    v_mfma_f32_16x16x32_bf16 v[112:115], a[4:7], v[84:87], v[112:115]
    s_waitcnt vmcnt(5)
    buffer_load_dwordx4 v[136:139], v76, s[52:55], s85 offen offset:1024 nt
    v_mfma_f32_16x16x32_bf16 v[112:115], a[8:11], v[88:91], v[112:115]
    s_nop 2
    v_mov_b32_dpp v122, v96 quad_perm:[0,0,0,0] row_mask:0xf bank_mask:0xf
    v_mov_b32_dpp v124, v98 quad_perm:[2,2,2,2] row_mask:0xf bank_mask:0xf
    s_nop 0
    v_add_f32_dpp v122, v97, v122 quad_perm:[1,1,1,1] row_mask:0xf bank_mask:0xf
    v_add_f32_dpp v124, v99, v124 quad_perm:[3,3,3,3] row_mask:0xf bank_mask:0xf
    v_add_f32 v122, v122, v124
    v_max_f32 v65, v65, v122
    ds_write_b32 v64, v122 offset:1792
    v_mfma_f32_16x16x32_bf16 v[112:115], a[12:15], v[92:95], v[112:115]
    v_mfma_f32_16x16x32_bf16 v[96:99], a[16:19], v[80:83], 0
    v_lshlrev_b32 v4, 11, v2
    v_bfe_u32 v5, v1, 2, 2
    v_lshl_add_u32 v4, v5, 8, v4
    v_bfe_u32 v5, v1, 2, 2
    v_lshl_add_u32 v4, v5, 6, v4
    v_bfe_u32 v5, v1, 4, 1
    v_lshl_add_u32 v4, v5, 5, v4
    v_bfe_u32 v5, v1, 1, 1
    v_lshl_add_u32 v4, v5, 4, v4
    v_bfe_u32 v5, v1, 0, 1
    v_lshl_add_u32 v4, v5, 3, v4
    s_lshl_b32 s38, s34, 6
    s_add_u32 s38, s38, 98304
    v_xor_b32 v24, s38, v4
    v_xor_b32 v25, 16, v24
    v_xor_b32 v26, 32, v24
    v_xor_b32 v27, 48, v24
    v_and_b32 v4, 3, v3
    v_lshrrev_b32 v5, 2, v3
    v_lshlrev_b32 v6, 4, v2
    v_add_u32 v6, 135168, v6
    s_movk_i32 s36, 320
    v_cmp_eq_u32 vcc, 0, v5
    s_nop 1
    v_cndmask_b32 v28, 4, v4, vcc
    v_mad_u32_u24 v28, v28, s36, v6
    v_cmp_eq_u32 vcc, 1, v5
    s_nop 1
    v_cndmask_b32 v29, 4, v4, vcc
    v_mad_u32_u24 v29, v29, s36, v6
    v_lshlrev_b32 v5, 2, v1
    v_add_u32 v5, 136448, v5
    v_mov_b32 v6, 0
    ds_write_b32 v5, v6
    s_waitcnt vmcnt(5)
    buffer_load_dwordx4 v[140:143], v77, s[52:55], s85 offen offset:1024 nt
    s_add_u32 s87, s87, 7
    s_add_u32 s39, s87, s88
    s_bfe_u32 s37, s39, 0x30000
    s_lshl_b32 s37, s37, 12
    s_add_u32 s85, s37, s89
    s_bfe_u32 s37, s39, 0x10003
    s_lshl_b32 s37, s37, 11
    s_add_u32 s85, s37, s85
    s_bfe_u32 s37, s39, 0x40004
    s_lshl_b32 s37, s37, 16
    s_add_u32 s85, s37, s85
    v_mfma_f32_16x16x32_bf16 v[96:99], a[20:23], v[84:87], v[96:99]
    v_mfma_f32_16x16x32_bf16 v[96:99], a[24:27], v[88:91], v[96:99]
    v_mov_b32_dpp v122, v112 quad_perm:[0,0,0,0] row_mask:0xf bank_mask:0xf
    v_mov_b32_dpp v124, v114 quad_perm:[2,2,2,2] row_mask:0xf bank_mask:0xf
    s_nop 0
    v_add_f32_dpp v122, v113, v122 quad_perm:[1,1,1,1] row_mask:0xf bank_mask:0xf
    v_add_f32_dpp v124, v115, v124 quad_perm:[3,3,3,3] row_mask:0xf bank_mask:0xf
    v_add_f32 v122, v122, v124
    v_max_f32 v65, v65, v122
    ds_write_b32 v64, v122 offset:2048
    v_mfma_f32_16x16x32_bf16 v[96:99], a[28:31], v[92:95], v[96:99]
    v_mfma_f32_16x16x32_bf16 v[112:115], a[32:35], v[80:83], 0
    s_waitcnt vmcnt(5)
    buffer_load_dwordx4 v[144:147], v76, s[52:55], s85 offen offset:0 nt
    v_mfma_f32_16x16x32_bf16 v[112:115], a[36:39], v[84:87], v[112:115]
    v_mfma_f32_16x16x32_bf16 v[112:115], a[40:43], v[88:91], v[112:115]
    s_nop 2
    v_mov_b32_dpp v122, v96 quad_perm:[0,0,0,0] row_mask:0xf bank_mask:0xf
    v_mov_b32_dpp v124, v98 quad_perm:[2,2,2,2] row_mask:0xf bank_mask:0xf
    s_nop 0
    v_add_f32_dpp v122, v97, v122 quad_perm:[1,1,1,1] row_mask:0xf bank_mask:0xf
    v_add_f32_dpp v124, v99, v124 quad_perm:[3,3,3,3] row_mask:0xf bank_mask:0xf
    v_add_f32 v122, v122, v124
    v_max_f32 v65, v65, v122
    ds_write_b32 v64, v122 offset:2304
    v_lshlrev_b32 v30, 4, v3
    v_lshl_add_u32 v30, v2, 13, v30
    s_lshl_b32 s38, s32, 13
    s_add_u32 s36, s38, 0
    s_lshl_b32 s38, s34, 6
    s_add_u32 s36, s38, s36
    v_lshrrev_b32 v5, 2, v1
    v_lshlrev_b32 v32, 8, v5
    v_bfe_u32 v5, v1, 0, 2
    v_lshl_add_u32 v32, v5, 4, v32
    v_add_u32 v32, s36, v32
    s_lshr_b32 s38, s32, 2
    s_lshl_b32 s38, s38, 7
    s_add_u32 s36, s38, 0
    s_lshl_b32 s38, s34, 5
    s_add_u32 s36, s38, s36
    s_bfe_u32 s38, s32, 0x20000
    s_lshl_b32 s38, s38, 3
    s_add_u32 s36, s38, s36
    v_bfe_u32 v5, v1, 0, 2
    v_lshlrev_b32 v33, 11, v5
    v_lshl_add_u32 v33, v2, 1, v33
    v_add_u32 v33, s36, v33
    v_and_b32 v5, 31, v1
    v_lshlrev_b32 v34, 4, v5
    s_mul_i32 s38, s34, 320
    s_add_u32 s38, s38, 135168
    v_lshl_add_u32 v35, v5, 3, s38
    v_mfma_f32_16x16x32_bf16 v[112:115], a[44:47], v[92:95], v[112:115]
    s_waitcnt vmcnt(5)
    buffer_load_dwordx4 v[148:151], v77, s[52:55], s85 offen offset:0 nt
    v_mfma_f32_16x16x32_bf16 v[96:99], a[48:51], v[80:83], 0
    v_mfma_f32_16x16x32_bf16 v[96:99], a[52:55], v[84:87], v[96:99]
    v_mfma_f32_16x16x32_bf16 v[96:99], a[56:59], v[88:91], v[96:99]
    s_nop 2
    v_mov_b32_dpp v122, v112 quad_perm:[0,0,0,0] row_mask:0xf bank_mask:0xf
    v_mov_b32_dpp v124, v114 quad_perm:[2,2,2,2] row_mask:0xf bank_mask:0xf
    s_nop 0
    v_add_f32_dpp v122, v113, v122 quad_perm:[1,1,1,1] row_mask:0xf bank_mask:0xf
    v_add_f32_dpp v124, v115, v124 quad_perm:[3,3,3,3] row_mask:0xf bank_mask:0xf
    v_add_f32 v122, v122, v124
    v_max_f32 v65, v65, v122
    ds_write_b32 v64, v122 offset:2560
    v_mfma_f32_16x16x32_bf16 v[96:99], a[60:63], v[92:95], v[96:99]
    v_add_u32 v64, 2816, v64
    s_mov_b32 s97, 10
    s_mov_b32 s86, 32
    s_and_b32 s36, s32, 3
    s_sub_u32 s80, s36, 2
    s_cmp_ge_u32 s36, 2
    s_cselect_b32 s80, s80, 8
    s_cselect_b32 s81, 27, 25
    s_cmp_eq_u32 s80, s33
    s_cselect_b32 s36, 2, 0
    s_sub_u32 s86, s86, s36
    s_lshr_b32 s36, s36, 1
    s_sub_u32 s97, s97, s36
    s_add_u32 s80, s80, 35
    s_sub_u32 s92, s81, 1
    s_mov_b32 s66, 134217728
    s_mov_b32 s67, 0x20000
    s_mov_b64 s[64:65], s[52:53]
    v_mov_b32 v62, v76
    v_mov_b32 v63, v77
L_bloop:
    s_waitcnt vmcnt(5)
    buffer_load_dwordx4 v[152:155], v62, s[64:67], s85 offen offset:1024 nt
    v_mfma_f32_16x16x32_bf16 v[112:115], v[128:131], v[80:83], 0
    s_waitcnt vmcnt(5)
    buffer_load_dwordx4 v[156:159], v63, s[64:67], s85 offen offset:1024 nt
    v_mfma_f32_16x16x32_bf16 v[112:115], v[132:135], v[84:87], v[112:115]
    s_add_u32 s87, s87, 7
    s_cmp_lg_u32 s97, 1
    s_cbranch_scc1 L_stayk_3
    s_mov_b64 s[64:65], s[56:57]
    v_mov_b32 v62, v126
    v_mov_b32 v63, v127
    s_mul_i32 s37, s86, 7
    s_sub_u32 s87, s87, s37
L_stayk_3:
    s_add_u32 s39, s87, s88
    s_bfe_u32 s37, s39, 0x30000
    s_lshl_b32 s37, s37, 12
    s_add_u32 s85, s37, s89
    s_bfe_u32 s37, s39, 0x10003
    s_lshl_b32 s37, s37, 11
    s_add_u32 s85, s37, s85
    s_bfe_u32 s37, s39, 0x40004
    s_lshl_b32 s37, s37, 16
    s_add_u32 s85, s37, s85
    v_mov_b32_dpp v122, v96 quad_perm:[0,0,0,0] row_mask:0xf bank_mask:0xf
    v_mov_b32_dpp v124, v98 quad_perm:[2,2,2,2] row_mask:0xf bank_mask:0xf
    s_nop 0
    v_add_f32_dpp v122, v97, v122 quad_perm:[1,1,1,1] row_mask:0xf bank_mask:0xf
    v_add_f32_dpp v124, v99, v124 quad_perm:[3,3,3,3] row_mask:0xf bank_mask:0xf
    v_add_f32 v122, v122, v124
    v_max_f32 v65, v65, v122
    ds_write_b32 v64, v122 offset:0
    s_waitcnt vmcnt(5)
    buffer_load_dwordx4 v[128:131], v62, s[64:67], s85 offen offset:0 nt
    v_mfma_f32_16x16x32_bf16 v[112:115], v[136:139], v[88:91], v[112:115]
    s_waitcnt vmcnt(5)
    buffer_load_dwordx4 v[132:135], v63, s[64:67], s85 offen offset:0 nt
    v_mfma_f32_16x16x32_bf16 v[112:115], v[140:143], v[92:95], v[112:115]
    s_waitcnt vmcnt(5)
    buffer_load_dwordx4 v[136:139], v62, s[64:67], s85 offen offset:1024 nt
    v_mfma_f32_16x16x32_bf16 v[96:99], v[144:147], v[80:83], 0
    s_waitcnt vmcnt(5)
    buffer_load_dwordx4 v[140:143], v63, s[64:67], s85 offen offset:1024 nt
    v_mfma_f32_16x16x32_bf16 v[96:99], v[148:151], v[84:87], v[96:99]
    s_add_u32 s87, s87, 7
    s_add_u32 s39, s87, s88
    s_bfe_u32 s37, s39, 0x30000
    s_lshl_b32 s37, s37, 12
    s_add_u32 s85, s37, s89
    s_bfe_u32 s37, s39, 0x10003
    s_lshl_b32 s37, s37, 11
    s_add_u32 s85, s37, s85
    s_bfe_u32 s37, s39, 0x40004
    s_lshl_b32 s37, s37, 16
    s_add_u32 s85, s37, s85
    v_mov_b32_dpp v122, v112 quad_perm:[0,0,0,0] row_mask:0xf bank_mask:0xf
    v_mov_b32_dpp v124, v114 quad_perm:[2,2,2,2] row_mask:0xf bank_mask:0xf
    s_nop 0
    v_add_f32_dpp v122, v113, v122 quad_perm:[1,1,1,1] row_mask:0xf bank_mask:0xf
    v_add_f32_dpp v124, v115, v124 quad_perm:[3,3,3,3] row_mask:0xf bank_mask:0xf
    v_add_f32 v122, v122, v124
    v_max_f32 v65, v65, v122
    ds_write_b32 v64, v122 offset:256
    s_waitcnt vmcnt(5)
    buffer_load_dwordx4 v[144:147], v62, s[64:67], s85 offen offset:0 nt
    v_mfma_f32_16x16x32_bf16 v[96:99], v[152:155], v[88:91], v[96:99]
    s_waitcnt vmcnt(5)
    buffer_load_dwordx4 v[148:151], v63, s[64:67], s85 offen offset:0 nt
    v_mfma_f32_16x16x32_bf16 v[96:99], v[156:159], v[92:95], v[96:99]
    v_add_u32 v64, 512, v64
    s_sub_u32 s97, s97, 1
    s_cmp_lg_u32 s97, 0
    s_cbranch_scc1 L_bloop
    s_nop 3
    v_mov_b32_dpp v122, v96 quad_perm:[0,0,0,0] row_mask:0xf bank_mask:0xf
    v_mov_b32_dpp v124, v98 quad_perm:[2,2,2,2] row_mask:0xf bank_mask:0xf
    s_nop 0
    v_add_f32_dpp v122, v97, v122 quad_perm:[1,1,1,1] row_mask:0xf bank_mask:0xf
    v_add_f32_dpp v124, v99, v124 quad_perm:[3,3,3,3] row_mask:0xf bank_mask:0xf
    v_add_f32 v122, v122, v124
    v_max_f32 v65, v65, v122
    ds_write_b32 v64, v122 offset:0
    v_mov_b32 v123, 0xff7f0000
    ds_write_b32 v64, v123 offset:256
    s_lshl_b32 s38, s34, 14
    s_add_u32 s38, s38, 16384
    v_lshl_add_u32 v64, v1, 2, s38
    ds_read_b32 v66, v64
    ds_read_b32 v67, v64 offset:256
    v_mul_f32 v65, s83, v65
    s_nop 1
    v_max_f32_dpp v124, v65, v65 row_ror:4 row_mask:0xf bank_mask:0xf
    s_nop 1
    v_max_f32_dpp v124, v124, v124 row_ror:8 row_mask:0xf bank_mask:0xf
    v_mov_b32 v125, v124
    s_nop 1
    v_permlane16_swap_b32 v124, v125
    v_max_f32 v124, v124, v125
    v_mov_b32 v125, v124
    s_nop 1
    v_permlane32_swap_b32 v124, v125
    v_max_f32 v124, v124, v125
    v_mov_b32 v120, v124
    s_lshr_b32 s97, s86, 1
    s_waitcnt lgkmcnt(1)
    v_fma_f32 v123, v66, s83, -v120
    v_exp_f32 v123, v123
    ds_read_b32 v66, v64 offset:512
    v_cvt_pk_bf16_f32 v100, v123, v123
    v_add_f32 v121, v121, v123
L_vloop:
    s_nop 0
    v_and_b32_dpp v104, v100, v10 row_newbcast:0 row_mask:0xf bank_mask:0xf
    v_and_b32_dpp v105, v100, v11 row_newbcast:0 row_mask:0xf bank_mask:0xf
    v_and_b32_dpp v106, v100, v12 row_newbcast:0 row_mask:0xf bank_mask:0xf
    v_and_b32_dpp v107, v100, v13 row_newbcast:0 row_mask:0xf bank_mask:0xf
    s_waitcnt vmcnt(5)
    buffer_load_dwordx4 v[152:155], v62, s[64:67], s85 offen offset:1024 nt
    v_mfma_f32_16x16x32_bf16 v[116:119], v[128:131], v[104:107], v[116:119]
    v_and_b32_dpp v108, v100, v10 row_newbcast:4 row_mask:0xf bank_mask:0xf
    v_and_b32_dpp v109, v100, v11 row_newbcast:4 row_mask:0xf bank_mask:0xf
    v_and_b32_dpp v110, v100, v12 row_newbcast:4 row_mask:0xf bank_mask:0xf
    v_and_b32_dpp v111, v100, v13 row_newbcast:4 row_mask:0xf bank_mask:0xf
    s_waitcnt vmcnt(5)
    buffer_load_dwordx4 v[156:159], v63, s[64:67], s85 offen offset:1024 nt
    v_mfma_f32_16x16x32_bf16 v[116:119], v[132:135], v[108:111], v[116:119]
    s_add_u32 s87, s87, 7
    s_cmp_lg_u32 s97, 1
    s_cbranch_scc1 L_stayv_4
    s_mov_b64 s[64:65], s[52:53]
    v_mov_b32 v62, v76
    v_mov_b32 v63, v77
    s_mov_b64 exec, 1
    global_atomic_add v19, v9, v18, s[30:31] sc0 sc1
    s_mov_b64 exec, -1
    s_add_u32 s87, s33, 224
L_stayv_4:
    s_add_u32 s39, s87, s88
    s_bfe_u32 s37, s39, 0x30000
    s_lshl_b32 s37, s37, 12
    s_add_u32 s85, s37, s89
    s_bfe_u32 s37, s39, 0x10003
    s_lshl_b32 s37, s37, 11
    s_add_u32 s85, s37, s85
    s_bfe_u32 s37, s39, 0x40004
    s_lshl_b32 s37, s37, 16
    s_add_u32 s85, s37, s85
    s_waitcnt lgkmcnt(1)
    v_fma_f32 v123, v67, s83, -v120
    v_exp_f32 v123, v123
    ds_read_b32 v67, v64 offset:768
    v_cvt_pk_bf16_f32 v101, v123, v123
    v_add_f32 v121, v121, v123
    v_and_b32_dpp v104, v100, v10 row_newbcast:8 row_mask:0xf bank_mask:0xf
    v_and_b32_dpp v105, v100, v11 row_newbcast:8 row_mask:0xf bank_mask:0xf
    v_and_b32_dpp v106, v100, v12 row_newbcast:8 row_mask:0xf bank_mask:0xf
    v_and_b32_dpp v107, v100, v13 row_newbcast:8 row_mask:0xf bank_mask:0xf
    s_waitcnt vmcnt(5)
    buffer_load_dwordx4 v[128:131], v62, s[64:67], s85 offen offset:0 nt
    v_mfma_f32_16x16x32_bf16 v[116:119], v[136:139], v[104:107], v[116:119]
    v_and_b32_dpp v108, v100, v10 row_newbcast:12 row_mask:0xf bank_mask:0xf
    v_and_b32_dpp v109, v100, v11 row_newbcast:12 row_mask:0xf bank_mask:0xf
    v_and_b32_dpp v110, v100, v12 row_newbcast:12 row_mask:0xf bank_mask:0xf
    v_and_b32_dpp v111, v100, v13 row_newbcast:12 row_mask:0xf bank_mask:0xf
    s_waitcnt vmcnt(5)
    buffer_load_dwordx4 v[132:135], v63, s[64:67], s85 offen offset:0 nt
    v_mfma_f32_16x16x32_bf16 v[116:119], v[140:143], v[108:111], v[116:119]
    v_and_b32_dpp v104, v101, v10 row_newbcast:0 row_mask:0xf bank_mask:0xf
    v_and_b32_dpp v105, v101, v11 row_newbcast:0 row_mask:0xf bank_mask:0xf
    v_and_b32_dpp v106, v101, v12 row_newbcast:0 row_mask:0xf bank_mask:0xf
    v_and_b32_dpp v107, v101, v13 row_newbcast:0 row_mask:0xf bank_mask:0xf
    s_waitcnt vmcnt(5)
    buffer_load_dwordx4 v[136:139], v62, s[64:67], s85 offen offset:1024 nt
    v_mfma_f32_16x16x32_bf16 v[116:119], v[144:147], v[104:107], v[116:119]
    v_and_b32_dpp v108, v101, v10 row_newbcast:4 row_mask:0xf bank_mask:0xf
    v_and_b32_dpp v109, v101, v11 row_newbcast:4 row_mask:0xf bank_mask:0xf
    v_and_b32_dpp v110, v101, v12 row_newbcast:4 row_mask:0xf bank_mask:0xf
    v_and_b32_dpp v111, v101, v13 row_newbcast:4 row_mask:0xf bank_mask:0xf
    s_waitcnt vmcnt(5)
    buffer_load_dwordx4 v[140:143], v63, s[64:67], s85 offen offset:1024 nt
    v_mfma_f32_16x16x32_bf16 v[116:119], v[148:151], v[108:111], v[116:119]
    s_add_u32 s87, s87, 7
    s_cmp_lg_u32 s97, 1
    s_cbranch_scc1 L_stayv_5
    s_mov_b64 s[64:65], s[56:57]
    v_mov_b32 v62, v126
    v_mov_b32 v63, v127
    s_add_u32 s87, s33, 224
L_stayv_5:
    s_add_u32 s39, s87, s88
    s_bfe_u32 s37, s39, 0x30000
    s_lshl_b32 s37, s37, 12
    s_add_u32 s85, s37, s89
    s_bfe_u32 s37, s39, 0x10003
    s_lshl_b32 s37, s37, 11
    s_add_u32 s85, s37, s85
    s_bfe_u32 s37, s39, 0x40004
    s_lshl_b32 s37, s37, 16
    s_add_u32 s85, s37, s85
    v_add_u32 v64, 512, v64
    s_waitcnt lgkmcnt(1)
    v_fma_f32 v123, v66, s83, -v120
    v_exp_f32 v123, v123
    ds_read_b32 v66, v64 offset:512
    v_cvt_pk_bf16_f32 v100, v123, v123
    v_add_f32 v121, v121, v123
    v_and_b32_dpp v104, v101, v10 row_newbcast:8 row_mask:0xf bank_mask:0xf
    v_and_b32_dpp v105, v101, v11 row_newbcast:8 row_mask:0xf bank_mask:0xf
    v_and_b32_dpp v106, v101, v12 row_newbcast:8 row_mask:0xf bank_mask:0xf
    v_and_b32_dpp v107, v101, v13 row_newbcast:8 row_mask:0xf bank_mask:0xf
    s_waitcnt vmcnt(5)
    buffer_load_dwordx4 v[144:147], v62, s[64:67], s85 offen offset:0 nt
    v_mfma_f32_16x16x32_bf16 v[116:119], v[152:155], v[104:107], v[116:119]
    v_and_b32_dpp v108, v101, v10 row_newbcast:12 row_mask:0xf bank_mask:0xf
    v_and_b32_dpp v109, v101, v11 row_newbcast:12 row_mask:0xf bank_mask:0xf
    v_and_b32_dpp v110, v101, v12 row_newbcast:12 row_mask:0xf bank_mask:0xf
    v_and_b32_dpp v111, v101, v13 row_newbcast:12 row_mask:0xf bank_mask:0xf
    s_waitcnt vmcnt(5)
    buffer_load_dwordx4 v[148:151], v63, s[64:67], s85 offen offset:0 nt
    v_mfma_f32_16x16x32_bf16 v[116:119], v[156:159], v[108:111], v[116:119]
    s_sub_u32 s97, s97, 1
    s_cmp_lg_u32 s97, 0
    s_cbranch_scc1 L_vloop
    buffer_load_dwordx4 v[152:155], v126, s[56:59], s85 offen offset:1024 nt
    buffer_load_dwordx4 v[156:159], v127, s[56:59], s85 offen offset:1024 nt
L_dloop:
    s_waitcnt vmcnt(7)
    v_readfirstlane_b32 s93, v19
    v_mov_b32 v19, 64
    s_cmp_ge_u32 s93, s81
    s_cbranch_scc1 L_last0
    s_add_u32 s87, s93, 231
    s_mul_i32 s36, s93, 7
    s_add_u32 s36, s36, s80
    s_cmp_ge_u32 s93, 25
    s_cselect_b32 s87, s36, s87
    s_add_u32 s39, s87, s88
    s_bfe_u32 s37, s39, 0x30000
    s_lshl_b32 s37, s37, 12
    s_add_u32 s85, s37, s89
    s_bfe_u32 s37, s39, 0x10003
    s_lshl_b32 s37, s37, 11
    s_add_u32 s85, s37, s85
    s_bfe_u32 s37, s39, 0x40004
    s_lshl_b32 s37, s37, 16
    s_add_u32 s85, s37, s85
    s_cmp_ge_u32 s93, s92
    s_cbranch_scc1 L_noclaim_6
    s_mov_b64 exec, 1
    global_atomic_add v19, v9, v18, s[30:31] sc0 sc1
    s_mov_b64 exec, -1
L_noclaim_6:
    buffer_load_dwordx4 v[160:163], v76, s[52:55], s85 offen offset:0 nt
    v_mfma_f32_16x16x32_bf16 v[112:115], v[128:131], v[80:83], 0
    s_waitcnt vmcnt(7)
    buffer_load_dwordx4 v[164:167], v77, s[52:55], s85 offen offset:0 nt
    v_mfma_f32_16x16x32_bf16 v[112:115], v[132:135], v[84:87], v[112:115]
    s_waitcnt vmcnt(7)
    buffer_load_dwordx4 v[168:171], v76, s[52:55], s85 offen offset:1024 nt
    v_mfma_f32_16x16x32_bf16 v[112:115], v[136:139], v[88:91], v[112:115]
    s_waitcnt vmcnt(7)
    buffer_load_dwordx4 v[172:175], v77, s[52:55], s85 offen offset:1024 nt
    v_mfma_f32_16x16x32_bf16 v[112:115], v[140:143], v[92:95], v[112:115]
    s_nop 7
    v_mov_b32_dpp v122, v112 quad_perm:[0,0,0,0] row_mask:0xf bank_mask:0xf
    v_mov_b32_dpp v124, v114 quad_perm:[2,2,2,2] row_mask:0xf bank_mask:0xf
    s_nop 0
    v_add_f32_dpp v122, v113, v122 quad_perm:[1,1,1,1] row_mask:0xf bank_mask:0xf
    v_add_f32_dpp v124, v115, v124 quad_perm:[3,3,3,3] row_mask:0xf bank_mask:0xf
    v_add_f32 v122, v122, v124
    v_fma_f32 v123, v122, s83, -v120
    v_cmp_lt_f32 vcc, 0, v123
    s_cbranch_vccz L_nomax_7
    v_mul_f32 v122, s83, v122
    s_nop 1
    v_max_f32_dpp v124, v122, v122 row_ror:4 row_mask:0xf bank_mask:0xf
    s_nop 1
    v_max_f32_dpp v124, v124, v124 row_ror:8 row_mask:0xf bank_mask:0xf
    v_mov_b32 v125, v124
    s_nop 1
    v_permlane16_swap_b32 v124, v125
    v_max_f32 v124, v124, v125
    v_mov_b32 v125, v124
    s_nop 1
    v_permlane32_swap_b32 v124, v125
    v_max_f32 v124, v124, v125
    v_max_f32 v124, v124, v120
    v_sub_f32 v125, v120, v124
    v_exp_f32 v125, v125
    v_mov_b32 v120, v124
    v_sub_f32 v123, v122, v124
    v_mul_f32 v121, v121, v125
    v_mul_f32 v116, v116, v125
    v_mul_f32 v117, v117, v125
    v_mul_f32 v118, v118, v125
    v_mul_f32 v119, v119, v125
L_nomax_7:
    v_exp_f32 v123, v123
    s_nop 0
    v_cvt_pk_bf16_f32 v124, v123, v123
    v_add_f32 v121, v121, v123
    s_nop 0
    v_and_b32_dpp v96, v124, v10 row_newbcast:0 row_mask:0xf bank_mask:0xf
    v_and_b32_dpp v97, v124, v11 row_newbcast:0 row_mask:0xf bank_mask:0xf
    v_and_b32_dpp v98, v124, v12 row_newbcast:0 row_mask:0xf bank_mask:0xf
    v_and_b32_dpp v99, v124, v13 row_newbcast:0 row_mask:0xf bank_mask:0xf
    v_and_b32_dpp v100, v124, v10 row_newbcast:4 row_mask:0xf bank_mask:0xf
    v_and_b32_dpp v101, v124, v11 row_newbcast:4 row_mask:0xf bank_mask:0xf
    v_and_b32_dpp v102, v124, v12 row_newbcast:4 row_mask:0xf bank_mask:0xf
    v_and_b32_dpp v103, v124, v13 row_newbcast:4 row_mask:0xf bank_mask:0xf
    v_and_b32_dpp v104, v124, v10 row_newbcast:8 row_mask:0xf bank_mask:0xf
    v_and_b32_dpp v105, v124, v11 row_newbcast:8 row_mask:0xf bank_mask:0xf
    v_and_b32_dpp v106, v124, v12 row_newbcast:8 row_mask:0xf bank_mask:0xf
    v_and_b32_dpp v107, v124, v13 row_newbcast:8 row_mask:0xf bank_mask:0xf
    v_and_b32_dpp v108, v124, v10 row_newbcast:12 row_mask:0xf bank_mask:0xf
    v_and_b32_dpp v109, v124, v11 row_newbcast:12 row_mask:0xf bank_mask:0xf
    v_and_b32_dpp v110, v124, v12 row_newbcast:12 row_mask:0xf bank_mask:0xf
    v_and_b32_dpp v111, v124, v13 row_newbcast:12 row_mask:0xf bank_mask:0xf
    s_waitcnt vmcnt(7)
    buffer_load_dwordx4 v[176:179], v126, s[56:59], s85 offen offset:0 nt
    v_mfma_f32_16x16x32_bf16 v[116:119], v[144:147], v[96:99], v[116:119]
    s_waitcnt vmcnt(7)
    buffer_load_dwordx4 v[180:183], v127, s[56:59], s85 offen offset:0 nt
    v_mfma_f32_16x16x32_bf16 v[116:119], v[148:151], v[100:103], v[116:119]
    s_waitcnt vmcnt(7)
    buffer_load_dwordx4 v[184:187], v126, s[56:59], s85 offen offset:1024 nt
    v_mfma_f32_16x16x32_bf16 v[116:119], v[152:155], v[104:107], v[116:119]
    s_waitcnt vmcnt(7)
    buffer_load_dwordx4 v[188:191], v127, s[56:59], s85 offen offset:1024 nt
    v_mfma_f32_16x16x32_bf16 v[116:119], v[156:159], v[108:111], v[116:119]
    s_waitcnt vmcnt(7)
    v_readfirstlane_b32 s93, v19
    v_mov_b32 v19, 64
    s_cmp_ge_u32 s93, s81
    s_cbranch_scc1 L_last1
    s_add_u32 s87, s93, 231
    s_mul_i32 s36, s93, 7
    s_add_u32 s36, s36, s80
    s_cmp_ge_u32 s93, 25
    s_cselect_b32 s87, s36, s87
    s_add_u32 s39, s87, s88
    s_bfe_u32 s37, s39, 0x30000
    s_lshl_b32 s37, s37, 12
    s_add_u32 s85, s37, s89
    s_bfe_u32 s37, s39, 0x10003
    s_lshl_b32 s37, s37, 11
    s_add_u32 s85, s37, s85
    s_bfe_u32 s37, s39, 0x40004
    s_lshl_b32 s37, s37, 16
    s_add_u32 s85, s37, s85
    s_cmp_ge_u32 s93, s92
    s_cbranch_scc1 L_noclaim_8
    s_mov_b64 exec, 1
    global_atomic_add v19, v9, v18, s[30:31] sc0 sc1
    s_mov_b64 exec, -1
L_noclaim_8:
    buffer_load_dwordx4 v[128:131], v76, s[52:55], s85 offen offset:0 nt
    v_mfma_f32_16x16x32_bf16 v[112:115], v[160:163], v[80:83], 0
    s_waitcnt vmcnt(7)
    buffer_load_dwordx4 v[132:135], v77, s[52:55], s85 offen offset:0 nt
    v_mfma_f32_16x16x32_bf16 v[112:115], v[164:167], v[84:87], v[112:115]
    s_waitcnt vmcnt(7)
    buffer_load_dwordx4 v[136:139], v76, s[52:55], s85 offen offset:1024 nt
    v_mfma_f32_16x16x32_bf16 v[112:115], v[168:171], v[88:91], v[112:115]
    s_waitcnt vmcnt(7)
    buffer_load_dwordx4 v[140:143], v77, s[52:55], s85 offen offset:1024 nt
    v_mfma_f32_16x16x32_bf16 v[112:115], v[172:175], v[92:95], v[112:115]
    s_nop 7
    v_mov_b32_dpp v122, v112 quad_perm:[0,0,0,0] row_mask:0xf bank_mask:0xf
    v_mov_b32_dpp v124, v114 quad_perm:[2,2,2,2] row_mask:0xf bank_mask:0xf
    s_nop 0
    v_add_f32_dpp v122, v113, v122 quad_perm:[1,1,1,1] row_mask:0xf bank_mask:0xf
    v_add_f32_dpp v124, v115, v124 quad_perm:[3,3,3,3] row_mask:0xf bank_mask:0xf
    v_add_f32 v122, v122, v124
    v_fma_f32 v123, v122, s83, -v120
    v_cmp_lt_f32 vcc, 0, v123
    s_cbranch_vccz L_nomax_9
    v_mul_f32 v122, s83, v122
    s_nop 1
    v_max_f32_dpp v124, v122, v122 row_ror:4 row_mask:0xf bank_mask:0xf
    s_nop 1
    v_max_f32_dpp v124, v124, v124 row_ror:8 row_mask:0xf bank_mask:0xf
    v_mov_b32 v125, v124
    s_nop 1
    v_permlane16_swap_b32 v124, v125
    v_max_f32 v124, v124, v125
    v_mov_b32 v125, v124
    s_nop 1
    v_permlane32_swap_b32 v124, v125
    v_max_f32 v124, v124, v125
    v_max_f32 v124, v124, v120
    v_sub_f32 v125, v120, v124
    v_exp_f32 v125, v125
    v_mov_b32 v120, v124
    v_sub_f32 v123, v122, v124
    v_mul_f32 v121, v121, v125
    v_mul_f32 v116, v116, v125
    v_mul_f32 v117, v117, v125
    v_mul_f32 v118, v118, v125
    v_mul_f32 v119, v119, v125
L_nomax_9:
    v_exp_f32 v123, v123
    s_nop 0
    v_cvt_pk_bf16_f32 v124, v123, v123
    v_add_f32 v121, v121, v123
    s_nop 0
    v_and_b32_dpp v96, v124, v10 row_newbcast:0 row_mask:0xf bank_mask:0xf
    v_and_b32_dpp v97, v124, v11 row_newbcast:0 row_mask:0xf bank_mask:0xf
    v_and_b32_dpp v98, v124, v12 row_newbcast:0 row_mask:0xf bank_mask:0xf
    v_and_b32_dpp v99, v124, v13 row_newbcast:0 row_mask:0xf bank_mask:0xf
    v_and_b32_dpp v100, v124, v10 row_newbcast:4 row_mask:0xf bank_mask:0xf
    v_and_b32_dpp v101, v124, v11 row_newbcast:4 row_mask:0xf bank_mask:0xf
    v_and_b32_dpp v102, v124, v12 row_newbcast:4 row_mask:0xf bank_mask:0xf
    v_and_b32_dpp v103, v124, v13 row_newbcast:4 row_mask:0xf bank_mask:0xf
    v_and_b32_dpp v104, v124, v10 row_newbcast:8 row_mask:0xf bank_mask:0xf
    v_and_b32_dpp v105, v124, v11 row_newbcast:8 row_mask:0xf bank_mask:0xf
    v_and_b32_dpp v106, v124, v12 row_newbcast:8 row_mask:0xf bank_mask:0xf
    v_and_b32_dpp v107, v124, v13 row_newbcast:8 row_mask:0xf bank_mask:0xf
    v_and_b32_dpp v108, v124, v10 row_newbcast:12 row_mask:0xf bank_mask:0xf
    v_and_b32_dpp v109, v124, v11 row_newbcast:12 row_mask:0xf bank_mask:0xf
    v_and_b32_dpp v110, v124, v12 row_newbcast:12 row_mask:0xf bank_mask:0xf
    v_and_b32_dpp v111, v124, v13 row_newbcast:12 row_mask:0xf bank_mask:0xf
    s_waitcnt vmcnt(7)
    buffer_load_dwordx4 v[144:147], v126, s[56:59], s85 offen offset:0 nt
    v_mfma_f32_16x16x32_bf16 v[116:119], v[176:179], v[96:99], v[116:119]
    s_waitcnt vmcnt(7)
    buffer_load_dwordx4 v[148:151], v127, s[56:59], s85 offen offset:0 nt
    v_mfma_f32_16x16x32_bf16 v[116:119], v[180:183], v[100:103], v[116:119]
    s_waitcnt vmcnt(7)
    buffer_load_dwordx4 v[152:155], v126, s[56:59], s85 offen offset:1024 nt
    v_mfma_f32_16x16x32_bf16 v[116:119], v[184:187], v[104:107], v[116:119]
    s_waitcnt vmcnt(7)
    buffer_load_dwordx4 v[156:159], v127, s[56:59], s85 offen offset:1024 nt
    v_mfma_f32_16x16x32_bf16 v[116:119], v[188:191], v[108:111], v[116:119]
    s_branch L_dloop
L_last1:
    buffer_load_dwordx4 v[224:227], v34, s[48:51], s46 offen sc1
    s_lshl_b32 s39, s34, 13
    s_add_u32 s39, s39, 98304
    s_mov_b32 m0, s39
    s_nop 0
    buffer_load_dwordx4 v20, s[40:43], s44 offen offset:0 nt lds
    v_mfma_f32_16x16x32_bf16 v[112:115], v[160:163], v[80:83], 0
    s_waitcnt vmcnt(8)
    buffer_load_dwordx4 v21, s[40:43], s44 offen offset:1024 nt lds
    v_mfma_f32_16x16x32_bf16 v[112:115], v[164:167], v[84:87], v[112:115]
    s_waitcnt vmcnt(8)
    buffer_load_dwordx4 v22, s[40:43], s44 offen offset:2048 nt lds
    v_mfma_f32_16x16x32_bf16 v[112:115], v[168:171], v[88:91], v[112:115]
    s_waitcnt vmcnt(8)
    buffer_load_dwordx4 v23, s[40:43], s44 offen offset:3072 nt lds
    v_mfma_f32_16x16x32_bf16 v[112:115], v[172:175], v[92:95], v[112:115]
    s_nop 7
    v_mov_b32_dpp v122, v112 quad_perm:[0,0,0,0] row_mask:0xf bank_mask:0xf
    v_mov_b32_dpp v124, v114 quad_perm:[2,2,2,2] row_mask:0xf bank_mask:0xf
    s_nop 0
    v_add_f32_dpp v122, v113, v122 quad_perm:[1,1,1,1] row_mask:0xf bank_mask:0xf
    v_add_f32_dpp v124, v115, v124 quad_perm:[3,3,3,3] row_mask:0xf bank_mask:0xf
    v_add_f32 v122, v122, v124
    v_fma_f32 v123, v122, s83, -v120
    v_cmp_lt_f32 vcc, 0, v123
    s_cbranch_vccz L_nomax_10
    v_mul_f32 v122, s83, v122
    s_nop 1
    v_max_f32_dpp v124, v122, v122 row_ror:4 row_mask:0xf bank_mask:0xf
    s_nop 1
    v_max_f32_dpp v124, v124, v124 row_ror:8 row_mask:0xf bank_mask:0xf
    v_mov_b32 v125, v124
    s_nop 1
    v_permlane16_swap_b32 v124, v125
    v_max_f32 v124, v124, v125
    v_mov_b32 v125, v124
    s_nop 1
    v_permlane32_swap_b32 v124, v125
    v_max_f32 v124, v124, v125
    v_max_f32 v124, v124, v120
    v_sub_f32 v125, v120, v124
    v_exp_f32 v125, v125
    v_mov_b32 v120, v124
    v_sub_f32 v123, v122, v124
    v_mul_f32 v121, v121, v125
    v_mul_f32 v116, v116, v125
    v_mul_f32 v117, v117, v125
    v_mul_f32 v118, v118, v125
    v_mul_f32 v119, v119, v125
L_nomax_10:
    v_exp_f32 v123, v123
    s_nop 0
    v_cvt_pk_bf16_f32 v124, v123, v123
    v_add_f32 v121, v121, v123
    s_nop 0
    v_and_b32_dpp v96, v124, v10 row_newbcast:0 row_mask:0xf bank_mask:0xf
    v_and_b32_dpp v97, v124, v11 row_newbcast:0 row_mask:0xf bank_mask:0xf
    v_and_b32_dpp v98, v124, v12 row_newbcast:0 row_mask:0xf bank_mask:0xf
    v_and_b32_dpp v99, v124, v13 row_newbcast:0 row_mask:0xf bank_mask:0xf
    v_and_b32_dpp v100, v124, v10 row_newbcast:4 row_mask:0xf bank_mask:0xf
    v_and_b32_dpp v101, v124, v11 row_newbcast:4 row_mask:0xf bank_mask:0xf
    v_and_b32_dpp v102, v124, v12 row_newbcast:4 row_mask:0xf bank_mask:0xf
    v_and_b32_dpp v103, v124, v13 row_newbcast:4 row_mask:0xf bank_mask:0xf
    v_and_b32_dpp v104, v124, v10 row_newbcast:8 row_mask:0xf bank_mask:0xf
    v_and_b32_dpp v105, v124, v11 row_newbcast:8 row_mask:0xf bank_mask:0xf
    v_and_b32_dpp v106, v124, v12 row_newbcast:8 row_mask:0xf bank_mask:0xf
    v_and_b32_dpp v107, v124, v13 row_newbcast:8 row_mask:0xf bank_mask:0xf
    v_and_b32_dpp v108, v124, v10 row_newbcast:12 row_mask:0xf bank_mask:0xf
    v_and_b32_dpp v109, v124, v11 row_newbcast:12 row_mask:0xf bank_mask:0xf
    v_and_b32_dpp v110, v124, v12 row_newbcast:12 row_mask:0xf bank_mask:0xf
    v_and_b32_dpp v111, v124, v13 row_newbcast:12 row_mask:0xf bank_mask:0xf
    s_waitcnt vmcnt(8)
    s_lshl_b32 s39, s34, 13
    s_add_u32 s39, s39, 102400
    s_mov_b32 m0, s39
    s_add_u32 s44, s44, 16384
    buffer_load_dwordx4 v20, s[40:43], s44 offen offset:0 nt lds
    v_mfma_f32_16x16x32_bf16 v[116:119], v[176:179], v[96:99], v[116:119]
    v_add_f32_dpp v121, v121, v121 row_ror:8 row_mask:0xf bank_mask:0xf
    s_nop 1
    v_add_f32_dpp v121, v121, v121 row_ror:4 row_mask:0xf bank_mask:0xf
    v_mov_b32 v125, v121
    s_nop 1
    v_permlane16_swap_b32 v121, v125
    v_add_f32 v121, v121, v125
    v_mov_b32 v125, v121
    s_nop 1
    v_permlane32_swap_b32 v121, v125
    v_add_f32 v121, v121, v125
    v_and_b32 v125, s82, v120
    v_sub_f32 v125, v120, v125
    s_mov_b32 vcc_lo, 0xff00ff00
    s_mov_b32 vcc_hi, 0xff00ff00
    s_waitcnt vmcnt(8)
    buffer_load_dwordx4 v21, s[40:43], s44 offen offset:1024 nt lds
    v_mfma_f32_16x16x32_bf16 v[116:119], v[180:183], v[100:103], v[116:119]
    s_waitcnt vmcnt(8)
    buffer_load_dwordx4 v22, s[40:43], s44 offen offset:2048 nt lds
    v_mfma_f32_16x16x32_bf16 v[116:119], v[184:187], v[104:107], v[116:119]
    s_waitcnt vmcnt(8)
    buffer_load_dwordx4 v23, s[40:43], s44 offen offset:3072 nt lds
    v_mfma_f32_16x16x32_bf16 v[116:119], v[188:191], v[108:111], v[116:119]
    s_branch L_bdone
L_last0:
    buffer_load_dwordx4 v[224:227], v34, s[48:51], s46 offen sc1
    s_lshl_b32 s39, s34, 13
    s_add_u32 s39, s39, 98304
    s_mov_b32 m0, s39
    s_nop 0
    buffer_load_dwordx4 v20, s[40:43], s44 offen offset:0 nt lds
    v_mfma_f32_16x16x32_bf16 v[112:115], v[128:131], v[80:83], 0
    s_waitcnt vmcnt(8)
    buffer_load_dwordx4 v21, s[40:43], s44 offen offset:1024 nt lds
    v_mfma_f32_16x16x32_bf16 v[112:115], v[132:135], v[84:87], v[112:115]
    s_waitcnt vmcnt(8)
    buffer_load_dwordx4 v22, s[40:43], s44 offen offset:2048 nt lds
    v_mfma_f32_16x16x32_bf16 v[112:115], v[136:139], v[88:91], v[112:115]
    s_waitcnt vmcnt(8)
    buffer_load_dwordx4 v23, s[40:43], s44 offen offset:3072 nt lds
    v_mfma_f32_16x16x32_bf16 v[112:115], v[140:143], v[92:95], v[112:115]
    s_nop 7
    v_mov_b32_dpp v122, v112 quad_perm:[0,0,0,0] row_mask:0xf bank_mask:0xf
    v_mov_b32_dpp v124, v114 quad_perm:[2,2,2,2] row_mask:0xf bank_mask:0xf
    s_nop 0
    v_add_f32_dpp v122, v113, v122 quad_perm:[1,1,1,1] row_mask:0xf bank_mask:0xf
    v_add_f32_dpp v124, v115, v124 quad_perm:[3,3,3,3] row_mask:0xf bank_mask:0xf
    v_add_f32 v122, v122, v124
    v_fma_f32 v123, v122, s83, -v120
    v_cmp_lt_f32 vcc, 0, v123
    s_cbranch_vccz L_nomax_11
    v_mul_f32 v122, s83, v122
    s_nop 1
    v_max_f32_dpp v124, v122, v122 row_ror:4 row_mask:0xf bank_mask:0xf
    s_nop 1
    v_max_f32_dpp v124, v124, v124 row_ror:8 row_mask:0xf bank_mask:0xf
    v_mov_b32 v125, v124
    s_nop 1
    v_permlane16_swap_b32 v124, v125
    v_max_f32 v124, v124, v125
    v_mov_b32 v125, v124
    s_nop 1
    v_permlane32_swap_b32 v124, v125
    v_max_f32 v124, v124, v125
    v_max_f32 v124, v124, v120
    v_sub_f32 v125, v120, v124
    v_exp_f32 v125, v125
    v_mov_b32 v120, v124
    v_sub_f32 v123, v122, v124
    v_mul_f32 v121, v121, v125
    v_mul_f32 v116, v116, v125
    v_mul_f32 v117, v117, v125
    v_mul_f32 v118, v118, v125
    v_mul_f32 v119, v119, v125
L_nomax_11:
    v_exp_f32 v123, v123
    s_nop 0
    v_cvt_pk_bf16_f32 v124, v123, v123
    v_add_f32 v121, v121, v123
    s_nop 0
    v_and_b32_dpp v96, v124, v10 row_newbcast:0 row_mask:0xf bank_mask:0xf
    v_and_b32_dpp v97, v124, v11 row_newbcast:0 row_mask:0xf bank_mask:0xf
    v_and_b32_dpp v98, v124, v12 row_newbcast:0 row_mask:0xf bank_mask:0xf
    v_and_b32_dpp v99, v124, v13 row_newbcast:0 row_mask:0xf bank_mask:0xf
    v_and_b32_dpp v100, v124, v10 row_newbcast:4 row_mask:0xf bank_mask:0xf
    v_and_b32_dpp v101, v124, v11 row_newbcast:4 row_mask:0xf bank_mask:0xf
    v_and_b32_dpp v102, v124, v12 row_newbcast:4 row_mask:0xf bank_mask:0xf
    v_and_b32_dpp v103, v124, v13 row_newbcast:4 row_mask:0xf bank_mask:0xf
    v_and_b32_dpp v104, v124, v10 row_newbcast:8 row_mask:0xf bank_mask:0xf
    v_and_b32_dpp v105, v124, v11 row_newbcast:8 row_mask:0xf bank_mask:0xf
    v_and_b32_dpp v106, v124, v12 row_newbcast:8 row_mask:0xf bank_mask:0xf
    v_and_b32_dpp v107, v124, v13 row_newbcast:8 row_mask:0xf bank_mask:0xf
    v_and_b32_dpp v108, v124, v10 row_newbcast:12 row_mask:0xf bank_mask:0xf
    v_and_b32_dpp v109, v124, v11 row_newbcast:12 row_mask:0xf bank_mask:0xf
    v_and_b32_dpp v110, v124, v12 row_newbcast:12 row_mask:0xf bank_mask:0xf
    v_and_b32_dpp v111, v124, v13 row_newbcast:12 row_mask:0xf bank_mask:0xf
    s_waitcnt vmcnt(8)
    s_lshl_b32 s39, s34, 13
    s_add_u32 s39, s39, 102400
    s_mov_b32 m0, s39
    s_add_u32 s44, s44, 16384
    buffer_load_dwordx4 v20, s[40:43], s44 offen offset:0 nt lds
    v_mfma_f32_16x16x32_bf16 v[116:119], v[144:147], v[96:99], v[116:119]
    v_add_f32_dpp v121, v121, v121 row_ror:8 row_mask:0xf bank_mask:0xf
    s_nop 1
    v_add_f32_dpp v121, v121, v121 row_ror:4 row_mask:0xf bank_mask:0xf
    v_mov_b32 v125, v121
    s_nop 1
    v_permlane16_swap_b32 v121, v125
    v_add_f32 v121, v121, v125
    v_mov_b32 v125, v121
    s_nop 1
    v_permlane32_swap_b32 v121, v125
    v_add_f32 v121, v121, v125
    v_and_b32 v125, s82, v120
    v_sub_f32 v125, v120, v125
    s_mov_b32 vcc_lo, 0xff00ff00
    s_mov_b32 vcc_hi, 0xff00ff00
    s_waitcnt vmcnt(8)
    buffer_load_dwordx4 v21, s[40:43], s44 offen offset:1024 nt lds
    v_mfma_f32_16x16x32_bf16 v[116:119], v[148:151], v[100:103], v[116:119]
    s_waitcnt vmcnt(8)
    buffer_load_dwordx4 v22, s[40:43], s44 offen offset:2048 nt lds
    v_mfma_f32_16x16x32_bf16 v[116:119], v[152:155], v[104:107], v[116:119]
    s_waitcnt vmcnt(8)
    buffer_load_dwordx4 v23, s[40:43], s44 offen offset:3072 nt lds
    v_mfma_f32_16x16x32_bf16 v[116:119], v[156:159], v[108:111], v[116:119]
L_bdone:
    s_nop 7
    v_cndmask_b32 v116, v116, v120, vcc
    v_cndmask_b32 v117, v117, v121, vcc
    v_cndmask_b32 v118, v118, v125, vcc
    v_and_or_b32 v119, v119, s82, v8
    v_and_or_b32 v116, v116, s82, v8
    v_and_or_b32 v117, v117, s82, v8
    v_and_or_b32 v118, v118, s82, v8
    s_mov_b32 exec_lo, 0xff01ff
    s_mov_b32 exec_hi, 0xff00ff
    buffer_store_dwordx4 v[116:119], v79, s[48:51], s96 offen sc1
    s_mov_b64 exec, -1
    s_cmp_lt_u32 s33, 3
    s_cbranch_scc1 L_ctx
    s_mov_b32 s93, 0x7f
    s_bitset0_b32 s93, s33
    s_mov_b32 s86, 0
    s_and_b32 s86, s86, s93
    s_cselect_b32 s86, s86, s93
    s_ff1_i32_b32 s4, s86
    s_bitset0_b32 s86, s4
    s_lshl_b32 s36, s4, 10
    s_add_u32 s36, s36, s47
    buffer_load_dwordx4 v[192:195], v79, s[48:51], s36 offen sc1
    s_and_b32 s86, s86, s93
    s_cselect_b32 s86, s86, s93
    s_ff1_i32_b32 s5, s86
    s_bitset0_b32 s86, s5
    s_lshl_b32 s36, s5, 10
    s_add_u32 s36, s36, s47
    buffer_load_dwordx4 v[196:199], v79, s[48:51], s36 offen sc1
    s_and_b32 s86, s86, s93
    s_cselect_b32 s86, s86, s93
    s_ff1_i32_b32 s6, s86
    s_bitset0_b32 s86, s6
    s_lshl_b32 s36, s6, 10
    s_add_u32 s36, s36, s47
    buffer_load_dwordx4 v[200:203], v79, s[48:51], s36 offen sc1
    s_and_b32 s86, s86, s93
    s_cselect_b32 s86, s86, s93
    s_ff1_i32_b32 s7, s86
    s_bitset0_b32 s86, s7
    s_lshl_b32 s36, s7, 10
    s_add_u32 s36, s36, s47
    buffer_load_dwordx4 v[204:207], v79, s[48:51], s36 offen sc1
    v_xor_b32 v104, s35, v116
    v_xor_b32 v105, s35, v117
    v_xor_b32 v106, s35, v118
    v_xor_b32 v107, s35, v119
L_hop1poll:
    s_and_b32 s86, s86, s93
    s_cselect_b32 s86, s86, s93
    s_ff1_i32_b32 s8, s86
    s_bitset0_b32 s86, s8
    s_lshl_b32 s36, s8, 10
    s_add_u32 s36, s36, s47
    buffer_load_dwordx4 v[208:211], v79, s[48:51], s36 offen sc1
    s_waitcnt vmcnt(4)
    v_xor_b32 v192, s35, v192
    v_xor_b32 v193, s35, v193
    v_xor_b32 v194, s35, v194
    v_xor_b32 v195, s35, v195
    v_or_b32 v4, v192, v193
    v_or3_b32 v4, v4, v194, v195
    v_and_b32 v4, 0xff, v4
    v_cmp_ne_u32 vcc, 0, v4
    v_add_f32 v6, v192, v194
    v_max_f32 v5, v120, v6
    s_cbranch_vccnz L_mnext_12
    s_bitcmp1_b32 s93, s4
    s_cbranch_scc0 L_mnext_12
    v_sub_f32 v122, v120, v5
    v_sub_f32 v123, v6, v5
    v_exp_f32 v122, v122
    v_exp_f32 v123, v123
    v_mov_b32 v120, v5
    s_bitset0_b32 s93, s4
    v_mul_f32_dpp v105, v122, v105 row_newbcast:8 row_mask:0xf bank_mask:0xf
    v_mul_f32_dpp v104, v122, v104 row_newbcast:8 row_mask:0xf bank_mask:0xf
    v_mul_f32_dpp v106, v122, v106 row_newbcast:8 row_mask:0xf bank_mask:0xf
    v_mul_f32_dpp v107, v122, v107 row_newbcast:8 row_mask:0xf bank_mask:0xf
    v_fmac_f32_dpp v105, v123, v193 row_newbcast:8 row_mask:0xf bank_mask:0xf
    v_fmac_f32_dpp v104, v123, v192 row_newbcast:8 row_mask:0xf bank_mask:0xf
    v_fmac_f32_dpp v106, v123, v194 row_newbcast:8 row_mask:0xf bank_mask:0xf
    v_fmac_f32_dpp v107, v123, v195 row_newbcast:8 row_mask:0xf bank_mask:0xf
    s_cmp_eq_u32 s93, 0
    s_cbranch_scc1 L_hop1ok
L_mnext_12:
    s_and_b32 s86, s86, s93
    s_cselect_b32 s86, s86, s93
    s_ff1_i32_b32 s4, s86
    s_bitset0_b32 s86, s4
    s_lshl_b32 s36, s4, 10
    s_add_u32 s36, s36, s47
    buffer_load_dwordx4 v[192:195], v79, s[48:51], s36 offen sc1
    s_waitcnt vmcnt(4)
    v_xor_b32 v196, s35, v196
    v_xor_b32 v197, s35, v197
    v_xor_b32 v198, s35, v198
    v_xor_b32 v199, s35, v199
    v_or_b32 v4, v196, v197
    v_or3_b32 v4, v4, v198, v199
    v_and_b32 v4, 0xff, v4
    v_cmp_ne_u32 vcc, 0, v4
    v_add_f32 v6, v196, v198
    v_max_f32 v5, v120, v6
    s_cbranch_vccnz L_mnext_13
    s_bitcmp1_b32 s93, s5
    s_cbranch_scc0 L_mnext_13
    v_sub_f32 v122, v120, v5
    v_sub_f32 v123, v6, v5
    v_exp_f32 v122, v122
    v_exp_f32 v123, v123
    v_mov_b32 v120, v5
    s_bitset0_b32 s93, s5
    v_mul_f32_dpp v105, v122, v105 row_newbcast:8 row_mask:0xf bank_mask:0xf
    v_mul_f32_dpp v104, v122, v104 row_newbcast:8 row_mask:0xf bank_mask:0xf
    v_mul_f32_dpp v106, v122, v106 row_newbcast:8 row_mask:0xf bank_mask:0xf
    v_mul_f32_dpp v107, v122, v107 row_newbcast:8 row_mask:0xf bank_mask:0xf
    v_fmac_f32_dpp v105, v123, v197 row_newbcast:8 row_mask:0xf bank_mask:0xf
    v_fmac_f32_dpp v104, v123, v196 row_newbcast:8 row_mask:0xf bank_mask:0xf
    v_fmac_f32_dpp v106, v123, v198 row_newbcast:8 row_mask:0xf bank_mask:0xf
    v_fmac_f32_dpp v107, v123, v199 row_newbcast:8 row_mask:0xf bank_mask:0xf
    s_cmp_eq_u32 s93, 0
    s_cbranch_scc1 L_hop1ok
L_mnext_13:
    s_and_b32 s86, s86, s93
    s_cselect_b32 s86, s86, s93
    s_ff1_i32_b32 s5, s86
    s_bitset0_b32 s86, s5
    s_lshl_b32 s36, s5, 10
    s_add_u32 s36, s36, s47
    buffer_load_dwordx4 v[196:199], v79, s[48:51], s36 offen sc1
    s_waitcnt vmcnt(4)
    v_xor_b32 v200, s35, v200
    v_xor_b32 v201, s35, v201
    v_xor_b32 v202, s35, v202
    v_xor_b32 v203, s35, v203
    v_or_b32 v4, v200, v201
    v_or3_b32 v4, v4, v202, v203
    v_and_b32 v4, 0xff, v4
    v_cmp_ne_u32 vcc, 0, v4
    v_add_f32 v6, v200, v202
    v_max_f32 v5, v120, v6
    s_cbranch_vccnz L_mnext_14
    s_bitcmp1_b32 s93, s6
    s_cbranch_scc0 L_mnext_14
    v_sub_f32 v122, v120, v5
    v_sub_f32 v123, v6, v5
    v_exp_f32 v122, v122
    v_exp_f32 v123, v123
    v_mov_b32 v120, v5
    s_bitset0_b32 s93, s6
    v_mul_f32_dpp v105, v122, v105 row_newbcast:8 row_mask:0xf bank_mask:0xf
    v_mul_f32_dpp v104, v122, v104 row_newbcast:8 row_mask:0xf bank_mask:0xf
    v_mul_f32_dpp v106, v122, v106 row_newbcast:8 row_mask:0xf bank_mask:0xf
    v_mul_f32_dpp v107, v122, v107 row_newbcast:8 row_mask:0xf bank_mask:0xf
    v_fmac_f32_dpp v105, v123, v201 row_newbcast:8 row_mask:0xf bank_mask:0xf
    v_fmac_f32_dpp v104, v123, v200 row_newbcast:8 row_mask:0xf bank_mask:0xf
    v_fmac_f32_dpp v106, v123, v202 row_newbcast:8 row_mask:0xf bank_mask:0xf
    v_fmac_f32_dpp v107, v123, v203 row_newbcast:8 row_mask:0xf bank_mask:0xf
    s_cmp_eq_u32 s93, 0
    s_cbranch_scc1 L_hop1ok
L_mnext_14:
    s_and_b32 s86, s86, s93
    s_cselect_b32 s86, s86, s93
    s_ff1_i32_b32 s6, s86
    s_bitset0_b32 s86, s6
    s_lshl_b32 s36, s6, 10
    s_add_u32 s36, s36, s47
    buffer_load_dwordx4 v[200:203], v79, s[48:51], s36 offen sc1
    s_waitcnt vmcnt(4)
    v_xor_b32 v204, s35, v204
    v_xor_b32 v205, s35, v205
    v_xor_b32 v206, s35, v206
    v_xor_b32 v207, s35, v207
    v_or_b32 v4, v204, v205
    v_or3_b32 v4, v4, v206, v207
    v_and_b32 v4, 0xff, v4
    v_cmp_ne_u32 vcc, 0, v4
    v_add_f32 v6, v204, v206
    v_max_f32 v5, v120, v6
    s_cbranch_vccnz L_mnext_15
    s_bitcmp1_b32 s93, s7
    s_cbranch_scc0 L_mnext_15
    v_sub_f32 v122, v120, v5
    v_sub_f32 v123, v6, v5
    v_exp_f32 v122, v122
    v_exp_f32 v123, v123
    v_mov_b32 v120, v5
    s_bitset0_b32 s93, s7
    v_mul_f32_dpp v105, v122, v105 row_newbcast:8 row_mask:0xf bank_mask:0xf
    v_mul_f32_dpp v104, v122, v104 row_newbcast:8 row_mask:0xf bank_mask:0xf
    v_mul_f32_dpp v106, v122, v106 row_newbcast:8 row_mask:0xf bank_mask:0xf
    v_mul_f32_dpp v107, v122, v107 row_newbcast:8 row_mask:0xf bank_mask:0xf
    v_fmac_f32_dpp v105, v123, v205 row_newbcast:8 row_mask:0xf bank_mask:0xf
    v_fmac_f32_dpp v104, v123, v204 row_newbcast:8 row_mask:0xf bank_mask:0xf
    v_fmac_f32_dpp v106, v123, v206 row_newbcast:8 row_mask:0xf bank_mask:0xf
    v_fmac_f32_dpp v107, v123, v207 row_newbcast:8 row_mask:0xf bank_mask:0xf
    s_cmp_eq_u32 s93, 0
    s_cbranch_scc1 L_hop1ok
L_mnext_15:
    s_and_b32 s86, s86, s93
    s_cselect_b32 s86, s86, s93
    s_ff1_i32_b32 s7, s86
    s_bitset0_b32 s86, s7
    s_lshl_b32 s36, s7, 10
    s_add_u32 s36, s36, s47
    buffer_load_dwordx4 v[204:207], v79, s[48:51], s36 offen sc1
    s_waitcnt vmcnt(4)
    v_xor_b32 v208, s35, v208
    v_xor_b32 v209, s35, v209
    v_xor_b32 v210, s35, v210
    v_xor_b32 v211, s35, v211
    v_or_b32 v4, v208, v209
    v_or3_b32 v4, v4, v210, v211
    v_and_b32 v4, 0xff, v4
    v_cmp_ne_u32 vcc, 0, v4
    v_add_f32 v6, v208, v210
    v_max_f32 v5, v120, v6
    s_cbranch_vccnz L_mnext_16
    s_bitcmp1_b32 s93, s8
    s_cbranch_scc0 L_mnext_16
    v_sub_f32 v122, v120, v5
    v_sub_f32 v123, v6, v5
    v_exp_f32 v122, v122
    v_exp_f32 v123, v123
    v_mov_b32 v120, v5
    s_bitset0_b32 s93, s8
    v_mul_f32_dpp v105, v122, v105 row_newbcast:8 row_mask:0xf bank_mask:0xf
    v_mul_f32_dpp v104, v122, v104 row_newbcast:8 row_mask:0xf bank_mask:0xf
    v_mul_f32_dpp v106, v122, v106 row_newbcast:8 row_mask:0xf bank_mask:0xf
    v_mul_f32_dpp v107, v122, v107 row_newbcast:8 row_mask:0xf bank_mask:0xf
    v_fmac_f32_dpp v105, v123, v209 row_newbcast:8 row_mask:0xf bank_mask:0xf
    v_fmac_f32_dpp v104, v123, v208 row_newbcast:8 row_mask:0xf bank_mask:0xf
    v_fmac_f32_dpp v106, v123, v210 row_newbcast:8 row_mask:0xf bank_mask:0xf
    v_fmac_f32_dpp v107, v123, v211 row_newbcast:8 row_mask:0xf bank_mask:0xf
    s_cmp_eq_u32 s93, 0
    s_cbranch_scc1 L_hop1ok
L_mnext_16:
    s_sub_u32 s84, s84, 1
    s_cmp_lg_u32 s84, 0
    s_cbranch_scc1 L_hop1poll
    s_branch L_end
L_ctx:
    s_waitcnt vmcnt(1)
L_ctxcheck:
    v_xor_b32 v224, s35, v224
    v_xor_b32 v225, s35, v225
    v_xor_b32 v226, s35, v226
    v_xor_b32 v227, s35, v227
    v_or_b32 v4, v224, v225
    v_or3_b32 v4, v4, v226, v227
    v_and_b32 v4, 0xff, v4
    v_cmp_ne_u32 vcc, 0, v4
    s_cbranch_vccz L_ctxok
    buffer_load_dwordx4 v[224:227], v34, s[48:51], s46 offen sc1
    s_waitcnt vmcnt(0)
    s_sub_u32 s84, s84, 1
    s_cmp_lg_u32 s84, 0
    s_cbranch_scc1 L_ctxcheck
    s_branch L_end
L_ctxok:
    v_cvt_pk_bf16_f32 v224, v224, v225
    v_cvt_pk_bf16_f32 v225, v226, v227
    ds_write_b64 v35, v[224:225]
    s_branch L_final
L_hop1ok:
    v_rcp_f32 v122, v105
    s_nop 1
    v_mul_f32_dpp v104, v122, v104 row_newbcast:8 row_mask:0xf bank_mask:0xf
    v_mul_f32_dpp v105, v122, v105 row_newbcast:8 row_mask:0xf bank_mask:0xf
    v_mul_f32_dpp v106, v122, v106 row_newbcast:8 row_mask:0xf bank_mask:0xf
    v_mul_f32_dpp v107, v122, v107 row_newbcast:8 row_mask:0xf bank_mask:0xf
    v_cvt_pk_bf16_f32 v104, v104, v105
    v_cvt_pk_bf16_f32 v106, v106, v107
    s_mov_b32 exec_lo, 0xff00ff
    s_mov_b32 exec_hi, 0xff00ff
    ds_write_b16 v31, v104
    ds_write_b16_d16_hi v31, v104 offset:16
    ds_write_b16 v31, v106 offset:32
    ds_write_b16_d16_hi v31, v106 offset:48
    s_mov_b64 exec, -1
L_final:
    s_waitcnt lgkmcnt(0)
    s_barrier
    ds_read_b64_tr_b16 v[128:129], v24 offset:0
    ds_read_b64_tr_b16 v[130:131], v25 offset:1024
    ds_read_b128 v[160:163], v28 offset:0
    ds_read_b64_tr_b16 v[132:133], v24 offset:8192
    ds_read_b64_tr_b16 v[134:135], v25 offset:9216
    ds_read_b128 v[164:167], v28 offset:64
    ds_read_b64_tr_b16 v[136:137], v24 offset:16384
    ds_read_b64_tr_b16 v[138:139], v25 offset:17408
    ds_read_b128 v[168:171], v28 offset:128
    ds_read_b64_tr_b16 v[140:141], v24 offset:24576
    ds_read_b64_tr_b16 v[142:143], v25 offset:25600
    ds_read_b128 v[172:175], v28 offset:192
    ds_read_b64_tr_b16 v[144:145], v26 offset:0
    ds_read_b64_tr_b16 v[146:147], v27 offset:1024
    ds_read_b128 v[176:179], v29 offset:0
    s_waitcnt lgkmcnt(12)
    v_mfma_f32_16x16x32_bf16 v[112:115], v[128:131], v[160:163], 0
    ds_read_b64_tr_b16 v[148:149], v26 offset:8192
    ds_read_b64_tr_b16 v[150:151], v27 offset:9216
    ds_read_b128 v[180:183], v29 offset:64
    s_waitcnt lgkmcnt(12)
    v_mfma_f32_16x16x32_bf16 v[112:115], v[132:135], v[164:167], v[112:115]
    ds_read_b64_tr_b16 v[152:153], v26 offset:16384
    ds_read_b64_tr_b16 v[154:155], v27 offset:17408
    ds_read_b128 v[184:187], v29 offset:128
    s_waitcnt lgkmcnt(12)
    v_mfma_f32_16x16x32_bf16 v[112:115], v[136:139], v[168:171], v[112:115]
    ds_read_b64_tr_b16 v[156:157], v26 offset:24576
    ds_read_b64_tr_b16 v[158:159], v27 offset:25600
    ds_read_b128 v[188:191], v29 offset:192
    s_waitcnt lgkmcnt(12)
    v_mfma_f32_16x16x32_bf16 v[112:115], v[140:143], v[172:175], v[112:115]
    s_waitcnt lgkmcnt(9)
    v_mfma_f32_16x16x32_bf16 v[112:115], v[144:147], v[176:179], v[112:115]
    s_waitcnt lgkmcnt(6)
    v_mfma_f32_16x16x32_bf16 v[112:115], v[148:151], v[180:183], v[112:115]
    s_waitcnt lgkmcnt(3)
    v_mfma_f32_16x16x32_bf16 v[112:115], v[152:155], v[184:187], v[112:115]
    s_waitcnt lgkmcnt(0)
    v_mfma_f32_16x16x32_bf16 v[112:115], v[156:159], v[188:191], v[112:115]
    s_cmp_eq_u32 s33, 0
    s_cselect_b32 s36, 0, 262144
    s_cselect_b32 s39, 0, 1024
    s_add_u32 s36, s36, 524288
    s_add_u32 s37, s36, 4096
    s_mov_b32 exec_lo, 0xff00ff
    s_mov_b32 exec_hi, 0xff00ff
    s_nop 0
    v_and_or_b32 v112, v112, s82, v8
    v_and_or_b32 v113, v113, s82, v8
    v_and_or_b32 v114, v114, s82, v8
    v_and_or_b32 v115, v115, s82, v8
    buffer_store_dwordx4 v[112:115], v30, s[48:51], s45 offen sc1
    s_mov_b64 exec, -1
    s_sub_u32 s38, s33, 1
    s_cmp_lt_u32 s38, 6
    s_cbranch_scc1 L_done
L_hop2:
    buffer_load_dwordx4 v[224:227], v32, s[48:51], s36 offen sc1
    buffer_load_dwordx4 v[228:231], v32, s[48:51], s37 offen sc1
    s_waitcnt vmcnt(0)
    v_xor_b32 v224, s35, v224
    v_xor_b32 v225, s35, v225
    v_xor_b32 v226, s35, v226
    v_xor_b32 v227, s35, v227
    v_xor_b32 v228, s35, v228
    v_xor_b32 v229, s35, v229
    v_xor_b32 v230, s35, v230
    v_xor_b32 v231, s35, v231
    v_or_b32 v4, v224, v225
    v_or3_b32 v4, v4, v226, v227
    v_or3_b32 v4, v4, v228, v229
    v_or3_b32 v4, v4, v230, v231
    v_and_b32 v4, 0xff, v4
    v_cmp_ne_u32 vcc, 0, v4
    v_add_f32 v232, v224, v228
    v_add_f32 v233, v225, v229
    v_add_f32 v234, v226, v230
    v_add_f32 v235, v227, v231
    s_cbranch_vccz L_hop2ok
    s_sub_u32 s84, s84, 1
    s_cmp_lg_u32 s84, 0
    s_cbranch_scc1 L_hop2
    s_branch L_end
L_hop2ok:
    v_permlane16_swap_b32 v232, v233
    v_permlane16_swap_b32 v234, v235
    v_add_f32 v232, v232, v233
    v_add_f32 v234, v234, v235
    s_nop 1
    v_permlane32_swap_b32 v232, v234
    v_add_f32 v232, v232, v234
    s_nop 1
    v_add_f32_dpp v232, v232, v232 row_ror:8 row_mask:0xf bank_mask:0xf
    s_nop 1
    v_add_f32_dpp v232, v232, v232 row_ror:4 row_mask:0xf bank_mask:0xf
    v_cvt_pk_bf16_f32 v232, v232, v232
    s_mov_b32 exec_lo, 0xf000f
    s_mov_b32 exec_hi, 0xf000f
    buffer_store_short v232, v33, s[72:75], s39 offen
    s_or_b32 s36, s2, s34
    s_cmp_lg_u32 s36, 0
    s_cbranch_scc1 L_done
    v_mov_b32 v4, 0
    s_mov_b64 exec, 1
    buffer_store_dword v8, v4, s[48:51], 0 offen
L_done:
L_end:
    s_endpgm
L_qp:
    v_lshlrev_b32 v4, 18, v2
    v_lshl_add_u32 v14, v3, 4, v4
    v_lshrrev_b32 v5, 3, v3
    v_lshlrev_b32 v5, 10, v5
    v_lshl_add_u32 v15, v2, 6, v5
    s_cmp_eq_u32 s33, 0
    s_cselect_b32 s61, 3, 2
    s_xor_b32 s61, s61, s32
    s_lshl_b32 s86, s34, 8
    s_lshl_b32 s63, s34, 20
    s_lshl_b32 s38, s61, 8
    s_add_u32 s63, s63, s38
    s_mov_b32 s42, 4194304
    s_mov_b32 s43, 0x20000
    s_mov_b32 s46, 4096
    s_mov_b32 s47, 0x20000
    s_cmp_eq_u32 s33, 0
    s_waitcnt lgkmcnt(0)
    s_cselect_b64 s[40:41], s[22:23], s[8:9]
    s_cselect_b64 s[44:45], s[16:17], s[4:5]
    buffer_load_dwordx4 a[128:131], v14, s[40:43], s63 offen nt
    s_add_u32 s63, s63, 8192
    buffer_load_dwordx4 a[132:135], v14, s[40:43], s63 offen nt
    s_add_u32 s63, s63, 8192
    buffer_load_dwordx4 v[20:23], v15, s[44:47], s86 offen offset:0
    buffer_load_dwordx4 v[36:39], v15, s[44:47], s86 offen offset:2048
    buffer_load_dwordx4 a[136:139], v14, s[40:43], s63 offen nt
    s_add_u32 s63, s63, 8192
    buffer_load_dwordx4 a[140:143], v14, s[40:43], s63 offen nt
    s_add_u32 s63, s63, 8192
    buffer_load_dwordx4 a[144:147], v14, s[40:43], s63 offen nt
    s_add_u32 s63, s63, 8192
    buffer_load_dwordx4 a[148:151], v14, s[40:43], s63 offen nt
    s_add_u32 s63, s63, 8192
    buffer_load_dwordx4 a[152:155], v14, s[40:43], s63 offen nt
    s_add_u32 s63, s63, 8192
    buffer_load_dwordx4 a[156:159], v14, s[40:43], s63 offen nt
    s_add_u32 s63, s63, 8192
    s_load_dword s35, s[30:31], 0
    s_mov_b32 s48, s30
    s_and_b32 s49, s31, 0xffff
    s_mov_b32 s50, 8388608
    s_mov_b32 s51, 0x20000
    s_mov_b32 s82, 0xffffff00
    s_mov_b32 s83, 0x3e0293ee
    s_mov_b32 s84, 2097152
    v_and_b32 v4, 1, v1
    v_lshlrev_b32 v4, 4, v4
    v_mov_b32 v5, 0xffff
    v_lshlrev_b32 v4, v4, v5
    v_bfe_u32 v5, v1, 1, 2
    v_cmp_eq_u32 vcc, 0, v5
    s_nop 1
    v_cndmask_b32 v10, 0, v4, vcc
    v_cmp_eq_u32 vcc, 1, v5
    s_nop 1
    v_cndmask_b32 v11, 0, v4, vcc
    v_cmp_eq_u32 vcc, 2, v5
    s_nop 1
    v_cndmask_b32 v12, 0, v4, vcc
    v_cmp_eq_u32 vcc, 3, v5
    s_nop 1
    v_cndmask_b32 v13, 0, v4, vcc
    buffer_load_dwordx4 v[24:27], v15, s[44:47], s86 offen offset:16
    buffer_load_dwordx4 v[40:43], v15, s[44:47], s86 offen offset:2064
    buffer_load_dwordx4 v[28:31], v15, s[44:47], s86 offen offset:32
    buffer_load_dwordx4 v[44:47], v15, s[44:47], s86 offen offset:2080
    buffer_load_dwordx4 v[32:35], v15, s[44:47], s86 offen offset:48
    buffer_load_dwordx4 v[48:51], v15, s[44:47], s86 offen offset:2096
    s_lshl_b32 s38, s61, 10
    s_add_u32 s36, s38, 65536
    s_lshl_b32 s38, s34, 8
    s_add_u32 s36, s38, s36
    v_mov_b32 v19, 0
    s_cmp_eq_u32 s33, 0
    s_cselect_b32 s38, s36, 8388608
    s_mov_b64 exec, 1
    buffer_store_dword v19, v19, s[48:51], s38 offen sc1
    s_mov_b64 exec, -1
    s_mov_b32 s80, 0x01000100
    s_mov_b32 s81, 0x03020302
    s_waitcnt vmcnt(13)
    buffer_load_dwordx4 a[160:163], v14, s[40:43], s63 offen nt
    s_add_u32 s63, s63, 8192
    v_perm_b32 v4, v20, v20, s80
    v_perm_b32 v5, v36, v36, s80
    v_and_b32 v52, v4, v10
    v_and_b32 v53, v4, v11
    v_and_b32 v54, v4, v12
    v_and_b32 v55, v4, v13
    v_and_b32 v56, v5, v10
    v_and_b32 v57, v5, v11
    v_and_b32 v58, v5, v12
    v_and_b32 v59, v5, v13
    v_mfma_f32_16x16x32_bf16 v[60:63], a[128:131], v[52:55], 0
    s_nop 0
    v_mfma_f32_16x16x32_bf16 v[64:67], a[128:131], v[56:59], 0
    buffer_load_dwordx4 a[164:167], v14, s[40:43], s63 offen nt
    s_add_u32 s63, s63, 8192
    v_perm_b32 v4, v20, v20, s81
    v_perm_b32 v5, v36, v36, s81
    v_and_b32 v52, v4, v10
    v_and_b32 v53, v4, v11
    v_and_b32 v54, v4, v12
    v_and_b32 v55, v4, v13
    v_and_b32 v56, v5, v10
    v_and_b32 v57, v5, v11
    v_and_b32 v58, v5, v12
    v_and_b32 v59, v5, v13
    v_mfma_f32_16x16x32_bf16 v[60:63], a[132:135], v[52:55], v[60:63]
    s_nop 0
    v_mfma_f32_16x16x32_bf16 v[64:67], a[132:135], v[56:59], v[64:67]
    s_waitcnt vmcnt(14)
    buffer_load_dwordx4 a[168:171], v14, s[40:43], s63 offen nt
    s_add_u32 s63, s63, 8192
    v_perm_b32 v4, v21, v21, s80
    v_perm_b32 v5, v37, v37, s80
    v_and_b32 v52, v4, v10
    v_and_b32 v53, v4, v11
    v_and_b32 v54, v4, v12
    v_and_b32 v55, v4, v13
    v_and_b32 v56, v5, v10
    v_and_b32 v57, v5, v11
    v_and_b32 v58, v5, v12
    v_and_b32 v59, v5, v13
    v_mfma_f32_16x16x32_bf16 v[60:63], a[136:139], v[52:55], v[60:63]
    s_nop 0
    v_mfma_f32_16x16x32_bf16 v[64:67], a[136:139], v[56:59], v[64:67]
    s_waitcnt vmcnt(14)
    buffer_load_dwordx4 a[172:175], v14, s[40:43], s63 offen nt
    s_add_u32 s63, s63, 8192
    v_perm_b32 v4, v21, v21, s81
    v_perm_b32 v5, v37, v37, s81
    v_and_b32 v52, v4, v10
    v_and_b32 v53, v4, v11
    v_and_b32 v54, v4, v12
    v_and_b32 v55, v4, v13
    v_and_b32 v56, v5, v10
    v_and_b32 v57, v5, v11
    v_and_b32 v58, v5, v12
    v_and_b32 v59, v5, v13
    v_mfma_f32_16x16x32_bf16 v[60:63], a[140:143], v[52:55], v[60:63]
    s_nop 0
    v_mfma_f32_16x16x32_bf16 v[64:67], a[140:143], v[56:59], v[64:67]
    s_waitcnt vmcnt(14)
    buffer_load_dwordx4 a[176:179], v14, s[40:43], s63 offen nt
    s_add_u32 s63, s63, 8192
    v_lshrrev_b32 v4, 2, v3
    v_and_b32 v5, 3, v3
    v_lshlrev_b32 v76, 8, v4
    v_lshlrev_b32 v126, 8, v2
    v_lshl_add_u32 v76, v2, 6, v76
    v_lshl_add_u32 v76, v5, 4, v76
    v_lshl_add_u32 v126, v3, 4, v126
    v_xor_b32 v77, 32768, v76
    v_xor_b32 v127, 32768, v126
    s_add_u32 s3, s34, s33
    s_and_b32 s3, s3, 3
    s_lshl_b32 s89, s3, 5
    s_add_u32 s89, s89, s32
    s_lshl_b32 s89, s89, 20
    s_mul_i32 s88, s32, 8
    s_add_u32 s88, s88, s3
    s_lshl_b32 s87, s33, 0
    v_perm_b32 v4, v22, v22, s80
    v_perm_b32 v5, v38, v38, s80
    v_and_b32 v52, v4, v10
    v_and_b32 v53, v4, v11
    v_and_b32 v54, v4, v12
    v_and_b32 v55, v4, v13
    v_and_b32 v56, v5, v10
    v_and_b32 v57, v5, v11
    v_and_b32 v58, v5, v12
    v_and_b32 v59, v5, v13
    v_mfma_f32_16x16x32_bf16 v[60:63], a[144:147], v[52:55], v[60:63]
    s_nop 0
    v_mfma_f32_16x16x32_bf16 v[64:67], a[144:147], v[56:59], v[64:67]
    s_waitcnt vmcnt(14)
    buffer_load_dwordx4 a[180:183], v14, s[40:43], s63 offen nt
    s_add_u32 s63, s63, 8192
    v_perm_b32 v4, v22, v22, s81
    v_perm_b32 v5, v38, v38, s81
    v_and_b32 v52, v4, v10
    v_and_b32 v53, v4, v11
    v_and_b32 v54, v4, v12
    v_and_b32 v55, v4, v13
    v_and_b32 v56, v5, v10
    v_and_b32 v57, v5, v11
    v_and_b32 v58, v5, v12
    v_and_b32 v59, v5, v13
    v_mfma_f32_16x16x32_bf16 v[60:63], a[148:151], v[52:55], v[60:63]
    s_nop 0
    v_mfma_f32_16x16x32_bf16 v[64:67], a[148:151], v[56:59], v[64:67]
    s_waitcnt vmcnt(14)
    buffer_load_dwordx4 a[184:187], v14, s[40:43], s63 offen nt
    s_add_u32 s63, s63, 8192
    v_perm_b32 v4, v23, v23, s80
    v_perm_b32 v5, v39, v39, s80
    v_and_b32 v52, v4, v10
    v_and_b32 v53, v4, v11
    v_and_b32 v54, v4, v12
    v_and_b32 v55, v4, v13
    v_and_b32 v56, v5, v10
    v_and_b32 v57, v5, v11
    v_and_b32 v58, v5, v12
    v_and_b32 v59, v5, v13
    v_mfma_f32_16x16x32_bf16 v[60:63], a[152:155], v[52:55], v[60:63]
    s_nop 0
    v_mfma_f32_16x16x32_bf16 v[64:67], a[152:155], v[56:59], v[64:67]
    s_waitcnt vmcnt(14)
    buffer_load_dwordx4 a[188:191], v14, s[40:43], s63 offen nt
    s_add_u32 s63, s63, 8192
    v_perm_b32 v4, v23, v23, s81
    v_perm_b32 v5, v39, v39, s81
    v_and_b32 v52, v4, v10
    v_and_b32 v53, v4, v11
    v_and_b32 v54, v4, v12
    v_and_b32 v55, v4, v13
    v_and_b32 v56, v5, v10
    v_and_b32 v57, v5, v11
    v_and_b32 v58, v5, v12
    v_and_b32 v59, v5, v13
    v_mfma_f32_16x16x32_bf16 v[60:63], a[156:159], v[52:55], v[60:63]
    s_nop 0
    v_mfma_f32_16x16x32_bf16 v[64:67], a[156:159], v[56:59], v[64:67]
    s_waitcnt vmcnt(13)
    s_waitcnt vmcnt(7)
    buffer_load_dwordx4 a[192:195], v14, s[40:43], s63 offen nt
    s_add_u32 s63, s63, 8192
    s_mov_b32 s52, s18
    s_and_b32 s53, s19, 0xffff
    s_mov_b32 s54, 134217728
    s_mov_b32 s55, 0x20000
    s_mov_b32 s56, s20
    s_and_b32 s57, s21, 0xffff
    s_mov_b32 s58, 134217728
    s_mov_b32 s59, 0x20000
    v_perm_b32 v4, v24, v24, s80
    v_perm_b32 v5, v40, v40, s80
    v_and_b32 v52, v4, v10
    v_and_b32 v53, v4, v11
    v_and_b32 v54, v4, v12
    v_and_b32 v55, v4, v13
    v_and_b32 v56, v5, v10
    v_and_b32 v57, v5, v11
    v_and_b32 v58, v5, v12
    v_and_b32 v59, v5, v13
    v_mfma_f32_16x16x32_bf16 v[60:63], a[160:163], v[52:55], v[60:63]
    s_nop 0
    v_mfma_f32_16x16x32_bf16 v[64:67], a[160:163], v[56:59], v[64:67]
    s_waitcnt vmcnt(7)
    buffer_load_dwordx4 a[196:199], v14, s[40:43], s63 offen nt
    s_add_u32 s63, s63, 8192
    v_perm_b32 v4, v24, v24, s81
    v_perm_b32 v5, v40, v40, s81
    v_and_b32 v52, v4, v10
    v_and_b32 v53, v4, v11
    v_and_b32 v54, v4, v12
    v_and_b32 v55, v4, v13
    v_and_b32 v56, v5, v10
    v_and_b32 v57, v5, v11
    v_and_b32 v58, v5, v12
    v_and_b32 v59, v5, v13
    v_mfma_f32_16x16x32_bf16 v[60:63], a[164:167], v[52:55], v[60:63]
    s_nop 0
    v_mfma_f32_16x16x32_bf16 v[64:67], a[164:167], v[56:59], v[64:67]
    s_waitcnt vmcnt(7)
    buffer_load_dwordx4 a[200:203], v14, s[40:43], s63 offen nt
    s_add_u32 s63, s63, 8192
    v_perm_b32 v4, v25, v25, s80
    v_perm_b32 v5, v41, v41, s80
    v_and_b32 v52, v4, v10
    v_and_b32 v53, v4, v11
    v_and_b32 v54, v4, v12
    v_and_b32 v55, v4, v13
    v_and_b32 v56, v5, v10
    v_and_b32 v57, v5, v11
    v_and_b32 v58, v5, v12
    v_and_b32 v59, v5, v13
    v_mfma_f32_16x16x32_bf16 v[60:63], a[168:171], v[52:55], v[60:63]
    s_nop 0
    v_mfma_f32_16x16x32_bf16 v[64:67], a[168:171], v[56:59], v[64:67]
    s_waitcnt vmcnt(7)
    buffer_load_dwordx4 a[204:207], v14, s[40:43], s63 offen nt
    s_add_u32 s63, s63, 8192
    v_perm_b32 v4, v25, v25, s81
    v_perm_b32 v5, v41, v41, s81
    v_and_b32 v52, v4, v10
    v_and_b32 v53, v4, v11
    v_and_b32 v54, v4, v12
    v_and_b32 v55, v4, v13
    v_and_b32 v56, v5, v10
    v_and_b32 v57, v5, v11
    v_and_b32 v58, v5, v12
    v_and_b32 v59, v5, v13
    v_mfma_f32_16x16x32_bf16 v[60:63], a[172:175], v[52:55], v[60:63]
    s_nop 0
    v_mfma_f32_16x16x32_bf16 v[64:67], a[172:175], v[56:59], v[64:67]
    s_waitcnt vmcnt(7)
    buffer_load_dwordx4 a[208:211], v14, s[40:43], s63 offen nt
    s_add_u32 s63, s63, 8192
    v_mov_b32 v120, 0xff7f0000
    v_mov_b32 v121, 0
    v_mov_b32 v18, 1
    v_mov_b32 v116, 0
    v_mov_b32 v117, 0
    v_mov_b32 v118, 0
    v_mov_b32 v119, 0
    s_lshl_b32 s38, s32, 10
    s_add_u32 s96, s38, 65536
    s_lshl_b32 s38, s3, 8
    s_add_u32 s96, s38, s96
    v_mov_b32 v9, s96
    s_lshl_b32 s38, s32, 15
    s_add_u32 s96, s38, 1048576
    s_lshl_b32 s38, s3, 13
    s_add_u32 s96, s38, s96
    s_lshl_b32 s38, s33, 10
    s_add_u32 s96, s38, s96
    v_and_b32 v5, 3, v3
    v_lshlrev_b32 v78, 7, v2
    v_lshl_add_u32 v78, v5, 5, v78
    s_lshl_b32 s38, s32, 12
    s_add_u32 s91, s38, 262144
    s_lshl_b32 s38, s3, 9
    s_add_u32 s91, s38, s91
    v_lshlrev_b32 v4, 7, v2
    v_lshl_add_u32 v4, v3, 4, v4
    v_mov_b32 v5, 512
    v_cmp_gt_u32 vcc, 8, v3
    s_nop 1
    v_cndmask_b32 v79, v5, v4, vcc
    v_perm_b32 v4, v26, v26, s80
    v_perm_b32 v5, v42, v42, s80
    v_and_b32 v52, v4, v10
    v_and_b32 v53, v4, v11
    v_and_b32 v54, v4, v12
    v_and_b32 v55, v4, v13
    v_and_b32 v56, v5, v10
    v_and_b32 v57, v5, v11
    v_and_b32 v58, v5, v12
    v_and_b32 v59, v5, v13
    v_mfma_f32_16x16x32_bf16 v[60:63], a[176:179], v[52:55], v[60:63]
    s_nop 0
    v_mfma_f32_16x16x32_bf16 v[64:67], a[176:179], v[56:59], v[64:67]
    s_waitcnt vmcnt(7)
    buffer_load_dwordx4 a[212:215], v14, s[40:43], s63 offen nt
    s_add_u32 s63, s63, 8192
    v_perm_b32 v4, v26, v26, s81
    v_perm_b32 v5, v42, v42, s81
    v_and_b32 v52, v4, v10
    v_and_b32 v53, v4, v11
    v_and_b32 v54, v4, v12
    v_and_b32 v55, v4, v13
    v_and_b32 v56, v5, v10
    v_and_b32 v57, v5, v11
    v_and_b32 v58, v5, v12
    v_and_b32 v59, v5, v13
    v_mfma_f32_16x16x32_bf16 v[60:63], a[180:183], v[52:55], v[60:63]
    s_nop 0
    v_mfma_f32_16x16x32_bf16 v[64:67], a[180:183], v[56:59], v[64:67]
    s_waitcnt vmcnt(7)
    buffer_load_dwordx4 a[216:219], v14, s[40:43], s63 offen nt
    s_add_u32 s63, s63, 8192
    v_perm_b32 v4, v27, v27, s80
    v_perm_b32 v5, v43, v43, s80
    v_and_b32 v52, v4, v10
    v_and_b32 v53, v4, v11
    v_and_b32 v54, v4, v12
    v_and_b32 v55, v4, v13
    v_and_b32 v56, v5, v10
    v_and_b32 v57, v5, v11
    v_and_b32 v58, v5, v12
    v_and_b32 v59, v5, v13
    v_mfma_f32_16x16x32_bf16 v[60:63], a[184:187], v[52:55], v[60:63]
    s_nop 0
    v_mfma_f32_16x16x32_bf16 v[64:67], a[184:187], v[56:59], v[64:67]
    s_waitcnt vmcnt(7)
    buffer_load_dwordx4 a[220:223], v14, s[40:43], s63 offen nt
    s_add_u32 s63, s63, 8192
    v_perm_b32 v4, v27, v27, s81
    v_perm_b32 v5, v43, v43, s81
    v_and_b32 v52, v4, v10
    v_and_b32 v53, v4, v11
    v_and_b32 v54, v4, v12
    v_and_b32 v55, v4, v13
    v_and_b32 v56, v5, v10
    v_and_b32 v57, v5, v11
    v_and_b32 v58, v5, v12
    v_and_b32 v59, v5, v13
    v_mfma_f32_16x16x32_bf16 v[60:63], a[188:191], v[52:55], v[60:63]
    s_nop 0
    v_mfma_f32_16x16x32_bf16 v[64:67], a[188:191], v[56:59], v[64:67]
    s_waitcnt vmcnt(7)
    buffer_load_dwordx4 a[224:227], v14, s[40:43], s63 offen nt
    s_add_u32 s63, s63, 8192
    v_perm_b32 v4, v28, v28, s80
    v_perm_b32 v5, v44, v44, s80
    v_and_b32 v52, v4, v10
    v_and_b32 v53, v4, v11
    v_and_b32 v54, v4, v12
    v_and_b32 v55, v4, v13
    v_and_b32 v56, v5, v10
    v_and_b32 v57, v5, v11
    v_and_b32 v58, v5, v12
    v_and_b32 v59, v5, v13
    v_mfma_f32_16x16x32_bf16 v[60:63], a[192:195], v[52:55], v[60:63]
    s_nop 0
    v_mfma_f32_16x16x32_bf16 v[64:67], a[192:195], v[56:59], v[64:67]
    s_waitcnt vmcnt(7)
    buffer_load_dwordx4 a[228:231], v14, s[40:43], s63 offen nt
    s_add_u32 s63, s63, 8192
    v_perm_b32 v4, v28, v28, s81
    v_perm_b32 v5, v44, v44, s81
    v_and_b32 v52, v4, v10
    v_and_b32 v53, v4, v11
    v_and_b32 v54, v4, v12
    v_and_b32 v55, v4, v13
    v_and_b32 v56, v5, v10
    v_and_b32 v57, v5, v11
    v_and_b32 v58, v5, v12
    v_and_b32 v59, v5, v13
    v_mfma_f32_16x16x32_bf16 v[60:63], a[196:199], v[52:55], v[60:63]
    s_nop 0
    v_mfma_f32_16x16x32_bf16 v[64:67], a[196:199], v[56:59], v[64:67]
    s_waitcnt vmcnt(7)
    buffer_load_dwordx4 a[232:235], v14, s[40:43], s63 offen nt
    s_add_u32 s63, s63, 8192
    v_perm_b32 v4, v29, v29, s80
    v_perm_b32 v5, v45, v45, s80
    v_and_b32 v52, v4, v10
    v_and_b32 v53, v4, v11
    v_and_b32 v54, v4, v12
    v_and_b32 v55, v4, v13
    v_and_b32 v56, v5, v10
    v_and_b32 v57, v5, v11
    v_and_b32 v58, v5, v12
    v_and_b32 v59, v5, v13
    v_mfma_f32_16x16x32_bf16 v[60:63], a[200:203], v[52:55], v[60:63]
    s_nop 0
    v_mfma_f32_16x16x32_bf16 v[64:67], a[200:203], v[56:59], v[64:67]
    s_waitcnt vmcnt(7)
    buffer_load_dwordx4 a[236:239], v14, s[40:43], s63 offen nt
    s_add_u32 s63, s63, 8192
    v_perm_b32 v4, v29, v29, s81
    v_perm_b32 v5, v45, v45, s81
    v_and_b32 v52, v4, v10
    v_and_b32 v53, v4, v11
    v_and_b32 v54, v4, v12
    v_and_b32 v55, v4, v13
    v_and_b32 v56, v5, v10
    v_and_b32 v57, v5, v11
    v_and_b32 v58, v5, v12
    v_and_b32 v59, v5, v13
    v_mfma_f32_16x16x32_bf16 v[60:63], a[204:207], v[52:55], v[60:63]
    s_nop 0
    v_mfma_f32_16x16x32_bf16 v[64:67], a[204:207], v[56:59], v[64:67]
    s_waitcnt vmcnt(7)
    buffer_load_dwordx4 a[240:243], v14, s[40:43], s63 offen nt
    s_add_u32 s63, s63, 8192
    v_perm_b32 v4, v30, v30, s80
    v_perm_b32 v5, v46, v46, s80
    v_and_b32 v52, v4, v10
    v_and_b32 v53, v4, v11
    v_and_b32 v54, v4, v12
    v_and_b32 v55, v4, v13
    v_and_b32 v56, v5, v10
    v_and_b32 v57, v5, v11
    v_and_b32 v58, v5, v12
    v_and_b32 v59, v5, v13
    v_mfma_f32_16x16x32_bf16 v[60:63], a[208:211], v[52:55], v[60:63]
    s_nop 0
    v_mfma_f32_16x16x32_bf16 v[64:67], a[208:211], v[56:59], v[64:67]
    s_waitcnt vmcnt(7)
    buffer_load_dwordx4 a[244:247], v14, s[40:43], s63 offen nt
    s_add_u32 s63, s63, 8192
    v_perm_b32 v4, v30, v30, s81
    v_perm_b32 v5, v46, v46, s81
    v_and_b32 v52, v4, v10
    v_and_b32 v53, v4, v11
    v_and_b32 v54, v4, v12
    v_and_b32 v55, v4, v13
    v_and_b32 v56, v5, v10
    v_and_b32 v57, v5, v11
    v_and_b32 v58, v5, v12
    v_and_b32 v59, v5, v13
    v_mfma_f32_16x16x32_bf16 v[60:63], a[212:215], v[52:55], v[60:63]
    s_nop 0
    v_mfma_f32_16x16x32_bf16 v[64:67], a[212:215], v[56:59], v[64:67]
    s_waitcnt vmcnt(7)
    buffer_load_dwordx4 a[248:251], v14, s[40:43], s63 offen nt
    s_add_u32 s63, s63, 8192
    v_perm_b32 v4, v31, v31, s80
    v_perm_b32 v5, v47, v47, s80
    v_and_b32 v52, v4, v10
    v_and_b32 v53, v4, v11
    v_and_b32 v54, v4, v12
    v_and_b32 v55, v4, v13
    v_and_b32 v56, v5, v10
    v_and_b32 v57, v5, v11
    v_and_b32 v58, v5, v12
    v_and_b32 v59, v5, v13
    v_mfma_f32_16x16x32_bf16 v[60:63], a[216:219], v[52:55], v[60:63]
    s_nop 0
    v_mfma_f32_16x16x32_bf16 v[64:67], a[216:219], v[56:59], v[64:67]
    s_waitcnt vmcnt(7)
    buffer_load_dwordx4 a[252:255], v14, s[40:43], s63 offen nt
    s_add_u32 s63, s63, 8192
    v_perm_b32 v4, v31, v31, s81
    v_perm_b32 v5, v47, v47, s81
    v_and_b32 v52, v4, v10
    v_and_b32 v53, v4, v11
    v_and_b32 v54, v4, v12
    v_and_b32 v55, v4, v13
    v_and_b32 v56, v5, v10
    v_and_b32 v57, v5, v11
    v_and_b32 v58, v5, v12
    v_and_b32 v59, v5, v13
    v_mfma_f32_16x16x32_bf16 v[60:63], a[220:223], v[52:55], v[60:63]
    s_nop 0
    v_mfma_f32_16x16x32_bf16 v[64:67], a[220:223], v[56:59], v[64:67]
    s_waitcnt vmcnt(7)
    v_perm_b32 v4, v32, v32, s80
    v_perm_b32 v5, v48, v48, s80
    v_and_b32 v52, v4, v10
    v_and_b32 v53, v4, v11
    v_and_b32 v54, v4, v12
    v_and_b32 v55, v4, v13
    v_and_b32 v56, v5, v10
    v_and_b32 v57, v5, v11
    v_and_b32 v58, v5, v12
    v_and_b32 v59, v5, v13
    v_mfma_f32_16x16x32_bf16 v[60:63], a[224:227], v[52:55], v[60:63]
    s_nop 0
    v_mfma_f32_16x16x32_bf16 v[64:67], a[224:227], v[56:59], v[64:67]
    s_waitcnt vmcnt(6)
    s_add_u32 s39, s87, s88
    s_bfe_u32 s37, s39, 0x30000
    s_lshl_b32 s37, s37, 12
    s_add_u32 s85, s37, s89
    s_bfe_u32 s37, s39, 0x10003
    s_lshl_b32 s37, s37, 11
    s_add_u32 s85, s37, s85
    s_bfe_u32 s37, s39, 0x40004
    s_lshl_b32 s37, s37, 16
    s_add_u32 s85, s37, s85
    buffer_load_dwordx4 v[128:131], v76, s[52:55], s85 offen offset:0 nt
    v_perm_b32 v4, v32, v32, s81
    v_perm_b32 v5, v48, v48, s81
    v_and_b32 v52, v4, v10
    v_and_b32 v53, v4, v11
    v_and_b32 v54, v4, v12
    v_and_b32 v55, v4, v13
    v_and_b32 v56, v5, v10
    v_and_b32 v57, v5, v11
    v_and_b32 v58, v5, v12
    v_and_b32 v59, v5, v13
    v_mfma_f32_16x16x32_bf16 v[60:63], a[228:231], v[52:55], v[60:63]
    s_nop 0
    v_mfma_f32_16x16x32_bf16 v[64:67], a[228:231], v[56:59], v[64:67]
    s_waitcnt vmcnt(6)
    buffer_load_dwordx4 v[132:135], v77, s[52:55], s85 offen offset:0 nt
    v_perm_b32 v4, v33, v33, s80
    v_perm_b32 v5, v49, v49, s80
    v_and_b32 v52, v4, v10
    v_and_b32 v53, v4, v11
    v_and_b32 v54, v4, v12
    v_and_b32 v55, v4, v13
    v_and_b32 v56, v5, v10
    v_and_b32 v57, v5, v11
    v_and_b32 v58, v5, v12
    v_and_b32 v59, v5, v13
    v_mfma_f32_16x16x32_bf16 v[60:63], a[232:235], v[52:55], v[60:63]
    s_nop 0
    v_mfma_f32_16x16x32_bf16 v[64:67], a[232:235], v[56:59], v[64:67]
    s_waitcnt vmcnt(6)
    buffer_load_dwordx4 v[136:139], v76, s[52:55], s85 offen offset:1024 nt
    v_perm_b32 v4, v33, v33, s81
    v_perm_b32 v5, v49, v49, s81
    v_and_b32 v52, v4, v10
    v_and_b32 v53, v4, v11
    v_and_b32 v54, v4, v12
    v_and_b32 v55, v4, v13
    v_and_b32 v56, v5, v10
    v_and_b32 v57, v5, v11
    v_and_b32 v58, v5, v12
    v_and_b32 v59, v5, v13
    v_mfma_f32_16x16x32_bf16 v[60:63], a[236:239], v[52:55], v[60:63]
    s_nop 0
    v_mfma_f32_16x16x32_bf16 v[64:67], a[236:239], v[56:59], v[64:67]
    s_waitcnt vmcnt(6)
    buffer_load_dwordx4 v[140:143], v77, s[52:55], s85 offen offset:1024 nt
    s_add_u32 s87, s87, 7
    s_add_u32 s39, s87, s88
    s_bfe_u32 s37, s39, 0x30000
    s_lshl_b32 s37, s37, 12
    s_add_u32 s85, s37, s89
    s_bfe_u32 s37, s39, 0x10003
    s_lshl_b32 s37, s37, 11
    s_add_u32 s85, s37, s85
    s_bfe_u32 s37, s39, 0x40004
    s_lshl_b32 s37, s37, 16
    s_add_u32 s85, s37, s85
    v_perm_b32 v4, v34, v34, s80
    v_perm_b32 v5, v50, v50, s80
    v_and_b32 v52, v4, v10
    v_and_b32 v53, v4, v11
    v_and_b32 v54, v4, v12
    v_and_b32 v55, v4, v13
    v_and_b32 v56, v5, v10
    v_and_b32 v57, v5, v11
    v_and_b32 v58, v5, v12
    v_and_b32 v59, v5, v13
    v_mfma_f32_16x16x32_bf16 v[60:63], a[240:243], v[52:55], v[60:63]
    s_nop 0
    v_mfma_f32_16x16x32_bf16 v[64:67], a[240:243], v[56:59], v[64:67]
    s_waitcnt vmcnt(6)
    buffer_load_dwordx4 v[144:147], v76, s[52:55], s85 offen offset:0 nt
    v_perm_b32 v4, v34, v34, s81
    v_perm_b32 v5, v50, v50, s81
    v_and_b32 v52, v4, v10
    v_and_b32 v53, v4, v11
    v_and_b32 v54, v4, v12
    v_and_b32 v55, v4, v13
    v_and_b32 v56, v5, v10
    v_and_b32 v57, v5, v11
    v_and_b32 v58, v5, v12
    v_and_b32 v59, v5, v13
    v_mfma_f32_16x16x32_bf16 v[60:63], a[244:247], v[52:55], v[60:63]
    s_nop 0
    v_mfma_f32_16x16x32_bf16 v[64:67], a[244:247], v[56:59], v[64:67]
    s_waitcnt vmcnt(6)
    buffer_load_dwordx4 v[148:151], v77, s[52:55], s85 offen offset:0 nt
    v_perm_b32 v4, v35, v35, s80
    v_perm_b32 v5, v51, v51, s80
    v_and_b32 v52, v4, v10
    v_and_b32 v53, v4, v11
    v_and_b32 v54, v4, v12
    v_and_b32 v55, v4, v13
    v_and_b32 v56, v5, v10
    v_and_b32 v57, v5, v11
    v_and_b32 v58, v5, v12
    v_and_b32 v59, v5, v13
    v_mfma_f32_16x16x32_bf16 v[60:63], a[248:251], v[52:55], v[60:63]
    s_nop 0
    v_mfma_f32_16x16x32_bf16 v[64:67], a[248:251], v[56:59], v[64:67]
    s_waitcnt vmcnt(6)
    buffer_load_dwordx4 v[152:155], v76, s[52:55], s85 offen offset:1024 nt
    v_perm_b32 v4, v35, v35, s81
    v_perm_b32 v5, v51, v51, s81
    v_and_b32 v52, v4, v10
    v_and_b32 v53, v4, v11
    v_and_b32 v54, v4, v12
    v_and_b32 v55, v4, v13
    v_and_b32 v56, v5, v10
    v_and_b32 v57, v5, v11
    v_and_b32 v58, v5, v12
    v_and_b32 v59, v5, v13
    v_mfma_f32_16x16x32_bf16 v[60:63], a[252:255], v[52:55], v[60:63]
    s_nop 0
    v_mfma_f32_16x16x32_bf16 v[64:67], a[252:255], v[56:59], v[64:67]
    s_lshl_b32 s38, s34, 11
    v_lshrrev_b32 v4, 3, v3
    v_lshlrev_b32 v4, 9, v4
    v_lshl_add_u32 v4, v2, 7, v4
    v_and_b32 v5, 7, v3
    v_lshl_add_u32 v4, v5, 2, v4
    v_add_u32 v4, s38, v4
    ds_write_b32 v4, v60 offset:0
    ds_write_b32 v4, v61 offset:32
    ds_write_b32 v4, v62 offset:64
    ds_write_b32 v4, v63 offset:96
    ds_write_b32 v4, v64 offset:1024
    ds_write_b32 v4, v65 offset:1056
    ds_write_b32 v4, v66 offset:1088
    ds_write_b32 v4, v67 offset:1120
    s_lshl_b32 s38, s34, 9
    v_and_b32 v5, 31, v1
    v_lshl_add_u32 v5, v5, 4, s38
    s_waitcnt lgkmcnt(0)
    s_add_u32 s35, s35, 0x5b
    s_and_b32 s35, s35, 0xff
    v_mov_b32 v8, s35
    s_barrier
    ds_read_b128 v[20:23], v5 offset:0
    ds_read_b128 v[24:27], v5 offset:2048
    ds_read_b128 v[28:31], v5 offset:4096
    ds_read_b128 v[32:35], v5 offset:6144
    s_lshl_b32 s38, s61, 12
    s_add_u32 s36, s38, 262144
    s_lshl_b32 s38, s33, 11
    s_add_u32 s36, s38, s36
    s_waitcnt lgkmcnt(0)
    v_add_f32 v20, v20, v24
    v_add_f32 v28, v28, v32
    v_add_f32 v21, v21, v25
    v_add_f32 v29, v29, v33
    v_add_f32 v22, v22, v26
    v_add_f32 v30, v30, v34
    v_add_f32 v23, v23, v27
    v_add_f32 v31, v31, v35
    v_add_f32 v20, v20, v28
    v_add_f32 v21, v21, v29
    v_add_f32 v22, v22, v30
    v_add_f32 v23, v23, v31
    s_mov_b32 s38, 0xffff0000
    v_cvt_pk_bf16_f32 v20, v20, v20
    v_cvt_pk_bf16_f32 v21, v21, v21
    v_cvt_pk_bf16_f32 v22, v22, v22
    v_cvt_pk_bf16_f32 v23, v23, v23
    v_and_or_b32 v20, v20, s38, v8
    v_and_or_b32 v21, v21, s38, v8
    v_and_or_b32 v22, v22, s38, v8
    v_and_or_b32 v23, v23, s38, v8
    s_mov_b32 exec_lo, 0xffffffff
    s_mov_b32 exec_hi, 0x0
    buffer_store_dwordx4 v[20:23], v5, s[48:51], s36 offen sc1
    s_mov_b64 exec, -1
    s_waitcnt vmcnt(7)
    buffer_load_dwordx4 v[156:159], v77, s[52:55], s85 offen offset:1024 nt
    s_add_u32 s87, s87, 7
    s_add_u32 s39, s87, s88
    s_bfe_u32 s37, s39, 0x30000
    s_lshl_b32 s37, s37, 12
    s_add_u32 s85, s37, s89
    s_bfe_u32 s37, s39, 0x10003
    s_lshl_b32 s37, s37, 11
    s_add_u32 s85, s37, s85
    s_bfe_u32 s37, s39, 0x40004
    s_lshl_b32 s37, s37, 16
    s_add_u32 s85, s37, s85
    s_waitcnt vmcnt(7)
    buffer_load_dwordx4 v[160:163], v76, s[52:55], s85 offen offset:0 nt
    s_waitcnt vmcnt(7)
    buffer_load_dwordx4 v[164:167], v77, s[52:55], s85 offen offset:0 nt
    s_waitcnt vmcnt(7)
    buffer_load_dwordx4 v[168:171], v76, s[52:55], s85 offen offset:1024 nt
    s_waitcnt vmcnt(7)
    buffer_load_dwordx4 v[172:175], v77, s[52:55], s85 offen offset:1024 nt
    s_add_u32 s87, s87, 7
    s_add_u32 s39, s87, s88
    s_bfe_u32 s37, s39, 0x30000
    s_lshl_b32 s37, s37, 12
    s_add_u32 s85, s37, s89
    s_bfe_u32 s37, s39, 0x10003
    s_lshl_b32 s37, s37, 11
    s_add_u32 s85, s37, s85
    s_bfe_u32 s37, s39, 0x40004
    s_lshl_b32 s37, s37, 16
    s_add_u32 s85, s37, s85
    s_waitcnt vmcnt(7)
    buffer_load_dwordx4 v[176:179], v76, s[52:55], s85 offen offset:0 nt
    s_waitcnt vmcnt(7)
    buffer_load_dwordx4 v[180:183], v77, s[52:55], s85 offen offset:0 nt
    s_waitcnt vmcnt(6)
    buffer_load_dwordx4 v[184:187], v76, s[52:55], s85 offen offset:1024 nt
    s_waitcnt vmcnt(6)
    buffer_load_dwordx4 v[188:191], v77, s[52:55], s85 offen offset:1024 nt
    s_add_u32 s87, s87, 7
    s_add_u32 s39, s87, s88
    s_bfe_u32 s37, s39, 0x30000
    s_lshl_b32 s37, s37, 12
    s_add_u32 s85, s37, s89
    s_bfe_u32 s37, s39, 0x10003
    s_lshl_b32 s37, s37, 11
    s_add_u32 s85, s37, s85
    s_bfe_u32 s37, s39, 0x40004
    s_lshl_b32 s37, s37, 16
    s_add_u32 s85, s37, s85
    s_waitcnt vmcnt(6)
    buffer_load_dwordx4 v[192:195], v76, s[52:55], s85 offen offset:0 nt
    s_waitcnt vmcnt(6)
    buffer_load_dwordx4 v[196:199], v77, s[52:55], s85 offen offset:0 nt
    s_waitcnt vmcnt(6)
    buffer_load_dwordx4 v[200:203], v76, s[52:55], s85 offen offset:1024 nt
    s_waitcnt vmcnt(6)
    buffer_load_dwordx4 v[204:207], v77, s[52:55], s85 offen offset:1024 nt
    s_add_u32 s87, s87, 7
    s_add_u32 s39, s87, s88
    s_bfe_u32 s37, s39, 0x30000
    s_lshl_b32 s37, s37, 12
    s_add_u32 s85, s37, s89
    s_bfe_u32 s37, s39, 0x10003
    s_lshl_b32 s37, s37, 11
    s_add_u32 s85, s37, s85
    s_bfe_u32 s37, s39, 0x40004
    s_lshl_b32 s37, s37, 16
    s_add_u32 s85, s37, s85
    s_waitcnt vmcnt(6)
    buffer_load_dwordx4 v[208:211], v76, s[52:55], s85 offen offset:0 nt
    s_waitcnt vmcnt(6)
    buffer_load_dwordx4 v[212:215], v77, s[52:55], s85 offen offset:0 nt
    s_waitcnt vmcnt(6)
    buffer_load_dwordx4 v[216:219], v76, s[52:55], s85 offen offset:1024 nt
    s_waitcnt vmcnt(6)
    buffer_load_dwordx4 v[220:223], v77, s[52:55], s85 offen offset:1024 nt
    s_add_u32 s87, s87, 7
    s_add_u32 s39, s87, s88
    s_bfe_u32 s37, s39, 0x30000
    s_lshl_b32 s37, s37, 12
    s_add_u32 s85, s37, s89
    s_bfe_u32 s37, s39, 0x10003
    s_lshl_b32 s37, s37, 11
    s_add_u32 s85, s37, s85
    s_bfe_u32 s37, s39, 0x40004
    s_lshl_b32 s37, s37, 16
    s_add_u32 s85, s37, s85
    s_waitcnt vmcnt(6)
    buffer_load_dwordx4 v[224:227], v76, s[52:55], s85 offen offset:0 nt
    s_waitcnt vmcnt(6)
    buffer_load_dwordx4 v[228:231], v77, s[52:55], s85 offen offset:0 nt
    s_waitcnt vmcnt(6)
    buffer_load_dwordx4 v[232:235], v76, s[52:55], s85 offen offset:1024 nt
    s_waitcnt vmcnt(6)
    buffer_load_dwordx4 v[236:239], v77, s[52:55], s85 offen offset:1024 nt
    s_add_u32 s87, s87, 7
    s_add_u32 s39, s87, s88
    s_bfe_u32 s37, s39, 0x30000
    s_lshl_b32 s37, s37, 12
    s_add_u32 s85, s37, s89
    s_bfe_u32 s37, s39, 0x10003
    s_lshl_b32 s37, s37, 11
    s_add_u32 s85, s37, s85
    s_bfe_u32 s37, s39, 0x40004
    s_lshl_b32 s37, s37, 16
    s_add_u32 s85, s37, s85
    s_waitcnt vmcnt(6)
    buffer_load_dwordx4 v[240:243], v76, s[52:55], s85 offen offset:0 nt
    s_waitcnt vmcnt(6)
    buffer_load_dwordx4 v[244:247], v77, s[52:55], s85 offen offset:0 nt
    s_waitcnt vmcnt(6)
    buffer_load_dwordx4 v[248:251], v76, s[52:55], s85 offen offset:1024 nt
    s_waitcnt vmcnt(6)
    buffer_load_dwordx4 v[252:255], v77, s[52:55], s85 offen offset:1024 nt
    s_add_u32 s87, s87, 7
    s_add_u32 s39, s87, s88
    s_bfe_u32 s37, s39, 0x30000
    s_lshl_b32 s37, s37, 12
    s_add_u32 s85, s37, s89
    s_bfe_u32 s37, s39, 0x10003
    s_lshl_b32 s37, s37, 11
    s_add_u32 s85, s37, s85
    s_bfe_u32 s37, s39, 0x40004
    s_lshl_b32 s37, s37, 16
    s_add_u32 s85, s37, s85
    s_waitcnt vmcnt(6)
    buffer_load_dwordx4 a[0:3], v76, s[52:55], s85 offen offset:0 nt
    s_waitcnt vmcnt(6)
    buffer_load_dwordx4 a[4:7], v77, s[52:55], s85 offen offset:0 nt
    buffer_load_dwordx4 v[68:71], v78, s[48:51], s91 offen offset:0 sc1
    buffer_load_dwordx4 v[72:75], v78, s[48:51], s91 offen offset:16 sc1
    s_waitcnt vmcnt(8)
    buffer_load_dwordx4 a[8:11], v76, s[52:55], s85 offen offset:1024 nt
    s_waitcnt vmcnt(8)
    buffer_load_dwordx4 a[12:15], v77, s[52:55], s85 offen offset:1024 nt
    s_add_u32 s87, s87, 7
    s_add_u32 s39, s87, s88
    s_bfe_u32 s37, s39, 0x30000
    s_lshl_b32 s37, s37, 12
    s_add_u32 s85, s37, s89
    s_bfe_u32 s37, s39, 0x10003
    s_lshl_b32 s37, s37, 11
    s_add_u32 s85, s37, s85
    s_bfe_u32 s37, s39, 0x40004
    s_lshl_b32 s37, s37, 16
    s_add_u32 s85, s37, s85
    s_waitcnt vmcnt(8)
    buffer_load_dwordx4 a[16:19], v76, s[52:55], s85 offen offset:0 nt
    s_waitcnt vmcnt(8)
    buffer_load_dwordx4 a[20:23], v77, s[52:55], s85 offen offset:0 nt
    s_waitcnt vmcnt(8)
    buffer_load_dwordx4 a[24:27], v76, s[52:55], s85 offen offset:1024 nt
    s_waitcnt vmcnt(8)
    buffer_load_dwordx4 a[28:31], v77, s[52:55], s85 offen offset:1024 nt
    s_add_u32 s87, s87, 7
    s_add_u32 s39, s87, s88
    s_bfe_u32 s37, s39, 0x30000
    s_lshl_b32 s37, s37, 12
    s_add_u32 s85, s37, s89
    s_bfe_u32 s37, s39, 0x10003
    s_lshl_b32 s37, s37, 11
    s_add_u32 s85, s37, s85
    s_bfe_u32 s37, s39, 0x40004
    s_lshl_b32 s37, s37, 16
    s_add_u32 s85, s37, s85
    s_waitcnt vmcnt(6)
L_qcheck_17:
    v_xor_b32 v68, s35, v68
    v_xor_b32 v69, s35, v69
    v_xor_b32 v70, s35, v70
    v_xor_b32 v71, s35, v71
    v_xor_b32 v72, s35, v72
    v_xor_b32 v73, s35, v73
    v_xor_b32 v74, s35, v74
    v_xor_b32 v75, s35, v75
    v_or_b32 v4, v68, v69
    v_or3_b32 v4, v4, v70, v71
    v_or3_b32 v4, v4, v72, v73
    v_or3_b32 v4, v4, v74, v75
    v_and_b32 v4, 0xff, v4
    v_cmp_ne_u32 vcc, 0, v4
    s_cbranch_vccz L_qok_18
    buffer_load_dwordx4 v[68:71], v78, s[48:51], s91 offen offset:0 sc1
    buffer_load_dwordx4 v[72:75], v78, s[48:51], s91 offen offset:16 sc1
    s_waitcnt vmcnt(0)
    s_sub_u32 s84, s84, 1
    s_cmp_lg_u32 s84, 0
    s_cbranch_scc1 L_qcheck_17
    s_branch L_end
L_qok_18:
    v_cvt_pk_bf16_f32 v68, v68, v69
    v_cvt_pk_bf16_f32 v69, v70, v71
    v_cvt_pk_bf16_f32 v70, v72, v73
    v_cvt_pk_bf16_f32 v71, v74, v75
    s_mov_b32 vcc_lo, 0xf000f
    s_mov_b32 vcc_hi, 0xf000f
    v_cndmask_b32 v80, 0, v68, vcc
    v_cndmask_b32 v81, 0, v69, vcc
    v_cndmask_b32 v82, 0, v70, vcc
    v_cndmask_b32 v83, 0, v71, vcc
    s_mov_b32 vcc_lo, 0xf000f0
    s_mov_b32 vcc_hi, 0xf000f0
    v_cndmask_b32 v84, 0, v68, vcc
    v_cndmask_b32 v85, 0, v69, vcc
    v_cndmask_b32 v86, 0, v70, vcc
    v_cndmask_b32 v87, 0, v71, vcc
    s_mov_b32 vcc_lo, 0xf000f00
    s_mov_b32 vcc_hi, 0xf000f00
    v_cndmask_b32 v88, 0, v68, vcc
    v_cndmask_b32 v89, 0, v69, vcc
    v_cndmask_b32 v90, 0, v70, vcc
    v_cndmask_b32 v91, 0, v71, vcc
    s_mov_b32 vcc_lo, 0xf000f000
    s_mov_b32 vcc_hi, 0xf000f000
    v_cndmask_b32 v92, 0, v68, vcc
    v_cndmask_b32 v93, 0, v69, vcc
    v_cndmask_b32 v94, 0, v70, vcc
    v_cndmask_b32 v95, 0, v71, vcc
    v_mov_b32 v65, 0xff7f0000
    s_lshl_b32 s38, s34, 14
    s_add_u32 s38, s38, 16384
    v_lshl_add_u32 v64, v1, 2, s38
    buffer_load_dwordx4 a[32:35], v76, s[52:55], s85 offen offset:0 nt
    v_mfma_f32_16x16x32_bf16 v[112:115], v[128:131], v[80:83], 0
    v_mfma_f32_16x16x32_bf16 v[112:115], v[132:135], v[84:87], v[112:115]
    v_mfma_f32_16x16x32_bf16 v[112:115], v[136:139], v[88:91], v[112:115]
    s_waitcnt vmcnt(6)
    buffer_load_dwordx4 a[36:39], v77, s[52:55], s85 offen offset:0 nt
    v_mfma_f32_16x16x32_bf16 v[112:115], v[140:143], v[92:95], v[112:115]
    v_mfma_f32_16x16x32_bf16 v[96:99], v[144:147], v[80:83], 0
    v_mfma_f32_16x16x32_bf16 v[96:99], v[148:151], v[84:87], v[96:99]
    s_waitcnt vmcnt(6)
    buffer_load_dwordx4 a[40:43], v76, s[52:55], s85 offen offset:1024 nt
    v_mfma_f32_16x16x32_bf16 v[96:99], v[152:155], v[88:91], v[96:99]
    s_nop 2
    v_mov_b32_dpp v122, v112 quad_perm:[0,0,0,0] row_mask:0xf bank_mask:0xf
    v_mov_b32_dpp v124, v114 quad_perm:[2,2,2,2] row_mask:0xf bank_mask:0xf
    s_nop 0
    v_add_f32_dpp v122, v113, v122 quad_perm:[1,1,1,1] row_mask:0xf bank_mask:0xf
    v_add_f32_dpp v124, v115, v124 quad_perm:[3,3,3,3] row_mask:0xf bank_mask:0xf
    v_add_f32 v122, v122, v124
    v_max_f32 v65, v65, v122
    ds_write_b32 v64, v122 offset:0
    v_mfma_f32_16x16x32_bf16 v[96:99], v[156:159], v[92:95], v[96:99]
    v_mfma_f32_16x16x32_bf16 v[112:115], v[160:163], v[80:83], 0
    v_mfma_f32_16x16x32_bf16 v[112:115], v[164:167], v[84:87], v[112:115]
    s_waitcnt vmcnt(6)
    buffer_load_dwordx4 a[44:47], v77, s[52:55], s85 offen offset:1024 nt
    s_add_u32 s87, s87, 7
    s_add_u32 s39, s87, s88
    s_bfe_u32 s37, s39, 0x30000
    s_lshl_b32 s37, s37, 12
    s_add_u32 s85, s37, s89
    s_bfe_u32 s37, s39, 0x10003
    s_lshl_b32 s37, s37, 11
    s_add_u32 s85, s37, s85
    s_bfe_u32 s37, s39, 0x40004
    s_lshl_b32 s37, s37, 16
    s_add_u32 s85, s37, s85
    v_mfma_f32_16x16x32_bf16 v[112:115], v[168:171], v[88:91], v[112:115]
    v_mov_b32_dpp v122, v96 quad_perm:[0,0,0,0] row_mask:0xf bank_mask:0xf
    v_mov_b32_dpp v124, v98 quad_perm:[2,2,2,2] row_mask:0xf bank_mask:0xf
    s_nop 0
    v_add_f32_dpp v122, v97, v122 quad_perm:[1,1,1,1] row_mask:0xf bank_mask:0xf
    v_add_f32_dpp v124, v99, v124 quad_perm:[3,3,3,3] row_mask:0xf bank_mask:0xf
    v_add_f32 v122, v122, v124
    v_max_f32 v65, v65, v122
    ds_write_b32 v64, v122 offset:256
    v_mfma_f32_16x16x32_bf16 v[112:115], v[172:175], v[92:95], v[112:115]
    v_mfma_f32_16x16x32_bf16 v[96:99], v[176:179], v[80:83], 0
    s_waitcnt vmcnt(6)
    buffer_load_dwordx4 a[48:51], v76, s[52:55], s85 offen offset:0 nt
    v_mfma_f32_16x16x32_bf16 v[96:99], v[180:183], v[84:87], v[96:99]
    v_mfma_f32_16x16x32_bf16 v[96:99], v[184:187], v[88:91], v[96:99]
    s_nop 2
    v_mov_b32_dpp v122, v112 quad_perm:[0,0,0,0] row_mask:0xf bank_mask:0xf
    v_mov_b32_dpp v124, v114 quad_perm:[2,2,2,2] row_mask:0xf bank_mask:0xf
    s_nop 0
    v_add_f32_dpp v122, v113, v122 quad_perm:[1,1,1,1] row_mask:0xf bank_mask:0xf
    v_add_f32_dpp v124, v115, v124 quad_perm:[3,3,3,3] row_mask:0xf bank_mask:0xf
    v_add_f32 v122, v122, v124
    v_max_f32 v65, v65, v122
    ds_write_b32 v64, v122 offset:512
    v_mfma_f32_16x16x32_bf16 v[96:99], v[188:191], v[92:95], v[96:99]
    v_mfma_f32_16x16x32_bf16 v[112:115], v[192:195], v[80:83], 0
    s_waitcnt vmcnt(6)
    buffer_load_dwordx4 a[52:55], v77, s[52:55], s85 offen offset:0 nt
    v_mfma_f32_16x16x32_bf16 v[112:115], v[196:199], v[84:87], v[112:115]
    v_mfma_f32_16x16x32_bf16 v[112:115], v[200:203], v[88:91], v[112:115]
    s_nop 2
    v_mov_b32_dpp v122, v96 quad_perm:[0,0,0,0] row_mask:0xf bank_mask:0xf
    v_mov_b32_dpp v124, v98 quad_perm:[2,2,2,2] row_mask:0xf bank_mask:0xf
    s_nop 0
    v_add_f32_dpp v122, v97, v122 quad_perm:[1,1,1,1] row_mask:0xf bank_mask:0xf
    v_add_f32_dpp v124, v99, v124 quad_perm:[3,3,3,3] row_mask:0xf bank_mask:0xf
    v_add_f32 v122, v122, v124
    v_max_f32 v65, v65, v122
    ds_write_b32 v64, v122 offset:768
    v_mfma_f32_16x16x32_bf16 v[112:115], v[204:207], v[92:95], v[112:115]
    s_waitcnt vmcnt(6)
    buffer_load_dwordx4 a[56:59], v76, s[52:55], s85 offen offset:1024 nt
    v_mfma_f32_16x16x32_bf16 v[96:99], v[208:211], v[80:83], 0
    v_mfma_f32_16x16x32_bf16 v[96:99], v[212:215], v[84:87], v[96:99]
    v_mfma_f32_16x16x32_bf16 v[96:99], v[216:219], v[88:91], v[96:99]
    s_nop 2
    v_mov_b32_dpp v122, v112 quad_perm:[0,0,0,0] row_mask:0xf bank_mask:0xf
    v_mov_b32_dpp v124, v114 quad_perm:[2,2,2,2] row_mask:0xf bank_mask:0xf
    s_nop 0
    v_add_f32_dpp v122, v113, v122 quad_perm:[1,1,1,1] row_mask:0xf bank_mask:0xf
    v_add_f32_dpp v124, v115, v124 quad_perm:[3,3,3,3] row_mask:0xf bank_mask:0xf
    v_add_f32 v122, v122, v124
    v_max_f32 v65, v65, v122
    ds_write_b32 v64, v122 offset:1024
    v_mfma_f32_16x16x32_bf16 v[96:99], v[220:223], v[92:95], v[96:99]
    s_waitcnt vmcnt(6)
    buffer_load_dwordx4 a[60:63], v77, s[52:55], s85 offen offset:1024 nt
    s_add_u32 s87, s87, 7
    s_add_u32 s39, s87, s88
    s_bfe_u32 s37, s39, 0x30000
    s_lshl_b32 s37, s37, 12
    s_add_u32 s85, s37, s89
    s_bfe_u32 s37, s39, 0x10003
    s_lshl_b32 s37, s37, 11
    s_add_u32 s85, s37, s85
    s_bfe_u32 s37, s39, 0x40004
    s_lshl_b32 s37, s37, 16
    s_add_u32 s85, s37, s85
    v_mfma_f32_16x16x32_bf16 v[112:115], v[224:227], v[80:83], 0
    s_sub_u32 s36, s33, 3
    s_and_b32 s37, s33, 3
    s_cmp_lt_u32 s36, 4
    s_cselect_b64 s[40:41], s[24:25], s[14:15]
    s_cselect_b32 s36, s36, s37
    s_cselect_b32 s45, 262144, 0
    s_cselect_b32 s46, 8388608, 0
    s_add_u32 s45, s45, 524288
    s_add_u32 s46, s46, 196608
    s_mov_b32 s42, 4194304
    s_mov_b32 s43, 0x20000
    s_lshl_b32 s38, s32, 17
    s_add_u32 s44, s38, 0
    s_lshl_b32 s38, s34, 15
    s_add_u32 s44, s38, s44
    s_lshl_b32 s38, s36, 8
    s_add_u32 s44, s38, s44
    s_lshl_b32 s38, s36, 16
    s_add_u32 s45, s38, s45
    s_lshr_b32 s38, s34, 1
    s_lshl_b32 s38, s38, 15
    s_add_u32 s45, s38, s45
    s_lshl_b32 s38, s32, 8
    s_add_u32 s45, s38, s45
    s_bfe_u32 s38, s34, 0x10000
    s_lshl_b32 s38, s38, 7
    s_add_u32 s45, s38, s45
    s_lshl_b32 s38, s32, 11
    s_add_u32 s46, s38, s46
    s_lshl_b32 s38, s34, 9
    s_add_u32 s46, s38, s46
    s_mov_b32 s72, s26
    s_and_b32 s73, s27, 0xffff
    s_mov_b32 s74, 8192
    s_mov_b32 s75, 0x20000
    v_mfma_f32_16x16x32_bf16 v[112:115], v[228:231], v[84:87], v[112:115]
    v_mfma_f32_16x16x32_bf16 v[112:115], v[232:235], v[88:91], v[112:115]
    v_mov_b32_dpp v122, v96 quad_perm:[0,0,0,0] row_mask:0xf bank_mask:0xf
    v_mov_b32_dpp v124, v98 quad_perm:[2,2,2,2] row_mask:0xf bank_mask:0xf
    s_nop 0
    v_add_f32_dpp v122, v97, v122 quad_perm:[1,1,1,1] row_mask:0xf bank_mask:0xf
    v_add_f32_dpp v124, v99, v124 quad_perm:[3,3,3,3] row_mask:0xf bank_mask:0xf
    v_add_f32 v122, v122, v124
    v_max_f32 v65, v65, v122
    ds_write_b32 v64, v122 offset:1280
    s_waitcnt vmcnt(5)
    buffer_load_dwordx4 v[128:131], v76, s[52:55], s85 offen offset:0 nt
    v_mfma_f32_16x16x32_bf16 v[112:115], v[236:239], v[92:95], v[112:115]
    v_mfma_f32_16x16x32_bf16 v[96:99], v[240:243], v[80:83], 0
    v_mfma_f32_16x16x32_bf16 v[96:99], v[244:247], v[84:87], v[96:99]
    s_waitcnt vmcnt(5)
    buffer_load_dwordx4 v[132:135], v77, s[52:55], s85 offen offset:0 nt
    v_mfma_f32_16x16x32_bf16 v[96:99], v[248:251], v[88:91], v[96:99]
    s_nop 2
    v_mov_b32_dpp v122, v112 quad_perm:[0,0,0,0] row_mask:0xf bank_mask:0xf
    v_mov_b32_dpp v124, v114 quad_perm:[2,2,2,2] row_mask:0xf bank_mask:0xf
    s_nop 0
    v_add_f32_dpp v122, v113, v122 quad_perm:[1,1,1,1] row_mask:0xf bank_mask:0xf
    v_add_f32_dpp v124, v115, v124 quad_perm:[3,3,3,3] row_mask:0xf bank_mask:0xf
    v_add_f32 v122, v122, v124
    v_max_f32 v65, v65, v122
    ds_write_b32 v64, v122 offset:1536
    v_lshlrev_b32 v4, 2, v2
    v_xor_b32 v4, v4, v3
    v_xor_b32 v5, 0, v4
    v_lshlrev_b32 v5, 4, v5
    v_lshl_add_u32 v20, v2, 10, v5
    v_xor_b32 v5, 1, v4
    v_lshlrev_b32 v5, 4, v5
    v_lshl_add_u32 v21, v2, 10, v5
    v_add_u32 v21, 3072, v21
    v_xor_b32 v5, 2, v4
    v_lshlrev_b32 v5, 4, v5
    v_lshl_add_u32 v22, v2, 10, v5
    v_add_u32 v22, 6144, v22
    v_xor_b32 v5, 3, v4
    v_lshlrev_b32 v5, 4, v5
    v_lshl_add_u32 v23, v2, 10, v5
    v_add_u32 v23, 9216, v23
    s_lshl_b32 s38, s32, 15
    s_add_u32 s47, s38, 1048576
    s_lshl_b32 s38, s3, 13
    s_add_u32 s47, s38, s47
    s_mul_i32 s38, s3, 320
    s_add_u32 s38, s38, 135168
    v_lshlrev_b32 v4, 6, v2
    v_lshl_add_u32 v4, v3, 1, v4
    v_add_u32 v31, s38, v4
    v_mfma_f32_16x16x32_bf16 v[96:99], v[252:255], v[92:95], v[96:99]
    v_mfma_f32_16x16x32_bf16 v[112:115], a[0:3], v[80:83], 0
    v_mfma_f32_16x16x32_bf16 v[112:115], a[4:7], v[84:87], v[112:115]
    s_waitcnt vmcnt(5)
    buffer_load_dwordx4 v[136:139], v76, s[52:55], s85 offen offset:1024 nt
    v_mfma_f32_16x16x32_bf16 v[112:115], a[8:11], v[88:91], v[112:115]
    s_nop 2
    v_mov_b32_dpp v122, v96 quad_perm:[0,0,0,0] row_mask:0xf bank_mask:0xf
    v_mov_b32_dpp v124, v98 quad_perm:[2,2,2,2] row_mask:0xf bank_mask:0xf
    s_nop 0
    v_add_f32_dpp v122, v97, v122 quad_perm:[1,1,1,1] row_mask:0xf bank_mask:0xf
    v_add_f32_dpp v124, v99, v124 quad_perm:[3,3,3,3] row_mask:0xf bank_mask:0xf
    v_add_f32 v122, v122, v124
    v_max_f32 v65, v65, v122
    ds_write_b32 v64, v122 offset:1792
    v_mfma_f32_16x16x32_bf16 v[112:115], a[12:15], v[92:95], v[112:115]
    v_mfma_f32_16x16x32_bf16 v[96:99], a[16:19], v[80:83], 0
    v_lshlrev_b32 v4, 11, v2
    v_bfe_u32 v5, v1, 2, 2
    v_lshl_add_u32 v4, v5, 8, v4
    v_bfe_u32 v5, v1, 2, 2
    v_lshl_add_u32 v4, v5, 6, v4
    v_bfe_u32 v5, v1, 4, 1
    v_lshl_add_u32 v4, v5, 5, v4
    v_bfe_u32 v5, v1, 1, 1
    v_lshl_add_u32 v4, v5, 4, v4
    v_bfe_u32 v5, v1, 0, 1
    v_lshl_add_u32 v4, v5, 3, v4
    s_lshl_b32 s38, s34, 6
    s_add_u32 s38, s38, 98304
    v_xor_b32 v24, s38, v4
    v_xor_b32 v25, 16, v24
    v_xor_b32 v26, 32, v24
    v_xor_b32 v27, 48, v24
    v_and_b32 v4, 3, v3
    v_lshrrev_b32 v5, 2, v3
    v_lshlrev_b32 v6, 4, v2
    v_add_u32 v6, 135168, v6
    s_movk_i32 s36, 320
    v_cmp_eq_u32 vcc, 0, v5
    s_nop 1
    v_cndmask_b32 v28, 4, v4, vcc
    v_mad_u32_u24 v28, v28, s36, v6
    v_cmp_eq_u32 vcc, 1, v5
    s_nop 1
    v_cndmask_b32 v29, 4, v4, vcc
    v_mad_u32_u24 v29, v29, s36, v6
    v_lshlrev_b32 v5, 2, v1
    v_add_u32 v5, 136448, v5
    v_mov_b32 v6, 0
    ds_write_b32 v5, v6
    s_waitcnt vmcnt(5)
    buffer_load_dwordx4 v[140:143], v77, s[52:55], s85 offen offset:1024 nt
    s_add_u32 s87, s87, 7
    s_add_u32 s39, s87, s88
    s_bfe_u32 s37, s39, 0x30000
    s_lshl_b32 s37, s37, 12
    s_add_u32 s85, s37, s89
    s_bfe_u32 s37, s39, 0x10003
    s_lshl_b32 s37, s37, 11
    s_add_u32 s85, s37, s85
    s_bfe_u32 s37, s39, 0x40004
    s_lshl_b32 s37, s37, 16
    s_add_u32 s85, s37, s85
    v_mfma_f32_16x16x32_bf16 v[96:99], a[20:23], v[84:87], v[96:99]
    v_mfma_f32_16x16x32_bf16 v[96:99], a[24:27], v[88:91], v[96:99]
    v_mov_b32_dpp v122, v112 quad_perm:[0,0,0,0] row_mask:0xf bank_mask:0xf
    v_mov_b32_dpp v124, v114 quad_perm:[2,2,2,2] row_mask:0xf bank_mask:0xf
    s_nop 0
    v_add_f32_dpp v122, v113, v122 quad_perm:[1,1,1,1] row_mask:0xf bank_mask:0xf
    v_add_f32_dpp v124, v115, v124 quad_perm:[3,3,3,3] row_mask:0xf bank_mask:0xf
    v_add_f32 v122, v122, v124
    v_max_f32 v65, v65, v122
    ds_write_b32 v64, v122 offset:2048
    v_mfma_f32_16x16x32_bf16 v[96:99], a[28:31], v[92:95], v[96:99]
    v_mfma_f32_16x16x32_bf16 v[112:115], a[32:35], v[80:83], 0
    s_waitcnt vmcnt(5)
    buffer_load_dwordx4 v[144:147], v76, s[52:55], s85 offen offset:0 nt
    v_mfma_f32_16x16x32_bf16 v[112:115], a[36:39], v[84:87], v[112:115]
    v_mfma_f32_16x16x32_bf16 v[112:115], a[40:43], v[88:91], v[112:115]
    s_nop 2
    v_mov_b32_dpp v122, v96 quad_perm:[0,0,0,0] row_mask:0xf bank_mask:0xf
    v_mov_b32_dpp v124, v98 quad_perm:[2,2,2,2] row_mask:0xf bank_mask:0xf
    s_nop 0
    v_add_f32_dpp v122, v97, v122 quad_perm:[1,1,1,1] row_mask:0xf bank_mask:0xf
    v_add_f32_dpp v124, v99, v124 quad_perm:[3,3,3,3] row_mask:0xf bank_mask:0xf
    v_add_f32 v122, v122, v124
    v_max_f32 v65, v65, v122
    ds_write_b32 v64, v122 offset:2304
    v_lshlrev_b32 v30, 4, v3
    v_lshl_add_u32 v30, v2, 13, v30
    s_lshl_b32 s38, s32, 13
    s_add_u32 s36, s38, 0
    s_lshl_b32 s38, s34, 6
    s_add_u32 s36, s38, s36
    v_lshrrev_b32 v5, 2, v1
    v_lshlrev_b32 v32, 8, v5
    v_bfe_u32 v5, v1, 0, 2
    v_lshl_add_u32 v32, v5, 4, v32
    v_add_u32 v32, s36, v32
    s_lshr_b32 s38, s32, 2
    s_lshl_b32 s38, s38, 7
    s_add_u32 s36, s38, 0
    s_lshl_b32 s38, s34, 5
    s_add_u32 s36, s38, s36
    s_bfe_u32 s38, s32, 0x20000
    s_lshl_b32 s38, s38, 3
    s_add_u32 s36, s38, s36
    v_bfe_u32 v5, v1, 0, 2
    v_lshlrev_b32 v33, 11, v5
    v_lshl_add_u32 v33, v2, 1, v33
    v_add_u32 v33, s36, v33
    v_and_b32 v5, 31, v1
    v_lshlrev_b32 v34, 4, v5
    s_mul_i32 s38, s34, 320
    s_add_u32 s38, s38, 135168
    v_lshl_add_u32 v35, v5, 3, s38
    v_mfma_f32_16x16x32_bf16 v[112:115], a[44:47], v[92:95], v[112:115]
    s_waitcnt vmcnt(5)
    buffer_load_dwordx4 v[148:151], v77, s[52:55], s85 offen offset:0 nt
    v_mfma_f32_16x16x32_bf16 v[96:99], a[48:51], v[80:83], 0
    v_mfma_f32_16x16x32_bf16 v[96:99], a[52:55], v[84:87], v[96:99]
    v_mfma_f32_16x16x32_bf16 v[96:99], a[56:59], v[88:91], v[96:99]
    s_nop 2
    v_mov_b32_dpp v122, v112 quad_perm:[0,0,0,0] row_mask:0xf bank_mask:0xf
    v_mov_b32_dpp v124, v114 quad_perm:[2,2,2,2] row_mask:0xf bank_mask:0xf
    s_nop 0
    v_add_f32_dpp v122, v113, v122 quad_perm:[1,1,1,1] row_mask:0xf bank_mask:0xf
    v_add_f32_dpp v124, v115, v124 quad_perm:[3,3,3,3] row_mask:0xf bank_mask:0xf
    v_add_f32 v122, v122, v124
    v_max_f32 v65, v65, v122
    ds_write_b32 v64, v122 offset:2560
    v_mfma_f32_16x16x32_bf16 v[96:99], a[60:63], v[92:95], v[96:99]
    v_add_u32 v64, 2816, v64
    s_mov_b32 s97, 10
    s_mov_b32 s86, 32
    s_and_b32 s36, s32, 3
    s_sub_u32 s80, s36, 2
    s_cmp_ge_u32 s36, 2
    s_cselect_b32 s80, s80, 8
    s_cselect_b32 s81, 27, 25
    s_cmp_eq_u32 s80, s33
    s_cselect_b32 s36, 2, 0
    s_sub_u32 s86, s86, s36
    s_lshr_b32 s36, s36, 1
    s_sub_u32 s97, s97, s36
    s_add_u32 s80, s80, 35
    s_sub_u32 s92, s81, 1
    s_mov_b32 s66, 134217728
    s_mov_b32 s67, 0x20000
    s_mov_b64 s[64:65], s[52:53]
    v_mov_b32 v62, v76
    v_mov_b32 v63, v77
    s_branch L_bloop
L_ql:
    v_lshrrev_b32 v4, 2, v3
    v_and_b32 v5, 3, v3
    v_lshlrev_b32 v19, 6, v2
    v_lshl_add_u32 v19, v5, 4, v19
    v_lshl_add_u32 v14, v4, 18, v19
    s_and_b32 s61, s32, 28
    s_add_u32 s61, s61, s34
    s_and_b32 s60, s32, 3
    s_lshl_b32 s38, s60, 20
    s_add_u32 s63, s38, 0
    s_lshl_b32 s38, s61, 8
    s_add_u32 s63, s38, s63
    s_mov_b32 s74, 4194304
    s_mov_b32 s75, 0x20000
    s_waitcnt lgkmcnt(0)
    s_mov_b64 s[72:73], s[10:11]
    buffer_load_dwordx4 a[128:131], v14, s[72:75], s63 offen nt
    s_add_u32 s63, s63, 8192
    buffer_load_dwordx4 a[132:135], v14, s[72:75], s63 offen nt
    s_add_u32 s63, s63, 8192
    buffer_load_dwordx4 a[136:139], v14, s[72:75], s63 offen nt
    s_add_u32 s63, s63, 8192
    buffer_load_dwordx4 a[140:143], v14, s[72:75], s63 offen nt
    s_add_u32 s63, s63, 8192
    buffer_load_dwordx4 a[144:147], v14, s[72:75], s63 offen nt
    s_add_u32 s63, s63, 8192
    buffer_load_dwordx4 a[148:151], v14, s[72:75], s63 offen nt
    s_add_u32 s63, s63, 8192
    buffer_load_dwordx4 a[152:155], v14, s[72:75], s63 offen nt
    s_add_u32 s63, s63, 8192
    buffer_load_dwordx4 a[156:159], v14, s[72:75], s63 offen nt
    s_add_u32 s63, s63, 8192
    v_lshlrev_b32 v15, 1, v19
    v_lshl_add_u32 v15, v4, 9, v15
    v_lshl_add_u32 v19, v4, 15, v19
    s_load_dword s35, s[30:31], 0
    s_mov_b32 s48, s30
    s_and_b32 s49, s31, 0xffff
    s_mov_b32 s50, 8388608
    s_mov_b32 s51, 0x20000
    s_mov_b32 s82, 0xffffff00
    s_mov_b32 s83, 0x3e0293ee
    s_mov_b32 s84, 2097152
    s_lshl_b32 s38, s61, 12
    s_add_u32 s95, s38, 264192
    s_lshl_b32 s38, s61, 10
    s_add_u32 s94, s38, 393216
    s_lshl_b32 s38, s60, 8
    s_add_u32 s94, s38, s94
    s_waitcnt vmcnt(7)
    buffer_load_dwordx4 a[160:163], v14, s[72:75], s63 offen nt
    s_add_u32 s63, s63, 8192
    s_waitcnt vmcnt(7)
    buffer_load_dwordx4 a[164:167], v14, s[72:75], s63 offen nt
    s_add_u32 s63, s63, 8192
    s_waitcnt vmcnt(7)
    buffer_load_dwordx4 a[168:171], v14, s[72:75], s63 offen nt
    s_add_u32 s63, s63, 8192
    s_waitcnt vmcnt(7)
    buffer_load_dwordx4 a[172:175], v14, s[72:75], s63 offen nt
    s_add_u32 s63, s63, 8192
    s_waitcnt vmcnt(7)
    buffer_load_dwordx4 a[176:179], v14, s[72:75], s63 offen nt
    s_add_u32 s63, s63, 8192
    v_and_b32 v4, 1, v1
    v_lshlrev_b32 v4, 4, v4
    v_mov_b32 v5, 0xffff
    v_lshlrev_b32 v4, v4, v5
    v_bfe_u32 v5, v1, 1, 2
    v_cmp_eq_u32 vcc, 0, v5
    s_nop 1
    v_cndmask_b32 v10, 0, v4, vcc
    v_cmp_eq_u32 vcc, 1, v5
    s_nop 1
    v_cndmask_b32 v11, 0, v4, vcc
    v_cmp_eq_u32 vcc, 2, v5
    s_nop 1
    v_cndmask_b32 v12, 0, v4, vcc
    v_cmp_eq_u32 vcc, 3, v5
    s_nop 1
    v_cndmask_b32 v13, 0, v4, vcc
    s_waitcnt vmcnt(7)
    buffer_load_dwordx4 a[180:183], v14, s[72:75], s63 offen nt
    s_add_u32 s63, s63, 8192
    s_waitcnt vmcnt(7)
    buffer_load_dwordx4 a[184:187], v14, s[72:75], s63 offen nt
    s_add_u32 s63, s63, 8192
    s_waitcnt vmcnt(7)
    buffer_load_dwordx4 a[188:191], v14, s[72:75], s63 offen nt
    s_add_u32 s63, s63, 8192
    s_waitcnt vmcnt(7)
    buffer_load_dwordx4 a[192:195], v14, s[72:75], s63 offen nt
    s_add_u32 s63, s63, 8192
    v_lshrrev_b32 v4, 2, v3
    v_and_b32 v5, 3, v3
    v_lshlrev_b32 v76, 8, v4
    v_lshlrev_b32 v126, 8, v2
    v_lshl_add_u32 v76, v2, 6, v76
    v_lshl_add_u32 v76, v5, 4, v76
    v_lshl_add_u32 v126, v3, 4, v126
    v_xor_b32 v77, 32768, v76
    v_xor_b32 v127, 32768, v126
    s_add_u32 s3, s34, s33
    s_and_b32 s3, s3, 3
    s_lshl_b32 s89, s3, 5
    s_add_u32 s89, s89, s32
    s_lshl_b32 s89, s89, 20
    s_mul_i32 s88, s32, 8
    s_add_u32 s88, s88, s3
    s_lshl_b32 s87, s33, 0
    s_waitcnt vmcnt(7)
    buffer_load_dwordx4 a[196:199], v14, s[72:75], s63 offen nt
    s_add_u32 s63, s63, 8192
    s_waitcnt vmcnt(7)
    buffer_load_dwordx4 a[200:203], v14, s[72:75], s63 offen nt
    s_add_u32 s63, s63, 8192
    s_waitcnt vmcnt(7)
    buffer_load_dwordx4 a[204:207], v14, s[72:75], s63 offen nt
    s_add_u32 s63, s63, 8192
    s_waitcnt vmcnt(7)
    buffer_load_dwordx4 a[208:211], v14, s[72:75], s63 offen nt
    s_add_u32 s63, s63, 8192
    s_mov_b32 s52, s18
    s_and_b32 s53, s19, 0xffff
    s_mov_b32 s54, 134217728
    s_mov_b32 s55, 0x20000
    s_mov_b32 s56, s20
    s_and_b32 s57, s21, 0xffff
    s_mov_b32 s58, 134217728
    s_mov_b32 s59, 0x20000
    s_waitcnt vmcnt(7)
    buffer_load_dwordx4 a[212:215], v14, s[72:75], s63 offen nt
    s_add_u32 s63, s63, 8192
    s_waitcnt vmcnt(7)
    buffer_load_dwordx4 a[216:219], v14, s[72:75], s63 offen nt
    s_add_u32 s63, s63, 8192
    s_waitcnt vmcnt(7)
    buffer_load_dwordx4 a[220:223], v14, s[72:75], s63 offen nt
    s_add_u32 s63, s63, 8192
    s_waitcnt vmcnt(7)
    buffer_load_dwordx4 a[224:227], v14, s[72:75], s63 offen nt
    s_add_u32 s63, s63, 8192
    v_mov_b32 v120, 0xff7f0000
    v_mov_b32 v121, 0
    v_mov_b32 v18, 1
    v_mov_b32 v116, 0
    v_mov_b32 v117, 0
    v_mov_b32 v118, 0
    v_mov_b32 v119, 0
    s_lshl_b32 s38, s32, 10
    s_add_u32 s96, s38, 65536
    s_lshl_b32 s38, s3, 8
    s_add_u32 s96, s38, s96
    v_mov_b32 v9, s96
    s_lshl_b32 s38, s32, 15
    s_add_u32 s96, s38, 1048576
    s_lshl_b32 s38, s3, 13
    s_add_u32 s96, s38, s96
    s_lshl_b32 s38, s33, 10
    s_add_u32 s96, s38, s96
    v_and_b32 v5, 3, v3
    v_lshlrev_b32 v78, 7, v2
    v_lshl_add_u32 v78, v5, 5, v78
    s_lshl_b32 s38, s32, 12
    s_add_u32 s91, s38, 262144
    s_lshl_b32 s38, s3, 9
    s_add_u32 s91, s38, s91
    v_lshlrev_b32 v4, 7, v2
    v_lshl_add_u32 v4, v3, 4, v4
    v_mov_b32 v5, 512
    v_cmp_gt_u32 vcc, 8, v3
    s_nop 1
    v_cndmask_b32 v79, v5, v4, vcc
    s_waitcnt vmcnt(7)
    buffer_load_dwordx4 a[228:231], v14, s[72:75], s63 offen nt
    s_add_u32 s63, s63, 8192
    s_waitcnt vmcnt(7)
    buffer_load_dwordx4 a[232:235], v14, s[72:75], s63 offen nt
    s_add_u32 s63, s63, 8192
    s_waitcnt vmcnt(7)
    buffer_load_dwordx4 a[236:239], v14, s[72:75], s63 offen nt
    s_add_u32 s63, s63, 8192
    s_waitcnt vmcnt(7)
    buffer_load_dwordx4 a[240:243], v14, s[72:75], s63 offen nt
    s_add_u32 s63, s63, 8192
    s_waitcnt vmcnt(7)
    buffer_load_dwordx4 a[244:247], v14, s[72:75], s63 offen nt
    s_add_u32 s63, s63, 8192
    s_waitcnt vmcnt(7)
    buffer_load_dwordx4 a[248:251], v14, s[72:75], s63 offen nt
    s_add_u32 s63, s63, 8192
    s_waitcnt vmcnt(7)
    buffer_load_dwordx4 a[252:255], v14, s[72:75], s63 offen nt
    s_add_u32 s63, s63, 8192
    s_waitcnt lgkmcnt(0)
    s_add_u32 s35, s35, 0x5b
    s_and_b32 s35, s35, 0xff
    v_mov_b32 v8, s35
    s_or_b32 s68, s35, 0x6b3ac500
    s_waitcnt vmcnt(6)
    s_add_u32 s39, s87, s88
    s_bfe_u32 s37, s39, 0x30000
    s_lshl_b32 s37, s37, 12
    s_add_u32 s85, s37, s89
    s_bfe_u32 s37, s39, 0x10003
    s_lshl_b32 s37, s37, 11
    s_add_u32 s85, s37, s85
    s_bfe_u32 s37, s39, 0x40004
    s_lshl_b32 s37, s37, 16
    s_add_u32 s85, s37, s85
    buffer_load_dwordx4 v[128:131], v76, s[52:55], s85 offen offset:0 nt
    s_waitcnt vmcnt(6)
    buffer_load_dwordx4 v[132:135], v77, s[52:55], s85 offen offset:0 nt
    s_waitcnt vmcnt(6)
    buffer_load_dwordx4 v[136:139], v76, s[52:55], s85 offen offset:1024 nt
    s_waitcnt vmcnt(6)
    buffer_load_dwordx4 v[140:143], v77, s[52:55], s85 offen offset:1024 nt
    s_add_u32 s87, s87, 7
    s_add_u32 s39, s87, s88
    s_bfe_u32 s37, s39, 0x30000
    s_lshl_b32 s37, s37, 12
    s_add_u32 s85, s37, s89
    s_bfe_u32 s37, s39, 0x10003
    s_lshl_b32 s37, s37, 11
    s_add_u32 s85, s37, s85
    s_bfe_u32 s37, s39, 0x40004
    s_lshl_b32 s37, s37, 16
    s_add_u32 s85, s37, s85
    s_waitcnt vmcnt(6)
    buffer_load_dwordx4 v[144:147], v76, s[52:55], s85 offen offset:0 nt
    s_waitcnt vmcnt(6)
    buffer_load_dwordx4 v[148:151], v77, s[52:55], s85 offen offset:0 nt
    s_waitcnt vmcnt(6)
    buffer_load_dwordx4 v[152:155], v76, s[52:55], s85 offen offset:1024 nt
    s_waitcnt vmcnt(6)
    buffer_load_dwordx4 v[156:159], v77, s[52:55], s85 offen offset:1024 nt
    s_add_u32 s87, s87, 7
    s_add_u32 s39, s87, s88
    s_bfe_u32 s37, s39, 0x30000
    s_lshl_b32 s37, s37, 12
    s_add_u32 s85, s37, s89
    s_bfe_u32 s37, s39, 0x10003
    s_lshl_b32 s37, s37, 11
    s_add_u32 s85, s37, s85
    s_bfe_u32 s37, s39, 0x40004
    s_lshl_b32 s37, s37, 16
    s_add_u32 s85, s37, s85
    s_waitcnt vmcnt(6)
    buffer_load_dwordx4 v[160:163], v76, s[52:55], s85 offen offset:0 nt
    s_waitcnt vmcnt(6)
    buffer_load_dwordx4 v[164:167], v77, s[52:55], s85 offen offset:0 nt
    s_waitcnt vmcnt(6)
    buffer_load_dwordx4 v[168:171], v76, s[52:55], s85 offen offset:1024 nt
    s_waitcnt vmcnt(6)
    buffer_load_dwordx4 v[172:175], v77, s[52:55], s85 offen offset:1024 nt
    s_add_u32 s87, s87, 7
    s_add_u32 s39, s87, s88
    s_bfe_u32 s37, s39, 0x30000
    s_lshl_b32 s37, s37, 12
    s_add_u32 s85, s37, s89
    s_bfe_u32 s37, s39, 0x10003
    s_lshl_b32 s37, s37, 11
    s_add_u32 s85, s37, s85
    s_bfe_u32 s37, s39, 0x40004
    s_lshl_b32 s37, s37, 16
    s_add_u32 s85, s37, s85
    s_waitcnt vmcnt(6)
    buffer_load_dwordx4 v[176:179], v76, s[52:55], s85 offen offset:0 nt
    s_waitcnt vmcnt(6)
    buffer_load_dwordx4 v[180:183], v77, s[52:55], s85 offen offset:0 nt
    s_waitcnt vmcnt(6)
    buffer_load_dwordx4 v[184:187], v76, s[52:55], s85 offen offset:1024 nt
    s_waitcnt vmcnt(6)
    buffer_load_dwordx4 v[188:191], v77, s[52:55], s85 offen offset:1024 nt
    s_add_u32 s87, s87, 7
    s_add_u32 s39, s87, s88
    s_bfe_u32 s37, s39, 0x30000
    s_lshl_b32 s37, s37, 12
    s_add_u32 s85, s37, s89
    s_bfe_u32 s37, s39, 0x10003
    s_lshl_b32 s37, s37, 11
    s_add_u32 s85, s37, s85
    s_bfe_u32 s37, s39, 0x40004
    s_lshl_b32 s37, s37, 16
    s_add_u32 s85, s37, s85
    s_waitcnt vmcnt(6)
    buffer_load_dwordx4 v[192:195], v76, s[52:55], s85 offen offset:0 nt
    s_waitcnt vmcnt(6)
    buffer_load_dwordx4 v[196:199], v77, s[52:55], s85 offen offset:0 nt
    s_waitcnt vmcnt(6)
    buffer_load_dwordx4 v[200:203], v76, s[52:55], s85 offen offset:1024 nt
    s_waitcnt vmcnt(6)
    buffer_load_dwordx4 v[204:207], v77, s[52:55], s85 offen offset:1024 nt
    s_add_u32 s87, s87, 7
    s_add_u32 s39, s87, s88
    s_bfe_u32 s37, s39, 0x30000
    s_lshl_b32 s37, s37, 12
    s_add_u32 s85, s37, s89
    s_bfe_u32 s37, s39, 0x10003
    s_lshl_b32 s37, s37, 11
    s_add_u32 s85, s37, s85
    s_bfe_u32 s37, s39, 0x40004
    s_lshl_b32 s37, s37, 16
    s_add_u32 s85, s37, s85
    s_waitcnt vmcnt(6)
    buffer_load_dwordx4 v[208:211], v76, s[52:55], s85 offen offset:0 nt
    s_waitcnt vmcnt(6)
    buffer_load_dwordx4 v[212:215], v77, s[52:55], s85 offen offset:0 nt
    s_waitcnt vmcnt(6)
    buffer_load_dwordx4 v[216:219], v76, s[52:55], s85 offen offset:1024 nt
    s_waitcnt vmcnt(6)
    buffer_load_dwordx4 v[220:223], v77, s[52:55], s85 offen offset:1024 nt
    s_add_u32 s87, s87, 7
    s_add_u32 s39, s87, s88
    s_bfe_u32 s37, s39, 0x30000
    s_lshl_b32 s37, s37, 12
    s_add_u32 s85, s37, s89
    s_bfe_u32 s37, s39, 0x10003
    s_lshl_b32 s37, s37, 11
    s_add_u32 s85, s37, s85
    s_bfe_u32 s37, s39, 0x40004
    s_lshl_b32 s37, s37, 16
    s_add_u32 s85, s37, s85
    buffer_load_dwordx4 v[20:23], v15, s[48:51], s95 offen offset:0 sc1
    buffer_load_dwordx4 v[24:27], v15, s[48:51], s95 offen offset:16 sc1
    s_waitcnt vmcnt(8)
    buffer_load_dwordx4 v[224:227], v76, s[52:55], s85 offen offset:0 nt
    s_waitcnt vmcnt(8)
    buffer_load_dwordx4 v[228:231], v77, s[52:55], s85 offen offset:0 nt
    s_waitcnt vmcnt(8)
    buffer_load_dwordx4 v[232:235], v76, s[52:55], s85 offen offset:1024 nt
    s_waitcnt vmcnt(8)
    buffer_load_dwordx4 v[236:239], v77, s[52:55], s85 offen offset:1024 nt
    s_add_u32 s87, s87, 7
    s_add_u32 s39, s87, s88
    s_bfe_u32 s37, s39, 0x30000
    s_lshl_b32 s37, s37, 12
    s_add_u32 s85, s37, s89
    s_bfe_u32 s37, s39, 0x10003
    s_lshl_b32 s37, s37, 11
    s_add_u32 s85, s37, s85
    s_bfe_u32 s37, s39, 0x40004
    s_lshl_b32 s37, s37, 16
    s_add_u32 s85, s37, s85
    s_waitcnt vmcnt(8)
    buffer_load_dwordx4 v[240:243], v76, s[52:55], s85 offen offset:0 nt
    s_waitcnt vmcnt(8)
    buffer_load_dwordx4 v[244:247], v77, s[52:55], s85 offen offset:0 nt
    s_waitcnt vmcnt(6)
L_qacheck_19:
    v_xor_b32 v20, s35, v20
    v_xor_b32 v21, s35, v21
    v_xor_b32 v22, s35, v22
    v_xor_b32 v23, s35, v23
    v_xor_b32 v24, s35, v24
    v_xor_b32 v25, s35, v25
    v_xor_b32 v26, s35, v26
    v_xor_b32 v27, s35, v27
    v_or_b32 v4, v20, v21
    v_or3_b32 v4, v4, v22, v23
    v_or3_b32 v4, v4, v24, v25
    v_or3_b32 v4, v4, v26, v27
    v_and_b32 v4, 0xff, v4
    v_cmp_ne_u32 vcc, 0, v4
    s_cbranch_vccz L_qaok_20
    buffer_load_dwordx4 v[20:23], v15, s[48:51], s95 offen offset:0 sc1
    buffer_load_dwordx4 v[24:27], v15, s[48:51], s95 offen offset:16 sc1
    s_waitcnt vmcnt(0)
    s_sub_u32 s84, s84, 1
    s_cmp_lg_u32 s84, 0
    s_cbranch_scc1 L_qacheck_19
    s_branch L_end
L_qaok_20:
    buffer_load_dwordx4 v[68:71], v78, s[48:51], s91 offen offset:0 sc1
    buffer_load_dwordx4 v[72:75], v78, s[48:51], s91 offen offset:16 sc1
    v_cvt_pk_bf16_f32 v20, v20, v21
    v_cvt_pk_bf16_f32 v21, v22, v23
    v_cvt_pk_bf16_f32 v22, v24, v25
    v_cvt_pk_bf16_f32 v23, v26, v27
    s_nop 1
    v_mfma_f32_16x16x32_bf16 v[28:31], a[128:131], v[20:23], 0
    v_mfma_f32_16x16x32_bf16 v[32:35], a[132:135], v[20:23], 0
    v_mfma_f32_16x16x32_bf16 v[36:39], a[136:139], v[20:23], 0
    s_nop 5
    v_mov_b32_dpp v60, v28 quad_perm:[0,0,0,0] row_mask:0xf bank_mask:0xf
    v_mov_b32_dpp v4, v30 quad_perm:[2,2,2,2] row_mask:0xf bank_mask:0xf
    s_nop 0
    v_add_f32_dpp v60, v29, v60 quad_perm:[1,1,1,1] row_mask:0xf bank_mask:0xf
    v_add_f32_dpp v4, v31, v4 quad_perm:[3,3,3,3] row_mask:0xf bank_mask:0xf
    v_add_f32 v60, v60, v4
    v_mfma_f32_16x16x32_bf16 v[40:43], a[140:143], v[20:23], 0
    v_mov_b32_dpp v61, v32 quad_perm:[0,0,0,0] row_mask:0xf bank_mask:0xf
    v_mov_b32_dpp v4, v34 quad_perm:[2,2,2,2] row_mask:0xf bank_mask:0xf
    s_nop 0
    v_add_f32_dpp v61, v33, v61 quad_perm:[1,1,1,1] row_mask:0xf bank_mask:0xf
    v_add_f32_dpp v4, v35, v4 quad_perm:[3,3,3,3] row_mask:0xf bank_mask:0xf
    v_add_f32 v61, v61, v4
    v_cvt_pk_bf16_f32 v44, v60, v61
    v_mfma_f32_16x16x32_bf16 v[28:31], a[144:147], v[20:23], 0
    v_mov_b32_dpp v60, v36 quad_perm:[0,0,0,0] row_mask:0xf bank_mask:0xf
    v_mov_b32_dpp v4, v38 quad_perm:[2,2,2,2] row_mask:0xf bank_mask:0xf
    s_nop 0
    v_add_f32_dpp v60, v37, v60 quad_perm:[1,1,1,1] row_mask:0xf bank_mask:0xf
    v_add_f32_dpp v4, v39, v4 quad_perm:[3,3,3,3] row_mask:0xf bank_mask:0xf
    v_add_f32 v60, v60, v4
    buffer_load_dwordx4 v[248:251], v76, s[52:55], s85 offen offset:1024 nt
    v_mfma_f32_16x16x32_bf16 v[32:35], a[148:151], v[20:23], 0
    v_mov_b32_dpp v61, v40 quad_perm:[0,0,0,0] row_mask:0xf bank_mask:0xf
    v_mov_b32_dpp v4, v42 quad_perm:[2,2,2,2] row_mask:0xf bank_mask:0xf
    s_nop 0
    v_add_f32_dpp v61, v41, v61 quad_perm:[1,1,1,1] row_mask:0xf bank_mask:0xf
    v_add_f32_dpp v4, v43, v4 quad_perm:[3,3,3,3] row_mask:0xf bank_mask:0xf
    v_add_f32 v61, v61, v4
    v_cvt_pk_bf16_f32 v45, v60, v61
    v_mfma_f32_16x16x32_bf16 v[36:39], a[152:155], v[20:23], 0
    v_mov_b32_dpp v60, v28 quad_perm:[0,0,0,0] row_mask:0xf bank_mask:0xf
    v_mov_b32_dpp v4, v30 quad_perm:[2,2,2,2] row_mask:0xf bank_mask:0xf
    s_nop 0
    v_add_f32_dpp v60, v29, v60 quad_perm:[1,1,1,1] row_mask:0xf bank_mask:0xf
    v_add_f32_dpp v4, v31, v4 quad_perm:[3,3,3,3] row_mask:0xf bank_mask:0xf
    v_add_f32 v60, v60, v4
    v_mfma_f32_16x16x32_bf16 v[40:43], a[156:159], v[20:23], 0
    v_mov_b32_dpp v61, v32 quad_perm:[0,0,0,0] row_mask:0xf bank_mask:0xf
    v_mov_b32_dpp v4, v34 quad_perm:[2,2,2,2] row_mask:0xf bank_mask:0xf
    s_nop 0
    v_add_f32_dpp v61, v33, v61 quad_perm:[1,1,1,1] row_mask:0xf bank_mask:0xf
    v_add_f32_dpp v4, v35, v4 quad_perm:[3,3,3,3] row_mask:0xf bank_mask:0xf
    v_add_f32 v61, v61, v4
    v_cvt_pk_bf16_f32 v46, v60, v61
    v_mfma_f32_16x16x32_bf16 v[28:31], a[160:163], v[20:23], 0
    v_mov_b32_dpp v60, v36 quad_perm:[0,0,0,0] row_mask:0xf bank_mask:0xf
    v_mov_b32_dpp v4, v38 quad_perm:[2,2,2,2] row_mask:0xf bank_mask:0xf
    s_nop 0
    v_add_f32_dpp v60, v37, v60 quad_perm:[1,1,1,1] row_mask:0xf bank_mask:0xf
    v_add_f32_dpp v4, v39, v4 quad_perm:[3,3,3,3] row_mask:0xf bank_mask:0xf
    v_add_f32 v60, v60, v4
    v_mfma_f32_16x16x32_bf16 v[32:35], a[164:167], v[20:23], 0
    v_mov_b32_dpp v61, v40 quad_perm:[0,0,0,0] row_mask:0xf bank_mask:0xf
    v_mov_b32_dpp v4, v42 quad_perm:[2,2,2,2] row_mask:0xf bank_mask:0xf
    s_nop 0
    v_add_f32_dpp v61, v41, v61 quad_perm:[1,1,1,1] row_mask:0xf bank_mask:0xf
    v_add_f32_dpp v4, v43, v4 quad_perm:[3,3,3,3] row_mask:0xf bank_mask:0xf
    v_add_f32 v61, v61, v4
    v_cvt_pk_bf16_f32 v47, v60, v61
    v_mfma_f32_16x16x32_bf16 v[36:39], a[168:171], v[20:23], 0
    v_mov_b32_dpp v60, v28 quad_perm:[0,0,0,0] row_mask:0xf bank_mask:0xf
    v_mov_b32_dpp v4, v30 quad_perm:[2,2,2,2] row_mask:0xf bank_mask:0xf
    s_nop 0
    v_add_f32_dpp v60, v29, v60 quad_perm:[1,1,1,1] row_mask:0xf bank_mask:0xf
    v_add_f32_dpp v4, v31, v4 quad_perm:[3,3,3,3] row_mask:0xf bank_mask:0xf
    v_add_f32 v60, v60, v4
    v_mfma_f32_16x16x32_bf16 v[40:43], a[172:175], v[20:23], 0
    v_mov_b32_dpp v61, v32 quad_perm:[0,0,0,0] row_mask:0xf bank_mask:0xf
    v_mov_b32_dpp v4, v34 quad_perm:[2,2,2,2] row_mask:0xf bank_mask:0xf
    s_nop 0
    v_add_f32_dpp v61, v33, v61 quad_perm:[1,1,1,1] row_mask:0xf bank_mask:0xf
    v_add_f32_dpp v4, v35, v4 quad_perm:[3,3,3,3] row_mask:0xf bank_mask:0xf
    v_add_f32 v61, v61, v4
    v_cvt_pk_bf16_f32 v48, v60, v61
    v_mfma_f32_16x16x32_bf16 v[28:31], a[176:179], v[20:23], 0
    v_mov_b32_dpp v60, v36 quad_perm:[0,0,0,0] row_mask:0xf bank_mask:0xf
    v_mov_b32_dpp v4, v38 quad_perm:[2,2,2,2] row_mask:0xf bank_mask:0xf
    s_nop 0
    v_add_f32_dpp v60, v37, v60 quad_perm:[1,1,1,1] row_mask:0xf bank_mask:0xf
    v_add_f32_dpp v4, v39, v4 quad_perm:[3,3,3,3] row_mask:0xf bank_mask:0xf
    v_add_f32 v60, v60, v4
    buffer_load_dwordx4 v[252:255], v77, s[52:55], s85 offen offset:1024 nt
    s_add_u32 s87, s87, 7
    s_add_u32 s39, s87, s88
    s_bfe_u32 s37, s39, 0x30000
    s_lshl_b32 s37, s37, 12
    s_add_u32 s85, s37, s89
    s_bfe_u32 s37, s39, 0x10003
    s_lshl_b32 s37, s37, 11
    s_add_u32 s85, s37, s85
    s_bfe_u32 s37, s39, 0x40004
    s_lshl_b32 s37, s37, 16
    s_add_u32 s85, s37, s85
    v_mfma_f32_16x16x32_bf16 v[32:35], a[180:183], v[20:23], 0
    v_mov_b32_dpp v61, v40 quad_perm:[0,0,0,0] row_mask:0xf bank_mask:0xf
    v_mov_b32_dpp v4, v42 quad_perm:[2,2,2,2] row_mask:0xf bank_mask:0xf
    s_nop 0
    v_add_f32_dpp v61, v41, v61 quad_perm:[1,1,1,1] row_mask:0xf bank_mask:0xf
    v_add_f32_dpp v4, v43, v4 quad_perm:[3,3,3,3] row_mask:0xf bank_mask:0xf
    v_add_f32 v61, v61, v4
    v_cvt_pk_bf16_f32 v49, v60, v61
    v_mfma_f32_16x16x32_bf16 v[36:39], a[184:187], v[20:23], 0
    v_mov_b32_dpp v60, v28 quad_perm:[0,0,0,0] row_mask:0xf bank_mask:0xf
    v_mov_b32_dpp v4, v30 quad_perm:[2,2,2,2] row_mask:0xf bank_mask:0xf
    s_nop 0
    v_add_f32_dpp v60, v29, v60 quad_perm:[1,1,1,1] row_mask:0xf bank_mask:0xf
    v_add_f32_dpp v4, v31, v4 quad_perm:[3,3,3,3] row_mask:0xf bank_mask:0xf
    v_add_f32 v60, v60, v4
    v_mfma_f32_16x16x32_bf16 v[40:43], a[188:191], v[20:23], 0
    v_mov_b32_dpp v61, v32 quad_perm:[0,0,0,0] row_mask:0xf bank_mask:0xf
    v_mov_b32_dpp v4, v34 quad_perm:[2,2,2,2] row_mask:0xf bank_mask:0xf
    s_nop 0
    v_add_f32_dpp v61, v33, v61 quad_perm:[1,1,1,1] row_mask:0xf bank_mask:0xf
    v_add_f32_dpp v4, v35, v4 quad_perm:[3,3,3,3] row_mask:0xf bank_mask:0xf
    v_add_f32 v61, v61, v4
    v_cvt_pk_bf16_f32 v50, v60, v61
    v_mfma_f32_16x16x32_bf16 v[28:31], a[192:195], v[20:23], 0
    v_mov_b32_dpp v60, v36 quad_perm:[0,0,0,0] row_mask:0xf bank_mask:0xf
    v_mov_b32_dpp v4, v38 quad_perm:[2,2,2,2] row_mask:0xf bank_mask:0xf
    s_nop 0
    v_add_f32_dpp v60, v37, v60 quad_perm:[1,1,1,1] row_mask:0xf bank_mask:0xf
    v_add_f32_dpp v4, v39, v4 quad_perm:[3,3,3,3] row_mask:0xf bank_mask:0xf
    v_add_f32 v60, v60, v4
    v_mfma_f32_16x16x32_bf16 v[32:35], a[196:199], v[20:23], 0
    v_mov_b32_dpp v61, v40 quad_perm:[0,0,0,0] row_mask:0xf bank_mask:0xf
    v_mov_b32_dpp v4, v42 quad_perm:[2,2,2,2] row_mask:0xf bank_mask:0xf
    s_nop 0
    v_add_f32_dpp v61, v41, v61 quad_perm:[1,1,1,1] row_mask:0xf bank_mask:0xf
    v_add_f32_dpp v4, v43, v4 quad_perm:[3,3,3,3] row_mask:0xf bank_mask:0xf
    v_add_f32 v61, v61, v4
    v_cvt_pk_bf16_f32 v51, v60, v61
    v_mfma_f32_16x16x32_bf16 v[36:39], a[200:203], v[20:23], 0
    v_mov_b32_dpp v60, v28 quad_perm:[0,0,0,0] row_mask:0xf bank_mask:0xf
    v_mov_b32_dpp v4, v30 quad_perm:[2,2,2,2] row_mask:0xf bank_mask:0xf
    s_nop 0
    v_add_f32_dpp v60, v29, v60 quad_perm:[1,1,1,1] row_mask:0xf bank_mask:0xf
    v_add_f32_dpp v4, v31, v4 quad_perm:[3,3,3,3] row_mask:0xf bank_mask:0xf
    v_add_f32 v60, v60, v4
    v_mfma_f32_16x16x32_bf16 v[40:43], a[204:207], v[20:23], 0
    v_mov_b32_dpp v61, v32 quad_perm:[0,0,0,0] row_mask:0xf bank_mask:0xf
    v_mov_b32_dpp v4, v34 quad_perm:[2,2,2,2] row_mask:0xf bank_mask:0xf
    s_nop 0
    v_add_f32_dpp v61, v33, v61 quad_perm:[1,1,1,1] row_mask:0xf bank_mask:0xf
    v_add_f32_dpp v4, v35, v4 quad_perm:[3,3,3,3] row_mask:0xf bank_mask:0xf
    v_add_f32 v61, v61, v4
    v_cvt_pk_bf16_f32 v52, v60, v61
    v_mfma_f32_16x16x32_bf16 v[28:31], a[208:211], v[20:23], 0
    v_mov_b32_dpp v60, v36 quad_perm:[0,0,0,0] row_mask:0xf bank_mask:0xf
    v_mov_b32_dpp v4, v38 quad_perm:[2,2,2,2] row_mask:0xf bank_mask:0xf
    s_nop 0
    v_add_f32_dpp v60, v37, v60 quad_perm:[1,1,1,1] row_mask:0xf bank_mask:0xf
    v_add_f32_dpp v4, v39, v4 quad_perm:[3,3,3,3] row_mask:0xf bank_mask:0xf
    v_add_f32 v60, v60, v4
    buffer_load_dwordx4 a[0:3], v76, s[52:55], s85 offen offset:0 nt
    v_mfma_f32_16x16x32_bf16 v[32:35], a[212:215], v[20:23], 0
    v_mov_b32_dpp v61, v40 quad_perm:[0,0,0,0] row_mask:0xf bank_mask:0xf
    v_mov_b32_dpp v4, v42 quad_perm:[2,2,2,2] row_mask:0xf bank_mask:0xf
    s_nop 0
    v_add_f32_dpp v61, v41, v61 quad_perm:[1,1,1,1] row_mask:0xf bank_mask:0xf
    v_add_f32_dpp v4, v43, v4 quad_perm:[3,3,3,3] row_mask:0xf bank_mask:0xf
    v_add_f32 v61, v61, v4
    v_cvt_pk_bf16_f32 v53, v60, v61
    v_mfma_f32_16x16x32_bf16 v[36:39], a[216:219], v[20:23], 0
    v_mov_b32_dpp v60, v28 quad_perm:[0,0,0,0] row_mask:0xf bank_mask:0xf
    v_mov_b32_dpp v4, v30 quad_perm:[2,2,2,2] row_mask:0xf bank_mask:0xf
    s_nop 0
    v_add_f32_dpp v60, v29, v60 quad_perm:[1,1,1,1] row_mask:0xf bank_mask:0xf
    v_add_f32_dpp v4, v31, v4 quad_perm:[3,3,3,3] row_mask:0xf bank_mask:0xf
    v_add_f32 v60, v60, v4
    v_mfma_f32_16x16x32_bf16 v[40:43], a[220:223], v[20:23], 0
    v_mov_b32_dpp v61, v32 quad_perm:[0,0,0,0] row_mask:0xf bank_mask:0xf
    v_mov_b32_dpp v4, v34 quad_perm:[2,2,2,2] row_mask:0xf bank_mask:0xf
    s_nop 0
    v_add_f32_dpp v61, v33, v61 quad_perm:[1,1,1,1] row_mask:0xf bank_mask:0xf
    v_add_f32_dpp v4, v35, v4 quad_perm:[3,3,3,3] row_mask:0xf bank_mask:0xf
    v_add_f32 v61, v61, v4
    v_cvt_pk_bf16_f32 v54, v60, v61
    v_mfma_f32_16x16x32_bf16 v[28:31], a[224:227], v[20:23], 0
    v_mov_b32_dpp v60, v36 quad_perm:[0,0,0,0] row_mask:0xf bank_mask:0xf
    v_mov_b32_dpp v4, v38 quad_perm:[2,2,2,2] row_mask:0xf bank_mask:0xf
    s_nop 0
    v_add_f32_dpp v60, v37, v60 quad_perm:[1,1,1,1] row_mask:0xf bank_mask:0xf
    v_add_f32_dpp v4, v39, v4 quad_perm:[3,3,3,3] row_mask:0xf bank_mask:0xf
    v_add_f32 v60, v60, v4
    v_mfma_f32_16x16x32_bf16 v[32:35], a[228:231], v[20:23], 0
    v_mov_b32_dpp v61, v40 quad_perm:[0,0,0,0] row_mask:0xf bank_mask:0xf
    v_mov_b32_dpp v4, v42 quad_perm:[2,2,2,2] row_mask:0xf bank_mask:0xf
    s_nop 0
    v_add_f32_dpp v61, v41, v61 quad_perm:[1,1,1,1] row_mask:0xf bank_mask:0xf
    v_add_f32_dpp v4, v43, v4 quad_perm:[3,3,3,3] row_mask:0xf bank_mask:0xf
    v_add_f32 v61, v61, v4
    v_cvt_pk_bf16_f32 v55, v60, v61
    v_mfma_f32_16x16x32_bf16 v[36:39], a[232:235], v[20:23], 0
    v_mov_b32_dpp v60, v28 quad_perm:[0,0,0,0] row_mask:0xf bank_mask:0xf
    v_mov_b32_dpp v4, v30 quad_perm:[2,2,2,2] row_mask:0xf bank_mask:0xf
    s_nop 0
    v_add_f32_dpp v60, v29, v60 quad_perm:[1,1,1,1] row_mask:0xf bank_mask:0xf
    v_add_f32_dpp v4, v31, v4 quad_perm:[3,3,3,3] row_mask:0xf bank_mask:0xf
    v_add_f32 v60, v60, v4
    v_mfma_f32_16x16x32_bf16 v[40:43], a[236:239], v[20:23], 0
    v_mov_b32_dpp v61, v32 quad_perm:[0,0,0,0] row_mask:0xf bank_mask:0xf
    v_mov_b32_dpp v4, v34 quad_perm:[2,2,2,2] row_mask:0xf bank_mask:0xf
    s_nop 0
    v_add_f32_dpp v61, v33, v61 quad_perm:[1,1,1,1] row_mask:0xf bank_mask:0xf
    v_add_f32_dpp v4, v35, v4 quad_perm:[3,3,3,3] row_mask:0xf bank_mask:0xf
    v_add_f32 v61, v61, v4
    v_cvt_pk_bf16_f32 v56, v60, v61
    v_mfma_f32_16x16x32_bf16 v[28:31], a[240:243], v[20:23], 0
    v_mov_b32_dpp v60, v36 quad_perm:[0,0,0,0] row_mask:0xf bank_mask:0xf
    v_mov_b32_dpp v4, v38 quad_perm:[2,2,2,2] row_mask:0xf bank_mask:0xf
    s_nop 0
    v_add_f32_dpp v60, v37, v60 quad_perm:[1,1,1,1] row_mask:0xf bank_mask:0xf
    v_add_f32_dpp v4, v39, v4 quad_perm:[3,3,3,3] row_mask:0xf bank_mask:0xf
    v_add_f32 v60, v60, v4
    buffer_load_dwordx4 a[4:7], v77, s[52:55], s85 offen offset:0 nt
    v_mfma_f32_16x16x32_bf16 v[32:35], a[244:247], v[20:23], 0
    v_mov_b32_dpp v61, v40 quad_perm:[0,0,0,0] row_mask:0xf bank_mask:0xf
    v_mov_b32_dpp v4, v42 quad_perm:[2,2,2,2] row_mask:0xf bank_mask:0xf
    s_nop 0
    v_add_f32_dpp v61, v41, v61 quad_perm:[1,1,1,1] row_mask:0xf bank_mask:0xf
    v_add_f32_dpp v4, v43, v4 quad_perm:[3,3,3,3] row_mask:0xf bank_mask:0xf
    v_add_f32 v61, v61, v4
    v_cvt_pk_bf16_f32 v57, v60, v61
    v_mfma_f32_16x16x32_bf16 v[36:39], a[248:251], v[20:23], 0
    v_mov_b32_dpp v60, v28 quad_perm:[0,0,0,0] row_mask:0xf bank_mask:0xf
    v_mov_b32_dpp v4, v30 quad_perm:[2,2,2,2] row_mask:0xf bank_mask:0xf
    s_nop 0
    v_add_f32_dpp v60, v29, v60 quad_perm:[1,1,1,1] row_mask:0xf bank_mask:0xf
    v_add_f32_dpp v4, v31, v4 quad_perm:[3,3,3,3] row_mask:0xf bank_mask:0xf
    v_add_f32 v60, v60, v4
    v_mfma_f32_16x16x32_bf16 v[40:43], a[252:255], v[20:23], 0
    v_mov_b32_dpp v61, v32 quad_perm:[0,0,0,0] row_mask:0xf bank_mask:0xf
    v_mov_b32_dpp v4, v34 quad_perm:[2,2,2,2] row_mask:0xf bank_mask:0xf
    s_nop 0
    v_add_f32_dpp v61, v33, v61 quad_perm:[1,1,1,1] row_mask:0xf bank_mask:0xf
    v_add_f32_dpp v4, v35, v4 quad_perm:[3,3,3,3] row_mask:0xf bank_mask:0xf
    v_add_f32 v61, v61, v4
    v_cvt_pk_bf16_f32 v58, v60, v61
    v_mov_b32_dpp v60, v36 quad_perm:[0,0,0,0] row_mask:0xf bank_mask:0xf
    v_mov_b32_dpp v4, v38 quad_perm:[2,2,2,2] row_mask:0xf bank_mask:0xf
    s_nop 0
    v_add_f32_dpp v60, v37, v60 quad_perm:[1,1,1,1] row_mask:0xf bank_mask:0xf
    v_add_f32_dpp v4, v39, v4 quad_perm:[3,3,3,3] row_mask:0xf bank_mask:0xf
    v_add_f32 v60, v60, v4
    v_mov_b32_dpp v61, v40 quad_perm:[0,0,0,0] row_mask:0xf bank_mask:0xf
    v_mov_b32_dpp v4, v42 quad_perm:[2,2,2,2] row_mask:0xf bank_mask:0xf
    s_nop 0
    v_add_f32_dpp v61, v41, v61 quad_perm:[1,1,1,1] row_mask:0xf bank_mask:0xf
    v_add_f32_dpp v4, v43, v4 quad_perm:[3,3,3,3] row_mask:0xf bank_mask:0xf
    v_add_f32 v61, v61, v4
    v_cvt_pk_bf16_f32 v59, v60, v61
    s_mov_b32 exec_lo, 0x22222222
    s_mov_b32 exec_hi, 0x22222222
    v_mov_b32 v44, v48
    v_mov_b32 v45, v49
    v_mov_b32 v46, v50
    v_mov_b32 v47, v51
    s_mov_b32 exec_lo, 0x44444444
    s_mov_b32 exec_hi, 0x44444444
    v_mov_b32 v44, v52
    v_mov_b32 v45, v53
    v_mov_b32 v46, v54
    v_mov_b32 v47, v55
    s_mov_b32 exec_lo, 0x88888888
    s_mov_b32 exec_hi, 0x88888888
    v_mov_b32 v44, v56
    v_mov_b32 v45, v57
    v_mov_b32 v46, v58
    v_mov_b32 v47, v59
    s_mov_b64 exec, -1
    buffer_store_dwordx4 v[44:47], v19, s[48:51], s94 offen sc1
    s_waitcnt vmcnt(5)
L_qcheck_21:
    v_xor_b32 v68, s35, v68
    v_xor_b32 v69, s35, v69
    v_xor_b32 v70, s35, v70
    v_xor_b32 v71, s35, v71
    v_xor_b32 v72, s35, v72
    v_xor_b32 v73, s35, v73
    v_xor_b32 v74, s35, v74
    v_xor_b32 v75, s35, v75
    v_or_b32 v4, v68, v69
    v_or3_b32 v4, v4, v70, v71
    v_or3_b32 v4, v4, v72, v73
    v_or3_b32 v4, v4, v74, v75
    v_and_b32 v4, 0xff, v4
    v_cmp_ne_u32 vcc, 0, v4
    s_cbranch_vccz L_qok_22
    buffer_load_dwordx4 v[68:71], v78, s[48:51], s91 offen offset:0 sc1
    buffer_load_dwordx4 v[72:75], v78, s[48:51], s91 offen offset:16 sc1
    s_waitcnt vmcnt(0)
    s_sub_u32 s84, s84, 1
    s_cmp_lg_u32 s84, 0
    s_cbranch_scc1 L_qcheck_21
    s_branch L_end
L_qok_22:
    v_cvt_pk_bf16_f32 v68, v68, v69
    v_cvt_pk_bf16_f32 v69, v70, v71
    v_cvt_pk_bf16_f32 v70, v72, v73
    v_cvt_pk_bf16_f32 v71, v74, v75
    s_mov_b32 vcc_lo, 0xf000f
    s_mov_b32 vcc_hi, 0xf000f
    v_cndmask_b32 v80, 0, v68, vcc
    v_cndmask_b32 v81, 0, v69, vcc
    v_cndmask_b32 v82, 0, v70, vcc
    v_cndmask_b32 v83, 0, v71, vcc
    s_mov_b32 vcc_lo, 0xf000f0
    s_mov_b32 vcc_hi, 0xf000f0
    v_cndmask_b32 v84, 0, v68, vcc
    v_cndmask_b32 v85, 0, v69, vcc
    v_cndmask_b32 v86, 0, v70, vcc
    v_cndmask_b32 v87, 0, v71, vcc
    s_mov_b32 vcc_lo, 0xf000f00
    s_mov_b32 vcc_hi, 0xf000f00
    v_cndmask_b32 v88, 0, v68, vcc
    v_cndmask_b32 v89, 0, v69, vcc
    v_cndmask_b32 v90, 0, v70, vcc
    v_cndmask_b32 v91, 0, v71, vcc
    s_mov_b32 vcc_lo, 0xf000f000
    s_mov_b32 vcc_hi, 0xf000f000
    v_cndmask_b32 v92, 0, v68, vcc
    v_cndmask_b32 v93, 0, v69, vcc
    v_cndmask_b32 v94, 0, v70, vcc
    v_cndmask_b32 v95, 0, v71, vcc
    v_mov_b32 v65, 0xff7f0000
    s_lshl_b32 s38, s34, 14
    s_add_u32 s38, s38, 16384
    v_lshl_add_u32 v64, v1, 2, s38
    buffer_load_dwordx4 a[8:11], v76, s[52:55], s85 offen offset:1024 nt
    v_mfma_f32_16x16x32_bf16 v[112:115], v[128:131], v[80:83], 0
    v_mfma_f32_16x16x32_bf16 v[112:115], v[132:135], v[84:87], v[112:115]
    buffer_load_dwordx4 a[12:15], v77, s[52:55], s85 offen offset:1024 nt
    s_add_u32 s87, s87, 7
    s_add_u32 s39, s87, s88
    s_bfe_u32 s37, s39, 0x30000
    s_lshl_b32 s37, s37, 12
    s_add_u32 s85, s37, s89
    s_bfe_u32 s37, s39, 0x10003
    s_lshl_b32 s37, s37, 11
    s_add_u32 s85, s37, s85
    s_bfe_u32 s37, s39, 0x40004
    s_lshl_b32 s37, s37, 16
    s_add_u32 s85, s37, s85
    v_mfma_f32_16x16x32_bf16 v[112:115], v[136:139], v[88:91], v[112:115]
    v_mfma_f32_16x16x32_bf16 v[112:115], v[140:143], v[92:95], v[112:115]
    buffer_load_dwordx4 a[16:19], v76, s[52:55], s85 offen offset:0 nt
    v_mfma_f32_16x16x32_bf16 v[96:99], v[144:147], v[80:83], 0
    v_mfma_f32_16x16x32_bf16 v[96:99], v[148:151], v[84:87], v[96:99]
    v_mfma_f32_16x16x32_bf16 v[96:99], v[152:155], v[88:91], v[96:99]
    s_nop 3
    v_mov_b32_dpp v122, v112 quad_perm:[0,0,0,0] row_mask:0xf bank_mask:0xf
    v_mov_b32_dpp v124, v114 quad_perm:[2,2,2,2] row_mask:0xf bank_mask:0xf
    s_nop 0
    v_add_f32_dpp v122, v113, v122 quad_perm:[1,1,1,1] row_mask:0xf bank_mask:0xf
    v_add_f32_dpp v124, v115, v124 quad_perm:[3,3,3,3] row_mask:0xf bank_mask:0xf
    v_add_f32 v122, v122, v124
    v_max_f32 v65, v65, v122
    ds_write_b32 v64, v122 offset:0
    s_waitcnt vmcnt(7)
    buffer_load_dwordx4 a[20:23], v77, s[52:55], s85 offen offset:0 nt
    v_mfma_f32_16x16x32_bf16 v[96:99], v[156:159], v[92:95], v[96:99]
    v_mfma_f32_16x16x32_bf16 v[112:115], v[160:163], v[80:83], 0
    s_waitcnt vmcnt(7)
    buffer_load_dwordx4 a[24:27], v76, s[52:55], s85 offen offset:1024 nt
    v_mfma_f32_16x16x32_bf16 v[112:115], v[164:167], v[84:87], v[112:115]
    v_mfma_f32_16x16x32_bf16 v[112:115], v[168:171], v[88:91], v[112:115]
    s_nop 2
    v_mov_b32_dpp v122, v96 quad_perm:[0,0,0,0] row_mask:0xf bank_mask:0xf
    v_mov_b32_dpp v124, v98 quad_perm:[2,2,2,2] row_mask:0xf bank_mask:0xf
    s_nop 0
    v_add_f32_dpp v122, v97, v122 quad_perm:[1,1,1,1] row_mask:0xf bank_mask:0xf
    v_add_f32_dpp v124, v99, v124 quad_perm:[3,3,3,3] row_mask:0xf bank_mask:0xf
    v_add_f32 v122, v122, v124
    v_max_f32 v65, v65, v122
    ds_write_b32 v64, v122 offset:256
    v_mfma_f32_16x16x32_bf16 v[112:115], v[172:175], v[92:95], v[112:115]
    s_waitcnt vmcnt(7)
    buffer_load_dwordx4 a[28:31], v77, s[52:55], s85 offen offset:1024 nt
    s_add_u32 s87, s87, 7
    s_add_u32 s39, s87, s88
    s_bfe_u32 s37, s39, 0x30000
    s_lshl_b32 s37, s37, 12
    s_add_u32 s85, s37, s89
    s_bfe_u32 s37, s39, 0x10003
    s_lshl_b32 s37, s37, 11
    s_add_u32 s85, s37, s85
    s_bfe_u32 s37, s39, 0x40004
    s_lshl_b32 s37, s37, 16
    s_add_u32 s85, s37, s85
    v_mfma_f32_16x16x32_bf16 v[96:99], v[176:179], v[80:83], 0
    v_mfma_f32_16x16x32_bf16 v[96:99], v[180:183], v[84:87], v[96:99]
    s_waitcnt vmcnt(7)
    buffer_load_dwordx4 a[32:35], v76, s[52:55], s85 offen offset:0 nt
    v_mfma_f32_16x16x32_bf16 v[96:99], v[184:187], v[88:91], v[96:99]
    v_mov_b32_dpp v122, v112 quad_perm:[0,0,0,0] row_mask:0xf bank_mask:0xf
    v_mov_b32_dpp v124, v114 quad_perm:[2,2,2,2] row_mask:0xf bank_mask:0xf
    s_nop 0
    v_add_f32_dpp v122, v113, v122 quad_perm:[1,1,1,1] row_mask:0xf bank_mask:0xf
    v_add_f32_dpp v124, v115, v124 quad_perm:[3,3,3,3] row_mask:0xf bank_mask:0xf
    v_add_f32 v122, v122, v124
    v_max_f32 v65, v65, v122
    ds_write_b32 v64, v122 offset:512
    v_mfma_f32_16x16x32_bf16 v[96:99], v[188:191], v[92:95], v[96:99]
    s_lshl_b32 s38, s61, 8
    s_add_u32 s69, s38, 98304
    s_lshl_b32 s38, s60, 13
    s_add_u32 s69, s38, s69
    v_mov_b32 v48, s69
    v_mov_b32 v49, s68
    s_waitcnt vmcnt(7)
    s_mov_b64 exec, 1
    buffer_store_dword v49, v48, s[48:51], 0 offen sc1
    s_mov_b64 exec, -1
    s_waitcnt vmcnt(7)
    buffer_load_dwordx4 a[36:39], v77, s[52:55], s85 offen offset:0 nt
    v_mfma_f32_16x16x32_bf16 v[112:115], v[192:195], v[80:83], 0
    v_mfma_f32_16x16x32_bf16 v[112:115], v[196:199], v[84:87], v[112:115]
    v_mfma_f32_16x16x32_bf16 v[112:115], v[200:203], v[88:91], v[112:115]
    v_mov_b32_dpp v122, v96 quad_perm:[0,0,0,0] row_mask:0xf bank_mask:0xf
    v_mov_b32_dpp v124, v98 quad_perm:[2,2,2,2] row_mask:0xf bank_mask:0xf
    s_nop 0
    v_add_f32_dpp v122, v97, v122 quad_perm:[1,1,1,1] row_mask:0xf bank_mask:0xf
    v_add_f32_dpp v124, v99, v124 quad_perm:[3,3,3,3] row_mask:0xf bank_mask:0xf
    v_add_f32 v122, v122, v124
    v_max_f32 v65, v65, v122
    ds_write_b32 v64, v122 offset:768
    s_waitcnt vmcnt(7)
    buffer_load_dwordx4 a[40:43], v76, s[52:55], s85 offen offset:1024 nt
    v_mfma_f32_16x16x32_bf16 v[112:115], v[204:207], v[92:95], v[112:115]
    v_mfma_f32_16x16x32_bf16 v[96:99], v[208:211], v[80:83], 0
    s_waitcnt vmcnt(7)
    buffer_load_dwordx4 a[44:47], v77, s[52:55], s85 offen offset:1024 nt
    s_add_u32 s87, s87, 7
    s_add_u32 s39, s87, s88
    s_bfe_u32 s37, s39, 0x30000
    s_lshl_b32 s37, s37, 12
    s_add_u32 s85, s37, s89
    s_bfe_u32 s37, s39, 0x10003
    s_lshl_b32 s37, s37, 11
    s_add_u32 s85, s37, s85
    s_bfe_u32 s37, s39, 0x40004
    s_lshl_b32 s37, s37, 16
    s_add_u32 s85, s37, s85
    v_mfma_f32_16x16x32_bf16 v[96:99], v[212:215], v[84:87], v[96:99]
    v_mfma_f32_16x16x32_bf16 v[96:99], v[216:219], v[88:91], v[96:99]
    v_mov_b32_dpp v122, v112 quad_perm:[0,0,0,0] row_mask:0xf bank_mask:0xf
    v_mov_b32_dpp v124, v114 quad_perm:[2,2,2,2] row_mask:0xf bank_mask:0xf
    s_nop 0
    v_add_f32_dpp v122, v113, v122 quad_perm:[1,1,1,1] row_mask:0xf bank_mask:0xf
    v_add_f32_dpp v124, v115, v124 quad_perm:[3,3,3,3] row_mask:0xf bank_mask:0xf
    v_add_f32 v122, v122, v124
    v_max_f32 v65, v65, v122
    ds_write_b32 v64, v122 offset:1024
    v_mfma_f32_16x16x32_bf16 v[96:99], v[220:223], v[92:95], v[96:99]
    s_waitcnt vmcnt(7)
    buffer_load_dwordx4 a[48:51], v76, s[52:55], s85 offen offset:0 nt
    v_mfma_f32_16x16x32_bf16 v[112:115], v[224:227], v[80:83], 0
    s_sub_u32 s36, s33, 3
    s_and_b32 s37, s33, 3
    s_cmp_lt_u32 s36, 4
    s_cselect_b64 s[40:41], s[24:25], s[14:15]
    s_cselect_b32 s36, s36, s37
    s_cselect_b32 s45, 262144, 0
    s_cselect_b32 s46, 8388608, 0
    s_add_u32 s45, s45, 524288
    s_add_u32 s46, s46, 196608
    s_mov_b32 s42, 4194304
    s_mov_b32 s43, 0x20000
    s_lshl_b32 s38, s32, 17
    s_add_u32 s44, s38, 0
    s_lshl_b32 s38, s34, 15
    s_add_u32 s44, s38, s44
    s_lshl_b32 s38, s36, 8
    s_add_u32 s44, s38, s44
    s_lshl_b32 s38, s36, 16
    s_add_u32 s45, s38, s45
    s_lshr_b32 s38, s34, 1
    s_lshl_b32 s38, s38, 15
    s_add_u32 s45, s38, s45
    s_lshl_b32 s38, s32, 8
    s_add_u32 s45, s38, s45
    s_bfe_u32 s38, s34, 0x10000
    s_lshl_b32 s38, s38, 7
    s_add_u32 s45, s38, s45
    s_lshl_b32 s38, s32, 11
    s_add_u32 s46, s38, s46
    s_lshl_b32 s38, s34, 9
    s_add_u32 s46, s38, s46
    s_mov_b32 s72, s26
    s_and_b32 s73, s27, 0xffff
    s_mov_b32 s74, 8192
    s_mov_b32 s75, 0x20000
    v_mfma_f32_16x16x32_bf16 v[112:115], v[228:231], v[84:87], v[112:115]
    s_waitcnt vmcnt(7)
    buffer_load_dwordx4 a[52:55], v77, s[52:55], s85 offen offset:0 nt
    v_mfma_f32_16x16x32_bf16 v[112:115], v[232:235], v[88:91], v[112:115]
    v_mov_b32_dpp v122, v96 quad_perm:[0,0,0,0] row_mask:0xf bank_mask:0xf
    v_mov_b32_dpp v124, v98 quad_perm:[2,2,2,2] row_mask:0xf bank_mask:0xf
    s_nop 0
    v_add_f32_dpp v122, v97, v122 quad_perm:[1,1,1,1] row_mask:0xf bank_mask:0xf
    v_add_f32_dpp v124, v99, v124 quad_perm:[3,3,3,3] row_mask:0xf bank_mask:0xf
    v_add_f32 v122, v122, v124
    v_max_f32 v65, v65, v122
    ds_write_b32 v64, v122 offset:1280
    v_mfma_f32_16x16x32_bf16 v[112:115], v[236:239], v[92:95], v[112:115]
    s_waitcnt vmcnt(7)
    buffer_load_dwordx4 a[56:59], v76, s[52:55], s85 offen offset:1024 nt
    v_mfma_f32_16x16x32_bf16 v[96:99], v[240:243], v[80:83], 0
    v_mfma_f32_16x16x32_bf16 v[96:99], v[244:247], v[84:87], v[96:99]
    v_mfma_f32_16x16x32_bf16 v[96:99], v[248:251], v[88:91], v[96:99]
    s_nop 2
    v_mov_b32_dpp v122, v112 quad_perm:[0,0,0,0] row_mask:0xf bank_mask:0xf
    v_mov_b32_dpp v124, v114 quad_perm:[2,2,2,2] row_mask:0xf bank_mask:0xf
    s_nop 0
    v_add_f32_dpp v122, v113, v122 quad_perm:[1,1,1,1] row_mask:0xf bank_mask:0xf
    v_add_f32_dpp v124, v115, v124 quad_perm:[3,3,3,3] row_mask:0xf bank_mask:0xf
    v_add_f32 v122, v122, v124
    v_max_f32 v65, v65, v122
    ds_write_b32 v64, v122 offset:1536
    v_lshlrev_b32 v4, 2, v2
    v_xor_b32 v4, v4, v3
    v_xor_b32 v5, 0, v4
    v_lshlrev_b32 v5, 4, v5
    v_lshl_add_u32 v20, v2, 10, v5
    v_xor_b32 v5, 1, v4
    v_lshlrev_b32 v5, 4, v5
    v_lshl_add_u32 v21, v2, 10, v5
    v_add_u32 v21, 3072, v21
    v_xor_b32 v5, 2, v4
    v_lshlrev_b32 v5, 4, v5
    v_lshl_add_u32 v22, v2, 10, v5
    v_add_u32 v22, 6144, v22
    v_xor_b32 v5, 3, v4
    v_lshlrev_b32 v5, 4, v5
    v_lshl_add_u32 v23, v2, 10, v5
    v_add_u32 v23, 9216, v23
    s_lshl_b32 s38, s32, 15
    s_add_u32 s47, s38, 1048576
    s_lshl_b32 s38, s3, 13
    s_add_u32 s47, s38, s47
    s_mul_i32 s38, s3, 320
    s_add_u32 s38, s38, 135168
    v_lshlrev_b32 v4, 6, v2
    v_lshl_add_u32 v4, v3, 1, v4
    v_add_u32 v31, s38, v4
    s_waitcnt vmcnt(7)
    buffer_load_dwordx4 a[60:63], v77, s[52:55], s85 offen offset:1024 nt
    s_add_u32 s87, s87, 7
    s_add_u32 s39, s87, s88
    s_bfe_u32 s37, s39, 0x30000
    s_lshl_b32 s37, s37, 12
    s_add_u32 s85, s37, s89
    s_bfe_u32 s37, s39, 0x10003
    s_lshl_b32 s37, s37, 11
    s_add_u32 s85, s37, s85
    s_bfe_u32 s37, s39, 0x40004
    s_lshl_b32 s37, s37, 16
    s_add_u32 s85, s37, s85
    v_mfma_f32_16x16x32_bf16 v[96:99], v[252:255], v[92:95], v[96:99]
    v_mfma_f32_16x16x32_bf16 v[112:115], a[0:3], v[80:83], 0
    s_waitcnt vmcnt(5)
    buffer_load_dwordx4 v[128:131], v76, s[52:55], s85 offen offset:0 nt
    v_mfma_f32_16x16x32_bf16 v[112:115], a[4:7], v[84:87], v[112:115]
    v_mfma_f32_16x16x32_bf16 v[112:115], a[8:11], v[88:91], v[112:115]
    s_nop 2
    v_mov_b32_dpp v122, v96 quad_perm:[0,0,0,0] row_mask:0xf bank_mask:0xf
    v_mov_b32_dpp v124, v98 quad_perm:[2,2,2,2] row_mask:0xf bank_mask:0xf
    s_nop 0
    v_add_f32_dpp v122, v97, v122 quad_perm:[1,1,1,1] row_mask:0xf bank_mask:0xf
    v_add_f32_dpp v124, v99, v124 quad_perm:[3,3,3,3] row_mask:0xf bank_mask:0xf
    v_add_f32 v122, v122, v124
    v_max_f32 v65, v65, v122
    ds_write_b32 v64, v122 offset:1792
    v_mfma_f32_16x16x32_bf16 v[112:115], a[12:15], v[92:95], v[112:115]
    s_waitcnt vmcnt(5)
    buffer_load_dwordx4 v[132:135], v77, s[52:55], s85 offen offset:0 nt
    v_mfma_f32_16x16x32_bf16 v[96:99], a[16:19], v[80:83], 0
    v_lshlrev_b32 v4, 11, v2
    v_bfe_u32 v5, v1, 2, 2
    v_lshl_add_u32 v4, v5, 8, v4
    v_bfe_u32 v5, v1, 2, 2
    v_lshl_add_u32 v4, v5, 6, v4
    v_bfe_u32 v5, v1, 4, 1
    v_lshl_add_u32 v4, v5, 5, v4
    v_bfe_u32 v5, v1, 1, 1
    v_lshl_add_u32 v4, v5, 4, v4
    v_bfe_u32 v5, v1, 0, 1
    v_lshl_add_u32 v4, v5, 3, v4
    s_lshl_b32 s38, s34, 6
    s_add_u32 s38, s38, 98304
    v_xor_b32 v24, s38, v4
    v_xor_b32 v25, 16, v24
    v_xor_b32 v26, 32, v24
    v_xor_b32 v27, 48, v24
    v_and_b32 v4, 3, v3
    v_lshrrev_b32 v5, 2, v3
    v_lshlrev_b32 v6, 4, v2
    v_add_u32 v6, 135168, v6
    s_movk_i32 s36, 320
    v_cmp_eq_u32 vcc, 0, v5
    s_nop 1
    v_cndmask_b32 v28, 4, v4, vcc
    v_mad_u32_u24 v28, v28, s36, v6
    v_cmp_eq_u32 vcc, 1, v5
    s_nop 1
    v_cndmask_b32 v29, 4, v4, vcc
    v_mad_u32_u24 v29, v29, s36, v6
    v_lshlrev_b32 v5, 2, v1
    v_add_u32 v5, 136448, v5
    v_mov_b32 v6, 0
    ds_write_b32 v5, v6
    v_mfma_f32_16x16x32_bf16 v[96:99], a[20:23], v[84:87], v[96:99]
    s_waitcnt vmcnt(5)
    buffer_load_dwordx4 v[136:139], v76, s[52:55], s85 offen offset:1024 nt
    v_mfma_f32_16x16x32_bf16 v[96:99], a[24:27], v[88:91], v[96:99]
    v_mov_b32_dpp v122, v112 quad_perm:[0,0,0,0] row_mask:0xf bank_mask:0xf
    v_mov_b32_dpp v124, v114 quad_perm:[2,2,2,2] row_mask:0xf bank_mask:0xf
    s_nop 0
    v_add_f32_dpp v122, v113, v122 quad_perm:[1,1,1,1] row_mask:0xf bank_mask:0xf
    v_add_f32_dpp v124, v115, v124 quad_perm:[3,3,3,3] row_mask:0xf bank_mask:0xf
    v_add_f32 v122, v122, v124
    v_max_f32 v65, v65, v122
    ds_write_b32 v64, v122 offset:2048
    v_mfma_f32_16x16x32_bf16 v[96:99], a[28:31], v[92:95], v[96:99]
    s_waitcnt vmcnt(5)
    buffer_load_dwordx4 v[140:143], v77, s[52:55], s85 offen offset:1024 nt
    s_add_u32 s87, s87, 7
    s_add_u32 s39, s87, s88
    s_bfe_u32 s37, s39, 0x30000
    s_lshl_b32 s37, s37, 12
    s_add_u32 s85, s37, s89
    s_bfe_u32 s37, s39, 0x10003
    s_lshl_b32 s37, s37, 11
    s_add_u32 s85, s37, s85
    s_bfe_u32 s37, s39, 0x40004
    s_lshl_b32 s37, s37, 16
    s_add_u32 s85, s37, s85
    v_mfma_f32_16x16x32_bf16 v[112:115], a[32:35], v[80:83], 0
    v_mfma_f32_16x16x32_bf16 v[112:115], a[36:39], v[84:87], v[112:115]
    v_mfma_f32_16x16x32_bf16 v[112:115], a[40:43], v[88:91], v[112:115]
    v_mov_b32_dpp v122, v96 quad_perm:[0,0,0,0] row_mask:0xf bank_mask:0xf
    v_mov_b32_dpp v124, v98 quad_perm:[2,2,2,2] row_mask:0xf bank_mask:0xf
    s_nop 0
    v_add_f32_dpp v122, v97, v122 quad_perm:[1,1,1,1] row_mask:0xf bank_mask:0xf
    v_add_f32_dpp v124, v99, v124 quad_perm:[3,3,3,3] row_mask:0xf bank_mask:0xf
    v_add_f32 v122, v122, v124
    v_max_f32 v65, v65, v122
    ds_write_b32 v64, v122 offset:2304
    v_lshlrev_b32 v30, 4, v3
    v_lshl_add_u32 v30, v2, 13, v30
    s_lshl_b32 s38, s32, 13
    s_add_u32 s36, s38, 0
    s_lshl_b32 s38, s34, 6
    s_add_u32 s36, s38, s36
    v_lshrrev_b32 v5, 2, v1
    v_lshlrev_b32 v32, 8, v5
    v_bfe_u32 v5, v1, 0, 2
    v_lshl_add_u32 v32, v5, 4, v32
    v_add_u32 v32, s36, v32
    s_lshr_b32 s38, s32, 2
    s_lshl_b32 s38, s38, 7
    s_add_u32 s36, s38, 0
    s_lshl_b32 s38, s34, 5
    s_add_u32 s36, s38, s36
    s_bfe_u32 s38, s32, 0x20000
    s_lshl_b32 s38, s38, 3
    s_add_u32 s36, s38, s36
    v_bfe_u32 v5, v1, 0, 2
    v_lshlrev_b32 v33, 11, v5
    v_lshl_add_u32 v33, v2, 1, v33
    v_add_u32 v33, s36, v33
    v_and_b32 v5, 31, v1
    v_lshlrev_b32 v34, 4, v5
    s_mul_i32 s38, s34, 320
    s_add_u32 s38, s38, 135168
    v_lshl_add_u32 v35, v5, 3, s38
    s_waitcnt vmcnt(5)
    buffer_load_dwordx4 v[144:147], v76, s[52:55], s85 offen offset:0 nt
    v_mfma_f32_16x16x32_bf16 v[112:115], a[44:47], v[92:95], v[112:115]
    v_mfma_f32_16x16x32_bf16 v[96:99], a[48:51], v[80:83], 0
    s_waitcnt vmcnt(5)
    buffer_load_dwordx4 v[148:151], v77, s[52:55], s85 offen offset:0 nt
    v_mfma_f32_16x16x32_bf16 v[96:99], a[52:55], v[84:87], v[96:99]
    v_mfma_f32_16x16x32_bf16 v[96:99], a[56:59], v[88:91], v[96:99]
    s_nop 2
    v_mov_b32_dpp v122, v112 quad_perm:[0,0,0,0] row_mask:0xf bank_mask:0xf
    v_mov_b32_dpp v124, v114 quad_perm:[2,2,2,2] row_mask:0xf bank_mask:0xf
    s_nop 0
    v_add_f32_dpp v122, v113, v122 quad_perm:[1,1,1,1] row_mask:0xf bank_mask:0xf
    v_add_f32_dpp v124, v115, v124 quad_perm:[3,3,3,3] row_mask:0xf bank_mask:0xf
    v_add_f32 v122, v122, v124
    v_max_f32 v65, v65, v122
    ds_write_b32 v64, v122 offset:2560
    v_mfma_f32_16x16x32_bf16 v[96:99], a[60:63], v[92:95], v[96:99]
    v_add_u32 v64, 2816, v64
    s_mov_b32 s97, 10
    s_mov_b32 s86, 32
    s_and_b32 s36, s32, 3
    s_sub_u32 s80, s36, 2
    s_cmp_ge_u32 s36, 2
    s_cselect_b32 s80, s80, 8
    s_cselect_b32 s81, 27, 25
    s_cmp_eq_u32 s80, s33
    s_cselect_b32 s36, 2, 0
    s_sub_u32 s86, s86, s36
    s_lshr_b32 s36, s36, 1
    s_sub_u32 s97, s97, s36
    s_add_u32 s80, s80, 35
    s_sub_u32 s92, s81, 1
    s_mov_b32 s66, 134217728
    s_mov_b32 s67, 0x20000
    s_mov_b64 s[64:65], s[52:53]
    v_mov_b32 v62, v76
    v_mov_b32 v63, v77
    s_branch L_bloop
L_aux:
    v_lshlrev_b32 v4, 2, v2
    v_xor_b32 v4, v4, v3
    v_xor_b32 v96, 0, v4
    v_lshlrev_b32 v96, 4, v96
    v_lshl_add_u32 v10, v2, 13, v96
    v_xor_b32 v97, 1, v4
    v_lshlrev_b32 v97, 4, v97
    v_lshl_add_u32 v11, v2, 13, v97
    v_add_u32 v11, 31744, v11
    v_xor_b32 v98, 2, v4
    v_lshlrev_b32 v98, 4, v98
    v_lshl_add_u32 v12, v2, 13, v98
    v_add_u32 v12, 63488, v12
    v_xor_b32 v99, 3, v4
    v_lshlrev_b32 v99, 4, v99
    v_lshl_add_u32 v13, v2, 13, v99
    v_add_u32 v13, 95232, v13
    s_lshl_b32 s90, s34, 15
    s_mov_b32 s62, 0
    s_mov_b32 s94, 0
    s_lshl_b32 s95, s34, 20
    s_lshl_b32 s38, s32, 8
    s_add_u32 s95, s95, s38
    s_waitcnt lgkmcnt(0)
    s_mov_b32 s52, s12
    s_and_b32 s53, s13, 0xffff
    s_mov_b32 s54, 4194304
    s_mov_b32 s55, 0x20000
    s_add_u32 s39, s90, s62
    s_mov_b32 m0, s39
    s_add_u32 s62, s62, 4096
    s_and_b32 s62, s62, 0x7fff
    buffer_load_dwordx4 v10, s[52:55], s95 offen offset:0 nt lds
    buffer_load_dwordx4 v11, s[52:55], s95 offen offset:1024 nt lds
    buffer_load_dwordx4 v12, s[52:55], s95 offen offset:2048 nt lds
    buffer_load_dwordx4 v13, s[52:55], s95 offen offset:3072 nt lds
    s_add_u32 s95, s95, 131072
    s_add_u32 s39, s90, s62
    s_mov_b32 m0, s39
    s_add_u32 s62, s62, 4096
    s_and_b32 s62, s62, 0x7fff
    buffer_load_dwordx4 v10, s[52:55], s95 offen offset:0 nt lds
    buffer_load_dwordx4 v11, s[52:55], s95 offen offset:1024 nt lds
    buffer_load_dwordx4 v12, s[52:55], s95 offen offset:2048 nt lds
    buffer_load_dwordx4 v13, s[52:55], s95 offen offset:3072 nt lds
    s_add_u32 s95, s95, 131072
    s_load_dword s35, s[30:31], 0
    s_mov_b32 s48, s30
    s_and_b32 s49, s31, 0xffff
    s_mov_b32 s50, 8388608
    s_mov_b32 s51, 0x20000
    s_mov_b32 s82, 0xffffff00
    s_mov_b32 s83, 0x3e0293ee
    s_mov_b32 s84, 2097152
    v_lshl_add_u32 v76, v2, 10, v96
    v_lshl_add_u32 v96, v2, 8, v96
    v_lshl_add_u32 v77, v2, 10, v97
    v_lshl_add_u32 v97, v2, 8, v97
    v_add_u32 v77, 3072, v77
    v_lshl_add_u32 v78, v2, 10, v98
    v_lshl_add_u32 v98, v2, 8, v98
    v_add_u32 v78, 6144, v78
    v_lshl_add_u32 v79, v2, 10, v99
    v_lshl_add_u32 v99, v2, 8, v99
    v_add_u32 v79, 9216, v79
    v_bfe_u32 v100, v1, 0, 5
    v_lshlrev_b32 v101, 8, v100
    v_mov_b32 v100, 0
    s_lshl_b32 s38, s34, 13
    v_add_u32 v101, s38, v101
    v_lshlrev_b32 v4, 4, v3
    v_lshl_add_u32 v9, v2, 10, v4
    v_and_b32 v4, 3, v1
    v_bfe_u32 v5, v1, 2, 2
    v_lshrrev_b32 v6, 5, v1
    v_lshl_add_u32 v7, v4, 2, v5
    v_xor_b32 v7, v7, v6
    v_lshlrev_b32 v7, 4, v7
    v_and_b32 v80, 31, v1
    v_lshl_add_u32 v80, v80, 8, v7
    v_lshl_add_u32 v81, v6, 2, v5
    v_lshlrev_b32 v81, 8, v81
    v_lshl_add_u32 v81, v5, 6, v81
    v_bfe_u32 v7, v1, 4, 1
    v_lshlrev_b32 v7, 1, v7
    v_bfe_u32 v82, v1, 1, 1
    v_add_u32 v7, v7, v82
    v_xor_b32 v7, v7, v6
    v_lshl_add_u32 v81, v7, 4, v81
    v_and_b32 v7, 1, v1
    v_lshl_add_u32 v81, v7, 3, v81
    v_lshl_add_u32 v95, v2, 3, v5
    v_lshlrev_b32 v95, 8, v95
    v_lshl_add_u32 v95, v5, 6, v95
    v_bfe_u32 v4, v1, 4, 1
    v_lshl_add_u32 v4, v4, 1, v82
    v_lshl_add_u32 v95, v4, 4, v95
    v_lshl_add_u32 v95, v7, 3, v95
    v_add_u32 v95, s90, v95
    v_xor_b32 v136, 0, v95
    v_xor_b32 v137, 16, v95
    v_xor_b32 v138, 32, v95
    v_xor_b32 v139, 48, v95
    v_xor_b32 v140, 64, v95
    v_xor_b32 v141, 80, v95
    v_xor_b32 v142, 96, v95
    v_xor_b32 v143, 112, v95
    v_xor_b32 v144, 128, v95
    v_xor_b32 v145, 144, v95
    v_xor_b32 v146, 160, v95
    v_xor_b32 v147, 176, v95
    v_xor_b32 v148, 192, v95
    v_xor_b32 v149, 208, v95
    v_xor_b32 v150, 224, v95
    v_xor_b32 v151, 240, v95
    s_lshl_b32 s85, s34, 13
    s_add_u32 s85, s85, 131072
    v_lshl_add_u32 v94, v1, 4, s85
    v_add_u32 v96, s85, v96
    v_add_u32 v97, s85, v97
    v_add_u32 v98, s85, v98
    v_add_u32 v99, s85, v99
    s_add_u32 s39, s90, s62
    s_mov_b32 m0, s39
    s_add_u32 s62, s62, 4096
    s_and_b32 s62, s62, 0x7fff
    buffer_load_dwordx4 v10, s[52:55], s95 offen offset:0 nt lds
    buffer_load_dwordx4 v11, s[52:55], s95 offen offset:1024 nt lds
    buffer_load_dwordx4 v12, s[52:55], s95 offen offset:2048 nt lds
    buffer_load_dwordx4 v13, s[52:55], s95 offen offset:3072 nt lds
    s_add_u32 s95, s95, 131072
    s_add_u32 s39, s90, s62
    s_mov_b32 m0, s39
    s_add_u32 s62, s62, 4096
    s_and_b32 s62, s62, 0x7fff
    buffer_load_dwordx4 v10, s[52:55], s95 offen offset:0 nt lds
    buffer_load_dwordx4 v11, s[52:55], s95 offen offset:1024 nt lds
    buffer_load_dwordx4 v12, s[52:55], s95 offen offset:2048 nt lds
    buffer_load_dwordx4 v13, s[52:55], s95 offen offset:3072 nt lds
    s_add_u32 s95, s95, 131072
    s_add_u32 s39, s90, s62
    s_mov_b32 m0, s39
    s_add_u32 s62, s62, 4096
    s_and_b32 s62, s62, 0x7fff
    buffer_load_dwordx4 v10, s[52:55], s95 offen offset:0 nt lds
    buffer_load_dwordx4 v11, s[52:55], s95 offen offset:1024 nt lds
    buffer_load_dwordx4 v12, s[52:55], s95 offen offset:2048 nt lds
    buffer_load_dwordx4 v13, s[52:55], s95 offen offset:3072 nt lds
    s_add_u32 s95, s95, 131072
    s_add_u32 s39, s90, s62
    s_mov_b32 m0, s39
    s_add_u32 s62, s62, 4096
    s_and_b32 s62, s62, 0x7fff
    buffer_load_dwordx4 v10, s[52:55], s95 offen offset:0 nt lds
    buffer_load_dwordx4 v11, s[52:55], s95 offen offset:1024 nt lds
    buffer_load_dwordx4 v12, s[52:55], s95 offen offset:2048 nt lds
    buffer_load_dwordx4 v13, s[52:55], s95 offen offset:3072 nt lds
    s_add_u32 s95, s95, 131072
    s_add_u32 s39, s90, s62
    s_mov_b32 m0, s39
    s_add_u32 s62, s62, 4096
    s_and_b32 s62, s62, 0x7fff
    buffer_load_dwordx4 v10, s[52:55], s95 offen offset:0 nt lds
    buffer_load_dwordx4 v11, s[52:55], s95 offen offset:1024 nt lds
    buffer_load_dwordx4 v12, s[52:55], s95 offen offset:2048 nt lds
    buffer_load_dwordx4 v13, s[52:55], s95 offen offset:3072 nt lds
    s_add_u32 s95, s95, 131072
    s_add_u32 s39, s90, s62
    s_mov_b32 m0, s39
    s_add_u32 s62, s62, 4096
    s_and_b32 s62, s62, 0x7fff
    buffer_load_dwordx4 v10, s[52:55], s95 offen offset:0 nt lds
    buffer_load_dwordx4 v11, s[52:55], s95 offen offset:1024 nt lds
    buffer_load_dwordx4 v12, s[52:55], s95 offen offset:2048 nt lds
    buffer_load_dwordx4 v13, s[52:55], s95 offen offset:3072 nt lds
    s_add_u32 s95, s95, 131072
    s_waitcnt lgkmcnt(0)
    s_add_u32 s35, s35, 0x5b
    s_and_b32 s35, s35, 0xff
    v_mov_b32 v8, s35
    s_or_b32 s68, s35, 0x6b3ac500
    s_mov_b32 s52, s6
    s_and_b32 s53, s7, 0xffff
    s_mov_b32 s54, 16777216
    s_mov_b32 s55, 0x20000
    s_bfe_u32 s38, s32, 0x30000
    s_lshl_b32 s38, s38, 2
    s_add_u32 s3, s38, 0
    s_lshr_b32 s38, s32, 3
    s_lshl_b32 s38, s38, 0
    s_add_u32 s3, s38, s3
    s_lshl_b32 s38, s3, 19
    s_add_u32 s95, s38, 0
    s_lshl_b32 s38, s34, 8
    s_add_u32 s95, s38, s95
    s_waitcnt vmcnt(24)
    ds_read_b64_tr_b16 a[128:129], v136 offset:0
    ds_read_b64_tr_b16 a[130:131], v137 offset:1024
    ds_read_b64_tr_b16 a[144:145], v138 offset:0
    ds_read_b64_tr_b16 a[146:147], v139 offset:1024
    ds_read_b64_tr_b16 a[160:161], v140 offset:0
    ds_read_b64_tr_b16 a[162:163], v141 offset:1024
    ds_read_b64_tr_b16 a[176:177], v142 offset:0
    ds_read_b64_tr_b16 a[178:179], v143 offset:1024
    ds_read_b64_tr_b16 a[192:193], v144 offset:0
    ds_read_b64_tr_b16 a[194:195], v145 offset:1024
    ds_read_b64_tr_b16 a[208:209], v146 offset:0
    ds_read_b64_tr_b16 a[210:211], v147 offset:1024
    ds_read_b64_tr_b16 a[224:225], v148 offset:0
    ds_read_b64_tr_b16 a[226:227], v149 offset:1024
    ds_read_b64_tr_b16 a[240:241], v150 offset:0
    ds_read_b64_tr_b16 a[242:243], v151 offset:1024
    s_waitcnt lgkmcnt(0)
    s_add_u32 s39, s90, s62
    s_mov_b32 m0, s39
    s_add_u32 s62, s62, 4096
    s_and_b32 s62, s62, 0x7fff
    buffer_load_dwordx4 v76, s[52:55], s95 offen offset:0 nt lds
    buffer_load_dwordx4 v77, s[52:55], s95 offen offset:1024 nt lds
    buffer_load_dwordx4 v78, s[52:55], s95 offen offset:2048 nt lds
    buffer_load_dwordx4 v79, s[52:55], s95 offen offset:3072 nt lds
    s_add_u32 s95, s95, 16384
    s_add_u32 s39, s90, s62
    s_mov_b32 m0, s39
    s_add_u32 s62, s62, 4096
    s_and_b32 s62, s62, 0x7fff
    buffer_load_dwordx4 v76, s[52:55], s95 offen offset:0 nt lds
    buffer_load_dwordx4 v77, s[52:55], s95 offen offset:1024 nt lds
    buffer_load_dwordx4 v78, s[52:55], s95 offen offset:2048 nt lds
    buffer_load_dwordx4 v79, s[52:55], s95 offen offset:3072 nt lds
    s_add_u32 s95, s95, 16384
    s_waitcnt vmcnt(24)
    ds_read_b64_tr_b16 a[132:133], v136 offset:8192
    ds_read_b64_tr_b16 a[134:135], v137 offset:9216
    ds_read_b64_tr_b16 a[148:149], v138 offset:8192
    ds_read_b64_tr_b16 a[150:151], v139 offset:9216
    ds_read_b64_tr_b16 a[164:165], v140 offset:8192
    ds_read_b64_tr_b16 a[166:167], v141 offset:9216
    ds_read_b64_tr_b16 a[180:181], v142 offset:8192
    ds_read_b64_tr_b16 a[182:183], v143 offset:9216
    ds_read_b64_tr_b16 a[196:197], v144 offset:8192
    ds_read_b64_tr_b16 a[198:199], v145 offset:9216
    ds_read_b64_tr_b16 a[212:213], v146 offset:8192
    ds_read_b64_tr_b16 a[214:215], v147 offset:9216
    ds_read_b64_tr_b16 a[228:229], v148 offset:8192
    ds_read_b64_tr_b16 a[230:231], v149 offset:9216
    ds_read_b64_tr_b16 a[244:245], v150 offset:8192
    ds_read_b64_tr_b16 a[246:247], v151 offset:9216
    s_waitcnt lgkmcnt(0)
    s_add_u32 s39, s90, s62
    s_mov_b32 m0, s39
    s_add_u32 s62, s62, 4096
    s_and_b32 s62, s62, 0x7fff
    buffer_load_dwordx4 v76, s[52:55], s95 offen offset:0 nt lds
    buffer_load_dwordx4 v77, s[52:55], s95 offen offset:1024 nt lds
    buffer_load_dwordx4 v78, s[52:55], s95 offen offset:2048 nt lds
    buffer_load_dwordx4 v79, s[52:55], s95 offen offset:3072 nt lds
    s_add_u32 s95, s95, 16384
    s_add_u32 s39, s90, s62
    s_mov_b32 m0, s39
    s_add_u32 s62, s62, 4096
    s_and_b32 s62, s62, 0x7fff
    buffer_load_dwordx4 v76, s[52:55], s95 offen offset:0 nt lds
    buffer_load_dwordx4 v77, s[52:55], s95 offen offset:1024 nt lds
    buffer_load_dwordx4 v78, s[52:55], s95 offen offset:2048 nt lds
    buffer_load_dwordx4 v79, s[52:55], s95 offen offset:3072 nt lds
    s_add_u32 s95, s95, 16384
    s_waitcnt vmcnt(24)
    ds_read_b64_tr_b16 a[136:137], v136 offset:16384
    ds_read_b64_tr_b16 a[138:139], v137 offset:17408
    ds_read_b64_tr_b16 a[152:153], v138 offset:16384
    ds_read_b64_tr_b16 a[154:155], v139 offset:17408
    ds_read_b64_tr_b16 a[168:169], v140 offset:16384
    ds_read_b64_tr_b16 a[170:171], v141 offset:17408
    ds_read_b64_tr_b16 a[184:185], v142 offset:16384
    ds_read_b64_tr_b16 a[186:187], v143 offset:17408
    ds_read_b64_tr_b16 a[200:201], v144 offset:16384
    ds_read_b64_tr_b16 a[202:203], v145 offset:17408
    ds_read_b64_tr_b16 a[216:217], v146 offset:16384
    ds_read_b64_tr_b16 a[218:219], v147 offset:17408
    ds_read_b64_tr_b16 a[232:233], v148 offset:16384
    ds_read_b64_tr_b16 a[234:235], v149 offset:17408
    ds_read_b64_tr_b16 a[248:249], v150 offset:16384
    ds_read_b64_tr_b16 a[250:251], v151 offset:17408
    s_waitcnt lgkmcnt(0)
    s_add_u32 s39, s90, s62
    s_mov_b32 m0, s39
    s_add_u32 s62, s62, 4096
    s_and_b32 s62, s62, 0x7fff
    buffer_load_dwordx4 v76, s[52:55], s95 offen offset:0 nt lds
    buffer_load_dwordx4 v77, s[52:55], s95 offen offset:1024 nt lds
    buffer_load_dwordx4 v78, s[52:55], s95 offen offset:2048 nt lds
    buffer_load_dwordx4 v79, s[52:55], s95 offen offset:3072 nt lds
    s_add_u32 s95, s95, 16384
    s_add_u32 s39, s90, s62
    s_mov_b32 m0, s39
    s_add_u32 s62, s62, 4096
    s_and_b32 s62, s62, 0x7fff
    buffer_load_dwordx4 v76, s[52:55], s95 offen offset:0 nt lds
    buffer_load_dwordx4 v77, s[52:55], s95 offen offset:1024 nt lds
    buffer_load_dwordx4 v78, s[52:55], s95 offen offset:2048 nt lds
    buffer_load_dwordx4 v79, s[52:55], s95 offen offset:3072 nt lds
    s_add_u32 s95, s95, 16384
    s_waitcnt vmcnt(24)
    ds_read_b64_tr_b16 a[140:141], v136 offset:24576
    ds_read_b64_tr_b16 a[142:143], v137 offset:25600
    ds_read_b64_tr_b16 a[156:157], v138 offset:24576
    ds_read_b64_tr_b16 a[158:159], v139 offset:25600
    ds_read_b64_tr_b16 a[172:173], v140 offset:24576
    ds_read_b64_tr_b16 a[174:175], v141 offset:25600
    ds_read_b64_tr_b16 a[188:189], v142 offset:24576
    ds_read_b64_tr_b16 a[190:191], v143 offset:25600
    ds_read_b64_tr_b16 a[204:205], v144 offset:24576
    ds_read_b64_tr_b16 a[206:207], v145 offset:25600
    ds_read_b64_tr_b16 a[220:221], v146 offset:24576
    ds_read_b64_tr_b16 a[222:223], v147 offset:25600
    ds_read_b64_tr_b16 a[236:237], v148 offset:24576
    ds_read_b64_tr_b16 a[238:239], v149 offset:25600
    ds_read_b64_tr_b16 a[252:253], v150 offset:24576
    ds_read_b64_tr_b16 a[254:255], v151 offset:25600
    s_waitcnt lgkmcnt(0)
    s_mov_b32 s86, 98304
    buffer_load_dword v7, v101, s[48:51], s86 offen sc1
    s_add_u32 s39, s90, s62
    s_mov_b32 m0, s39
    s_add_u32 s62, s62, 4096
    s_and_b32 s62, s62, 0x7fff
    buffer_load_dwordx4 v76, s[52:55], s95 offen offset:0 nt lds
    buffer_load_dwordx4 v77, s[52:55], s95 offen offset:1024 nt lds
    buffer_load_dwordx4 v78, s[52:55], s95 offen offset:2048 nt lds
    buffer_load_dwordx4 v79, s[52:55], s95 offen offset:3072 nt lds
    s_add_u32 s95, s95, 16384
    s_add_u32 s39, s90, s62
    s_mov_b32 m0, s39
    s_add_u32 s62, s62, 4096
    s_and_b32 s62, s62, 0x7fff
    buffer_load_dwordx4 v76, s[52:55], s95 offen offset:0 nt lds
    v_mov_b32 v136, 0
    v_mov_b32 v137, 0
    v_mov_b32 v138, 0
    v_mov_b32 v139, 0
    v_mov_b32 v140, 0
    v_mov_b32 v141, 0
    v_mov_b32 v142, 0
    v_mov_b32 v143, 0
    v_mov_b32 v144, 0
    v_mov_b32 v145, 0
    v_mov_b32 v146, 0
    v_mov_b32 v147, 0
    v_mov_b32 v148, 0
    v_mov_b32 v149, 0
    v_mov_b32 v150, 0
    v_mov_b32 v151, 0
    v_mov_b32 v152, 0
    v_mov_b32 v153, 0
    v_mov_b32 v154, 0
    v_mov_b32 v155, 0
    v_mov_b32 v156, 0
    v_mov_b32 v157, 0
    v_mov_b32 v158, 0
    v_mov_b32 v159, 0
    v_mov_b32 v160, 0
    v_mov_b32 v161, 0
    v_mov_b32 v162, 0
    v_mov_b32 v163, 0
    v_mov_b32 v164, 0
    v_mov_b32 v165, 0
    v_mov_b32 v166, 0
    v_mov_b32 v167, 0
    v_mov_b32 v168, 0
    v_mov_b32 v169, 0
    v_mov_b32 v170, 0
    v_mov_b32 v171, 0
    v_mov_b32 v172, 0
    v_mov_b32 v173, 0
    v_mov_b32 v174, 0
    v_mov_b32 v175, 0
    v_mov_b32 v176, 0
    v_mov_b32 v177, 0
    v_mov_b32 v178, 0
    v_mov_b32 v179, 0
    v_mov_b32 v180, 0
    v_mov_b32 v181, 0
    v_mov_b32 v182, 0
    v_mov_b32 v183, 0
    v_mov_b32 v184, 0
    v_mov_b32 v185, 0
    v_mov_b32 v186, 0
    v_mov_b32 v187, 0
    v_mov_b32 v188, 0
    v_mov_b32 v189, 0
    v_mov_b32 v190, 0
    v_mov_b32 v191, 0
    v_mov_b32 v192, 0
    v_mov_b32 v193, 0
    v_mov_b32 v194, 0
    v_mov_b32 v195, 0
    v_mov_b32 v196, 0
    v_mov_b32 v197, 0
    v_mov_b32 v198, 0
    v_mov_b32 v199, 0
    v_mov_b32 v90, 0xff7f0000
    s_mov_b32 s93, 0
    v_mov_b32 v102, 0
    v_mov_b32 v103, 0
    s_mov_b32 s60, s83
    s_mov_b32 s61, s83
    v_add_u32 v4, s85, v80
    v_xor_b32 v82, 0, v4
    v_xor_b32 v83, 32, v4
    v_xor_b32 v84, 64, v4
    v_xor_b32 v85, 96, v4
    v_xor_b32 v86, 128, v4
    v_xor_b32 v87, 160, v4
    v_xor_b32 v88, 192, v4
    v_xor_b32 v89, 224, v4
    v_add_u32 v80, s90, v80
    v_add_u32 v81, s90, v81
    s_lshr_b32 s38, s3, 3
    s_lshl_b32 s38, s38, 15
    s_add_u32 s36, s38, 393216
    s_lshl_b32 s38, s34, 8
    s_add_u32 s36, s38, s36
    s_waitcnt vmcnt(5)
L_fcheck_23:
    v_cmp_ne_u32 vcc, s68, v7
    s_cbranch_vccz L_fok_24
    s_sleep 2
    s_mov_b32 s86, 98304
    buffer_load_dword v7, v101, s[48:51], s86 offen sc1
    s_waitcnt vmcnt(0)
    s_sub_u32 s84, s84, 1
    s_cmp_lg_u32 s84, 0
    s_cbranch_scc1 L_fcheck_23
    s_branch L_end
L_fok_24:
    buffer_load_dwordx4 v[20:23], v9, s[48:51], s36 offen sc1
    s_add_u32 s36, s36, 4096
    buffer_load_dwordx4 v[24:27], v9, s[48:51], s36 offen sc1
    s_add_u32 s36, s36, 4096
    buffer_load_dwordx4 v[28:31], v9, s[48:51], s36 offen sc1
    s_add_u32 s36, s36, 4096
    buffer_load_dwordx4 v[32:35], v9, s[48:51], s36 offen sc1
    s_add_u32 s36, s36, 4096
    buffer_load_dwordx4 v[36:39], v9, s[48:51], s36 offen sc1
    s_add_u32 s36, s36, 4096
    buffer_load_dwordx4 v[40:43], v9, s[48:51], s36 offen sc1
    s_add_u32 s36, s36, 4096
    buffer_load_dwordx4 v[44:47], v9, s[48:51], s36 offen sc1
    s_add_u32 s36, s36, 4096
    buffer_load_dwordx4 v[48:51], v9, s[48:51], s36 offen sc1
    s_waitcnt vmcnt(7)
    ds_write_b128 v96, v[20:23] offset:0
    s_waitcnt vmcnt(6)
    ds_write_b128 v97, v[24:27] offset:1024
    s_waitcnt vmcnt(5)
    ds_write_b128 v98, v[28:31] offset:2048
    s_waitcnt vmcnt(4)
    ds_write_b128 v99, v[32:35] offset:3072
    s_waitcnt vmcnt(3)
    ds_write_b128 v96, v[36:39] offset:4096
    s_waitcnt vmcnt(2)
    ds_write_b128 v97, v[40:43] offset:5120
    s_waitcnt vmcnt(1)
    ds_write_b128 v98, v[44:47] offset:6144
    s_waitcnt vmcnt(0)
    ds_write_b128 v99, v[48:51] offset:7168
    s_waitcnt lgkmcnt(0)
    ds_read_b128 v[104:107], v82
    ds_read_b128 v[108:111], v83
    ds_read_b128 v[112:115], v84
    ds_read_b128 v[116:119], v85
    ds_read_b128 v[120:123], v86
    ds_read_b128 v[124:127], v87
    ds_read_b128 v[128:131], v88
    ds_read_b128 v[132:135], v89
    v_xor_b32 v82, 0, v80
    ds_read_b128 v[216:219], v82
    v_xor_b32 v83, 32, v80
    ds_read_b128 v[220:223], v83
    v_xor_b32 v84, 64, v80
    ds_read_b128 v[224:227], v84
    v_xor_b32 v85, 96, v80
    ds_read_b128 v[228:231], v85
    v_xor_b32 v86, 128, v80
    ds_read_b128 v[232:235], v86
    v_xor_b32 v87, 160, v80
    ds_read_b128 v[236:239], v87
    v_xor_b32 v88, 192, v80
    ds_read_b128 v[240:243], v88
    v_xor_b32 v89, 224, v80
    ds_read_b128 v[244:247], v89
L_att:
    v_add_u32 v4, s94, v81
    s_waitcnt lgkmcnt(0)
    v_mfma_f32_32x32x16_bf16 v[200:215], v[216:219], v[104:107], 0
    v_xor_b32 v82, 0, v4
    ds_read_b64_tr_b16 v[20:21], v82 offset:0
    ds_read_b64_tr_b16 v[24:25], v82 offset:4096
    buffer_load_dwordx4 v77, s[52:55], s95 offen offset:1024 nt lds
    v_mfma_f32_32x32x16_bf16 v[200:215], v[220:223], v[108:111], v[200:215]
    v_xor_b32 v83, 32, v4
    ds_read_b64_tr_b16 v[22:23], v83 offset:2048
    ds_read_b64_tr_b16 v[26:27], v83 offset:6144
    v_mfma_f32_32x32x16_bf16 v[200:215], v[224:227], v[112:115], v[200:215]
    v_xor_b32 v84, 64, v4
    ds_read_b64_tr_b16 v[28:29], v84 offset:0
    ds_read_b64_tr_b16 v[32:33], v84 offset:4096
    v_mfma_f32_32x32x16_bf16 v[200:215], v[228:231], v[116:119], v[200:215]
    v_xor_b32 v85, 96, v4
    ds_read_b64_tr_b16 v[30:31], v85 offset:2048
    ds_read_b64_tr_b16 v[34:35], v85 offset:6144
    v_mfma_f32_32x32x16_bf16 v[200:215], v[232:235], v[120:123], v[200:215]
    v_xor_b32 v86, 128, v4
    ds_read_b64_tr_b16 v[36:37], v86 offset:0
    ds_read_b64_tr_b16 v[40:41], v86 offset:4096
    buffer_load_dwordx4 v78, s[52:55], s95 offen offset:2048 nt lds
    v_mfma_f32_32x32x16_bf16 v[200:215], v[236:239], v[124:127], v[200:215]
    v_xor_b32 v87, 160, v4
    ds_read_b64_tr_b16 v[38:39], v87 offset:2048
    ds_read_b64_tr_b16 v[42:43], v87 offset:6144
    v_mfma_f32_32x32x16_bf16 v[200:215], v[240:243], v[128:131], v[200:215]
    v_xor_b32 v88, 192, v4
    ds_read_b64_tr_b16 v[44:45], v88 offset:0
    ds_read_b64_tr_b16 v[48:49], v88 offset:4096
    v_mfma_f32_32x32x16_bf16 v[200:215], v[244:247], v[132:135], v[200:215]
    v_xor_b32 v89, 224, v4
    ds_read_b64_tr_b16 v[46:47], v89 offset:2048
    ds_read_b64_tr_b16 v[50:51], v89 offset:6144
    buffer_load_dwordx4 v79, s[52:55], s95 offen offset:3072 nt lds
    s_add_u32 s95, s95, 16384
    v_xor_b32 v5, 0x2000, v94
    v_xor_b32 v6, 0x4000, v94
    v_xor_b32 v7, 0x6000, v94
    s_cmp_eq_u32 s93, 12
    s_cselect_b32 s95, 16777216, s95
    s_nop 1
    ds_write_b128 v94, v[200:203] offset:0
    ds_write_b128 v94, v[204:207] offset:1024
    ds_write_b128 v94, v[208:211] offset:2048
    ds_write_b128 v94, v[212:215] offset:3072
    s_waitcnt lgkmcnt(0)
    s_barrier
    ds_read_b128 v[60:63], v5 offset:0
    ds_read_b128 v[216:219], v6 offset:0
    ds_read_b128 v[232:235], v7 offset:0
    ds_read_b128 v[64:67], v5 offset:1024
    ds_read_b128 v[220:223], v6 offset:1024
    ds_read_b128 v[236:239], v7 offset:1024
    ds_read_b128 v[68:71], v5 offset:2048
    ds_read_b128 v[224:227], v6 offset:2048
    ds_read_b128 v[240:243], v7 offset:2048
    ds_read_b128 v[72:75], v5 offset:3072
    ds_read_b128 v[228:231], v6 offset:3072
    ds_read_b128 v[244:247], v7 offset:3072
    v_xor_b32 v94, 0x1000, v94
    s_add_u32 s39, s90, s62
    s_mov_b32 m0, s39
    s_add_u32 s62, s62, 4096
    s_and_b32 s62, s62, 0x7fff
    buffer_load_dwordx4 v76, s[52:55], s95 offen offset:0 nt lds
    s_add_u32 s94, s94, 8192
    s_and_b32 s94, s94, 0x7fff
    s_waitcnt lgkmcnt(9)
    v_pk_add_f32 v[200:201], v[200:201], v[60:61]
    v_pk_add_f32 v[216:217], v[216:217], v[232:233]
    v_pk_add_f32 v[202:203], v[202:203], v[62:63]
    v_pk_add_f32 v[218:219], v[218:219], v[234:235]
    v_pk_add_f32 v[200:201], v[200:201], v[216:217]
    v_pk_add_f32 v[202:203], v[202:203], v[218:219]
    s_waitcnt lgkmcnt(6)
    v_pk_add_f32 v[204:205], v[204:205], v[64:65]
    v_pk_add_f32 v[220:221], v[220:221], v[236:237]
    v_pk_add_f32 v[206:207], v[206:207], v[66:67]
    v_pk_add_f32 v[222:223], v[222:223], v[238:239]
    v_pk_add_f32 v[204:205], v[204:205], v[220:221]
    v_pk_add_f32 v[206:207], v[206:207], v[222:223]
    s_waitcnt lgkmcnt(3)
    v_pk_add_f32 v[208:209], v[208:209], v[68:69]
    v_pk_add_f32 v[224:225], v[224:225], v[240:241]
    v_pk_add_f32 v[210:211], v[210:211], v[70:71]
    v_pk_add_f32 v[226:227], v[226:227], v[242:243]
    v_pk_add_f32 v[208:209], v[208:209], v[224:225]
    v_pk_add_f32 v[210:211], v[210:211], v[226:227]
    s_waitcnt lgkmcnt(0)
    v_pk_add_f32 v[212:213], v[212:213], v[72:73]
    v_pk_add_f32 v[228:229], v[228:229], v[244:245]
    v_pk_add_f32 v[214:215], v[214:215], v[74:75]
    v_pk_add_f32 v[230:231], v[230:231], v[246:247]
    v_pk_add_f32 v[212:213], v[212:213], v[228:229]
    v_pk_add_f32 v[214:215], v[214:215], v[230:231]
    buffer_load_dwordx4 v77, s[52:55], s95 offen offset:1024 nt lds
    v_max_f32 v4, v200, v201
    v_max3_f32 v4, v4, v202, v203
    v_max3_f32 v4, v4, v204, v205
    v_max3_f32 v4, v4, v206, v207
    v_max3_f32 v4, v4, v208, v209
    v_max3_f32 v4, v4, v210, v211
    v_max3_f32 v4, v4, v212, v213
    v_max3_f32 v4, v4, v214, v215
    v_mov_b32 v5, v4
    s_nop 1
    v_permlane32_swap_b32 v4, v5
    v_max_f32 v4, v4, v5
    v_mul_f32 v4, s83, v4
    v_max_f32 v4, v4, v90
    v_sub_f32 v92, v90, v4
    v_exp_f32 v92, v92
    v_mov_b32 v90, v4
    v_pk_fma_f32 v[200:201], v[200:201], s[60:61], v[90:91] op_sel_hi:[1,1,0] neg_lo:[0,0,1] neg_hi:[0,0,1]
    v_pk_fma_f32 v[202:203], v[202:203], s[60:61], v[90:91] op_sel_hi:[1,1,0] neg_lo:[0,0,1] neg_hi:[0,0,1]
    v_pk_fma_f32 v[204:205], v[204:205], s[60:61], v[90:91] op_sel_hi:[1,1,0] neg_lo:[0,0,1] neg_hi:[0,0,1]
    v_pk_fma_f32 v[206:207], v[206:207], s[60:61], v[90:91] op_sel_hi:[1,1,0] neg_lo:[0,0,1] neg_hi:[0,0,1]
    v_pk_fma_f32 v[208:209], v[208:209], s[60:61], v[90:91] op_sel_hi:[1,1,0] neg_lo:[0,0,1] neg_hi:[0,0,1]
    v_pk_fma_f32 v[210:211], v[210:211], s[60:61], v[90:91] op_sel_hi:[1,1,0] neg_lo:[0,0,1] neg_hi:[0,0,1]
    v_pk_fma_f32 v[212:213], v[212:213], s[60:61], v[90:91] op_sel_hi:[1,1,0] neg_lo:[0,0,1] neg_hi:[0,0,1]
    v_pk_fma_f32 v[214:215], v[214:215], s[60:61], v[90:91] op_sel_hi:[1,1,0] neg_lo:[0,0,1] neg_hi:[0,0,1]
    v_exp_f32 v200, v200
    v_exp_f32 v201, v201
    v_exp_f32 v202, v202
    v_exp_f32 v203, v203
    v_exp_f32 v204, v204
    buffer_load_dwordx4 v78, s[52:55], s95 offen offset:2048 nt lds
    v_exp_f32 v205, v205
    v_exp_f32 v206, v206
    v_exp_f32 v207, v207
    v_exp_f32 v208, v208
    v_exp_f32 v209, v209
    v_exp_f32 v210, v210
    v_exp_f32 v211, v211
    v_exp_f32 v212, v212
    v_exp_f32 v213, v213
    v_exp_f32 v214, v214
    v_exp_f32 v215, v215
    v_add_u32 v4, s94, v80
    v_pk_mul_f32 v[102:103], v[102:103], v[92:93] op_sel_hi:[1,0]
    v_pk_mul_f32 v[136:137], v[136:137], v[92:93] op_sel_hi:[1,0]
    v_pk_mul_f32 v[138:139], v[138:139], v[92:93] op_sel_hi:[1,0]
    v_pk_mul_f32 v[140:141], v[140:141], v[92:93] op_sel_hi:[1,0]
    v_pk_mul_f32 v[142:143], v[142:143], v[92:93] op_sel_hi:[1,0]
    v_pk_mul_f32 v[144:145], v[144:145], v[92:93] op_sel_hi:[1,0]
    v_pk_mul_f32 v[146:147], v[146:147], v[92:93] op_sel_hi:[1,0]
    v_pk_mul_f32 v[148:149], v[148:149], v[92:93] op_sel_hi:[1,0]
    v_pk_mul_f32 v[150:151], v[150:151], v[92:93] op_sel_hi:[1,0]
    v_pk_mul_f32 v[152:153], v[152:153], v[92:93] op_sel_hi:[1,0]
    v_pk_mul_f32 v[154:155], v[154:155], v[92:93] op_sel_hi:[1,0]
    v_pk_mul_f32 v[156:157], v[156:157], v[92:93] op_sel_hi:[1,0]
    v_pk_mul_f32 v[158:159], v[158:159], v[92:93] op_sel_hi:[1,0]
    v_pk_mul_f32 v[160:161], v[160:161], v[92:93] op_sel_hi:[1,0]
    v_pk_mul_f32 v[162:163], v[162:163], v[92:93] op_sel_hi:[1,0]
    v_pk_mul_f32 v[164:165], v[164:165], v[92:93] op_sel_hi:[1,0]
    v_pk_mul_f32 v[166:167], v[166:167], v[92:93] op_sel_hi:[1,0]
    v_pk_mul_f32 v[168:169], v[168:169], v[92:93] op_sel_hi:[1,0]
    v_pk_mul_f32 v[170:171], v[170:171], v[92:93] op_sel_hi:[1,0]
    v_pk_mul_f32 v[172:173], v[172:173], v[92:93] op_sel_hi:[1,0]
    v_pk_mul_f32 v[174:175], v[174:175], v[92:93] op_sel_hi:[1,0]
    v_pk_mul_f32 v[176:177], v[176:177], v[92:93] op_sel_hi:[1,0]
    buffer_load_dwordx4 v79, s[52:55], s95 offen offset:3072 nt lds
    s_add_u32 s95, s95, 16384
    v_pk_mul_f32 v[178:179], v[178:179], v[92:93] op_sel_hi:[1,0]
    v_pk_mul_f32 v[180:181], v[180:181], v[92:93] op_sel_hi:[1,0]
    v_pk_mul_f32 v[182:183], v[182:183], v[92:93] op_sel_hi:[1,0]
    v_pk_mul_f32 v[184:185], v[184:185], v[92:93] op_sel_hi:[1,0]
    v_pk_mul_f32 v[186:187], v[186:187], v[92:93] op_sel_hi:[1,0]
    v_pk_mul_f32 v[188:189], v[188:189], v[92:93] op_sel_hi:[1,0]
    v_pk_mul_f32 v[190:191], v[190:191], v[92:93] op_sel_hi:[1,0]
    v_pk_mul_f32 v[192:193], v[192:193], v[92:93] op_sel_hi:[1,0]
    v_pk_mul_f32 v[194:195], v[194:195], v[92:93] op_sel_hi:[1,0]
    v_pk_mul_f32 v[196:197], v[196:197], v[92:93] op_sel_hi:[1,0]
    v_pk_mul_f32 v[198:199], v[198:199], v[92:93] op_sel_hi:[1,0]
    v_cvt_pk_bf16_f32 v52, v200, v201
    v_pk_add_f32 v[102:103], v[102:103], v[200:201]
    v_cvt_pk_bf16_f32 v53, v202, v203
    v_pk_add_f32 v[102:103], v[102:103], v[202:203]
    v_cvt_pk_bf16_f32 v54, v204, v205
    v_pk_add_f32 v[102:103], v[102:103], v[204:205]
    v_cvt_pk_bf16_f32 v55, v206, v207
    v_pk_add_f32 v[102:103], v[102:103], v[206:207]
    v_cvt_pk_bf16_f32 v56, v208, v209
    v_pk_add_f32 v[102:103], v[102:103], v[208:209]
    v_cvt_pk_bf16_f32 v57, v210, v211
    v_pk_add_f32 v[102:103], v[102:103], v[210:211]
    v_cvt_pk_bf16_f32 v58, v212, v213
    v_pk_add_f32 v[102:103], v[102:103], v[212:213]
    v_cvt_pk_bf16_f32 v59, v214, v215
    v_pk_add_f32 v[102:103], v[102:103], v[214:215]
    s_waitcnt vmcnt(20)
    v_mfma_f32_32x32x16_bf16 v[136:151], v[20:23], v[52:55], v[136:151]
    v_xor_b32 v82, 0, v4
    ds_read_b128 v[216:219], v82
    v_xor_b32 v83, 32, v4
    ds_read_b128 v[220:223], v83
    v_mfma_f32_32x32x16_bf16 v[152:167], v[28:31], v[52:55], v[152:167]
    v_xor_b32 v84, 64, v4
    ds_read_b128 v[224:227], v84
    v_xor_b32 v85, 96, v4
    ds_read_b128 v[228:231], v85
    v_mfma_f32_32x32x16_bf16 v[168:183], v[36:39], v[52:55], v[168:183]
    v_xor_b32 v86, 128, v4
    ds_read_b128 v[232:235], v86
    v_xor_b32 v87, 160, v4
    ds_read_b128 v[236:239], v87
    v_mfma_f32_32x32x16_bf16 v[184:199], v[44:47], v[52:55], v[184:199]
    v_xor_b32 v88, 192, v4
    ds_read_b128 v[240:243], v88
    v_xor_b32 v89, 224, v4
    ds_read_b128 v[244:247], v89
    v_mfma_f32_32x32x16_bf16 v[136:151], v[24:27], v[56:59], v[136:151]
    s_add_u32 s39, s90, s62
    s_mov_b32 m0, s39
    s_add_u32 s62, s62, 4096
    s_and_b32 s62, s62, 0x7fff
    buffer_load_dwordx4 v76, s[52:55], s95 offen offset:0 nt lds
    v_mfma_f32_32x32x16_bf16 v[152:167], v[32:35], v[56:59], v[152:167]
    v_mfma_f32_32x32x16_bf16 v[168:183], v[40:43], v[56:59], v[168:183]
    v_mfma_f32_32x32x16_bf16 v[184:199], v[48:51], v[56:59], v[184:199]
    s_add_u32 s93, s93, 1
    s_cmp_lt_u32 s93, 16
    s_cbranch_scc1 L_att
    v_add_f32 v91, v102, v103
    v_mov_b32 v5, v91
    s_nop 1
    v_permlane32_swap_b32 v91, v5
    v_add_f32 v91, v91, v5
    v_and_b32 v4, 31, v1
    v_lshlrev_b32 v5, 8, v4
    v_lshl_add_u32 v5, v3, 4, v5
    v_lshrrev_b32 v6, 5, v1
    v_lshl_add_u32 v5, v6, 3, v5
    v_add_u32 v5, s85, v5
    s_waitcnt vmcnt(0) lgkmcnt(0)
    s_barrier
    v_cvt_pk_bf16_f32 v20, v136, v137
    v_cvt_pk_bf16_f32 v21, v138, v139
    v_xor_b32 v82, 0, v5
    ds_write_b64 v82, v[20:21]
    v_cvt_pk_bf16_f32 v22, v140, v141
    v_cvt_pk_bf16_f32 v23, v142, v143
    v_xor_b32 v83, 16, v5
    ds_write_b64 v83, v[22:23]
    v_cvt_pk_bf16_f32 v24, v144, v145
    v_cvt_pk_bf16_f32 v25, v146, v147
    v_xor_b32 v84, 32, v5
    ds_write_b64 v84, v[24:25]
    v_cvt_pk_bf16_f32 v26, v148, v149
    v_cvt_pk_bf16_f32 v27, v150, v151
    v_xor_b32 v85, 48, v5
    ds_write_b64 v85, v[26:27]
    v_cvt_pk_bf16_f32 v28, v152, v153
    v_cvt_pk_bf16_f32 v29, v154, v155
    v_xor_b32 v86, 64, v5
    ds_write_b64 v86, v[28:29]
    v_cvt_pk_bf16_f32 v30, v156, v157
    v_cvt_pk_bf16_f32 v31, v158, v159
    v_xor_b32 v87, 80, v5
    ds_write_b64 v87, v[30:31]
    v_cvt_pk_bf16_f32 v32, v160, v161
    v_cvt_pk_bf16_f32 v33, v162, v163
    v_xor_b32 v88, 96, v5
    ds_write_b64 v88, v[32:33]
    v_cvt_pk_bf16_f32 v34, v164, v165
    v_cvt_pk_bf16_f32 v35, v166, v167
    v_xor_b32 v89, 112, v5
    ds_write_b64 v89, v[34:35]
    v_cvt_pk_bf16_f32 v36, v168, v169
    v_cvt_pk_bf16_f32 v37, v170, v171
    v_xor_b32 v82, 128, v5
    ds_write_b64 v82, v[36:37]
    v_cvt_pk_bf16_f32 v38, v172, v173
    v_cvt_pk_bf16_f32 v39, v174, v175
    v_xor_b32 v83, 144, v5
    ds_write_b64 v83, v[38:39]
    v_cvt_pk_bf16_f32 v40, v176, v177
    v_cvt_pk_bf16_f32 v41, v178, v179
    v_xor_b32 v84, 160, v5
    ds_write_b64 v84, v[40:41]
    v_cvt_pk_bf16_f32 v42, v180, v181
    v_cvt_pk_bf16_f32 v43, v182, v183
    v_xor_b32 v85, 176, v5
    ds_write_b64 v85, v[42:43]
    v_cvt_pk_bf16_f32 v44, v184, v185
    v_cvt_pk_bf16_f32 v45, v186, v187
    v_xor_b32 v86, 192, v5
    ds_write_b64 v86, v[44:45]
    v_cvt_pk_bf16_f32 v46, v188, v189
    v_cvt_pk_bf16_f32 v47, v190, v191
    v_xor_b32 v87, 208, v5
    ds_write_b64 v87, v[46:47]
    v_cvt_pk_bf16_f32 v48, v192, v193
    v_cvt_pk_bf16_f32 v49, v194, v195
    v_xor_b32 v88, 224, v5
    ds_write_b64 v88, v[48:49]
    v_cvt_pk_bf16_f32 v50, v196, v197
    v_cvt_pk_bf16_f32 v51, v198, v199
    v_xor_b32 v89, 240, v5
    ds_write_b64 v89, v[50:51]
    v_xor_b32 v6, v3, v2
    v_lshlrev_b32 v6, 4, v6
    v_lshl_add_u32 v6, v2, 8, v6
    v_add_u32 v6, s85, v6
    v_xor_b32 v82, 0, v6
    v_xor_b32 v83, 64, v6
    v_xor_b32 v84, 128, v6
    v_xor_b32 v85, 192, v6
    v_lshlrev_b32 v7, 4, v3
    v_lshl_add_u32 v7, v2, 15, v7
    s_lshl_b32 s38, s3, 10
    s_add_u32 s36, s38, 2097152
    s_lshl_b32 s38, s34, 8
    s_add_u32 s36, s38, s36
    s_waitcnt lgkmcnt(0)
    ds_read_b128 v[200:203], v82 offset:0
    ds_read_b128 v[204:207], v83 offset:1024
    ds_read_b128 v[208:211], v84 offset:2048
    ds_read_b128 v[212:215], v85 offset:3072
    ds_read_b128 v[216:219], v82 offset:4096
    ds_read_b128 v[220:223], v83 offset:5120
    ds_read_b128 v[224:227], v84 offset:6144
    ds_read_b128 v[228:231], v85 offset:7168
    v_lshlrev_b32 v4, 3, v4
    s_lshl_b32 s38, s3, 8
    s_add_u32 s37, s38, 163840
    s_lshl_b32 s38, s34, 13
    s_add_u32 s37, s38, s37
    s_mov_b32 exec_lo, 0xffffffff
    s_mov_b32 exec_hi, 0x0
    buffer_store_dwordx2 v[90:91], v4, s[48:51], s37 offen sc1
    s_mov_b64 exec, -1
    s_waitcnt lgkmcnt(7)
    buffer_store_dwordx4 v[200:203], v7, s[48:51], s36 offen sc1
    s_add_u32 s36, s36, 131072
    s_waitcnt lgkmcnt(6)
    buffer_store_dwordx4 v[204:207], v7, s[48:51], s36 offen sc1
    s_add_u32 s36, s36, 131072
    s_waitcnt lgkmcnt(5)
    buffer_store_dwordx4 v[208:211], v7, s[48:51], s36 offen sc1
    s_add_u32 s36, s36, 131072
    s_waitcnt lgkmcnt(4)
    buffer_store_dwordx4 v[212:215], v7, s[48:51], s36 offen sc1
    s_add_u32 s36, s36, 131072
    s_waitcnt lgkmcnt(3)
    buffer_store_dwordx4 v[216:219], v7, s[48:51], s36 offen sc1
    s_add_u32 s36, s36, 131072
    s_waitcnt lgkmcnt(2)
    buffer_store_dwordx4 v[220:223], v7, s[48:51], s36 offen sc1
    s_add_u32 s36, s36, 131072
    s_waitcnt lgkmcnt(1)
    buffer_store_dwordx4 v[224:227], v7, s[48:51], s36 offen sc1
    s_add_u32 s36, s36, 131072
    s_waitcnt lgkmcnt(0)
    buffer_store_dwordx4 v[228:231], v7, s[48:51], s36 offen sc1
    s_sub_u32 s36, s33, 3
    s_and_b32 s37, s33, 3
    s_cmp_lt_u32 s36, 4
    s_cselect_b64 s[40:41], s[24:25], s[14:15]
    s_cselect_b32 s36, s36, s37
    s_cselect_b32 s45, 262144, 0
    s_cselect_b32 s46, 8388608, 0
    s_add_u32 s45, s45, 524288
    s_add_u32 s46, s46, 196608
    s_mov_b32 s42, 4194304
    s_mov_b32 s43, 0x20000
    s_lshl_b32 s38, s32, 17
    s_add_u32 s44, s38, 0
    s_lshl_b32 s38, s34, 15
    s_add_u32 s44, s38, s44
    s_lshl_b32 s38, s36, 8
    s_add_u32 s44, s38, s44
    s_lshl_b32 s38, s36, 16
    s_add_u32 s45, s38, s45
    s_lshr_b32 s38, s34, 1
    s_lshl_b32 s38, s38, 15
    s_add_u32 s45, s38, s45
    s_lshl_b32 s38, s32, 8
    s_add_u32 s45, s38, s45
    s_bfe_u32 s38, s34, 0x10000
    s_lshl_b32 s38, s38, 7
    s_add_u32 s45, s38, s45
    s_lshl_b32 s38, s32, 11
    s_add_u32 s46, s38, s46
    s_lshl_b32 s38, s34, 9
    s_add_u32 s46, s38, s46
    s_mov_b32 s72, s26
    s_and_b32 s73, s27, 0xffff
    s_mov_b32 s74, 8192
    s_mov_b32 s75, 0x20000
    s_lshl_b32 s39, s34, 13
    s_add_u32 s39, s39, 98304
    s_mov_b32 m0, s39
    s_nop 0
    buffer_load_dwordx4 v76, s[40:43], s44 offen offset:0 nt lds
    buffer_load_dwordx4 v77, s[40:43], s44 offen offset:1024 nt lds
    buffer_load_dwordx4 v78, s[40:43], s44 offen offset:2048 nt lds
    buffer_load_dwordx4 v79, s[40:43], s44 offen offset:3072 nt lds
    s_lshl_b32 s39, s34, 13
    s_add_u32 s39, s39, 102400
    s_mov_b32 m0, s39
    s_add_u32 s44, s44, 16384
    buffer_load_dwordx4 v76, s[40:43], s44 offen offset:0 nt lds
    buffer_load_dwordx4 v77, s[40:43], s44 offen offset:1024 nt lds
    buffer_load_dwordx4 v78, s[40:43], s44 offen offset:2048 nt lds
    buffer_load_dwordx4 v79, s[40:43], s44 offen offset:3072 nt lds
    v_lshlrev_b32 v30, 4, v3
    v_lshl_add_u32 v30, v2, 13, v30
    s_lshl_b32 s38, s32, 13
    s_add_u32 s36, s38, 0
    s_lshl_b32 s38, s34, 6
    s_add_u32 s36, s38, s36
    v_lshrrev_b32 v5, 2, v1
    v_lshlrev_b32 v32, 8, v5
    v_bfe_u32 v5, v1, 0, 2
    v_lshl_add_u32 v32, v5, 4, v32
    v_add_u32 v32, s36, v32
    s_lshr_b32 s38, s32, 2
    s_lshl_b32 s38, s38, 7
    s_add_u32 s36, s38, 0
    s_lshl_b32 s38, s34, 5
    s_add_u32 s36, s38, s36
    s_bfe_u32 s38, s32, 0x20000
    s_lshl_b32 s38, s38, 3
    s_add_u32 s36, s38, s36
    v_bfe_u32 v5, v1, 0, 2
    v_lshlrev_b32 v33, 11, v5
    v_lshl_add_u32 v33, v2, 1, v33
    v_add_u32 v33, s36, v33
    v_and_b32 v5, 31, v1
    v_lshlrev_b32 v34, 4, v5
    s_mul_i32 s38, s34, 320
    s_add_u32 s38, s38, 135168
    v_lshl_add_u32 v35, v5, 3, s38
    v_and_b32 v4, 3, v3
    v_bfe_u32 v5, v3, 0, 2
    v_lshlrev_b32 v81, 11, v5
    v_lshrrev_b32 v5, 2, v3
    v_lshl_add_u32 v81, v5, 8, v81
    v_and_b32 v5, 12, v3
    v_xor_b32 v5, v5, v2
    v_and_b32 v6, 1, v3
    v_lshlrev_b32 v6, 1, v6
    v_xor_b32 v5, v5, v6
    v_lshlrev_b32 v80, 4, v5
    v_bfe_u32 v6, v3, 0, 2
    v_lshl_add_u32 v80, v6, 11, v80
    v_lshrrev_b32 v6, 2, v3
    v_lshl_add_u32 v80, v6, 8, v80
    v_add_u32 v80, s85, v80
    v_lshlrev_b32 v4, 9, v4
    v_lshl_add_u32 v4, v2, 4, v4
    v_add_u32 v94, s85, v4
    s_lshl_b32 s38, s34, 9
    s_add_u32 s38, s38, 131072
    v_and_b32 v5, 31, v1
    v_lshl_add_u32 v102, v5, 4, s38
    s_lshl_b32 s38, s32, 15
    s_add_u32 s36, s38, 2097152
    s_lshl_b32 s38, s34, 8
    s_add_u32 s36, s38, s36
    s_lshl_b32 s38, s32, 3
    s_add_u32 s37, s38, 163840
    s_lshl_b32 s38, s34, 13
    s_add_u32 s37, s38, s37
    s_lshl_b32 s38, s32, 8
    s_add_u32 s69, s38, 131072
    s_lshl_b32 s38, s34, 13
    s_add_u32 s69, s38, s69
    v_mov_b32 v4, s69
    v_mov_b32 v5, s68
    s_waitcnt vmcnt(8)
    s_mov_b64 exec, 1
    buffer_store_dword v5, v4, s[48:51], 0 offen sc1
    s_mov_b64 exec, -1
    s_mov_b32 s86, 131072
    buffer_load_dword v7, v101, s[48:51], s86 offen sc1
    s_waitcnt vmcnt(0)
L_fcheck_25:
    v_cmp_ne_u32 vcc, s68, v7
    s_cbranch_vccz L_fok_26
    s_sleep 2
    s_mov_b32 s86, 131072
    buffer_load_dword v7, v101, s[48:51], s86 offen sc1
    s_waitcnt vmcnt(0)
    s_sub_u32 s84, s84, 1
    s_cmp_lg_u32 s84, 0
    s_cbranch_scc1 L_fcheck_25
    s_branch L_end
L_fok_26:
    buffer_load_dwordx2 v[52:53], v81, s[48:51], s37 offen sc1
    s_add_u32 s37, s37, 1024
    buffer_load_dwordx2 v[54:55], v81, s[48:51], s37 offen sc1
    buffer_load_dwordx4 v[200:203], v9, s[48:51], s36 offen sc1
    s_add_u32 s36, s36, 4096
    buffer_load_dwordx4 v[204:207], v9, s[48:51], s36 offen sc1
    s_add_u32 s36, s36, 4096
    buffer_load_dwordx4 v[208:211], v9, s[48:51], s36 offen sc1
    s_add_u32 s36, s36, 4096
    buffer_load_dwordx4 v[212:215], v9, s[48:51], s36 offen sc1
    s_add_u32 s36, s36, 4096
    buffer_load_dwordx4 v[216:219], v9, s[48:51], s36 offen sc1
    s_add_u32 s36, s36, 4096
    buffer_load_dwordx4 v[220:223], v9, s[48:51], s36 offen sc1
    s_add_u32 s36, s36, 4096
    buffer_load_dwordx4 v[224:227], v9, s[48:51], s36 offen sc1
    s_add_u32 s36, s36, 4096
    buffer_load_dwordx4 v[228:231], v9, s[48:51], s36 offen sc1
    v_xor_b32 v82, 0, v80
    v_xor_b32 v83, 64, v80
    v_xor_b32 v84, 128, v80
    v_xor_b32 v85, 192, v80
    v_xor_b32 v86, 16, v80
    v_xor_b32 v87, 80, v80
    v_xor_b32 v88, 144, v80
    v_xor_b32 v89, 208, v80
    s_waitcnt vmcnt(8)
    v_max_f32 v4, v52, v54
    s_nop 1
    v_max_f32_dpp v4, v4, v4 row_ror:8 row_mask:0xf bank_mask:0xf
    s_nop 1
    v_max_f32_dpp v4, v4, v4 row_ror:4 row_mask:0xf bank_mask:0xf
    v_sub_f32 v52, v52, v4
    v_sub_f32 v54, v54, v4
    v_exp_f32 v52, v52
    v_exp_f32 v54, v54
    v_mul_f32 v5, v52, v53
    v_fmac_f32 v5, v54, v55
    s_nop 1
    v_add_f32_dpp v5, v5, v5 row_ror:8 row_mask:0xf bank_mask:0xf
    s_nop 1
    v_add_f32_dpp v5, v5, v5 row_ror:4 row_mask:0xf bank_mask:0xf
    v_rcp_f32 v5, v5
    s_nop 0
    v_mul_f32 v52, v52, v5
    v_mul_f32 v54, v54, v5
    s_waitcnt vmcnt(7)
    ds_write_b128 v96, v[200:203] offset:0
    s_waitcnt vmcnt(6)
    ds_write_b128 v97, v[204:207] offset:1024
    s_waitcnt vmcnt(5)
    ds_write_b128 v98, v[208:211] offset:2048
    s_waitcnt vmcnt(4)
    ds_write_b128 v99, v[212:215] offset:3072
    s_waitcnt vmcnt(3)
    ds_write_b128 v96, v[216:219] offset:4096
    s_waitcnt vmcnt(2)
    ds_write_b128 v97, v[220:223] offset:5120
    s_waitcnt vmcnt(1)
    ds_write_b128 v98, v[224:227] offset:6144
    s_waitcnt vmcnt(0)
    ds_write_b128 v99, v[228:231] offset:7168
    s_waitcnt lgkmcnt(0)
    ds_read_b128 v[136:139], v82 offset:0
    ds_read_b128 v[140:143], v83 offset:0
    ds_read_b128 v[144:147], v84 offset:0
    ds_read_b128 v[148:151], v85 offset:0
    ds_read_b128 v[152:155], v86 offset:1024
    ds_read_b128 v[156:159], v87 offset:1024
    ds_read_b128 v[160:163], v88 offset:1024
    ds_read_b128 v[164:167], v89 offset:1024
    s_waitcnt lgkmcnt(0)
    v_mfma_f32_16x16x32_bf16 v[60:63], a[128:131], v[136:139], 0
    v_mfma_f32_16x16x32_bf16 v[64:67], a[128:131], v[152:155], 0
    v_mfma_f32_16x16x32_bf16 v[60:63], a[132:135], v[140:143], v[60:63]
    v_mfma_f32_16x16x32_bf16 v[64:67], a[132:135], v[156:159], v[64:67]
    v_mfma_f32_16x16x32_bf16 v[60:63], a[136:139], v[144:147], v[60:63]
    v_mfma_f32_16x16x32_bf16 v[64:67], a[136:139], v[160:163], v[64:67]
    v_mfma_f32_16x16x32_bf16 v[60:63], a[140:143], v[148:151], v[60:63]
    v_mfma_f32_16x16x32_bf16 v[64:67], a[140:143], v[164:167], v[64:67]
    v_mfma_f32_16x16x32_bf16 v[68:71], a[144:147], v[136:139], 0
    v_mfma_f32_16x16x32_bf16 v[72:75], a[144:147], v[152:155], 0
    v_mfma_f32_16x16x32_bf16 v[68:71], a[148:151], v[140:143], v[68:71]
    v_mfma_f32_16x16x32_bf16 v[72:75], a[148:151], v[156:159], v[72:75]
    v_mfma_f32_16x16x32_bf16 v[68:71], a[152:155], v[144:147], v[68:71]
    v_mfma_f32_16x16x32_bf16 v[72:75], a[152:155], v[160:163], v[72:75]
    v_mfma_f32_16x16x32_bf16 v[68:71], a[156:159], v[148:151], v[68:71]
    v_mfma_f32_16x16x32_bf16 v[72:75], a[156:159], v[164:167], v[72:75]
    v_mul_f32 v104, v60, v52
    v_mul_f32 v105, v61, v52
    v_mul_f32 v106, v62, v52
    v_mul_f32 v107, v63, v52
    v_fmac_f32 v104, v64, v54
    v_fmac_f32 v105, v65, v54
    v_fmac_f32 v106, v66, v54
    v_fmac_f32 v107, v67, v54
    v_add_f32_dpp v104, v104, v104 row_ror:8 row_mask:0xf bank_mask:0xf
    v_add_f32_dpp v105, v105, v105 row_ror:8 row_mask:0xf bank_mask:0xf
    v_add_f32_dpp v106, v106, v106 row_ror:8 row_mask:0xf bank_mask:0xf
    v_add_f32_dpp v107, v107, v107 row_ror:8 row_mask:0xf bank_mask:0xf
    v_add_f32_dpp v104, v104, v104 row_ror:4 row_mask:0xf bank_mask:0xf
    v_add_f32_dpp v105, v105, v105 row_ror:4 row_mask:0xf bank_mask:0xf
    v_add_f32_dpp v106, v106, v106 row_ror:4 row_mask:0xf bank_mask:0xf
    v_add_f32_dpp v107, v107, v107 row_ror:4 row_mask:0xf bank_mask:0xf
    ds_write_b128 v94, v[104:107] offset:0
    v_mfma_f32_16x16x32_bf16 v[60:63], a[160:163], v[136:139], 0
    v_mfma_f32_16x16x32_bf16 v[64:67], a[160:163], v[152:155], 0
    v_mfma_f32_16x16x32_bf16 v[60:63], a[164:167], v[140:143], v[60:63]
    v_mfma_f32_16x16x32_bf16 v[64:67], a[164:167], v[156:159], v[64:67]
    v_mfma_f32_16x16x32_bf16 v[60:63], a[168:171], v[144:147], v[60:63]
    v_mfma_f32_16x16x32_bf16 v[64:67], a[168:171], v[160:163], v[64:67]
    v_mfma_f32_16x16x32_bf16 v[60:63], a[172:175], v[148:151], v[60:63]
    v_mfma_f32_16x16x32_bf16 v[64:67], a[172:175], v[164:167], v[64:67]
    v_mul_f32 v108, v68, v52
    v_mul_f32 v109, v69, v52
    v_mul_f32 v110, v70, v52
    v_mul_f32 v111, v71, v52
    v_fmac_f32 v108, v72, v54
    v_fmac_f32 v109, v73, v54
    v_fmac_f32 v110, v74, v54
    v_fmac_f32 v111, v75, v54
    v_add_f32_dpp v108, v108, v108 row_ror:8 row_mask:0xf bank_mask:0xf
    v_add_f32_dpp v109, v109, v109 row_ror:8 row_mask:0xf bank_mask:0xf
    v_add_f32_dpp v110, v110, v110 row_ror:8 row_mask:0xf bank_mask:0xf
    v_add_f32_dpp v111, v111, v111 row_ror:8 row_mask:0xf bank_mask:0xf
    v_add_f32_dpp v108, v108, v108 row_ror:4 row_mask:0xf bank_mask:0xf
    v_add_f32_dpp v109, v109, v109 row_ror:4 row_mask:0xf bank_mask:0xf
    v_add_f32_dpp v110, v110, v110 row_ror:4 row_mask:0xf bank_mask:0xf
    v_add_f32_dpp v111, v111, v111 row_ror:4 row_mask:0xf bank_mask:0xf
    ds_write_b128 v94, v[108:111] offset:64
    v_mfma_f32_16x16x32_bf16 v[68:71], a[176:179], v[136:139], 0
    v_mfma_f32_16x16x32_bf16 v[72:75], a[176:179], v[152:155], 0
    v_mfma_f32_16x16x32_bf16 v[68:71], a[180:183], v[140:143], v[68:71]
    v_mfma_f32_16x16x32_bf16 v[72:75], a[180:183], v[156:159], v[72:75]
    v_mfma_f32_16x16x32_bf16 v[68:71], a[184:187], v[144:147], v[68:71]
    v_mfma_f32_16x16x32_bf16 v[72:75], a[184:187], v[160:163], v[72:75]
    v_mfma_f32_16x16x32_bf16 v[68:71], a[188:191], v[148:151], v[68:71]
    v_mfma_f32_16x16x32_bf16 v[72:75], a[188:191], v[164:167], v[72:75]
    v_mul_f32 v104, v60, v52
    v_mul_f32 v105, v61, v52
    v_mul_f32 v106, v62, v52
    v_mul_f32 v107, v63, v52
    v_fmac_f32 v104, v64, v54
    v_fmac_f32 v105, v65, v54
    v_fmac_f32 v106, v66, v54
    v_fmac_f32 v107, v67, v54
    v_add_f32_dpp v104, v104, v104 row_ror:8 row_mask:0xf bank_mask:0xf
    v_add_f32_dpp v105, v105, v105 row_ror:8 row_mask:0xf bank_mask:0xf
    v_add_f32_dpp v106, v106, v106 row_ror:8 row_mask:0xf bank_mask:0xf
    v_add_f32_dpp v107, v107, v107 row_ror:8 row_mask:0xf bank_mask:0xf
    v_add_f32_dpp v104, v104, v104 row_ror:4 row_mask:0xf bank_mask:0xf
    v_add_f32_dpp v105, v105, v105 row_ror:4 row_mask:0xf bank_mask:0xf
    v_add_f32_dpp v106, v106, v106 row_ror:4 row_mask:0xf bank_mask:0xf
    v_add_f32_dpp v107, v107, v107 row_ror:4 row_mask:0xf bank_mask:0xf
    ds_write_b128 v94, v[104:107] offset:128
    v_mfma_f32_16x16x32_bf16 v[60:63], a[192:195], v[136:139], 0
    v_mfma_f32_16x16x32_bf16 v[64:67], a[192:195], v[152:155], 0
    v_mfma_f32_16x16x32_bf16 v[60:63], a[196:199], v[140:143], v[60:63]
    v_mfma_f32_16x16x32_bf16 v[64:67], a[196:199], v[156:159], v[64:67]
    v_mfma_f32_16x16x32_bf16 v[60:63], a[200:203], v[144:147], v[60:63]
    v_mfma_f32_16x16x32_bf16 v[64:67], a[200:203], v[160:163], v[64:67]
    v_mfma_f32_16x16x32_bf16 v[60:63], a[204:207], v[148:151], v[60:63]
    v_mfma_f32_16x16x32_bf16 v[64:67], a[204:207], v[164:167], v[64:67]
    v_mul_f32 v108, v68, v52
    v_mul_f32 v109, v69, v52
    v_mul_f32 v110, v70, v52
    v_mul_f32 v111, v71, v52
    v_fmac_f32 v108, v72, v54
    v_fmac_f32 v109, v73, v54
    v_fmac_f32 v110, v74, v54
    v_fmac_f32 v111, v75, v54
    v_add_f32_dpp v108, v108, v108 row_ror:8 row_mask:0xf bank_mask:0xf
    v_add_f32_dpp v109, v109, v109 row_ror:8 row_mask:0xf bank_mask:0xf
    v_add_f32_dpp v110, v110, v110 row_ror:8 row_mask:0xf bank_mask:0xf
    v_add_f32_dpp v111, v111, v111 row_ror:8 row_mask:0xf bank_mask:0xf
    v_add_f32_dpp v108, v108, v108 row_ror:4 row_mask:0xf bank_mask:0xf
    v_add_f32_dpp v109, v109, v109 row_ror:4 row_mask:0xf bank_mask:0xf
    v_add_f32_dpp v110, v110, v110 row_ror:4 row_mask:0xf bank_mask:0xf
    v_add_f32_dpp v111, v111, v111 row_ror:4 row_mask:0xf bank_mask:0xf
    ds_write_b128 v94, v[108:111] offset:192
    v_mfma_f32_16x16x32_bf16 v[68:71], a[208:211], v[136:139], 0
    v_mfma_f32_16x16x32_bf16 v[72:75], a[208:211], v[152:155], 0
    v_mfma_f32_16x16x32_bf16 v[68:71], a[212:215], v[140:143], v[68:71]
    v_mfma_f32_16x16x32_bf16 v[72:75], a[212:215], v[156:159], v[72:75]
    v_mfma_f32_16x16x32_bf16 v[68:71], a[216:219], v[144:147], v[68:71]
    v_mfma_f32_16x16x32_bf16 v[72:75], a[216:219], v[160:163], v[72:75]
    v_mfma_f32_16x16x32_bf16 v[68:71], a[220:223], v[148:151], v[68:71]
    v_mfma_f32_16x16x32_bf16 v[72:75], a[220:223], v[164:167], v[72:75]
    v_mul_f32 v104, v60, v52
    v_mul_f32 v105, v61, v52
    v_mul_f32 v106, v62, v52
    v_mul_f32 v107, v63, v52
    v_fmac_f32 v104, v64, v54
    v_fmac_f32 v105, v65, v54
    v_fmac_f32 v106, v66, v54
    v_fmac_f32 v107, v67, v54
    v_add_f32_dpp v104, v104, v104 row_ror:8 row_mask:0xf bank_mask:0xf
    v_add_f32_dpp v105, v105, v105 row_ror:8 row_mask:0xf bank_mask:0xf
    v_add_f32_dpp v106, v106, v106 row_ror:8 row_mask:0xf bank_mask:0xf
    v_add_f32_dpp v107, v107, v107 row_ror:8 row_mask:0xf bank_mask:0xf
    v_add_f32_dpp v104, v104, v104 row_ror:4 row_mask:0xf bank_mask:0xf
    v_add_f32_dpp v105, v105, v105 row_ror:4 row_mask:0xf bank_mask:0xf
    v_add_f32_dpp v106, v106, v106 row_ror:4 row_mask:0xf bank_mask:0xf
    v_add_f32_dpp v107, v107, v107 row_ror:4 row_mask:0xf bank_mask:0xf
    ds_write_b128 v94, v[104:107] offset:256
    v_mfma_f32_16x16x32_bf16 v[60:63], a[224:227], v[136:139], 0
    v_mfma_f32_16x16x32_bf16 v[64:67], a[224:227], v[152:155], 0
    v_mfma_f32_16x16x32_bf16 v[60:63], a[228:231], v[140:143], v[60:63]
    v_mfma_f32_16x16x32_bf16 v[64:67], a[228:231], v[156:159], v[64:67]
    v_mfma_f32_16x16x32_bf16 v[60:63], a[232:235], v[144:147], v[60:63]
    v_mfma_f32_16x16x32_bf16 v[64:67], a[232:235], v[160:163], v[64:67]
    v_mfma_f32_16x16x32_bf16 v[60:63], a[236:239], v[148:151], v[60:63]
    v_mfma_f32_16x16x32_bf16 v[64:67], a[236:239], v[164:167], v[64:67]
    v_mul_f32 v108, v68, v52
    v_mul_f32 v109, v69, v52
    v_mul_f32 v110, v70, v52
    v_mul_f32 v111, v71, v52
    v_fmac_f32 v108, v72, v54
    v_fmac_f32 v109, v73, v54
    v_fmac_f32 v110, v74, v54
    v_fmac_f32 v111, v75, v54
    v_add_f32_dpp v108, v108, v108 row_ror:8 row_mask:0xf bank_mask:0xf
    v_add_f32_dpp v109, v109, v109 row_ror:8 row_mask:0xf bank_mask:0xf
    v_add_f32_dpp v110, v110, v110 row_ror:8 row_mask:0xf bank_mask:0xf
    v_add_f32_dpp v111, v111, v111 row_ror:8 row_mask:0xf bank_mask:0xf
    v_add_f32_dpp v108, v108, v108 row_ror:4 row_mask:0xf bank_mask:0xf
    v_add_f32_dpp v109, v109, v109 row_ror:4 row_mask:0xf bank_mask:0xf
    v_add_f32_dpp v110, v110, v110 row_ror:4 row_mask:0xf bank_mask:0xf
    v_add_f32_dpp v111, v111, v111 row_ror:4 row_mask:0xf bank_mask:0xf
    ds_write_b128 v94, v[108:111] offset:320
    v_mfma_f32_16x16x32_bf16 v[68:71], a[240:243], v[136:139], 0
    v_mfma_f32_16x16x32_bf16 v[72:75], a[240:243], v[152:155], 0
    v_mfma_f32_16x16x32_bf16 v[68:71], a[244:247], v[140:143], v[68:71]
    v_mfma_f32_16x16x32_bf16 v[72:75], a[244:247], v[156:159], v[72:75]
    v_mfma_f32_16x16x32_bf16 v[68:71], a[248:251], v[144:147], v[68:71]
    v_mfma_f32_16x16x32_bf16 v[72:75], a[248:251], v[160:163], v[72:75]
    v_mfma_f32_16x16x32_bf16 v[68:71], a[252:255], v[148:151], v[68:71]
    v_mfma_f32_16x16x32_bf16 v[72:75], a[252:255], v[164:167], v[72:75]
    v_mul_f32 v104, v60, v52
    v_mul_f32 v105, v61, v52
    v_mul_f32 v106, v62, v52
    v_mul_f32 v107, v63, v52
    v_fmac_f32 v104, v64, v54
    v_fmac_f32 v105, v65, v54
    v_fmac_f32 v106, v66, v54
    v_fmac_f32 v107, v67, v54
    v_add_f32_dpp v104, v104, v104 row_ror:8 row_mask:0xf bank_mask:0xf
    v_add_f32_dpp v105, v105, v105 row_ror:8 row_mask:0xf bank_mask:0xf
    v_add_f32_dpp v106, v106, v106 row_ror:8 row_mask:0xf bank_mask:0xf
    v_add_f32_dpp v107, v107, v107 row_ror:8 row_mask:0xf bank_mask:0xf
    v_add_f32_dpp v104, v104, v104 row_ror:4 row_mask:0xf bank_mask:0xf
    v_add_f32_dpp v105, v105, v105 row_ror:4 row_mask:0xf bank_mask:0xf
    v_add_f32_dpp v106, v106, v106 row_ror:4 row_mask:0xf bank_mask:0xf
    v_add_f32_dpp v107, v107, v107 row_ror:4 row_mask:0xf bank_mask:0xf
    ds_write_b128 v94, v[104:107] offset:384
    v_mul_f32 v108, v68, v52
    v_mul_f32 v109, v69, v52
    v_mul_f32 v110, v70, v52
    v_mul_f32 v111, v71, v52
    v_fmac_f32 v108, v72, v54
    v_fmac_f32 v109, v73, v54
    v_fmac_f32 v110, v74, v54
    v_fmac_f32 v111, v75, v54
    v_add_f32_dpp v108, v108, v108 row_ror:8 row_mask:0xf bank_mask:0xf
    v_add_f32_dpp v109, v109, v109 row_ror:8 row_mask:0xf bank_mask:0xf
    v_add_f32_dpp v110, v110, v110 row_ror:8 row_mask:0xf bank_mask:0xf
    v_add_f32_dpp v111, v111, v111 row_ror:8 row_mask:0xf bank_mask:0xf
    v_add_f32_dpp v108, v108, v108 row_ror:4 row_mask:0xf bank_mask:0xf
    v_add_f32_dpp v109, v109, v109 row_ror:4 row_mask:0xf bank_mask:0xf
    v_add_f32_dpp v110, v110, v110 row_ror:4 row_mask:0xf bank_mask:0xf
    v_add_f32_dpp v111, v111, v111 row_ror:4 row_mask:0xf bank_mask:0xf
    ds_write_b128 v94, v[108:111] offset:448
    s_waitcnt lgkmcnt(0)
    s_barrier
    ds_read_b128 v[136:139], v102 offset:0
    ds_read_b128 v[140:143], v102 offset:8192
    ds_read_b128 v[144:147], v102 offset:16384
    ds_read_b128 v[148:151], v102 offset:24576
    s_waitcnt lgkmcnt(0)
    v_add_f32 v136, v136, v140
    v_add_f32 v144, v144, v148
    v_add_f32 v137, v137, v141
    v_add_f32 v145, v145, v149
    v_add_f32 v138, v138, v142
    v_add_f32 v146, v146, v150
    v_add_f32 v139, v139, v143
    v_add_f32 v147, v147, v151
    v_add_f32 v136, v136, v144
    v_add_f32 v137, v137, v145
    v_add_f32 v138, v138, v146
    v_add_f32 v139, v139, v147
    s_mov_b32 s38, 0xffff0000
    v_cvt_pk_bf16_f32 v136, v136, v136
    v_cvt_pk_bf16_f32 v137, v137, v137
    v_cvt_pk_bf16_f32 v138, v138, v138
    v_cvt_pk_bf16_f32 v139, v139, v139
    v_and_or_b32 v136, v136, s38, v8
    v_and_or_b32 v137, v137, s38, v8
    v_and_or_b32 v138, v138, s38, v8
    v_and_or_b32 v139, v139, s38, v8
    s_mov_b32 exec_lo, 0xffffffff
    s_mov_b32 exec_hi, 0x0
    buffer_store_dwordx4 v[136:139], v34, s[48:51], s46 offen sc1
    s_mov_b64 exec, -1
    v_xor_b32 v224, s35, v136
    v_xor_b32 v225, s35, v137
    v_xor_b32 v226, s35, v138
    v_xor_b32 v227, s35, v139
    v_lshlrev_b32 v4, 11, v2
    v_bfe_u32 v5, v1, 2, 2
    v_lshl_add_u32 v4, v5, 8, v4
    v_bfe_u32 v5, v1, 2, 2
    v_lshl_add_u32 v4, v5, 6, v4
    v_bfe_u32 v5, v1, 4, 1
    v_lshl_add_u32 v4, v5, 5, v4
    v_bfe_u32 v5, v1, 1, 1
    v_lshl_add_u32 v4, v5, 4, v4
    v_bfe_u32 v5, v1, 0, 1
    v_lshl_add_u32 v4, v5, 3, v4
    s_lshl_b32 s38, s34, 6
    s_add_u32 s38, s38, 98304
    v_xor_b32 v24, s38, v4
    v_xor_b32 v25, 16, v24
    v_xor_b32 v26, 32, v24
    v_xor_b32 v27, 48, v24
    v_and_b32 v4, 3, v3
    v_lshrrev_b32 v5, 2, v3
    v_lshlrev_b32 v6, 4, v2
    v_add_u32 v6, 135168, v6
    s_movk_i32 s36, 320
    v_cmp_eq_u32 vcc, 0, v5
    s_nop 1
    v_cndmask_b32 v28, 4, v4, vcc
    v_mad_u32_u24 v28, v28, s36, v6
    v_cmp_eq_u32 vcc, 1, v5
    s_nop 1
    v_cndmask_b32 v29, 4, v4, vcc
    v_mad_u32_u24 v29, v29, s36, v6
    v_lshlrev_b32 v5, 2, v1
    v_add_u32 v5, 136448, v5
    v_mov_b32 v6, 0
    ds_write_b32 v5, v6
    s_branch L_ctxok
.section .rodata,"a"
.p2align 6
.amdhsa_kernel concat_heads__compressed_kv_cla__mha_block_cached__decode_kernel
  .amdhsa_next_free_vgpr 512
  .amdhsa_next_free_sgpr 102
  .amdhsa_accum_offset 256
  .amdhsa_group_segment_fixed_size 0
  .amdhsa_kernarg_size 112
  .amdhsa_user_sgpr_count 2
  .amdhsa_user_sgpr_kernarg_segment_ptr 1
  .amdhsa_system_sgpr_workgroup_id_x 1
.end_amdhsa_kernel
```

```asm
; @launch grid=(256,1,1) block=(256,1,1) lds=163840
    .amdgcn_target "amdgcn-amd-amdhsa--gfx950"
    .text
    .globl concat_heads__compressed_kv_cla__mha_block_cached__decode_kernel
    .p2align 8
    .type concat_heads__compressed_kv_cla__mha_block_cached__decode_kernel,@function
concat_heads__compressed_kv_cla__mha_block_cached__decode_kernel:
    s_cmp_ge_u32 s2, 256
    s_cbranch_scc1 L_end
    s_load_dwordx16 s[4:19], s[0:1], 0
    s_load_dwordx8 s[20:27], s[0:1], 64
    s_load_dwordx4 s[28:31], s[0:1], 96
    v_lshrrev_b32 v4, 6, v0
    v_and_b32 v1, 63, v0
    v_readfirstlane_b32 s34, v4
    s_lshr_b32 s32, s2, 3
    s_sub_u32 s33, s2, s32
    s_sub_u32 s33, s33, 1
    s_and_b32 s33, s33, 7
    v_lshrrev_b32 v2, 4, v1
    v_and_b32 v3, 15, v1
    s_cmp_lt_u32 s33, 2
    s_cbranch_scc1 L_qp
    s_cmp_eq_u32 s33, 2
    s_cbranch_scc1 L_ql
    s_cmp_eq_u32 s33, 7
    s_cbranch_scc1 L_aux
    s_bfe_u32 s38, s2, 0x30000
    s_lshl_b32 s38, s38, 21
    s_add_u32 s36, s38, -393216
    s_lshr_b32 s38, s32, 3
    s_lshl_b32 s38, s38, 19
    s_add_u32 s36, s38, s36
    s_lshl_b32 s38, s33, 17
    s_add_u32 s36, s38, s36
    s_lshl_b32 s38, s34, 12
    s_add_u32 s36, s38, s36
    v_bfe_u32 v5, v1, 0, 5
    v_lshlrev_b32 v4, 7, v5
    v_lshrrev_b32 v5, 5, v1
    v_lshl_add_u32 v4, v5, 15, v4
    s_mov_b32 s42, 16777216
    s_mov_b32 s43, 0x20000
    s_waitcnt lgkmcnt(0)
    s_mov_b64 s[40:41], s[6:7]
    buffer_load_dword v20, v4, s[40:43], s36 offen
    s_add_u32 s36, s36, 16384
    buffer_load_dword v21, v4, s[40:43], s36 offen
    s_add_u32 s36, s36, 49152
    buffer_load_dword v22, v4, s[40:43], s36 offen
    s_add_u32 s36, s36, 16384
    buffer_load_dword v23, v4, s[40:43], s36 offen
    s_load_dword s35, s[30:31], 0
    s_mov_b32 s48, s30
    s_and_b32 s49, s31, 0xffff
    s_mov_b32 s50, 8388608
    s_mov_b32 s51, 0x20000
    s_mov_b32 s82, 0xffffff00
    s_mov_b32 s83, 0x3e0293ee
    s_mov_b32 s84, 2097152
    v_lshrrev_b32 v4, 2, v3
    v_and_b32 v5, 3, v3
    v_lshlrev_b32 v76, 8, v4
    v_lshlrev_b32 v126, 8, v2
    v_lshl_add_u32 v76, v2, 6, v76
    v_lshl_add_u32 v76, v5, 4, v76
    v_lshl_add_u32 v126, v3, 4, v126
    v_xor_b32 v77, 32768, v76
    v_xor_b32 v127, 32768, v126
    s_add_u32 s3, s34, s33
    s_and_b32 s3, s3, 3
    s_lshl_b32 s89, s3, 5
    s_add_u32 s89, s89, s32
    s_lshl_b32 s89, s89, 20
    s_mul_i32 s88, s32, 8
    s_add_u32 s88, s88, s3
    s_lshl_b32 s87, s33, 0
    s_mov_b32 s52, s18
    s_and_b32 s53, s19, 0xffff
    s_mov_b32 s54, 134217728
    s_mov_b32 s55, 0x20000
    s_mov_b32 s56, s20
    s_and_b32 s57, s21, 0xffff
    s_mov_b32 s58, 134217728
    s_mov_b32 s59, 0x20000
    v_and_b32 v4, 1, v1
    v_lshlrev_b32 v4, 4, v4
    v_mov_b32 v5, 0xffff
    v_lshlrev_b32 v4, v4, v5
    v_bfe_u32 v5, v1, 1, 2
    v_cmp_eq_u32 vcc, 0, v5
    s_nop 1
    v_cndmask_b32 v10, 0, v4, vcc
    v_cmp_eq_u32 vcc, 1, v5
    s_nop 1
    v_cndmask_b32 v11, 0, v4, vcc
    v_cmp_eq_u32 vcc, 2, v5
    s_nop 1
    v_cndmask_b32 v12, 0, v4, vcc
    v_cmp_eq_u32 vcc, 3, v5
    s_nop 1
    v_cndmask_b32 v13, 0, v4, vcc
    v_mov_b32 v120, 0xff7f0000
    v_mov_b32 v121, 0
    v_mov_b32 v18, 1
    v_mov_b32 v116, 0
    v_mov_b32 v117, 0
    v_mov_b32 v118, 0
    v_mov_b32 v119, 0
    s_lshl_b32 s38, s32, 10
    s_add_u32 s96, s38, 65536
    s_lshl_b32 s38, s3, 8
    s_add_u32 s96, s38, s96
    v_mov_b32 v9, s96
    s_lshl_b32 s38, s32, 15
    s_add_u32 s96, s38, 1048576
    s_lshl_b32 s38, s3, 13
    s_add_u32 s96, s38, s96
    s_lshl_b32 s38, s33, 10
    s_add_u32 s96, s38, s96
    v_and_b32 v5, 3, v3
    v_lshlrev_b32 v78, 7, v2
    v_lshl_add_u32 v78, v5, 5, v78
    s_lshl_b32 s38, s32, 12
    s_add_u32 s91, s38, 262144
    s_lshl_b32 s38, s3, 9
    s_add_u32 s91, s38, s91
    v_lshlrev_b32 v4, 7, v2
    v_lshl_add_u32 v4, v3, 4, v4
    v_mov_b32 v5, 512
    v_cmp_gt_u32 vcc, 8, v3
    s_nop 1
    v_cndmask_b32 v79, v5, v4, vcc
    s_add_u32 s39, s87, s88
    s_bfe_u32 s37, s39, 0x30000
    s_lshl_b32 s37, s37, 12
    s_add_u32 s85, s37, s89
    s_bfe_u32 s37, s39, 0x10003
    s_lshl_b32 s37, s37, 11
    s_add_u32 s85, s37, s85
    s_bfe_u32 s37, s39, 0x40004
    s_lshl_b32 s37, s37, 16
    s_add_u32 s85, s37, s85
    buffer_load_dwordx4 v[128:131], v76, s[52:55], s85 offen offset:0 nt
    buffer_load_dwordx4 v[132:135], v77, s[52:55], s85 offen offset:0 nt
    buffer_load_dwordx4 v[136:139], v76, s[52:55], s85 offen offset:1024 nt
    buffer_load_dwordx4 v[140:143], v77, s[52:55], s85 offen offset:1024 nt
    s_add_u32 s87, s87, 7
    s_add_u32 s39, s87, s88
    s_bfe_u32 s37, s39, 0x30000
    s_lshl_b32 s37, s37, 12
    s_add_u32 s85, s37, s89
    s_bfe_u32 s37, s39, 0x10003
    s_lshl_b32 s37, s37, 11
    s_add_u32 s85, s37, s85
    s_bfe_u32 s37, s39, 0x40004
    s_lshl_b32 s37, s37, 16
    s_add_u32 s85, s37, s85
    buffer_load_dwordx4 v[144:147], v76, s[52:55], s85 offen offset:0 nt
    buffer_load_dwordx4 v[148:151], v77, s[52:55], s85 offen offset:0 nt
    buffer_load_dwordx4 v[152:155], v76, s[52:55], s85 offen offset:1024 nt
    s_waitcnt vmcnt(6)
    buffer_load_dwordx4 v[156:159], v77, s[52:55], s85 offen offset:1024 nt
    s_add_u32 s87, s87, 7
    s_add_u32 s39, s87, s88
    s_bfe_u32 s37, s39, 0x30000
    s_lshl_b32 s37, s37, 12
    s_add_u32 s85, s37, s89
    s_bfe_u32 s37, s39, 0x10003
    s_lshl_b32 s37, s37, 11
    s_add_u32 s85, s37, s85
    s_bfe_u32 s37, s39, 0x40004
    s_lshl_b32 s37, s37, 16
    s_add_u32 s85, s37, s85
    s_waitcnt vmcnt(6)
    buffer_load_dwordx4 v[160:163], v76, s[52:55], s85 offen offset:0 nt
    s_waitcnt vmcnt(6)
    buffer_load_dwordx4 v[164:167], v77, s[52:55], s85 offen offset:0 nt
    s_waitcnt vmcnt(6)
    buffer_load_dwordx4 v[168:171], v76, s[52:55], s85 offen offset:1024 nt
    s_waitcnt vmcnt(6)
    buffer_load_dwordx4 v[172:175], v77, s[52:55], s85 offen offset:1024 nt
    s_add_u32 s87, s87, 7
    s_add_u32 s39, s87, s88
    s_bfe_u32 s37, s39, 0x30000
    s_lshl_b32 s37, s37, 12
    s_add_u32 s85, s37, s89
    s_bfe_u32 s37, s39, 0x10003
    s_lshl_b32 s37, s37, 11
    s_add_u32 s85, s37, s85
    s_bfe_u32 s37, s39, 0x40004
    s_lshl_b32 s37, s37, 16
    s_add_u32 s85, s37, s85
    s_waitcnt vmcnt(6)
    buffer_load_dwordx4 v[176:179], v76, s[52:55], s85 offen offset:0 nt
    s_waitcnt vmcnt(6)
    buffer_load_dwordx4 v[180:183], v77, s[52:55], s85 offen offset:0 nt
    s_waitcnt vmcnt(6)
    buffer_load_dwordx4 v[184:187], v76, s[52:55], s85 offen offset:1024 nt
    s_waitcnt vmcnt(6)
    buffer_load_dwordx4 v[188:191], v77, s[52:55], s85 offen offset:1024 nt
    s_add_u32 s87, s87, 7
    s_add_u32 s39, s87, s88
    s_bfe_u32 s37, s39, 0x30000
    s_lshl_b32 s37, s37, 12
    s_add_u32 s85, s37, s89
    s_bfe_u32 s37, s39, 0x10003
    s_lshl_b32 s37, s37, 11
    s_add_u32 s85, s37, s85
    s_bfe_u32 s37, s39, 0x40004
    s_lshl_b32 s37, s37, 16
    s_add_u32 s85, s37, s85
    s_waitcnt vmcnt(6)
    buffer_load_dwordx4 v[192:195], v76, s[52:55], s85 offen offset:0 nt
    s_waitcnt vmcnt(6)
    buffer_load_dwordx4 v[196:199], v77, s[52:55], s85 offen offset:0 nt
    s_waitcnt vmcnt(6)
    buffer_load_dwordx4 v[200:203], v76, s[52:55], s85 offen offset:1024 nt
    s_waitcnt vmcnt(6)
    buffer_load_dwordx4 v[204:207], v77, s[52:55], s85 offen offset:1024 nt
    s_add_u32 s87, s87, 7
    s_add_u32 s39, s87, s88
    s_bfe_u32 s37, s39, 0x30000
    s_lshl_b32 s37, s37, 12
    s_add_u32 s85, s37, s89
    s_bfe_u32 s37, s39, 0x10003
    s_lshl_b32 s37, s37, 11
    s_add_u32 s85, s37, s85
    s_bfe_u32 s37, s39, 0x40004
    s_lshl_b32 s37, s37, 16
    s_add_u32 s85, s37, s85
    s_waitcnt vmcnt(6)
    buffer_load_dwordx4 v[208:211], v76, s[52:55], s85 offen offset:0 nt
    s_waitcnt vmcnt(6)
    buffer_load_dwordx4 v[212:215], v77, s[52:55], s85 offen offset:0 nt
    s_waitcnt vmcnt(6)
    buffer_load_dwordx4 v[216:219], v76, s[52:55], s85 offen offset:1024 nt
    s_waitcnt vmcnt(6)
    buffer_load_dwordx4 v[220:223], v77, s[52:55], s85 offen offset:1024 nt
    s_add_u32 s87, s87, 7
    s_add_u32 s39, s87, s88
    s_bfe_u32 s37, s39, 0x30000
    s_lshl_b32 s37, s37, 12
    s_add_u32 s85, s37, s89
    s_bfe_u32 s37, s39, 0x10003
    s_lshl_b32 s37, s37, 11
    s_add_u32 s85, s37, s85
    s_bfe_u32 s37, s39, 0x40004
    s_lshl_b32 s37, s37, 16
    s_add_u32 s85, s37, s85
    s_waitcnt vmcnt(6)
    buffer_load_dwordx4 v[224:227], v76, s[52:55], s85 offen offset:0 nt
    s_waitcnt vmcnt(6)
    buffer_load_dwordx4 v[228:231], v77, s[52:55], s85 offen offset:0 nt
    s_waitcnt vmcnt(6)
    buffer_load_dwordx4 v[232:235], v76, s[52:55], s85 offen offset:1024 nt
    s_waitcnt vmcnt(6)
    buffer_load_dwordx4 v[236:239], v77, s[52:55], s85 offen offset:1024 nt
    s_add_u32 s87, s87, 7
    s_add_u32 s39, s87, s88
    s_bfe_u32 s37, s39, 0x30000
    s_lshl_b32 s37, s37, 12
    s_add_u32 s85, s37, s89
    s_bfe_u32 s37, s39, 0x10003
    s_lshl_b32 s37, s37, 11
    s_add_u32 s85, s37, s85
    s_bfe_u32 s37, s39, 0x40004
    s_lshl_b32 s37, s37, 16
    s_add_u32 s85, s37, s85
    s_waitcnt vmcnt(6)
    buffer_load_dwordx4 v[240:243], v76, s[52:55], s85 offen offset:0 nt
    s_waitcnt vmcnt(6)
    buffer_load_dwordx4 v[244:247], v77, s[52:55], s85 offen offset:0 nt
    s_waitcnt vmcnt(6)
    buffer_load_dwordx4 v[248:251], v76, s[52:55], s85 offen offset:1024 nt
    s_waitcnt vmcnt(6)
    buffer_load_dwordx4 v[252:255], v77, s[52:55], s85 offen offset:1024 nt
    s_add_u32 s87, s87, 7
    s_add_u32 s39, s87, s88
    s_bfe_u32 s37, s39, 0x30000
    s_lshl_b32 s37, s37, 12
    s_add_u32 s85, s37, s89
    s_bfe_u32 s37, s39, 0x10003
    s_lshl_b32 s37, s37, 11
    s_add_u32 s85, s37, s85
    s_bfe_u32 s37, s39, 0x40004
    s_lshl_b32 s37, s37, 16
    s_add_u32 s85, s37, s85
    s_waitcnt vmcnt(6)
    buffer_load_dwordx4 a[0:3], v76, s[52:55], s85 offen offset:0 nt
    s_waitcnt vmcnt(6)
    buffer_load_dwordx4 a[4:7], v77, s[52:55], s85 offen offset:0 nt
    buffer_load_dwordx4 v[68:71], v78, s[48:51], s91 offen offset:0 sc1
    buffer_load_dwordx4 v[72:75], v78, s[48:51], s91 offen offset:16 sc1
    s_waitcnt vmcnt(8)
    buffer_load_dwordx4 a[8:11], v76, s[52:55], s85 offen offset:1024 nt
    s_waitcnt vmcnt(8)
    buffer_load_dwordx4 a[12:15], v77, s[52:55], s85 offen offset:1024 nt
    s_add_u32 s87, s87, 7
    s_add_u32 s39, s87, s88
    s_bfe_u32 s37, s39, 0x30000
    s_lshl_b32 s37, s37, 12
    s_add_u32 s85, s37, s89
    s_bfe_u32 s37, s39, 0x10003
    s_lshl_b32 s37, s37, 11
    s_add_u32 s85, s37, s85
    s_bfe_u32 s37, s39, 0x40004
    s_lshl_b32 s37, s37, 16
    s_add_u32 s85, s37, s85
    s_waitcnt vmcnt(8)
    buffer_load_dwordx4 a[16:19], v76, s[52:55], s85 offen offset:0 nt
    s_waitcnt vmcnt(8)
    buffer_load_dwordx4 a[20:23], v77, s[52:55], s85 offen offset:0 nt
    s_waitcnt vmcnt(8)
    buffer_load_dwordx4 a[24:27], v76, s[52:55], s85 offen offset:1024 nt
    s_waitcnt vmcnt(8)
    buffer_load_dwordx4 a[28:31], v77, s[52:55], s85 offen offset:1024 nt
    s_add_u32 s87, s87, 7
    s_add_u32 s39, s87, s88
    s_bfe_u32 s37, s39, 0x30000
    s_lshl_b32 s37, s37, 12
    s_add_u32 s85, s37, s89
    s_bfe_u32 s37, s39, 0x10003
    s_lshl_b32 s37, s37, 11
    s_add_u32 s85, s37, s85
    s_bfe_u32 s37, s39, 0x40004
    s_lshl_b32 s37, s37, 16
    s_add_u32 s85, s37, s85
    s_waitcnt lgkmcnt(0)
    s_add_u32 s35, s35, 0x5b
    s_and_b32 s35, s35, 0xff
    v_mov_b32 v8, s35
    s_waitcnt vmcnt(6)
L_qcheck_1:
    v_xor_b32 v68, s35, v68
    v_xor_b32 v69, s35, v69
    v_xor_b32 v70, s35, v70
    v_xor_b32 v71, s35, v71
    v_xor_b32 v72, s35, v72
    v_xor_b32 v73, s35, v73
    v_xor_b32 v74, s35, v74
    v_xor_b32 v75, s35, v75
    v_or_b32 v4, v68, v69
    v_or3_b32 v4, v4, v70, v71
    v_or3_b32 v4, v4, v72, v73
    v_or3_b32 v4, v4, v74, v75
    v_and_b32 v4, 0xff, v4
    v_cmp_ne_u32 vcc, 0, v4
    s_cbranch_vccz L_qok_2
    buffer_load_dwordx4 v[68:71], v78, s[48:51], s91 offen offset:0 sc1
    buffer_load_dwordx4 v[72:75], v78, s[48:51], s91 offen offset:16 sc1
    s_waitcnt vmcnt(0)
    s_sub_u32 s84, s84, 1
    s_cmp_lg_u32 s84, 0
    s_cbranch_scc1 L_qcheck_1
    s_branch L_end
L_qok_2:
    v_cvt_pk_bf16_f32 v68, v68, v69
    v_cvt_pk_bf16_f32 v69, v70, v71
    v_cvt_pk_bf16_f32 v70, v72, v73
    v_cvt_pk_bf16_f32 v71, v74, v75
    s_mov_b32 vcc_lo, 0xf000f
    s_mov_b32 vcc_hi, 0xf000f
    v_cndmask_b32 v80, 0, v68, vcc
    v_cndmask_b32 v81, 0, v69, vcc
    v_cndmask_b32 v82, 0, v70, vcc
    v_cndmask_b32 v83, 0, v71, vcc
    s_mov_b32 vcc_lo, 0xf000f0
    s_mov_b32 vcc_hi, 0xf000f0
    v_cndmask_b32 v84, 0, v68, vcc
    v_cndmask_b32 v85, 0, v69, vcc
    v_cndmask_b32 v86, 0, v70, vcc
    v_cndmask_b32 v87, 0, v71, vcc
    s_mov_b32 vcc_lo, 0xf000f00
    s_mov_b32 vcc_hi, 0xf000f00
    v_cndmask_b32 v88, 0, v68, vcc
    v_cndmask_b32 v89, 0, v69, vcc
    v_cndmask_b32 v90, 0, v70, vcc
    v_cndmask_b32 v91, 0, v71, vcc
    s_mov_b32 vcc_lo, 0xf000f000
    s_mov_b32 vcc_hi, 0xf000f000
    v_cndmask_b32 v92, 0, v68, vcc
    v_cndmask_b32 v93, 0, v69, vcc
    v_cndmask_b32 v94, 0, v70, vcc
    v_cndmask_b32 v95, 0, v71, vcc
    v_mov_b32 v65, 0xff7f0000
    s_lshl_b32 s38, s34, 14
    s_add_u32 s38, s38, 16384
    v_lshl_add_u32 v64, v1, 2, s38
    buffer_load_dwordx4 a[32:35], v76, s[52:55], s85 offen offset:0 nt
    v_mfma_f32_16x16x32_bf16 v[112:115], v[128:131], v[80:83], 0
    v_mfma_f32_16x16x32_bf16 v[112:115], v[132:135], v[84:87], v[112:115]
    v_mfma_f32_16x16x32_bf16 v[112:115], v[136:139], v[88:91], v[112:115]
    s_waitcnt vmcnt(6)
    buffer_load_dwordx4 a[36:39], v77, s[52:55], s85 offen offset:0 nt
    v_mfma_f32_16x16x32_bf16 v[112:115], v[140:143], v[92:95], v[112:115]
    v_mfma_f32_16x16x32_bf16 v[96:99], v[144:147], v[80:83], 0
    v_mfma_f32_16x16x32_bf16 v[96:99], v[148:151], v[84:87], v[96:99]
    s_waitcnt vmcnt(6)
    buffer_load_dwordx4 a[40:43], v76, s[52:55], s85 offen offset:1024 nt
    v_mfma_f32_16x16x32_bf16 v[96:99], v[152:155], v[88:91], v[96:99]
    s_nop 2
    v_mov_b32_dpp v122, v112 quad_perm:[0,0,0,0] row_mask:0xf bank_mask:0xf
    v_mov_b32_dpp v124, v114 quad_perm:[2,2,2,2] row_mask:0xf bank_mask:0xf
    s_nop 0
    v_add_f32_dpp v122, v113, v122 quad_perm:[1,1,1,1] row_mask:0xf bank_mask:0xf
    v_add_f32_dpp v124, v115, v124 quad_perm:[3,3,3,3] row_mask:0xf bank_mask:0xf
    v_add_f32 v122, v122, v124
    v_max_f32 v65, v65, v122
    ds_write_b32 v64, v122 offset:0
    v_mfma_f32_16x16x32_bf16 v[96:99], v[156:159], v[92:95], v[96:99]
    v_mfma_f32_16x16x32_bf16 v[112:115], v[160:163], v[80:83], 0
    v_mfma_f32_16x16x32_bf16 v[112:115], v[164:167], v[84:87], v[112:115]
    s_waitcnt vmcnt(6)
    buffer_load_dwordx4 a[44:47], v77, s[52:55], s85 offen offset:1024 nt
    s_add_u32 s87, s87, 7
    s_add_u32 s39, s87, s88
    s_bfe_u32 s37, s39, 0x30000
    s_lshl_b32 s37, s37, 12
    s_add_u32 s85, s37, s89
    s_bfe_u32 s37, s39, 0x10003
    s_lshl_b32 s37, s37, 11
    s_add_u32 s85, s37, s85
    s_bfe_u32 s37, s39, 0x40004
    s_lshl_b32 s37, s37, 16
    s_add_u32 s85, s37, s85
    v_mfma_f32_16x16x32_bf16 v[112:115], v[168:171], v[88:91], v[112:115]
    v_mov_b32_dpp v122, v96 quad_perm:[0,0,0,0] row_mask:0xf bank_mask:0xf
    v_mov_b32_dpp v124, v98 quad_perm:[2,2,2,2] row_mask:0xf bank_mask:0xf
    s_nop 0
    v_add_f32_dpp v122, v97, v122 quad_perm:[1,1,1,1] row_mask:0xf bank_mask:0xf
    v_add_f32_dpp v124, v99, v124 quad_perm:[3,3,3,3] row_mask:0xf bank_mask:0xf
    v_add_f32 v122, v122, v124
    v_max_f32 v65, v65, v122
    ds_write_b32 v64, v122 offset:256
    v_mfma_f32_16x16x32_bf16 v[112:115], v[172:175], v[92:95], v[112:115]
    v_mfma_f32_16x16x32_bf16 v[96:99], v[176:179], v[80:83], 0
    s_waitcnt vmcnt(6)
    buffer_load_dwordx4 a[48:51], v76, s[52:55], s85 offen offset:0 nt
    v_mfma_f32_16x16x32_bf16 v[96:99], v[180:183], v[84:87], v[96:99]
    v_mfma_f32_16x16x32_bf16 v[96:99], v[184:187], v[88:91], v[96:99]
    s_nop 2
    v_mov_b32_dpp v122, v112 quad_perm:[0,0,0,0] row_mask:0xf bank_mask:0xf
    v_mov_b32_dpp v124, v114 quad_perm:[2,2,2,2] row_mask:0xf bank_mask:0xf
    s_nop 0
    v_add_f32_dpp v122, v113, v122 quad_perm:[1,1,1,1] row_mask:0xf bank_mask:0xf
    v_add_f32_dpp v124, v115, v124 quad_perm:[3,3,3,3] row_mask:0xf bank_mask:0xf
    v_add_f32 v122, v122, v124
    v_max_f32 v65, v65, v122
    ds_write_b32 v64, v122 offset:512
    v_mfma_f32_16x16x32_bf16 v[96:99], v[188:191], v[92:95], v[96:99]
    v_mfma_f32_16x16x32_bf16 v[112:115], v[192:195], v[80:83], 0
    s_waitcnt vmcnt(6)
    buffer_load_dwordx4 a[52:55], v77, s[52:55], s85 offen offset:0 nt
    v_mfma_f32_16x16x32_bf16 v[112:115], v[196:199], v[84:87], v[112:115]
    v_mfma_f32_16x16x32_bf16 v[112:115], v[200:203], v[88:91], v[112:115]
    s_nop 2
    v_mov_b32_dpp v122, v96 quad_perm:[0,0,0,0] row_mask:0xf bank_mask:0xf
    v_mov_b32_dpp v124, v98 quad_perm:[2,2,2,2] row_mask:0xf bank_mask:0xf
    s_nop 0
    v_add_f32_dpp v122, v97, v122 quad_perm:[1,1,1,1] row_mask:0xf bank_mask:0xf
    v_add_f32_dpp v124, v99, v124 quad_perm:[3,3,3,3] row_mask:0xf bank_mask:0xf
    v_add_f32 v122, v122, v124
    v_max_f32 v65, v65, v122
    ds_write_b32 v64, v122 offset:768
    v_mfma_f32_16x16x32_bf16 v[112:115], v[204:207], v[92:95], v[112:115]
    s_waitcnt vmcnt(6)
    buffer_load_dwordx4 a[56:59], v76, s[52:55], s85 offen offset:1024 nt
    v_mfma_f32_16x16x32_bf16 v[96:99], v[208:211], v[80:83], 0
    v_mfma_f32_16x16x32_bf16 v[96:99], v[212:215], v[84:87], v[96:99]
    v_mfma_f32_16x16x32_bf16 v[96:99], v[216:219], v[88:91], v[96:99]
    s_nop 2
    v_mov_b32_dpp v122, v112 quad_perm:[0,0,0,0] row_mask:0xf bank_mask:0xf
    v_mov_b32_dpp v124, v114 quad_perm:[2,2,2,2] row_mask:0xf bank_mask:0xf
    s_nop 0
    v_add_f32_dpp v122, v113, v122 quad_perm:[1,1,1,1] row_mask:0xf bank_mask:0xf
    v_add_f32_dpp v124, v115, v124 quad_perm:[3,3,3,3] row_mask:0xf bank_mask:0xf
    v_add_f32 v122, v122, v124
    v_max_f32 v65, v65, v122
    ds_write_b32 v64, v122 offset:1024
    v_mfma_f32_16x16x32_bf16 v[96:99], v[220:223], v[92:95], v[96:99]
    s_waitcnt vmcnt(6)
    buffer_load_dwordx4 a[60:63], v77, s[52:55], s85 offen offset:1024 nt
    s_add_u32 s87, s87, 7
    s_add_u32 s39, s87, s88
    s_bfe_u32 s37, s39, 0x30000
    s_lshl_b32 s37, s37, 12
    s_add_u32 s85, s37, s89
    s_bfe_u32 s37, s39, 0x10003
    s_lshl_b32 s37, s37, 11
    s_add_u32 s85, s37, s85
    s_bfe_u32 s37, s39, 0x40004
    s_lshl_b32 s37, s37, 16
    s_add_u32 s85, s37, s85
    v_mfma_f32_16x16x32_bf16 v[112:115], v[224:227], v[80:83], 0
    s_sub_u32 s36, s33, 3
    s_and_b32 s37, s33, 3
    s_cmp_lt_u32 s36, 4
    s_cselect_b64 s[40:41], s[24:25], s[14:15]
    s_cselect_b32 s36, s36, s37
    s_cselect_b32 s45, 262144, 0
    s_cselect_b32 s46, 8388608, 0
    s_add_u32 s45, s45, 524288
    s_add_u32 s46, s46, 196608
    s_mov_b32 s42, 4194304
    s_mov_b32 s43, 0x20000
    s_lshl_b32 s38, s32, 17
    s_add_u32 s44, s38, 0
    s_lshl_b32 s38, s34, 15
    s_add_u32 s44, s38, s44
    s_lshl_b32 s38, s36, 8
    s_add_u32 s44, s38, s44
    s_lshl_b32 s38, s36, 16
    s_add_u32 s45, s38, s45
    s_lshr_b32 s38, s34, 1
    s_lshl_b32 s38, s38, 15
    s_add_u32 s45, s38, s45
    s_lshl_b32 s38, s32, 8
    s_add_u32 s45, s38, s45
    s_bfe_u32 s38, s34, 0x10000
    s_lshl_b32 s38, s38, 7
    s_add_u32 s45, s38, s45
    s_lshl_b32 s38, s32, 11
    s_add_u32 s46, s38, s46
    s_lshl_b32 s38, s34, 9
    s_add_u32 s46, s38, s46
    s_mov_b32 s72, s26
    s_and_b32 s73, s27, 0xffff
    s_mov_b32 s74, 8192
    s_mov_b32 s75, 0x20000
    v_mfma_f32_16x16x32_bf16 v[112:115], v[228:231], v[84:87], v[112:115]
    v_mfma_f32_16x16x32_bf16 v[112:115], v[232:235], v[88:91], v[112:115]
    v_mov_b32_dpp v122, v96 quad_perm:[0,0,0,0] row_mask:0xf bank_mask:0xf
    v_mov_b32_dpp v124, v98 quad_perm:[2,2,2,2] row_mask:0xf bank_mask:0xf
    s_nop 0
    v_add_f32_dpp v122, v97, v122 quad_perm:[1,1,1,1] row_mask:0xf bank_mask:0xf
    v_add_f32_dpp v124, v99, v124 quad_perm:[3,3,3,3] row_mask:0xf bank_mask:0xf
    v_add_f32 v122, v122, v124
    v_max_f32 v65, v65, v122
    ds_write_b32 v64, v122 offset:1280
    s_waitcnt vmcnt(5)
    buffer_load_dwordx4 v[128:131], v76, s[52:55], s85 offen offset:0 nt
    v_mfma_f32_16x16x32_bf16 v[112:115], v[236:239], v[92:95], v[112:115]
    v_mfma_f32_16x16x32_bf16 v[96:99], v[240:243], v[80:83], 0
    v_mfma_f32_16x16x32_bf16 v[96:99], v[244:247], v[84:87], v[96:99]
    s_waitcnt vmcnt(5)
    buffer_load_dwordx4 v[132:135], v77, s[52:55], s85 offen offset:0 nt
    v_mfma_f32_16x16x32_bf16 v[96:99], v[248:251], v[88:91], v[96:99]
    s_nop 2
    v_mov_b32_dpp v122, v112 quad_perm:[0,0,0,0] row_mask:0xf bank_mask:0xf
    v_mov_b32_dpp v124, v114 quad_perm:[2,2,2,2] row_mask:0xf bank_mask:0xf
    s_nop 0
    v_add_f32_dpp v122, v113, v122 quad_perm:[1,1,1,1] row_mask:0xf bank_mask:0xf
    v_add_f32_dpp v124, v115, v124 quad_perm:[3,3,3,3] row_mask:0xf bank_mask:0xf
    v_add_f32 v122, v122, v124
    v_max_f32 v65, v65, v122
    ds_write_b32 v64, v122 offset:1536
    v_lshlrev_b32 v4, 2, v2
    v_xor_b32 v4, v4, v3
    v_xor_b32 v5, 0, v4
    v_lshlrev_b32 v5, 4, v5
    v_lshl_add_u32 v20, v2, 10, v5
    v_xor_b32 v5, 1, v4
    v_lshlrev_b32 v5, 4, v5
    v_lshl_add_u32 v21, v2, 10, v5
    v_add_u32 v21, 3072, v21
    v_xor_b32 v5, 2, v4
    v_lshlrev_b32 v5, 4, v5
    v_lshl_add_u32 v22, v2, 10, v5
    v_add_u32 v22, 6144, v22
    v_xor_b32 v5, 3, v4
    v_lshlrev_b32 v5, 4, v5
    v_lshl_add_u32 v23, v2, 10, v5
    v_add_u32 v23, 9216, v23
    s_lshl_b32 s38, s32, 15
    s_add_u32 s47, s38, 1048576
    s_lshl_b32 s38, s3, 13
    s_add_u32 s47, s38, s47
    s_mul_i32 s38, s3, 320
    s_add_u32 s38, s38, 135168
    v_lshlrev_b32 v4, 6, v2
    v_lshl_add_u32 v4, v3, 1, v4
    v_add_u32 v31, s38, v4
    v_mfma_f32_16x16x32_bf16 v[96:99], v[252:255], v[92:95], v[96:99]
    v_mfma_f32_16x16x32_bf16 v[112:115], a[0:3], v[80:83], 0
    v_mfma_f32_16x16x32_bf16 v[112:115], a[4:7], v[84:87], v[112:115]
    s_waitcnt vmcnt(5)
    buffer_load_dwordx4 v[136:139], v76, s[52:55], s85 offen offset:1024 nt
    v_mfma_f32_16x16x32_bf16 v[112:115], a[8:11], v[88:91], v[112:115]
    s_nop 2
    v_mov_b32_dpp v122, v96 quad_perm:[0,0,0,0] row_mask:0xf bank_mask:0xf
    v_mov_b32_dpp v124, v98 quad_perm:[2,2,2,2] row_mask:0xf bank_mask:0xf
    s_nop 0
    v_add_f32_dpp v122, v97, v122 quad_perm:[1,1,1,1] row_mask:0xf bank_mask:0xf
    v_add_f32_dpp v124, v99, v124 quad_perm:[3,3,3,3] row_mask:0xf bank_mask:0xf
    v_add_f32 v122, v122, v124
    v_max_f32 v65, v65, v122
    ds_write_b32 v64, v122 offset:1792
    v_mfma_f32_16x16x32_bf16 v[112:115], a[12:15], v[92:95], v[112:115]
    v_mfma_f32_16x16x32_bf16 v[96:99], a[16:19], v[80:83], 0
    v_lshlrev_b32 v4, 11, v2
    v_bfe_u32 v5, v1, 2, 2
    v_lshl_add_u32 v4, v5, 8, v4
    v_bfe_u32 v5, v1, 2, 2
    v_lshl_add_u32 v4, v5, 6, v4
    v_bfe_u32 v5, v1, 4, 1
    v_lshl_add_u32 v4, v5, 5, v4
    v_bfe_u32 v5, v1, 1, 1
    v_lshl_add_u32 v4, v5, 4, v4
    v_bfe_u32 v5, v1, 0, 1
    v_lshl_add_u32 v4, v5, 3, v4
    s_lshl_b32 s38, s34, 6
    s_add_u32 s38, s38, 98304
    v_xor_b32 v24, s38, v4
    v_xor_b32 v25, 16, v24
    v_xor_b32 v26, 32, v24
    v_xor_b32 v27, 48, v24
    v_and_b32 v4, 3, v3
    v_lshrrev_b32 v5, 2, v3
    v_lshlrev_b32 v6, 4, v2
    v_add_u32 v6, 135168, v6
    s_movk_i32 s36, 320
    v_cmp_eq_u32 vcc, 0, v5
    s_nop 1
    v_cndmask_b32 v28, 4, v4, vcc
    v_mad_u32_u24 v28, v28, s36, v6
    v_cmp_eq_u32 vcc, 1, v5
    s_nop 1
    v_cndmask_b32 v29, 4, v4, vcc
    v_mad_u32_u24 v29, v29, s36, v6
    v_lshlrev_b32 v5, 2, v1
    v_add_u32 v5, 136448, v5
    v_mov_b32 v6, 0
    ds_write_b32 v5, v6
    s_waitcnt vmcnt(5)
    buffer_load_dwordx4 v[140:143], v77, s[52:55], s85 offen offset:1024 nt
    s_add_u32 s87, s87, 7
    s_add_u32 s39, s87, s88
    s_bfe_u32 s37, s39, 0x30000
    s_lshl_b32 s37, s37, 12
    s_add_u32 s85, s37, s89
    s_bfe_u32 s37, s39, 0x10003
    s_lshl_b32 s37, s37, 11
    s_add_u32 s85, s37, s85
    s_bfe_u32 s37, s39, 0x40004
    s_lshl_b32 s37, s37, 16
    s_add_u32 s85, s37, s85
    v_mfma_f32_16x16x32_bf16 v[96:99], a[20:23], v[84:87], v[96:99]
    v_mfma_f32_16x16x32_bf16 v[96:99], a[24:27], v[88:91], v[96:99]
    v_mov_b32_dpp v122, v112 quad_perm:[0,0,0,0] row_mask:0xf bank_mask:0xf
    v_mov_b32_dpp v124, v114 quad_perm:[2,2,2,2] row_mask:0xf bank_mask:0xf
    s_nop 0
    v_add_f32_dpp v122, v113, v122 quad_perm:[1,1,1,1] row_mask:0xf bank_mask:0xf
    v_add_f32_dpp v124, v115, v124 quad_perm:[3,3,3,3] row_mask:0xf bank_mask:0xf
    v_add_f32 v122, v122, v124
    v_max_f32 v65, v65, v122
    ds_write_b32 v64, v122 offset:2048
    v_mfma_f32_16x16x32_bf16 v[96:99], a[28:31], v[92:95], v[96:99]
    v_mfma_f32_16x16x32_bf16 v[112:115], a[32:35], v[80:83], 0
    s_waitcnt vmcnt(5)
    buffer_load_dwordx4 v[144:147], v76, s[52:55], s85 offen offset:0 nt
    v_mfma_f32_16x16x32_bf16 v[112:115], a[36:39], v[84:87], v[112:115]
    v_mfma_f32_16x16x32_bf16 v[112:115], a[40:43], v[88:91], v[112:115]
    s_nop 2
    v_mov_b32_dpp v122, v96 quad_perm:[0,0,0,0] row_mask:0xf bank_mask:0xf
    v_mov_b32_dpp v124, v98 quad_perm:[2,2,2,2] row_mask:0xf bank_mask:0xf
    s_nop 0
    v_add_f32_dpp v122, v97, v122 quad_perm:[1,1,1,1] row_mask:0xf bank_mask:0xf
    v_add_f32_dpp v124, v99, v124 quad_perm:[3,3,3,3] row_mask:0xf bank_mask:0xf
    v_add_f32 v122, v122, v124
    v_max_f32 v65, v65, v122
    ds_write_b32 v64, v122 offset:2304
    v_lshlrev_b32 v30, 4, v3
    v_lshl_add_u32 v30, v2, 13, v30
    s_lshl_b32 s38, s32, 13
    s_add_u32 s36, s38, 0
    s_lshl_b32 s38, s34, 6
    s_add_u32 s36, s38, s36
    v_lshrrev_b32 v5, 2, v1
    v_lshlrev_b32 v32, 8, v5
    v_bfe_u32 v5, v1, 0, 2
    v_lshl_add_u32 v32, v5, 4, v32
    v_add_u32 v32, s36, v32
    s_lshr_b32 s38, s32, 2
    s_lshl_b32 s38, s38, 7
    s_add_u32 s36, s38, 0
    s_lshl_b32 s38, s34, 5
    s_add_u32 s36, s38, s36
    s_bfe_u32 s38, s32, 0x20000
    s_lshl_b32 s38, s38, 3
    s_add_u32 s36, s38, s36
    v_bfe_u32 v5, v1, 0, 2
    v_lshlrev_b32 v33, 11, v5
    v_lshl_add_u32 v33, v2, 1, v33
    v_add_u32 v33, s36, v33
    v_and_b32 v5, 31, v1
    v_lshlrev_b32 v34, 4, v5
    s_mul_i32 s38, s34, 320
    s_add_u32 s38, s38, 135168
    v_lshl_add_u32 v35, v5, 3, s38
    v_mfma_f32_16x16x32_bf16 v[112:115], a[44:47], v[92:95], v[112:115]
    s_waitcnt vmcnt(5)
    buffer_load_dwordx4 v[148:151], v77, s[52:55], s85 offen offset:0 nt
    v_mfma_f32_16x16x32_bf16 v[96:99], a[48:51], v[80:83], 0
    v_mfma_f32_16x16x32_bf16 v[96:99], a[52:55], v[84:87], v[96:99]
    v_mfma_f32_16x16x32_bf16 v[96:99], a[56:59], v[88:91], v[96:99]
    s_nop 2
    v_mov_b32_dpp v122, v112 quad_perm:[0,0,0,0] row_mask:0xf bank_mask:0xf
    v_mov_b32_dpp v124, v114 quad_perm:[2,2,2,2] row_mask:0xf bank_mask:0xf
    s_nop 0
    v_add_f32_dpp v122, v113, v122 quad_perm:[1,1,1,1] row_mask:0xf bank_mask:0xf
    v_add_f32_dpp v124, v115, v124 quad_perm:[3,3,3,3] row_mask:0xf bank_mask:0xf
    v_add_f32 v122, v122, v124
    v_max_f32 v65, v65, v122
    ds_write_b32 v64, v122 offset:2560
    v_mfma_f32_16x16x32_bf16 v[96:99], a[60:63], v[92:95], v[96:99]
    v_add_u32 v64, 2816, v64
    s_mov_b32 s97, 10
    s_mov_b32 s86, 32
    s_and_b32 s36, s32, 3
    s_sub_u32 s80, s36, 2
    s_cmp_ge_u32 s36, 2
    s_cselect_b32 s80, s80, 8
    s_cselect_b32 s81, 27, 25
    s_cmp_eq_u32 s80, s33
    s_cselect_b32 s36, 2, 0
    s_sub_u32 s86, s86, s36
    s_lshr_b32 s36, s36, 1
    s_sub_u32 s97, s97, s36
    s_add_u32 s80, s80, 35
    s_sub_u32 s92, s81, 1
    s_mov_b32 s66, 134217728
    s_mov_b32 s67, 0x20000
    s_mov_b64 s[64:65], s[52:53]
    v_mov_b32 v62, v76
    v_mov_b32 v63, v77
L_bloop:
    s_waitcnt vmcnt(5)
    buffer_load_dwordx4 v[152:155], v62, s[64:67], s85 offen offset:1024 nt
    v_mfma_f32_16x16x32_bf16 v[112:115], v[128:131], v[80:83], 0
    s_waitcnt vmcnt(5)
    buffer_load_dwordx4 v[156:159], v63, s[64:67], s85 offen offset:1024 nt
    v_mfma_f32_16x16x32_bf16 v[112:115], v[132:135], v[84:87], v[112:115]
    s_add_u32 s87, s87, 7
    s_cmp_lg_u32 s97, 1
    s_cbranch_scc1 L_stayk_3
    s_mov_b64 s[64:65], s[56:57]
    v_mov_b32 v62, v126
    v_mov_b32 v63, v127
    s_mul_i32 s37, s86, 7
    s_sub_u32 s87, s87, s37
L_stayk_3:
    s_add_u32 s39, s87, s88
    s_bfe_u32 s37, s39, 0x30000
    s_lshl_b32 s37, s37, 12
    s_add_u32 s85, s37, s89
    s_bfe_u32 s37, s39, 0x10003
    s_lshl_b32 s37, s37, 11
    s_add_u32 s85, s37, s85
    s_bfe_u32 s37, s39, 0x40004
    s_lshl_b32 s37, s37, 16
    s_add_u32 s85, s37, s85
    v_mov_b32_dpp v122, v96 quad_perm:[0,0,0,0] row_mask:0xf bank_mask:0xf
    v_mov_b32_dpp v124, v98 quad_perm:[2,2,2,2] row_mask:0xf bank_mask:0xf
    s_nop 0
    v_add_f32_dpp v122, v97, v122 quad_perm:[1,1,1,1] row_mask:0xf bank_mask:0xf
    v_add_f32_dpp v124, v99, v124 quad_perm:[3,3,3,3] row_mask:0xf bank_mask:0xf
    v_add_f32 v122, v122, v124
    v_max_f32 v65, v65, v122
    ds_write_b32 v64, v122 offset:0
    s_waitcnt vmcnt(5)
    buffer_load_dwordx4 v[128:131], v62, s[64:67], s85 offen offset:0 nt
    v_mfma_f32_16x16x32_bf16 v[112:115], v[136:139], v[88:91], v[112:115]
    s_waitcnt vmcnt(5)
    buffer_load_dwordx4 v[132:135], v63, s[64:67], s85 offen offset:0 nt
    v_mfma_f32_16x16x32_bf16 v[112:115], v[140:143], v[92:95], v[112:115]
    s_waitcnt vmcnt(5)
    buffer_load_dwordx4 v[136:139], v62, s[64:67], s85 offen offset:1024 nt
    v_mfma_f32_16x16x32_bf16 v[96:99], v[144:147], v[80:83], 0
    s_waitcnt vmcnt(5)
    buffer_load_dwordx4 v[140:143], v63, s[64:67], s85 offen offset:1024 nt
    v_mfma_f32_16x16x32_bf16 v[96:99], v[148:151], v[84:87], v[96:99]
    s_add_u32 s87, s87, 7
    s_add_u32 s39, s87, s88
    s_bfe_u32 s37, s39, 0x30000
    s_lshl_b32 s37, s37, 12
    s_add_u32 s85, s37, s89
    s_bfe_u32 s37, s39, 0x10003
    s_lshl_b32 s37, s37, 11
    s_add_u32 s85, s37, s85
    s_bfe_u32 s37, s39, 0x40004
    s_lshl_b32 s37, s37, 16
    s_add_u32 s85, s37, s85
    v_mov_b32_dpp v122, v112 quad_perm:[0,0,0,0] row_mask:0xf bank_mask:0xf
    v_mov_b32_dpp v124, v114 quad_perm:[2,2,2,2] row_mask:0xf bank_mask:0xf
    s_nop 0
    v_add_f32_dpp v122, v113, v122 quad_perm:[1,1,1,1] row_mask:0xf bank_mask:0xf
    v_add_f32_dpp v124, v115, v124 quad_perm:[3,3,3,3] row_mask:0xf bank_mask:0xf
    v_add_f32 v122, v122, v124
    v_max_f32 v65, v65, v122
    ds_write_b32 v64, v122 offset:256
    s_waitcnt vmcnt(5)
    buffer_load_dwordx4 v[144:147], v62, s[64:67], s85 offen offset:0 nt
    v_mfma_f32_16x16x32_bf16 v[96:99], v[152:155], v[88:91], v[96:99]
    s_waitcnt vmcnt(5)
    buffer_load_dwordx4 v[148:151], v63, s[64:67], s85 offen offset:0 nt
    v_mfma_f32_16x16x32_bf16 v[96:99], v[156:159], v[92:95], v[96:99]
    v_add_u32 v64, 512, v64
    s_sub_u32 s97, s97, 1
    s_cmp_lg_u32 s97, 0
    s_cbranch_scc1 L_bloop
    s_nop 3
    v_mov_b32_dpp v122, v96 quad_perm:[0,0,0,0] row_mask:0xf bank_mask:0xf
    v_mov_b32_dpp v124, v98 quad_perm:[2,2,2,2] row_mask:0xf bank_mask:0xf
    s_nop 0
    v_add_f32_dpp v122, v97, v122 quad_perm:[1,1,1,1] row_mask:0xf bank_mask:0xf
    v_add_f32_dpp v124, v99, v124 quad_perm:[3,3,3,3] row_mask:0xf bank_mask:0xf
    v_add_f32 v122, v122, v124
    v_max_f32 v65, v65, v122
    ds_write_b32 v64, v122 offset:0
    v_mov_b32 v123, 0xff7f0000
    ds_write_b32 v64, v123 offset:256
    s_lshl_b32 s38, s34, 14
    s_add_u32 s38, s38, 16384
    v_lshl_add_u32 v64, v1, 2, s38
    ds_read_b32 v66, v64
    ds_read_b32 v67, v64 offset:256
    v_mul_f32 v65, s83, v65
    s_nop 1
    v_max_f32_dpp v124, v65, v65 row_ror:4 row_mask:0xf bank_mask:0xf
    s_nop 1
    v_max_f32_dpp v124, v124, v124 row_ror:8 row_mask:0xf bank_mask:0xf
    v_mov_b32 v125, v124
    s_nop 1
    v_permlane16_swap_b32 v124, v125
    v_max_f32 v124, v124, v125
    v_mov_b32 v125, v124
    s_nop 1
    v_permlane32_swap_b32 v124, v125
    v_max_f32 v124, v124, v125
    v_mov_b32 v120, v124
    s_lshr_b32 s97, s86, 1
    s_waitcnt lgkmcnt(1)
    v_fma_f32 v123, v66, s83, -v120
    v_exp_f32 v123, v123
    ds_read_b32 v66, v64 offset:512
    v_cvt_pk_bf16_f32 v100, v123, v123
    v_add_f32 v121, v121, v123
L_vloop:
    s_nop 0
    v_and_b32_dpp v104, v100, v10 row_newbcast:0 row_mask:0xf bank_mask:0xf
    v_and_b32_dpp v105, v100, v11 row_newbcast:0 row_mask:0xf bank_mask:0xf
    v_and_b32_dpp v106, v100, v12 row_newbcast:0 row_mask:0xf bank_mask:0xf
    v_and_b32_dpp v107, v100, v13 row_newbcast:0 row_mask:0xf bank_mask:0xf
    s_waitcnt vmcnt(5)
    buffer_load_dwordx4 v[152:155], v62, s[64:67], s85 offen offset:1024 nt
    v_mfma_f32_16x16x32_bf16 v[116:119], v[128:131], v[104:107], v[116:119]
    v_and_b32_dpp v108, v100, v10 row_newbcast:4 row_mask:0xf bank_mask:0xf
    v_and_b32_dpp v109, v100, v11 row_newbcast:4 row_mask:0xf bank_mask:0xf
    v_and_b32_dpp v110, v100, v12 row_newbcast:4 row_mask:0xf bank_mask:0xf
    v_and_b32_dpp v111, v100, v13 row_newbcast:4 row_mask:0xf bank_mask:0xf
    s_waitcnt vmcnt(5)
    buffer_load_dwordx4 v[156:159], v63, s[64:67], s85 offen offset:1024 nt
    v_mfma_f32_16x16x32_bf16 v[116:119], v[132:135], v[108:111], v[116:119]
    s_add_u32 s87, s87, 7
    s_cmp_lg_u32 s97, 1
    s_cbranch_scc1 L_stayv_4
    s_mov_b64 s[64:65], s[52:53]
    v_mov_b32 v62, v76
    v_mov_b32 v63, v77
    s_mov_b64 exec, 1
    global_atomic_add v19, v9, v18, s[30:31] sc0 sc1
    s_mov_b64 exec, -1
    s_add_u32 s87, s33, 224
L_stayv_4:
    s_add_u32 s39, s87, s88
    s_bfe_u32 s37, s39, 0x30000
    s_lshl_b32 s37, s37, 12
    s_add_u32 s85, s37, s89
    s_bfe_u32 s37, s39, 0x10003
    s_lshl_b32 s37, s37, 11
    s_add_u32 s85, s37, s85
    s_bfe_u32 s37, s39, 0x40004
    s_lshl_b32 s37, s37, 16
    s_add_u32 s85, s37, s85
    s_waitcnt lgkmcnt(1)
    v_fma_f32 v123, v67, s83, -v120
    v_exp_f32 v123, v123
    ds_read_b32 v67, v64 offset:768
    v_cvt_pk_bf16_f32 v101, v123, v123
    v_add_f32 v121, v121, v123
    v_and_b32_dpp v104, v100, v10 row_newbcast:8 row_mask:0xf bank_mask:0xf
    v_and_b32_dpp v105, v100, v11 row_newbcast:8 row_mask:0xf bank_mask:0xf
    v_and_b32_dpp v106, v100, v12 row_newbcast:8 row_mask:0xf bank_mask:0xf
    v_and_b32_dpp v107, v100, v13 row_newbcast:8 row_mask:0xf bank_mask:0xf
    s_waitcnt vmcnt(5)
    buffer_load_dwordx4 v[128:131], v62, s[64:67], s85 offen offset:0 nt
    v_mfma_f32_16x16x32_bf16 v[116:119], v[136:139], v[104:107], v[116:119]
    v_and_b32_dpp v108, v100, v10 row_newbcast:12 row_mask:0xf bank_mask:0xf
    v_and_b32_dpp v109, v100, v11 row_newbcast:12 row_mask:0xf bank_mask:0xf
    v_and_b32_dpp v110, v100, v12 row_newbcast:12 row_mask:0xf bank_mask:0xf
    v_and_b32_dpp v111, v100, v13 row_newbcast:12 row_mask:0xf bank_mask:0xf
    s_waitcnt vmcnt(5)
    buffer_load_dwordx4 v[132:135], v63, s[64:67], s85 offen offset:0 nt
    v_mfma_f32_16x16x32_bf16 v[116:119], v[140:143], v[108:111], v[116:119]
    v_and_b32_dpp v104, v101, v10 row_newbcast:0 row_mask:0xf bank_mask:0xf
    v_and_b32_dpp v105, v101, v11 row_newbcast:0 row_mask:0xf bank_mask:0xf
    v_and_b32_dpp v106, v101, v12 row_newbcast:0 row_mask:0xf bank_mask:0xf
    v_and_b32_dpp v107, v101, v13 row_newbcast:0 row_mask:0xf bank_mask:0xf
    s_waitcnt vmcnt(5)
    buffer_load_dwordx4 v[136:139], v62, s[64:67], s85 offen offset:1024 nt
    v_mfma_f32_16x16x32_bf16 v[116:119], v[144:147], v[104:107], v[116:119]
    v_and_b32_dpp v108, v101, v10 row_newbcast:4 row_mask:0xf bank_mask:0xf
    v_and_b32_dpp v109, v101, v11 row_newbcast:4 row_mask:0xf bank_mask:0xf
    v_and_b32_dpp v110, v101, v12 row_newbcast:4 row_mask:0xf bank_mask:0xf
    v_and_b32_dpp v111, v101, v13 row_newbcast:4 row_mask:0xf bank_mask:0xf
    s_waitcnt vmcnt(5)
    buffer_load_dwordx4 v[140:143], v63, s[64:67], s85 offen offset:1024 nt
    v_mfma_f32_16x16x32_bf16 v[116:119], v[148:151], v[108:111], v[116:119]
    s_add_u32 s87, s87, 7
    s_cmp_lg_u32 s97, 1
    s_cbranch_scc1 L_stayv_5
    s_mov_b64 s[64:65], s[56:57]
    v_mov_b32 v62, v126
    v_mov_b32 v63, v127
    s_add_u32 s87, s33, 224
L_stayv_5:
    s_add_u32 s39, s87, s88
    s_bfe_u32 s37, s39, 0x30000
    s_lshl_b32 s37, s37, 12
    s_add_u32 s85, s37, s89
    s_bfe_u32 s37, s39, 0x10003
    s_lshl_b32 s37, s37, 11
    s_add_u32 s85, s37, s85
    s_bfe_u32 s37, s39, 0x40004
    s_lshl_b32 s37, s37, 16
    s_add_u32 s85, s37, s85
    v_add_u32 v64, 512, v64
    s_waitcnt lgkmcnt(1)
    v_fma_f32 v123, v66, s83, -v120
    v_exp_f32 v123, v123
    ds_read_b32 v66, v64 offset:512
    v_cvt_pk_bf16_f32 v100, v123, v123
    v_add_f32 v121, v121, v123
    v_and_b32_dpp v104, v101, v10 row_newbcast:8 row_mask:0xf bank_mask:0xf
    v_and_b32_dpp v105, v101, v11 row_newbcast:8 row_mask:0xf bank_mask:0xf
    v_and_b32_dpp v106, v101, v12 row_newbcast:8 row_mask:0xf bank_mask:0xf
    v_and_b32_dpp v107, v101, v13 row_newbcast:8 row_mask:0xf bank_mask:0xf
    s_waitcnt vmcnt(5)
    buffer_load_dwordx4 v[144:147], v62, s[64:67], s85 offen offset:0 nt
    v_mfma_f32_16x16x32_bf16 v[116:119], v[152:155], v[104:107], v[116:119]
    v_and_b32_dpp v108, v101, v10 row_newbcast:12 row_mask:0xf bank_mask:0xf
    v_and_b32_dpp v109, v101, v11 row_newbcast:12 row_mask:0xf bank_mask:0xf
    v_and_b32_dpp v110, v101, v12 row_newbcast:12 row_mask:0xf bank_mask:0xf
    v_and_b32_dpp v111, v101, v13 row_newbcast:12 row_mask:0xf bank_mask:0xf
    s_waitcnt vmcnt(5)
    buffer_load_dwordx4 v[148:151], v63, s[64:67], s85 offen offset:0 nt
    v_mfma_f32_16x16x32_bf16 v[116:119], v[156:159], v[108:111], v[116:119]
    s_sub_u32 s97, s97, 1
    s_cmp_lg_u32 s97, 0
    s_cbranch_scc1 L_vloop
    buffer_load_dwordx4 v[152:155], v126, s[56:59], s85 offen offset:1024 nt
    buffer_load_dwordx4 v[156:159], v127, s[56:59], s85 offen offset:1024 nt
L_dloop:
    s_waitcnt vmcnt(7)
    v_readfirstlane_b32 s93, v19
    v_mov_b32 v19, 64
    s_cmp_ge_u32 s93, s81
    s_cbranch_scc1 L_last0
    s_add_u32 s87, s93, 231
    s_mul_i32 s36, s93, 7
    s_add_u32 s36, s36, s80
    s_cmp_ge_u32 s93, 25
    s_cselect_b32 s87, s36, s87
    s_add_u32 s39, s87, s88
    s_bfe_u32 s37, s39, 0x30000
    s_lshl_b32 s37, s37, 12
    s_add_u32 s85, s37, s89
    s_bfe_u32 s37, s39, 0x10003
    s_lshl_b32 s37, s37, 11
    s_add_u32 s85, s37, s85
    s_bfe_u32 s37, s39, 0x40004
    s_lshl_b32 s37, s37, 16
    s_add_u32 s85, s37, s85
    s_cmp_ge_u32 s93, s92
    s_cbranch_scc1 L_noclaim_6
    s_mov_b64 exec, 1
    global_atomic_add v19, v9, v18, s[30:31] sc0 sc1
    s_mov_b64 exec, -1
L_noclaim_6:
    buffer_load_dwordx4 v[160:163], v76, s[52:55], s85 offen offset:0 nt
    v_mfma_f32_16x16x32_bf16 v[112:115], v[128:131], v[80:83], 0
    s_waitcnt vmcnt(7)
    buffer_load_dwordx4 v[164:167], v77, s[52:55], s85 offen offset:0 nt
    v_mfma_f32_16x16x32_bf16 v[112:115], v[132:135], v[84:87], v[112:115]
    s_waitcnt vmcnt(7)
    buffer_load_dwordx4 v[168:171], v76, s[52:55], s85 offen offset:1024 nt
    v_mfma_f32_16x16x32_bf16 v[112:115], v[136:139], v[88:91], v[112:115]
    s_waitcnt vmcnt(7)
    buffer_load_dwordx4 v[172:175], v77, s[52:55], s85 offen offset:1024 nt
    v_mfma_f32_16x16x32_bf16 v[112:115], v[140:143], v[92:95], v[112:115]
    s_nop 7
    v_mov_b32_dpp v122, v112 quad_perm:[0,0,0,0] row_mask:0xf bank_mask:0xf
    v_mov_b32_dpp v124, v114 quad_perm:[2,2,2,2] row_mask:0xf bank_mask:0xf
    s_nop 0
    v_add_f32_dpp v122, v113, v122 quad_perm:[1,1,1,1] row_mask:0xf bank_mask:0xf
    v_add_f32_dpp v124, v115, v124 quad_perm:[3,3,3,3] row_mask:0xf bank_mask:0xf
    v_add_f32 v122, v122, v124
    v_fma_f32 v123, v122, s83, -v120
    v_cmp_lt_f32 vcc, 0, v123
    s_cbranch_vccz L_nomax_7
    v_mul_f32 v122, s83, v122
    s_nop 1
    v_max_f32_dpp v124, v122, v122 row_ror:4 row_mask:0xf bank_mask:0xf
    s_nop 1
    v_max_f32_dpp v124, v124, v124 row_ror:8 row_mask:0xf bank_mask:0xf
    v_mov_b32 v125, v124
    s_nop 1
    v_permlane16_swap_b32 v124, v125
    v_max_f32 v124, v124, v125
    v_mov_b32 v125, v124
    s_nop 1
    v_permlane32_swap_b32 v124, v125
    v_max_f32 v124, v124, v125
    v_max_f32 v124, v124, v120
    v_sub_f32 v125, v120, v124
    v_exp_f32 v125, v125
    v_mov_b32 v120, v124
    v_sub_f32 v123, v122, v124
    v_mul_f32 v121, v121, v125
    v_mul_f32 v116, v116, v125
    v_mul_f32 v117, v117, v125
    v_mul_f32 v118, v118, v125
    v_mul_f32 v119, v119, v125
L_nomax_7:
    v_exp_f32 v123, v123
    s_nop 0
    v_cvt_pk_bf16_f32 v124, v123, v123
    v_add_f32 v121, v121, v123
    s_nop 0
    v_and_b32_dpp v96, v124, v10 row_newbcast:0 row_mask:0xf bank_mask:0xf
    v_and_b32_dpp v97, v124, v11 row_newbcast:0 row_mask:0xf bank_mask:0xf
    v_and_b32_dpp v98, v124, v12 row_newbcast:0 row_mask:0xf bank_mask:0xf
    v_and_b32_dpp v99, v124, v13 row_newbcast:0 row_mask:0xf bank_mask:0xf
    v_and_b32_dpp v100, v124, v10 row_newbcast:4 row_mask:0xf bank_mask:0xf
    v_and_b32_dpp v101, v124, v11 row_newbcast:4 row_mask:0xf bank_mask:0xf
    v_and_b32_dpp v102, v124, v12 row_newbcast:4 row_mask:0xf bank_mask:0xf
    v_and_b32_dpp v103, v124, v13 row_newbcast:4 row_mask:0xf bank_mask:0xf
    v_and_b32_dpp v104, v124, v10 row_newbcast:8 row_mask:0xf bank_mask:0xf
    v_and_b32_dpp v105, v124, v11 row_newbcast:8 row_mask:0xf bank_mask:0xf
    v_and_b32_dpp v106, v124, v12 row_newbcast:8 row_mask:0xf bank_mask:0xf
    v_and_b32_dpp v107, v124, v13 row_newbcast:8 row_mask:0xf bank_mask:0xf
    v_and_b32_dpp v108, v124, v10 row_newbcast:12 row_mask:0xf bank_mask:0xf
    v_and_b32_dpp v109, v124, v11 row_newbcast:12 row_mask:0xf bank_mask:0xf
    v_and_b32_dpp v110, v124, v12 row_newbcast:12 row_mask:0xf bank_mask:0xf
    v_and_b32_dpp v111, v124, v13 row_newbcast:12 row_mask:0xf bank_mask:0xf
    s_waitcnt vmcnt(7)
    buffer_load_dwordx4 v[176:179], v126, s[56:59], s85 offen offset:0 nt
    v_mfma_f32_16x16x32_bf16 v[116:119], v[144:147], v[96:99], v[116:119]
    s_waitcnt vmcnt(7)
    buffer_load_dwordx4 v[180:183], v127, s[56:59], s85 offen offset:0 nt
    v_mfma_f32_16x16x32_bf16 v[116:119], v[148:151], v[100:103], v[116:119]
    s_waitcnt vmcnt(7)
    buffer_load_dwordx4 v[184:187], v126, s[56:59], s85 offen offset:1024 nt
    v_mfma_f32_16x16x32_bf16 v[116:119], v[152:155], v[104:107], v[116:119]
    s_waitcnt vmcnt(7)
    buffer_load_dwordx4 v[188:191], v127, s[56:59], s85 offen offset:1024 nt
    v_mfma_f32_16x16x32_bf16 v[116:119], v[156:159], v[108:111], v[116:119]
    s_waitcnt vmcnt(7)
    v_readfirstlane_b32 s93, v19
    v_mov_b32 v19, 64
    s_cmp_ge_u32 s93, s81
    s_cbranch_scc1 L_last1
    s_add_u32 s87, s93, 231
    s_mul_i32 s36, s93, 7
    s_add_u32 s36, s36, s80
    s_cmp_ge_u32 s93, 25
    s_cselect_b32 s87, s36, s87
    s_add_u32 s39, s87, s88
    s_bfe_u32 s37, s39, 0x30000
    s_lshl_b32 s37, s37, 12
    s_add_u32 s85, s37, s89
    s_bfe_u32 s37, s39, 0x10003
    s_lshl_b32 s37, s37, 11
    s_add_u32 s85, s37, s85
    s_bfe_u32 s37, s39, 0x40004
    s_lshl_b32 s37, s37, 16
    s_add_u32 s85, s37, s85
    s_cmp_ge_u32 s93, s92
    s_cbranch_scc1 L_noclaim_8
    s_mov_b64 exec, 1
    global_atomic_add v19, v9, v18, s[30:31] sc0 sc1
    s_mov_b64 exec, -1
L_noclaim_8:
    buffer_load_dwordx4 v[128:131], v76, s[52:55], s85 offen offset:0 nt
    v_mfma_f32_16x16x32_bf16 v[112:115], v[160:163], v[80:83], 0
    s_waitcnt vmcnt(7)
    buffer_load_dwordx4 v[132:135], v77, s[52:55], s85 offen offset:0 nt
    v_mfma_f32_16x16x32_bf16 v[112:115], v[164:167], v[84:87], v[112:115]
    s_waitcnt vmcnt(7)
    buffer_load_dwordx4 v[136:139], v76, s[52:55], s85 offen offset:1024 nt
    v_mfma_f32_16x16x32_bf16 v[112:115], v[168:171], v[88:91], v[112:115]
    s_waitcnt vmcnt(7)
    buffer_load_dwordx4 v[140:143], v77, s[52:55], s85 offen offset:1024 nt
    v_mfma_f32_16x16x32_bf16 v[112:115], v[172:175], v[92:95], v[112:115]
    s_nop 7
    v_mov_b32_dpp v122, v112 quad_perm:[0,0,0,0] row_mask:0xf bank_mask:0xf
    v_mov_b32_dpp v124, v114 quad_perm:[2,2,2,2] row_mask:0xf bank_mask:0xf
    s_nop 0
    v_add_f32_dpp v122, v113, v122 quad_perm:[1,1,1,1] row_mask:0xf bank_mask:0xf
    v_add_f32_dpp v124, v115, v124 quad_perm:[3,3,3,3] row_mask:0xf bank_mask:0xf
    v_add_f32 v122, v122, v124
    v_fma_f32 v123, v122, s83, -v120
    v_cmp_lt_f32 vcc, 0, v123
    s_cbranch_vccz L_nomax_9
    v_mul_f32 v122, s83, v122
    s_nop 1
    v_max_f32_dpp v124, v122, v122 row_ror:4 row_mask:0xf bank_mask:0xf
    s_nop 1
    v_max_f32_dpp v124, v124, v124 row_ror:8 row_mask:0xf bank_mask:0xf
    v_mov_b32 v125, v124
    s_nop 1
    v_permlane16_swap_b32 v124, v125
    v_max_f32 v124, v124, v125
    v_mov_b32 v125, v124
    s_nop 1
    v_permlane32_swap_b32 v124, v125
    v_max_f32 v124, v124, v125
    v_max_f32 v124, v124, v120
    v_sub_f32 v125, v120, v124
    v_exp_f32 v125, v125
    v_mov_b32 v120, v124
    v_sub_f32 v123, v122, v124
    v_mul_f32 v121, v121, v125
    v_mul_f32 v116, v116, v125
    v_mul_f32 v117, v117, v125
    v_mul_f32 v118, v118, v125
    v_mul_f32 v119, v119, v125
L_nomax_9:
    v_exp_f32 v123, v123
    s_nop 0
    v_cvt_pk_bf16_f32 v124, v123, v123
    v_add_f32 v121, v121, v123
    s_nop 0
    v_and_b32_dpp v96, v124, v10 row_newbcast:0 row_mask:0xf bank_mask:0xf
    v_and_b32_dpp v97, v124, v11 row_newbcast:0 row_mask:0xf bank_mask:0xf
    v_and_b32_dpp v98, v124, v12 row_newbcast:0 row_mask:0xf bank_mask:0xf
    v_and_b32_dpp v99, v124, v13 row_newbcast:0 row_mask:0xf bank_mask:0xf
    v_and_b32_dpp v100, v124, v10 row_newbcast:4 row_mask:0xf bank_mask:0xf
    v_and_b32_dpp v101, v124, v11 row_newbcast:4 row_mask:0xf bank_mask:0xf
    v_and_b32_dpp v102, v124, v12 row_newbcast:4 row_mask:0xf bank_mask:0xf
    v_and_b32_dpp v103, v124, v13 row_newbcast:4 row_mask:0xf bank_mask:0xf
    v_and_b32_dpp v104, v124, v10 row_newbcast:8 row_mask:0xf bank_mask:0xf
    v_and_b32_dpp v105, v124, v11 row_newbcast:8 row_mask:0xf bank_mask:0xf
    v_and_b32_dpp v106, v124, v12 row_newbcast:8 row_mask:0xf bank_mask:0xf
    v_and_b32_dpp v107, v124, v13 row_newbcast:8 row_mask:0xf bank_mask:0xf
    v_and_b32_dpp v108, v124, v10 row_newbcast:12 row_mask:0xf bank_mask:0xf
    v_and_b32_dpp v109, v124, v11 row_newbcast:12 row_mask:0xf bank_mask:0xf
    v_and_b32_dpp v110, v124, v12 row_newbcast:12 row_mask:0xf bank_mask:0xf
    v_and_b32_dpp v111, v124, v13 row_newbcast:12 row_mask:0xf bank_mask:0xf
    s_waitcnt vmcnt(7)
    buffer_load_dwordx4 v[144:147], v126, s[56:59], s85 offen offset:0 nt
    v_mfma_f32_16x16x32_bf16 v[116:119], v[176:179], v[96:99], v[116:119]
    s_waitcnt vmcnt(7)
    buffer_load_dwordx4 v[148:151], v127, s[56:59], s85 offen offset:0 nt
    v_mfma_f32_16x16x32_bf16 v[116:119], v[180:183], v[100:103], v[116:119]
    s_waitcnt vmcnt(7)
    buffer_load_dwordx4 v[152:155], v126, s[56:59], s85 offen offset:1024 nt
    v_mfma_f32_16x16x32_bf16 v[116:119], v[184:187], v[104:107], v[116:119]
    s_waitcnt vmcnt(7)
    buffer_load_dwordx4 v[156:159], v127, s[56:59], s85 offen offset:1024 nt
    v_mfma_f32_16x16x32_bf16 v[116:119], v[188:191], v[108:111], v[116:119]
    s_branch L_dloop
L_last1:
    buffer_load_dwordx4 v[224:227], v34, s[48:51], s46 offen sc1
    s_lshl_b32 s39, s34, 13
    s_add_u32 s39, s39, 98304
    s_mov_b32 m0, s39
    s_nop 0
    buffer_load_dwordx4 v20, s[40:43], s44 offen offset:0 nt lds
    v_mfma_f32_16x16x32_bf16 v[112:115], v[160:163], v[80:83], 0
    s_waitcnt vmcnt(8)
    buffer_load_dwordx4 v21, s[40:43], s44 offen offset:1024 nt lds
    v_mfma_f32_16x16x32_bf16 v[112:115], v[164:167], v[84:87], v[112:115]
    s_waitcnt vmcnt(8)
    buffer_load_dwordx4 v22, s[40:43], s44 offen offset:2048 nt lds
    v_mfma_f32_16x16x32_bf16 v[112:115], v[168:171], v[88:91], v[112:115]
    s_waitcnt vmcnt(8)
    buffer_load_dwordx4 v23, s[40:43], s44 offen offset:3072 nt lds
    v_mfma_f32_16x16x32_bf16 v[112:115], v[172:175], v[92:95], v[112:115]
    s_nop 7
    v_mov_b32_dpp v122, v112 quad_perm:[0,0,0,0] row_mask:0xf bank_mask:0xf
    v_mov_b32_dpp v124, v114 quad_perm:[2,2,2,2] row_mask:0xf bank_mask:0xf
    s_nop 0
    v_add_f32_dpp v122, v113, v122 quad_perm:[1,1,1,1] row_mask:0xf bank_mask:0xf
    v_add_f32_dpp v124, v115, v124 quad_perm:[3,3,3,3] row_mask:0xf bank_mask:0xf
    v_add_f32 v122, v122, v124
    v_fma_f32 v123, v122, s83, -v120
    v_cmp_lt_f32 vcc, 0, v123
    s_cbranch_vccz L_nomax_10
    v_mul_f32 v122, s83, v122
    s_nop 1
    v_max_f32_dpp v124, v122, v122 row_ror:4 row_mask:0xf bank_mask:0xf
    s_nop 1
    v_max_f32_dpp v124, v124, v124 row_ror:8 row_mask:0xf bank_mask:0xf
    v_mov_b32 v125, v124
    s_nop 1
    v_permlane16_swap_b32 v124, v125
    v_max_f32 v124, v124, v125
    v_mov_b32 v125, v124
    s_nop 1
    v_permlane32_swap_b32 v124, v125
    v_max_f32 v124, v124, v125
    v_max_f32 v124, v124, v120
    v_sub_f32 v125, v120, v124
    v_exp_f32 v125, v125
    v_mov_b32 v120, v124
    v_sub_f32 v123, v122, v124
    v_mul_f32 v121, v121, v125
    v_mul_f32 v116, v116, v125
    v_mul_f32 v117, v117, v125
    v_mul_f32 v118, v118, v125
    v_mul_f32 v119, v119, v125
L_nomax_10:
    v_exp_f32 v123, v123
    s_nop 0
    v_cvt_pk_bf16_f32 v124, v123, v123
    v_add_f32 v121, v121, v123
    s_nop 0
    v_and_b32_dpp v96, v124, v10 row_newbcast:0 row_mask:0xf bank_mask:0xf
    v_and_b32_dpp v97, v124, v11 row_newbcast:0 row_mask:0xf bank_mask:0xf
    v_and_b32_dpp v98, v124, v12 row_newbcast:0 row_mask:0xf bank_mask:0xf
    v_and_b32_dpp v99, v124, v13 row_newbcast:0 row_mask:0xf bank_mask:0xf
    v_and_b32_dpp v100, v124, v10 row_newbcast:4 row_mask:0xf bank_mask:0xf
    v_and_b32_dpp v101, v124, v11 row_newbcast:4 row_mask:0xf bank_mask:0xf
    v_and_b32_dpp v102, v124, v12 row_newbcast:4 row_mask:0xf bank_mask:0xf
    v_and_b32_dpp v103, v124, v13 row_newbcast:4 row_mask:0xf bank_mask:0xf
    v_and_b32_dpp v104, v124, v10 row_newbcast:8 row_mask:0xf bank_mask:0xf
    v_and_b32_dpp v105, v124, v11 row_newbcast:8 row_mask:0xf bank_mask:0xf
    v_and_b32_dpp v106, v124, v12 row_newbcast:8 row_mask:0xf bank_mask:0xf
    v_and_b32_dpp v107, v124, v13 row_newbcast:8 row_mask:0xf bank_mask:0xf
    v_and_b32_dpp v108, v124, v10 row_newbcast:12 row_mask:0xf bank_mask:0xf
    v_and_b32_dpp v109, v124, v11 row_newbcast:12 row_mask:0xf bank_mask:0xf
    v_and_b32_dpp v110, v124, v12 row_newbcast:12 row_mask:0xf bank_mask:0xf
    v_and_b32_dpp v111, v124, v13 row_newbcast:12 row_mask:0xf bank_mask:0xf
    s_waitcnt vmcnt(8)
    s_lshl_b32 s39, s34, 13
    s_add_u32 s39, s39, 102400
    s_mov_b32 m0, s39
    s_add_u32 s44, s44, 16384
    buffer_load_dwordx4 v20, s[40:43], s44 offen offset:0 nt lds
    v_mfma_f32_16x16x32_bf16 v[116:119], v[176:179], v[96:99], v[116:119]
    v_add_f32_dpp v121, v121, v121 row_ror:8 row_mask:0xf bank_mask:0xf
    s_nop 1
    v_add_f32_dpp v121, v121, v121 row_ror:4 row_mask:0xf bank_mask:0xf
    v_mov_b32 v125, v121
    s_nop 1
    v_permlane16_swap_b32 v121, v125
    v_add_f32 v121, v121, v125
    v_mov_b32 v125, v121
    s_nop 1
    v_permlane32_swap_b32 v121, v125
    v_add_f32 v121, v121, v125
    v_and_b32 v125, s82, v120
    v_sub_f32 v125, v120, v125
    s_mov_b32 vcc_lo, 0xff00ff00
    s_mov_b32 vcc_hi, 0xff00ff00
    s_waitcnt vmcnt(8)
    buffer_load_dwordx4 v21, s[40:43], s44 offen offset:1024 nt lds
    v_mfma_f32_16x16x32_bf16 v[116:119], v[180:183], v[100:103], v[116:119]
    s_waitcnt vmcnt(8)
    buffer_load_dwordx4 v22, s[40:43], s44 offen offset:2048 nt lds
    v_mfma_f32_16x16x32_bf16 v[116:119], v[184:187], v[104:107], v[116:119]
    s_waitcnt vmcnt(8)
    buffer_load_dwordx4 v23, s[40:43], s44 offen offset:3072 nt lds
    v_mfma_f32_16x16x32_bf16 v[116:119], v[188:191], v[108:111], v[116:119]
    s_branch L_bdone
L_last0:
    buffer_load_dwordx4 v[224:227], v34, s[48:51], s46 offen sc1
    s_lshl_b32 s39, s34, 13
    s_add_u32 s39, s39, 98304
    s_mov_b32 m0, s39
    s_nop 0
    buffer_load_dwordx4 v20, s[40:43], s44 offen offset:0 nt lds
    v_mfma_f32_16x16x32_bf16 v[112:115], v[128:131], v[80:83], 0
    s_waitcnt vmcnt(8)
    buffer_load_dwordx4 v21, s[40:43], s44 offen offset:1024 nt lds
    v_mfma_f32_16x16x32_bf16 v[112:115], v[132:135], v[84:87], v[112:115]
    s_waitcnt vmcnt(8)
    buffer_load_dwordx4 v22, s[40:43], s44 offen offset:2048 nt lds
    v_mfma_f32_16x16x32_bf16 v[112:115], v[136:139], v[88:91], v[112:115]
    s_waitcnt vmcnt(8)
    buffer_load_dwordx4 v23, s[40:43], s44 offen offset:3072 nt lds
    v_mfma_f32_16x16x32_bf16 v[112:115], v[140:143], v[92:95], v[112:115]
    s_nop 7
    v_mov_b32_dpp v122, v112 quad_perm:[0,0,0,0] row_mask:0xf bank_mask:0xf
    v_mov_b32_dpp v124, v114 quad_perm:[2,2,2,2] row_mask:0xf bank_mask:0xf
    s_nop 0
    v_add_f32_dpp v122, v113, v122 quad_perm:[1,1,1,1] row_mask:0xf bank_mask:0xf
    v_add_f32_dpp v124, v115, v124 quad_perm:[3,3,3,3] row_mask:0xf bank_mask:0xf
    v_add_f32 v122, v122, v124
    v_fma_f32 v123, v122, s83, -v120
    v_cmp_lt_f32 vcc, 0, v123
    s_cbranch_vccz L_nomax_11
    v_mul_f32 v122, s83, v122
    s_nop 1
    v_max_f32_dpp v124, v122, v122 row_ror:4 row_mask:0xf bank_mask:0xf
    s_nop 1
    v_max_f32_dpp v124, v124, v124 row_ror:8 row_mask:0xf bank_mask:0xf
    v_mov_b32 v125, v124
    s_nop 1
    v_permlane16_swap_b32 v124, v125
    v_max_f32 v124, v124, v125
    v_mov_b32 v125, v124
    s_nop 1
    v_permlane32_swap_b32 v124, v125
    v_max_f32 v124, v124, v125
    v_max_f32 v124, v124, v120
    v_sub_f32 v125, v120, v124
    v_exp_f32 v125, v125
    v_mov_b32 v120, v124
    v_sub_f32 v123, v122, v124
    v_mul_f32 v121, v121, v125
    v_mul_f32 v116, v116, v125
    v_mul_f32 v117, v117, v125
    v_mul_f32 v118, v118, v125
    v_mul_f32 v119, v119, v125
L_nomax_11:
    v_exp_f32 v123, v123
    s_nop 0
    v_cvt_pk_bf16_f32 v124, v123, v123
    v_add_f32 v121, v121, v123
    s_nop 0
    v_and_b32_dpp v96, v124, v10 row_newbcast:0 row_mask:0xf bank_mask:0xf
    v_and_b32_dpp v97, v124, v11 row_newbcast:0 row_mask:0xf bank_mask:0xf
    v_and_b32_dpp v98, v124, v12 row_newbcast:0 row_mask:0xf bank_mask:0xf
    v_and_b32_dpp v99, v124, v13 row_newbcast:0 row_mask:0xf bank_mask:0xf
    v_and_b32_dpp v100, v124, v10 row_newbcast:4 row_mask:0xf bank_mask:0xf
    v_and_b32_dpp v101, v124, v11 row_newbcast:4 row_mask:0xf bank_mask:0xf
    v_and_b32_dpp v102, v124, v12 row_newbcast:4 row_mask:0xf bank_mask:0xf
    v_and_b32_dpp v103, v124, v13 row_newbcast:4 row_mask:0xf bank_mask:0xf
    v_and_b32_dpp v104, v124, v10 row_newbcast:8 row_mask:0xf bank_mask:0xf
    v_and_b32_dpp v105, v124, v11 row_newbcast:8 row_mask:0xf bank_mask:0xf
    v_and_b32_dpp v106, v124, v12 row_newbcast:8 row_mask:0xf bank_mask:0xf
    v_and_b32_dpp v107, v124, v13 row_newbcast:8 row_mask:0xf bank_mask:0xf
    v_and_b32_dpp v108, v124, v10 row_newbcast:12 row_mask:0xf bank_mask:0xf
    v_and_b32_dpp v109, v124, v11 row_newbcast:12 row_mask:0xf bank_mask:0xf
    v_and_b32_dpp v110, v124, v12 row_newbcast:12 row_mask:0xf bank_mask:0xf
    v_and_b32_dpp v111, v124, v13 row_newbcast:12 row_mask:0xf bank_mask:0xf
    s_waitcnt vmcnt(8)
    s_lshl_b32 s39, s34, 13
    s_add_u32 s39, s39, 102400
    s_mov_b32 m0, s39
    s_add_u32 s44, s44, 16384
    buffer_load_dwordx4 v20, s[40:43], s44 offen offset:0 nt lds
    v_mfma_f32_16x16x32_bf16 v[116:119], v[144:147], v[96:99], v[116:119]
    v_add_f32_dpp v121, v121, v121 row_ror:8 row_mask:0xf bank_mask:0xf
    s_nop 1
    v_add_f32_dpp v121, v121, v121 row_ror:4 row_mask:0xf bank_mask:0xf
    v_mov_b32 v125, v121
    s_nop 1
    v_permlane16_swap_b32 v121, v125
    v_add_f32 v121, v121, v125
    v_mov_b32 v125, v121
    s_nop 1
    v_permlane32_swap_b32 v121, v125
    v_add_f32 v121, v121, v125
    v_and_b32 v125, s82, v120
    v_sub_f32 v125, v120, v125
    s_mov_b32 vcc_lo, 0xff00ff00
    s_mov_b32 vcc_hi, 0xff00ff00
    s_waitcnt vmcnt(8)
    buffer_load_dwordx4 v21, s[40:43], s44 offen offset:1024 nt lds
    v_mfma_f32_16x16x32_bf16 v[116:119], v[148:151], v[100:103], v[116:119]
    s_waitcnt vmcnt(8)
    buffer_load_dwordx4 v22, s[40:43], s44 offen offset:2048 nt lds
    v_mfma_f32_16x16x32_bf16 v[116:119], v[152:155], v[104:107], v[116:119]
    s_waitcnt vmcnt(8)
    buffer_load_dwordx4 v23, s[40:43], s44 offen offset:3072 nt lds
    v_mfma_f32_16x16x32_bf16 v[116:119], v[156:159], v[108:111], v[116:119]
L_bdone:
    s_nop 7
    v_cndmask_b32 v116, v116, v120, vcc
    v_cndmask_b32 v117, v117, v121, vcc
    v_cndmask_b32 v118, v118, v125, vcc
    v_and_or_b32 v119, v119, s82, v8
    v_and_or_b32 v116, v116, s82, v8
    v_and_or_b32 v117, v117, s82, v8
    v_and_or_b32 v118, v118, s82, v8
    s_mov_b32 exec_lo, 0xff01ff
    s_mov_b32 exec_hi, 0xff00ff
    buffer_store_dwordx4 v[116:119], v79, s[48:51], s96 offen sc1
    s_mov_b64 exec, -1
    s_cmp_lt_u32 s33, 3
    s_cbranch_scc1 L_ctx
    s_mov_b32 s93, 0x7f
    s_bitset0_b32 s93, s33
    s_mov_b32 s86, 0
    s_and_b32 s86, s86, s93
    s_cselect_b32 s86, s86, s93
    s_ff1_i32_b32 s4, s86
    s_bitset0_b32 s86, s4
    s_lshl_b32 s36, s4, 10
    s_add_u32 s36, s36, s47
    buffer_load_dwordx4 v[192:195], v79, s[48:51], s36 offen sc1
    s_and_b32 s86, s86, s93
    s_cselect_b32 s86, s86, s93
    s_ff1_i32_b32 s5, s86
    s_bitset0_b32 s86, s5
    s_lshl_b32 s36, s5, 10
    s_add_u32 s36, s36, s47
    buffer_load_dwordx4 v[196:199], v79, s[48:51], s36 offen sc1
    s_and_b32 s86, s86, s93
    s_cselect_b32 s86, s86, s93
    s_ff1_i32_b32 s6, s86
    s_bitset0_b32 s86, s6
    s_lshl_b32 s36, s6, 10
    s_add_u32 s36, s36, s47
    buffer_load_dwordx4 v[200:203], v79, s[48:51], s36 offen sc1
    s_and_b32 s86, s86, s93
    s_cselect_b32 s86, s86, s93
    s_ff1_i32_b32 s7, s86
    s_bitset0_b32 s86, s7
    s_lshl_b32 s36, s7, 10
    s_add_u32 s36, s36, s47
    buffer_load_dwordx4 v[204:207], v79, s[48:51], s36 offen sc1
    v_xor_b32 v104, s35, v116
    v_xor_b32 v105, s35, v117
    v_xor_b32 v106, s35, v118
    v_xor_b32 v107, s35, v119
L_hop1poll:
    s_and_b32 s86, s86, s93
    s_cselect_b32 s86, s86, s93
    s_ff1_i32_b32 s8, s86
    s_bitset0_b32 s86, s8
    s_lshl_b32 s36, s8, 10
    s_add_u32 s36, s36, s47
    buffer_load_dwordx4 v[208:211], v79, s[48:51], s36 offen sc1
    s_waitcnt vmcnt(4)
    v_xor_b32 v192, s35, v192
    v_xor_b32 v193, s35, v193
    v_xor_b32 v194, s35, v194
    v_xor_b32 v195, s35, v195
    v_or_b32 v4, v192, v193
    v_or3_b32 v4, v4, v194, v195
    v_and_b32 v4, 0xff, v4
    v_cmp_ne_u32 vcc, 0, v4
    v_add_f32 v6, v192, v194
    v_max_f32 v5, v120, v6
    s_cbranch_vccnz L_mnext_12
    s_bitcmp1_b32 s93, s4
    s_cbranch_scc0 L_mnext_12
    v_sub_f32 v122, v120, v5
    v_sub_f32 v123, v6, v5
    v_exp_f32 v122, v122
    v_exp_f32 v123, v123
    v_mov_b32 v120, v5
    s_bitset0_b32 s93, s4
    v_mul_f32_dpp v105, v122, v105 row_newbcast:8 row_mask:0xf bank_mask:0xf
    v_mul_f32_dpp v104, v122, v104 row_newbcast:8 row_mask:0xf bank_mask:0xf
    v_mul_f32_dpp v106, v122, v106 row_newbcast:8 row_mask:0xf bank_mask:0xf
    v_mul_f32_dpp v107, v122, v107 row_newbcast:8 row_mask:0xf bank_mask:0xf
    v_fmac_f32_dpp v105, v123, v193 row_newbcast:8 row_mask:0xf bank_mask:0xf
    v_fmac_f32_dpp v104, v123, v192 row_newbcast:8 row_mask:0xf bank_mask:0xf
    v_fmac_f32_dpp v106, v123, v194 row_newbcast:8 row_mask:0xf bank_mask:0xf
    v_fmac_f32_dpp v107, v123, v195 row_newbcast:8 row_mask:0xf bank_mask:0xf
    s_cmp_eq_u32 s93, 0
    s_cbranch_scc1 L_hop1ok
L_mnext_12:
    s_and_b32 s86, s86, s93
    s_cselect_b32 s86, s86, s93
    s_ff1_i32_b32 s4, s86
    s_bitset0_b32 s86, s4
    s_lshl_b32 s36, s4, 10
    s_add_u32 s36, s36, s47
    buffer_load_dwordx4 v[192:195], v79, s[48:51], s36 offen sc1
    s_waitcnt vmcnt(4)
    v_xor_b32 v196, s35, v196
    v_xor_b32 v197, s35, v197
    v_xor_b32 v198, s35, v198
    v_xor_b32 v199, s35, v199
    v_or_b32 v4, v196, v197
    v_or3_b32 v4, v4, v198, v199
    v_and_b32 v4, 0xff, v4
    v_cmp_ne_u32 vcc, 0, v4
    v_add_f32 v6, v196, v198
    v_max_f32 v5, v120, v6
    s_cbranch_vccnz L_mnext_13
    s_bitcmp1_b32 s93, s5
    s_cbranch_scc0 L_mnext_13
    v_sub_f32 v122, v120, v5
    v_sub_f32 v123, v6, v5
    v_exp_f32 v122, v122
    v_exp_f32 v123, v123
    v_mov_b32 v120, v5
    s_bitset0_b32 s93, s5
    v_mul_f32_dpp v105, v122, v105 row_newbcast:8 row_mask:0xf bank_mask:0xf
    v_mul_f32_dpp v104, v122, v104 row_newbcast:8 row_mask:0xf bank_mask:0xf
    v_mul_f32_dpp v106, v122, v106 row_newbcast:8 row_mask:0xf bank_mask:0xf
    v_mul_f32_dpp v107, v122, v107 row_newbcast:8 row_mask:0xf bank_mask:0xf
    v_fmac_f32_dpp v105, v123, v197 row_newbcast:8 row_mask:0xf bank_mask:0xf
    v_fmac_f32_dpp v104, v123, v196 row_newbcast:8 row_mask:0xf bank_mask:0xf
    v_fmac_f32_dpp v106, v123, v198 row_newbcast:8 row_mask:0xf bank_mask:0xf
    v_fmac_f32_dpp v107, v123, v199 row_newbcast:8 row_mask:0xf bank_mask:0xf
    s_cmp_eq_u32 s93, 0
    s_cbranch_scc1 L_hop1ok
L_mnext_13:
    s_and_b32 s86, s86, s93
    s_cselect_b32 s86, s86, s93
    s_ff1_i32_b32 s5, s86
    s_bitset0_b32 s86, s5
    s_lshl_b32 s36, s5, 10
    s_add_u32 s36, s36, s47
    buffer_load_dwordx4 v[196:199], v79, s[48:51], s36 offen sc1
    s_waitcnt vmcnt(4)
    v_xor_b32 v200, s35, v200
    v_xor_b32 v201, s35, v201
    v_xor_b32 v202, s35, v202
    v_xor_b32 v203, s35, v203
    v_or_b32 v4, v200, v201
    v_or3_b32 v4, v4, v202, v203
    v_and_b32 v4, 0xff, v4
    v_cmp_ne_u32 vcc, 0, v4
    v_add_f32 v6, v200, v202
    v_max_f32 v5, v120, v6
    s_cbranch_vccnz L_mnext_14
    s_bitcmp1_b32 s93, s6
    s_cbranch_scc0 L_mnext_14
    v_sub_f32 v122, v120, v5
    v_sub_f32 v123, v6, v5
    v_exp_f32 v122, v122
    v_exp_f32 v123, v123
    v_mov_b32 v120, v5
    s_bitset0_b32 s93, s6
    v_mul_f32_dpp v105, v122, v105 row_newbcast:8 row_mask:0xf bank_mask:0xf
    v_mul_f32_dpp v104, v122, v104 row_newbcast:8 row_mask:0xf bank_mask:0xf
    v_mul_f32_dpp v106, v122, v106 row_newbcast:8 row_mask:0xf bank_mask:0xf
    v_mul_f32_dpp v107, v122, v107 row_newbcast:8 row_mask:0xf bank_mask:0xf
    v_fmac_f32_dpp v105, v123, v201 row_newbcast:8 row_mask:0xf bank_mask:0xf
    v_fmac_f32_dpp v104, v123, v200 row_newbcast:8 row_mask:0xf bank_mask:0xf
    v_fmac_f32_dpp v106, v123, v202 row_newbcast:8 row_mask:0xf bank_mask:0xf
    v_fmac_f32_dpp v107, v123, v203 row_newbcast:8 row_mask:0xf bank_mask:0xf
    s_cmp_eq_u32 s93, 0
    s_cbranch_scc1 L_hop1ok
L_mnext_14:
    s_and_b32 s86, s86, s93
    s_cselect_b32 s86, s86, s93
    s_ff1_i32_b32 s6, s86
    s_bitset0_b32 s86, s6
    s_lshl_b32 s36, s6, 10
    s_add_u32 s36, s36, s47
    buffer_load_dwordx4 v[200:203], v79, s[48:51], s36 offen sc1
    s_waitcnt vmcnt(4)
    v_xor_b32 v204, s35, v204
    v_xor_b32 v205, s35, v205
    v_xor_b32 v206, s35, v206
    v_xor_b32 v207, s35, v207
    v_or_b32 v4, v204, v205
    v_or3_b32 v4, v4, v206, v207
    v_and_b32 v4, 0xff, v4
    v_cmp_ne_u32 vcc, 0, v4
    v_add_f32 v6, v204, v206
    v_max_f32 v5, v120, v6
    s_cbranch_vccnz L_mnext_15
    s_bitcmp1_b32 s93, s7
    s_cbranch_scc0 L_mnext_15
    v_sub_f32 v122, v120, v5
    v_sub_f32 v123, v6, v5
    v_exp_f32 v122, v122
    v_exp_f32 v123, v123
    v_mov_b32 v120, v5
    s_bitset0_b32 s93, s7
    v_mul_f32_dpp v105, v122, v105 row_newbcast:8 row_mask:0xf bank_mask:0xf
    v_mul_f32_dpp v104, v122, v104 row_newbcast:8 row_mask:0xf bank_mask:0xf
    v_mul_f32_dpp v106, v122, v106 row_newbcast:8 row_mask:0xf bank_mask:0xf
    v_mul_f32_dpp v107, v122, v107 row_newbcast:8 row_mask:0xf bank_mask:0xf
    v_fmac_f32_dpp v105, v123, v205 row_newbcast:8 row_mask:0xf bank_mask:0xf
    v_fmac_f32_dpp v104, v123, v204 row_newbcast:8 row_mask:0xf bank_mask:0xf
    v_fmac_f32_dpp v106, v123, v206 row_newbcast:8 row_mask:0xf bank_mask:0xf
    v_fmac_f32_dpp v107, v123, v207 row_newbcast:8 row_mask:0xf bank_mask:0xf
    s_cmp_eq_u32 s93, 0
    s_cbranch_scc1 L_hop1ok
L_mnext_15:
    s_and_b32 s86, s86, s93
    s_cselect_b32 s86, s86, s93
    s_ff1_i32_b32 s7, s86
    s_bitset0_b32 s86, s7
    s_lshl_b32 s36, s7, 10
    s_add_u32 s36, s36, s47
    buffer_load_dwordx4 v[204:207], v79, s[48:51], s36 offen sc1
    s_waitcnt vmcnt(4)
    v_xor_b32 v208, s35, v208
    v_xor_b32 v209, s35, v209
    v_xor_b32 v210, s35, v210
    v_xor_b32 v211, s35, v211
    v_or_b32 v4, v208, v209
    v_or3_b32 v4, v4, v210, v211
    v_and_b32 v4, 0xff, v4
    v_cmp_ne_u32 vcc, 0, v4
    v_add_f32 v6, v208, v210
    v_max_f32 v5, v120, v6
    s_cbranch_vccnz L_mnext_16
    s_bitcmp1_b32 s93, s8
    s_cbranch_scc0 L_mnext_16
    v_sub_f32 v122, v120, v5
    v_sub_f32 v123, v6, v5
    v_exp_f32 v122, v122
    v_exp_f32 v123, v123
    v_mov_b32 v120, v5
    s_bitset0_b32 s93, s8
    v_mul_f32_dpp v105, v122, v105 row_newbcast:8 row_mask:0xf bank_mask:0xf
    v_mul_f32_dpp v104, v122, v104 row_newbcast:8 row_mask:0xf bank_mask:0xf
    v_mul_f32_dpp v106, v122, v106 row_newbcast:8 row_mask:0xf bank_mask:0xf
    v_mul_f32_dpp v107, v122, v107 row_newbcast:8 row_mask:0xf bank_mask:0xf
    v_fmac_f32_dpp v105, v123, v209 row_newbcast:8 row_mask:0xf bank_mask:0xf
    v_fmac_f32_dpp v104, v123, v208 row_newbcast:8 row_mask:0xf bank_mask:0xf
    v_fmac_f32_dpp v106, v123, v210 row_newbcast:8 row_mask:0xf bank_mask:0xf
    v_fmac_f32_dpp v107, v123, v211 row_newbcast:8 row_mask:0xf bank_mask:0xf
    s_cmp_eq_u32 s93, 0
    s_cbranch_scc1 L_hop1ok
L_mnext_16:
    s_sub_u32 s84, s84, 1
    s_cmp_lg_u32 s84, 0
    s_cbranch_scc1 L_hop1poll
    s_branch L_end
L_ctx:
    s_waitcnt vmcnt(1)
L_ctxcheck:
    v_xor_b32 v224, s35, v224
    v_xor_b32 v225, s35, v225
    v_xor_b32 v226, s35, v226
    v_xor_b32 v227, s35, v227
    v_or_b32 v4, v224, v225
    v_or3_b32 v4, v4, v226, v227
    v_and_b32 v4, 0xff, v4
    v_cmp_ne_u32 vcc, 0, v4
    s_cbranch_vccz L_ctxok
    buffer_load_dwordx4 v[224:227], v34, s[48:51], s46 offen sc1
    s_waitcnt vmcnt(0)
    s_sub_u32 s84, s84, 1
    s_cmp_lg_u32 s84, 0
    s_cbranch_scc1 L_ctxcheck
    s_branch L_end
L_ctxok:
    v_cvt_pk_bf16_f32 v224, v224, v225
    v_cvt_pk_bf16_f32 v225, v226, v227
    ds_write_b64 v35, v[224:225]
    s_branch L_final
L_hop1ok:
    v_rcp_f32 v122, v105
    s_nop 1
    v_mul_f32_dpp v104, v122, v104 row_newbcast:8 row_mask:0xf bank_mask:0xf
    v_mul_f32_dpp v105, v122, v105 row_newbcast:8 row_mask:0xf bank_mask:0xf
    v_mul_f32_dpp v106, v122, v106 row_newbcast:8 row_mask:0xf bank_mask:0xf
    v_mul_f32_dpp v107, v122, v107 row_newbcast:8 row_mask:0xf bank_mask:0xf
    v_cvt_pk_bf16_f32 v104, v104, v105
    v_cvt_pk_bf16_f32 v106, v106, v107
    s_mov_b32 exec_lo, 0xff00ff
    s_mov_b32 exec_hi, 0xff00ff
    ds_write_b16 v31, v104
    ds_write_b16_d16_hi v31, v104 offset:16
    ds_write_b16 v31, v106 offset:32
    ds_write_b16_d16_hi v31, v106 offset:48
    s_mov_b64 exec, -1
L_final:
    s_waitcnt lgkmcnt(0)
    s_barrier
    ds_read_b64_tr_b16 v[128:129], v24 offset:0
    ds_read_b64_tr_b16 v[130:131], v25 offset:1024
    ds_read_b128 v[160:163], v28 offset:0
    ds_read_b64_tr_b16 v[132:133], v24 offset:8192
    ds_read_b64_tr_b16 v[134:135], v25 offset:9216
    ds_read_b128 v[164:167], v28 offset:64
    ds_read_b64_tr_b16 v[136:137], v24 offset:16384
    ds_read_b64_tr_b16 v[138:139], v25 offset:17408
    ds_read_b128 v[168:171], v28 offset:128
    ds_read_b64_tr_b16 v[140:141], v24 offset:24576
    ds_read_b64_tr_b16 v[142:143], v25 offset:25600
    ds_read_b128 v[172:175], v28 offset:192
    ds_read_b64_tr_b16 v[144:145], v26 offset:0
    ds_read_b64_tr_b16 v[146:147], v27 offset:1024
    ds_read_b128 v[176:179], v29 offset:0
    s_waitcnt lgkmcnt(12)
    v_mfma_f32_16x16x32_bf16 v[112:115], v[128:131], v[160:163], 0
    ds_read_b64_tr_b16 v[148:149], v26 offset:8192
    ds_read_b64_tr_b16 v[150:151], v27 offset:9216
    ds_read_b128 v[180:183], v29 offset:64
    s_waitcnt lgkmcnt(12)
    v_mfma_f32_16x16x32_bf16 v[112:115], v[132:135], v[164:167], v[112:115]
    ds_read_b64_tr_b16 v[152:153], v26 offset:16384
    ds_read_b64_tr_b16 v[154:155], v27 offset:17408
    ds_read_b128 v[184:187], v29 offset:128
    s_waitcnt lgkmcnt(12)
    v_mfma_f32_16x16x32_bf16 v[112:115], v[136:139], v[168:171], v[112:115]
    ds_read_b64_tr_b16 v[156:157], v26 offset:24576
    ds_read_b64_tr_b16 v[158:159], v27 offset:25600
    ds_read_b128 v[188:191], v29 offset:192
    s_waitcnt lgkmcnt(12)
    v_mfma_f32_16x16x32_bf16 v[112:115], v[140:143], v[172:175], v[112:115]
    s_waitcnt lgkmcnt(9)
    v_mfma_f32_16x16x32_bf16 v[112:115], v[144:147], v[176:179], v[112:115]
    s_waitcnt lgkmcnt(6)
    v_mfma_f32_16x16x32_bf16 v[112:115], v[148:151], v[180:183], v[112:115]
    s_waitcnt lgkmcnt(3)
    v_mfma_f32_16x16x32_bf16 v[112:115], v[152:155], v[184:187], v[112:115]
    s_waitcnt lgkmcnt(0)
    v_mfma_f32_16x16x32_bf16 v[112:115], v[156:159], v[188:191], v[112:115]
    s_cmp_eq_u32 s33, 0
    s_cselect_b32 s36, 0, 262144
    s_cselect_b32 s39, 0, 1024
    s_add_u32 s36, s36, 524288
    s_add_u32 s37, s36, 4096
    s_mov_b32 exec_lo, 0xff00ff
    s_mov_b32 exec_hi, 0xff00ff
    s_nop 0
    v_and_or_b32 v112, v112, s82, v8
    v_and_or_b32 v113, v113, s82, v8
    v_and_or_b32 v114, v114, s82, v8
    v_and_or_b32 v115, v115, s82, v8
    buffer_store_dwordx4 v[112:115], v30, s[48:51], s45 offen sc1
    s_mov_b64 exec, -1
    s_sub_u32 s38, s33, 1
    s_cmp_lt_u32 s38, 6
    s_cbranch_scc1 L_done
L_hop2:
    buffer_load_dwordx4 v[224:227], v32, s[48:51], s36 offen sc1
    buffer_load_dwordx4 v[228:231], v32, s[48:51], s37 offen sc1
    s_waitcnt vmcnt(0)
    v_xor_b32 v224, s35, v224
    v_xor_b32 v225, s35, v225
    v_xor_b32 v226, s35, v226
    v_xor_b32 v227, s35, v227
    v_xor_b32 v228, s35, v228
    v_xor_b32 v229, s35, v229
    v_xor_b32 v230, s35, v230
    v_xor_b32 v231, s35, v231
    v_or_b32 v4, v224, v225
    v_or3_b32 v4, v4, v226, v227
    v_or3_b32 v4, v4, v228, v229
    v_or3_b32 v4, v4, v230, v231
    v_and_b32 v4, 0xff, v4
    v_cmp_ne_u32 vcc, 0, v4
    v_add_f32 v232, v224, v228
    v_add_f32 v233, v225, v229
    v_add_f32 v234, v226, v230
    v_add_f32 v235, v227, v231
    s_cbranch_vccz L_hop2ok
    s_sub_u32 s84, s84, 1
    s_cmp_lg_u32 s84, 0
    s_cbranch_scc1 L_hop2
    s_branch L_end
L_hop2ok:
    v_permlane16_swap_b32 v232, v233
    v_permlane16_swap_b32 v234, v235
    v_add_f32 v232, v232, v233
    v_add_f32 v234, v234, v235
    s_nop 1
    v_permlane32_swap_b32 v232, v234
    v_add_f32 v232, v232, v234
    s_nop 1
    v_add_f32_dpp v232, v232, v232 row_ror:8 row_mask:0xf bank_mask:0xf
    s_nop 1
    v_add_f32_dpp v232, v232, v232 row_ror:4 row_mask:0xf bank_mask:0xf
    v_cvt_pk_bf16_f32 v232, v232, v232
    s_mov_b32 exec_lo, 0xf000f
    s_mov_b32 exec_hi, 0xf000f
    buffer_store_short v232, v33, s[72:75], s39 offen
    s_or_b32 s36, s2, s34
    s_cmp_lg_u32 s36, 0
    s_cbranch_scc1 L_done
    v_mov_b32 v4, 0
    s_mov_b64 exec, 1
    buffer_store_dword v8, v4, s[48:51], 0 offen
L_done:
L_end:
    s_endpgm
L_qp:
    v_lshlrev_b32 v4, 18, v2
    v_lshl_add_u32 v14, v3, 4, v4
    v_lshrrev_b32 v5, 3, v3
    v_lshlrev_b32 v5, 10, v5
    v_lshl_add_u32 v15, v2, 6, v5
    s_cmp_eq_u32 s33, 0
    s_cselect_b32 s61, 3, 2
    s_xor_b32 s61, s61, s32
    s_lshl_b32 s86, s34, 8
    s_lshl_b32 s63, s34, 20
    s_lshl_b32 s38, s61, 8
    s_add_u32 s63, s63, s38
    s_mov_b32 s42, 4194304
    s_mov_b32 s43, 0x20000
    s_mov_b32 s46, 4096
    s_mov_b32 s47, 0x20000
    s_cmp_eq_u32 s33, 0
    s_waitcnt lgkmcnt(0)
    s_cselect_b64 s[40:41], s[22:23], s[8:9]
    s_cselect_b64 s[44:45], s[16:17], s[4:5]
    buffer_load_dwordx4 a[128:131], v14, s[40:43], s63 offen nt
    s_add_u32 s63, s63, 8192
    buffer_load_dwordx4 a[132:135], v14, s[40:43], s63 offen nt
    s_add_u32 s63, s63, 8192
    buffer_load_dwordx4 v[20:23], v15, s[44:47], s86 offen offset:0
    buffer_load_dwordx4 v[36:39], v15, s[44:47], s86 offen offset:2048
    buffer_load_dwordx4 a[136:139], v14, s[40:43], s63 offen nt
    s_add_u32 s63, s63, 8192
    buffer_load_dwordx4 a[140:143], v14, s[40:43], s63 offen nt
    s_add_u32 s63, s63, 8192
    buffer_load_dwordx4 a[144:147], v14, s[40:43], s63 offen nt
    s_add_u32 s63, s63, 8192
    buffer_load_dwordx4 a[148:151], v14, s[40:43], s63 offen nt
    s_add_u32 s63, s63, 8192
    buffer_load_dwordx4 a[152:155], v14, s[40:43], s63 offen nt
    s_add_u32 s63, s63, 8192
    buffer_load_dwordx4 a[156:159], v14, s[40:43], s63 offen nt
    s_add_u32 s63, s63, 8192
    s_load_dword s35, s[30:31], 0
    s_mov_b32 s48, s30
    s_and_b32 s49, s31, 0xffff
    s_mov_b32 s50, 8388608
    s_mov_b32 s51, 0x20000
    s_mov_b32 s82, 0xffffff00
    s_mov_b32 s83, 0x3e0293ee
    s_mov_b32 s84, 2097152
    v_and_b32 v4, 1, v1
    v_lshlrev_b32 v4, 4, v4
    v_mov_b32 v5, 0xffff
    v_lshlrev_b32 v4, v4, v5
    v_bfe_u32 v5, v1, 1, 2
    v_cmp_eq_u32 vcc, 0, v5
    s_nop 1
    v_cndmask_b32 v10, 0, v4, vcc
    v_cmp_eq_u32 vcc, 1, v5
    s_nop 1
    v_cndmask_b32 v11, 0, v4, vcc
    v_cmp_eq_u32 vcc, 2, v5
    s_nop 1
    v_cndmask_b32 v12, 0, v4, vcc
    v_cmp_eq_u32 vcc, 3, v5
    s_nop 1
    v_cndmask_b32 v13, 0, v4, vcc
    buffer_load_dwordx4 v[24:27], v15, s[44:47], s86 offen offset:16
    buffer_load_dwordx4 v[40:43], v15, s[44:47], s86 offen offset:2064
    buffer_load_dwordx4 v[28:31], v15, s[44:47], s86 offen offset:32
    buffer_load_dwordx4 v[44:47], v15, s[44:47], s86 offen offset:2080
    buffer_load_dwordx4 v[32:35], v15, s[44:47], s86 offen offset:48
    buffer_load_dwordx4 v[48:51], v15, s[44:47], s86 offen offset:2096
    s_lshl_b32 s38, s61, 10
    s_add_u32 s36, s38, 65536
    s_lshl_b32 s38, s34, 8
    s_add_u32 s36, s38, s36
    v_mov_b32 v19, 0
    s_cmp_eq_u32 s33, 0
    s_cselect_b32 s38, s36, 8388608
    s_mov_b64 exec, 1
    buffer_store_dword v19, v19, s[48:51], s38 offen sc1
    s_mov_b64 exec, -1
    s_mov_b32 s80, 0x01000100
    s_mov_b32 s81, 0x03020302
    s_waitcnt vmcnt(13)
    buffer_load_dwordx4 a[160:163], v14, s[40:43], s63 offen nt
    s_add_u32 s63, s63, 8192
    v_perm_b32 v4, v20, v20, s80
    v_perm_b32 v5, v36, v36, s80
    v_and_b32 v52, v4, v10
    v_and_b32 v53, v4, v11
    v_and_b32 v54, v4, v12
    v_and_b32 v55, v4, v13
    v_and_b32 v56, v5, v10
    v_and_b32 v57, v5, v11
    v_and_b32 v58, v5, v12
    v_and_b32 v59, v5, v13
    v_mfma_f32_16x16x32_bf16 v[60:63], a[128:131], v[52:55], 0
    s_nop 0
    v_mfma_f32_16x16x32_bf16 v[64:67], a[128:131], v[56:59], 0
    buffer_load_dwordx4 a[164:167], v14, s[40:43], s63 offen nt
    s_add_u32 s63, s63, 8192
    v_perm_b32 v4, v20, v20, s81
    v_perm_b32 v5, v36, v36, s81
    v_and_b32 v52, v4, v10
    v_and_b32 v53, v4, v11
    v_and_b32 v54, v4, v12
    v_and_b32 v55, v4, v13
    v_and_b32 v56, v5, v10
    v_and_b32 v57, v5, v11
    v_and_b32 v58, v5, v12
    v_and_b32 v59, v5, v13
    v_mfma_f32_16x16x32_bf16 v[60:63], a[132:135], v[52:55], v[60:63]
    s_nop 0
    v_mfma_f32_16x16x32_bf16 v[64:67], a[132:135], v[56:59], v[64:67]
    s_waitcnt vmcnt(14)
    buffer_load_dwordx4 a[168:171], v14, s[40:43], s63 offen nt
    s_add_u32 s63, s63, 8192
    v_perm_b32 v4, v21, v21, s80
    v_perm_b32 v5, v37, v37, s80
    v_and_b32 v52, v4, v10
    v_and_b32 v53, v4, v11
    v_and_b32 v54, v4, v12
    v_and_b32 v55, v4, v13
    v_and_b32 v56, v5, v10
    v_and_b32 v57, v5, v11
    v_and_b32 v58, v5, v12
    v_and_b32 v59, v5, v13
    v_mfma_f32_16x16x32_bf16 v[60:63], a[136:139], v[52:55], v[60:63]
    s_nop 0
    v_mfma_f32_16x16x32_bf16 v[64:67], a[136:139], v[56:59], v[64:67]
    s_waitcnt vmcnt(14)
    buffer_load_dwordx4 a[172:175], v14, s[40:43], s63 offen nt
    s_add_u32 s63, s63, 8192
    v_perm_b32 v4, v21, v21, s81
    v_perm_b32 v5, v37, v37, s81
    v_and_b32 v52, v4, v10
    v_and_b32 v53, v4, v11
    v_and_b32 v54, v4, v12
    v_and_b32 v55, v4, v13
    v_and_b32 v56, v5, v10
    v_and_b32 v57, v5, v11
    v_and_b32 v58, v5, v12
    v_and_b32 v59, v5, v13
    v_mfma_f32_16x16x32_bf16 v[60:63], a[140:143], v[52:55], v[60:63]
    s_nop 0
    v_mfma_f32_16x16x32_bf16 v[64:67], a[140:143], v[56:59], v[64:67]
    s_waitcnt vmcnt(14)
    buffer_load_dwordx4 a[176:179], v14, s[40:43], s63 offen nt
    s_add_u32 s63, s63, 8192
    v_lshrrev_b32 v4, 2, v3
    v_and_b32 v5, 3, v3
    v_lshlrev_b32 v76, 8, v4
    v_lshlrev_b32 v126, 8, v2
    v_lshl_add_u32 v76, v2, 6, v76
    v_lshl_add_u32 v76, v5, 4, v76
    v_lshl_add_u32 v126, v3, 4, v126
    v_xor_b32 v77, 32768, v76
    v_xor_b32 v127, 32768, v126
    s_add_u32 s3, s34, s33
    s_and_b32 s3, s3, 3
    s_lshl_b32 s89, s3, 5
    s_add_u32 s89, s89, s32
    s_lshl_b32 s89, s89, 20
    s_mul_i32 s88, s32, 8
    s_add_u32 s88, s88, s3
    s_lshl_b32 s87, s33, 0
    v_perm_b32 v4, v22, v22, s80
    v_perm_b32 v5, v38, v38, s80
    v_and_b32 v52, v4, v10
    v_and_b32 v53, v4, v11
    v_and_b32 v54, v4, v12
    v_and_b32 v55, v4, v13
    v_and_b32 v56, v5, v10
    v_and_b32 v57, v5, v11
    v_and_b32 v58, v5, v12
    v_and_b32 v59, v5, v13
    v_mfma_f32_16x16x32_bf16 v[60:63], a[144:147], v[52:55], v[60:63]
    s_nop 0
    v_mfma_f32_16x16x32_bf16 v[64:67], a[144:147], v[56:59], v[64:67]
    s_waitcnt vmcnt(14)
    buffer_load_dwordx4 a[180:183], v14, s[40:43], s63 offen nt
    s_add_u32 s63, s63, 8192
    v_perm_b32 v4, v22, v22, s81
    v_perm_b32 v5, v38, v38, s81
    v_and_b32 v52, v4, v10
    v_and_b32 v53, v4, v11
    v_and_b32 v54, v4, v12
    v_and_b32 v55, v4, v13
    v_and_b32 v56, v5, v10
    v_and_b32 v57, v5, v11
    v_and_b32 v58, v5, v12
    v_and_b32 v59, v5, v13
    v_mfma_f32_16x16x32_bf16 v[60:63], a[148:151], v[52:55], v[60:63]
    s_nop 0
    v_mfma_f32_16x16x32_bf16 v[64:67], a[148:151], v[56:59], v[64:67]
    s_waitcnt vmcnt(14)
    buffer_load_dwordx4 a[184:187], v14, s[40:43], s63 offen nt
    s_add_u32 s63, s63, 8192
    v_perm_b32 v4, v23, v23, s80
    v_perm_b32 v5, v39, v39, s80
    v_and_b32 v52, v4, v10
    v_and_b32 v53, v4, v11
    v_and_b32 v54, v4, v12
    v_and_b32 v55, v4, v13
    v_and_b32 v56, v5, v10
    v_and_b32 v57, v5, v11
    v_and_b32 v58, v5, v12
    v_and_b32 v59, v5, v13
    v_mfma_f32_16x16x32_bf16 v[60:63], a[152:155], v[52:55], v[60:63]
    s_nop 0
    v_mfma_f32_16x16x32_bf16 v[64:67], a[152:155], v[56:59], v[64:67]
    s_waitcnt vmcnt(14)
    buffer_load_dwordx4 a[188:191], v14, s[40:43], s63 offen nt
    s_add_u32 s63, s63, 8192
    v_perm_b32 v4, v23, v23, s81
    v_perm_b32 v5, v39, v39, s81
    v_and_b32 v52, v4, v10
    v_and_b32 v53, v4, v11
    v_and_b32 v54, v4, v12
    v_and_b32 v55, v4, v13
    v_and_b32 v56, v5, v10
    v_and_b32 v57, v5, v11
    v_and_b32 v58, v5, v12
    v_and_b32 v59, v5, v13
    v_mfma_f32_16x16x32_bf16 v[60:63], a[156:159], v[52:55], v[60:63]
    s_nop 0
    v_mfma_f32_16x16x32_bf16 v[64:67], a[156:159], v[56:59], v[64:67]
    s_waitcnt vmcnt(13)
    s_waitcnt vmcnt(7)
    buffer_load_dwordx4 a[192:195], v14, s[40:43], s63 offen nt
    s_add_u32 s63, s63, 8192
    s_mov_b32 s52, s18
    s_and_b32 s53, s19, 0xffff
    s_mov_b32 s54, 134217728
    s_mov_b32 s55, 0x20000
    s_mov_b32 s56, s20
    s_and_b32 s57, s21, 0xffff
    s_mov_b32 s58, 134217728
    s_mov_b32 s59, 0x20000
    v_perm_b32 v4, v24, v24, s80
    v_perm_b32 v5, v40, v40, s80
    v_and_b32 v52, v4, v10
    v_and_b32 v53, v4, v11
    v_and_b32 v54, v4, v12
    v_and_b32 v55, v4, v13
    v_and_b32 v56, v5, v10
    v_and_b32 v57, v5, v11
    v_and_b32 v58, v5, v12
    v_and_b32 v59, v5, v13
    v_mfma_f32_16x16x32_bf16 v[60:63], a[160:163], v[52:55], v[60:63]
    s_nop 0
    v_mfma_f32_16x16x32_bf16 v[64:67], a[160:163], v[56:59], v[64:67]
    s_waitcnt vmcnt(7)
    buffer_load_dwordx4 a[196:199], v14, s[40:43], s63 offen nt
    s_add_u32 s63, s63, 8192
    v_perm_b32 v4, v24, v24, s81
    v_perm_b32 v5, v40, v40, s81
    v_and_b32 v52, v4, v10
    v_and_b32 v53, v4, v11
    v_and_b32 v54, v4, v12
    v_and_b32 v55, v4, v13
    v_and_b32 v56, v5, v10
    v_and_b32 v57, v5, v11
    v_and_b32 v58, v5, v12
    v_and_b32 v59, v5, v13
    v_mfma_f32_16x16x32_bf16 v[60:63], a[164:167], v[52:55], v[60:63]
    s_nop 0
    v_mfma_f32_16x16x32_bf16 v[64:67], a[164:167], v[56:59], v[64:67]
    s_waitcnt vmcnt(7)
    buffer_load_dwordx4 a[200:203], v14, s[40:43], s63 offen nt
    s_add_u32 s63, s63, 8192
    v_perm_b32 v4, v25, v25, s80
    v_perm_b32 v5, v41, v41, s80
    v_and_b32 v52, v4, v10
    v_and_b32 v53, v4, v11
    v_and_b32 v54, v4, v12
    v_and_b32 v55, v4, v13
    v_and_b32 v56, v5, v10
    v_and_b32 v57, v5, v11
    v_and_b32 v58, v5, v12
    v_and_b32 v59, v5, v13
    v_mfma_f32_16x16x32_bf16 v[60:63], a[168:171], v[52:55], v[60:63]
    s_nop 0
    v_mfma_f32_16x16x32_bf16 v[64:67], a[168:171], v[56:59], v[64:67]
    s_waitcnt vmcnt(7)
    buffer_load_dwordx4 a[204:207], v14, s[40:43], s63 offen nt
    s_add_u32 s63, s63, 8192
    v_perm_b32 v4, v25, v25, s81
    v_perm_b32 v5, v41, v41, s81
    v_and_b32 v52, v4, v10
    v_and_b32 v53, v4, v11
    v_and_b32 v54, v4, v12
    v_and_b32 v55, v4, v13
    v_and_b32 v56, v5, v10
    v_and_b32 v57, v5, v11
    v_and_b32 v58, v5, v12
    v_and_b32 v59, v5, v13
    v_mfma_f32_16x16x32_bf16 v[60:63], a[172:175], v[52:55], v[60:63]
    s_nop 0
    v_mfma_f32_16x16x32_bf16 v[64:67], a[172:175], v[56:59], v[64:67]
    s_waitcnt vmcnt(7)
    buffer_load_dwordx4 a[208:211], v14, s[40:43], s63 offen nt
    s_add_u32 s63, s63, 8192
    v_mov_b32 v120, 0xff7f0000
    v_mov_b32 v121, 0
    v_mov_b32 v18, 1
    v_mov_b32 v116, 0
    v_mov_b32 v117, 0
    v_mov_b32 v118, 0
    v_mov_b32 v119, 0
    s_lshl_b32 s38, s32, 10
    s_add_u32 s96, s38, 65536
    s_lshl_b32 s38, s3, 8
    s_add_u32 s96, s38, s96
    v_mov_b32 v9, s96
    s_lshl_b32 s38, s32, 15
    s_add_u32 s96, s38, 1048576
    s_lshl_b32 s38, s3, 13
    s_add_u32 s96, s38, s96
    s_lshl_b32 s38, s33, 10
    s_add_u32 s96, s38, s96
    v_and_b32 v5, 3, v3
    v_lshlrev_b32 v78, 7, v2
    v_lshl_add_u32 v78, v5, 5, v78
    s_lshl_b32 s38, s32, 12
    s_add_u32 s91, s38, 262144
    s_lshl_b32 s38, s3, 9
    s_add_u32 s91, s38, s91
    v_lshlrev_b32 v4, 7, v2
    v_lshl_add_u32 v4, v3, 4, v4
    v_mov_b32 v5, 512
    v_cmp_gt_u32 vcc, 8, v3
    s_nop 1
    v_cndmask_b32 v79, v5, v4, vcc
    v_perm_b32 v4, v26, v26, s80
    v_perm_b32 v5, v42, v42, s80
    v_and_b32 v52, v4, v10
    v_and_b32 v53, v4, v11
    v_and_b32 v54, v4, v12
    v_and_b32 v55, v4, v13
    v_and_b32 v56, v5, v10
    v_and_b32 v57, v5, v11
    v_and_b32 v58, v5, v12
    v_and_b32 v59, v5, v13
    v_mfma_f32_16x16x32_bf16 v[60:63], a[176:179], v[52:55], v[60:63]
    s_nop 0
    v_mfma_f32_16x16x32_bf16 v[64:67], a[176:179], v[56:59], v[64:67]
    s_waitcnt vmcnt(7)
    buffer_load_dwordx4 a[212:215], v14, s[40:43], s63 offen nt
    s_add_u32 s63, s63, 8192
    v_perm_b32 v4, v26, v26, s81
    v_perm_b32 v5, v42, v42, s81
    v_and_b32 v52, v4, v10
    v_and_b32 v53, v4, v11
    v_and_b32 v54, v4, v12
    v_and_b32 v55, v4, v13
    v_and_b32 v56, v5, v10
    v_and_b32 v57, v5, v11
    v_and_b32 v58, v5, v12
    v_and_b32 v59, v5, v13
    v_mfma_f32_16x16x32_bf16 v[60:63], a[180:183], v[52:55], v[60:63]
    s_nop 0
    v_mfma_f32_16x16x32_bf16 v[64:67], a[180:183], v[56:59], v[64:67]
    s_waitcnt vmcnt(7)
    buffer_load_dwordx4 a[216:219], v14, s[40:43], s63 offen nt
    s_add_u32 s63, s63, 8192
    v_perm_b32 v4, v27, v27, s80
    v_perm_b32 v5, v43, v43, s80
    v_and_b32 v52, v4, v10
    v_and_b32 v53, v4, v11
    v_and_b32 v54, v4, v12
    v_and_b32 v55, v4, v13
    v_and_b32 v56, v5, v10
    v_and_b32 v57, v5, v11
    v_and_b32 v58, v5, v12
    v_and_b32 v59, v5, v13
    v_mfma_f32_16x16x32_bf16 v[60:63], a[184:187], v[52:55], v[60:63]
    s_nop 0
    v_mfma_f32_16x16x32_bf16 v[64:67], a[184:187], v[56:59], v[64:67]
    s_waitcnt vmcnt(7)
    buffer_load_dwordx4 a[220:223], v14, s[40:43], s63 offen nt
    s_add_u32 s63, s63, 8192
    v_perm_b32 v4, v27, v27, s81
    v_perm_b32 v5, v43, v43, s81
    v_and_b32 v52, v4, v10
    v_and_b32 v53, v4, v11
    v_and_b32 v54, v4, v12
    v_and_b32 v55, v4, v13
    v_and_b32 v56, v5, v10
    v_and_b32 v57, v5, v11
    v_and_b32 v58, v5, v12
    v_and_b32 v59, v5, v13
    v_mfma_f32_16x16x32_bf16 v[60:63], a[188:191], v[52:55], v[60:63]
    s_nop 0
    v_mfma_f32_16x16x32_bf16 v[64:67], a[188:191], v[56:59], v[64:67]
    s_waitcnt vmcnt(7)
    buffer_load_dwordx4 a[224:227], v14, s[40:43], s63 offen nt
    s_add_u32 s63, s63, 8192
    v_perm_b32 v4, v28, v28, s80
    v_perm_b32 v5, v44, v44, s80
    v_and_b32 v52, v4, v10
    v_and_b32 v53, v4, v11
    v_and_b32 v54, v4, v12
    v_and_b32 v55, v4, v13
    v_and_b32 v56, v5, v10
    v_and_b32 v57, v5, v11
    v_and_b32 v58, v5, v12
    v_and_b32 v59, v5, v13
    v_mfma_f32_16x16x32_bf16 v[60:63], a[192:195], v[52:55], v[60:63]
    s_nop 0
    v_mfma_f32_16x16x32_bf16 v[64:67], a[192:195], v[56:59], v[64:67]
    s_waitcnt vmcnt(7)
    buffer_load_dwordx4 a[228:231], v14, s[40:43], s63 offen nt
    s_add_u32 s63, s63, 8192
    v_perm_b32 v4, v28, v28, s81
    v_perm_b32 v5, v44, v44, s81
    v_and_b32 v52, v4, v10
    v_and_b32 v53, v4, v11
    v_and_b32 v54, v4, v12
    v_and_b32 v55, v4, v13
    v_and_b32 v56, v5, v10
    v_and_b32 v57, v5, v11
    v_and_b32 v58, v5, v12
    v_and_b32 v59, v5, v13
    v_mfma_f32_16x16x32_bf16 v[60:63], a[196:199], v[52:55], v[60:63]
    s_nop 0
    v_mfma_f32_16x16x32_bf16 v[64:67], a[196:199], v[56:59], v[64:67]
    s_waitcnt vmcnt(7)
    buffer_load_dwordx4 a[232:235], v14, s[40:43], s63 offen nt
    s_add_u32 s63, s63, 8192
    v_perm_b32 v4, v29, v29, s80
    v_perm_b32 v5, v45, v45, s80
    v_and_b32 v52, v4, v10
    v_and_b32 v53, v4, v11
    v_and_b32 v54, v4, v12
    v_and_b32 v55, v4, v13
    v_and_b32 v56, v5, v10
    v_and_b32 v57, v5, v11
    v_and_b32 v58, v5, v12
    v_and_b32 v59, v5, v13
    v_mfma_f32_16x16x32_bf16 v[60:63], a[200:203], v[52:55], v[60:63]
    s_nop 0
    v_mfma_f32_16x16x32_bf16 v[64:67], a[200:203], v[56:59], v[64:67]
    s_waitcnt vmcnt(7)
    buffer_load_dwordx4 a[236:239], v14, s[40:43], s63 offen nt
    s_add_u32 s63, s63, 8192
    v_perm_b32 v4, v29, v29, s81
    v_perm_b32 v5, v45, v45, s81
    v_and_b32 v52, v4, v10
    v_and_b32 v53, v4, v11
    v_and_b32 v54, v4, v12
    v_and_b32 v55, v4, v13
    v_and_b32 v56, v5, v10
    v_and_b32 v57, v5, v11
    v_and_b32 v58, v5, v12
    v_and_b32 v59, v5, v13
    v_mfma_f32_16x16x32_bf16 v[60:63], a[204:207], v[52:55], v[60:63]
    s_nop 0
    v_mfma_f32_16x16x32_bf16 v[64:67], a[204:207], v[56:59], v[64:67]
    s_waitcnt vmcnt(7)
    buffer_load_dwordx4 a[240:243], v14, s[40:43], s63 offen nt
    s_add_u32 s63, s63, 8192
    v_perm_b32 v4, v30, v30, s80
    v_perm_b32 v5, v46, v46, s80
    v_and_b32 v52, v4, v10
    v_and_b32 v53, v4, v11
    v_and_b32 v54, v4, v12
    v_and_b32 v55, v4, v13
    v_and_b32 v56, v5, v10
    v_and_b32 v57, v5, v11
    v_and_b32 v58, v5, v12
    v_and_b32 v59, v5, v13
    v_mfma_f32_16x16x32_bf16 v[60:63], a[208:211], v[52:55], v[60:63]
    s_nop 0
    v_mfma_f32_16x16x32_bf16 v[64:67], a[208:211], v[56:59], v[64:67]
    s_waitcnt vmcnt(7)
    buffer_load_dwordx4 a[244:247], v14, s[40:43], s63 offen nt
    s_add_u32 s63, s63, 8192
    v_perm_b32 v4, v30, v30, s81
    v_perm_b32 v5, v46, v46, s81
    v_and_b32 v52, v4, v10
    v_and_b32 v53, v4, v11
    v_and_b32 v54, v4, v12
    v_and_b32 v55, v4, v13
    v_and_b32 v56, v5, v10
    v_and_b32 v57, v5, v11
    v_and_b32 v58, v5, v12
    v_and_b32 v59, v5, v13
    v_mfma_f32_16x16x32_bf16 v[60:63], a[212:215], v[52:55], v[60:63]
    s_nop 0
    v_mfma_f32_16x16x32_bf16 v[64:67], a[212:215], v[56:59], v[64:67]
    s_waitcnt vmcnt(7)
    buffer_load_dwordx4 a[248:251], v14, s[40:43], s63 offen nt
    s_add_u32 s63, s63, 8192
    v_perm_b32 v4, v31, v31, s80
    v_perm_b32 v5, v47, v47, s80
    v_and_b32 v52, v4, v10
    v_and_b32 v53, v4, v11
    v_and_b32 v54, v4, v12
    v_and_b32 v55, v4, v13
    v_and_b32 v56, v5, v10
    v_and_b32 v57, v5, v11
    v_and_b32 v58, v5, v12
    v_and_b32 v59, v5, v13
    v_mfma_f32_16x16x32_bf16 v[60:63], a[216:219], v[52:55], v[60:63]
    s_nop 0
    v_mfma_f32_16x16x32_bf16 v[64:67], a[216:219], v[56:59], v[64:67]
    s_waitcnt vmcnt(7)
    buffer_load_dwordx4 a[252:255], v14, s[40:43], s63 offen nt
    s_add_u32 s63, s63, 8192
    v_perm_b32 v4, v31, v31, s81
    v_perm_b32 v5, v47, v47, s81
    v_and_b32 v52, v4, v10
    v_and_b32 v53, v4, v11
    v_and_b32 v54, v4, v12
    v_and_b32 v55, v4, v13
    v_and_b32 v56, v5, v10
    v_and_b32 v57, v5, v11
    v_and_b32 v58, v5, v12
    v_and_b32 v59, v5, v13
    v_mfma_f32_16x16x32_bf16 v[60:63], a[220:223], v[52:55], v[60:63]
    s_nop 0
    v_mfma_f32_16x16x32_bf16 v[64:67], a[220:223], v[56:59], v[64:67]
    s_waitcnt vmcnt(7)
    v_perm_b32 v4, v32, v32, s80
    v_perm_b32 v5, v48, v48, s80
    v_and_b32 v52, v4, v10
    v_and_b32 v53, v4, v11
    v_and_b32 v54, v4, v12
    v_and_b32 v55, v4, v13
    v_and_b32 v56, v5, v10
    v_and_b32 v57, v5, v11
    v_and_b32 v58, v5, v12
    v_and_b32 v59, v5, v13
    v_mfma_f32_16x16x32_bf16 v[60:63], a[224:227], v[52:55], v[60:63]
    s_nop 0
    v_mfma_f32_16x16x32_bf16 v[64:67], a[224:227], v[56:59], v[64:67]
    s_waitcnt vmcnt(6)
    s_add_u32 s39, s87, s88
    s_bfe_u32 s37, s39, 0x30000
    s_lshl_b32 s37, s37, 12
    s_add_u32 s85, s37, s89
    s_bfe_u32 s37, s39, 0x10003
    s_lshl_b32 s37, s37, 11
    s_add_u32 s85, s37, s85
    s_bfe_u32 s37, s39, 0x40004
    s_lshl_b32 s37, s37, 16
    s_add_u32 s85, s37, s85
    buffer_load_dwordx4 v[128:131], v76, s[52:55], s85 offen offset:0 nt
    v_perm_b32 v4, v32, v32, s81
    v_perm_b32 v5, v48, v48, s81
    v_and_b32 v52, v4, v10
    v_and_b32 v53, v4, v11
    v_and_b32 v54, v4, v12
    v_and_b32 v55, v4, v13
    v_and_b32 v56, v5, v10
    v_and_b32 v57, v5, v11
    v_and_b32 v58, v5, v12
    v_and_b32 v59, v5, v13
    v_mfma_f32_16x16x32_bf16 v[60:63], a[228:231], v[52:55], v[60:63]
    s_nop 0
    v_mfma_f32_16x16x32_bf16 v[64:67], a[228:231], v[56:59], v[64:67]
    s_waitcnt vmcnt(6)
    buffer_load_dwordx4 v[132:135], v77, s[52:55], s85 offen offset:0 nt
    v_perm_b32 v4, v33, v33, s80
    v_perm_b32 v5, v49, v49, s80
    v_and_b32 v52, v4, v10
    v_and_b32 v53, v4, v11
    v_and_b32 v54, v4, v12
    v_and_b32 v55, v4, v13
    v_and_b32 v56, v5, v10
    v_and_b32 v57, v5, v11
    v_and_b32 v58, v5, v12
    v_and_b32 v59, v5, v13
    v_mfma_f32_16x16x32_bf16 v[60:63], a[232:235], v[52:55], v[60:63]
    s_nop 0
    v_mfma_f32_16x16x32_bf16 v[64:67], a[232:235], v[56:59], v[64:67]
    s_waitcnt vmcnt(6)
    buffer_load_dwordx4 v[136:139], v76, s[52:55], s85 offen offset:1024 nt
    v_perm_b32 v4, v33, v33, s81
    v_perm_b32 v5, v49, v49, s81
    v_and_b32 v52, v4, v10
    v_and_b32 v53, v4, v11
    v_and_b32 v54, v4, v12
    v_and_b32 v55, v4, v13
    v_and_b32 v56, v5, v10
    v_and_b32 v57, v5, v11
    v_and_b32 v58, v5, v12
    v_and_b32 v59, v5, v13
    v_mfma_f32_16x16x32_bf16 v[60:63], a[236:239], v[52:55], v[60:63]
    s_nop 0
    v_mfma_f32_16x16x32_bf16 v[64:67], a[236:239], v[56:59], v[64:67]
    s_waitcnt vmcnt(6)
    buffer_load_dwordx4 v[140:143], v77, s[52:55], s85 offen offset:1024 nt
    s_add_u32 s87, s87, 7
    s_add_u32 s39, s87, s88
    s_bfe_u32 s37, s39, 0x30000
    s_lshl_b32 s37, s37, 12
    s_add_u32 s85, s37, s89
    s_bfe_u32 s37, s39, 0x10003
    s_lshl_b32 s37, s37, 11
    s_add_u32 s85, s37, s85
    s_bfe_u32 s37, s39, 0x40004
    s_lshl_b32 s37, s37, 16
    s_add_u32 s85, s37, s85
    v_perm_b32 v4, v34, v34, s80
    v_perm_b32 v5, v50, v50, s80
    v_and_b32 v52, v4, v10
    v_and_b32 v53, v4, v11
    v_and_b32 v54, v4, v12
    v_and_b32 v55, v4, v13
    v_and_b32 v56, v5, v10
    v_and_b32 v57, v5, v11
    v_and_b32 v58, v5, v12
    v_and_b32 v59, v5, v13
    v_mfma_f32_16x16x32_bf16 v[60:63], a[240:243], v[52:55], v[60:63]
    s_nop 0
    v_mfma_f32_16x16x32_bf16 v[64:67], a[240:243], v[56:59], v[64:67]
    s_waitcnt vmcnt(6)
    buffer_load_dwordx4 v[144:147], v76, s[52:55], s85 offen offset:0 nt
    v_perm_b32 v4, v34, v34, s81
    v_perm_b32 v5, v50, v50, s81
    v_and_b32 v52, v4, v10
    v_and_b32 v53, v4, v11
    v_and_b32 v54, v4, v12
    v_and_b32 v55, v4, v13
    v_and_b32 v56, v5, v10
    v_and_b32 v57, v5, v11
    v_and_b32 v58, v5, v12
    v_and_b32 v59, v5, v13
    v_mfma_f32_16x16x32_bf16 v[60:63], a[244:247], v[52:55], v[60:63]
    s_nop 0
    v_mfma_f32_16x16x32_bf16 v[64:67], a[244:247], v[56:59], v[64:67]
    s_waitcnt vmcnt(6)
    buffer_load_dwordx4 v[148:151], v77, s[52:55], s85 offen offset:0 nt
    v_perm_b32 v4, v35, v35, s80
    v_perm_b32 v5, v51, v51, s80
    v_and_b32 v52, v4, v10
    v_and_b32 v53, v4, v11
    v_and_b32 v54, v4, v12
    v_and_b32 v55, v4, v13
    v_and_b32 v56, v5, v10
    v_and_b32 v57, v5, v11
    v_and_b32 v58, v5, v12
    v_and_b32 v59, v5, v13
    v_mfma_f32_16x16x32_bf16 v[60:63], a[248:251], v[52:55], v[60:63]
    s_nop 0
    v_mfma_f32_16x16x32_bf16 v[64:67], a[248:251], v[56:59], v[64:67]
    s_waitcnt vmcnt(6)
    buffer_load_dwordx4 v[152:155], v76, s[52:55], s85 offen offset:1024 nt
    v_perm_b32 v4, v35, v35, s81
    v_perm_b32 v5, v51, v51, s81
    v_and_b32 v52, v4, v10
    v_and_b32 v53, v4, v11
    v_and_b32 v54, v4, v12
    v_and_b32 v55, v4, v13
    v_and_b32 v56, v5, v10
    v_and_b32 v57, v5, v11
    v_and_b32 v58, v5, v12
    v_and_b32 v59, v5, v13
    v_mfma_f32_16x16x32_bf16 v[60:63], a[252:255], v[52:55], v[60:63]
    s_nop 0
    v_mfma_f32_16x16x32_bf16 v[64:67], a[252:255], v[56:59], v[64:67]
    s_lshl_b32 s38, s34, 11
    v_lshrrev_b32 v4, 3, v3
    v_lshlrev_b32 v4, 9, v4
    v_lshl_add_u32 v4, v2, 7, v4
    v_and_b32 v5, 7, v3
    v_lshl_add_u32 v4, v5, 2, v4
    v_add_u32 v4, s38, v4
    ds_write_b32 v4, v60 offset:0
    ds_write_b32 v4, v61 offset:32
    ds_write_b32 v4, v62 offset:64
    ds_write_b32 v4, v63 offset:96
    ds_write_b32 v4, v64 offset:1024
    ds_write_b32 v4, v65 offset:1056
    ds_write_b32 v4, v66 offset:1088
    ds_write_b32 v4, v67 offset:1120
    s_lshl_b32 s38, s34, 9
    v_and_b32 v5, 31, v1
    v_lshl_add_u32 v5, v5, 4, s38
    s_waitcnt lgkmcnt(0)
    s_add_u32 s35, s35, 0x5b
    s_and_b32 s35, s35, 0xff
    v_mov_b32 v8, s35
    s_barrier
    ds_read_b128 v[20:23], v5 offset:0
    ds_read_b128 v[24:27], v5 offset:2048
    ds_read_b128 v[28:31], v5 offset:4096
    ds_read_b128 v[32:35], v5 offset:6144
    s_lshl_b32 s38, s61, 12
    s_add_u32 s36, s38, 262144
    s_lshl_b32 s38, s33, 11
    s_add_u32 s36, s38, s36
    s_waitcnt lgkmcnt(0)
    v_add_f32 v20, v20, v24
    v_add_f32 v28, v28, v32
    v_add_f32 v21, v21, v25
    v_add_f32 v29, v29, v33
    v_add_f32 v22, v22, v26
    v_add_f32 v30, v30, v34
    v_add_f32 v23, v23, v27
    v_add_f32 v31, v31, v35
    v_add_f32 v20, v20, v28
    v_add_f32 v21, v21, v29
    v_add_f32 v22, v22, v30
    v_add_f32 v23, v23, v31
    s_mov_b32 s38, 0xffff0000
    v_cvt_pk_bf16_f32 v20, v20, v20
    v_cvt_pk_bf16_f32 v21, v21, v21
    v_cvt_pk_bf16_f32 v22, v22, v22
    v_cvt_pk_bf16_f32 v23, v23, v23
    v_and_or_b32 v20, v20, s38, v8
    v_and_or_b32 v21, v21, s38, v8
    v_and_or_b32 v22, v22, s38, v8
    v_and_or_b32 v23, v23, s38, v8
    s_mov_b32 exec_lo, 0xffffffff
    s_mov_b32 exec_hi, 0x0
    buffer_store_dwordx4 v[20:23], v5, s[48:51], s36 offen sc1
    s_mov_b64 exec, -1
    s_waitcnt vmcnt(7)
    buffer_load_dwordx4 v[156:159], v77, s[52:55], s85 offen offset:1024 nt
    s_add_u32 s87, s87, 7
    s_add_u32 s39, s87, s88
    s_bfe_u32 s37, s39, 0x30000
    s_lshl_b32 s37, s37, 12
    s_add_u32 s85, s37, s89
    s_bfe_u32 s37, s39, 0x10003
    s_lshl_b32 s37, s37, 11
    s_add_u32 s85, s37, s85
    s_bfe_u32 s37, s39, 0x40004
    s_lshl_b32 s37, s37, 16
    s_add_u32 s85, s37, s85
    s_waitcnt vmcnt(7)
    buffer_load_dwordx4 v[160:163], v76, s[52:55], s85 offen offset:0 nt
    s_waitcnt vmcnt(7)
    buffer_load_dwordx4 v[164:167], v77, s[52:55], s85 offen offset:0 nt
    s_waitcnt vmcnt(7)
    buffer_load_dwordx4 v[168:171], v76, s[52:55], s85 offen offset:1024 nt
    s_waitcnt vmcnt(7)
    buffer_load_dwordx4 v[172:175], v77, s[52:55], s85 offen offset:1024 nt
    s_add_u32 s87, s87, 7
    s_add_u32 s39, s87, s88
    s_bfe_u32 s37, s39, 0x30000
    s_lshl_b32 s37, s37, 12
    s_add_u32 s85, s37, s89
    s_bfe_u32 s37, s39, 0x10003
    s_lshl_b32 s37, s37, 11
    s_add_u32 s85, s37, s85
    s_bfe_u32 s37, s39, 0x40004
    s_lshl_b32 s37, s37, 16
    s_add_u32 s85, s37, s85
    s_waitcnt vmcnt(7)
    buffer_load_dwordx4 v[176:179], v76, s[52:55], s85 offen offset:0 nt
    s_waitcnt vmcnt(7)
    buffer_load_dwordx4 v[180:183], v77, s[52:55], s85 offen offset:0 nt
    s_waitcnt vmcnt(6)
    buffer_load_dwordx4 v[184:187], v76, s[52:55], s85 offen offset:1024 nt
    s_waitcnt vmcnt(6)
    buffer_load_dwordx4 v[188:191], v77, s[52:55], s85 offen offset:1024 nt
    s_add_u32 s87, s87, 7
    s_add_u32 s39, s87, s88
    s_bfe_u32 s37, s39, 0x30000
    s_lshl_b32 s37, s37, 12
    s_add_u32 s85, s37, s89
    s_bfe_u32 s37, s39, 0x10003
    s_lshl_b32 s37, s37, 11
    s_add_u32 s85, s37, s85
    s_bfe_u32 s37, s39, 0x40004
    s_lshl_b32 s37, s37, 16
    s_add_u32 s85, s37, s85
    s_waitcnt vmcnt(6)
    buffer_load_dwordx4 v[192:195], v76, s[52:55], s85 offen offset:0 nt
    s_waitcnt vmcnt(6)
    buffer_load_dwordx4 v[196:199], v77, s[52:55], s85 offen offset:0 nt
    s_waitcnt vmcnt(6)
    buffer_load_dwordx4 v[200:203], v76, s[52:55], s85 offen offset:1024 nt
    s_waitcnt vmcnt(6)
    buffer_load_dwordx4 v[204:207], v77, s[52:55], s85 offen offset:1024 nt
    s_add_u32 s87, s87, 7
    s_add_u32 s39, s87, s88
    s_bfe_u32 s37, s39, 0x30000
    s_lshl_b32 s37, s37, 12
    s_add_u32 s85, s37, s89
    s_bfe_u32 s37, s39, 0x10003
    s_lshl_b32 s37, s37, 11
    s_add_u32 s85, s37, s85
    s_bfe_u32 s37, s39, 0x40004
    s_lshl_b32 s37, s37, 16
    s_add_u32 s85, s37, s85
    s_waitcnt vmcnt(6)
    buffer_load_dwordx4 v[208:211], v76, s[52:55], s85 offen offset:0 nt
    s_waitcnt vmcnt(6)
    buffer_load_dwordx4 v[212:215], v77, s[52:55], s85 offen offset:0 nt
    s_waitcnt vmcnt(6)
    buffer_load_dwordx4 v[216:219], v76, s[52:55], s85 offen offset:1024 nt
    s_waitcnt vmcnt(6)
    buffer_load_dwordx4 v[220:223], v77, s[52:55], s85 offen offset:1024 nt
    s_add_u32 s87, s87, 7
    s_add_u32 s39, s87, s88
    s_bfe_u32 s37, s39, 0x30000
    s_lshl_b32 s37, s37, 12
    s_add_u32 s85, s37, s89
    s_bfe_u32 s37, s39, 0x10003
    s_lshl_b32 s37, s37, 11
    s_add_u32 s85, s37, s85
    s_bfe_u32 s37, s39, 0x40004
    s_lshl_b32 s37, s37, 16
    s_add_u32 s85, s37, s85
    s_waitcnt vmcnt(6)
    buffer_load_dwordx4 v[224:227], v76, s[52:55], s85 offen offset:0 nt
    s_waitcnt vmcnt(6)
    buffer_load_dwordx4 v[228:231], v77, s[52:55], s85 offen offset:0 nt
    s_waitcnt vmcnt(6)
    buffer_load_dwordx4 v[232:235], v76, s[52:55], s85 offen offset:1024 nt
    s_waitcnt vmcnt(6)
    buffer_load_dwordx4 v[236:239], v77, s[52:55], s85 offen offset:1024 nt
    s_add_u32 s87, s87, 7
    s_add_u32 s39, s87, s88
    s_bfe_u32 s37, s39, 0x30000
    s_lshl_b32 s37, s37, 12
    s_add_u32 s85, s37, s89
    s_bfe_u32 s37, s39, 0x10003
    s_lshl_b32 s37, s37, 11
    s_add_u32 s85, s37, s85
    s_bfe_u32 s37, s39, 0x40004
    s_lshl_b32 s37, s37, 16
    s_add_u32 s85, s37, s85
    s_waitcnt vmcnt(6)
    buffer_load_dwordx4 v[240:243], v76, s[52:55], s85 offen offset:0 nt
    s_waitcnt vmcnt(6)
    buffer_load_dwordx4 v[244:247], v77, s[52:55], s85 offen offset:0 nt
    s_waitcnt vmcnt(6)
    buffer_load_dwordx4 v[248:251], v76, s[52:55], s85 offen offset:1024 nt
    s_waitcnt vmcnt(6)
    buffer_load_dwordx4 v[252:255], v77, s[52:55], s85 offen offset:1024 nt
    s_add_u32 s87, s87, 7
    s_add_u32 s39, s87, s88
    s_bfe_u32 s37, s39, 0x30000
    s_lshl_b32 s37, s37, 12
    s_add_u32 s85, s37, s89
    s_bfe_u32 s37, s39, 0x10003
    s_lshl_b32 s37, s37, 11
    s_add_u32 s85, s37, s85
    s_bfe_u32 s37, s39, 0x40004
    s_lshl_b32 s37, s37, 16
    s_add_u32 s85, s37, s85
    s_waitcnt vmcnt(6)
    buffer_load_dwordx4 a[0:3], v76, s[52:55], s85 offen offset:0 nt
    s_waitcnt vmcnt(6)
    buffer_load_dwordx4 a[4:7], v77, s[52:55], s85 offen offset:0 nt
    buffer_load_dwordx4 v[68:71], v78, s[48:51], s91 offen offset:0 sc1
    buffer_load_dwordx4 v[72:75], v78, s[48:51], s91 offen offset:16 sc1
    s_waitcnt vmcnt(8)
    buffer_load_dwordx4 a[8:11], v76, s[52:55], s85 offen offset:1024 nt
    s_waitcnt vmcnt(8)
    buffer_load_dwordx4 a[12:15], v77, s[52:55], s85 offen offset:1024 nt
    s_add_u32 s87, s87, 7
    s_add_u32 s39, s87, s88
    s_bfe_u32 s37, s39, 0x30000
    s_lshl_b32 s37, s37, 12
    s_add_u32 s85, s37, s89
    s_bfe_u32 s37, s39, 0x10003
    s_lshl_b32 s37, s37, 11
    s_add_u32 s85, s37, s85
    s_bfe_u32 s37, s39, 0x40004
    s_lshl_b32 s37, s37, 16
    s_add_u32 s85, s37, s85
    s_waitcnt vmcnt(8)
    buffer_load_dwordx4 a[16:19], v76, s[52:55], s85 offen offset:0 nt
    s_waitcnt vmcnt(8)
    buffer_load_dwordx4 a[20:23], v77, s[52:55], s85 offen offset:0 nt
    s_waitcnt vmcnt(8)
    buffer_load_dwordx4 a[24:27], v76, s[52:55], s85 offen offset:1024 nt
    s_waitcnt vmcnt(8)
    buffer_load_dwordx4 a[28:31], v77, s[52:55], s85 offen offset:1024 nt
    s_add_u32 s87, s87, 7
    s_add_u32 s39, s87, s88
    s_bfe_u32 s37, s39, 0x30000
    s_lshl_b32 s37, s37, 12
    s_add_u32 s85, s37, s89
    s_bfe_u32 s37, s39, 0x10003
    s_lshl_b32 s37, s37, 11
    s_add_u32 s85, s37, s85
    s_bfe_u32 s37, s39, 0x40004
    s_lshl_b32 s37, s37, 16
    s_add_u32 s85, s37, s85
    s_waitcnt vmcnt(6)
L_qcheck_17:
    v_xor_b32 v68, s35, v68
    v_xor_b32 v69, s35, v69
    v_xor_b32 v70, s35, v70
    v_xor_b32 v71, s35, v71
    v_xor_b32 v72, s35, v72
    v_xor_b32 v73, s35, v73
    v_xor_b32 v74, s35, v74
    v_xor_b32 v75, s35, v75
    v_or_b32 v4, v68, v69
    v_or3_b32 v4, v4, v70, v71
    v_or3_b32 v4, v4, v72, v73
    v_or3_b32 v4, v4, v74, v75
    v_and_b32 v4, 0xff, v4
    v_cmp_ne_u32 vcc, 0, v4
    s_cbranch_vccz L_qok_18
    buffer_load_dwordx4 v[68:71], v78, s[48:51], s91 offen offset:0 sc1
    buffer_load_dwordx4 v[72:75], v78, s[48:51], s91 offen offset:16 sc1
    s_waitcnt vmcnt(0)
    s_sub_u32 s84, s84, 1
    s_cmp_lg_u32 s84, 0
    s_cbranch_scc1 L_qcheck_17
    s_branch L_end
L_qok_18:
    v_cvt_pk_bf16_f32 v68, v68, v69
    v_cvt_pk_bf16_f32 v69, v70, v71
    v_cvt_pk_bf16_f32 v70, v72, v73
    v_cvt_pk_bf16_f32 v71, v74, v75
    s_mov_b32 vcc_lo, 0xf000f
    s_mov_b32 vcc_hi, 0xf000f
    v_cndmask_b32 v80, 0, v68, vcc
    v_cndmask_b32 v81, 0, v69, vcc
    v_cndmask_b32 v82, 0, v70, vcc
    v_cndmask_b32 v83, 0, v71, vcc
    s_mov_b32 vcc_lo, 0xf000f0
    s_mov_b32 vcc_hi, 0xf000f0
    v_cndmask_b32 v84, 0, v68, vcc
    v_cndmask_b32 v85, 0, v69, vcc
    v_cndmask_b32 v86, 0, v70, vcc
    v_cndmask_b32 v87, 0, v71, vcc
    s_mov_b32 vcc_lo, 0xf000f00
    s_mov_b32 vcc_hi, 0xf000f00
    v_cndmask_b32 v88, 0, v68, vcc
    v_cndmask_b32 v89, 0, v69, vcc
    v_cndmask_b32 v90, 0, v70, vcc
    v_cndmask_b32 v91, 0, v71, vcc
    s_mov_b32 vcc_lo, 0xf000f000
    s_mov_b32 vcc_hi, 0xf000f000
    v_cndmask_b32 v92, 0, v68, vcc
    v_cndmask_b32 v93, 0, v69, vcc
    v_cndmask_b32 v94, 0, v70, vcc
    v_cndmask_b32 v95, 0, v71, vcc
    v_mov_b32 v65, 0xff7f0000
    s_lshl_b32 s38, s34, 14
    s_add_u32 s38, s38, 16384
    v_lshl_add_u32 v64, v1, 2, s38
    buffer_load_dwordx4 a[32:35], v76, s[52:55], s85 offen offset:0 nt
    v_mfma_f32_16x16x32_bf16 v[112:115], v[128:131], v[80:83], 0
    v_mfma_f32_16x16x32_bf16 v[112:115], v[132:135], v[84:87], v[112:115]
    v_mfma_f32_16x16x32_bf16 v[112:115], v[136:139], v[88:91], v[112:115]
    s_waitcnt vmcnt(6)
    buffer_load_dwordx4 a[36:39], v77, s[52:55], s85 offen offset:0 nt
    v_mfma_f32_16x16x32_bf16 v[112:115], v[140:143], v[92:95], v[112:115]
    v_mfma_f32_16x16x32_bf16 v[96:99], v[144:147], v[80:83], 0
    v_mfma_f32_16x16x32_bf16 v[96:99], v[148:151], v[84:87], v[96:99]
    s_waitcnt vmcnt(6)
    buffer_load_dwordx4 a[40:43], v76, s[52:55], s85 offen offset:1024 nt
    v_mfma_f32_16x16x32_bf16 v[96:99], v[152:155], v[88:91], v[96:99]
    s_nop 2
    v_mov_b32_dpp v122, v112 quad_perm:[0,0,0,0] row_mask:0xf bank_mask:0xf
    v_mov_b32_dpp v124, v114 quad_perm:[2,2,2,2] row_mask:0xf bank_mask:0xf
    s_nop 0
    v_add_f32_dpp v122, v113, v122 quad_perm:[1,1,1,1] row_mask:0xf bank_mask:0xf
    v_add_f32_dpp v124, v115, v124 quad_perm:[3,3,3,3] row_mask:0xf bank_mask:0xf
    v_add_f32 v122, v122, v124
    v_max_f32 v65, v65, v122
    ds_write_b32 v64, v122 offset:0
    v_mfma_f32_16x16x32_bf16 v[96:99], v[156:159], v[92:95], v[96:99]
    v_mfma_f32_16x16x32_bf16 v[112:115], v[160:163], v[80:83], 0
    v_mfma_f32_16x16x32_bf16 v[112:115], v[164:167], v[84:87], v[112:115]
    s_waitcnt vmcnt(6)
    buffer_load_dwordx4 a[44:47], v77, s[52:55], s85 offen offset:1024 nt
    s_add_u32 s87, s87, 7
    s_add_u32 s39, s87, s88
    s_bfe_u32 s37, s39, 0x30000
    s_lshl_b32 s37, s37, 12
    s_add_u32 s85, s37, s89
    s_bfe_u32 s37, s39, 0x10003
    s_lshl_b32 s37, s37, 11
    s_add_u32 s85, s37, s85
    s_bfe_u32 s37, s39, 0x40004
    s_lshl_b32 s37, s37, 16
    s_add_u32 s85, s37, s85
    v_mfma_f32_16x16x32_bf16 v[112:115], v[168:171], v[88:91], v[112:115]
    v_mov_b32_dpp v122, v96 quad_perm:[0,0,0,0] row_mask:0xf bank_mask:0xf
    v_mov_b32_dpp v124, v98 quad_perm:[2,2,2,2] row_mask:0xf bank_mask:0xf
    s_nop 0
    v_add_f32_dpp v122, v97, v122 quad_perm:[1,1,1,1] row_mask:0xf bank_mask:0xf
    v_add_f32_dpp v124, v99, v124 quad_perm:[3,3,3,3] row_mask:0xf bank_mask:0xf
    v_add_f32 v122, v122, v124
    v_max_f32 v65, v65, v122
    ds_write_b32 v64, v122 offset:256
    v_mfma_f32_16x16x32_bf16 v[112:115], v[172:175], v[92:95], v[112:115]
    v_mfma_f32_16x16x32_bf16 v[96:99], v[176:179], v[80:83], 0
    s_waitcnt vmcnt(6)
    buffer_load_dwordx4 a[48:51], v76, s[52:55], s85 offen offset:0 nt
    v_mfma_f32_16x16x32_bf16 v[96:99], v[180:183], v[84:87], v[96:99]
    v_mfma_f32_16x16x32_bf16 v[96:99], v[184:187], v[88:91], v[96:99]
    s_nop 2
    v_mov_b32_dpp v122, v112 quad_perm:[0,0,0,0] row_mask:0xf bank_mask:0xf
    v_mov_b32_dpp v124, v114 quad_perm:[2,2,2,2] row_mask:0xf bank_mask:0xf
    s_nop 0
    v_add_f32_dpp v122, v113, v122 quad_perm:[1,1,1,1] row_mask:0xf bank_mask:0xf
    v_add_f32_dpp v124, v115, v124 quad_perm:[3,3,3,3] row_mask:0xf bank_mask:0xf
    v_add_f32 v122, v122, v124
    v_max_f32 v65, v65, v122
    ds_write_b32 v64, v122 offset:512
    v_mfma_f32_16x16x32_bf16 v[96:99], v[188:191], v[92:95], v[96:99]
    v_mfma_f32_16x16x32_bf16 v[112:115], v[192:195], v[80:83], 0
    s_waitcnt vmcnt(6)
    buffer_load_dwordx4 a[52:55], v77, s[52:55], s85 offen offset:0 nt
    v_mfma_f32_16x16x32_bf16 v[112:115], v[196:199], v[84:87], v[112:115]
    v_mfma_f32_16x16x32_bf16 v[112:115], v[200:203], v[88:91], v[112:115]
    s_nop 2
    v_mov_b32_dpp v122, v96 quad_perm:[0,0,0,0] row_mask:0xf bank_mask:0xf
    v_mov_b32_dpp v124, v98 quad_perm:[2,2,2,2] row_mask:0xf bank_mask:0xf
    s_nop 0
    v_add_f32_dpp v122, v97, v122 quad_perm:[1,1,1,1] row_mask:0xf bank_mask:0xf
    v_add_f32_dpp v124, v99, v124 quad_perm:[3,3,3,3] row_mask:0xf bank_mask:0xf
    v_add_f32 v122, v122, v124
    v_max_f32 v65, v65, v122
    ds_write_b32 v64, v122 offset:768
    v_mfma_f32_16x16x32_bf16 v[112:115], v[204:207], v[92:95], v[112:115]
    s_waitcnt vmcnt(6)
    buffer_load_dwordx4 a[56:59], v76, s[52:55], s85 offen offset:1024 nt
    v_mfma_f32_16x16x32_bf16 v[96:99], v[208:211], v[80:83], 0
    v_mfma_f32_16x16x32_bf16 v[96:99], v[212:215], v[84:87], v[96:99]
    v_mfma_f32_16x16x32_bf16 v[96:99], v[216:219], v[88:91], v[96:99]
    s_nop 2
    v_mov_b32_dpp v122, v112 quad_perm:[0,0,0,0] row_mask:0xf bank_mask:0xf
    v_mov_b32_dpp v124, v114 quad_perm:[2,2,2,2] row_mask:0xf bank_mask:0xf
    s_nop 0
    v_add_f32_dpp v122, v113, v122 quad_perm:[1,1,1,1] row_mask:0xf bank_mask:0xf
    v_add_f32_dpp v124, v115, v124 quad_perm:[3,3,3,3] row_mask:0xf bank_mask:0xf
    v_add_f32 v122, v122, v124
    v_max_f32 v65, v65, v122
    ds_write_b32 v64, v122 offset:1024
    v_mfma_f32_16x16x32_bf16 v[96:99], v[220:223], v[92:95], v[96:99]
    s_waitcnt vmcnt(6)
    buffer_load_dwordx4 a[60:63], v77, s[52:55], s85 offen offset:1024 nt
    s_add_u32 s87, s87, 7
    s_add_u32 s39, s87, s88
    s_bfe_u32 s37, s39, 0x30000
    s_lshl_b32 s37, s37, 12
    s_add_u32 s85, s37, s89
    s_bfe_u32 s37, s39, 0x10003
    s_lshl_b32 s37, s37, 11
    s_add_u32 s85, s37, s85
    s_bfe_u32 s37, s39, 0x40004
    s_lshl_b32 s37, s37, 16
    s_add_u32 s85, s37, s85
    v_mfma_f32_16x16x32_bf16 v[112:115], v[224:227], v[80:83], 0
    s_sub_u32 s36, s33, 3
    s_and_b32 s37, s33, 3
    s_cmp_lt_u32 s36, 4
    s_cselect_b64 s[40:41], s[24:25], s[14:15]
    s_cselect_b32 s36, s36, s37
    s_cselect_b32 s45, 262144, 0
    s_cselect_b32 s46, 8388608, 0
    s_add_u32 s45, s45, 524288
    s_add_u32 s46, s46, 196608
    s_mov_b32 s42, 4194304
    s_mov_b32 s43, 0x20000
    s_lshl_b32 s38, s32, 17
    s_add_u32 s44, s38, 0
    s_lshl_b32 s38, s34, 15
    s_add_u32 s44, s38, s44
    s_lshl_b32 s38, s36, 8
    s_add_u32 s44, s38, s44
    s_lshl_b32 s38, s36, 16
    s_add_u32 s45, s38, s45
    s_lshr_b32 s38, s34, 1
    s_lshl_b32 s38, s38, 15
    s_add_u32 s45, s38, s45
    s_lshl_b32 s38, s32, 8
    s_add_u32 s45, s38, s45
    s_bfe_u32 s38, s34, 0x10000
    s_lshl_b32 s38, s38, 7
    s_add_u32 s45, s38, s45
    s_lshl_b32 s38, s32, 11
    s_add_u32 s46, s38, s46
    s_lshl_b32 s38, s34, 9
    s_add_u32 s46, s38, s46
    s_mov_b32 s72, s26
    s_and_b32 s73, s27, 0xffff
    s_mov_b32 s74, 8192
    s_mov_b32 s75, 0x20000
    v_mfma_f32_16x16x32_bf16 v[112:115], v[228:231], v[84:87], v[112:115]
    v_mfma_f32_16x16x32_bf16 v[112:115], v[232:235], v[88:91], v[112:115]
    v_mov_b32_dpp v122, v96 quad_perm:[0,0,0,0] row_mask:0xf bank_mask:0xf
    v_mov_b32_dpp v124, v98 quad_perm:[2,2,2,2] row_mask:0xf bank_mask:0xf
    s_nop 0
    v_add_f32_dpp v122, v97, v122 quad_perm:[1,1,1,1] row_mask:0xf bank_mask:0xf
    v_add_f32_dpp v124, v99, v124 quad_perm:[3,3,3,3] row_mask:0xf bank_mask:0xf
    v_add_f32 v122, v122, v124
    v_max_f32 v65, v65, v122
    ds_write_b32 v64, v122 offset:1280
    s_waitcnt vmcnt(5)
    buffer_load_dwordx4 v[128:131], v76, s[52:55], s85 offen offset:0 nt
    v_mfma_f32_16x16x32_bf16 v[112:115], v[236:239], v[92:95], v[112:115]
    v_mfma_f32_16x16x32_bf16 v[96:99], v[240:243], v[80:83], 0
    v_mfma_f32_16x16x32_bf16 v[96:99], v[244:247], v[84:87], v[96:99]
    s_waitcnt vmcnt(5)
    buffer_load_dwordx4 v[132:135], v77, s[52:55], s85 offen offset:0 nt
    v_mfma_f32_16x16x32_bf16 v[96:99], v[248:251], v[88:91], v[96:99]
    s_nop 2
    v_mov_b32_dpp v122, v112 quad_perm:[0,0,0,0] row_mask:0xf bank_mask:0xf
    v_mov_b32_dpp v124, v114 quad_perm:[2,2,2,2] row_mask:0xf bank_mask:0xf
    s_nop 0
    v_add_f32_dpp v122, v113, v122 quad_perm:[1,1,1,1] row_mask:0xf bank_mask:0xf
    v_add_f32_dpp v124, v115, v124 quad_perm:[3,3,3,3] row_mask:0xf bank_mask:0xf
    v_add_f32 v122, v122, v124
    v_max_f32 v65, v65, v122
    ds_write_b32 v64, v122 offset:1536
    v_lshlrev_b32 v4, 2, v2
    v_xor_b32 v4, v4, v3
    v_xor_b32 v5, 0, v4
    v_lshlrev_b32 v5, 4, v5
    v_lshl_add_u32 v20, v2, 10, v5
    v_xor_b32 v5, 1, v4
    v_lshlrev_b32 v5, 4, v5
    v_lshl_add_u32 v21, v2, 10, v5
    v_add_u32 v21, 3072, v21
    v_xor_b32 v5, 2, v4
    v_lshlrev_b32 v5, 4, v5
    v_lshl_add_u32 v22, v2, 10, v5
    v_add_u32 v22, 6144, v22
    v_xor_b32 v5, 3, v4
    v_lshlrev_b32 v5, 4, v5
    v_lshl_add_u32 v23, v2, 10, v5
    v_add_u32 v23, 9216, v23
    s_lshl_b32 s38, s32, 15
    s_add_u32 s47, s38, 1048576
    s_lshl_b32 s38, s3, 13
    s_add_u32 s47, s38, s47
    s_mul_i32 s38, s3, 320
    s_add_u32 s38, s38, 135168
    v_lshlrev_b32 v4, 6, v2
    v_lshl_add_u32 v4, v3, 1, v4
    v_add_u32 v31, s38, v4
    v_mfma_f32_16x16x32_bf16 v[96:99], v[252:255], v[92:95], v[96:99]
    v_mfma_f32_16x16x32_bf16 v[112:115], a[0:3], v[80:83], 0
    v_mfma_f32_16x16x32_bf16 v[112:115], a[4:7], v[84:87], v[112:115]
    s_waitcnt vmcnt(5)
    buffer_load_dwordx4 v[136:139], v76, s[52:55], s85 offen offset:1024 nt
    v_mfma_f32_16x16x32_bf16 v[112:115], a[8:11], v[88:91], v[112:115]
    s_nop 2
    v_mov_b32_dpp v122, v96 quad_perm:[0,0,0,0] row_mask:0xf bank_mask:0xf
    v_mov_b32_dpp v124, v98 quad_perm:[2,2,2,2] row_mask:0xf bank_mask:0xf
    s_nop 0
    v_add_f32_dpp v122, v97, v122 quad_perm:[1,1,1,1] row_mask:0xf bank_mask:0xf
    v_add_f32_dpp v124, v99, v124 quad_perm:[3,3,3,3] row_mask:0xf bank_mask:0xf
    v_add_f32 v122, v122, v124
    v_max_f32 v65, v65, v122
    ds_write_b32 v64, v122 offset:1792
    v_mfma_f32_16x16x32_bf16 v[112:115], a[12:15], v[92:95], v[112:115]
    v_mfma_f32_16x16x32_bf16 v[96:99], a[16:19], v[80:83], 0
    v_lshlrev_b32 v4, 11, v2
    v_bfe_u32 v5, v1, 2, 2
    v_lshl_add_u32 v4, v5, 8, v4
    v_bfe_u32 v5, v1, 2, 2
    v_lshl_add_u32 v4, v5, 6, v4
    v_bfe_u32 v5, v1, 4, 1
    v_lshl_add_u32 v4, v5, 5, v4
    v_bfe_u32 v5, v1, 1, 1
    v_lshl_add_u32 v4, v5, 4, v4
    v_bfe_u32 v5, v1, 0, 1
    v_lshl_add_u32 v4, v5, 3, v4
    s_lshl_b32 s38, s34, 6
    s_add_u32 s38, s38, 98304
    v_xor_b32 v24, s38, v4
    v_xor_b32 v25, 16, v24
    v_xor_b32 v26, 32, v24
    v_xor_b32 v27, 48, v24
    v_and_b32 v4, 3, v3
    v_lshrrev_b32 v5, 2, v3
    v_lshlrev_b32 v6, 4, v2
    v_add_u32 v6, 135168, v6
    s_movk_i32 s36, 320
    v_cmp_eq_u32 vcc, 0, v5
    s_nop 1
    v_cndmask_b32 v28, 4, v4, vcc
    v_mad_u32_u24 v28, v28, s36, v6
    v_cmp_eq_u32 vcc, 1, v5
    s_nop 1
    v_cndmask_b32 v29, 4, v4, vcc
    v_mad_u32_u24 v29, v29, s36, v6
    v_lshlrev_b32 v5, 2, v1
    v_add_u32 v5, 136448, v5
    v_mov_b32 v6, 0
    ds_write_b32 v5, v6
    s_waitcnt vmcnt(5)
    buffer_load_dwordx4 v[140:143], v77, s[52:55], s85 offen offset:1024 nt
    s_add_u32 s87, s87, 7
    s_add_u32 s39, s87, s88
    s_bfe_u32 s37, s39, 0x30000
    s_lshl_b32 s37, s37, 12
    s_add_u32 s85, s37, s89
    s_bfe_u32 s37, s39, 0x10003
    s_lshl_b32 s37, s37, 11
    s_add_u32 s85, s37, s85
    s_bfe_u32 s37, s39, 0x40004
    s_lshl_b32 s37, s37, 16
    s_add_u32 s85, s37, s85
    v_mfma_f32_16x16x32_bf16 v[96:99], a[20:23], v[84:87], v[96:99]
    v_mfma_f32_16x16x32_bf16 v[96:99], a[24:27], v[88:91], v[96:99]
    v_mov_b32_dpp v122, v112 quad_perm:[0,0,0,0] row_mask:0xf bank_mask:0xf
    v_mov_b32_dpp v124, v114 quad_perm:[2,2,2,2] row_mask:0xf bank_mask:0xf
    s_nop 0
    v_add_f32_dpp v122, v113, v122 quad_perm:[1,1,1,1] row_mask:0xf bank_mask:0xf
    v_add_f32_dpp v124, v115, v124 quad_perm:[3,3,3,3] row_mask:0xf bank_mask:0xf
    v_add_f32 v122, v122, v124
    v_max_f32 v65, v65, v122
    ds_write_b32 v64, v122 offset:2048
    v_mfma_f32_16x16x32_bf16 v[96:99], a[28:31], v[92:95], v[96:99]
    v_mfma_f32_16x16x32_bf16 v[112:115], a[32:35], v[80:83], 0
    s_waitcnt vmcnt(5)
    buffer_load_dwordx4 v[144:147], v76, s[52:55], s85 offen offset:0 nt
    v_mfma_f32_16x16x32_bf16 v[112:115], a[36:39], v[84:87], v[112:115]
    v_mfma_f32_16x16x32_bf16 v[112:115], a[40:43], v[88:91], v[112:115]
    s_nop 2
    v_mov_b32_dpp v122, v96 quad_perm:[0,0,0,0] row_mask:0xf bank_mask:0xf
    v_mov_b32_dpp v124, v98 quad_perm:[2,2,2,2] row_mask:0xf bank_mask:0xf
    s_nop 0
    v_add_f32_dpp v122, v97, v122 quad_perm:[1,1,1,1] row_mask:0xf bank_mask:0xf
    v_add_f32_dpp v124, v99, v124 quad_perm:[3,3,3,3] row_mask:0xf bank_mask:0xf
    v_add_f32 v122, v122, v124
    v_max_f32 v65, v65, v122
    ds_write_b32 v64, v122 offset:2304
    v_lshlrev_b32 v30, 4, v3
    v_lshl_add_u32 v30, v2, 13, v30
    s_lshl_b32 s38, s32, 13
    s_add_u32 s36, s38, 0
    s_lshl_b32 s38, s34, 6
    s_add_u32 s36, s38, s36
    v_lshrrev_b32 v5, 2, v1
    v_lshlrev_b32 v32, 8, v5
    v_bfe_u32 v5, v1, 0, 2
    v_lshl_add_u32 v32, v5, 4, v32
    v_add_u32 v32, s36, v32
    s_lshr_b32 s38, s32, 2
    s_lshl_b32 s38, s38, 7
    s_add_u32 s36, s38, 0
    s_lshl_b32 s38, s34, 5
    s_add_u32 s36, s38, s36
    s_bfe_u32 s38, s32, 0x20000
    s_lshl_b32 s38, s38, 3
    s_add_u32 s36, s38, s36
    v_bfe_u32 v5, v1, 0, 2
    v_lshlrev_b32 v33, 11, v5
    v_lshl_add_u32 v33, v2, 1, v33
    v_add_u32 v33, s36, v33
    v_and_b32 v5, 31, v1
    v_lshlrev_b32 v34, 4, v5
    s_mul_i32 s38, s34, 320
    s_add_u32 s38, s38, 135168
    v_lshl_add_u32 v35, v5, 3, s38
    v_mfma_f32_16x16x32_bf16 v[112:115], a[44:47], v[92:95], v[112:115]
    s_waitcnt vmcnt(5)
    buffer_load_dwordx4 v[148:151], v77, s[52:55], s85 offen offset:0 nt
    v_mfma_f32_16x16x32_bf16 v[96:99], a[48:51], v[80:83], 0
    v_mfma_f32_16x16x32_bf16 v[96:99], a[52:55], v[84:87], v[96:99]
    v_mfma_f32_16x16x32_bf16 v[96:99], a[56:59], v[88:91], v[96:99]
    s_nop 2
    v_mov_b32_dpp v122, v112 quad_perm:[0,0,0,0] row_mask:0xf bank_mask:0xf
    v_mov_b32_dpp v124, v114 quad_perm:[2,2,2,2] row_mask:0xf bank_mask:0xf
    s_nop 0
    v_add_f32_dpp v122, v113, v122 quad_perm:[1,1,1,1] row_mask:0xf bank_mask:0xf
    v_add_f32_dpp v124, v115, v124 quad_perm:[3,3,3,3] row_mask:0xf bank_mask:0xf
    v_add_f32 v122, v122, v124
    v_max_f32 v65, v65, v122
    ds_write_b32 v64, v122 offset:2560
    v_mfma_f32_16x16x32_bf16 v[96:99], a[60:63], v[92:95], v[96:99]
    v_add_u32 v64, 2816, v64
    s_mov_b32 s97, 10
    s_mov_b32 s86, 32
    s_and_b32 s36, s32, 3
    s_sub_u32 s80, s36, 2
    s_cmp_ge_u32 s36, 2
    s_cselect_b32 s80, s80, 8
    s_cselect_b32 s81, 27, 25
    s_cmp_eq_u32 s80, s33
    s_cselect_b32 s36, 2, 0
    s_sub_u32 s86, s86, s36
    s_lshr_b32 s36, s36, 1
    s_sub_u32 s97, s97, s36
    s_add_u32 s80, s80, 35
    s_sub_u32 s92, s81, 1
    s_mov_b32 s66, 134217728
    s_mov_b32 s67, 0x20000
    s_mov_b64 s[64:65], s[52:53]
    v_mov_b32 v62, v76
    v_mov_b32 v63, v77
    s_branch L_bloop
L_ql:
    v_lshrrev_b32 v4, 2, v3
    v_and_b32 v5, 3, v3
    v_lshlrev_b32 v19, 6, v2
    v_lshl_add_u32 v19, v5, 4, v19
    v_lshl_add_u32 v14, v4, 18, v19
    s_and_b32 s61, s32, 28
    s_add_u32 s61, s61, s34
    s_and_b32 s60, s32, 3
    s_lshl_b32 s38, s60, 20
    s_add_u32 s63, s38, 0
    s_lshl_b32 s38, s61, 8
    s_add_u32 s63, s38, s63
    s_mov_b32 s74, 4194304
    s_mov_b32 s75, 0x20000
    s_waitcnt lgkmcnt(0)
    s_mov_b64 s[72:73], s[10:11]
    buffer_load_dwordx4 a[128:131], v14, s[72:75], s63 offen nt
    s_add_u32 s63, s63, 8192
    buffer_load_dwordx4 a[132:135], v14, s[72:75], s63 offen nt
    s_add_u32 s63, s63, 8192
    buffer_load_dwordx4 a[136:139], v14, s[72:75], s63 offen nt
    s_add_u32 s63, s63, 8192
    buffer_load_dwordx4 a[140:143], v14, s[72:75], s63 offen nt
    s_add_u32 s63, s63, 8192
    buffer_load_dwordx4 a[144:147], v14, s[72:75], s63 offen nt
    s_add_u32 s63, s63, 8192
    buffer_load_dwordx4 a[148:151], v14, s[72:75], s63 offen nt
    s_add_u32 s63, s63, 8192
    buffer_load_dwordx4 a[152:155], v14, s[72:75], s63 offen nt
    s_add_u32 s63, s63, 8192
    buffer_load_dwordx4 a[156:159], v14, s[72:75], s63 offen nt
    s_add_u32 s63, s63, 8192
    v_lshlrev_b32 v15, 1, v19
    v_lshl_add_u32 v15, v4, 9, v15
    v_lshl_add_u32 v19, v4, 15, v19
    s_load_dword s35, s[30:31], 0
    s_mov_b32 s48, s30
    s_and_b32 s49, s31, 0xffff
    s_mov_b32 s50, 8388608
    s_mov_b32 s51, 0x20000
    s_mov_b32 s82, 0xffffff00
    s_mov_b32 s83, 0x3e0293ee
    s_mov_b32 s84, 2097152
    s_lshl_b32 s38, s61, 12
    s_add_u32 s95, s38, 264192
    s_lshl_b32 s38, s61, 10
    s_add_u32 s94, s38, 393216
    s_lshl_b32 s38, s60, 8
    s_add_u32 s94, s38, s94
    s_waitcnt vmcnt(7)
    buffer_load_dwordx4 a[160:163], v14, s[72:75], s63 offen nt
    s_add_u32 s63, s63, 8192
    s_waitcnt vmcnt(7)
    buffer_load_dwordx4 a[164:167], v14, s[72:75], s63 offen nt
    s_add_u32 s63, s63, 8192
    s_waitcnt vmcnt(7)
    buffer_load_dwordx4 a[168:171], v14, s[72:75], s63 offen nt
    s_add_u32 s63, s63, 8192
    s_waitcnt vmcnt(7)
    buffer_load_dwordx4 a[172:175], v14, s[72:75], s63 offen nt
    s_add_u32 s63, s63, 8192
    s_waitcnt vmcnt(7)
    buffer_load_dwordx4 a[176:179], v14, s[72:75], s63 offen nt
    s_add_u32 s63, s63, 8192
    v_and_b32 v4, 1, v1
    v_lshlrev_b32 v4, 4, v4
    v_mov_b32 v5, 0xffff
    v_lshlrev_b32 v4, v4, v5
    v_bfe_u32 v5, v1, 1, 2
    v_cmp_eq_u32 vcc, 0, v5
    s_nop 1
    v_cndmask_b32 v10, 0, v4, vcc
    v_cmp_eq_u32 vcc, 1, v5
    s_nop 1
    v_cndmask_b32 v11, 0, v4, vcc
    v_cmp_eq_u32 vcc, 2, v5
    s_nop 1
    v_cndmask_b32 v12, 0, v4, vcc
    v_cmp_eq_u32 vcc, 3, v5
    s_nop 1
    v_cndmask_b32 v13, 0, v4, vcc
    s_waitcnt vmcnt(7)
    buffer_load_dwordx4 a[180:183], v14, s[72:75], s63 offen nt
    s_add_u32 s63, s63, 8192
    s_waitcnt vmcnt(7)
    buffer_load_dwordx4 a[184:187], v14, s[72:75], s63 offen nt
    s_add_u32 s63, s63, 8192
    s_waitcnt vmcnt(7)
    buffer_load_dwordx4 a[188:191], v14, s[72:75], s63 offen nt
    s_add_u32 s63, s63, 8192
    s_waitcnt vmcnt(7)
    buffer_load_dwordx4 a[192:195], v14, s[72:75], s63 offen nt
    s_add_u32 s63, s63, 8192
    v_lshrrev_b32 v4, 2, v3
    v_and_b32 v5, 3, v3
    v_lshlrev_b32 v76, 8, v4
    v_lshlrev_b32 v126, 8, v2
    v_lshl_add_u32 v76, v2, 6, v76
    v_lshl_add_u32 v76, v5, 4, v76
    v_lshl_add_u32 v126, v3, 4, v126
    v_xor_b32 v77, 32768, v76
    v_xor_b32 v127, 32768, v126
    s_add_u32 s3, s34, s33
    s_and_b32 s3, s3, 3
    s_lshl_b32 s89, s3, 5
    s_add_u32 s89, s89, s32
    s_lshl_b32 s89, s89, 20
    s_mul_i32 s88, s32, 8
    s_add_u32 s88, s88, s3
    s_lshl_b32 s87, s33, 0
    s_waitcnt vmcnt(7)
    buffer_load_dwordx4 a[196:199], v14, s[72:75], s63 offen nt
    s_add_u32 s63, s63, 8192
    s_waitcnt vmcnt(7)
    buffer_load_dwordx4 a[200:203], v14, s[72:75], s63 offen nt
    s_add_u32 s63, s63, 8192
    s_waitcnt vmcnt(7)
    buffer_load_dwordx4 a[204:207], v14, s[72:75], s63 offen nt
    s_add_u32 s63, s63, 8192
    s_waitcnt vmcnt(7)
    buffer_load_dwordx4 a[208:211], v14, s[72:75], s63 offen nt
    s_add_u32 s63, s63, 8192
    s_mov_b32 s52, s18
    s_and_b32 s53, s19, 0xffff
    s_mov_b32 s54, 134217728
    s_mov_b32 s55, 0x20000
    s_mov_b32 s56, s20
    s_and_b32 s57, s21, 0xffff
    s_mov_b32 s58, 134217728
    s_mov_b32 s59, 0x20000
    s_waitcnt vmcnt(7)
    buffer_load_dwordx4 a[212:215], v14, s[72:75], s63 offen nt
    s_add_u32 s63, s63, 8192
    s_waitcnt vmcnt(7)
    buffer_load_dwordx4 a[216:219], v14, s[72:75], s63 offen nt
    s_add_u32 s63, s63, 8192
    s_waitcnt vmcnt(7)
    buffer_load_dwordx4 a[220:223], v14, s[72:75], s63 offen nt
    s_add_u32 s63, s63, 8192
    s_waitcnt vmcnt(7)
    buffer_load_dwordx4 a[224:227], v14, s[72:75], s63 offen nt
    s_add_u32 s63, s63, 8192
    v_mov_b32 v120, 0xff7f0000
    v_mov_b32 v121, 0
    v_mov_b32 v18, 1
    v_mov_b32 v116, 0
    v_mov_b32 v117, 0
    v_mov_b32 v118, 0
    v_mov_b32 v119, 0
    s_lshl_b32 s38, s32, 10
    s_add_u32 s96, s38, 65536
    s_lshl_b32 s38, s3, 8
    s_add_u32 s96, s38, s96
    v_mov_b32 v9, s96
    s_lshl_b32 s38, s32, 15
    s_add_u32 s96, s38, 1048576
    s_lshl_b32 s38, s3, 13
    s_add_u32 s96, s38, s96
    s_lshl_b32 s38, s33, 10
    s_add_u32 s96, s38, s96
    v_and_b32 v5, 3, v3
    v_lshlrev_b32 v78, 7, v2
    v_lshl_add_u32 v78, v5, 5, v78
    s_lshl_b32 s38, s32, 12
    s_add_u32 s91, s38, 262144
    s_lshl_b32 s38, s3, 9
    s_add_u32 s91, s38, s91
    v_lshlrev_b32 v4, 7, v2
    v_lshl_add_u32 v4, v3, 4, v4
    v_mov_b32 v5, 512
    v_cmp_gt_u32 vcc, 8, v3
    s_nop 1
    v_cndmask_b32 v79, v5, v4, vcc
    s_waitcnt vmcnt(7)
    buffer_load_dwordx4 a[228:231], v14, s[72:75], s63 offen nt
    s_add_u32 s63, s63, 8192
    s_waitcnt vmcnt(7)
    buffer_load_dwordx4 a[232:235], v14, s[72:75], s63 offen nt
    s_add_u32 s63, s63, 8192
    s_waitcnt vmcnt(7)
    buffer_load_dwordx4 a[236:239], v14, s[72:75], s63 offen nt
    s_add_u32 s63, s63, 8192
    s_waitcnt vmcnt(7)
    buffer_load_dwordx4 a[240:243], v14, s[72:75], s63 offen nt
    s_add_u32 s63, s63, 8192
    s_waitcnt vmcnt(7)
    buffer_load_dwordx4 a[244:247], v14, s[72:75], s63 offen nt
    s_add_u32 s63, s63, 8192
    s_waitcnt vmcnt(7)
    buffer_load_dwordx4 a[248:251], v14, s[72:75], s63 offen nt
    s_add_u32 s63, s63, 8192
    s_waitcnt vmcnt(7)
    buffer_load_dwordx4 a[252:255], v14, s[72:75], s63 offen nt
    s_add_u32 s63, s63, 8192
    s_waitcnt lgkmcnt(0)
    s_add_u32 s35, s35, 0x5b
    s_and_b32 s35, s35, 0xff
    v_mov_b32 v8, s35
    s_or_b32 s68, s35, 0x6b3ac500
    s_waitcnt vmcnt(6)
    s_add_u32 s39, s87, s88
    s_bfe_u32 s37, s39, 0x30000
    s_lshl_b32 s37, s37, 12
    s_add_u32 s85, s37, s89
    s_bfe_u32 s37, s39, 0x10003
    s_lshl_b32 s37, s37, 11
    s_add_u32 s85, s37, s85
    s_bfe_u32 s37, s39, 0x40004
    s_lshl_b32 s37, s37, 16
    s_add_u32 s85, s37, s85
    buffer_load_dwordx4 v[128:131], v76, s[52:55], s85 offen offset:0 nt
    s_waitcnt vmcnt(6)
    buffer_load_dwordx4 v[132:135], v77, s[52:55], s85 offen offset:0 nt
    s_waitcnt vmcnt(6)
    buffer_load_dwordx4 v[136:139], v76, s[52:55], s85 offen offset:1024 nt
    s_waitcnt vmcnt(6)
    buffer_load_dwordx4 v[140:143], v77, s[52:55], s85 offen offset:1024 nt
    s_add_u32 s87, s87, 7
    s_add_u32 s39, s87, s88
    s_bfe_u32 s37, s39, 0x30000
    s_lshl_b32 s37, s37, 12
    s_add_u32 s85, s37, s89
    s_bfe_u32 s37, s39, 0x10003
    s_lshl_b32 s37, s37, 11
    s_add_u32 s85, s37, s85
    s_bfe_u32 s37, s39, 0x40004
    s_lshl_b32 s37, s37, 16
    s_add_u32 s85, s37, s85
    s_waitcnt vmcnt(6)
    buffer_load_dwordx4 v[144:147], v76, s[52:55], s85 offen offset:0 nt
    s_waitcnt vmcnt(6)
    buffer_load_dwordx4 v[148:151], v77, s[52:55], s85 offen offset:0 nt
    s_waitcnt vmcnt(6)
    buffer_load_dwordx4 v[152:155], v76, s[52:55], s85 offen offset:1024 nt
    s_waitcnt vmcnt(6)
    buffer_load_dwordx4 v[156:159], v77, s[52:55], s85 offen offset:1024 nt
    s_add_u32 s87, s87, 7
    s_add_u32 s39, s87, s88
    s_bfe_u32 s37, s39, 0x30000
    s_lshl_b32 s37, s37, 12
    s_add_u32 s85, s37, s89
    s_bfe_u32 s37, s39, 0x10003
    s_lshl_b32 s37, s37, 11
    s_add_u32 s85, s37, s85
    s_bfe_u32 s37, s39, 0x40004
    s_lshl_b32 s37, s37, 16
    s_add_u32 s85, s37, s85
    s_waitcnt vmcnt(6)
    buffer_load_dwordx4 v[160:163], v76, s[52:55], s85 offen offset:0 nt
    s_waitcnt vmcnt(6)
    buffer_load_dwordx4 v[164:167], v77, s[52:55], s85 offen offset:0 nt
    s_waitcnt vmcnt(6)
    buffer_load_dwordx4 v[168:171], v76, s[52:55], s85 offen offset:1024 nt
    s_waitcnt vmcnt(6)
    buffer_load_dwordx4 v[172:175], v77, s[52:55], s85 offen offset:1024 nt
    s_add_u32 s87, s87, 7
    s_add_u32 s39, s87, s88
    s_bfe_u32 s37, s39, 0x30000
    s_lshl_b32 s37, s37, 12
    s_add_u32 s85, s37, s89
    s_bfe_u32 s37, s39, 0x10003
    s_lshl_b32 s37, s37, 11
    s_add_u32 s85, s37, s85
    s_bfe_u32 s37, s39, 0x40004
    s_lshl_b32 s37, s37, 16
    s_add_u32 s85, s37, s85
    s_waitcnt vmcnt(6)
    buffer_load_dwordx4 v[176:179], v76, s[52:55], s85 offen offset:0 nt
    s_waitcnt vmcnt(6)
    buffer_load_dwordx4 v[180:183], v77, s[52:55], s85 offen offset:0 nt
    s_waitcnt vmcnt(6)
    buffer_load_dwordx4 v[184:187], v76, s[52:55], s85 offen offset:1024 nt
    s_waitcnt vmcnt(6)
    buffer_load_dwordx4 v[188:191], v77, s[52:55], s85 offen offset:1024 nt
    s_add_u32 s87, s87, 7
    s_add_u32 s39, s87, s88
    s_bfe_u32 s37, s39, 0x30000
    s_lshl_b32 s37, s37, 12
    s_add_u32 s85, s37, s89
    s_bfe_u32 s37, s39, 0x10003
    s_lshl_b32 s37, s37, 11
    s_add_u32 s85, s37, s85
    s_bfe_u32 s37, s39, 0x40004
    s_lshl_b32 s37, s37, 16
    s_add_u32 s85, s37, s85
    s_waitcnt vmcnt(6)
    buffer_load_dwordx4 v[192:195], v76, s[52:55], s85 offen offset:0 nt
    s_waitcnt vmcnt(6)
    buffer_load_dwordx4 v[196:199], v77, s[52:55], s85 offen offset:0 nt
    s_waitcnt vmcnt(6)
    buffer_load_dwordx4 v[200:203], v76, s[52:55], s85 offen offset:1024 nt
    s_waitcnt vmcnt(6)
    buffer_load_dwordx4 v[204:207], v77, s[52:55], s85 offen offset:1024 nt
    s_add_u32 s87, s87, 7
    s_add_u32 s39, s87, s88
    s_bfe_u32 s37, s39, 0x30000
    s_lshl_b32 s37, s37, 12
    s_add_u32 s85, s37, s89
    s_bfe_u32 s37, s39, 0x10003
    s_lshl_b32 s37, s37, 11
    s_add_u32 s85, s37, s85
    s_bfe_u32 s37, s39, 0x40004
    s_lshl_b32 s37, s37, 16
    s_add_u32 s85, s37, s85
    s_waitcnt vmcnt(6)
    buffer_load_dwordx4 v[208:211], v76, s[52:55], s85 offen offset:0 nt
    s_waitcnt vmcnt(6)
    buffer_load_dwordx4 v[212:215], v77, s[52:55], s85 offen offset:0 nt
    s_waitcnt vmcnt(6)
    buffer_load_dwordx4 v[216:219], v76, s[52:55], s85 offen offset:1024 nt
    s_waitcnt vmcnt(6)
    buffer_load_dwordx4 v[220:223], v77, s[52:55], s85 offen offset:1024 nt
    s_add_u32 s87, s87, 7
    s_add_u32 s39, s87, s88
    s_bfe_u32 s37, s39, 0x30000
    s_lshl_b32 s37, s37, 12
    s_add_u32 s85, s37, s89
    s_bfe_u32 s37, s39, 0x10003
    s_lshl_b32 s37, s37, 11
    s_add_u32 s85, s37, s85
    s_bfe_u32 s37, s39, 0x40004
    s_lshl_b32 s37, s37, 16
    s_add_u32 s85, s37, s85
    buffer_load_dwordx4 v[20:23], v15, s[48:51], s95 offen offset:0 sc1
    buffer_load_dwordx4 v[24:27], v15, s[48:51], s95 offen offset:16 sc1
    s_waitcnt vmcnt(8)
    buffer_load_dwordx4 v[224:227], v76, s[52:55], s85 offen offset:0 nt
    s_waitcnt vmcnt(8)
    buffer_load_dwordx4 v[228:231], v77, s[52:55], s85 offen offset:0 nt
    s_waitcnt vmcnt(8)
    buffer_load_dwordx4 v[232:235], v76, s[52:55], s85 offen offset:1024 nt
    s_waitcnt vmcnt(8)
    buffer_load_dwordx4 v[236:239], v77, s[52:55], s85 offen offset:1024 nt
    s_add_u32 s87, s87, 7
    s_add_u32 s39, s87, s88
    s_bfe_u32 s37, s39, 0x30000
    s_lshl_b32 s37, s37, 12
    s_add_u32 s85, s37, s89
    s_bfe_u32 s37, s39, 0x10003
    s_lshl_b32 s37, s37, 11
    s_add_u32 s85, s37, s85
    s_bfe_u32 s37, s39, 0x40004
    s_lshl_b32 s37, s37, 16
    s_add_u32 s85, s37, s85
    s_waitcnt vmcnt(8)
    buffer_load_dwordx4 v[240:243], v76, s[52:55], s85 offen offset:0 nt
    s_waitcnt vmcnt(8)
    buffer_load_dwordx4 v[244:247], v77, s[52:55], s85 offen offset:0 nt
    s_waitcnt vmcnt(6)
L_qacheck_19:
    v_xor_b32 v20, s35, v20
    v_xor_b32 v21, s35, v21
    v_xor_b32 v22, s35, v22
    v_xor_b32 v23, s35, v23
    v_xor_b32 v24, s35, v24
    v_xor_b32 v25, s35, v25
    v_xor_b32 v26, s35, v26
    v_xor_b32 v27, s35, v27
    v_or_b32 v4, v20, v21
    v_or3_b32 v4, v4, v22, v23
    v_or3_b32 v4, v4, v24, v25
    v_or3_b32 v4, v4, v26, v27
    v_and_b32 v4, 0xff, v4
    v_cmp_ne_u32 vcc, 0, v4
    s_cbranch_vccz L_qaok_20
    buffer_load_dwordx4 v[20:23], v15, s[48:51], s95 offen offset:0 sc1
    buffer_load_dwordx4 v[24:27], v15, s[48:51], s95 offen offset:16 sc1
    s_waitcnt vmcnt(0)
    s_sub_u32 s84, s84, 1
    s_cmp_lg_u32 s84, 0
    s_cbranch_scc1 L_qacheck_19
    s_branch L_end
L_qaok_20:
    buffer_load_dwordx4 v[68:71], v78, s[48:51], s91 offen offset:0 sc1
    buffer_load_dwordx4 v[72:75], v78, s[48:51], s91 offen offset:16 sc1
    v_cvt_pk_bf16_f32 v20, v20, v21
    v_cvt_pk_bf16_f32 v21, v22, v23
    v_cvt_pk_bf16_f32 v22, v24, v25
    v_cvt_pk_bf16_f32 v23, v26, v27
    s_nop 1
    v_mfma_f32_16x16x32_bf16 v[28:31], a[128:131], v[20:23], 0
    v_mfma_f32_16x16x32_bf16 v[32:35], a[132:135], v[20:23], 0
    v_mfma_f32_16x16x32_bf16 v[36:39], a[136:139], v[20:23], 0
    s_nop 5
    v_mov_b32_dpp v60, v28 quad_perm:[0,0,0,0] row_mask:0xf bank_mask:0xf
    v_mov_b32_dpp v4, v30 quad_perm:[2,2,2,2] row_mask:0xf bank_mask:0xf
    s_nop 0
    v_add_f32_dpp v60, v29, v60 quad_perm:[1,1,1,1] row_mask:0xf bank_mask:0xf
    v_add_f32_dpp v4, v31, v4 quad_perm:[3,3,3,3] row_mask:0xf bank_mask:0xf
    v_add_f32 v60, v60, v4
    v_mfma_f32_16x16x32_bf16 v[40:43], a[140:143], v[20:23], 0
    v_mov_b32_dpp v61, v32 quad_perm:[0,0,0,0] row_mask:0xf bank_mask:0xf
    v_mov_b32_dpp v4, v34 quad_perm:[2,2,2,2] row_mask:0xf bank_mask:0xf
    s_nop 0
    v_add_f32_dpp v61, v33, v61 quad_perm:[1,1,1,1] row_mask:0xf bank_mask:0xf
    v_add_f32_dpp v4, v35, v4 quad_perm:[3,3,3,3] row_mask:0xf bank_mask:0xf
    v_add_f32 v61, v61, v4
    v_cvt_pk_bf16_f32 v44, v60, v61
    v_mfma_f32_16x16x32_bf16 v[28:31], a[144:147], v[20:23], 0
    v_mov_b32_dpp v60, v36 quad_perm:[0,0,0,0] row_mask:0xf bank_mask:0xf
    v_mov_b32_dpp v4, v38 quad_perm:[2,2,2,2] row_mask:0xf bank_mask:0xf
    s_nop 0
    v_add_f32_dpp v60, v37, v60 quad_perm:[1,1,1,1] row_mask:0xf bank_mask:0xf
    v_add_f32_dpp v4, v39, v4 quad_perm:[3,3,3,3] row_mask:0xf bank_mask:0xf
    v_add_f32 v60, v60, v4
    buffer_load_dwordx4 v[248:251], v76, s[52:55], s85 offen offset:1024 nt
    v_mfma_f32_16x16x32_bf16 v[32:35], a[148:151], v[20:23], 0
    v_mov_b32_dpp v61, v40 quad_perm:[0,0,0,0] row_mask:0xf bank_mask:0xf
    v_mov_b32_dpp v4, v42 quad_perm:[2,2,2,2] row_mask:0xf bank_mask:0xf
    s_nop 0
    v_add_f32_dpp v61, v41, v61 quad_perm:[1,1,1,1] row_mask:0xf bank_mask:0xf
    v_add_f32_dpp v4, v43, v4 quad_perm:[3,3,3,3] row_mask:0xf bank_mask:0xf
    v_add_f32 v61, v61, v4
    v_cvt_pk_bf16_f32 v45, v60, v61
    v_mfma_f32_16x16x32_bf16 v[36:39], a[152:155], v[20:23], 0
    v_mov_b32_dpp v60, v28 quad_perm:[0,0,0,0] row_mask:0xf bank_mask:0xf
    v_mov_b32_dpp v4, v30 quad_perm:[2,2,2,2] row_mask:0xf bank_mask:0xf
    s_nop 0
    v_add_f32_dpp v60, v29, v60 quad_perm:[1,1,1,1] row_mask:0xf bank_mask:0xf
    v_add_f32_dpp v4, v31, v4 quad_perm:[3,3,3,3] row_mask:0xf bank_mask:0xf
    v_add_f32 v60, v60, v4
    v_mfma_f32_16x16x32_bf16 v[40:43], a[156:159], v[20:23], 0
    v_mov_b32_dpp v61, v32 quad_perm:[0,0,0,0] row_mask:0xf bank_mask:0xf
    v_mov_b32_dpp v4, v34 quad_perm:[2,2,2,2] row_mask:0xf bank_mask:0xf
    s_nop 0
    v_add_f32_dpp v61, v33, v61 quad_perm:[1,1,1,1] row_mask:0xf bank_mask:0xf
    v_add_f32_dpp v4, v35, v4 quad_perm:[3,3,3,3] row_mask:0xf bank_mask:0xf
    v_add_f32 v61, v61, v4
    v_cvt_pk_bf16_f32 v46, v60, v61
    v_mfma_f32_16x16x32_bf16 v[28:31], a[160:163], v[20:23], 0
    v_mov_b32_dpp v60, v36 quad_perm:[0,0,0,0] row_mask:0xf bank_mask:0xf
    v_mov_b32_dpp v4, v38 quad_perm:[2,2,2,2] row_mask:0xf bank_mask:0xf
    s_nop 0
    v_add_f32_dpp v60, v37, v60 quad_perm:[1,1,1,1] row_mask:0xf bank_mask:0xf
    v_add_f32_dpp v4, v39, v4 quad_perm:[3,3,3,3] row_mask:0xf bank_mask:0xf
    v_add_f32 v60, v60, v4
    v_mfma_f32_16x16x32_bf16 v[32:35], a[164:167], v[20:23], 0
    v_mov_b32_dpp v61, v40 quad_perm:[0,0,0,0] row_mask:0xf bank_mask:0xf
    v_mov_b32_dpp v4, v42 quad_perm:[2,2,2,2] row_mask:0xf bank_mask:0xf
    s_nop 0
    v_add_f32_dpp v61, v41, v61 quad_perm:[1,1,1,1] row_mask:0xf bank_mask:0xf
    v_add_f32_dpp v4, v43, v4 quad_perm:[3,3,3,3] row_mask:0xf bank_mask:0xf
    v_add_f32 v61, v61, v4
    v_cvt_pk_bf16_f32 v47, v60, v61
    v_mfma_f32_16x16x32_bf16 v[36:39], a[168:171], v[20:23], 0
    v_mov_b32_dpp v60, v28 quad_perm:[0,0,0,0] row_mask:0xf bank_mask:0xf
    v_mov_b32_dpp v4, v30 quad_perm:[2,2,2,2] row_mask:0xf bank_mask:0xf
    s_nop 0
    v_add_f32_dpp v60, v29, v60 quad_perm:[1,1,1,1] row_mask:0xf bank_mask:0xf
    v_add_f32_dpp v4, v31, v4 quad_perm:[3,3,3,3] row_mask:0xf bank_mask:0xf
    v_add_f32 v60, v60, v4
    v_mfma_f32_16x16x32_bf16 v[40:43], a[172:175], v[20:23], 0
    v_mov_b32_dpp v61, v32 quad_perm:[0,0,0,0] row_mask:0xf bank_mask:0xf
    v_mov_b32_dpp v4, v34 quad_perm:[2,2,2,2] row_mask:0xf bank_mask:0xf
    s_nop 0
    v_add_f32_dpp v61, v33, v61 quad_perm:[1,1,1,1] row_mask:0xf bank_mask:0xf
    v_add_f32_dpp v4, v35, v4 quad_perm:[3,3,3,3] row_mask:0xf bank_mask:0xf
    v_add_f32 v61, v61, v4
    v_cvt_pk_bf16_f32 v48, v60, v61
    v_mfma_f32_16x16x32_bf16 v[28:31], a[176:179], v[20:23], 0
    v_mov_b32_dpp v60, v36 quad_perm:[0,0,0,0] row_mask:0xf bank_mask:0xf
    v_mov_b32_dpp v4, v38 quad_perm:[2,2,2,2] row_mask:0xf bank_mask:0xf
    s_nop 0
    v_add_f32_dpp v60, v37, v60 quad_perm:[1,1,1,1] row_mask:0xf bank_mask:0xf
    v_add_f32_dpp v4, v39, v4 quad_perm:[3,3,3,3] row_mask:0xf bank_mask:0xf
    v_add_f32 v60, v60, v4
    buffer_load_dwordx4 v[252:255], v77, s[52:55], s85 offen offset:1024 nt
    s_add_u32 s87, s87, 7
    s_add_u32 s39, s87, s88
    s_bfe_u32 s37, s39, 0x30000
    s_lshl_b32 s37, s37, 12
    s_add_u32 s85, s37, s89
    s_bfe_u32 s37, s39, 0x10003
    s_lshl_b32 s37, s37, 11
    s_add_u32 s85, s37, s85
    s_bfe_u32 s37, s39, 0x40004
    s_lshl_b32 s37, s37, 16
    s_add_u32 s85, s37, s85
    v_mfma_f32_16x16x32_bf16 v[32:35], a[180:183], v[20:23], 0
    v_mov_b32_dpp v61, v40 quad_perm:[0,0,0,0] row_mask:0xf bank_mask:0xf
    v_mov_b32_dpp v4, v42 quad_perm:[2,2,2,2] row_mask:0xf bank_mask:0xf
    s_nop 0
    v_add_f32_dpp v61, v41, v61 quad_perm:[1,1,1,1] row_mask:0xf bank_mask:0xf
    v_add_f32_dpp v4, v43, v4 quad_perm:[3,3,3,3] row_mask:0xf bank_mask:0xf
    v_add_f32 v61, v61, v4
    v_cvt_pk_bf16_f32 v49, v60, v61
    v_mfma_f32_16x16x32_bf16 v[36:39], a[184:187], v[20:23], 0
    v_mov_b32_dpp v60, v28 quad_perm:[0,0,0,0] row_mask:0xf bank_mask:0xf
    v_mov_b32_dpp v4, v30 quad_perm:[2,2,2,2] row_mask:0xf bank_mask:0xf
    s_nop 0
    v_add_f32_dpp v60, v29, v60 quad_perm:[1,1,1,1] row_mask:0xf bank_mask:0xf
    v_add_f32_dpp v4, v31, v4 quad_perm:[3,3,3,3] row_mask:0xf bank_mask:0xf
    v_add_f32 v60, v60, v4
    v_mfma_f32_16x16x32_bf16 v[40:43], a[188:191], v[20:23], 0
    v_mov_b32_dpp v61, v32 quad_perm:[0,0,0,0] row_mask:0xf bank_mask:0xf
    v_mov_b32_dpp v4, v34 quad_perm:[2,2,2,2] row_mask:0xf bank_mask:0xf
    s_nop 0
    v_add_f32_dpp v61, v33, v61 quad_perm:[1,1,1,1] row_mask:0xf bank_mask:0xf
    v_add_f32_dpp v4, v35, v4 quad_perm:[3,3,3,3] row_mask:0xf bank_mask:0xf
    v_add_f32 v61, v61, v4
    v_cvt_pk_bf16_f32 v50, v60, v61
    v_mfma_f32_16x16x32_bf16 v[28:31], a[192:195], v[20:23], 0
    v_mov_b32_dpp v60, v36 quad_perm:[0,0,0,0] row_mask:0xf bank_mask:0xf
    v_mov_b32_dpp v4, v38 quad_perm:[2,2,2,2] row_mask:0xf bank_mask:0xf
    s_nop 0
    v_add_f32_dpp v60, v37, v60 quad_perm:[1,1,1,1] row_mask:0xf bank_mask:0xf
    v_add_f32_dpp v4, v39, v4 quad_perm:[3,3,3,3] row_mask:0xf bank_mask:0xf
    v_add_f32 v60, v60, v4
    v_mfma_f32_16x16x32_bf16 v[32:35], a[196:199], v[20:23], 0
    v_mov_b32_dpp v61, v40 quad_perm:[0,0,0,0] row_mask:0xf bank_mask:0xf
    v_mov_b32_dpp v4, v42 quad_perm:[2,2,2,2] row_mask:0xf bank_mask:0xf
    s_nop 0
    v_add_f32_dpp v61, v41, v61 quad_perm:[1,1,1,1] row_mask:0xf bank_mask:0xf
    v_add_f32_dpp v4, v43, v4 quad_perm:[3,3,3,3] row_mask:0xf bank_mask:0xf
    v_add_f32 v61, v61, v4
    v_cvt_pk_bf16_f32 v51, v60, v61
    v_mfma_f32_16x16x32_bf16 v[36:39], a[200:203], v[20:23], 0
    v_mov_b32_dpp v60, v28 quad_perm:[0,0,0,0] row_mask:0xf bank_mask:0xf
    v_mov_b32_dpp v4, v30 quad_perm:[2,2,2,2] row_mask:0xf bank_mask:0xf
    s_nop 0
    v_add_f32_dpp v60, v29, v60 quad_perm:[1,1,1,1] row_mask:0xf bank_mask:0xf
    v_add_f32_dpp v4, v31, v4 quad_perm:[3,3,3,3] row_mask:0xf bank_mask:0xf
    v_add_f32 v60, v60, v4
    v_mfma_f32_16x16x32_bf16 v[40:43], a[204:207], v[20:23], 0
    v_mov_b32_dpp v61, v32 quad_perm:[0,0,0,0] row_mask:0xf bank_mask:0xf
    v_mov_b32_dpp v4, v34 quad_perm:[2,2,2,2] row_mask:0xf bank_mask:0xf
    s_nop 0
    v_add_f32_dpp v61, v33, v61 quad_perm:[1,1,1,1] row_mask:0xf bank_mask:0xf
    v_add_f32_dpp v4, v35, v4 quad_perm:[3,3,3,3] row_mask:0xf bank_mask:0xf
    v_add_f32 v61, v61, v4
    v_cvt_pk_bf16_f32 v52, v60, v61
    v_mfma_f32_16x16x32_bf16 v[28:31], a[208:211], v[20:23], 0
    v_mov_b32_dpp v60, v36 quad_perm:[0,0,0,0] row_mask:0xf bank_mask:0xf
    v_mov_b32_dpp v4, v38 quad_perm:[2,2,2,2] row_mask:0xf bank_mask:0xf
    s_nop 0
    v_add_f32_dpp v60, v37, v60 quad_perm:[1,1,1,1] row_mask:0xf bank_mask:0xf
    v_add_f32_dpp v4, v39, v4 quad_perm:[3,3,3,3] row_mask:0xf bank_mask:0xf
    v_add_f32 v60, v60, v4
    buffer_load_dwordx4 a[0:3], v76, s[52:55], s85 offen offset:0 nt
    v_mfma_f32_16x16x32_bf16 v[32:35], a[212:215], v[20:23], 0
    v_mov_b32_dpp v61, v40 quad_perm:[0,0,0,0] row_mask:0xf bank_mask:0xf
    v_mov_b32_dpp v4, v42 quad_perm:[2,2,2,2] row_mask:0xf bank_mask:0xf
    s_nop 0
    v_add_f32_dpp v61, v41, v61 quad_perm:[1,1,1,1] row_mask:0xf bank_mask:0xf
    v_add_f32_dpp v4, v43, v4 quad_perm:[3,3,3,3] row_mask:0xf bank_mask:0xf
    v_add_f32 v61, v61, v4
    v_cvt_pk_bf16_f32 v53, v60, v61
    v_mfma_f32_16x16x32_bf16 v[36:39], a[216:219], v[20:23], 0
    v_mov_b32_dpp v60, v28 quad_perm:[0,0,0,0] row_mask:0xf bank_mask:0xf
    v_mov_b32_dpp v4, v30 quad_perm:[2,2,2,2] row_mask:0xf bank_mask:0xf
    s_nop 0
    v_add_f32_dpp v60, v29, v60 quad_perm:[1,1,1,1] row_mask:0xf bank_mask:0xf
    v_add_f32_dpp v4, v31, v4 quad_perm:[3,3,3,3] row_mask:0xf bank_mask:0xf
    v_add_f32 v60, v60, v4
    v_mfma_f32_16x16x32_bf16 v[40:43], a[220:223], v[20:23], 0
    v_mov_b32_dpp v61, v32 quad_perm:[0,0,0,0] row_mask:0xf bank_mask:0xf
    v_mov_b32_dpp v4, v34 quad_perm:[2,2,2,2] row_mask:0xf bank_mask:0xf
    s_nop 0
    v_add_f32_dpp v61, v33, v61 quad_perm:[1,1,1,1] row_mask:0xf bank_mask:0xf
    v_add_f32_dpp v4, v35, v4 quad_perm:[3,3,3,3] row_mask:0xf bank_mask:0xf
    v_add_f32 v61, v61, v4
    v_cvt_pk_bf16_f32 v54, v60, v61
    v_mfma_f32_16x16x32_bf16 v[28:31], a[224:227], v[20:23], 0
    v_mov_b32_dpp v60, v36 quad_perm:[0,0,0,0] row_mask:0xf bank_mask:0xf
    v_mov_b32_dpp v4, v38 quad_perm:[2,2,2,2] row_mask:0xf bank_mask:0xf
    s_nop 0
    v_add_f32_dpp v60, v37, v60 quad_perm:[1,1,1,1] row_mask:0xf bank_mask:0xf
    v_add_f32_dpp v4, v39, v4 quad_perm:[3,3,3,3] row_mask:0xf bank_mask:0xf
    v_add_f32 v60, v60, v4
    v_mfma_f32_16x16x32_bf16 v[32:35], a[228:231], v[20:23], 0
    v_mov_b32_dpp v61, v40 quad_perm:[0,0,0,0] row_mask:0xf bank_mask:0xf
    v_mov_b32_dpp v4, v42 quad_perm:[2,2,2,2] row_mask:0xf bank_mask:0xf
    s_nop 0
    v_add_f32_dpp v61, v41, v61 quad_perm:[1,1,1,1] row_mask:0xf bank_mask:0xf
    v_add_f32_dpp v4, v43, v4 quad_perm:[3,3,3,3] row_mask:0xf bank_mask:0xf
    v_add_f32 v61, v61, v4
    v_cvt_pk_bf16_f32 v55, v60, v61
    v_mfma_f32_16x16x32_bf16 v[36:39], a[232:235], v[20:23], 0
    v_mov_b32_dpp v60, v28 quad_perm:[0,0,0,0] row_mask:0xf bank_mask:0xf
    v_mov_b32_dpp v4, v30 quad_perm:[2,2,2,2] row_mask:0xf bank_mask:0xf
    s_nop 0
    v_add_f32_dpp v60, v29, v60 quad_perm:[1,1,1,1] row_mask:0xf bank_mask:0xf
    v_add_f32_dpp v4, v31, v4 quad_perm:[3,3,3,3] row_mask:0xf bank_mask:0xf
    v_add_f32 v60, v60, v4
    v_mfma_f32_16x16x32_bf16 v[40:43], a[236:239], v[20:23], 0
    v_mov_b32_dpp v61, v32 quad_perm:[0,0,0,0] row_mask:0xf bank_mask:0xf
    v_mov_b32_dpp v4, v34 quad_perm:[2,2,2,2] row_mask:0xf bank_mask:0xf
    s_nop 0
    v_add_f32_dpp v61, v33, v61 quad_perm:[1,1,1,1] row_mask:0xf bank_mask:0xf
    v_add_f32_dpp v4, v35, v4 quad_perm:[3,3,3,3] row_mask:0xf bank_mask:0xf
    v_add_f32 v61, v61, v4
    v_cvt_pk_bf16_f32 v56, v60, v61
    v_mfma_f32_16x16x32_bf16 v[28:31], a[240:243], v[20:23], 0
    v_mov_b32_dpp v60, v36 quad_perm:[0,0,0,0] row_mask:0xf bank_mask:0xf
    v_mov_b32_dpp v4, v38 quad_perm:[2,2,2,2] row_mask:0xf bank_mask:0xf
    s_nop 0
    v_add_f32_dpp v60, v37, v60 quad_perm:[1,1,1,1] row_mask:0xf bank_mask:0xf
    v_add_f32_dpp v4, v39, v4 quad_perm:[3,3,3,3] row_mask:0xf bank_mask:0xf
    v_add_f32 v60, v60, v4
    buffer_load_dwordx4 a[4:7], v77, s[52:55], s85 offen offset:0 nt
    v_mfma_f32_16x16x32_bf16 v[32:35], a[244:247], v[20:23], 0
    v_mov_b32_dpp v61, v40 quad_perm:[0,0,0,0] row_mask:0xf bank_mask:0xf
    v_mov_b32_dpp v4, v42 quad_perm:[2,2,2,2] row_mask:0xf bank_mask:0xf
    s_nop 0
    v_add_f32_dpp v61, v41, v61 quad_perm:[1,1,1,1] row_mask:0xf bank_mask:0xf
    v_add_f32_dpp v4, v43, v4 quad_perm:[3,3,3,3] row_mask:0xf bank_mask:0xf
    v_add_f32 v61, v61, v4
    v_cvt_pk_bf16_f32 v57, v60, v61
    v_mfma_f32_16x16x32_bf16 v[36:39], a[248:251], v[20:23], 0
    v_mov_b32_dpp v60, v28 quad_perm:[0,0,0,0] row_mask:0xf bank_mask:0xf
    v_mov_b32_dpp v4, v30 quad_perm:[2,2,2,2] row_mask:0xf bank_mask:0xf
    s_nop 0
    v_add_f32_dpp v60, v29, v60 quad_perm:[1,1,1,1] row_mask:0xf bank_mask:0xf
    v_add_f32_dpp v4, v31, v4 quad_perm:[3,3,3,3] row_mask:0xf bank_mask:0xf
    v_add_f32 v60, v60, v4
    v_mfma_f32_16x16x32_bf16 v[40:43], a[252:255], v[20:23], 0
    v_mov_b32_dpp v61, v32 quad_perm:[0,0,0,0] row_mask:0xf bank_mask:0xf
    v_mov_b32_dpp v4, v34 quad_perm:[2,2,2,2] row_mask:0xf bank_mask:0xf
    s_nop 0
    v_add_f32_dpp v61, v33, v61 quad_perm:[1,1,1,1] row_mask:0xf bank_mask:0xf
    v_add_f32_dpp v4, v35, v4 quad_perm:[3,3,3,3] row_mask:0xf bank_mask:0xf
    v_add_f32 v61, v61, v4
    v_cvt_pk_bf16_f32 v58, v60, v61
    v_mov_b32_dpp v60, v36 quad_perm:[0,0,0,0] row_mask:0xf bank_mask:0xf
    v_mov_b32_dpp v4, v38 quad_perm:[2,2,2,2] row_mask:0xf bank_mask:0xf
    s_nop 0
    v_add_f32_dpp v60, v37, v60 quad_perm:[1,1,1,1] row_mask:0xf bank_mask:0xf
    v_add_f32_dpp v4, v39, v4 quad_perm:[3,3,3,3] row_mask:0xf bank_mask:0xf
    v_add_f32 v60, v60, v4
    v_mov_b32_dpp v61, v40 quad_perm:[0,0,0,0] row_mask:0xf bank_mask:0xf
    v_mov_b32_dpp v4, v42 quad_perm:[2,2,2,2] row_mask:0xf bank_mask:0xf
    s_nop 0
    v_add_f32_dpp v61, v41, v61 quad_perm:[1,1,1,1] row_mask:0xf bank_mask:0xf
    v_add_f32_dpp v4, v43, v4 quad_perm:[3,3,3,3] row_mask:0xf bank_mask:0xf
    v_add_f32 v61, v61, v4
    v_cvt_pk_bf16_f32 v59, v60, v61
    s_mov_b32 exec_lo, 0x22222222
    s_mov_b32 exec_hi, 0x22222222
    v_mov_b32 v44, v48
    v_mov_b32 v45, v49
    v_mov_b32 v46, v50
    v_mov_b32 v47, v51
    s_mov_b32 exec_lo, 0x44444444
    s_mov_b32 exec_hi, 0x44444444
    v_mov_b32 v44, v52
    v_mov_b32 v45, v53
    v_mov_b32 v46, v54
    v_mov_b32 v47, v55
    s_mov_b32 exec_lo, 0x88888888
    s_mov_b32 exec_hi, 0x88888888
    v_mov_b32 v44, v56
    v_mov_b32 v45, v57
    v_mov_b32 v46, v58
    v_mov_b32 v47, v59
    s_mov_b64 exec, -1
    buffer_store_dwordx4 v[44:47], v19, s[48:51], s94 offen sc1
    s_waitcnt vmcnt(5)
L_qcheck_21:
    v_xor_b32 v68, s35, v68
    v_xor_b32 v69, s35, v69
    v_xor_b32 v70, s35, v70
    v_xor_b32 v71, s35, v71
    v_xor_b32 v72, s35, v72
    v_xor_b32 v73, s35, v73
    v_xor_b32 v74, s35, v74
    v_xor_b32 v75, s35, v75
    v_or_b32 v4, v68, v69
    v_or3_b32 v4, v4, v70, v71
    v_or3_b32 v4, v4, v72, v73
    v_or3_b32 v4, v4, v74, v75
    v_and_b32 v4, 0xff, v4
    v_cmp_ne_u32 vcc, 0, v4
    s_cbranch_vccz L_qok_22
    buffer_load_dwordx4 v[68:71], v78, s[48:51], s91 offen offset:0 sc1
    buffer_load_dwordx4 v[72:75], v78, s[48:51], s91 offen offset:16 sc1
    s_waitcnt vmcnt(0)
    s_sub_u32 s84, s84, 1
    s_cmp_lg_u32 s84, 0
    s_cbranch_scc1 L_qcheck_21
    s_branch L_end
L_qok_22:
    v_cvt_pk_bf16_f32 v68, v68, v69
    v_cvt_pk_bf16_f32 v69, v70, v71
    v_cvt_pk_bf16_f32 v70, v72, v73
    v_cvt_pk_bf16_f32 v71, v74, v75
    s_mov_b32 vcc_lo, 0xf000f
    s_mov_b32 vcc_hi, 0xf000f
    v_cndmask_b32 v80, 0, v68, vcc
    v_cndmask_b32 v81, 0, v69, vcc
    v_cndmask_b32 v82, 0, v70, vcc
    v_cndmask_b32 v83, 0, v71, vcc
    s_mov_b32 vcc_lo, 0xf000f0
    s_mov_b32 vcc_hi, 0xf000f0
    v_cndmask_b32 v84, 0, v68, vcc
    v_cndmask_b32 v85, 0, v69, vcc
    v_cndmask_b32 v86, 0, v70, vcc
    v_cndmask_b32 v87, 0, v71, vcc
    s_mov_b32 vcc_lo, 0xf000f00
    s_mov_b32 vcc_hi, 0xf000f00
    v_cndmask_b32 v88, 0, v68, vcc
    v_cndmask_b32 v89, 0, v69, vcc
    v_cndmask_b32 v90, 0, v70, vcc
    v_cndmask_b32 v91, 0, v71, vcc
    s_mov_b32 vcc_lo, 0xf000f000
    s_mov_b32 vcc_hi, 0xf000f000
    v_cndmask_b32 v92, 0, v68, vcc
    v_cndmask_b32 v93, 0, v69, vcc
    v_cndmask_b32 v94, 0, v70, vcc
    v_cndmask_b32 v95, 0, v71, vcc
    v_mov_b32 v65, 0xff7f0000
    s_lshl_b32 s38, s34, 14
    s_add_u32 s38, s38, 16384
    v_lshl_add_u32 v64, v1, 2, s38
    buffer_load_dwordx4 a[8:11], v76, s[52:55], s85 offen offset:1024 nt
    v_mfma_f32_16x16x32_bf16 v[112:115], v[128:131], v[80:83], 0
    v_mfma_f32_16x16x32_bf16 v[112:115], v[132:135], v[84:87], v[112:115]
    buffer_load_dwordx4 a[12:15], v77, s[52:55], s85 offen offset:1024 nt
    s_add_u32 s87, s87, 7
    s_add_u32 s39, s87, s88
    s_bfe_u32 s37, s39, 0x30000
    s_lshl_b32 s37, s37, 12
    s_add_u32 s85, s37, s89
    s_bfe_u32 s37, s39, 0x10003
    s_lshl_b32 s37, s37, 11
    s_add_u32 s85, s37, s85
    s_bfe_u32 s37, s39, 0x40004
    s_lshl_b32 s37, s37, 16
    s_add_u32 s85, s37, s85
    v_mfma_f32_16x16x32_bf16 v[112:115], v[136:139], v[88:91], v[112:115]
    v_mfma_f32_16x16x32_bf16 v[112:115], v[140:143], v[92:95], v[112:115]
    buffer_load_dwordx4 a[16:19], v76, s[52:55], s85 offen offset:0 nt
    v_mfma_f32_16x16x32_bf16 v[96:99], v[144:147], v[80:83], 0
    v_mfma_f32_16x16x32_bf16 v[96:99], v[148:151], v[84:87], v[96:99]
    v_mfma_f32_16x16x32_bf16 v[96:99], v[152:155], v[88:91], v[96:99]
    s_nop 3
    v_mov_b32_dpp v122, v112 quad_perm:[0,0,0,0] row_mask:0xf bank_mask:0xf
    v_mov_b32_dpp v124, v114 quad_perm:[2,2,2,2] row_mask:0xf bank_mask:0xf
    s_nop 0
    v_add_f32_dpp v122, v113, v122 quad_perm:[1,1,1,1] row_mask:0xf bank_mask:0xf
    v_add_f32_dpp v124, v115, v124 quad_perm:[3,3,3,3] row_mask:0xf bank_mask:0xf
    v_add_f32 v122, v122, v124
    v_max_f32 v65, v65, v122
    ds_write_b32 v64, v122 offset:0
    s_waitcnt vmcnt(7)
    buffer_load_dwordx4 a[20:23], v77, s[52:55], s85 offen offset:0 nt
    v_mfma_f32_16x16x32_bf16 v[96:99], v[156:159], v[92:95], v[96:99]
    v_mfma_f32_16x16x32_bf16 v[112:115], v[160:163], v[80:83], 0
    s_waitcnt vmcnt(7)
    buffer_load_dwordx4 a[24:27], v76, s[52:55], s85 offen offset:1024 nt
    v_mfma_f32_16x16x32_bf16 v[112:115], v[164:167], v[84:87], v[112:115]
    v_mfma_f32_16x16x32_bf16 v[112:115], v[168:171], v[88:91], v[112:115]
    s_nop 2
    v_mov_b32_dpp v122, v96 quad_perm:[0,0,0,0] row_mask:0xf bank_mask:0xf
    v_mov_b32_dpp v124, v98 quad_perm:[2,2,2,2] row_mask:0xf bank_mask:0xf
    s_nop 0
    v_add_f32_dpp v122, v97, v122 quad_perm:[1,1,1,1] row_mask:0xf bank_mask:0xf
    v_add_f32_dpp v124, v99, v124 quad_perm:[3,3,3,3] row_mask:0xf bank_mask:0xf
    v_add_f32 v122, v122, v124
    v_max_f32 v65, v65, v122
    ds_write_b32 v64, v122 offset:256
    v_mfma_f32_16x16x32_bf16 v[112:115], v[172:175], v[92:95], v[112:115]
    s_waitcnt vmcnt(7)
    buffer_load_dwordx4 a[28:31], v77, s[52:55], s85 offen offset:1024 nt
    s_add_u32 s87, s87, 7
    s_add_u32 s39, s87, s88
    s_bfe_u32 s37, s39, 0x30000
    s_lshl_b32 s37, s37, 12
    s_add_u32 s85, s37, s89
    s_bfe_u32 s37, s39, 0x10003
    s_lshl_b32 s37, s37, 11
    s_add_u32 s85, s37, s85
    s_bfe_u32 s37, s39, 0x40004
    s_lshl_b32 s37, s37, 16
    s_add_u32 s85, s37, s85
    v_mfma_f32_16x16x32_bf16 v[96:99], v[176:179], v[80:83], 0
    v_mfma_f32_16x16x32_bf16 v[96:99], v[180:183], v[84:87], v[96:99]
    s_waitcnt vmcnt(7)
    buffer_load_dwordx4 a[32:35], v76, s[52:55], s85 offen offset:0 nt
    v_mfma_f32_16x16x32_bf16 v[96:99], v[184:187], v[88:91], v[96:99]
    v_mov_b32_dpp v122, v112 quad_perm:[0,0,0,0] row_mask:0xf bank_mask:0xf
    v_mov_b32_dpp v124, v114 quad_perm:[2,2,2,2] row_mask:0xf bank_mask:0xf
    s_nop 0
    v_add_f32_dpp v122, v113, v122 quad_perm:[1,1,1,1] row_mask:0xf bank_mask:0xf
    v_add_f32_dpp v124, v115, v124 quad_perm:[3,3,3,3] row_mask:0xf bank_mask:0xf
    v_add_f32 v122, v122, v124
    v_max_f32 v65, v65, v122
    ds_write_b32 v64, v122 offset:512
    v_mfma_f32_16x16x32_bf16 v[96:99], v[188:191], v[92:95], v[96:99]
    s_lshl_b32 s38, s32, 8
    s_add_u32 s69, s38, 98304
    s_cmp_eq_u32 s34, 0
    s_cselect_b32 s69, s69, 8388608
    v_mov_b32 v48, s69
    v_mov_b32 v49, s68
    s_waitcnt vmcnt(7)
    s_barrier
    s_mov_b64 exec, 1
    buffer_store_dword v49, v48, s[48:51], 0 offen sc1
    s_mov_b64 exec, -1
    s_waitcnt vmcnt(7)
    buffer_load_dwordx4 a[36:39], v77, s[52:55], s85 offen offset:0 nt
    v_mfma_f32_16x16x32_bf16 v[112:115], v[192:195], v[80:83], 0
    v_mfma_f32_16x16x32_bf16 v[112:115], v[196:199], v[84:87], v[112:115]
    v_mfma_f32_16x16x32_bf16 v[112:115], v[200:203], v[88:91], v[112:115]
    v_mov_b32_dpp v122, v96 quad_perm:[0,0,0,0] row_mask:0xf bank_mask:0xf
    v_mov_b32_dpp v124, v98 quad_perm:[2,2,2,2] row_mask:0xf bank_mask:0xf
    s_nop 0
    v_add_f32_dpp v122, v97, v122 quad_perm:[1,1,1,1] row_mask:0xf bank_mask:0xf
    v_add_f32_dpp v124, v99, v124 quad_perm:[3,3,3,3] row_mask:0xf bank_mask:0xf
    v_add_f32 v122, v122, v124
    v_max_f32 v65, v65, v122
    ds_write_b32 v64, v122 offset:768
    s_waitcnt vmcnt(7)
    buffer_load_dwordx4 a[40:43], v76, s[52:55], s85 offen offset:1024 nt
    v_mfma_f32_16x16x32_bf16 v[112:115], v[204:207], v[92:95], v[112:115]
    v_mfma_f32_16x16x32_bf16 v[96:99], v[208:211], v[80:83], 0
    s_waitcnt vmcnt(7)
    buffer_load_dwordx4 a[44:47], v77, s[52:55], s85 offen offset:1024 nt
    s_add_u32 s87, s87, 7
    s_add_u32 s39, s87, s88
    s_bfe_u32 s37, s39, 0x30000
    s_lshl_b32 s37, s37, 12
    s_add_u32 s85, s37, s89
    s_bfe_u32 s37, s39, 0x10003
    s_lshl_b32 s37, s37, 11
    s_add_u32 s85, s37, s85
    s_bfe_u32 s37, s39, 0x40004
    s_lshl_b32 s37, s37, 16
    s_add_u32 s85, s37, s85
    v_mfma_f32_16x16x32_bf16 v[96:99], v[212:215], v[84:87], v[96:99]
    v_mfma_f32_16x16x32_bf16 v[96:99], v[216:219], v[88:91], v[96:99]
    v_mov_b32_dpp v122, v112 quad_perm:[0,0,0,0] row_mask:0xf bank_mask:0xf
    v_mov_b32_dpp v124, v114 quad_perm:[2,2,2,2] row_mask:0xf bank_mask:0xf
    s_nop 0
    v_add_f32_dpp v122, v113, v122 quad_perm:[1,1,1,1] row_mask:0xf bank_mask:0xf
    v_add_f32_dpp v124, v115, v124 quad_perm:[3,3,3,3] row_mask:0xf bank_mask:0xf
    v_add_f32 v122, v122, v124
    v_max_f32 v65, v65, v122
    ds_write_b32 v64, v122 offset:1024
    v_mfma_f32_16x16x32_bf16 v[96:99], v[220:223], v[92:95], v[96:99]
    s_waitcnt vmcnt(7)
    buffer_load_dwordx4 a[48:51], v76, s[52:55], s85 offen offset:0 nt
    v_mfma_f32_16x16x32_bf16 v[112:115], v[224:227], v[80:83], 0
    s_sub_u32 s36, s33, 3
    s_and_b32 s37, s33, 3
    s_cmp_lt_u32 s36, 4
    s_cselect_b64 s[40:41], s[24:25], s[14:15]
    s_cselect_b32 s36, s36, s37
    s_cselect_b32 s45, 262144, 0
    s_cselect_b32 s46, 8388608, 0
    s_add_u32 s45, s45, 524288
    s_add_u32 s46, s46, 196608
    s_mov_b32 s42, 4194304
    s_mov_b32 s43, 0x20000
    s_lshl_b32 s38, s32, 17
    s_add_u32 s44, s38, 0
    s_lshl_b32 s38, s34, 15
    s_add_u32 s44, s38, s44
    s_lshl_b32 s38, s36, 8
    s_add_u32 s44, s38, s44
    s_lshl_b32 s38, s36, 16
    s_add_u32 s45, s38, s45
    s_lshr_b32 s38, s34, 1
    s_lshl_b32 s38, s38, 15
    s_add_u32 s45, s38, s45
    s_lshl_b32 s38, s32, 8
    s_add_u32 s45, s38, s45
    s_bfe_u32 s38, s34, 0x10000
    s_lshl_b32 s38, s38, 7
    s_add_u32 s45, s38, s45
    s_lshl_b32 s38, s32, 11
    s_add_u32 s46, s38, s46
    s_lshl_b32 s38, s34, 9
    s_add_u32 s46, s38, s46
    s_mov_b32 s72, s26
    s_and_b32 s73, s27, 0xffff
    s_mov_b32 s74, 8192
    s_mov_b32 s75, 0x20000
    v_mfma_f32_16x16x32_bf16 v[112:115], v[228:231], v[84:87], v[112:115]
    s_waitcnt vmcnt(7)
    buffer_load_dwordx4 a[52:55], v77, s[52:55], s85 offen offset:0 nt
    v_mfma_f32_16x16x32_bf16 v[112:115], v[232:235], v[88:91], v[112:115]
    v_mov_b32_dpp v122, v96 quad_perm:[0,0,0,0] row_mask:0xf bank_mask:0xf
    v_mov_b32_dpp v124, v98 quad_perm:[2,2,2,2] row_mask:0xf bank_mask:0xf
    s_nop 0
    v_add_f32_dpp v122, v97, v122 quad_perm:[1,1,1,1] row_mask:0xf bank_mask:0xf
    v_add_f32_dpp v124, v99, v124 quad_perm:[3,3,3,3] row_mask:0xf bank_mask:0xf
    v_add_f32 v122, v122, v124
    v_max_f32 v65, v65, v122
    ds_write_b32 v64, v122 offset:1280
    v_mfma_f32_16x16x32_bf16 v[112:115], v[236:239], v[92:95], v[112:115]
    s_waitcnt vmcnt(7)
    buffer_load_dwordx4 a[56:59], v76, s[52:55], s85 offen offset:1024 nt
    v_mfma_f32_16x16x32_bf16 v[96:99], v[240:243], v[80:83], 0
    v_mfma_f32_16x16x32_bf16 v[96:99], v[244:247], v[84:87], v[96:99]
    v_mfma_f32_16x16x32_bf16 v[96:99], v[248:251], v[88:91], v[96:99]
    s_nop 2
    v_mov_b32_dpp v122, v112 quad_perm:[0,0,0,0] row_mask:0xf bank_mask:0xf
    v_mov_b32_dpp v124, v114 quad_perm:[2,2,2,2] row_mask:0xf bank_mask:0xf
    s_nop 0
    v_add_f32_dpp v122, v113, v122 quad_perm:[1,1,1,1] row_mask:0xf bank_mask:0xf
    v_add_f32_dpp v124, v115, v124 quad_perm:[3,3,3,3] row_mask:0xf bank_mask:0xf
    v_add_f32 v122, v122, v124
    v_max_f32 v65, v65, v122
    ds_write_b32 v64, v122 offset:1536
    v_lshlrev_b32 v4, 2, v2
    v_xor_b32 v4, v4, v3
    v_xor_b32 v5, 0, v4
    v_lshlrev_b32 v5, 4, v5
    v_lshl_add_u32 v20, v2, 10, v5
    v_xor_b32 v5, 1, v4
    v_lshlrev_b32 v5, 4, v5
    v_lshl_add_u32 v21, v2, 10, v5
    v_add_u32 v21, 3072, v21
    v_xor_b32 v5, 2, v4
    v_lshlrev_b32 v5, 4, v5
    v_lshl_add_u32 v22, v2, 10, v5
    v_add_u32 v22, 6144, v22
    v_xor_b32 v5, 3, v4
    v_lshlrev_b32 v5, 4, v5
    v_lshl_add_u32 v23, v2, 10, v5
    v_add_u32 v23, 9216, v23
    s_lshl_b32 s38, s32, 15
    s_add_u32 s47, s38, 1048576
    s_lshl_b32 s38, s3, 13
    s_add_u32 s47, s38, s47
    s_mul_i32 s38, s3, 320
    s_add_u32 s38, s38, 135168
    v_lshlrev_b32 v4, 6, v2
    v_lshl_add_u32 v4, v3, 1, v4
    v_add_u32 v31, s38, v4
    s_waitcnt vmcnt(7)
    buffer_load_dwordx4 a[60:63], v77, s[52:55], s85 offen offset:1024 nt
    s_add_u32 s87, s87, 7
    s_add_u32 s39, s87, s88
    s_bfe_u32 s37, s39, 0x30000
    s_lshl_b32 s37, s37, 12
    s_add_u32 s85, s37, s89
    s_bfe_u32 s37, s39, 0x10003
    s_lshl_b32 s37, s37, 11
    s_add_u32 s85, s37, s85
    s_bfe_u32 s37, s39, 0x40004
    s_lshl_b32 s37, s37, 16
    s_add_u32 s85, s37, s85
    v_mfma_f32_16x16x32_bf16 v[96:99], v[252:255], v[92:95], v[96:99]
    v_mfma_f32_16x16x32_bf16 v[112:115], a[0:3], v[80:83], 0
    s_waitcnt vmcnt(5)
    buffer_load_dwordx4 v[128:131], v76, s[52:55], s85 offen offset:0 nt
    v_mfma_f32_16x16x32_bf16 v[112:115], a[4:7], v[84:87], v[112:115]
    v_mfma_f32_16x16x32_bf16 v[112:115], a[8:11], v[88:91], v[112:115]
    s_nop 2
    v_mov_b32_dpp v122, v96 quad_perm:[0,0,0,0] row_mask:0xf bank_mask:0xf
    v_mov_b32_dpp v124, v98 quad_perm:[2,2,2,2] row_mask:0xf bank_mask:0xf
    s_nop 0
    v_add_f32_dpp v122, v97, v122 quad_perm:[1,1,1,1] row_mask:0xf bank_mask:0xf
    v_add_f32_dpp v124, v99, v124 quad_perm:[3,3,3,3] row_mask:0xf bank_mask:0xf
    v_add_f32 v122, v122, v124
    v_max_f32 v65, v65, v122
    ds_write_b32 v64, v122 offset:1792
    v_mfma_f32_16x16x32_bf16 v[112:115], a[12:15], v[92:95], v[112:115]
    s_waitcnt vmcnt(5)
    buffer_load_dwordx4 v[132:135], v77, s[52:55], s85 offen offset:0 nt
    v_mfma_f32_16x16x32_bf16 v[96:99], a[16:19], v[80:83], 0
    v_lshlrev_b32 v4, 11, v2
    v_bfe_u32 v5, v1, 2, 2
    v_lshl_add_u32 v4, v5, 8, v4
    v_bfe_u32 v5, v1, 2, 2
    v_lshl_add_u32 v4, v5, 6, v4
    v_bfe_u32 v5, v1, 4, 1
    v_lshl_add_u32 v4, v5, 5, v4
    v_bfe_u32 v5, v1, 1, 1
    v_lshl_add_u32 v4, v5, 4, v4
    v_bfe_u32 v5, v1, 0, 1
    v_lshl_add_u32 v4, v5, 3, v4
    s_lshl_b32 s38, s34, 6
    s_add_u32 s38, s38, 98304
    v_xor_b32 v24, s38, v4
    v_xor_b32 v25, 16, v24
    v_xor_b32 v26, 32, v24
    v_xor_b32 v27, 48, v24
    v_and_b32 v4, 3, v3
    v_lshrrev_b32 v5, 2, v3
    v_lshlrev_b32 v6, 4, v2
    v_add_u32 v6, 135168, v6
    s_movk_i32 s36, 320
    v_cmp_eq_u32 vcc, 0, v5
    s_nop 1
    v_cndmask_b32 v28, 4, v4, vcc
    v_mad_u32_u24 v28, v28, s36, v6
    v_cmp_eq_u32 vcc, 1, v5
    s_nop 1
    v_cndmask_b32 v29, 4, v4, vcc
    v_mad_u32_u24 v29, v29, s36, v6
    v_lshlrev_b32 v5, 2, v1
    v_add_u32 v5, 136448, v5
    v_mov_b32 v6, 0
    ds_write_b32 v5, v6
    v_mfma_f32_16x16x32_bf16 v[96:99], a[20:23], v[84:87], v[96:99]
    s_waitcnt vmcnt(5)
    buffer_load_dwordx4 v[136:139], v76, s[52:55], s85 offen offset:1024 nt
    v_mfma_f32_16x16x32_bf16 v[96:99], a[24:27], v[88:91], v[96:99]
    v_mov_b32_dpp v122, v112 quad_perm:[0,0,0,0] row_mask:0xf bank_mask:0xf
    v_mov_b32_dpp v124, v114 quad_perm:[2,2,2,2] row_mask:0xf bank_mask:0xf
    s_nop 0
    v_add_f32_dpp v122, v113, v122 quad_perm:[1,1,1,1] row_mask:0xf bank_mask:0xf
    v_add_f32_dpp v124, v115, v124 quad_perm:[3,3,3,3] row_mask:0xf bank_mask:0xf
    v_add_f32 v122, v122, v124
    v_max_f32 v65, v65, v122
    ds_write_b32 v64, v122 offset:2048
    v_mfma_f32_16x16x32_bf16 v[96:99], a[28:31], v[92:95], v[96:99]
    s_waitcnt vmcnt(5)
    buffer_load_dwordx4 v[140:143], v77, s[52:55], s85 offen offset:1024 nt
    s_add_u32 s87, s87, 7
    s_add_u32 s39, s87, s88
    s_bfe_u32 s37, s39, 0x30000
    s_lshl_b32 s37, s37, 12
    s_add_u32 s85, s37, s89
    s_bfe_u32 s37, s39, 0x10003
    s_lshl_b32 s37, s37, 11
    s_add_u32 s85, s37, s85
    s_bfe_u32 s37, s39, 0x40004
    s_lshl_b32 s37, s37, 16
    s_add_u32 s85, s37, s85
    v_mfma_f32_16x16x32_bf16 v[112:115], a[32:35], v[80:83], 0
    v_mfma_f32_16x16x32_bf16 v[112:115], a[36:39], v[84:87], v[112:115]
    v_mfma_f32_16x16x32_bf16 v[112:115], a[40:43], v[88:91], v[112:115]
    v_mov_b32_dpp v122, v96 quad_perm:[0,0,0,0] row_mask:0xf bank_mask:0xf
    v_mov_b32_dpp v124, v98 quad_perm:[2,2,2,2] row_mask:0xf bank_mask:0xf
    s_nop 0
    v_add_f32_dpp v122, v97, v122 quad_perm:[1,1,1,1] row_mask:0xf bank_mask:0xf
    v_add_f32_dpp v124, v99, v124 quad_perm:[3,3,3,3] row_mask:0xf bank_mask:0xf
    v_add_f32 v122, v122, v124
    v_max_f32 v65, v65, v122
    ds_write_b32 v64, v122 offset:2304
    v_lshlrev_b32 v30, 4, v3
    v_lshl_add_u32 v30, v2, 13, v30
    s_lshl_b32 s38, s32, 13
    s_add_u32 s36, s38, 0
    s_lshl_b32 s38, s34, 6
    s_add_u32 s36, s38, s36
    v_lshrrev_b32 v5, 2, v1
    v_lshlrev_b32 v32, 8, v5
    v_bfe_u32 v5, v1, 0, 2
    v_lshl_add_u32 v32, v5, 4, v32
    v_add_u32 v32, s36, v32
    s_lshr_b32 s38, s32, 2
    s_lshl_b32 s38, s38, 7
    s_add_u32 s36, s38, 0
    s_lshl_b32 s38, s34, 5
    s_add_u32 s36, s38, s36
    s_bfe_u32 s38, s32, 0x20000
    s_lshl_b32 s38, s38, 3
    s_add_u32 s36, s38, s36
    v_bfe_u32 v5, v1, 0, 2
    v_lshlrev_b32 v33, 11, v5
    v_lshl_add_u32 v33, v2, 1, v33
    v_add_u32 v33, s36, v33
    v_and_b32 v5, 31, v1
    v_lshlrev_b32 v34, 4, v5
    s_mul_i32 s38, s34, 320
    s_add_u32 s38, s38, 135168
    v_lshl_add_u32 v35, v5, 3, s38
    s_waitcnt vmcnt(5)
    buffer_load_dwordx4 v[144:147], v76, s[52:55], s85 offen offset:0 nt
    v_mfma_f32_16x16x32_bf16 v[112:115], a[44:47], v[92:95], v[112:115]
    v_mfma_f32_16x16x32_bf16 v[96:99], a[48:51], v[80:83], 0
    s_waitcnt vmcnt(5)
    buffer_load_dwordx4 v[148:151], v77, s[52:55], s85 offen offset:0 nt
    v_mfma_f32_16x16x32_bf16 v[96:99], a[52:55], v[84:87], v[96:99]
    v_mfma_f32_16x16x32_bf16 v[96:99], a[56:59], v[88:91], v[96:99]
    s_nop 2
    v_mov_b32_dpp v122, v112 quad_perm:[0,0,0,0] row_mask:0xf bank_mask:0xf
    v_mov_b32_dpp v124, v114 quad_perm:[2,2,2,2] row_mask:0xf bank_mask:0xf
    s_nop 0
    v_add_f32_dpp v122, v113, v122 quad_perm:[1,1,1,1] row_mask:0xf bank_mask:0xf
    v_add_f32_dpp v124, v115, v124 quad_perm:[3,3,3,3] row_mask:0xf bank_mask:0xf
    v_add_f32 v122, v122, v124
    v_max_f32 v65, v65, v122
    ds_write_b32 v64, v122 offset:2560
    v_mfma_f32_16x16x32_bf16 v[96:99], a[60:63], v[92:95], v[96:99]
    v_add_u32 v64, 2816, v64
    s_mov_b32 s97, 10
    s_mov_b32 s86, 32
    s_and_b32 s36, s32, 3
    s_sub_u32 s80, s36, 2
    s_cmp_ge_u32 s36, 2
    s_cselect_b32 s80, s80, 8
    s_cselect_b32 s81, 27, 25
    s_cmp_eq_u32 s80, s33
    s_cselect_b32 s36, 2, 0
    s_sub_u32 s86, s86, s36
    s_lshr_b32 s36, s36, 1
    s_sub_u32 s97, s97, s36
    s_add_u32 s80, s80, 35
    s_sub_u32 s92, s81, 1
    s_mov_b32 s66, 134217728
    s_mov_b32 s67, 0x20000
    s_mov_b64 s[64:65], s[52:53]
    v_mov_b32 v62, v76
    v_mov_b32 v63, v77
    s_branch L_bloop
L_aux:
    v_lshlrev_b32 v4, 2, v2
    v_xor_b32 v4, v4, v3
    v_xor_b32 v96, 0, v4
    v_lshlrev_b32 v96, 4, v96
    v_lshl_add_u32 v10, v2, 13, v96
    v_xor_b32 v97, 1, v4
    v_lshlrev_b32 v97, 4, v97
    v_lshl_add_u32 v11, v2, 13, v97
    v_add_u32 v11, 31744, v11
    v_xor_b32 v98, 2, v4
    v_lshlrev_b32 v98, 4, v98
    v_lshl_add_u32 v12, v2, 13, v98
    v_add_u32 v12, 63488, v12
    v_xor_b32 v99, 3, v4
    v_lshlrev_b32 v99, 4, v99
    v_lshl_add_u32 v13, v2, 13, v99
    v_add_u32 v13, 95232, v13
    s_lshl_b32 s90, s34, 15
    s_mov_b32 s62, 0
    s_mov_b32 s94, 0
    s_lshl_b32 s95, s34, 20
    s_lshl_b32 s38, s32, 8
    s_add_u32 s95, s95, s38
    s_waitcnt lgkmcnt(0)
    s_mov_b32 s52, s12
    s_and_b32 s53, s13, 0xffff
    s_mov_b32 s54, 4194304
    s_mov_b32 s55, 0x20000
    s_add_u32 s39, s90, s62
    s_mov_b32 m0, s39
    s_add_u32 s62, s62, 4096
    s_and_b32 s62, s62, 0x7fff
    buffer_load_dwordx4 v10, s[52:55], s95 offen offset:0 nt lds
    buffer_load_dwordx4 v11, s[52:55], s95 offen offset:1024 nt lds
    buffer_load_dwordx4 v12, s[52:55], s95 offen offset:2048 nt lds
    buffer_load_dwordx4 v13, s[52:55], s95 offen offset:3072 nt lds
    s_add_u32 s95, s95, 131072
    s_add_u32 s39, s90, s62
    s_mov_b32 m0, s39
    s_add_u32 s62, s62, 4096
    s_and_b32 s62, s62, 0x7fff
    buffer_load_dwordx4 v10, s[52:55], s95 offen offset:0 nt lds
    buffer_load_dwordx4 v11, s[52:55], s95 offen offset:1024 nt lds
    buffer_load_dwordx4 v12, s[52:55], s95 offen offset:2048 nt lds
    buffer_load_dwordx4 v13, s[52:55], s95 offen offset:3072 nt lds
    s_add_u32 s95, s95, 131072
    s_load_dword s35, s[30:31], 0
    s_mov_b32 s48, s30
    s_and_b32 s49, s31, 0xffff
    s_mov_b32 s50, 8388608
    s_mov_b32 s51, 0x20000
    s_mov_b32 s82, 0xffffff00
    s_mov_b32 s83, 0x3e0293ee
    s_mov_b32 s84, 2097152
    v_lshl_add_u32 v76, v2, 10, v96
    v_lshl_add_u32 v96, v2, 8, v96
    v_lshl_add_u32 v77, v2, 10, v97
    v_lshl_add_u32 v97, v2, 8, v97
    v_add_u32 v77, 3072, v77
    v_lshl_add_u32 v78, v2, 10, v98
    v_lshl_add_u32 v98, v2, 8, v98
    v_add_u32 v78, 6144, v78
    v_lshl_add_u32 v79, v2, 10, v99
    v_lshl_add_u32 v99, v2, 8, v99
    v_add_u32 v79, 9216, v79
    v_bfe_u32 v100, v1, 0, 5
    v_lshlrev_b32 v101, 8, v100
    v_lshlrev_b32 v4, 4, v3
    v_lshl_add_u32 v9, v2, 10, v4
    v_and_b32 v4, 3, v1
    v_bfe_u32 v5, v1, 2, 2
    v_lshrrev_b32 v6, 5, v1
    v_lshl_add_u32 v7, v4, 2, v5
    v_xor_b32 v7, v7, v6
    v_lshlrev_b32 v7, 4, v7
    v_and_b32 v80, 31, v1
    v_lshl_add_u32 v80, v80, 8, v7
    v_lshl_add_u32 v81, v6, 2, v5
    v_lshlrev_b32 v81, 8, v81
    v_lshl_add_u32 v81, v5, 6, v81
    v_bfe_u32 v7, v1, 4, 1
    v_lshlrev_b32 v7, 1, v7
    v_bfe_u32 v82, v1, 1, 1
    v_add_u32 v7, v7, v82
    v_xor_b32 v7, v7, v6
    v_lshl_add_u32 v81, v7, 4, v81
    v_and_b32 v7, 1, v1
    v_lshl_add_u32 v81, v7, 3, v81
    v_lshl_add_u32 v95, v2, 3, v5
    v_lshlrev_b32 v95, 8, v95
    v_lshl_add_u32 v95, v5, 6, v95
    v_bfe_u32 v4, v1, 4, 1
    v_lshl_add_u32 v4, v4, 1, v82
    v_lshl_add_u32 v95, v4, 4, v95
    v_lshl_add_u32 v95, v7, 3, v95
    v_add_u32 v95, s90, v95
    v_xor_b32 v136, 0, v95
    v_xor_b32 v137, 16, v95
    v_xor_b32 v138, 32, v95
    v_xor_b32 v139, 48, v95
    v_xor_b32 v140, 64, v95
    v_xor_b32 v141, 80, v95
    v_xor_b32 v142, 96, v95
    v_xor_b32 v143, 112, v95
    v_xor_b32 v144, 128, v95
    v_xor_b32 v145, 144, v95
    v_xor_b32 v146, 160, v95
    v_xor_b32 v147, 176, v95
    v_xor_b32 v148, 192, v95
    v_xor_b32 v149, 208, v95
    v_xor_b32 v150, 224, v95
    v_xor_b32 v151, 240, v95
    s_lshl_b32 s85, s34, 13
    s_add_u32 s85, s85, 131072
    v_lshl_add_u32 v94, v1, 4, s85
    v_add_u32 v96, s85, v96
    v_add_u32 v97, s85, v97
    v_add_u32 v98, s85, v98
    v_add_u32 v99, s85, v99
    s_add_u32 s39, s90, s62
    s_mov_b32 m0, s39
    s_add_u32 s62, s62, 4096
    s_and_b32 s62, s62, 0x7fff
    buffer_load_dwordx4 v10, s[52:55], s95 offen offset:0 nt lds
    buffer_load_dwordx4 v11, s[52:55], s95 offen offset:1024 nt lds
    buffer_load_dwordx4 v12, s[52:55], s95 offen offset:2048 nt lds
    buffer_load_dwordx4 v13, s[52:55], s95 offen offset:3072 nt lds
    s_add_u32 s95, s95, 131072
    s_add_u32 s39, s90, s62
    s_mov_b32 m0, s39
    s_add_u32 s62, s62, 4096
    s_and_b32 s62, s62, 0x7fff
    buffer_load_dwordx4 v10, s[52:55], s95 offen offset:0 nt lds
    buffer_load_dwordx4 v11, s[52:55], s95 offen offset:1024 nt lds
    buffer_load_dwordx4 v12, s[52:55], s95 offen offset:2048 nt lds
    buffer_load_dwordx4 v13, s[52:55], s95 offen offset:3072 nt lds
    s_add_u32 s95, s95, 131072
    s_add_u32 s39, s90, s62
    s_mov_b32 m0, s39
    s_add_u32 s62, s62, 4096
    s_and_b32 s62, s62, 0x7fff
    buffer_load_dwordx4 v10, s[52:55], s95 offen offset:0 nt lds
    buffer_load_dwordx4 v11, s[52:55], s95 offen offset:1024 nt lds
    buffer_load_dwordx4 v12, s[52:55], s95 offen offset:2048 nt lds
    buffer_load_dwordx4 v13, s[52:55], s95 offen offset:3072 nt lds
    s_add_u32 s95, s95, 131072
    s_add_u32 s39, s90, s62
    s_mov_b32 m0, s39
    s_add_u32 s62, s62, 4096
    s_and_b32 s62, s62, 0x7fff
    buffer_load_dwordx4 v10, s[52:55], s95 offen offset:0 nt lds
    buffer_load_dwordx4 v11, s[52:55], s95 offen offset:1024 nt lds
    buffer_load_dwordx4 v12, s[52:55], s95 offen offset:2048 nt lds
    buffer_load_dwordx4 v13, s[52:55], s95 offen offset:3072 nt lds
    s_add_u32 s95, s95, 131072
    s_add_u32 s39, s90, s62
    s_mov_b32 m0, s39
    s_add_u32 s62, s62, 4096
    s_and_b32 s62, s62, 0x7fff
    buffer_load_dwordx4 v10, s[52:55], s95 offen offset:0 nt lds
    buffer_load_dwordx4 v11, s[52:55], s95 offen offset:1024 nt lds
    buffer_load_dwordx4 v12, s[52:55], s95 offen offset:2048 nt lds
    buffer_load_dwordx4 v13, s[52:55], s95 offen offset:3072 nt lds
    s_add_u32 s95, s95, 131072
    s_add_u32 s39, s90, s62
    s_mov_b32 m0, s39
    s_add_u32 s62, s62, 4096
    s_and_b32 s62, s62, 0x7fff
    buffer_load_dwordx4 v10, s[52:55], s95 offen offset:0 nt lds
    buffer_load_dwordx4 v11, s[52:55], s95 offen offset:1024 nt lds
    buffer_load_dwordx4 v12, s[52:55], s95 offen offset:2048 nt lds
    buffer_load_dwordx4 v13, s[52:55], s95 offen offset:3072 nt lds
    s_add_u32 s95, s95, 131072
    s_waitcnt lgkmcnt(0)
    s_add_u32 s35, s35, 0x5b
    s_and_b32 s35, s35, 0xff
    v_mov_b32 v8, s35
    s_or_b32 s68, s35, 0x6b3ac500
    s_mov_b32 s52, s6
    s_and_b32 s53, s7, 0xffff
    s_mov_b32 s54, 16777216
    s_mov_b32 s55, 0x20000
    s_bfe_u32 s38, s32, 0x30000
    s_lshl_b32 s38, s38, 2
    s_add_u32 s3, s38, 0
    s_lshr_b32 s38, s32, 3
    s_lshl_b32 s38, s38, 0
    s_add_u32 s3, s38, s3
    s_lshl_b32 s38, s3, 19
    s_add_u32 s95, s38, 0
    s_lshl_b32 s38, s34, 8
    s_add_u32 s95, s38, s95
    s_waitcnt vmcnt(24)
    ds_read_b64_tr_b16 a[128:129], v136 offset:0
    ds_read_b64_tr_b16 a[130:131], v137 offset:1024
    ds_read_b64_tr_b16 a[144:145], v138 offset:0
    ds_read_b64_tr_b16 a[146:147], v139 offset:1024
    ds_read_b64_tr_b16 a[160:161], v140 offset:0
    ds_read_b64_tr_b16 a[162:163], v141 offset:1024
    ds_read_b64_tr_b16 a[176:177], v142 offset:0
    ds_read_b64_tr_b16 a[178:179], v143 offset:1024
    ds_read_b64_tr_b16 a[192:193], v144 offset:0
    ds_read_b64_tr_b16 a[194:195], v145 offset:1024
    ds_read_b64_tr_b16 a[208:209], v146 offset:0
    ds_read_b64_tr_b16 a[210:211], v147 offset:1024
    ds_read_b64_tr_b16 a[224:225], v148 offset:0
    ds_read_b64_tr_b16 a[226:227], v149 offset:1024
    ds_read_b64_tr_b16 a[240:241], v150 offset:0
    ds_read_b64_tr_b16 a[242:243], v151 offset:1024
    s_waitcnt lgkmcnt(0)
    s_add_u32 s39, s90, s62
    s_mov_b32 m0, s39
    s_add_u32 s62, s62, 4096
    s_and_b32 s62, s62, 0x7fff
    buffer_load_dwordx4 v76, s[52:55], s95 offen offset:0 nt lds
    buffer_load_dwordx4 v77, s[52:55], s95 offen offset:1024 nt lds
    buffer_load_dwordx4 v78, s[52:55], s95 offen offset:2048 nt lds
    buffer_load_dwordx4 v79, s[52:55], s95 offen offset:3072 nt lds
    s_add_u32 s95, s95, 16384
    s_add_u32 s39, s90, s62
    s_mov_b32 m0, s39
    s_add_u32 s62, s62, 4096
    s_and_b32 s62, s62, 0x7fff
    buffer_load_dwordx4 v76, s[52:55], s95 offen offset:0 nt lds
    buffer_load_dwordx4 v77, s[52:55], s95 offen offset:1024 nt lds
    buffer_load_dwordx4 v78, s[52:55], s95 offen offset:2048 nt lds
    buffer_load_dwordx4 v79, s[52:55], s95 offen offset:3072 nt lds
    s_add_u32 s95, s95, 16384
    s_waitcnt vmcnt(24)
    ds_read_b64_tr_b16 a[132:133], v136 offset:8192
    ds_read_b64_tr_b16 a[134:135], v137 offset:9216
    ds_read_b64_tr_b16 a[148:149], v138 offset:8192
    ds_read_b64_tr_b16 a[150:151], v139 offset:9216
    ds_read_b64_tr_b16 a[164:165], v140 offset:8192
    ds_read_b64_tr_b16 a[166:167], v141 offset:9216
    ds_read_b64_tr_b16 a[180:181], v142 offset:8192
    ds_read_b64_tr_b16 a[182:183], v143 offset:9216
    ds_read_b64_tr_b16 a[196:197], v144 offset:8192
    ds_read_b64_tr_b16 a[198:199], v145 offset:9216
    ds_read_b64_tr_b16 a[212:213], v146 offset:8192
    ds_read_b64_tr_b16 a[214:215], v147 offset:9216
    ds_read_b64_tr_b16 a[228:229], v148 offset:8192
    ds_read_b64_tr_b16 a[230:231], v149 offset:9216
    ds_read_b64_tr_b16 a[244:245], v150 offset:8192
    ds_read_b64_tr_b16 a[246:247], v151 offset:9216
    s_waitcnt lgkmcnt(0)
    s_add_u32 s39, s90, s62
    s_mov_b32 m0, s39
    s_add_u32 s62, s62, 4096
    s_and_b32 s62, s62, 0x7fff
    buffer_load_dwordx4 v76, s[52:55], s95 offen offset:0 nt lds
    buffer_load_dwordx4 v77, s[52:55], s95 offen offset:1024 nt lds
    buffer_load_dwordx4 v78, s[52:55], s95 offen offset:2048 nt lds
    buffer_load_dwordx4 v79, s[52:55], s95 offen offset:3072 nt lds
    s_add_u32 s95, s95, 16384
    s_add_u32 s39, s90, s62
    s_mov_b32 m0, s39
    s_add_u32 s62, s62, 4096
    s_and_b32 s62, s62, 0x7fff
    buffer_load_dwordx4 v76, s[52:55], s95 offen offset:0 nt lds
    buffer_load_dwordx4 v77, s[52:55], s95 offen offset:1024 nt lds
    buffer_load_dwordx4 v78, s[52:55], s95 offen offset:2048 nt lds
    buffer_load_dwordx4 v79, s[52:55], s95 offen offset:3072 nt lds
    s_add_u32 s95, s95, 16384
    s_waitcnt vmcnt(24)
    ds_read_b64_tr_b16 a[136:137], v136 offset:16384
    ds_read_b64_tr_b16 a[138:139], v137 offset:17408
    ds_read_b64_tr_b16 a[152:153], v138 offset:16384
    ds_read_b64_tr_b16 a[154:155], v139 offset:17408
    ds_read_b64_tr_b16 a[168:169], v140 offset:16384
    ds_read_b64_tr_b16 a[170:171], v141 offset:17408
    ds_read_b64_tr_b16 a[184:185], v142 offset:16384
    ds_read_b64_tr_b16 a[186:187], v143 offset:17408
    ds_read_b64_tr_b16 a[200:201], v144 offset:16384
    ds_read_b64_tr_b16 a[202:203], v145 offset:17408
    ds_read_b64_tr_b16 a[216:217], v146 offset:16384
    ds_read_b64_tr_b16 a[218:219], v147 offset:17408
    ds_read_b64_tr_b16 a[232:233], v148 offset:16384
    ds_read_b64_tr_b16 a[234:235], v149 offset:17408
    ds_read_b64_tr_b16 a[248:249], v150 offset:16384
    ds_read_b64_tr_b16 a[250:251], v151 offset:17408
    s_waitcnt lgkmcnt(0)
    s_add_u32 s39, s90, s62
    s_mov_b32 m0, s39
    s_add_u32 s62, s62, 4096
    s_and_b32 s62, s62, 0x7fff
    buffer_load_dwordx4 v76, s[52:55], s95 offen offset:0 nt lds
    buffer_load_dwordx4 v77, s[52:55], s95 offen offset:1024 nt lds
    buffer_load_dwordx4 v78, s[52:55], s95 offen offset:2048 nt lds
    buffer_load_dwordx4 v79, s[52:55], s95 offen offset:3072 nt lds
    s_add_u32 s95, s95, 16384
    s_add_u32 s39, s90, s62
    s_mov_b32 m0, s39
    s_add_u32 s62, s62, 4096
    s_and_b32 s62, s62, 0x7fff
    buffer_load_dwordx4 v76, s[52:55], s95 offen offset:0 nt lds
    buffer_load_dwordx4 v77, s[52:55], s95 offen offset:1024 nt lds
    buffer_load_dwordx4 v78, s[52:55], s95 offen offset:2048 nt lds
    buffer_load_dwordx4 v79, s[52:55], s95 offen offset:3072 nt lds
    s_add_u32 s95, s95, 16384
    s_waitcnt vmcnt(24)
    ds_read_b64_tr_b16 a[140:141], v136 offset:24576
    ds_read_b64_tr_b16 a[142:143], v137 offset:25600
    ds_read_b64_tr_b16 a[156:157], v138 offset:24576
    ds_read_b64_tr_b16 a[158:159], v139 offset:25600
    ds_read_b64_tr_b16 a[172:173], v140 offset:24576
    ds_read_b64_tr_b16 a[174:175], v141 offset:25600
    ds_read_b64_tr_b16 a[188:189], v142 offset:24576
    ds_read_b64_tr_b16 a[190:191], v143 offset:25600
    ds_read_b64_tr_b16 a[204:205], v144 offset:24576
    ds_read_b64_tr_b16 a[206:207], v145 offset:25600
    ds_read_b64_tr_b16 a[220:221], v146 offset:24576
    ds_read_b64_tr_b16 a[222:223], v147 offset:25600
    ds_read_b64_tr_b16 a[236:237], v148 offset:24576
    ds_read_b64_tr_b16 a[238:239], v149 offset:25600
    ds_read_b64_tr_b16 a[252:253], v150 offset:24576
    ds_read_b64_tr_b16 a[254:255], v151 offset:25600
    s_waitcnt lgkmcnt(0)
    s_mov_b32 s86, 98304
    buffer_load_dword v7, v101, s[48:51], s86 offen sc1
    s_add_u32 s39, s90, s62
    s_mov_b32 m0, s39
    s_add_u32 s62, s62, 4096
    s_and_b32 s62, s62, 0x7fff
    buffer_load_dwordx4 v76, s[52:55], s95 offen offset:0 nt lds
    buffer_load_dwordx4 v77, s[52:55], s95 offen offset:1024 nt lds
    buffer_load_dwordx4 v78, s[52:55], s95 offen offset:2048 nt lds
    buffer_load_dwordx4 v79, s[52:55], s95 offen offset:3072 nt lds
    s_add_u32 s95, s95, 16384
    s_add_u32 s39, s90, s62
    s_mov_b32 m0, s39
    s_add_u32 s62, s62, 4096
    s_and_b32 s62, s62, 0x7fff
    buffer_load_dwordx4 v76, s[52:55], s95 offen offset:0 nt lds
    v_mov_b32 v136, 0
    v_mov_b32 v137, 0
    v_mov_b32 v138, 0
    v_mov_b32 v139, 0
    v_mov_b32 v140, 0
    v_mov_b32 v141, 0
    v_mov_b32 v142, 0
    v_mov_b32 v143, 0
    v_mov_b32 v144, 0
    v_mov_b32 v145, 0
    v_mov_b32 v146, 0
    v_mov_b32 v147, 0
    v_mov_b32 v148, 0
    v_mov_b32 v149, 0
    v_mov_b32 v150, 0
    v_mov_b32 v151, 0
    v_mov_b32 v152, 0
    v_mov_b32 v153, 0
    v_mov_b32 v154, 0
    v_mov_b32 v155, 0
    v_mov_b32 v156, 0
    v_mov_b32 v157, 0
    v_mov_b32 v158, 0
    v_mov_b32 v159, 0
    v_mov_b32 v160, 0
    v_mov_b32 v161, 0
    v_mov_b32 v162, 0
    v_mov_b32 v163, 0
    v_mov_b32 v164, 0
    v_mov_b32 v165, 0
    v_mov_b32 v166, 0
    v_mov_b32 v167, 0
    v_mov_b32 v168, 0
    v_mov_b32 v169, 0
    v_mov_b32 v170, 0
    v_mov_b32 v171, 0
    v_mov_b32 v172, 0
    v_mov_b32 v173, 0
    v_mov_b32 v174, 0
    v_mov_b32 v175, 0
    v_mov_b32 v176, 0
    v_mov_b32 v177, 0
    v_mov_b32 v178, 0
    v_mov_b32 v179, 0
    v_mov_b32 v180, 0
    v_mov_b32 v181, 0
    v_mov_b32 v182, 0
    v_mov_b32 v183, 0
    v_mov_b32 v184, 0
    v_mov_b32 v185, 0
    v_mov_b32 v186, 0
    v_mov_b32 v187, 0
    v_mov_b32 v188, 0
    v_mov_b32 v189, 0
    v_mov_b32 v190, 0
    v_mov_b32 v191, 0
    v_mov_b32 v192, 0
    v_mov_b32 v193, 0
    v_mov_b32 v194, 0
    v_mov_b32 v195, 0
    v_mov_b32 v196, 0
    v_mov_b32 v197, 0
    v_mov_b32 v198, 0
    v_mov_b32 v199, 0
    v_mov_b32 v90, 0xff7f0000
    s_mov_b32 s93, 0
    v_mov_b32 v102, 0
    v_mov_b32 v103, 0
    s_mov_b32 s60, s83
    s_mov_b32 s61, s83
    v_add_u32 v4, s85, v80
    v_xor_b32 v82, 0, v4
    v_xor_b32 v83, 32, v4
    v_xor_b32 v84, 64, v4
    v_xor_b32 v85, 96, v4
    v_xor_b32 v86, 128, v4
    v_xor_b32 v87, 160, v4
    v_xor_b32 v88, 192, v4
    v_xor_b32 v89, 224, v4
    v_add_u32 v80, s90, v80
    v_add_u32 v81, s90, v81
    s_lshr_b32 s38, s3, 3
    s_lshl_b32 s38, s38, 15
    s_add_u32 s36, s38, 393216
    s_lshl_b32 s38, s34, 8
    s_add_u32 s36, s38, s36
    s_waitcnt vmcnt(5)
L_fcheck_23:
    v_cmp_ne_u32 vcc, s68, v7
    s_cbranch_vccz L_fok_24
    s_sleep 2
    s_mov_b32 s86, 98304
    buffer_load_dword v7, v101, s[48:51], s86 offen sc1
    s_waitcnt vmcnt(0)
    s_sub_u32 s84, s84, 1
    s_cmp_lg_u32 s84, 0
    s_cbranch_scc1 L_fcheck_23
    s_branch L_end
L_fok_24:
    buffer_load_dwordx4 v[20:23], v9, s[48:51], s36 offen sc1
    s_add_u32 s36, s36, 4096
    buffer_load_dwordx4 v[24:27], v9, s[48:51], s36 offen sc1
    s_add_u32 s36, s36, 4096
    buffer_load_dwordx4 v[28:31], v9, s[48:51], s36 offen sc1
    s_add_u32 s36, s36, 4096
    buffer_load_dwordx4 v[32:35], v9, s[48:51], s36 offen sc1
    s_add_u32 s36, s36, 4096
    buffer_load_dwordx4 v[36:39], v9, s[48:51], s36 offen sc1
    s_add_u32 s36, s36, 4096
    buffer_load_dwordx4 v[40:43], v9, s[48:51], s36 offen sc1
    s_add_u32 s36, s36, 4096
    buffer_load_dwordx4 v[44:47], v9, s[48:51], s36 offen sc1
    s_add_u32 s36, s36, 4096
    buffer_load_dwordx4 v[48:51], v9, s[48:51], s36 offen sc1
    s_waitcnt vmcnt(7)
    ds_write_b128 v96, v[20:23] offset:0
    s_waitcnt vmcnt(6)
    ds_write_b128 v97, v[24:27] offset:1024
    s_waitcnt vmcnt(5)
    ds_write_b128 v98, v[28:31] offset:2048
    s_waitcnt vmcnt(4)
    ds_write_b128 v99, v[32:35] offset:3072
    s_waitcnt vmcnt(3)
    ds_write_b128 v96, v[36:39] offset:4096
    s_waitcnt vmcnt(2)
    ds_write_b128 v97, v[40:43] offset:5120
    s_waitcnt vmcnt(1)
    ds_write_b128 v98, v[44:47] offset:6144
    s_waitcnt vmcnt(0)
    ds_write_b128 v99, v[48:51] offset:7168
    s_waitcnt lgkmcnt(0)
    ds_read_b128 v[104:107], v82
    ds_read_b128 v[108:111], v83
    ds_read_b128 v[112:115], v84
    ds_read_b128 v[116:119], v85
    ds_read_b128 v[120:123], v86
    ds_read_b128 v[124:127], v87
    ds_read_b128 v[128:131], v88
    ds_read_b128 v[132:135], v89
    v_xor_b32 v82, 0, v80
    ds_read_b128 v[216:219], v82
    v_xor_b32 v83, 32, v80
    ds_read_b128 v[220:223], v83
    v_xor_b32 v84, 64, v80
    ds_read_b128 v[224:227], v84
    v_xor_b32 v85, 96, v80
    ds_read_b128 v[228:231], v85
    v_xor_b32 v86, 128, v80
    ds_read_b128 v[232:235], v86
    v_xor_b32 v87, 160, v80
    ds_read_b128 v[236:239], v87
    v_xor_b32 v88, 192, v80
    ds_read_b128 v[240:243], v88
    v_xor_b32 v89, 224, v80
    ds_read_b128 v[244:247], v89
L_att:
    v_add_u32 v4, s94, v81
    s_waitcnt lgkmcnt(0)
    v_mfma_f32_32x32x16_bf16 v[200:215], v[216:219], v[104:107], 0
    v_xor_b32 v82, 0, v4
    ds_read_b64_tr_b16 v[20:21], v82 offset:0
    ds_read_b64_tr_b16 v[24:25], v82 offset:4096
    buffer_load_dwordx4 v77, s[52:55], s95 offen offset:1024 nt lds
    v_mfma_f32_32x32x16_bf16 v[200:215], v[220:223], v[108:111], v[200:215]
    v_xor_b32 v83, 32, v4
    ds_read_b64_tr_b16 v[22:23], v83 offset:2048
    ds_read_b64_tr_b16 v[26:27], v83 offset:6144
    v_mfma_f32_32x32x16_bf16 v[200:215], v[224:227], v[112:115], v[200:215]
    v_xor_b32 v84, 64, v4
    ds_read_b64_tr_b16 v[28:29], v84 offset:0
    ds_read_b64_tr_b16 v[32:33], v84 offset:4096
    v_mfma_f32_32x32x16_bf16 v[200:215], v[228:231], v[116:119], v[200:215]
    v_xor_b32 v85, 96, v4
    ds_read_b64_tr_b16 v[30:31], v85 offset:2048
    ds_read_b64_tr_b16 v[34:35], v85 offset:6144
    v_mfma_f32_32x32x16_bf16 v[200:215], v[232:235], v[120:123], v[200:215]
    v_xor_b32 v86, 128, v4
    ds_read_b64_tr_b16 v[36:37], v86 offset:0
    ds_read_b64_tr_b16 v[40:41], v86 offset:4096
    buffer_load_dwordx4 v78, s[52:55], s95 offen offset:2048 nt lds
    v_mfma_f32_32x32x16_bf16 v[200:215], v[236:239], v[124:127], v[200:215]
    v_xor_b32 v87, 160, v4
    ds_read_b64_tr_b16 v[38:39], v87 offset:2048
    ds_read_b64_tr_b16 v[42:43], v87 offset:6144
    v_mfma_f32_32x32x16_bf16 v[200:215], v[240:243], v[128:131], v[200:215]
    v_xor_b32 v88, 192, v4
    ds_read_b64_tr_b16 v[44:45], v88 offset:0
    ds_read_b64_tr_b16 v[48:49], v88 offset:4096
    v_mfma_f32_32x32x16_bf16 v[200:215], v[244:247], v[132:135], v[200:215]
    v_xor_b32 v89, 224, v4
    ds_read_b64_tr_b16 v[46:47], v89 offset:2048
    ds_read_b64_tr_b16 v[50:51], v89 offset:6144
    buffer_load_dwordx4 v79, s[52:55], s95 offen offset:3072 nt lds
    s_add_u32 s95, s95, 16384
    v_xor_b32 v5, 0x2000, v94
    v_xor_b32 v6, 0x4000, v94
    v_xor_b32 v7, 0x6000, v94
    s_cmp_eq_u32 s93, 12
    s_cselect_b32 s95, 16777216, s95
    s_nop 1
    ds_write_b128 v94, v[200:203] offset:0
    ds_write_b128 v94, v[204:207] offset:1024
    ds_write_b128 v94, v[208:211] offset:2048
    ds_write_b128 v94, v[212:215] offset:3072
    s_waitcnt lgkmcnt(0)
    s_barrier
    ds_read_b128 v[60:63], v5 offset:0
    ds_read_b128 v[216:219], v6 offset:0
    ds_read_b128 v[232:235], v7 offset:0
    ds_read_b128 v[64:67], v5 offset:1024
    ds_read_b128 v[220:223], v6 offset:1024
    ds_read_b128 v[236:239], v7 offset:1024
    ds_read_b128 v[68:71], v5 offset:2048
    ds_read_b128 v[224:227], v6 offset:2048
    ds_read_b128 v[240:243], v7 offset:2048
    ds_read_b128 v[72:75], v5 offset:3072
    ds_read_b128 v[228:231], v6 offset:3072
    ds_read_b128 v[244:247], v7 offset:3072
    v_xor_b32 v94, 0x1000, v94
    s_add_u32 s39, s90, s62
    s_mov_b32 m0, s39
    s_add_u32 s62, s62, 4096
    s_and_b32 s62, s62, 0x7fff
    buffer_load_dwordx4 v76, s[52:55], s95 offen offset:0 nt lds
    s_add_u32 s94, s94, 8192
    s_and_b32 s94, s94, 0x7fff
    s_waitcnt lgkmcnt(9)
    v_pk_add_f32 v[200:201], v[200:201], v[60:61]
    v_pk_add_f32 v[216:217], v[216:217], v[232:233]
    v_pk_add_f32 v[202:203], v[202:203], v[62:63]
    v_pk_add_f32 v[218:219], v[218:219], v[234:235]
    v_pk_add_f32 v[200:201], v[200:201], v[216:217]
    v_pk_add_f32 v[202:203], v[202:203], v[218:219]
    s_waitcnt lgkmcnt(6)
    v_pk_add_f32 v[204:205], v[204:205], v[64:65]
    v_pk_add_f32 v[220:221], v[220:221], v[236:237]
    v_pk_add_f32 v[206:207], v[206:207], v[66:67]
    v_pk_add_f32 v[222:223], v[222:223], v[238:239]
    v_pk_add_f32 v[204:205], v[204:205], v[220:221]
    v_pk_add_f32 v[206:207], v[206:207], v[222:223]
    s_waitcnt lgkmcnt(3)
    v_pk_add_f32 v[208:209], v[208:209], v[68:69]
    v_pk_add_f32 v[224:225], v[224:225], v[240:241]
    v_pk_add_f32 v[210:211], v[210:211], v[70:71]
    v_pk_add_f32 v[226:227], v[226:227], v[242:243]
    v_pk_add_f32 v[208:209], v[208:209], v[224:225]
    v_pk_add_f32 v[210:211], v[210:211], v[226:227]
    s_waitcnt lgkmcnt(0)
    v_pk_add_f32 v[212:213], v[212:213], v[72:73]
    v_pk_add_f32 v[228:229], v[228:229], v[244:245]
    v_pk_add_f32 v[214:215], v[214:215], v[74:75]
    v_pk_add_f32 v[230:231], v[230:231], v[246:247]
    v_pk_add_f32 v[212:213], v[212:213], v[228:229]
    v_pk_add_f32 v[214:215], v[214:215], v[230:231]
    buffer_load_dwordx4 v77, s[52:55], s95 offen offset:1024 nt lds
    v_max_f32 v4, v200, v201
    v_max3_f32 v4, v4, v202, v203
    v_max3_f32 v4, v4, v204, v205
    v_max3_f32 v4, v4, v206, v207
    v_max3_f32 v4, v4, v208, v209
    v_max3_f32 v4, v4, v210, v211
    v_max3_f32 v4, v4, v212, v213
    v_max3_f32 v4, v4, v214, v215
    v_mov_b32 v5, v4
    s_nop 1
    v_permlane32_swap_b32 v4, v5
    v_max_f32 v4, v4, v5
    v_mul_f32 v4, s83, v4
    v_max_f32 v4, v4, v90
    v_sub_f32 v92, v90, v4
    v_exp_f32 v92, v92
    v_mov_b32 v90, v4
    v_pk_fma_f32 v[200:201], v[200:201], s[60:61], v[90:91] op_sel_hi:[1,1,0] neg_lo:[0,0,1] neg_hi:[0,0,1]
    v_pk_fma_f32 v[202:203], v[202:203], s[60:61], v[90:91] op_sel_hi:[1,1,0] neg_lo:[0,0,1] neg_hi:[0,0,1]
    v_pk_fma_f32 v[204:205], v[204:205], s[60:61], v[90:91] op_sel_hi:[1,1,0] neg_lo:[0,0,1] neg_hi:[0,0,1]
    v_pk_fma_f32 v[206:207], v[206:207], s[60:61], v[90:91] op_sel_hi:[1,1,0] neg_lo:[0,0,1] neg_hi:[0,0,1]
    v_pk_fma_f32 v[208:209], v[208:209], s[60:61], v[90:91] op_sel_hi:[1,1,0] neg_lo:[0,0,1] neg_hi:[0,0,1]
    v_pk_fma_f32 v[210:211], v[210:211], s[60:61], v[90:91] op_sel_hi:[1,1,0] neg_lo:[0,0,1] neg_hi:[0,0,1]
    v_pk_fma_f32 v[212:213], v[212:213], s[60:61], v[90:91] op_sel_hi:[1,1,0] neg_lo:[0,0,1] neg_hi:[0,0,1]
    v_pk_fma_f32 v[214:215], v[214:215], s[60:61], v[90:91] op_sel_hi:[1,1,0] neg_lo:[0,0,1] neg_hi:[0,0,1]
    v_exp_f32 v200, v200
    v_exp_f32 v201, v201
    v_exp_f32 v202, v202
    v_exp_f32 v203, v203
    v_exp_f32 v204, v204
    buffer_load_dwordx4 v78, s[52:55], s95 offen offset:2048 nt lds
    v_exp_f32 v205, v205
    v_exp_f32 v206, v206
    v_exp_f32 v207, v207
    v_exp_f32 v208, v208
    v_exp_f32 v209, v209
    v_exp_f32 v210, v210
    v_exp_f32 v211, v211
    v_exp_f32 v212, v212
    v_exp_f32 v213, v213
    v_exp_f32 v214, v214
    v_exp_f32 v215, v215
    v_add_u32 v4, s94, v80
    v_pk_mul_f32 v[102:103], v[102:103], v[92:93] op_sel_hi:[1,0]
    v_pk_mul_f32 v[136:137], v[136:137], v[92:93] op_sel_hi:[1,0]
    v_pk_mul_f32 v[138:139], v[138:139], v[92:93] op_sel_hi:[1,0]
    v_pk_mul_f32 v[140:141], v[140:141], v[92:93] op_sel_hi:[1,0]
    v_pk_mul_f32 v[142:143], v[142:143], v[92:93] op_sel_hi:[1,0]
    v_pk_mul_f32 v[144:145], v[144:145], v[92:93] op_sel_hi:[1,0]
    v_pk_mul_f32 v[146:147], v[146:147], v[92:93] op_sel_hi:[1,0]
    v_pk_mul_f32 v[148:149], v[148:149], v[92:93] op_sel_hi:[1,0]
    v_pk_mul_f32 v[150:151], v[150:151], v[92:93] op_sel_hi:[1,0]
    v_pk_mul_f32 v[152:153], v[152:153], v[92:93] op_sel_hi:[1,0]
    v_pk_mul_f32 v[154:155], v[154:155], v[92:93] op_sel_hi:[1,0]
    v_pk_mul_f32 v[156:157], v[156:157], v[92:93] op_sel_hi:[1,0]
    v_pk_mul_f32 v[158:159], v[158:159], v[92:93] op_sel_hi:[1,0]
    v_pk_mul_f32 v[160:161], v[160:161], v[92:93] op_sel_hi:[1,0]
    v_pk_mul_f32 v[162:163], v[162:163], v[92:93] op_sel_hi:[1,0]
    v_pk_mul_f32 v[164:165], v[164:165], v[92:93] op_sel_hi:[1,0]
    v_pk_mul_f32 v[166:167], v[166:167], v[92:93] op_sel_hi:[1,0]
    v_pk_mul_f32 v[168:169], v[168:169], v[92:93] op_sel_hi:[1,0]
    v_pk_mul_f32 v[170:171], v[170:171], v[92:93] op_sel_hi:[1,0]
    v_pk_mul_f32 v[172:173], v[172:173], v[92:93] op_sel_hi:[1,0]
    v_pk_mul_f32 v[174:175], v[174:175], v[92:93] op_sel_hi:[1,0]
    v_pk_mul_f32 v[176:177], v[176:177], v[92:93] op_sel_hi:[1,0]
    buffer_load_dwordx4 v79, s[52:55], s95 offen offset:3072 nt lds
    s_add_u32 s95, s95, 16384
    v_pk_mul_f32 v[178:179], v[178:179], v[92:93] op_sel_hi:[1,0]
    v_pk_mul_f32 v[180:181], v[180:181], v[92:93] op_sel_hi:[1,0]
    v_pk_mul_f32 v[182:183], v[182:183], v[92:93] op_sel_hi:[1,0]
    v_pk_mul_f32 v[184:185], v[184:185], v[92:93] op_sel_hi:[1,0]
    v_pk_mul_f32 v[186:187], v[186:187], v[92:93] op_sel_hi:[1,0]
    v_pk_mul_f32 v[188:189], v[188:189], v[92:93] op_sel_hi:[1,0]
    v_pk_mul_f32 v[190:191], v[190:191], v[92:93] op_sel_hi:[1,0]
    v_pk_mul_f32 v[192:193], v[192:193], v[92:93] op_sel_hi:[1,0]
    v_pk_mul_f32 v[194:195], v[194:195], v[92:93] op_sel_hi:[1,0]
    v_pk_mul_f32 v[196:197], v[196:197], v[92:93] op_sel_hi:[1,0]
    v_pk_mul_f32 v[198:199], v[198:199], v[92:93] op_sel_hi:[1,0]
    v_cvt_pk_bf16_f32 v52, v200, v201
    v_pk_add_f32 v[102:103], v[102:103], v[200:201]
    v_cvt_pk_bf16_f32 v53, v202, v203
    v_pk_add_f32 v[102:103], v[102:103], v[202:203]
    v_cvt_pk_bf16_f32 v54, v204, v205
    v_pk_add_f32 v[102:103], v[102:103], v[204:205]
    v_cvt_pk_bf16_f32 v55, v206, v207
    v_pk_add_f32 v[102:103], v[102:103], v[206:207]
    v_cvt_pk_bf16_f32 v56, v208, v209
    v_pk_add_f32 v[102:103], v[102:103], v[208:209]
    v_cvt_pk_bf16_f32 v57, v210, v211
    v_pk_add_f32 v[102:103], v[102:103], v[210:211]
    v_cvt_pk_bf16_f32 v58, v212, v213
    v_pk_add_f32 v[102:103], v[102:103], v[212:213]
    v_cvt_pk_bf16_f32 v59, v214, v215
    v_pk_add_f32 v[102:103], v[102:103], v[214:215]
    s_waitcnt vmcnt(20)
    v_mfma_f32_32x32x16_bf16 v[136:151], v[20:23], v[52:55], v[136:151]
    v_xor_b32 v82, 0, v4
    ds_read_b128 v[216:219], v82
    v_xor_b32 v83, 32, v4
    ds_read_b128 v[220:223], v83
    v_mfma_f32_32x32x16_bf16 v[152:167], v[28:31], v[52:55], v[152:167]
    v_xor_b32 v84, 64, v4
    ds_read_b128 v[224:227], v84
    v_xor_b32 v85, 96, v4
    ds_read_b128 v[228:231], v85
    v_mfma_f32_32x32x16_bf16 v[168:183], v[36:39], v[52:55], v[168:183]
    v_xor_b32 v86, 128, v4
    ds_read_b128 v[232:235], v86
    v_xor_b32 v87, 160, v4
    ds_read_b128 v[236:239], v87
    v_mfma_f32_32x32x16_bf16 v[184:199], v[44:47], v[52:55], v[184:199]
    v_xor_b32 v88, 192, v4
    ds_read_b128 v[240:243], v88
    v_xor_b32 v89, 224, v4
    ds_read_b128 v[244:247], v89
    v_mfma_f32_32x32x16_bf16 v[136:151], v[24:27], v[56:59], v[136:151]
    s_add_u32 s39, s90, s62
    s_mov_b32 m0, s39
    s_add_u32 s62, s62, 4096
    s_and_b32 s62, s62, 0x7fff
    buffer_load_dwordx4 v76, s[52:55], s95 offen offset:0 nt lds
    v_mfma_f32_32x32x16_bf16 v[152:167], v[32:35], v[56:59], v[152:167]
    v_mfma_f32_32x32x16_bf16 v[168:183], v[40:43], v[56:59], v[168:183]
    v_mfma_f32_32x32x16_bf16 v[184:199], v[48:51], v[56:59], v[184:199]
    s_add_u32 s93, s93, 1
    s_cmp_lt_u32 s93, 16
    s_cbranch_scc1 L_att
    v_add_f32 v91, v102, v103
    v_mov_b32 v5, v91
    s_nop 1
    v_permlane32_swap_b32 v91, v5
    v_add_f32 v91, v91, v5
    v_and_b32 v4, 31, v1
    v_lshlrev_b32 v5, 8, v4
    v_lshl_add_u32 v5, v3, 4, v5
    v_lshrrev_b32 v6, 5, v1
    v_lshl_add_u32 v5, v6, 3, v5
    v_add_u32 v5, s85, v5
    s_waitcnt vmcnt(0) lgkmcnt(0)
    s_barrier
    v_cvt_pk_bf16_f32 v20, v136, v137
    v_cvt_pk_bf16_f32 v21, v138, v139
    v_xor_b32 v82, 0, v5
    ds_write_b64 v82, v[20:21]
    v_cvt_pk_bf16_f32 v22, v140, v141
    v_cvt_pk_bf16_f32 v23, v142, v143
    v_xor_b32 v83, 16, v5
    ds_write_b64 v83, v[22:23]
    v_cvt_pk_bf16_f32 v24, v144, v145
    v_cvt_pk_bf16_f32 v25, v146, v147
    v_xor_b32 v84, 32, v5
    ds_write_b64 v84, v[24:25]
    v_cvt_pk_bf16_f32 v26, v148, v149
    v_cvt_pk_bf16_f32 v27, v150, v151
    v_xor_b32 v85, 48, v5
    ds_write_b64 v85, v[26:27]
    v_cvt_pk_bf16_f32 v28, v152, v153
    v_cvt_pk_bf16_f32 v29, v154, v155
    v_xor_b32 v86, 64, v5
    ds_write_b64 v86, v[28:29]
    v_cvt_pk_bf16_f32 v30, v156, v157
    v_cvt_pk_bf16_f32 v31, v158, v159
    v_xor_b32 v87, 80, v5
    ds_write_b64 v87, v[30:31]
    v_cvt_pk_bf16_f32 v32, v160, v161
    v_cvt_pk_bf16_f32 v33, v162, v163
    v_xor_b32 v88, 96, v5
    ds_write_b64 v88, v[32:33]
    v_cvt_pk_bf16_f32 v34, v164, v165
    v_cvt_pk_bf16_f32 v35, v166, v167
    v_xor_b32 v89, 112, v5
    ds_write_b64 v89, v[34:35]
    v_cvt_pk_bf16_f32 v36, v168, v169
    v_cvt_pk_bf16_f32 v37, v170, v171
    v_xor_b32 v82, 128, v5
    ds_write_b64 v82, v[36:37]
    v_cvt_pk_bf16_f32 v38, v172, v173
    v_cvt_pk_bf16_f32 v39, v174, v175
    v_xor_b32 v83, 144, v5
    ds_write_b64 v83, v[38:39]
    v_cvt_pk_bf16_f32 v40, v176, v177
    v_cvt_pk_bf16_f32 v41, v178, v179
    v_xor_b32 v84, 160, v5
    ds_write_b64 v84, v[40:41]
    v_cvt_pk_bf16_f32 v42, v180, v181
    v_cvt_pk_bf16_f32 v43, v182, v183
    v_xor_b32 v85, 176, v5
    ds_write_b64 v85, v[42:43]
    v_cvt_pk_bf16_f32 v44, v184, v185
    v_cvt_pk_bf16_f32 v45, v186, v187
    v_xor_b32 v86, 192, v5
    ds_write_b64 v86, v[44:45]
    v_cvt_pk_bf16_f32 v46, v188, v189
    v_cvt_pk_bf16_f32 v47, v190, v191
    v_xor_b32 v87, 208, v5
    ds_write_b64 v87, v[46:47]
    v_cvt_pk_bf16_f32 v48, v192, v193
    v_cvt_pk_bf16_f32 v49, v194, v195
    v_xor_b32 v88, 224, v5
    ds_write_b64 v88, v[48:49]
    v_cvt_pk_bf16_f32 v50, v196, v197
    v_cvt_pk_bf16_f32 v51, v198, v199
    v_xor_b32 v89, 240, v5
    ds_write_b64 v89, v[50:51]
    v_xor_b32 v6, v3, v2
    v_lshlrev_b32 v6, 4, v6
    v_lshl_add_u32 v6, v2, 8, v6
    v_add_u32 v6, s85, v6
    v_xor_b32 v82, 0, v6
    v_xor_b32 v83, 64, v6
    v_xor_b32 v84, 128, v6
    v_xor_b32 v85, 192, v6
    v_lshlrev_b32 v7, 4, v3
    v_lshl_add_u32 v7, v2, 15, v7
    s_lshl_b32 s38, s3, 10
    s_add_u32 s36, s38, 2097152
    s_lshl_b32 s38, s34, 8
    s_add_u32 s36, s38, s36
    s_waitcnt lgkmcnt(0)
    ds_read_b128 v[200:203], v82 offset:0
    ds_read_b128 v[204:207], v83 offset:1024
    ds_read_b128 v[208:211], v84 offset:2048
    ds_read_b128 v[212:215], v85 offset:3072
    ds_read_b128 v[216:219], v82 offset:4096
    ds_read_b128 v[220:223], v83 offset:5120
    ds_read_b128 v[224:227], v84 offset:6144
    ds_read_b128 v[228:231], v85 offset:7168
    v_lshlrev_b32 v4, 3, v4
    s_lshl_b32 s38, s3, 8
    s_add_u32 s37, s38, 163840
    s_lshl_b32 s38, s34, 23
    s_add_u32 s37, s38, s37
    s_mov_b32 exec_lo, 0xffffffff
    s_mov_b32 exec_hi, 0x0
    buffer_store_dwordx2 v[90:91], v4, s[48:51], s37 offen sc1
    s_mov_b64 exec, -1
    s_waitcnt lgkmcnt(7)
    buffer_store_dwordx4 v[200:203], v7, s[48:51], s36 offen sc1
    s_add_u32 s36, s36, 131072
    s_waitcnt lgkmcnt(6)
    buffer_store_dwordx4 v[204:207], v7, s[48:51], s36 offen sc1
    s_add_u32 s36, s36, 131072
    s_waitcnt lgkmcnt(5)
    buffer_store_dwordx4 v[208:211], v7, s[48:51], s36 offen sc1
    s_add_u32 s36, s36, 131072
    s_waitcnt lgkmcnt(4)
    buffer_store_dwordx4 v[212:215], v7, s[48:51], s36 offen sc1
    s_add_u32 s36, s36, 131072
    s_waitcnt lgkmcnt(3)
    buffer_store_dwordx4 v[216:219], v7, s[48:51], s36 offen sc1
    s_add_u32 s36, s36, 131072
    s_waitcnt lgkmcnt(2)
    buffer_store_dwordx4 v[220:223], v7, s[48:51], s36 offen sc1
    s_add_u32 s36, s36, 131072
    s_waitcnt lgkmcnt(1)
    buffer_store_dwordx4 v[224:227], v7, s[48:51], s36 offen sc1
    s_add_u32 s36, s36, 131072
    s_waitcnt lgkmcnt(0)
    buffer_store_dwordx4 v[228:231], v7, s[48:51], s36 offen sc1
    s_sub_u32 s36, s33, 3
    s_and_b32 s37, s33, 3
    s_cmp_lt_u32 s36, 4
    s_cselect_b64 s[40:41], s[24:25], s[14:15]
    s_cselect_b32 s36, s36, s37
    s_cselect_b32 s45, 262144, 0
    s_cselect_b32 s46, 8388608, 0
    s_add_u32 s45, s45, 524288
    s_add_u32 s46, s46, 196608
    s_mov_b32 s42, 4194304
    s_mov_b32 s43, 0x20000
    s_lshl_b32 s38, s32, 17
    s_add_u32 s44, s38, 0
    s_lshl_b32 s38, s34, 15
    s_add_u32 s44, s38, s44
    s_lshl_b32 s38, s36, 8
    s_add_u32 s44, s38, s44
    s_lshl_b32 s38, s36, 16
    s_add_u32 s45, s38, s45
    s_lshr_b32 s38, s34, 1
    s_lshl_b32 s38, s38, 15
    s_add_u32 s45, s38, s45
    s_lshl_b32 s38, s32, 8
    s_add_u32 s45, s38, s45
    s_bfe_u32 s38, s34, 0x10000
    s_lshl_b32 s38, s38, 7
    s_add_u32 s45, s38, s45
    s_lshl_b32 s38, s32, 11
    s_add_u32 s46, s38, s46
    s_lshl_b32 s38, s34, 9
    s_add_u32 s46, s38, s46
    s_mov_b32 s72, s26
    s_and_b32 s73, s27, 0xffff
    s_mov_b32 s74, 8192
    s_mov_b32 s75, 0x20000
    s_lshl_b32 s39, s34, 13
    s_add_u32 s39, s39, 98304
    s_mov_b32 m0, s39
    s_nop 0
    buffer_load_dwordx4 v76, s[40:43], s44 offen offset:0 nt lds
    buffer_load_dwordx4 v77, s[40:43], s44 offen offset:1024 nt lds
    buffer_load_dwordx4 v78, s[40:43], s44 offen offset:2048 nt lds
    buffer_load_dwordx4 v79, s[40:43], s44 offen offset:3072 nt lds
    s_lshl_b32 s39, s34, 13
    s_add_u32 s39, s39, 102400
    s_mov_b32 m0, s39
    s_add_u32 s44, s44, 16384
    buffer_load_dwordx4 v76, s[40:43], s44 offen offset:0 nt lds
    buffer_load_dwordx4 v77, s[40:43], s44 offen offset:1024 nt lds
    buffer_load_dwordx4 v78, s[40:43], s44 offen offset:2048 nt lds
    buffer_load_dwordx4 v79, s[40:43], s44 offen offset:3072 nt lds
    v_lshlrev_b32 v30, 4, v3
    v_lshl_add_u32 v30, v2, 13, v30
    s_lshl_b32 s38, s32, 13
    s_add_u32 s36, s38, 0
    s_lshl_b32 s38, s34, 6
    s_add_u32 s36, s38, s36
    v_lshrrev_b32 v5, 2, v1
    v_lshlrev_b32 v32, 8, v5
    v_bfe_u32 v5, v1, 0, 2
    v_lshl_add_u32 v32, v5, 4, v32
    v_add_u32 v32, s36, v32
    s_lshr_b32 s38, s32, 2
    s_lshl_b32 s38, s38, 7
    s_add_u32 s36, s38, 0
    s_lshl_b32 s38, s34, 5
    s_add_u32 s36, s38, s36
    s_bfe_u32 s38, s32, 0x20000
    s_lshl_b32 s38, s38, 3
    s_add_u32 s36, s38, s36
    v_bfe_u32 v5, v1, 0, 2
    v_lshlrev_b32 v33, 11, v5
    v_lshl_add_u32 v33, v2, 1, v33
    v_add_u32 v33, s36, v33
    v_and_b32 v5, 31, v1
    v_lshlrev_b32 v34, 4, v5
    s_mul_i32 s38, s34, 320
    s_add_u32 s38, s38, 135168
    v_lshl_add_u32 v35, v5, 3, s38
    v_and_b32 v4, 3, v3
    v_bfe_u32 v5, v3, 0, 2
    v_lshlrev_b32 v81, 11, v5
    v_lshrrev_b32 v5, 2, v3
    v_lshl_add_u32 v81, v5, 8, v81
    v_and_b32 v5, 12, v3
    v_xor_b32 v5, v5, v2
    v_and_b32 v6, 1, v3
    v_lshlrev_b32 v6, 1, v6
    v_xor_b32 v5, v5, v6
    v_lshlrev_b32 v80, 4, v5
    v_bfe_u32 v6, v3, 0, 2
    v_lshl_add_u32 v80, v6, 11, v80
    v_lshrrev_b32 v6, 2, v3
    v_lshl_add_u32 v80, v6, 8, v80
    v_add_u32 v80, s85, v80
    v_lshlrev_b32 v4, 9, v4
    v_lshl_add_u32 v4, v2, 4, v4
    v_add_u32 v94, s85, v4
    s_lshl_b32 s38, s34, 9
    s_add_u32 s38, s38, 131072
    v_and_b32 v5, 31, v1
    v_lshl_add_u32 v102, v5, 4, s38
    s_lshl_b32 s38, s32, 15
    s_add_u32 s36, s38, 2097152
    s_lshl_b32 s38, s34, 8
    s_add_u32 s36, s38, s36
    s_lshl_b32 s38, s32, 3
    s_add_u32 s37, s38, 163840
    s_lshl_b32 s38, s32, 8
    s_add_u32 s69, s38, 131072
    s_cmp_eq_u32 s34, 0
    s_cselect_b32 s69, s69, 8388608
    v_mov_b32 v4, s69
    v_mov_b32 v5, s68
    s_waitcnt vmcnt(8)
    s_barrier
    s_mov_b64 exec, 1
    buffer_store_dword v5, v4, s[48:51], 0 offen sc1
    s_mov_b64 exec, -1
    s_mov_b32 s86, 131072
    buffer_load_dword v7, v101, s[48:51], s86 offen sc1
    s_waitcnt vmcnt(0)
L_fcheck_25:
    v_cmp_ne_u32 vcc, s68, v7
    s_cbranch_vccz L_fok_26
    s_sleep 2
    s_mov_b32 s86, 131072
    buffer_load_dword v7, v101, s[48:51], s86 offen sc1
    s_waitcnt vmcnt(0)
    s_sub_u32 s84, s84, 1
    s_cmp_lg_u32 s84, 0
    s_cbranch_scc1 L_fcheck_25
    s_branch L_end
L_fok_26:
    buffer_load_dwordx2 v[52:53], v81, s[48:51], s37 offen sc1
    s_add_u32 s37, s37, 1024
    buffer_load_dwordx2 v[54:55], v81, s[48:51], s37 offen sc1
    buffer_load_dwordx4 v[200:203], v9, s[48:51], s36 offen sc1
    s_add_u32 s36, s36, 4096
    buffer_load_dwordx4 v[204:207], v9, s[48:51], s36 offen sc1
    s_add_u32 s36, s36, 4096
    buffer_load_dwordx4 v[208:211], v9, s[48:51], s36 offen sc1
    s_add_u32 s36, s36, 4096
    buffer_load_dwordx4 v[212:215], v9, s[48:51], s36 offen sc1
    s_add_u32 s36, s36, 4096
    buffer_load_dwordx4 v[216:219], v9, s[48:51], s36 offen sc1
    s_add_u32 s36, s36, 4096
    buffer_load_dwordx4 v[220:223], v9, s[48:51], s36 offen sc1
    s_add_u32 s36, s36, 4096
    buffer_load_dwordx4 v[224:227], v9, s[48:51], s36 offen sc1
    s_add_u32 s36, s36, 4096
    buffer_load_dwordx4 v[228:231], v9, s[48:51], s36 offen sc1
    v_xor_b32 v82, 0, v80
    v_xor_b32 v83, 64, v80
    v_xor_b32 v84, 128, v80
    v_xor_b32 v85, 192, v80
    v_xor_b32 v86, 16, v80
    v_xor_b32 v87, 80, v80
    v_xor_b32 v88, 144, v80
    v_xor_b32 v89, 208, v80
    s_waitcnt vmcnt(8)
    v_max_f32 v4, v52, v54
    s_nop 1
    v_max_f32_dpp v4, v4, v4 row_ror:8 row_mask:0xf bank_mask:0xf
    s_nop 1
    v_max_f32_dpp v4, v4, v4 row_ror:4 row_mask:0xf bank_mask:0xf
    v_sub_f32 v52, v52, v4
    v_sub_f32 v54, v54, v4
    v_exp_f32 v52, v52
    v_exp_f32 v54, v54
    v_mul_f32 v5, v52, v53
    v_fmac_f32 v5, v54, v55
    s_nop 1
    v_add_f32_dpp v5, v5, v5 row_ror:8 row_mask:0xf bank_mask:0xf
    s_nop 1
    v_add_f32_dpp v5, v5, v5 row_ror:4 row_mask:0xf bank_mask:0xf
    v_rcp_f32 v5, v5
    s_nop 0
    v_mul_f32 v52, v52, v5
    v_mul_f32 v54, v54, v5
    s_waitcnt vmcnt(7)
    ds_write_b128 v96, v[200:203] offset:0
    s_waitcnt vmcnt(6)
    ds_write_b128 v97, v[204:207] offset:1024
    s_waitcnt vmcnt(5)
    ds_write_b128 v98, v[208:211] offset:2048
    s_waitcnt vmcnt(4)
    ds_write_b128 v99, v[212:215] offset:3072
    s_waitcnt vmcnt(3)
    ds_write_b128 v96, v[216:219] offset:4096
    s_waitcnt vmcnt(2)
    ds_write_b128 v97, v[220:223] offset:5120
    s_waitcnt vmcnt(1)
    ds_write_b128 v98, v[224:227] offset:6144
    s_waitcnt vmcnt(0)
    ds_write_b128 v99, v[228:231] offset:7168
    s_waitcnt lgkmcnt(0)
    ds_read_b128 v[136:139], v82 offset:0
    ds_read_b128 v[140:143], v83 offset:0
    ds_read_b128 v[144:147], v84 offset:0
    ds_read_b128 v[148:151], v85 offset:0
    ds_read_b128 v[152:155], v86 offset:1024
    ds_read_b128 v[156:159], v87 offset:1024
    ds_read_b128 v[160:163], v88 offset:1024
    ds_read_b128 v[164:167], v89 offset:1024
    s_waitcnt lgkmcnt(0)
    v_mfma_f32_16x16x32_bf16 v[60:63], a[128:131], v[136:139], 0
    v_mfma_f32_16x16x32_bf16 v[64:67], a[128:131], v[152:155], 0
    v_mfma_f32_16x16x32_bf16 v[60:63], a[132:135], v[140:143], v[60:63]
    v_mfma_f32_16x16x32_bf16 v[64:67], a[132:135], v[156:159], v[64:67]
    v_mfma_f32_16x16x32_bf16 v[60:63], a[136:139], v[144:147], v[60:63]
    v_mfma_f32_16x16x32_bf16 v[64:67], a[136:139], v[160:163], v[64:67]
    v_mfma_f32_16x16x32_bf16 v[60:63], a[140:143], v[148:151], v[60:63]
    v_mfma_f32_16x16x32_bf16 v[64:67], a[140:143], v[164:167], v[64:67]
    v_mfma_f32_16x16x32_bf16 v[68:71], a[144:147], v[136:139], 0
    v_mfma_f32_16x16x32_bf16 v[72:75], a[144:147], v[152:155], 0
    v_mfma_f32_16x16x32_bf16 v[68:71], a[148:151], v[140:143], v[68:71]
    v_mfma_f32_16x16x32_bf16 v[72:75], a[148:151], v[156:159], v[72:75]
    v_mfma_f32_16x16x32_bf16 v[68:71], a[152:155], v[144:147], v[68:71]
    v_mfma_f32_16x16x32_bf16 v[72:75], a[152:155], v[160:163], v[72:75]
    v_mfma_f32_16x16x32_bf16 v[68:71], a[156:159], v[148:151], v[68:71]
    v_mfma_f32_16x16x32_bf16 v[72:75], a[156:159], v[164:167], v[72:75]
    v_mul_f32 v104, v60, v52
    v_mul_f32 v105, v61, v52
    v_mul_f32 v106, v62, v52
    v_mul_f32 v107, v63, v52
    v_fmac_f32 v104, v64, v54
    v_fmac_f32 v105, v65, v54
    v_fmac_f32 v106, v66, v54
    v_fmac_f32 v107, v67, v54
    v_add_f32_dpp v104, v104, v104 row_ror:8 row_mask:0xf bank_mask:0xf
    v_add_f32_dpp v105, v105, v105 row_ror:8 row_mask:0xf bank_mask:0xf
    v_add_f32_dpp v106, v106, v106 row_ror:8 row_mask:0xf bank_mask:0xf
    v_add_f32_dpp v107, v107, v107 row_ror:8 row_mask:0xf bank_mask:0xf
    v_add_f32_dpp v104, v104, v104 row_ror:4 row_mask:0xf bank_mask:0xf
    v_add_f32_dpp v105, v105, v105 row_ror:4 row_mask:0xf bank_mask:0xf
    v_add_f32_dpp v106, v106, v106 row_ror:4 row_mask:0xf bank_mask:0xf
    v_add_f32_dpp v107, v107, v107 row_ror:4 row_mask:0xf bank_mask:0xf
    ds_write_b128 v94, v[104:107] offset:0
    v_mfma_f32_16x16x32_bf16 v[60:63], a[160:163], v[136:139], 0
    v_mfma_f32_16x16x32_bf16 v[64:67], a[160:163], v[152:155], 0
    v_mfma_f32_16x16x32_bf16 v[60:63], a[164:167], v[140:143], v[60:63]
    v_mfma_f32_16x16x32_bf16 v[64:67], a[164:167], v[156:159], v[64:67]
    v_mfma_f32_16x16x32_bf16 v[60:63], a[168:171], v[144:147], v[60:63]
    v_mfma_f32_16x16x32_bf16 v[64:67], a[168:171], v[160:163], v[64:67]
    v_mfma_f32_16x16x32_bf16 v[60:63], a[172:175], v[148:151], v[60:63]
    v_mfma_f32_16x16x32_bf16 v[64:67], a[172:175], v[164:167], v[64:67]
    v_mul_f32 v108, v68, v52
    v_mul_f32 v109, v69, v52
    v_mul_f32 v110, v70, v52
    v_mul_f32 v111, v71, v52
    v_fmac_f32 v108, v72, v54
    v_fmac_f32 v109, v73, v54
    v_fmac_f32 v110, v74, v54
    v_fmac_f32 v111, v75, v54
    v_add_f32_dpp v108, v108, v108 row_ror:8 row_mask:0xf bank_mask:0xf
    v_add_f32_dpp v109, v109, v109 row_ror:8 row_mask:0xf bank_mask:0xf
    v_add_f32_dpp v110, v110, v110 row_ror:8 row_mask:0xf bank_mask:0xf
    v_add_f32_dpp v111, v111, v111 row_ror:8 row_mask:0xf bank_mask:0xf
    v_add_f32_dpp v108, v108, v108 row_ror:4 row_mask:0xf bank_mask:0xf
    v_add_f32_dpp v109, v109, v109 row_ror:4 row_mask:0xf bank_mask:0xf
    v_add_f32_dpp v110, v110, v110 row_ror:4 row_mask:0xf bank_mask:0xf
    v_add_f32_dpp v111, v111, v111 row_ror:4 row_mask:0xf bank_mask:0xf
    ds_write_b128 v94, v[108:111] offset:64
    v_mfma_f32_16x16x32_bf16 v[68:71], a[176:179], v[136:139], 0
    v_mfma_f32_16x16x32_bf16 v[72:75], a[176:179], v[152:155], 0
    v_mfma_f32_16x16x32_bf16 v[68:71], a[180:183], v[140:143], v[68:71]
    v_mfma_f32_16x16x32_bf16 v[72:75], a[180:183], v[156:159], v[72:75]
    v_mfma_f32_16x16x32_bf16 v[68:71], a[184:187], v[144:147], v[68:71]
    v_mfma_f32_16x16x32_bf16 v[72:75], a[184:187], v[160:163], v[72:75]
    v_mfma_f32_16x16x32_bf16 v[68:71], a[188:191], v[148:151], v[68:71]
    v_mfma_f32_16x16x32_bf16 v[72:75], a[188:191], v[164:167], v[72:75]
    v_mul_f32 v104, v60, v52
    v_mul_f32 v105, v61, v52
    v_mul_f32 v106, v62, v52
    v_mul_f32 v107, v63, v52
    v_fmac_f32 v104, v64, v54
    v_fmac_f32 v105, v65, v54
    v_fmac_f32 v106, v66, v54
    v_fmac_f32 v107, v67, v54
    v_add_f32_dpp v104, v104, v104 row_ror:8 row_mask:0xf bank_mask:0xf
    v_add_f32_dpp v105, v105, v105 row_ror:8 row_mask:0xf bank_mask:0xf
    v_add_f32_dpp v106, v106, v106 row_ror:8 row_mask:0xf bank_mask:0xf
    v_add_f32_dpp v107, v107, v107 row_ror:8 row_mask:0xf bank_mask:0xf
    v_add_f32_dpp v104, v104, v104 row_ror:4 row_mask:0xf bank_mask:0xf
    v_add_f32_dpp v105, v105, v105 row_ror:4 row_mask:0xf bank_mask:0xf
    v_add_f32_dpp v106, v106, v106 row_ror:4 row_mask:0xf bank_mask:0xf
    v_add_f32_dpp v107, v107, v107 row_ror:4 row_mask:0xf bank_mask:0xf
    ds_write_b128 v94, v[104:107] offset:128
    v_mfma_f32_16x16x32_bf16 v[60:63], a[192:195], v[136:139], 0
    v_mfma_f32_16x16x32_bf16 v[64:67], a[192:195], v[152:155], 0
    v_mfma_f32_16x16x32_bf16 v[60:63], a[196:199], v[140:143], v[60:63]
    v_mfma_f32_16x16x32_bf16 v[64:67], a[196:199], v[156:159], v[64:67]
    v_mfma_f32_16x16x32_bf16 v[60:63], a[200:203], v[144:147], v[60:63]
    v_mfma_f32_16x16x32_bf16 v[64:67], a[200:203], v[160:163], v[64:67]
    v_mfma_f32_16x16x32_bf16 v[60:63], a[204:207], v[148:151], v[60:63]
    v_mfma_f32_16x16x32_bf16 v[64:67], a[204:207], v[164:167], v[64:67]
    v_mul_f32 v108, v68, v52
    v_mul_f32 v109, v69, v52
    v_mul_f32 v110, v70, v52
    v_mul_f32 v111, v71, v52
    v_fmac_f32 v108, v72, v54
    v_fmac_f32 v109, v73, v54
    v_fmac_f32 v110, v74, v54
    v_fmac_f32 v111, v75, v54
    v_add_f32_dpp v108, v108, v108 row_ror:8 row_mask:0xf bank_mask:0xf
    v_add_f32_dpp v109, v109, v109 row_ror:8 row_mask:0xf bank_mask:0xf
    v_add_f32_dpp v110, v110, v110 row_ror:8 row_mask:0xf bank_mask:0xf
    v_add_f32_dpp v111, v111, v111 row_ror:8 row_mask:0xf bank_mask:0xf
    v_add_f32_dpp v108, v108, v108 row_ror:4 row_mask:0xf bank_mask:0xf
    v_add_f32_dpp v109, v109, v109 row_ror:4 row_mask:0xf bank_mask:0xf
    v_add_f32_dpp v110, v110, v110 row_ror:4 row_mask:0xf bank_mask:0xf
    v_add_f32_dpp v111, v111, v111 row_ror:4 row_mask:0xf bank_mask:0xf
    ds_write_b128 v94, v[108:111] offset:192
    v_mfma_f32_16x16x32_bf16 v[68:71], a[208:211], v[136:139], 0
    v_mfma_f32_16x16x32_bf16 v[72:75], a[208:211], v[152:155], 0
    v_mfma_f32_16x16x32_bf16 v[68:71], a[212:215], v[140:143], v[68:71]
    v_mfma_f32_16x16x32_bf16 v[72:75], a[212:215], v[156:159], v[72:75]
    v_mfma_f32_16x16x32_bf16 v[68:71], a[216:219], v[144:147], v[68:71]
    v_mfma_f32_16x16x32_bf16 v[72:75], a[216:219], v[160:163], v[72:75]
    v_mfma_f32_16x16x32_bf16 v[68:71], a[220:223], v[148:151], v[68:71]
    v_mfma_f32_16x16x32_bf16 v[72:75], a[220:223], v[164:167], v[72:75]
    v_mul_f32 v104, v60, v52
    v_mul_f32 v105, v61, v52
    v_mul_f32 v106, v62, v52
    v_mul_f32 v107, v63, v52
    v_fmac_f32 v104, v64, v54
    v_fmac_f32 v105, v65, v54
    v_fmac_f32 v106, v66, v54
    v_fmac_f32 v107, v67, v54
    v_add_f32_dpp v104, v104, v104 row_ror:8 row_mask:0xf bank_mask:0xf
    v_add_f32_dpp v105, v105, v105 row_ror:8 row_mask:0xf bank_mask:0xf
    v_add_f32_dpp v106, v106, v106 row_ror:8 row_mask:0xf bank_mask:0xf
    v_add_f32_dpp v107, v107, v107 row_ror:8 row_mask:0xf bank_mask:0xf
    v_add_f32_dpp v104, v104, v104 row_ror:4 row_mask:0xf bank_mask:0xf
    v_add_f32_dpp v105, v105, v105 row_ror:4 row_mask:0xf bank_mask:0xf
    v_add_f32_dpp v106, v106, v106 row_ror:4 row_mask:0xf bank_mask:0xf
    v_add_f32_dpp v107, v107, v107 row_ror:4 row_mask:0xf bank_mask:0xf
    ds_write_b128 v94, v[104:107] offset:256
    v_mfma_f32_16x16x32_bf16 v[60:63], a[224:227], v[136:139], 0
    v_mfma_f32_16x16x32_bf16 v[64:67], a[224:227], v[152:155], 0
    v_mfma_f32_16x16x32_bf16 v[60:63], a[228:231], v[140:143], v[60:63]
    v_mfma_f32_16x16x32_bf16 v[64:67], a[228:231], v[156:159], v[64:67]
    v_mfma_f32_16x16x32_bf16 v[60:63], a[232:235], v[144:147], v[60:63]
    v_mfma_f32_16x16x32_bf16 v[64:67], a[232:235], v[160:163], v[64:67]
    v_mfma_f32_16x16x32_bf16 v[60:63], a[236:239], v[148:151], v[60:63]
    v_mfma_f32_16x16x32_bf16 v[64:67], a[236:239], v[164:167], v[64:67]
    v_mul_f32 v108, v68, v52
    v_mul_f32 v109, v69, v52
    v_mul_f32 v110, v70, v52
    v_mul_f32 v111, v71, v52
    v_fmac_f32 v108, v72, v54
    v_fmac_f32 v109, v73, v54
    v_fmac_f32 v110, v74, v54
    v_fmac_f32 v111, v75, v54
    v_add_f32_dpp v108, v108, v108 row_ror:8 row_mask:0xf bank_mask:0xf
    v_add_f32_dpp v109, v109, v109 row_ror:8 row_mask:0xf bank_mask:0xf
    v_add_f32_dpp v110, v110, v110 row_ror:8 row_mask:0xf bank_mask:0xf
    v_add_f32_dpp v111, v111, v111 row_ror:8 row_mask:0xf bank_mask:0xf
    v_add_f32_dpp v108, v108, v108 row_ror:4 row_mask:0xf bank_mask:0xf
    v_add_f32_dpp v109, v109, v109 row_ror:4 row_mask:0xf bank_mask:0xf
    v_add_f32_dpp v110, v110, v110 row_ror:4 row_mask:0xf bank_mask:0xf
    v_add_f32_dpp v111, v111, v111 row_ror:4 row_mask:0xf bank_mask:0xf
    ds_write_b128 v94, v[108:111] offset:320
    v_mfma_f32_16x16x32_bf16 v[68:71], a[240:243], v[136:139], 0
    v_mfma_f32_16x16x32_bf16 v[72:75], a[240:243], v[152:155], 0
    v_mfma_f32_16x16x32_bf16 v[68:71], a[244:247], v[140:143], v[68:71]
    v_mfma_f32_16x16x32_bf16 v[72:75], a[244:247], v[156:159], v[72:75]
    v_mfma_f32_16x16x32_bf16 v[68:71], a[248:251], v[144:147], v[68:71]
    v_mfma_f32_16x16x32_bf16 v[72:75], a[248:251], v[160:163], v[72:75]
    v_mfma_f32_16x16x32_bf16 v[68:71], a[252:255], v[148:151], v[68:71]
    v_mfma_f32_16x16x32_bf16 v[72:75], a[252:255], v[164:167], v[72:75]
    v_mul_f32 v104, v60, v52
    v_mul_f32 v105, v61, v52
    v_mul_f32 v106, v62, v52
    v_mul_f32 v107, v63, v52
    v_fmac_f32 v104, v64, v54
    v_fmac_f32 v105, v65, v54
    v_fmac_f32 v106, v66, v54
    v_fmac_f32 v107, v67, v54
    v_add_f32_dpp v104, v104, v104 row_ror:8 row_mask:0xf bank_mask:0xf
    v_add_f32_dpp v105, v105, v105 row_ror:8 row_mask:0xf bank_mask:0xf
    v_add_f32_dpp v106, v106, v106 row_ror:8 row_mask:0xf bank_mask:0xf
    v_add_f32_dpp v107, v107, v107 row_ror:8 row_mask:0xf bank_mask:0xf
    v_add_f32_dpp v104, v104, v104 row_ror:4 row_mask:0xf bank_mask:0xf
    v_add_f32_dpp v105, v105, v105 row_ror:4 row_mask:0xf bank_mask:0xf
    v_add_f32_dpp v106, v106, v106 row_ror:4 row_mask:0xf bank_mask:0xf
    v_add_f32_dpp v107, v107, v107 row_ror:4 row_mask:0xf bank_mask:0xf
    ds_write_b128 v94, v[104:107] offset:384
    v_mul_f32 v108, v68, v52
    v_mul_f32 v109, v69, v52
    v_mul_f32 v110, v70, v52
    v_mul_f32 v111, v71, v52
    v_fmac_f32 v108, v72, v54
    v_fmac_f32 v109, v73, v54
    v_fmac_f32 v110, v74, v54
    v_fmac_f32 v111, v75, v54
    v_add_f32_dpp v108, v108, v108 row_ror:8 row_mask:0xf bank_mask:0xf
    v_add_f32_dpp v109, v109, v109 row_ror:8 row_mask:0xf bank_mask:0xf
    v_add_f32_dpp v110, v110, v110 row_ror:8 row_mask:0xf bank_mask:0xf
    v_add_f32_dpp v111, v111, v111 row_ror:8 row_mask:0xf bank_mask:0xf
    v_add_f32_dpp v108, v108, v108 row_ror:4 row_mask:0xf bank_mask:0xf
    v_add_f32_dpp v109, v109, v109 row_ror:4 row_mask:0xf bank_mask:0xf
    v_add_f32_dpp v110, v110, v110 row_ror:4 row_mask:0xf bank_mask:0xf
    v_add_f32_dpp v111, v111, v111 row_ror:4 row_mask:0xf bank_mask:0xf
    ds_write_b128 v94, v[108:111] offset:448
    s_waitcnt lgkmcnt(0)
    s_barrier
    ds_read_b128 v[136:139], v102 offset:0
    ds_read_b128 v[140:143], v102 offset:8192
    ds_read_b128 v[144:147], v102 offset:16384
    ds_read_b128 v[148:151], v102 offset:24576
    s_waitcnt lgkmcnt(0)
    v_add_f32 v136, v136, v140
    v_add_f32 v144, v144, v148
    v_add_f32 v137, v137, v141
    v_add_f32 v145, v145, v149
    v_add_f32 v138, v138, v142
    v_add_f32 v146, v146, v150
    v_add_f32 v139, v139, v143
    v_add_f32 v147, v147, v151
    v_add_f32 v136, v136, v144
    v_add_f32 v137, v137, v145
    v_add_f32 v138, v138, v146
    v_add_f32 v139, v139, v147
    s_mov_b32 s38, 0xffff0000
    v_cvt_pk_bf16_f32 v136, v136, v136
    v_cvt_pk_bf16_f32 v137, v137, v137
    v_cvt_pk_bf16_f32 v138, v138, v138
    v_cvt_pk_bf16_f32 v139, v139, v139
    v_and_or_b32 v136, v136, s38, v8
    v_and_or_b32 v137, v137, s38, v8
    v_and_or_b32 v138, v138, s38, v8
    v_and_or_b32 v139, v139, s38, v8
    s_mov_b32 exec_lo, 0xffffffff
    s_mov_b32 exec_hi, 0x0
    buffer_store_dwordx4 v[136:139], v34, s[48:51], s46 offen sc1
    s_mov_b64 exec, -1
    v_xor_b32 v224, s35, v136
    v_xor_b32 v225, s35, v137
    v_xor_b32 v226, s35, v138
    v_xor_b32 v227, s35, v139
    v_lshlrev_b32 v4, 11, v2
    v_bfe_u32 v5, v1, 2, 2
    v_lshl_add_u32 v4, v5, 8, v4
    v_bfe_u32 v5, v1, 2, 2
    v_lshl_add_u32 v4, v5, 6, v4
    v_bfe_u32 v5, v1, 4, 1
    v_lshl_add_u32 v4, v5, 5, v4
    v_bfe_u32 v5, v1, 1, 1
    v_lshl_add_u32 v4, v5, 4, v4
    v_bfe_u32 v5, v1, 0, 1
    v_lshl_add_u32 v4, v5, 3, v4
    s_lshl_b32 s38, s34, 6
    s_add_u32 s38, s38, 98304
    v_xor_b32 v24, s38, v4
    v_xor_b32 v25, 16, v24
    v_xor_b32 v26, 32, v24
    v_xor_b32 v27, 48, v24
    v_and_b32 v4, 3, v3
    v_lshrrev_b32 v5, 2, v3
    v_lshlrev_b32 v6, 4, v2
    v_add_u32 v6, 135168, v6
    s_movk_i32 s36, 320
    v_cmp_eq_u32 vcc, 0, v5
    s_nop 1
    v_cndmask_b32 v28, 4, v4, vcc
    v_mad_u32_u24 v28, v28, s36, v6
    v_cmp_eq_u32 vcc, 1, v5
    s_nop 1
    v_cndmask_b32 v29, 4, v4, vcc
    v_mad_u32_u24 v29, v29, s36, v6
    v_lshlrev_b32 v5, 2, v1
    v_add_u32 v5, 136448, v5
    v_mov_b32 v6, 0
    ds_write_b32 v5, v6
    s_branch L_ctxok
.section .rodata,"a"
.p2align 6
.amdhsa_kernel concat_heads__compressed_kv_cla__mha_block_cached__decode_kernel
  .amdhsa_next_free_vgpr 512
  .amdhsa_next_free_sgpr 102
  .amdhsa_accum_offset 256
  .amdhsa_group_segment_fixed_size 0
  .amdhsa_kernarg_size 112
  .amdhsa_user_sgpr_count 2
  .amdhsa_user_sgpr_kernarg_segment_ptr 1
  .amdhsa_system_sgpr_workgroup_id_x 1
.end_amdhsa_kernel
```

```asm
; @launch grid=(256,1,1) block=(256,1,1) lds=163840
    .amdgcn_target "amdgcn-amd-amdhsa--gfx950"
    .text
    .globl concat_heads__compressed_kv_cla__mha_block_cached__decode_kernel
    .p2align 8
    .type concat_heads__compressed_kv_cla__mha_block_cached__decode_kernel,@function
concat_heads__compressed_kv_cla__mha_block_cached__decode_kernel:
    s_cmp_ge_u32 s2, 256
    s_cbranch_scc1 L_end
    s_load_dwordx16 s[4:19], s[0:1], 0
    s_load_dwordx8 s[20:27], s[0:1], 64
    s_load_dwordx4 s[28:31], s[0:1], 96
    v_lshrrev_b32 v4, 6, v0
    v_and_b32 v1, 63, v0
    v_readfirstlane_b32 s34, v4
    s_lshr_b32 s32, s2, 3
    s_sub_u32 s33, s2, s32
    s_sub_u32 s33, s33, 1
    s_and_b32 s33, s33, 7
    v_lshrrev_b32 v2, 4, v1
    v_and_b32 v3, 15, v1
    s_cmp_lt_u32 s33, 2
    s_cbranch_scc1 L_qp
    s_cmp_eq_u32 s33, 2
    s_cbranch_scc1 L_ql
    s_cmp_eq_u32 s33, 7
    s_cbranch_scc1 L_aux
    s_bfe_u32 s38, s2, 0x30000
    s_lshl_b32 s38, s38, 21
    s_add_u32 s36, s38, -393216
    s_lshr_b32 s38, s32, 3
    s_lshl_b32 s38, s38, 19
    s_add_u32 s36, s38, s36
    s_lshl_b32 s38, s33, 17
    s_add_u32 s36, s38, s36
    s_lshl_b32 s38, s34, 12
    s_add_u32 s36, s38, s36
    v_bfe_u32 v5, v1, 0, 5
    v_lshlrev_b32 v4, 7, v5
    v_lshrrev_b32 v5, 5, v1
    v_lshl_add_u32 v4, v5, 15, v4
    s_mov_b32 s42, 16777216
    s_mov_b32 s43, 0x20000
    s_waitcnt lgkmcnt(0)
    s_mov_b64 s[40:41], s[6:7]
    buffer_load_dword v20, v4, s[40:43], s36 offen
    s_add_u32 s36, s36, 16384
    buffer_load_dword v21, v4, s[40:43], s36 offen
    s_add_u32 s36, s36, 49152
    buffer_load_dword v22, v4, s[40:43], s36 offen
    s_add_u32 s36, s36, 16384
    buffer_load_dword v23, v4, s[40:43], s36 offen
    s_load_dword s35, s[30:31], 0
    s_mov_b32 s48, s30
    s_and_b32 s49, s31, 0xffff
    s_mov_b32 s50, 8388608
    s_mov_b32 s51, 0x20000
    s_mov_b32 s82, 0xffffff00
    s_mov_b32 s83, 0x3e0293ee
    s_mov_b32 s84, 2097152
    v_lshrrev_b32 v4, 2, v3
    v_and_b32 v5, 3, v3
    v_lshlrev_b32 v76, 8, v4
    v_lshlrev_b32 v126, 8, v2
    v_lshl_add_u32 v76, v2, 6, v76
    v_lshl_add_u32 v76, v5, 4, v76
    v_lshl_add_u32 v126, v3, 4, v126
    v_xor_b32 v77, 32768, v76
    v_xor_b32 v127, 32768, v126
    s_add_u32 s3, s34, s33
    s_and_b32 s3, s3, 3
    s_lshl_b32 s89, s3, 5
    s_add_u32 s89, s89, s32
    s_lshl_b32 s89, s89, 20
    s_mul_i32 s88, s32, 8
    s_add_u32 s88, s88, s3
    s_lshl_b32 s87, s33, 0
    s_mov_b32 s52, s18
    s_and_b32 s53, s19, 0xffff
    s_mov_b32 s54, 134217728
    s_mov_b32 s55, 0x20000
    s_mov_b32 s56, s20
    s_and_b32 s57, s21, 0xffff
    s_mov_b32 s58, 134217728
    s_mov_b32 s59, 0x20000
    v_and_b32 v4, 1, v1
    v_lshlrev_b32 v4, 4, v4
    v_mov_b32 v5, 0xffff
    v_lshlrev_b32 v4, v4, v5
    v_bfe_u32 v5, v1, 1, 2
    v_cmp_eq_u32 vcc, 0, v5
    s_nop 1
    v_cndmask_b32 v10, 0, v4, vcc
    v_cmp_eq_u32 vcc, 1, v5
    s_nop 1
    v_cndmask_b32 v11, 0, v4, vcc
    v_cmp_eq_u32 vcc, 2, v5
    s_nop 1
    v_cndmask_b32 v12, 0, v4, vcc
    v_cmp_eq_u32 vcc, 3, v5
    s_nop 1
    v_cndmask_b32 v13, 0, v4, vcc
    v_mov_b32 v120, 0xff7f0000
    v_mov_b32 v121, 0
    v_mov_b32 v18, 1
    v_mov_b32 v116, 0
    v_mov_b32 v117, 0
    v_mov_b32 v118, 0
    v_mov_b32 v119, 0
    s_lshl_b32 s38, s32, 10
    s_add_u32 s96, s38, 65536
    s_lshl_b32 s38, s3, 8
    s_add_u32 s96, s38, s96
    v_mov_b32 v9, s96
    s_lshl_b32 s38, s32, 15
    s_add_u32 s96, s38, 1048576
    s_lshl_b32 s38, s3, 13
    s_add_u32 s96, s38, s96
    s_lshl_b32 s38, s33, 10
    s_add_u32 s96, s38, s96
    v_and_b32 v5, 3, v3
    v_lshlrev_b32 v78, 7, v2
    v_lshl_add_u32 v78, v5, 5, v78
    s_lshl_b32 s38, s32, 12
    s_add_u32 s91, s38, 262144
    s_lshl_b32 s38, s3, 9
    s_add_u32 s91, s38, s91
    v_lshlrev_b32 v4, 7, v2
    v_lshl_add_u32 v4, v3, 4, v4
    v_mov_b32 v5, 512
    v_cmp_gt_u32 vcc, 8, v3
    s_nop 1
    v_cndmask_b32 v79, v5, v4, vcc
    s_add_u32 s39, s87, s88
    s_bfe_u32 s37, s39, 0x30000
    s_lshl_b32 s37, s37, 12
    s_add_u32 s85, s37, s89
    s_bfe_u32 s37, s39, 0x10003
    s_lshl_b32 s37, s37, 11
    s_add_u32 s85, s37, s85
    s_bfe_u32 s37, s39, 0x40004
    s_lshl_b32 s37, s37, 16
    s_add_u32 s85, s37, s85
    buffer_load_dwordx4 v[128:131], v76, s[52:55], s85 offen offset:0 nt
    buffer_load_dwordx4 v[132:135], v77, s[52:55], s85 offen offset:0 nt
    buffer_load_dwordx4 v[136:139], v76, s[52:55], s85 offen offset:1024 nt
    buffer_load_dwordx4 v[140:143], v77, s[52:55], s85 offen offset:1024 nt
    s_add_u32 s87, s87, 7
    s_add_u32 s39, s87, s88
    s_bfe_u32 s37, s39, 0x30000
    s_lshl_b32 s37, s37, 12
    s_add_u32 s85, s37, s89
    s_bfe_u32 s37, s39, 0x10003
    s_lshl_b32 s37, s37, 11
    s_add_u32 s85, s37, s85
    s_bfe_u32 s37, s39, 0x40004
    s_lshl_b32 s37, s37, 16
    s_add_u32 s85, s37, s85
    buffer_load_dwordx4 v[144:147], v76, s[52:55], s85 offen offset:0 nt
    buffer_load_dwordx4 v[148:151], v77, s[52:55], s85 offen offset:0 nt
    buffer_load_dwordx4 v[152:155], v76, s[52:55], s85 offen offset:1024 nt
    s_waitcnt vmcnt(6)
    buffer_load_dwordx4 v[156:159], v77, s[52:55], s85 offen offset:1024 nt
    s_add_u32 s87, s87, 7
    s_add_u32 s39, s87, s88
    s_bfe_u32 s37, s39, 0x30000
    s_lshl_b32 s37, s37, 12
    s_add_u32 s85, s37, s89
    s_bfe_u32 s37, s39, 0x10003
    s_lshl_b32 s37, s37, 11
    s_add_u32 s85, s37, s85
    s_bfe_u32 s37, s39, 0x40004
    s_lshl_b32 s37, s37, 16
    s_add_u32 s85, s37, s85
    s_waitcnt vmcnt(6)
    buffer_load_dwordx4 v[160:163], v76, s[52:55], s85 offen offset:0 nt
    s_waitcnt vmcnt(6)
    buffer_load_dwordx4 v[164:167], v77, s[52:55], s85 offen offset:0 nt
    s_waitcnt vmcnt(6)
    buffer_load_dwordx4 v[168:171], v76, s[52:55], s85 offen offset:1024 nt
    s_waitcnt vmcnt(6)
    buffer_load_dwordx4 v[172:175], v77, s[52:55], s85 offen offset:1024 nt
    s_add_u32 s87, s87, 7
    s_add_u32 s39, s87, s88
    s_bfe_u32 s37, s39, 0x30000
    s_lshl_b32 s37, s37, 12
    s_add_u32 s85, s37, s89
    s_bfe_u32 s37, s39, 0x10003
    s_lshl_b32 s37, s37, 11
    s_add_u32 s85, s37, s85
    s_bfe_u32 s37, s39, 0x40004
    s_lshl_b32 s37, s37, 16
    s_add_u32 s85, s37, s85
    s_waitcnt vmcnt(6)
    buffer_load_dwordx4 v[176:179], v76, s[52:55], s85 offen offset:0 nt
    s_waitcnt vmcnt(6)
    buffer_load_dwordx4 v[180:183], v77, s[52:55], s85 offen offset:0 nt
    s_waitcnt vmcnt(6)
    buffer_load_dwordx4 v[184:187], v76, s[52:55], s85 offen offset:1024 nt
    s_waitcnt vmcnt(6)
    buffer_load_dwordx4 v[188:191], v77, s[52:55], s85 offen offset:1024 nt
    s_add_u32 s87, s87, 7
    s_add_u32 s39, s87, s88
    s_bfe_u32 s37, s39, 0x30000
    s_lshl_b32 s37, s37, 12
    s_add_u32 s85, s37, s89
    s_bfe_u32 s37, s39, 0x10003
    s_lshl_b32 s37, s37, 11
    s_add_u32 s85, s37, s85
    s_bfe_u32 s37, s39, 0x40004
    s_lshl_b32 s37, s37, 16
    s_add_u32 s85, s37, s85
    s_waitcnt vmcnt(6)
    buffer_load_dwordx4 v[192:195], v76, s[52:55], s85 offen offset:0 nt
    s_waitcnt vmcnt(6)
    buffer_load_dwordx4 v[196:199], v77, s[52:55], s85 offen offset:0 nt
    s_waitcnt vmcnt(6)
    buffer_load_dwordx4 v[200:203], v76, s[52:55], s85 offen offset:1024 nt
    s_waitcnt vmcnt(6)
    buffer_load_dwordx4 v[204:207], v77, s[52:55], s85 offen offset:1024 nt
    s_add_u32 s87, s87, 7
    s_add_u32 s39, s87, s88
    s_bfe_u32 s37, s39, 0x30000
    s_lshl_b32 s37, s37, 12
    s_add_u32 s85, s37, s89
    s_bfe_u32 s37, s39, 0x10003
    s_lshl_b32 s37, s37, 11
    s_add_u32 s85, s37, s85
    s_bfe_u32 s37, s39, 0x40004
    s_lshl_b32 s37, s37, 16
    s_add_u32 s85, s37, s85
    s_waitcnt vmcnt(6)
    buffer_load_dwordx4 v[208:211], v76, s[52:55], s85 offen offset:0 nt
    s_waitcnt vmcnt(6)
    buffer_load_dwordx4 v[212:215], v77, s[52:55], s85 offen offset:0 nt
    s_waitcnt vmcnt(6)
    buffer_load_dwordx4 v[216:219], v76, s[52:55], s85 offen offset:1024 nt
    s_waitcnt vmcnt(6)
    buffer_load_dwordx4 v[220:223], v77, s[52:55], s85 offen offset:1024 nt
    s_add_u32 s87, s87, 7
    s_add_u32 s39, s87, s88
    s_bfe_u32 s37, s39, 0x30000
    s_lshl_b32 s37, s37, 12
    s_add_u32 s85, s37, s89
    s_bfe_u32 s37, s39, 0x10003
    s_lshl_b32 s37, s37, 11
    s_add_u32 s85, s37, s85
    s_bfe_u32 s37, s39, 0x40004
    s_lshl_b32 s37, s37, 16
    s_add_u32 s85, s37, s85
    s_waitcnt vmcnt(6)
    buffer_load_dwordx4 v[224:227], v76, s[52:55], s85 offen offset:0 nt
    s_waitcnt vmcnt(6)
    buffer_load_dwordx4 v[228:231], v77, s[52:55], s85 offen offset:0 nt
    s_waitcnt vmcnt(6)
    buffer_load_dwordx4 v[232:235], v76, s[52:55], s85 offen offset:1024 nt
    s_waitcnt vmcnt(6)
    buffer_load_dwordx4 v[236:239], v77, s[52:55], s85 offen offset:1024 nt
    s_add_u32 s87, s87, 7
    s_add_u32 s39, s87, s88
    s_bfe_u32 s37, s39, 0x30000
    s_lshl_b32 s37, s37, 12
    s_add_u32 s85, s37, s89
    s_bfe_u32 s37, s39, 0x10003
    s_lshl_b32 s37, s37, 11
    s_add_u32 s85, s37, s85
    s_bfe_u32 s37, s39, 0x40004
    s_lshl_b32 s37, s37, 16
    s_add_u32 s85, s37, s85
    s_waitcnt vmcnt(6)
    buffer_load_dwordx4 v[240:243], v76, s[52:55], s85 offen offset:0 nt
    s_waitcnt vmcnt(6)
    buffer_load_dwordx4 v[244:247], v77, s[52:55], s85 offen offset:0 nt
    s_waitcnt vmcnt(6)
    buffer_load_dwordx4 v[248:251], v76, s[52:55], s85 offen offset:1024 nt
    s_waitcnt vmcnt(6)
    buffer_load_dwordx4 v[252:255], v77, s[52:55], s85 offen offset:1024 nt
    s_add_u32 s87, s87, 7
    s_add_u32 s39, s87, s88
    s_bfe_u32 s37, s39, 0x30000
    s_lshl_b32 s37, s37, 12
    s_add_u32 s85, s37, s89
    s_bfe_u32 s37, s39, 0x10003
    s_lshl_b32 s37, s37, 11
    s_add_u32 s85, s37, s85
    s_bfe_u32 s37, s39, 0x40004
    s_lshl_b32 s37, s37, 16
    s_add_u32 s85, s37, s85
    s_waitcnt vmcnt(6)
    buffer_load_dwordx4 a[0:3], v76, s[52:55], s85 offen offset:0 nt
    s_waitcnt vmcnt(6)
    buffer_load_dwordx4 a[4:7], v77, s[52:55], s85 offen offset:0 nt
    buffer_load_dwordx4 v[68:71], v78, s[48:51], s91 offen offset:0 sc1
    buffer_load_dwordx4 v[72:75], v78, s[48:51], s91 offen offset:16 sc1
    s_waitcnt vmcnt(8)
    buffer_load_dwordx4 a[8:11], v76, s[52:55], s85 offen offset:1024 nt
    s_waitcnt vmcnt(8)
    buffer_load_dwordx4 a[12:15], v77, s[52:55], s85 offen offset:1024 nt
    s_add_u32 s87, s87, 7
    s_add_u32 s39, s87, s88
    s_bfe_u32 s37, s39, 0x30000
    s_lshl_b32 s37, s37, 12
    s_add_u32 s85, s37, s89
    s_bfe_u32 s37, s39, 0x10003
    s_lshl_b32 s37, s37, 11
    s_add_u32 s85, s37, s85
    s_bfe_u32 s37, s39, 0x40004
    s_lshl_b32 s37, s37, 16
    s_add_u32 s85, s37, s85
    s_waitcnt vmcnt(8)
    buffer_load_dwordx4 a[16:19], v76, s[52:55], s85 offen offset:0 nt
    s_waitcnt vmcnt(8)
    buffer_load_dwordx4 a[20:23], v77, s[52:55], s85 offen offset:0 nt
    s_waitcnt vmcnt(8)
    buffer_load_dwordx4 a[24:27], v76, s[52:55], s85 offen offset:1024 nt
    s_waitcnt vmcnt(8)
    buffer_load_dwordx4 a[28:31], v77, s[52:55], s85 offen offset:1024 nt
    s_add_u32 s87, s87, 7
    s_add_u32 s39, s87, s88
    s_bfe_u32 s37, s39, 0x30000
    s_lshl_b32 s37, s37, 12
    s_add_u32 s85, s37, s89
    s_bfe_u32 s37, s39, 0x10003
    s_lshl_b32 s37, s37, 11
    s_add_u32 s85, s37, s85
    s_bfe_u32 s37, s39, 0x40004
    s_lshl_b32 s37, s37, 16
    s_add_u32 s85, s37, s85
    s_waitcnt lgkmcnt(0)
    s_add_u32 s35, s35, 0x5b
    s_and_b32 s35, s35, 0xff
    v_mov_b32 v8, s35
    s_waitcnt vmcnt(6)
L_qcheck_1:
    v_xor_b32 v68, s35, v68
    v_xor_b32 v69, s35, v69
    v_xor_b32 v70, s35, v70
    v_xor_b32 v71, s35, v71
    v_xor_b32 v72, s35, v72
    v_xor_b32 v73, s35, v73
    v_xor_b32 v74, s35, v74
    v_xor_b32 v75, s35, v75
    v_or_b32 v4, v68, v69
    v_or3_b32 v4, v4, v70, v71
    v_or3_b32 v4, v4, v72, v73
    v_or3_b32 v4, v4, v74, v75
    v_and_b32 v4, 0xff, v4
    v_cmp_ne_u32 vcc, 0, v4
    s_cbranch_vccz L_qok_2
    buffer_load_dwordx4 v[68:71], v78, s[48:51], s91 offen offset:0 sc1
    buffer_load_dwordx4 v[72:75], v78, s[48:51], s91 offen offset:16 sc1
    s_waitcnt vmcnt(0)
    s_sub_u32 s84, s84, 1
    s_cmp_lg_u32 s84, 0
    s_cbranch_scc1 L_qcheck_1
    s_branch L_end
L_qok_2:
    v_cvt_pk_bf16_f32 v68, v68, v69
    v_cvt_pk_bf16_f32 v69, v70, v71
    v_cvt_pk_bf16_f32 v70, v72, v73
    v_cvt_pk_bf16_f32 v71, v74, v75
    s_mov_b32 vcc_lo, 0xf000f
    s_mov_b32 vcc_hi, 0xf000f
    v_cndmask_b32 v80, 0, v68, vcc
    v_cndmask_b32 v81, 0, v69, vcc
    v_cndmask_b32 v82, 0, v70, vcc
    v_cndmask_b32 v83, 0, v71, vcc
    s_mov_b32 vcc_lo, 0xf000f0
    s_mov_b32 vcc_hi, 0xf000f0
    v_cndmask_b32 v84, 0, v68, vcc
    v_cndmask_b32 v85, 0, v69, vcc
    v_cndmask_b32 v86, 0, v70, vcc
    v_cndmask_b32 v87, 0, v71, vcc
    s_mov_b32 vcc_lo, 0xf000f00
    s_mov_b32 vcc_hi, 0xf000f00
    v_cndmask_b32 v88, 0, v68, vcc
    v_cndmask_b32 v89, 0, v69, vcc
    v_cndmask_b32 v90, 0, v70, vcc
    v_cndmask_b32 v91, 0, v71, vcc
    s_mov_b32 vcc_lo, 0xf000f000
    s_mov_b32 vcc_hi, 0xf000f000
    v_cndmask_b32 v92, 0, v68, vcc
    v_cndmask_b32 v93, 0, v69, vcc
    v_cndmask_b32 v94, 0, v70, vcc
    v_cndmask_b32 v95, 0, v71, vcc
    v_mov_b32 v65, 0xff7f0000
    s_lshl_b32 s38, s34, 14
    s_add_u32 s38, s38, 16384
    v_lshl_add_u32 v64, v1, 2, s38
    buffer_load_dwordx4 a[32:35], v76, s[52:55], s85 offen offset:0 nt
    v_mfma_f32_16x16x32_bf16 v[112:115], v[128:131], v[80:83], 0
    v_mfma_f32_16x16x32_bf16 v[112:115], v[132:135], v[84:87], v[112:115]
    v_mfma_f32_16x16x32_bf16 v[112:115], v[136:139], v[88:91], v[112:115]
    s_waitcnt vmcnt(6)
    buffer_load_dwordx4 a[36:39], v77, s[52:55], s85 offen offset:0 nt
    v_mfma_f32_16x16x32_bf16 v[112:115], v[140:143], v[92:95], v[112:115]
    v_mfma_f32_16x16x32_bf16 v[96:99], v[144:147], v[80:83], 0
    v_mfma_f32_16x16x32_bf16 v[96:99], v[148:151], v[84:87], v[96:99]
    s_waitcnt vmcnt(6)
    buffer_load_dwordx4 a[40:43], v76, s[52:55], s85 offen offset:1024 nt
    v_mfma_f32_16x16x32_bf16 v[96:99], v[152:155], v[88:91], v[96:99]
    s_nop 2
    v_mov_b32_dpp v122, v112 quad_perm:[0,0,0,0] row_mask:0xf bank_mask:0xf
    v_mov_b32_dpp v124, v114 quad_perm:[2,2,2,2] row_mask:0xf bank_mask:0xf
    s_nop 0
    v_add_f32_dpp v122, v113, v122 quad_perm:[1,1,1,1] row_mask:0xf bank_mask:0xf
    v_add_f32_dpp v124, v115, v124 quad_perm:[3,3,3,3] row_mask:0xf bank_mask:0xf
    v_add_f32 v122, v122, v124
    v_max_f32 v65, v65, v122
    ds_write_b32 v64, v122 offset:0
    v_mfma_f32_16x16x32_bf16 v[96:99], v[156:159], v[92:95], v[96:99]
    v_mfma_f32_16x16x32_bf16 v[112:115], v[160:163], v[80:83], 0
    v_mfma_f32_16x16x32_bf16 v[112:115], v[164:167], v[84:87], v[112:115]
    s_waitcnt vmcnt(6)
    buffer_load_dwordx4 a[44:47], v77, s[52:55], s85 offen offset:1024 nt
    s_add_u32 s87, s87, 7
    s_add_u32 s39, s87, s88
    s_bfe_u32 s37, s39, 0x30000
    s_lshl_b32 s37, s37, 12
    s_add_u32 s85, s37, s89
    s_bfe_u32 s37, s39, 0x10003
    s_lshl_b32 s37, s37, 11
    s_add_u32 s85, s37, s85
    s_bfe_u32 s37, s39, 0x40004
    s_lshl_b32 s37, s37, 16
    s_add_u32 s85, s37, s85
    v_mfma_f32_16x16x32_bf16 v[112:115], v[168:171], v[88:91], v[112:115]
    v_mov_b32_dpp v122, v96 quad_perm:[0,0,0,0] row_mask:0xf bank_mask:0xf
    v_mov_b32_dpp v124, v98 quad_perm:[2,2,2,2] row_mask:0xf bank_mask:0xf
    s_nop 0
    v_add_f32_dpp v122, v97, v122 quad_perm:[1,1,1,1] row_mask:0xf bank_mask:0xf
    v_add_f32_dpp v124, v99, v124 quad_perm:[3,3,3,3] row_mask:0xf bank_mask:0xf
    v_add_f32 v122, v122, v124
    v_max_f32 v65, v65, v122
    ds_write_b32 v64, v122 offset:256
    v_mfma_f32_16x16x32_bf16 v[112:115], v[172:175], v[92:95], v[112:115]
    v_mfma_f32_16x16x32_bf16 v[96:99], v[176:179], v[80:83], 0
    s_waitcnt vmcnt(6)
    buffer_load_dwordx4 a[48:51], v76, s[52:55], s85 offen offset:0 nt
    v_mfma_f32_16x16x32_bf16 v[96:99], v[180:183], v[84:87], v[96:99]
    v_mfma_f32_16x16x32_bf16 v[96:99], v[184:187], v[88:91], v[96:99]
    s_nop 2
    v_mov_b32_dpp v122, v112 quad_perm:[0,0,0,0] row_mask:0xf bank_mask:0xf
    v_mov_b32_dpp v124, v114 quad_perm:[2,2,2,2] row_mask:0xf bank_mask:0xf
    s_nop 0
    v_add_f32_dpp v122, v113, v122 quad_perm:[1,1,1,1] row_mask:0xf bank_mask:0xf
    v_add_f32_dpp v124, v115, v124 quad_perm:[3,3,3,3] row_mask:0xf bank_mask:0xf
    v_add_f32 v122, v122, v124
    v_max_f32 v65, v65, v122
    ds_write_b32 v64, v122 offset:512
    v_mfma_f32_16x16x32_bf16 v[96:99], v[188:191], v[92:95], v[96:99]
    v_mfma_f32_16x16x32_bf16 v[112:115], v[192:195], v[80:83], 0
    s_waitcnt vmcnt(6)
    buffer_load_dwordx4 a[52:55], v77, s[52:55], s85 offen offset:0 nt
    v_mfma_f32_16x16x32_bf16 v[112:115], v[196:199], v[84:87], v[112:115]
    v_mfma_f32_16x16x32_bf16 v[112:115], v[200:203], v[88:91], v[112:115]
    s_nop 2
    v_mov_b32_dpp v122, v96 quad_perm:[0,0,0,0] row_mask:0xf bank_mask:0xf
    v_mov_b32_dpp v124, v98 quad_perm:[2,2,2,2] row_mask:0xf bank_mask:0xf
    s_nop 0
    v_add_f32_dpp v122, v97, v122 quad_perm:[1,1,1,1] row_mask:0xf bank_mask:0xf
    v_add_f32_dpp v124, v99, v124 quad_perm:[3,3,3,3] row_mask:0xf bank_mask:0xf
    v_add_f32 v122, v122, v124
    v_max_f32 v65, v65, v122
    ds_write_b32 v64, v122 offset:768
    v_mfma_f32_16x16x32_bf16 v[112:115], v[204:207], v[92:95], v[112:115]
    s_waitcnt vmcnt(6)
    buffer_load_dwordx4 a[56:59], v76, s[52:55], s85 offen offset:1024 nt
    v_mfma_f32_16x16x32_bf16 v[96:99], v[208:211], v[80:83], 0
    v_mfma_f32_16x16x32_bf16 v[96:99], v[212:215], v[84:87], v[96:99]
    v_mfma_f32_16x16x32_bf16 v[96:99], v[216:219], v[88:91], v[96:99]
    s_nop 2
    v_mov_b32_dpp v122, v112 quad_perm:[0,0,0,0] row_mask:0xf bank_mask:0xf
    v_mov_b32_dpp v124, v114 quad_perm:[2,2,2,2] row_mask:0xf bank_mask:0xf
    s_nop 0
    v_add_f32_dpp v122, v113, v122 quad_perm:[1,1,1,1] row_mask:0xf bank_mask:0xf
    v_add_f32_dpp v124, v115, v124 quad_perm:[3,3,3,3] row_mask:0xf bank_mask:0xf
    v_add_f32 v122, v122, v124
    v_max_f32 v65, v65, v122
    ds_write_b32 v64, v122 offset:1024
    v_mfma_f32_16x16x32_bf16 v[96:99], v[220:223], v[92:95], v[96:99]
    s_waitcnt vmcnt(6)
    buffer_load_dwordx4 a[60:63], v77, s[52:55], s85 offen offset:1024 nt
    s_add_u32 s87, s87, 7
    s_add_u32 s39, s87, s88
    s_bfe_u32 s37, s39, 0x30000
    s_lshl_b32 s37, s37, 12
    s_add_u32 s85, s37, s89
    s_bfe_u32 s37, s39, 0x10003
    s_lshl_b32 s37, s37, 11
    s_add_u32 s85, s37, s85
    s_bfe_u32 s37, s39, 0x40004
    s_lshl_b32 s37, s37, 16
    s_add_u32 s85, s37, s85
    v_mfma_f32_16x16x32_bf16 v[112:115], v[224:227], v[80:83], 0
    s_sub_u32 s36, s33, 3
    s_and_b32 s37, s33, 3
    s_cmp_lt_u32 s36, 4
    s_cselect_b64 s[40:41], s[24:25], s[14:15]
    s_cselect_b32 s36, s36, s37
    s_cselect_b32 s45, 262144, 0
    s_cselect_b32 s46, 8388608, 0
    s_add_u32 s45, s45, 524288
    s_add_u32 s46, s46, 196608
    s_mov_b32 s42, 4194304
    s_mov_b32 s43, 0x20000
    s_lshl_b32 s38, s32, 17
    s_add_u32 s44, s38, 0
    s_lshl_b32 s38, s34, 15
    s_add_u32 s44, s38, s44
    s_lshl_b32 s38, s36, 8
    s_add_u32 s44, s38, s44
    s_lshl_b32 s38, s36, 16
    s_add_u32 s45, s38, s45
    s_lshr_b32 s38, s34, 1
    s_lshl_b32 s38, s38, 15
    s_add_u32 s45, s38, s45
    s_lshl_b32 s38, s32, 8
    s_add_u32 s45, s38, s45
    s_bfe_u32 s38, s34, 0x10000
    s_lshl_b32 s38, s38, 7
    s_add_u32 s45, s38, s45
    s_lshl_b32 s38, s32, 11
    s_add_u32 s46, s38, s46
    s_lshl_b32 s38, s34, 9
    s_add_u32 s46, s38, s46
    s_mov_b32 s72, s26
    s_and_b32 s73, s27, 0xffff
    s_mov_b32 s74, 8192
    s_mov_b32 s75, 0x20000
    v_mfma_f32_16x16x32_bf16 v[112:115], v[228:231], v[84:87], v[112:115]
    v_mfma_f32_16x16x32_bf16 v[112:115], v[232:235], v[88:91], v[112:115]
    v_mov_b32_dpp v122, v96 quad_perm:[0,0,0,0] row_mask:0xf bank_mask:0xf
    v_mov_b32_dpp v124, v98 quad_perm:[2,2,2,2] row_mask:0xf bank_mask:0xf
    s_nop 0
    v_add_f32_dpp v122, v97, v122 quad_perm:[1,1,1,1] row_mask:0xf bank_mask:0xf
    v_add_f32_dpp v124, v99, v124 quad_perm:[3,3,3,3] row_mask:0xf bank_mask:0xf
    v_add_f32 v122, v122, v124
    v_max_f32 v65, v65, v122
    ds_write_b32 v64, v122 offset:1280
    s_waitcnt vmcnt(5)
    buffer_load_dwordx4 v[128:131], v76, s[52:55], s85 offen offset:0 nt
    v_mfma_f32_16x16x32_bf16 v[112:115], v[236:239], v[92:95], v[112:115]
    v_mfma_f32_16x16x32_bf16 v[96:99], v[240:243], v[80:83], 0
    v_mfma_f32_16x16x32_bf16 v[96:99], v[244:247], v[84:87], v[96:99]
    s_waitcnt vmcnt(5)
    buffer_load_dwordx4 v[132:135], v77, s[52:55], s85 offen offset:0 nt
    v_mfma_f32_16x16x32_bf16 v[96:99], v[248:251], v[88:91], v[96:99]
    s_nop 2
    v_mov_b32_dpp v122, v112 quad_perm:[0,0,0,0] row_mask:0xf bank_mask:0xf
    v_mov_b32_dpp v124, v114 quad_perm:[2,2,2,2] row_mask:0xf bank_mask:0xf
    s_nop 0
    v_add_f32_dpp v122, v113, v122 quad_perm:[1,1,1,1] row_mask:0xf bank_mask:0xf
    v_add_f32_dpp v124, v115, v124 quad_perm:[3,3,3,3] row_mask:0xf bank_mask:0xf
    v_add_f32 v122, v122, v124
    v_max_f32 v65, v65, v122
    ds_write_b32 v64, v122 offset:1536
    v_lshlrev_b32 v4, 2, v2
    v_xor_b32 v4, v4, v3
    v_xor_b32 v5, 0, v4
    v_lshlrev_b32 v5, 4, v5
    v_lshl_add_u32 v20, v2, 10, v5
    v_xor_b32 v5, 1, v4
    v_lshlrev_b32 v5, 4, v5
    v_lshl_add_u32 v21, v2, 10, v5
    v_add_u32 v21, 3072, v21
    v_xor_b32 v5, 2, v4
    v_lshlrev_b32 v5, 4, v5
    v_lshl_add_u32 v22, v2, 10, v5
    v_add_u32 v22, 6144, v22
    v_xor_b32 v5, 3, v4
    v_lshlrev_b32 v5, 4, v5
    v_lshl_add_u32 v23, v2, 10, v5
    v_add_u32 v23, 9216, v23
    s_lshl_b32 s38, s32, 15
    s_add_u32 s47, s38, 1048576
    s_lshl_b32 s38, s3, 13
    s_add_u32 s47, s38, s47
    s_mul_i32 s38, s3, 320
    s_add_u32 s38, s38, 135168
    v_lshlrev_b32 v4, 6, v2
    v_lshl_add_u32 v4, v3, 1, v4
    v_add_u32 v31, s38, v4
    v_mfma_f32_16x16x32_bf16 v[96:99], v[252:255], v[92:95], v[96:99]
    v_mfma_f32_16x16x32_bf16 v[112:115], a[0:3], v[80:83], 0
    v_mfma_f32_16x16x32_bf16 v[112:115], a[4:7], v[84:87], v[112:115]
    s_waitcnt vmcnt(5)
    buffer_load_dwordx4 v[136:139], v76, s[52:55], s85 offen offset:1024 nt
    v_mfma_f32_16x16x32_bf16 v[112:115], a[8:11], v[88:91], v[112:115]
    s_nop 2
    v_mov_b32_dpp v122, v96 quad_perm:[0,0,0,0] row_mask:0xf bank_mask:0xf
    v_mov_b32_dpp v124, v98 quad_perm:[2,2,2,2] row_mask:0xf bank_mask:0xf
    s_nop 0
    v_add_f32_dpp v122, v97, v122 quad_perm:[1,1,1,1] row_mask:0xf bank_mask:0xf
    v_add_f32_dpp v124, v99, v124 quad_perm:[3,3,3,3] row_mask:0xf bank_mask:0xf
    v_add_f32 v122, v122, v124
    v_max_f32 v65, v65, v122
    ds_write_b32 v64, v122 offset:1792
    v_mfma_f32_16x16x32_bf16 v[112:115], a[12:15], v[92:95], v[112:115]
    v_mfma_f32_16x16x32_bf16 v[96:99], a[16:19], v[80:83], 0
    v_lshlrev_b32 v4, 11, v2
    v_bfe_u32 v5, v1, 2, 2
    v_lshl_add_u32 v4, v5, 8, v4
    v_bfe_u32 v5, v1, 2, 2
    v_lshl_add_u32 v4, v5, 6, v4
    v_bfe_u32 v5, v1, 4, 1
    v_lshl_add_u32 v4, v5, 5, v4
    v_bfe_u32 v5, v1, 1, 1
    v_lshl_add_u32 v4, v5, 4, v4
    v_bfe_u32 v5, v1, 0, 1
    v_lshl_add_u32 v4, v5, 3, v4
    s_lshl_b32 s38, s34, 6
    s_add_u32 s38, s38, 98304
    v_xor_b32 v24, s38, v4
    v_xor_b32 v25, 16, v24
    v_xor_b32 v26, 32, v24
    v_xor_b32 v27, 48, v24
    v_and_b32 v4, 3, v3
    v_lshrrev_b32 v5, 2, v3
    v_lshlrev_b32 v6, 4, v2
    v_add_u32 v6, 135168, v6
    s_movk_i32 s36, 320
    v_cmp_eq_u32 vcc, 0, v5
    s_nop 1
    v_cndmask_b32 v28, 4, v4, vcc
    v_mad_u32_u24 v28, v28, s36, v6
    v_cmp_eq_u32 vcc, 1, v5
    s_nop 1
    v_cndmask_b32 v29, 4, v4, vcc
    v_mad_u32_u24 v29, v29, s36, v6
    v_lshlrev_b32 v5, 2, v1
    v_add_u32 v5, 136448, v5
    v_mov_b32 v6, 0
    ds_write_b32 v5, v6
    s_waitcnt vmcnt(5)
    buffer_load_dwordx4 v[140:143], v77, s[52:55], s85 offen offset:1024 nt
    s_add_u32 s87, s87, 7
    s_add_u32 s39, s87, s88
    s_bfe_u32 s37, s39, 0x30000
    s_lshl_b32 s37, s37, 12
    s_add_u32 s85, s37, s89
    s_bfe_u32 s37, s39, 0x10003
    s_lshl_b32 s37, s37, 11
    s_add_u32 s85, s37, s85
    s_bfe_u32 s37, s39, 0x40004
    s_lshl_b32 s37, s37, 16
    s_add_u32 s85, s37, s85
    v_mfma_f32_16x16x32_bf16 v[96:99], a[20:23], v[84:87], v[96:99]
    v_mfma_f32_16x16x32_bf16 v[96:99], a[24:27], v[88:91], v[96:99]
    v_mov_b32_dpp v122, v112 quad_perm:[0,0,0,0] row_mask:0xf bank_mask:0xf
    v_mov_b32_dpp v124, v114 quad_perm:[2,2,2,2] row_mask:0xf bank_mask:0xf
    s_nop 0
    v_add_f32_dpp v122, v113, v122 quad_perm:[1,1,1,1] row_mask:0xf bank_mask:0xf
    v_add_f32_dpp v124, v115, v124 quad_perm:[3,3,3,3] row_mask:0xf bank_mask:0xf
    v_add_f32 v122, v122, v124
    v_max_f32 v65, v65, v122
    ds_write_b32 v64, v122 offset:2048
    v_mfma_f32_16x16x32_bf16 v[96:99], a[28:31], v[92:95], v[96:99]
    v_mfma_f32_16x16x32_bf16 v[112:115], a[32:35], v[80:83], 0
    s_waitcnt vmcnt(5)
    buffer_load_dwordx4 v[144:147], v76, s[52:55], s85 offen offset:0 nt
    v_mfma_f32_16x16x32_bf16 v[112:115], a[36:39], v[84:87], v[112:115]
    v_mfma_f32_16x16x32_bf16 v[112:115], a[40:43], v[88:91], v[112:115]
    s_nop 2
    v_mov_b32_dpp v122, v96 quad_perm:[0,0,0,0] row_mask:0xf bank_mask:0xf
    v_mov_b32_dpp v124, v98 quad_perm:[2,2,2,2] row_mask:0xf bank_mask:0xf
    s_nop 0
    v_add_f32_dpp v122, v97, v122 quad_perm:[1,1,1,1] row_mask:0xf bank_mask:0xf
    v_add_f32_dpp v124, v99, v124 quad_perm:[3,3,3,3] row_mask:0xf bank_mask:0xf
    v_add_f32 v122, v122, v124
    v_max_f32 v65, v65, v122
    ds_write_b32 v64, v122 offset:2304
    v_lshlrev_b32 v30, 4, v3
    v_lshl_add_u32 v30, v2, 13, v30
    s_lshl_b32 s38, s32, 13
    s_add_u32 s36, s38, 0
    s_lshl_b32 s38, s34, 6
    s_add_u32 s36, s38, s36
    v_lshrrev_b32 v5, 2, v1
    v_lshlrev_b32 v32, 8, v5
    v_bfe_u32 v5, v1, 0, 2
    v_lshl_add_u32 v32, v5, 4, v32
    v_add_u32 v32, s36, v32
    s_lshr_b32 s38, s32, 2
    s_lshl_b32 s38, s38, 7
    s_add_u32 s36, s38, 0
    s_lshl_b32 s38, s34, 5
    s_add_u32 s36, s38, s36
    s_bfe_u32 s38, s32, 0x20000
    s_lshl_b32 s38, s38, 3
    s_add_u32 s36, s38, s36
    v_bfe_u32 v5, v1, 0, 2
    v_lshlrev_b32 v33, 11, v5
    v_lshl_add_u32 v33, v2, 1, v33
    v_add_u32 v33, s36, v33
    v_and_b32 v5, 31, v1
    v_lshlrev_b32 v34, 4, v5
    s_mul_i32 s38, s34, 320
    s_add_u32 s38, s38, 135168
    v_lshl_add_u32 v35, v5, 3, s38
    v_mfma_f32_16x16x32_bf16 v[112:115], a[44:47], v[92:95], v[112:115]
    s_waitcnt vmcnt(5)
    buffer_load_dwordx4 v[148:151], v77, s[52:55], s85 offen offset:0 nt
    v_mfma_f32_16x16x32_bf16 v[96:99], a[48:51], v[80:83], 0
    v_mfma_f32_16x16x32_bf16 v[96:99], a[52:55], v[84:87], v[96:99]
    v_mfma_f32_16x16x32_bf16 v[96:99], a[56:59], v[88:91], v[96:99]
    s_nop 2
    v_mov_b32_dpp v122, v112 quad_perm:[0,0,0,0] row_mask:0xf bank_mask:0xf
    v_mov_b32_dpp v124, v114 quad_perm:[2,2,2,2] row_mask:0xf bank_mask:0xf
    s_nop 0
    v_add_f32_dpp v122, v113, v122 quad_perm:[1,1,1,1] row_mask:0xf bank_mask:0xf
    v_add_f32_dpp v124, v115, v124 quad_perm:[3,3,3,3] row_mask:0xf bank_mask:0xf
    v_add_f32 v122, v122, v124
    v_max_f32 v65, v65, v122
    ds_write_b32 v64, v122 offset:2560
    v_mfma_f32_16x16x32_bf16 v[96:99], a[60:63], v[92:95], v[96:99]
    v_add_u32 v64, 2816, v64
    s_mov_b32 s97, 10
    s_mov_b32 s86, 32
    s_and_b32 s36, s32, 3
    s_sub_u32 s80, s36, 2
    s_cmp_ge_u32 s36, 2
    s_cselect_b32 s80, s80, 8
    s_cselect_b32 s81, 27, 25
    s_cmp_eq_u32 s80, s33
    s_cselect_b32 s36, 2, 0
    s_sub_u32 s86, s86, s36
    s_lshr_b32 s36, s36, 1
    s_sub_u32 s97, s97, s36
    s_add_u32 s80, s80, 35
    s_sub_u32 s92, s81, 1
    s_mov_b32 s66, 134217728
    s_mov_b32 s67, 0x20000
    s_mov_b64 s[64:65], s[52:53]
    v_mov_b32 v62, v76
    v_mov_b32 v63, v77
L_bloop:
    s_waitcnt vmcnt(5)
    buffer_load_dwordx4 v[152:155], v62, s[64:67], s85 offen offset:1024 nt
    v_mfma_f32_16x16x32_bf16 v[112:115], v[128:131], v[80:83], 0
    s_waitcnt vmcnt(5)
    buffer_load_dwordx4 v[156:159], v63, s[64:67], s85 offen offset:1024 nt
    v_mfma_f32_16x16x32_bf16 v[112:115], v[132:135], v[84:87], v[112:115]
    s_add_u32 s87, s87, 7
    s_cmp_lg_u32 s97, 1
    s_cbranch_scc1 L_stayk_3
    s_mov_b64 s[64:65], s[56:57]
    v_mov_b32 v62, v126
    v_mov_b32 v63, v127
    s_mul_i32 s37, s86, 7
    s_sub_u32 s87, s87, s37
L_stayk_3:
    s_add_u32 s39, s87, s88
    s_bfe_u32 s37, s39, 0x30000
    s_lshl_b32 s37, s37, 12
    s_add_u32 s85, s37, s89
    s_bfe_u32 s37, s39, 0x10003
    s_lshl_b32 s37, s37, 11
    s_add_u32 s85, s37, s85
    s_bfe_u32 s37, s39, 0x40004
    s_lshl_b32 s37, s37, 16
    s_add_u32 s85, s37, s85
    v_mov_b32_dpp v122, v96 quad_perm:[0,0,0,0] row_mask:0xf bank_mask:0xf
    v_mov_b32_dpp v124, v98 quad_perm:[2,2,2,2] row_mask:0xf bank_mask:0xf
    s_nop 0
    v_add_f32_dpp v122, v97, v122 quad_perm:[1,1,1,1] row_mask:0xf bank_mask:0xf
    v_add_f32_dpp v124, v99, v124 quad_perm:[3,3,3,3] row_mask:0xf bank_mask:0xf
    v_add_f32 v122, v122, v124
    v_max_f32 v65, v65, v122
    ds_write_b32 v64, v122 offset:0
    s_waitcnt vmcnt(5)
    buffer_load_dwordx4 v[128:131], v62, s[64:67], s85 offen offset:0 nt
    v_mfma_f32_16x16x32_bf16 v[112:115], v[136:139], v[88:91], v[112:115]
    s_waitcnt vmcnt(5)
    buffer_load_dwordx4 v[132:135], v63, s[64:67], s85 offen offset:0 nt
    v_mfma_f32_16x16x32_bf16 v[112:115], v[140:143], v[92:95], v[112:115]
    s_waitcnt vmcnt(5)
    buffer_load_dwordx4 v[136:139], v62, s[64:67], s85 offen offset:1024 nt
    v_mfma_f32_16x16x32_bf16 v[96:99], v[144:147], v[80:83], 0
    s_waitcnt vmcnt(5)
    buffer_load_dwordx4 v[140:143], v63, s[64:67], s85 offen offset:1024 nt
    v_mfma_f32_16x16x32_bf16 v[96:99], v[148:151], v[84:87], v[96:99]
    s_add_u32 s87, s87, 7
    s_add_u32 s39, s87, s88
    s_bfe_u32 s37, s39, 0x30000
    s_lshl_b32 s37, s37, 12
    s_add_u32 s85, s37, s89
    s_bfe_u32 s37, s39, 0x10003
    s_lshl_b32 s37, s37, 11
    s_add_u32 s85, s37, s85
    s_bfe_u32 s37, s39, 0x40004
    s_lshl_b32 s37, s37, 16
    s_add_u32 s85, s37, s85
    v_mov_b32_dpp v122, v112 quad_perm:[0,0,0,0] row_mask:0xf bank_mask:0xf
    v_mov_b32_dpp v124, v114 quad_perm:[2,2,2,2] row_mask:0xf bank_mask:0xf
    s_nop 0
    v_add_f32_dpp v122, v113, v122 quad_perm:[1,1,1,1] row_mask:0xf bank_mask:0xf
    v_add_f32_dpp v124, v115, v124 quad_perm:[3,3,3,3] row_mask:0xf bank_mask:0xf
    v_add_f32 v122, v122, v124
    v_max_f32 v65, v65, v122
    ds_write_b32 v64, v122 offset:256
    s_waitcnt vmcnt(5)
    buffer_load_dwordx4 v[144:147], v62, s[64:67], s85 offen offset:0 nt
    v_mfma_f32_16x16x32_bf16 v[96:99], v[152:155], v[88:91], v[96:99]
    s_waitcnt vmcnt(5)
    buffer_load_dwordx4 v[148:151], v63, s[64:67], s85 offen offset:0 nt
    v_mfma_f32_16x16x32_bf16 v[96:99], v[156:159], v[92:95], v[96:99]
    v_add_u32 v64, 512, v64
    s_sub_u32 s97, s97, 1
    s_cmp_lg_u32 s97, 0
    s_cbranch_scc1 L_bloop
    s_nop 3
    v_mov_b32_dpp v122, v96 quad_perm:[0,0,0,0] row_mask:0xf bank_mask:0xf
    v_mov_b32_dpp v124, v98 quad_perm:[2,2,2,2] row_mask:0xf bank_mask:0xf
    s_nop 0
    v_add_f32_dpp v122, v97, v122 quad_perm:[1,1,1,1] row_mask:0xf bank_mask:0xf
    v_add_f32_dpp v124, v99, v124 quad_perm:[3,3,3,3] row_mask:0xf bank_mask:0xf
    v_add_f32 v122, v122, v124
    v_max_f32 v65, v65, v122
    ds_write_b32 v64, v122 offset:0
    v_mov_b32 v123, 0xff7f0000
    ds_write_b32 v64, v123 offset:256
    s_lshl_b32 s38, s34, 14
    s_add_u32 s38, s38, 16384
    v_lshl_add_u32 v64, v1, 2, s38
    ds_read_b32 v66, v64
    ds_read_b32 v67, v64 offset:256
    v_mul_f32 v65, s83, v65
    s_nop 1
    v_max_f32_dpp v124, v65, v65 row_ror:4 row_mask:0xf bank_mask:0xf
    s_nop 1
    v_max_f32_dpp v124, v124, v124 row_ror:8 row_mask:0xf bank_mask:0xf
    v_mov_b32 v125, v124
    s_nop 1
    v_permlane16_swap_b32 v124, v125
    v_max_f32 v124, v124, v125
    v_mov_b32 v125, v124
    s_nop 1
    v_permlane32_swap_b32 v124, v125
    v_max_f32 v124, v124, v125
    v_mov_b32 v120, v124
    s_lshr_b32 s97, s86, 1
    s_waitcnt lgkmcnt(1)
    v_fma_f32 v123, v66, s83, -v120
    v_exp_f32 v123, v123
    ds_read_b32 v66, v64 offset:512
    v_cvt_pk_bf16_f32 v100, v123, v123
    v_add_f32 v121, v121, v123
L_vloop:
    s_nop 0
    v_and_b32_dpp v104, v100, v10 row_newbcast:0 row_mask:0xf bank_mask:0xf
    v_and_b32_dpp v105, v100, v11 row_newbcast:0 row_mask:0xf bank_mask:0xf
    v_and_b32_dpp v106, v100, v12 row_newbcast:0 row_mask:0xf bank_mask:0xf
    v_and_b32_dpp v107, v100, v13 row_newbcast:0 row_mask:0xf bank_mask:0xf
    s_waitcnt vmcnt(5)
    buffer_load_dwordx4 v[152:155], v62, s[64:67], s85 offen offset:1024 nt
    v_mfma_f32_16x16x32_bf16 v[116:119], v[128:131], v[104:107], v[116:119]
    v_and_b32_dpp v108, v100, v10 row_newbcast:4 row_mask:0xf bank_mask:0xf
    v_and_b32_dpp v109, v100, v11 row_newbcast:4 row_mask:0xf bank_mask:0xf
    v_and_b32_dpp v110, v100, v12 row_newbcast:4 row_mask:0xf bank_mask:0xf
    v_and_b32_dpp v111, v100, v13 row_newbcast:4 row_mask:0xf bank_mask:0xf
    s_waitcnt vmcnt(5)
    buffer_load_dwordx4 v[156:159], v63, s[64:67], s85 offen offset:1024 nt
    v_mfma_f32_16x16x32_bf16 v[116:119], v[132:135], v[108:111], v[116:119]
    s_add_u32 s87, s87, 7
    s_cmp_lg_u32 s97, 1
    s_cbranch_scc1 L_stayv_4
    s_mov_b64 s[64:65], s[52:53]
    v_mov_b32 v62, v76
    v_mov_b32 v63, v77
    s_mov_b64 exec, 1
    global_atomic_add v19, v9, v18, s[30:31] sc0 sc1
    s_mov_b64 exec, -1
    s_add_u32 s87, s33, 224
L_stayv_4:
    s_add_u32 s39, s87, s88
    s_bfe_u32 s37, s39, 0x30000
    s_lshl_b32 s37, s37, 12
    s_add_u32 s85, s37, s89
    s_bfe_u32 s37, s39, 0x10003
    s_lshl_b32 s37, s37, 11
    s_add_u32 s85, s37, s85
    s_bfe_u32 s37, s39, 0x40004
    s_lshl_b32 s37, s37, 16
    s_add_u32 s85, s37, s85
    s_waitcnt lgkmcnt(1)
    v_fma_f32 v123, v67, s83, -v120
    v_exp_f32 v123, v123
    ds_read_b32 v67, v64 offset:768
    v_cvt_pk_bf16_f32 v101, v123, v123
    v_add_f32 v121, v121, v123
    v_and_b32_dpp v104, v100, v10 row_newbcast:8 row_mask:0xf bank_mask:0xf
    v_and_b32_dpp v105, v100, v11 row_newbcast:8 row_mask:0xf bank_mask:0xf
    v_and_b32_dpp v106, v100, v12 row_newbcast:8 row_mask:0xf bank_mask:0xf
    v_and_b32_dpp v107, v100, v13 row_newbcast:8 row_mask:0xf bank_mask:0xf
    s_waitcnt vmcnt(5)
    buffer_load_dwordx4 v[128:131], v62, s[64:67], s85 offen offset:0 nt
    v_mfma_f32_16x16x32_bf16 v[116:119], v[136:139], v[104:107], v[116:119]
    v_and_b32_dpp v108, v100, v10 row_newbcast:12 row_mask:0xf bank_mask:0xf
    v_and_b32_dpp v109, v100, v11 row_newbcast:12 row_mask:0xf bank_mask:0xf
    v_and_b32_dpp v110, v100, v12 row_newbcast:12 row_mask:0xf bank_mask:0xf
    v_and_b32_dpp v111, v100, v13 row_newbcast:12 row_mask:0xf bank_mask:0xf
    s_waitcnt vmcnt(5)
    buffer_load_dwordx4 v[132:135], v63, s[64:67], s85 offen offset:0 nt
    v_mfma_f32_16x16x32_bf16 v[116:119], v[140:143], v[108:111], v[116:119]
    v_and_b32_dpp v104, v101, v10 row_newbcast:0 row_mask:0xf bank_mask:0xf
    v_and_b32_dpp v105, v101, v11 row_newbcast:0 row_mask:0xf bank_mask:0xf
    v_and_b32_dpp v106, v101, v12 row_newbcast:0 row_mask:0xf bank_mask:0xf
    v_and_b32_dpp v107, v101, v13 row_newbcast:0 row_mask:0xf bank_mask:0xf
    s_waitcnt vmcnt(5)
    buffer_load_dwordx4 v[136:139], v62, s[64:67], s85 offen offset:1024 nt
    v_mfma_f32_16x16x32_bf16 v[116:119], v[144:147], v[104:107], v[116:119]
    v_and_b32_dpp v108, v101, v10 row_newbcast:4 row_mask:0xf bank_mask:0xf
    v_and_b32_dpp v109, v101, v11 row_newbcast:4 row_mask:0xf bank_mask:0xf
    v_and_b32_dpp v110, v101, v12 row_newbcast:4 row_mask:0xf bank_mask:0xf
    v_and_b32_dpp v111, v101, v13 row_newbcast:4 row_mask:0xf bank_mask:0xf
    s_waitcnt vmcnt(5)
    buffer_load_dwordx4 v[140:143], v63, s[64:67], s85 offen offset:1024 nt
    v_mfma_f32_16x16x32_bf16 v[116:119], v[148:151], v[108:111], v[116:119]
    s_add_u32 s87, s87, 7
    s_cmp_lg_u32 s97, 1
    s_cbranch_scc1 L_stayv_5
    s_mov_b64 s[64:65], s[56:57]
    v_mov_b32 v62, v126
    v_mov_b32 v63, v127
    s_add_u32 s87, s33, 224
L_stayv_5:
    s_add_u32 s39, s87, s88
    s_bfe_u32 s37, s39, 0x30000
    s_lshl_b32 s37, s37, 12
    s_add_u32 s85, s37, s89
    s_bfe_u32 s37, s39, 0x10003
    s_lshl_b32 s37, s37, 11
    s_add_u32 s85, s37, s85
    s_bfe_u32 s37, s39, 0x40004
    s_lshl_b32 s37, s37, 16
    s_add_u32 s85, s37, s85
    v_add_u32 v64, 512, v64
    s_waitcnt lgkmcnt(1)
    v_fma_f32 v123, v66, s83, -v120
    v_exp_f32 v123, v123
    ds_read_b32 v66, v64 offset:512
    v_cvt_pk_bf16_f32 v100, v123, v123
    v_add_f32 v121, v121, v123
    v_and_b32_dpp v104, v101, v10 row_newbcast:8 row_mask:0xf bank_mask:0xf
    v_and_b32_dpp v105, v101, v11 row_newbcast:8 row_mask:0xf bank_mask:0xf
    v_and_b32_dpp v106, v101, v12 row_newbcast:8 row_mask:0xf bank_mask:0xf
    v_and_b32_dpp v107, v101, v13 row_newbcast:8 row_mask:0xf bank_mask:0xf
    s_waitcnt vmcnt(5)
    buffer_load_dwordx4 v[144:147], v62, s[64:67], s85 offen offset:0 nt
    v_mfma_f32_16x16x32_bf16 v[116:119], v[152:155], v[104:107], v[116:119]
    v_and_b32_dpp v108, v101, v10 row_newbcast:12 row_mask:0xf bank_mask:0xf
    v_and_b32_dpp v109, v101, v11 row_newbcast:12 row_mask:0xf bank_mask:0xf
    v_and_b32_dpp v110, v101, v12 row_newbcast:12 row_mask:0xf bank_mask:0xf
    v_and_b32_dpp v111, v101, v13 row_newbcast:12 row_mask:0xf bank_mask:0xf
    s_waitcnt vmcnt(5)
    buffer_load_dwordx4 v[148:151], v63, s[64:67], s85 offen offset:0 nt
    v_mfma_f32_16x16x32_bf16 v[116:119], v[156:159], v[108:111], v[116:119]
    s_sub_u32 s97, s97, 1
    s_cmp_lg_u32 s97, 0
    s_cbranch_scc1 L_vloop
    buffer_load_dwordx4 v[152:155], v126, s[56:59], s85 offen offset:1024 nt
    buffer_load_dwordx4 v[156:159], v127, s[56:59], s85 offen offset:1024 nt
L_dloop:
    s_waitcnt vmcnt(7)
    v_readfirstlane_b32 s93, v19
    v_mov_b32 v19, 64
    s_cmp_ge_u32 s93, s81
    s_cbranch_scc1 L_last0
    s_add_u32 s87, s93, 231
    s_mul_i32 s36, s93, 7
    s_add_u32 s36, s36, s80
    s_cmp_ge_u32 s93, 25
    s_cselect_b32 s87, s36, s87
    s_add_u32 s39, s87, s88
    s_bfe_u32 s37, s39, 0x30000
    s_lshl_b32 s37, s37, 12
    s_add_u32 s85, s37, s89
    s_bfe_u32 s37, s39, 0x10003
    s_lshl_b32 s37, s37, 11
    s_add_u32 s85, s37, s85
    s_bfe_u32 s37, s39, 0x40004
    s_lshl_b32 s37, s37, 16
    s_add_u32 s85, s37, s85
    s_cmp_ge_u32 s93, s92
    s_cbranch_scc1 L_noclaim_6
    s_mov_b64 exec, 1
    global_atomic_add v19, v9, v18, s[30:31] sc0 sc1
    s_mov_b64 exec, -1
L_noclaim_6:
    buffer_load_dwordx4 v[160:163], v76, s[52:55], s85 offen offset:0 nt
    v_mfma_f32_16x16x32_bf16 v[112:115], v[128:131], v[80:83], 0
    s_waitcnt vmcnt(7)
    buffer_load_dwordx4 v[164:167], v77, s[52:55], s85 offen offset:0 nt
    v_mfma_f32_16x16x32_bf16 v[112:115], v[132:135], v[84:87], v[112:115]
    s_waitcnt vmcnt(7)
    buffer_load_dwordx4 v[168:171], v76, s[52:55], s85 offen offset:1024 nt
    v_mfma_f32_16x16x32_bf16 v[112:115], v[136:139], v[88:91], v[112:115]
    s_waitcnt vmcnt(7)
    buffer_load_dwordx4 v[172:175], v77, s[52:55], s85 offen offset:1024 nt
    v_mfma_f32_16x16x32_bf16 v[112:115], v[140:143], v[92:95], v[112:115]
    s_nop 7
    v_mov_b32_dpp v122, v112 quad_perm:[0,0,0,0] row_mask:0xf bank_mask:0xf
    v_mov_b32_dpp v124, v114 quad_perm:[2,2,2,2] row_mask:0xf bank_mask:0xf
    s_nop 0
    v_add_f32_dpp v122, v113, v122 quad_perm:[1,1,1,1] row_mask:0xf bank_mask:0xf
    v_add_f32_dpp v124, v115, v124 quad_perm:[3,3,3,3] row_mask:0xf bank_mask:0xf
    v_add_f32 v122, v122, v124
    v_fma_f32 v123, v122, s83, -v120
    v_cmp_lt_f32 vcc, 0, v123
    s_cbranch_vccz L_nomax_7
    v_mul_f32 v122, s83, v122
    s_nop 1
    v_max_f32_dpp v124, v122, v122 row_ror:4 row_mask:0xf bank_mask:0xf
    s_nop 1
    v_max_f32_dpp v124, v124, v124 row_ror:8 row_mask:0xf bank_mask:0xf
    v_mov_b32 v125, v124
    s_nop 1
    v_permlane16_swap_b32 v124, v125
    v_max_f32 v124, v124, v125
    v_mov_b32 v125, v124
    s_nop 1
    v_permlane32_swap_b32 v124, v125
    v_max_f32 v124, v124, v125
    v_max_f32 v124, v124, v120
    v_sub_f32 v125, v120, v124
    v_exp_f32 v125, v125
    v_mov_b32 v120, v124
    v_sub_f32 v123, v122, v124
    v_mul_f32 v121, v121, v125
    v_mul_f32 v116, v116, v125
    v_mul_f32 v117, v117, v125
    v_mul_f32 v118, v118, v125
    v_mul_f32 v119, v119, v125
L_nomax_7:
    v_exp_f32 v123, v123
    s_nop 0
    v_cvt_pk_bf16_f32 v124, v123, v123
    v_add_f32 v121, v121, v123
    s_nop 0
    v_and_b32_dpp v96, v124, v10 row_newbcast:0 row_mask:0xf bank_mask:0xf
    v_and_b32_dpp v97, v124, v11 row_newbcast:0 row_mask:0xf bank_mask:0xf
    v_and_b32_dpp v98, v124, v12 row_newbcast:0 row_mask:0xf bank_mask:0xf
    v_and_b32_dpp v99, v124, v13 row_newbcast:0 row_mask:0xf bank_mask:0xf
    v_and_b32_dpp v100, v124, v10 row_newbcast:4 row_mask:0xf bank_mask:0xf
    v_and_b32_dpp v101, v124, v11 row_newbcast:4 row_mask:0xf bank_mask:0xf
    v_and_b32_dpp v102, v124, v12 row_newbcast:4 row_mask:0xf bank_mask:0xf
    v_and_b32_dpp v103, v124, v13 row_newbcast:4 row_mask:0xf bank_mask:0xf
    v_and_b32_dpp v104, v124, v10 row_newbcast:8 row_mask:0xf bank_mask:0xf
    v_and_b32_dpp v105, v124, v11 row_newbcast:8 row_mask:0xf bank_mask:0xf
    v_and_b32_dpp v106, v124, v12 row_newbcast:8 row_mask:0xf bank_mask:0xf
    v_and_b32_dpp v107, v124, v13 row_newbcast:8 row_mask:0xf bank_mask:0xf
    v_and_b32_dpp v108, v124, v10 row_newbcast:12 row_mask:0xf bank_mask:0xf
    v_and_b32_dpp v109, v124, v11 row_newbcast:12 row_mask:0xf bank_mask:0xf
    v_and_b32_dpp v110, v124, v12 row_newbcast:12 row_mask:0xf bank_mask:0xf
    v_and_b32_dpp v111, v124, v13 row_newbcast:12 row_mask:0xf bank_mask:0xf
    s_waitcnt vmcnt(7)
    buffer_load_dwordx4 v[176:179], v126, s[56:59], s85 offen offset:0 nt
    v_mfma_f32_16x16x32_bf16 v[116:119], v[144:147], v[96:99], v[116:119]
    s_waitcnt vmcnt(7)
    buffer_load_dwordx4 v[180:183], v127, s[56:59], s85 offen offset:0 nt
    v_mfma_f32_16x16x32_bf16 v[116:119], v[148:151], v[100:103], v[116:119]
    s_waitcnt vmcnt(7)
    buffer_load_dwordx4 v[184:187], v126, s[56:59], s85 offen offset:1024 nt
    v_mfma_f32_16x16x32_bf16 v[116:119], v[152:155], v[104:107], v[116:119]
    s_waitcnt vmcnt(7)
    buffer_load_dwordx4 v[188:191], v127, s[56:59], s85 offen offset:1024 nt
    v_mfma_f32_16x16x32_bf16 v[116:119], v[156:159], v[108:111], v[116:119]
    s_waitcnt vmcnt(7)
    v_readfirstlane_b32 s93, v19
    v_mov_b32 v19, 64
    s_cmp_ge_u32 s93, s81
    s_cbranch_scc1 L_last1
    s_add_u32 s87, s93, 231
    s_mul_i32 s36, s93, 7
    s_add_u32 s36, s36, s80
    s_cmp_ge_u32 s93, 25
    s_cselect_b32 s87, s36, s87
    s_add_u32 s39, s87, s88
    s_bfe_u32 s37, s39, 0x30000
    s_lshl_b32 s37, s37, 12
    s_add_u32 s85, s37, s89
    s_bfe_u32 s37, s39, 0x10003
    s_lshl_b32 s37, s37, 11
    s_add_u32 s85, s37, s85
    s_bfe_u32 s37, s39, 0x40004
    s_lshl_b32 s37, s37, 16
    s_add_u32 s85, s37, s85
    s_cmp_ge_u32 s93, s92
    s_cbranch_scc1 L_noclaim_8
    s_mov_b64 exec, 1
    global_atomic_add v19, v9, v18, s[30:31] sc0 sc1
    s_mov_b64 exec, -1
L_noclaim_8:
    buffer_load_dwordx4 v[128:131], v76, s[52:55], s85 offen offset:0 nt
    v_mfma_f32_16x16x32_bf16 v[112:115], v[160:163], v[80:83], 0
    s_waitcnt vmcnt(7)
    buffer_load_dwordx4 v[132:135], v77, s[52:55], s85 offen offset:0 nt
    v_mfma_f32_16x16x32_bf16 v[112:115], v[164:167], v[84:87], v[112:115]
    s_waitcnt vmcnt(7)
    buffer_load_dwordx4 v[136:139], v76, s[52:55], s85 offen offset:1024 nt
    v_mfma_f32_16x16x32_bf16 v[112:115], v[168:171], v[88:91], v[112:115]
    s_waitcnt vmcnt(7)
    buffer_load_dwordx4 v[140:143], v77, s[52:55], s85 offen offset:1024 nt
    v_mfma_f32_16x16x32_bf16 v[112:115], v[172:175], v[92:95], v[112:115]
    s_nop 7
    v_mov_b32_dpp v122, v112 quad_perm:[0,0,0,0] row_mask:0xf bank_mask:0xf
    v_mov_b32_dpp v124, v114 quad_perm:[2,2,2,2] row_mask:0xf bank_mask:0xf
    s_nop 0
    v_add_f32_dpp v122, v113, v122 quad_perm:[1,1,1,1] row_mask:0xf bank_mask:0xf
    v_add_f32_dpp v124, v115, v124 quad_perm:[3,3,3,3] row_mask:0xf bank_mask:0xf
    v_add_f32 v122, v122, v124
    v_fma_f32 v123, v122, s83, -v120
    v_cmp_lt_f32 vcc, 0, v123
    s_cbranch_vccz L_nomax_9
    v_mul_f32 v122, s83, v122
    s_nop 1
    v_max_f32_dpp v124, v122, v122 row_ror:4 row_mask:0xf bank_mask:0xf
    s_nop 1
    v_max_f32_dpp v124, v124, v124 row_ror:8 row_mask:0xf bank_mask:0xf
    v_mov_b32 v125, v124
    s_nop 1
    v_permlane16_swap_b32 v124, v125
    v_max_f32 v124, v124, v125
    v_mov_b32 v125, v124
    s_nop 1
    v_permlane32_swap_b32 v124, v125
    v_max_f32 v124, v124, v125
    v_max_f32 v124, v124, v120
    v_sub_f32 v125, v120, v124
    v_exp_f32 v125, v125
    v_mov_b32 v120, v124
    v_sub_f32 v123, v122, v124
    v_mul_f32 v121, v121, v125
    v_mul_f32 v116, v116, v125
    v_mul_f32 v117, v117, v125
    v_mul_f32 v118, v118, v125
    v_mul_f32 v119, v119, v125
L_nomax_9:
    v_exp_f32 v123, v123
    s_nop 0
    v_cvt_pk_bf16_f32 v124, v123, v123
    v_add_f32 v121, v121, v123
    s_nop 0
    v_and_b32_dpp v96, v124, v10 row_newbcast:0 row_mask:0xf bank_mask:0xf
    v_and_b32_dpp v97, v124, v11 row_newbcast:0 row_mask:0xf bank_mask:0xf
    v_and_b32_dpp v98, v124, v12 row_newbcast:0 row_mask:0xf bank_mask:0xf
    v_and_b32_dpp v99, v124, v13 row_newbcast:0 row_mask:0xf bank_mask:0xf
    v_and_b32_dpp v100, v124, v10 row_newbcast:4 row_mask:0xf bank_mask:0xf
    v_and_b32_dpp v101, v124, v11 row_newbcast:4 row_mask:0xf bank_mask:0xf
    v_and_b32_dpp v102, v124, v12 row_newbcast:4 row_mask:0xf bank_mask:0xf
    v_and_b32_dpp v103, v124, v13 row_newbcast:4 row_mask:0xf bank_mask:0xf
    v_and_b32_dpp v104, v124, v10 row_newbcast:8 row_mask:0xf bank_mask:0xf
    v_and_b32_dpp v105, v124, v11 row_newbcast:8 row_mask:0xf bank_mask:0xf
    v_and_b32_dpp v106, v124, v12 row_newbcast:8 row_mask:0xf bank_mask:0xf
    v_and_b32_dpp v107, v124, v13 row_newbcast:8 row_mask:0xf bank_mask:0xf
    v_and_b32_dpp v108, v124, v10 row_newbcast:12 row_mask:0xf bank_mask:0xf
    v_and_b32_dpp v109, v124, v11 row_newbcast:12 row_mask:0xf bank_mask:0xf
    v_and_b32_dpp v110, v124, v12 row_newbcast:12 row_mask:0xf bank_mask:0xf
    v_and_b32_dpp v111, v124, v13 row_newbcast:12 row_mask:0xf bank_mask:0xf
    s_waitcnt vmcnt(7)
    buffer_load_dwordx4 v[144:147], v126, s[56:59], s85 offen offset:0 nt
    v_mfma_f32_16x16x32_bf16 v[116:119], v[176:179], v[96:99], v[116:119]
    s_waitcnt vmcnt(7)
    buffer_load_dwordx4 v[148:151], v127, s[56:59], s85 offen offset:0 nt
    v_mfma_f32_16x16x32_bf16 v[116:119], v[180:183], v[100:103], v[116:119]
    s_waitcnt vmcnt(7)
    buffer_load_dwordx4 v[152:155], v126, s[56:59], s85 offen offset:1024 nt
    v_mfma_f32_16x16x32_bf16 v[116:119], v[184:187], v[104:107], v[116:119]
    s_waitcnt vmcnt(7)
    buffer_load_dwordx4 v[156:159], v127, s[56:59], s85 offen offset:1024 nt
    v_mfma_f32_16x16x32_bf16 v[116:119], v[188:191], v[108:111], v[116:119]
    s_branch L_dloop
L_last1:
    buffer_load_dwordx4 v[224:227], v34, s[48:51], s46 offen sc1
    s_lshl_b32 s39, s34, 13
    s_add_u32 s39, s39, 98304
    s_mov_b32 m0, s39
    s_nop 0
    buffer_load_dwordx4 v20, s[40:43], s44 offen offset:0 nt lds
    v_mfma_f32_16x16x32_bf16 v[112:115], v[160:163], v[80:83], 0
    s_waitcnt vmcnt(8)
    buffer_load_dwordx4 v21, s[40:43], s44 offen offset:1024 nt lds
    v_mfma_f32_16x16x32_bf16 v[112:115], v[164:167], v[84:87], v[112:115]
    s_waitcnt vmcnt(8)
    buffer_load_dwordx4 v22, s[40:43], s44 offen offset:2048 nt lds
    v_mfma_f32_16x16x32_bf16 v[112:115], v[168:171], v[88:91], v[112:115]
    s_waitcnt vmcnt(8)
    buffer_load_dwordx4 v23, s[40:43], s44 offen offset:3072 nt lds
    v_mfma_f32_16x16x32_bf16 v[112:115], v[172:175], v[92:95], v[112:115]
    s_nop 7
    v_mov_b32_dpp v122, v112 quad_perm:[0,0,0,0] row_mask:0xf bank_mask:0xf
    v_mov_b32_dpp v124, v114 quad_perm:[2,2,2,2] row_mask:0xf bank_mask:0xf
    s_nop 0
    v_add_f32_dpp v122, v113, v122 quad_perm:[1,1,1,1] row_mask:0xf bank_mask:0xf
    v_add_f32_dpp v124, v115, v124 quad_perm:[3,3,3,3] row_mask:0xf bank_mask:0xf
    v_add_f32 v122, v122, v124
    v_fma_f32 v123, v122, s83, -v120
    v_cmp_lt_f32 vcc, 0, v123
    s_cbranch_vccz L_nomax_10
    v_mul_f32 v122, s83, v122
    s_nop 1
    v_max_f32_dpp v124, v122, v122 row_ror:4 row_mask:0xf bank_mask:0xf
    s_nop 1
    v_max_f32_dpp v124, v124, v124 row_ror:8 row_mask:0xf bank_mask:0xf
    v_mov_b32 v125, v124
    s_nop 1
    v_permlane16_swap_b32 v124, v125
    v_max_f32 v124, v124, v125
    v_mov_b32 v125, v124
    s_nop 1
    v_permlane32_swap_b32 v124, v125
    v_max_f32 v124, v124, v125
    v_max_f32 v124, v124, v120
    v_sub_f32 v125, v120, v124
    v_exp_f32 v125, v125
    v_mov_b32 v120, v124
    v_sub_f32 v123, v122, v124
    v_mul_f32 v121, v121, v125
    v_mul_f32 v116, v116, v125
    v_mul_f32 v117, v117, v125
    v_mul_f32 v118, v118, v125
    v_mul_f32 v119, v119, v125
L_nomax_10:
    v_exp_f32 v123, v123
    s_nop 0
    v_cvt_pk_bf16_f32 v124, v123, v123
    v_add_f32 v121, v121, v123
    s_nop 0
    v_and_b32_dpp v96, v124, v10 row_newbcast:0 row_mask:0xf bank_mask:0xf
    v_and_b32_dpp v97, v124, v11 row_newbcast:0 row_mask:0xf bank_mask:0xf
    v_and_b32_dpp v98, v124, v12 row_newbcast:0 row_mask:0xf bank_mask:0xf
    v_and_b32_dpp v99, v124, v13 row_newbcast:0 row_mask:0xf bank_mask:0xf
    v_and_b32_dpp v100, v124, v10 row_newbcast:4 row_mask:0xf bank_mask:0xf
    v_and_b32_dpp v101, v124, v11 row_newbcast:4 row_mask:0xf bank_mask:0xf
    v_and_b32_dpp v102, v124, v12 row_newbcast:4 row_mask:0xf bank_mask:0xf
    v_and_b32_dpp v103, v124, v13 row_newbcast:4 row_mask:0xf bank_mask:0xf
    v_and_b32_dpp v104, v124, v10 row_newbcast:8 row_mask:0xf bank_mask:0xf
    v_and_b32_dpp v105, v124, v11 row_newbcast:8 row_mask:0xf bank_mask:0xf
    v_and_b32_dpp v106, v124, v12 row_newbcast:8 row_mask:0xf bank_mask:0xf
    v_and_b32_dpp v107, v124, v13 row_newbcast:8 row_mask:0xf bank_mask:0xf
    v_and_b32_dpp v108, v124, v10 row_newbcast:12 row_mask:0xf bank_mask:0xf
    v_and_b32_dpp v109, v124, v11 row_newbcast:12 row_mask:0xf bank_mask:0xf
    v_and_b32_dpp v110, v124, v12 row_newbcast:12 row_mask:0xf bank_mask:0xf
    v_and_b32_dpp v111, v124, v13 row_newbcast:12 row_mask:0xf bank_mask:0xf
    s_waitcnt vmcnt(8)
    s_lshl_b32 s39, s34, 13
    s_add_u32 s39, s39, 102400
    s_mov_b32 m0, s39
    s_add_u32 s44, s44, 16384
    buffer_load_dwordx4 v20, s[40:43], s44 offen offset:0 nt lds
    v_mfma_f32_16x16x32_bf16 v[116:119], v[176:179], v[96:99], v[116:119]
    v_add_f32_dpp v121, v121, v121 row_ror:8 row_mask:0xf bank_mask:0xf
    s_nop 1
    v_add_f32_dpp v121, v121, v121 row_ror:4 row_mask:0xf bank_mask:0xf
    v_mov_b32 v125, v121
    s_nop 1
    v_permlane16_swap_b32 v121, v125
    v_add_f32 v121, v121, v125
    v_mov_b32 v125, v121
    s_nop 1
    v_permlane32_swap_b32 v121, v125
    v_add_f32 v121, v121, v125
    v_and_b32 v125, s82, v120
    v_sub_f32 v125, v120, v125
    s_mov_b32 vcc_lo, 0xff00ff00
    s_mov_b32 vcc_hi, 0xff00ff00
    s_waitcnt vmcnt(8)
    buffer_load_dwordx4 v21, s[40:43], s44 offen offset:1024 nt lds
    v_mfma_f32_16x16x32_bf16 v[116:119], v[180:183], v[100:103], v[116:119]
    s_waitcnt vmcnt(8)
    buffer_load_dwordx4 v22, s[40:43], s44 offen offset:2048 nt lds
    v_mfma_f32_16x16x32_bf16 v[116:119], v[184:187], v[104:107], v[116:119]
    s_waitcnt vmcnt(8)
    buffer_load_dwordx4 v23, s[40:43], s44 offen offset:3072 nt lds
    v_mfma_f32_16x16x32_bf16 v[116:119], v[188:191], v[108:111], v[116:119]
    s_branch L_bdone
L_last0:
    buffer_load_dwordx4 v[224:227], v34, s[48:51], s46 offen sc1
    s_lshl_b32 s39, s34, 13
    s_add_u32 s39, s39, 98304
    s_mov_b32 m0, s39
    s_nop 0
    buffer_load_dwordx4 v20, s[40:43], s44 offen offset:0 nt lds
    v_mfma_f32_16x16x32_bf16 v[112:115], v[128:131], v[80:83], 0
    s_waitcnt vmcnt(8)
    buffer_load_dwordx4 v21, s[40:43], s44 offen offset:1024 nt lds
    v_mfma_f32_16x16x32_bf16 v[112:115], v[132:135], v[84:87], v[112:115]
    s_waitcnt vmcnt(8)
    buffer_load_dwordx4 v22, s[40:43], s44 offen offset:2048 nt lds
    v_mfma_f32_16x16x32_bf16 v[112:115], v[136:139], v[88:91], v[112:115]
    s_waitcnt vmcnt(8)
    buffer_load_dwordx4 v23, s[40:43], s44 offen offset:3072 nt lds
    v_mfma_f32_16x16x32_bf16 v[112:115], v[140:143], v[92:95], v[112:115]
    s_nop 7
    v_mov_b32_dpp v122, v112 quad_perm:[0,0,0,0] row_mask:0xf bank_mask:0xf
    v_mov_b32_dpp v124, v114 quad_perm:[2,2,2,2] row_mask:0xf bank_mask:0xf
    s_nop 0
    v_add_f32_dpp v122, v113, v122 quad_perm:[1,1,1,1] row_mask:0xf bank_mask:0xf
    v_add_f32_dpp v124, v115, v124 quad_perm:[3,3,3,3] row_mask:0xf bank_mask:0xf
    v_add_f32 v122, v122, v124
    v_fma_f32 v123, v122, s83, -v120
    v_cmp_lt_f32 vcc, 0, v123
    s_cbranch_vccz L_nomax_11
    v_mul_f32 v122, s83, v122
    s_nop 1
    v_max_f32_dpp v124, v122, v122 row_ror:4 row_mask:0xf bank_mask:0xf
    s_nop 1
    v_max_f32_dpp v124, v124, v124 row_ror:8 row_mask:0xf bank_mask:0xf
    v_mov_b32 v125, v124
    s_nop 1
    v_permlane16_swap_b32 v124, v125
    v_max_f32 v124, v124, v125
    v_mov_b32 v125, v124
    s_nop 1
    v_permlane32_swap_b32 v124, v125
    v_max_f32 v124, v124, v125
    v_max_f32 v124, v124, v120
    v_sub_f32 v125, v120, v124
    v_exp_f32 v125, v125
    v_mov_b32 v120, v124
    v_sub_f32 v123, v122, v124
    v_mul_f32 v121, v121, v125
    v_mul_f32 v116, v116, v125
    v_mul_f32 v117, v117, v125
    v_mul_f32 v118, v118, v125
    v_mul_f32 v119, v119, v125
L_nomax_11:
    v_exp_f32 v123, v123
    s_nop 0
    v_cvt_pk_bf16_f32 v124, v123, v123
    v_add_f32 v121, v121, v123
    s_nop 0
    v_and_b32_dpp v96, v124, v10 row_newbcast:0 row_mask:0xf bank_mask:0xf
    v_and_b32_dpp v97, v124, v11 row_newbcast:0 row_mask:0xf bank_mask:0xf
    v_and_b32_dpp v98, v124, v12 row_newbcast:0 row_mask:0xf bank_mask:0xf
    v_and_b32_dpp v99, v124, v13 row_newbcast:0 row_mask:0xf bank_mask:0xf
    v_and_b32_dpp v100, v124, v10 row_newbcast:4 row_mask:0xf bank_mask:0xf
    v_and_b32_dpp v101, v124, v11 row_newbcast:4 row_mask:0xf bank_mask:0xf
    v_and_b32_dpp v102, v124, v12 row_newbcast:4 row_mask:0xf bank_mask:0xf
    v_and_b32_dpp v103, v124, v13 row_newbcast:4 row_mask:0xf bank_mask:0xf
    v_and_b32_dpp v104, v124, v10 row_newbcast:8 row_mask:0xf bank_mask:0xf
    v_and_b32_dpp v105, v124, v11 row_newbcast:8 row_mask:0xf bank_mask:0xf
    v_and_b32_dpp v106, v124, v12 row_newbcast:8 row_mask:0xf bank_mask:0xf
    v_and_b32_dpp v107, v124, v13 row_newbcast:8 row_mask:0xf bank_mask:0xf
    v_and_b32_dpp v108, v124, v10 row_newbcast:12 row_mask:0xf bank_mask:0xf
    v_and_b32_dpp v109, v124, v11 row_newbcast:12 row_mask:0xf bank_mask:0xf
    v_and_b32_dpp v110, v124, v12 row_newbcast:12 row_mask:0xf bank_mask:0xf
    v_and_b32_dpp v111, v124, v13 row_newbcast:12 row_mask:0xf bank_mask:0xf
    s_waitcnt vmcnt(8)
    s_lshl_b32 s39, s34, 13
    s_add_u32 s39, s39, 102400
    s_mov_b32 m0, s39
    s_add_u32 s44, s44, 16384
    buffer_load_dwordx4 v20, s[40:43], s44 offen offset:0 nt lds
    v_mfma_f32_16x16x32_bf16 v[116:119], v[144:147], v[96:99], v[116:119]
    v_add_f32_dpp v121, v121, v121 row_ror:8 row_mask:0xf bank_mask:0xf
    s_nop 1
    v_add_f32_dpp v121, v121, v121 row_ror:4 row_mask:0xf bank_mask:0xf
    v_mov_b32 v125, v121
    s_nop 1
    v_permlane16_swap_b32 v121, v125
    v_add_f32 v121, v121, v125
    v_mov_b32 v125, v121
    s_nop 1
    v_permlane32_swap_b32 v121, v125
    v_add_f32 v121, v121, v125
    v_and_b32 v125, s82, v120
    v_sub_f32 v125, v120, v125
    s_mov_b32 vcc_lo, 0xff00ff00
    s_mov_b32 vcc_hi, 0xff00ff00
    s_waitcnt vmcnt(8)
    buffer_load_dwordx4 v21, s[40:43], s44 offen offset:1024 nt lds
    v_mfma_f32_16x16x32_bf16 v[116:119], v[148:151], v[100:103], v[116:119]
    s_waitcnt vmcnt(8)
    buffer_load_dwordx4 v22, s[40:43], s44 offen offset:2048 nt lds
    v_mfma_f32_16x16x32_bf16 v[116:119], v[152:155], v[104:107], v[116:119]
    s_waitcnt vmcnt(8)
    buffer_load_dwordx4 v23, s[40:43], s44 offen offset:3072 nt lds
    v_mfma_f32_16x16x32_bf16 v[116:119], v[156:159], v[108:111], v[116:119]
L_bdone:
    s_nop 7
    v_cndmask_b32 v116, v116, v120, vcc
    v_cndmask_b32 v117, v117, v121, vcc
    v_cndmask_b32 v118, v118, v125, vcc
    v_and_or_b32 v119, v119, s82, v8
    v_and_or_b32 v116, v116, s82, v8
    v_and_or_b32 v117, v117, s82, v8
    v_and_or_b32 v118, v118, s82, v8
    s_mov_b32 exec_lo, 0xff01ff
    s_mov_b32 exec_hi, 0xff00ff
    buffer_store_dwordx4 v[116:119], v79, s[48:51], s96 offen sc1
    s_mov_b64 exec, -1
    s_cmp_lt_u32 s33, 3
    s_cbranch_scc1 L_ctx
    s_mov_b32 s93, 0x7f
    s_bitset0_b32 s93, s33
    s_mov_b32 s86, 0
    s_and_b32 s86, s86, s93
    s_cselect_b32 s86, s86, s93
    s_ff1_i32_b32 s4, s86
    s_bitset0_b32 s86, s4
    s_lshl_b32 s36, s4, 10
    s_add_u32 s36, s36, s47
    buffer_load_dwordx4 v[192:195], v79, s[48:51], s36 offen sc1
    s_and_b32 s86, s86, s93
    s_cselect_b32 s86, s86, s93
    s_ff1_i32_b32 s5, s86
    s_bitset0_b32 s86, s5
    s_lshl_b32 s36, s5, 10
    s_add_u32 s36, s36, s47
    buffer_load_dwordx4 v[196:199], v79, s[48:51], s36 offen sc1
    s_and_b32 s86, s86, s93
    s_cselect_b32 s86, s86, s93
    s_ff1_i32_b32 s6, s86
    s_bitset0_b32 s86, s6
    s_lshl_b32 s36, s6, 10
    s_add_u32 s36, s36, s47
    buffer_load_dwordx4 v[200:203], v79, s[48:51], s36 offen sc1
    s_and_b32 s86, s86, s93
    s_cselect_b32 s86, s86, s93
    s_ff1_i32_b32 s7, s86
    s_bitset0_b32 s86, s7
    s_lshl_b32 s36, s7, 10
    s_add_u32 s36, s36, s47
    buffer_load_dwordx4 v[204:207], v79, s[48:51], s36 offen sc1
    v_xor_b32 v104, s35, v116
    v_xor_b32 v105, s35, v117
    v_xor_b32 v106, s35, v118
    v_xor_b32 v107, s35, v119
L_hop1poll:
    s_and_b32 s86, s86, s93
    s_cselect_b32 s86, s86, s93
    s_ff1_i32_b32 s8, s86
    s_bitset0_b32 s86, s8
    s_lshl_b32 s36, s8, 10
    s_add_u32 s36, s36, s47
    buffer_load_dwordx4 v[208:211], v79, s[48:51], s36 offen sc1
    s_waitcnt vmcnt(4)
    v_xor_b32 v192, s35, v192
    v_xor_b32 v193, s35, v193
    v_xor_b32 v194, s35, v194
    v_xor_b32 v195, s35, v195
    v_or_b32 v4, v192, v193
    v_or3_b32 v4, v4, v194, v195
    v_and_b32 v4, 0xff, v4
    v_cmp_ne_u32 vcc, 0, v4
    v_add_f32 v6, v192, v194
    v_max_f32 v5, v120, v6
    s_cbranch_vccnz L_mnext_12
    s_bitcmp1_b32 s93, s4
    s_cbranch_scc0 L_mnext_12
    v_sub_f32 v122, v120, v5
    v_sub_f32 v123, v6, v5
    v_exp_f32 v122, v122
    v_exp_f32 v123, v123
    v_mov_b32 v120, v5
    s_bitset0_b32 s93, s4
    v_mul_f32_dpp v105, v122, v105 row_newbcast:8 row_mask:0xf bank_mask:0xf
    v_mul_f32_dpp v104, v122, v104 row_newbcast:8 row_mask:0xf bank_mask:0xf
    v_mul_f32_dpp v106, v122, v106 row_newbcast:8 row_mask:0xf bank_mask:0xf
    v_mul_f32_dpp v107, v122, v107 row_newbcast:8 row_mask:0xf bank_mask:0xf
    v_fmac_f32_dpp v105, v123, v193 row_newbcast:8 row_mask:0xf bank_mask:0xf
    v_fmac_f32_dpp v104, v123, v192 row_newbcast:8 row_mask:0xf bank_mask:0xf
    v_fmac_f32_dpp v106, v123, v194 row_newbcast:8 row_mask:0xf bank_mask:0xf
    v_fmac_f32_dpp v107, v123, v195 row_newbcast:8 row_mask:0xf bank_mask:0xf
    s_cmp_eq_u32 s93, 0
    s_cbranch_scc1 L_hop1ok
L_mnext_12:
    s_and_b32 s86, s86, s93
    s_cselect_b32 s86, s86, s93
    s_ff1_i32_b32 s4, s86
    s_bitset0_b32 s86, s4
    s_lshl_b32 s36, s4, 10
    s_add_u32 s36, s36, s47
    buffer_load_dwordx4 v[192:195], v79, s[48:51], s36 offen sc1
    s_waitcnt vmcnt(4)
    v_xor_b32 v196, s35, v196
    v_xor_b32 v197, s35, v197
    v_xor_b32 v198, s35, v198
    v_xor_b32 v199, s35, v199
    v_or_b32 v4, v196, v197
    v_or3_b32 v4, v4, v198, v199
    v_and_b32 v4, 0xff, v4
    v_cmp_ne_u32 vcc, 0, v4
    v_add_f32 v6, v196, v198
    v_max_f32 v5, v120, v6
    s_cbranch_vccnz L_mnext_13
    s_bitcmp1_b32 s93, s5
    s_cbranch_scc0 L_mnext_13
    v_sub_f32 v122, v120, v5
    v_sub_f32 v123, v6, v5
    v_exp_f32 v122, v122
    v_exp_f32 v123, v123
    v_mov_b32 v120, v5
    s_bitset0_b32 s93, s5
    v_mul_f32_dpp v105, v122, v105 row_newbcast:8 row_mask:0xf bank_mask:0xf
    v_mul_f32_dpp v104, v122, v104 row_newbcast:8 row_mask:0xf bank_mask:0xf
    v_mul_f32_dpp v106, v122, v106 row_newbcast:8 row_mask:0xf bank_mask:0xf
    v_mul_f32_dpp v107, v122, v107 row_newbcast:8 row_mask:0xf bank_mask:0xf
    v_fmac_f32_dpp v105, v123, v197 row_newbcast:8 row_mask:0xf bank_mask:0xf
    v_fmac_f32_dpp v104, v123, v196 row_newbcast:8 row_mask:0xf bank_mask:0xf
    v_fmac_f32_dpp v106, v123, v198 row_newbcast:8 row_mask:0xf bank_mask:0xf
    v_fmac_f32_dpp v107, v123, v199 row_newbcast:8 row_mask:0xf bank_mask:0xf
    s_cmp_eq_u32 s93, 0
    s_cbranch_scc1 L_hop1ok
L_mnext_13:
    s_and_b32 s86, s86, s93
    s_cselect_b32 s86, s86, s93
    s_ff1_i32_b32 s5, s86
    s_bitset0_b32 s86, s5
    s_lshl_b32 s36, s5, 10
    s_add_u32 s36, s36, s47
    buffer_load_dwordx4 v[196:199], v79, s[48:51], s36 offen sc1
    s_waitcnt vmcnt(4)
    v_xor_b32 v200, s35, v200
    v_xor_b32 v201, s35, v201
    v_xor_b32 v202, s35, v202
    v_xor_b32 v203, s35, v203
    v_or_b32 v4, v200, v201
    v_or3_b32 v4, v4, v202, v203
    v_and_b32 v4, 0xff, v4
    v_cmp_ne_u32 vcc, 0, v4
    v_add_f32 v6, v200, v202
    v_max_f32 v5, v120, v6
    s_cbranch_vccnz L_mnext_14
    s_bitcmp1_b32 s93, s6
    s_cbranch_scc0 L_mnext_14
    v_sub_f32 v122, v120, v5
    v_sub_f32 v123, v6, v5
    v_exp_f32 v122, v122
    v_exp_f32 v123, v123
    v_mov_b32 v120, v5
    s_bitset0_b32 s93, s6
    v_mul_f32_dpp v105, v122, v105 row_newbcast:8 row_mask:0xf bank_mask:0xf
    v_mul_f32_dpp v104, v122, v104 row_newbcast:8 row_mask:0xf bank_mask:0xf
    v_mul_f32_dpp v106, v122, v106 row_newbcast:8 row_mask:0xf bank_mask:0xf
    v_mul_f32_dpp v107, v122, v107 row_newbcast:8 row_mask:0xf bank_mask:0xf
    v_fmac_f32_dpp v105, v123, v201 row_newbcast:8 row_mask:0xf bank_mask:0xf
    v_fmac_f32_dpp v104, v123, v200 row_newbcast:8 row_mask:0xf bank_mask:0xf
    v_fmac_f32_dpp v106, v123, v202 row_newbcast:8 row_mask:0xf bank_mask:0xf
    v_fmac_f32_dpp v107, v123, v203 row_newbcast:8 row_mask:0xf bank_mask:0xf
    s_cmp_eq_u32 s93, 0
    s_cbranch_scc1 L_hop1ok
L_mnext_14:
    s_and_b32 s86, s86, s93
    s_cselect_b32 s86, s86, s93
    s_ff1_i32_b32 s6, s86
    s_bitset0_b32 s86, s6
    s_lshl_b32 s36, s6, 10
    s_add_u32 s36, s36, s47
    buffer_load_dwordx4 v[200:203], v79, s[48:51], s36 offen sc1
    s_waitcnt vmcnt(4)
    v_xor_b32 v204, s35, v204
    v_xor_b32 v205, s35, v205
    v_xor_b32 v206, s35, v206
    v_xor_b32 v207, s35, v207
    v_or_b32 v4, v204, v205
    v_or3_b32 v4, v4, v206, v207
    v_and_b32 v4, 0xff, v4
    v_cmp_ne_u32 vcc, 0, v4
    v_add_f32 v6, v204, v206
    v_max_f32 v5, v120, v6
    s_cbranch_vccnz L_mnext_15
    s_bitcmp1_b32 s93, s7
    s_cbranch_scc0 L_mnext_15
    v_sub_f32 v122, v120, v5
    v_sub_f32 v123, v6, v5
    v_exp_f32 v122, v122
    v_exp_f32 v123, v123
    v_mov_b32 v120, v5
    s_bitset0_b32 s93, s7
    v_mul_f32_dpp v105, v122, v105 row_newbcast:8 row_mask:0xf bank_mask:0xf
    v_mul_f32_dpp v104, v122, v104 row_newbcast:8 row_mask:0xf bank_mask:0xf
    v_mul_f32_dpp v106, v122, v106 row_newbcast:8 row_mask:0xf bank_mask:0xf
    v_mul_f32_dpp v107, v122, v107 row_newbcast:8 row_mask:0xf bank_mask:0xf
    v_fmac_f32_dpp v105, v123, v205 row_newbcast:8 row_mask:0xf bank_mask:0xf
    v_fmac_f32_dpp v104, v123, v204 row_newbcast:8 row_mask:0xf bank_mask:0xf
    v_fmac_f32_dpp v106, v123, v206 row_newbcast:8 row_mask:0xf bank_mask:0xf
    v_fmac_f32_dpp v107, v123, v207 row_newbcast:8 row_mask:0xf bank_mask:0xf
    s_cmp_eq_u32 s93, 0
    s_cbranch_scc1 L_hop1ok
L_mnext_15:
    s_and_b32 s86, s86, s93
    s_cselect_b32 s86, s86, s93
    s_ff1_i32_b32 s7, s86
    s_bitset0_b32 s86, s7
    s_lshl_b32 s36, s7, 10
    s_add_u32 s36, s36, s47
    buffer_load_dwordx4 v[204:207], v79, s[48:51], s36 offen sc1
    s_waitcnt vmcnt(4)
    v_xor_b32 v208, s35, v208
    v_xor_b32 v209, s35, v209
    v_xor_b32 v210, s35, v210
    v_xor_b32 v211, s35, v211
    v_or_b32 v4, v208, v209
    v_or3_b32 v4, v4, v210, v211
    v_and_b32 v4, 0xff, v4
    v_cmp_ne_u32 vcc, 0, v4
    v_add_f32 v6, v208, v210
    v_max_f32 v5, v120, v6
    s_cbranch_vccnz L_mnext_16
    s_bitcmp1_b32 s93, s8
    s_cbranch_scc0 L_mnext_16
    v_sub_f32 v122, v120, v5
    v_sub_f32 v123, v6, v5
    v_exp_f32 v122, v122
    v_exp_f32 v123, v123
    v_mov_b32 v120, v5
    s_bitset0_b32 s93, s8
    v_mul_f32_dpp v105, v122, v105 row_newbcast:8 row_mask:0xf bank_mask:0xf
    v_mul_f32_dpp v104, v122, v104 row_newbcast:8 row_mask:0xf bank_mask:0xf
    v_mul_f32_dpp v106, v122, v106 row_newbcast:8 row_mask:0xf bank_mask:0xf
    v_mul_f32_dpp v107, v122, v107 row_newbcast:8 row_mask:0xf bank_mask:0xf
    v_fmac_f32_dpp v105, v123, v209 row_newbcast:8 row_mask:0xf bank_mask:0xf
    v_fmac_f32_dpp v104, v123, v208 row_newbcast:8 row_mask:0xf bank_mask:0xf
    v_fmac_f32_dpp v106, v123, v210 row_newbcast:8 row_mask:0xf bank_mask:0xf
    v_fmac_f32_dpp v107, v123, v211 row_newbcast:8 row_mask:0xf bank_mask:0xf
    s_cmp_eq_u32 s93, 0
    s_cbranch_scc1 L_hop1ok
L_mnext_16:
    s_sub_u32 s84, s84, 1
    s_cmp_lg_u32 s84, 0
    s_cbranch_scc1 L_hop1poll
    s_branch L_end
L_ctx:
    s_waitcnt vmcnt(1)
L_ctxcheck:
    v_xor_b32 v224, s35, v224
    v_xor_b32 v225, s35, v225
    v_xor_b32 v226, s35, v226
    v_xor_b32 v227, s35, v227
    v_or_b32 v4, v224, v225
    v_or3_b32 v4, v4, v226, v227
    v_and_b32 v4, 0xff, v4
    v_cmp_ne_u32 vcc, 0, v4
    s_cbranch_vccz L_ctxok
    buffer_load_dwordx4 v[224:227], v34, s[48:51], s46 offen sc1
    s_waitcnt vmcnt(0)
    s_sub_u32 s84, s84, 1
    s_cmp_lg_u32 s84, 0
    s_cbranch_scc1 L_ctxcheck
    s_branch L_end
L_ctxok:
    v_cvt_pk_bf16_f32 v224, v224, v225
    v_cvt_pk_bf16_f32 v225, v226, v227
    ds_write_b64 v35, v[224:225]
    s_branch L_final
L_hop1ok:
    v_rcp_f32 v122, v105
    s_nop 1
    v_mul_f32_dpp v104, v122, v104 row_newbcast:8 row_mask:0xf bank_mask:0xf
    v_mul_f32_dpp v105, v122, v105 row_newbcast:8 row_mask:0xf bank_mask:0xf
    v_mul_f32_dpp v106, v122, v106 row_newbcast:8 row_mask:0xf bank_mask:0xf
    v_mul_f32_dpp v107, v122, v107 row_newbcast:8 row_mask:0xf bank_mask:0xf
    v_cvt_pk_bf16_f32 v104, v104, v105
    v_cvt_pk_bf16_f32 v106, v106, v107
    s_mov_b32 exec_lo, 0xff00ff
    s_mov_b32 exec_hi, 0xff00ff
    ds_write_b16 v31, v104
    ds_write_b16_d16_hi v31, v104 offset:16
    ds_write_b16 v31, v106 offset:32
    ds_write_b16_d16_hi v31, v106 offset:48
    s_mov_b64 exec, -1
L_final:
    s_waitcnt lgkmcnt(0)
    s_barrier
    ds_read_b64_tr_b16 v[128:129], v24 offset:0
    ds_read_b64_tr_b16 v[130:131], v25 offset:1024
    ds_read_b128 v[160:163], v28 offset:0
    ds_read_b64_tr_b16 v[132:133], v24 offset:8192
    ds_read_b64_tr_b16 v[134:135], v25 offset:9216
    ds_read_b128 v[164:167], v28 offset:64
    ds_read_b64_tr_b16 v[136:137], v24 offset:16384
    ds_read_b64_tr_b16 v[138:139], v25 offset:17408
    ds_read_b128 v[168:171], v28 offset:128
    ds_read_b64_tr_b16 v[140:141], v24 offset:24576
    ds_read_b64_tr_b16 v[142:143], v25 offset:25600
    ds_read_b128 v[172:175], v28 offset:192
    ds_read_b64_tr_b16 v[144:145], v26 offset:0
    ds_read_b64_tr_b16 v[146:147], v27 offset:1024
    ds_read_b128 v[176:179], v29 offset:0
    s_waitcnt lgkmcnt(12)
    v_mfma_f32_16x16x32_bf16 v[112:115], v[128:131], v[160:163], 0
    ds_read_b64_tr_b16 v[148:149], v26 offset:8192
    ds_read_b64_tr_b16 v[150:151], v27 offset:9216
    ds_read_b128 v[180:183], v29 offset:64
    s_waitcnt lgkmcnt(12)
    v_mfma_f32_16x16x32_bf16 v[112:115], v[132:135], v[164:167], v[112:115]
    ds_read_b64_tr_b16 v[152:153], v26 offset:16384
    ds_read_b64_tr_b16 v[154:155], v27 offset:17408
    ds_read_b128 v[184:187], v29 offset:128
    s_waitcnt lgkmcnt(12)
    v_mfma_f32_16x16x32_bf16 v[112:115], v[136:139], v[168:171], v[112:115]
    ds_read_b64_tr_b16 v[156:157], v26 offset:24576
    ds_read_b64_tr_b16 v[158:159], v27 offset:25600
    ds_read_b128 v[188:191], v29 offset:192
    s_waitcnt lgkmcnt(12)
    v_mfma_f32_16x16x32_bf16 v[112:115], v[140:143], v[172:175], v[112:115]
    s_waitcnt lgkmcnt(9)
    v_mfma_f32_16x16x32_bf16 v[112:115], v[144:147], v[176:179], v[112:115]
    s_waitcnt lgkmcnt(6)
    v_mfma_f32_16x16x32_bf16 v[112:115], v[148:151], v[180:183], v[112:115]
    s_waitcnt lgkmcnt(3)
    v_mfma_f32_16x16x32_bf16 v[112:115], v[152:155], v[184:187], v[112:115]
    s_waitcnt lgkmcnt(0)
    v_mfma_f32_16x16x32_bf16 v[112:115], v[156:159], v[188:191], v[112:115]
    s_cmp_eq_u32 s33, 0
    s_cselect_b32 s36, 0, 262144
    s_cselect_b32 s39, 0, 1024
    s_add_u32 s36, s36, 524288
    s_add_u32 s37, s36, 4096
    s_mov_b32 exec_lo, 0xff00ff
    s_mov_b32 exec_hi, 0xff00ff
    s_nop 0
    v_and_or_b32 v112, v112, s82, v8
    v_and_or_b32 v113, v113, s82, v8
    v_and_or_b32 v114, v114, s82, v8
    v_and_or_b32 v115, v115, s82, v8
    buffer_store_dwordx4 v[112:115], v30, s[48:51], s45 offen sc1
    s_mov_b64 exec, -1
    s_sub_u32 s38, s33, 1
    s_cmp_lt_u32 s38, 6
    s_cbranch_scc1 L_done
L_hop2:
    buffer_load_dwordx4 v[224:227], v32, s[48:51], s36 offen sc1
    buffer_load_dwordx4 v[228:231], v32, s[48:51], s37 offen sc1
    s_waitcnt vmcnt(0)
    v_xor_b32 v224, s35, v224
    v_xor_b32 v225, s35, v225
    v_xor_b32 v226, s35, v226
    v_xor_b32 v227, s35, v227
    v_xor_b32 v228, s35, v228
    v_xor_b32 v229, s35, v229
    v_xor_b32 v230, s35, v230
    v_xor_b32 v231, s35, v231
    v_or_b32 v4, v224, v225
    v_or3_b32 v4, v4, v226, v227
    v_or3_b32 v4, v4, v228, v229
    v_or3_b32 v4, v4, v230, v231
    v_and_b32 v4, 0xff, v4
    v_cmp_ne_u32 vcc, 0, v4
    v_add_f32 v232, v224, v228
    v_add_f32 v233, v225, v229
    v_add_f32 v234, v226, v230
    v_add_f32 v235, v227, v231
    s_cbranch_vccz L_hop2ok
    s_sub_u32 s84, s84, 1
    s_cmp_lg_u32 s84, 0
    s_cbranch_scc1 L_hop2
    s_branch L_end
L_hop2ok:
    v_permlane16_swap_b32 v232, v233
    v_permlane16_swap_b32 v234, v235
    v_add_f32 v232, v232, v233
    v_add_f32 v234, v234, v235
    s_nop 1
    v_permlane32_swap_b32 v232, v234
    v_add_f32 v232, v232, v234
    s_nop 1
    v_add_f32_dpp v232, v232, v232 row_ror:8 row_mask:0xf bank_mask:0xf
    s_nop 1
    v_add_f32_dpp v232, v232, v232 row_ror:4 row_mask:0xf bank_mask:0xf
    v_cvt_pk_bf16_f32 v232, v232, v232
    s_mov_b32 exec_lo, 0xf000f
    s_mov_b32 exec_hi, 0xf000f
    buffer_store_short v232, v33, s[72:75], s39 offen
    s_or_b32 s36, s2, s34
    s_cmp_lg_u32 s36, 0
    s_cbranch_scc1 L_done
    v_mov_b32 v4, 0
    s_mov_b64 exec, 1
    buffer_store_dword v8, v4, s[48:51], 0 offen
L_done:
L_end:
    s_endpgm
L_qp:
    v_lshlrev_b32 v4, 18, v2
    v_lshl_add_u32 v14, v3, 4, v4
    v_lshrrev_b32 v5, 3, v3
    v_lshlrev_b32 v5, 10, v5
    v_lshl_add_u32 v15, v2, 6, v5
    s_cmp_eq_u32 s33, 0
    s_cselect_b32 s61, 3, 2
    s_xor_b32 s61, s61, s32
    s_lshl_b32 s86, s34, 8
    s_lshl_b32 s63, s34, 20
    s_lshl_b32 s38, s61, 8
    s_add_u32 s63, s63, s38
    s_mov_b32 s42, 4194304
    s_mov_b32 s43, 0x20000
    s_mov_b32 s46, 4096
    s_mov_b32 s47, 0x20000
    s_cmp_eq_u32 s33, 0
    s_waitcnt lgkmcnt(0)
    s_cselect_b64 s[40:41], s[22:23], s[8:9]
    s_cselect_b64 s[44:45], s[16:17], s[4:5]
    buffer_load_dwordx4 a[128:131], v14, s[40:43], s63 offen nt
    s_add_u32 s63, s63, 8192
    buffer_load_dwordx4 a[132:135], v14, s[40:43], s63 offen nt
    s_add_u32 s63, s63, 8192
    buffer_load_dwordx4 v[20:23], v15, s[44:47], s86 offen offset:0
    buffer_load_dwordx4 v[36:39], v15, s[44:47], s86 offen offset:2048
    buffer_load_dwordx4 a[136:139], v14, s[40:43], s63 offen nt
    s_add_u32 s63, s63, 8192
    buffer_load_dwordx4 a[140:143], v14, s[40:43], s63 offen nt
    s_add_u32 s63, s63, 8192
    buffer_load_dwordx4 a[144:147], v14, s[40:43], s63 offen nt
    s_add_u32 s63, s63, 8192
    buffer_load_dwordx4 a[148:151], v14, s[40:43], s63 offen nt
    s_add_u32 s63, s63, 8192
    buffer_load_dwordx4 a[152:155], v14, s[40:43], s63 offen nt
    s_add_u32 s63, s63, 8192
    buffer_load_dwordx4 a[156:159], v14, s[40:43], s63 offen nt
    s_add_u32 s63, s63, 8192
    s_load_dword s35, s[30:31], 0
    s_mov_b32 s48, s30
    s_and_b32 s49, s31, 0xffff
    s_mov_b32 s50, 8388608
    s_mov_b32 s51, 0x20000
    s_mov_b32 s82, 0xffffff00
    s_mov_b32 s83, 0x3e0293ee
    s_mov_b32 s84, 2097152
    v_and_b32 v4, 1, v1
    v_lshlrev_b32 v4, 4, v4
    v_mov_b32 v5, 0xffff
    v_lshlrev_b32 v4, v4, v5
    v_bfe_u32 v5, v1, 1, 2
    v_cmp_eq_u32 vcc, 0, v5
    s_nop 1
    v_cndmask_b32 v10, 0, v4, vcc
    v_cmp_eq_u32 vcc, 1, v5
    s_nop 1
    v_cndmask_b32 v11, 0, v4, vcc
    v_cmp_eq_u32 vcc, 2, v5
    s_nop 1
    v_cndmask_b32 v12, 0, v4, vcc
    v_cmp_eq_u32 vcc, 3, v5
    s_nop 1
    v_cndmask_b32 v13, 0, v4, vcc
    buffer_load_dwordx4 v[24:27], v15, s[44:47], s86 offen offset:16
    buffer_load_dwordx4 v[40:43], v15, s[44:47], s86 offen offset:2064
    buffer_load_dwordx4 v[28:31], v15, s[44:47], s86 offen offset:32
    buffer_load_dwordx4 v[44:47], v15, s[44:47], s86 offen offset:2080
    buffer_load_dwordx4 v[32:35], v15, s[44:47], s86 offen offset:48
    buffer_load_dwordx4 v[48:51], v15, s[44:47], s86 offen offset:2096
    s_lshl_b32 s38, s61, 10
    s_add_u32 s36, s38, 65536
    s_lshl_b32 s38, s34, 8
    s_add_u32 s36, s38, s36
    v_mov_b32 v19, 0
    s_cmp_eq_u32 s33, 0
    s_cselect_b32 s38, s36, 8388608
    s_mov_b64 exec, 1
    buffer_store_dword v19, v19, s[48:51], s38 offen sc1
    s_mov_b64 exec, -1
    s_mov_b32 s80, 0x01000100
    s_mov_b32 s81, 0x03020302
    s_waitcnt vmcnt(13)
    buffer_load_dwordx4 a[160:163], v14, s[40:43], s63 offen nt
    s_add_u32 s63, s63, 8192
    v_perm_b32 v4, v20, v20, s80
    v_perm_b32 v5, v36, v36, s80
    v_and_b32 v52, v4, v10
    v_and_b32 v53, v4, v11
    v_and_b32 v54, v4, v12
    v_and_b32 v55, v4, v13
    v_and_b32 v56, v5, v10
    v_and_b32 v57, v5, v11
    v_and_b32 v58, v5, v12
    v_and_b32 v59, v5, v13
    v_mfma_f32_16x16x32_bf16 v[60:63], a[128:131], v[52:55], 0
    s_nop 0
    v_mfma_f32_16x16x32_bf16 v[64:67], a[128:131], v[56:59], 0
    buffer_load_dwordx4 a[164:167], v14, s[40:43], s63 offen nt
    s_add_u32 s63, s63, 8192
    v_perm_b32 v4, v20, v20, s81
    v_perm_b32 v5, v36, v36, s81
    v_and_b32 v52, v4, v10
    v_and_b32 v53, v4, v11
    v_and_b32 v54, v4, v12
    v_and_b32 v55, v4, v13
    v_and_b32 v56, v5, v10
    v_and_b32 v57, v5, v11
    v_and_b32 v58, v5, v12
    v_and_b32 v59, v5, v13
    v_mfma_f32_16x16x32_bf16 v[60:63], a[132:135], v[52:55], v[60:63]
    s_nop 0
    v_mfma_f32_16x16x32_bf16 v[64:67], a[132:135], v[56:59], v[64:67]
    s_waitcnt vmcnt(14)
    buffer_load_dwordx4 a[168:171], v14, s[40:43], s63 offen nt
    s_add_u32 s63, s63, 8192
    v_perm_b32 v4, v21, v21, s80
    v_perm_b32 v5, v37, v37, s80
    v_and_b32 v52, v4, v10
    v_and_b32 v53, v4, v11
    v_and_b32 v54, v4, v12
    v_and_b32 v55, v4, v13
    v_and_b32 v56, v5, v10
    v_and_b32 v57, v5, v11
    v_and_b32 v58, v5, v12
    v_and_b32 v59, v5, v13
    v_mfma_f32_16x16x32_bf16 v[60:63], a[136:139], v[52:55], v[60:63]
    s_nop 0
    v_mfma_f32_16x16x32_bf16 v[64:67], a[136:139], v[56:59], v[64:67]
    s_waitcnt vmcnt(14)
    buffer_load_dwordx4 a[172:175], v14, s[40:43], s63 offen nt
    s_add_u32 s63, s63, 8192
    v_perm_b32 v4, v21, v21, s81
    v_perm_b32 v5, v37, v37, s81
    v_and_b32 v52, v4, v10
    v_and_b32 v53, v4, v11
    v_and_b32 v54, v4, v12
    v_and_b32 v55, v4, v13
    v_and_b32 v56, v5, v10
    v_and_b32 v57, v5, v11
    v_and_b32 v58, v5, v12
    v_and_b32 v59, v5, v13
    v_mfma_f32_16x16x32_bf16 v[60:63], a[140:143], v[52:55], v[60:63]
    s_nop 0
    v_mfma_f32_16x16x32_bf16 v[64:67], a[140:143], v[56:59], v[64:67]
    s_waitcnt vmcnt(14)
    buffer_load_dwordx4 a[176:179], v14, s[40:43], s63 offen nt
    s_add_u32 s63, s63, 8192
    v_lshrrev_b32 v4, 2, v3
    v_and_b32 v5, 3, v3
    v_lshlrev_b32 v76, 8, v4
    v_lshlrev_b32 v126, 8, v2
    v_lshl_add_u32 v76, v2, 6, v76
    v_lshl_add_u32 v76, v5, 4, v76
    v_lshl_add_u32 v126, v3, 4, v126
    v_xor_b32 v77, 32768, v76
    v_xor_b32 v127, 32768, v126
    s_add_u32 s3, s34, s33
    s_and_b32 s3, s3, 3
    s_lshl_b32 s89, s3, 5
    s_add_u32 s89, s89, s32
    s_lshl_b32 s89, s89, 20
    s_mul_i32 s88, s32, 8
    s_add_u32 s88, s88, s3
    s_lshl_b32 s87, s33, 0
    v_perm_b32 v4, v22, v22, s80
    v_perm_b32 v5, v38, v38, s80
    v_and_b32 v52, v4, v10
    v_and_b32 v53, v4, v11
    v_and_b32 v54, v4, v12
    v_and_b32 v55, v4, v13
    v_and_b32 v56, v5, v10
    v_and_b32 v57, v5, v11
    v_and_b32 v58, v5, v12
    v_and_b32 v59, v5, v13
    v_mfma_f32_16x16x32_bf16 v[60:63], a[144:147], v[52:55], v[60:63]
    s_nop 0
    v_mfma_f32_16x16x32_bf16 v[64:67], a[144:147], v[56:59], v[64:67]
    s_waitcnt vmcnt(14)
    buffer_load_dwordx4 a[180:183], v14, s[40:43], s63 offen nt
    s_add_u32 s63, s63, 8192
    v_perm_b32 v4, v22, v22, s81
    v_perm_b32 v5, v38, v38, s81
    v_and_b32 v52, v4, v10
    v_and_b32 v53, v4, v11
    v_and_b32 v54, v4, v12
    v_and_b32 v55, v4, v13
    v_and_b32 v56, v5, v10
    v_and_b32 v57, v5, v11
    v_and_b32 v58, v5, v12
    v_and_b32 v59, v5, v13
    v_mfma_f32_16x16x32_bf16 v[60:63], a[148:151], v[52:55], v[60:63]
    s_nop 0
    v_mfma_f32_16x16x32_bf16 v[64:67], a[148:151], v[56:59], v[64:67]
    s_waitcnt vmcnt(14)
    buffer_load_dwordx4 a[184:187], v14, s[40:43], s63 offen nt
    s_add_u32 s63, s63, 8192
    v_perm_b32 v4, v23, v23, s80
    v_perm_b32 v5, v39, v39, s80
    v_and_b32 v52, v4, v10
    v_and_b32 v53, v4, v11
    v_and_b32 v54, v4, v12
    v_and_b32 v55, v4, v13
    v_and_b32 v56, v5, v10
    v_and_b32 v57, v5, v11
    v_and_b32 v58, v5, v12
    v_and_b32 v59, v5, v13
    v_mfma_f32_16x16x32_bf16 v[60:63], a[152:155], v[52:55], v[60:63]
    s_nop 0
    v_mfma_f32_16x16x32_bf16 v[64:67], a[152:155], v[56:59], v[64:67]
    s_waitcnt vmcnt(14)
    buffer_load_dwordx4 a[188:191], v14, s[40:43], s63 offen nt
    s_add_u32 s63, s63, 8192
    v_perm_b32 v4, v23, v23, s81
    v_perm_b32 v5, v39, v39, s81
    v_and_b32 v52, v4, v10
    v_and_b32 v53, v4, v11
    v_and_b32 v54, v4, v12
    v_and_b32 v55, v4, v13
    v_and_b32 v56, v5, v10
    v_and_b32 v57, v5, v11
    v_and_b32 v58, v5, v12
    v_and_b32 v59, v5, v13
    v_mfma_f32_16x16x32_bf16 v[60:63], a[156:159], v[52:55], v[60:63]
    s_nop 0
    v_mfma_f32_16x16x32_bf16 v[64:67], a[156:159], v[56:59], v[64:67]
    s_waitcnt vmcnt(13)
    s_waitcnt vmcnt(7)
    buffer_load_dwordx4 a[192:195], v14, s[40:43], s63 offen nt
    s_add_u32 s63, s63, 8192
    s_mov_b32 s52, s18
    s_and_b32 s53, s19, 0xffff
    s_mov_b32 s54, 134217728
    s_mov_b32 s55, 0x20000
    s_mov_b32 s56, s20
    s_and_b32 s57, s21, 0xffff
    s_mov_b32 s58, 134217728
    s_mov_b32 s59, 0x20000
    v_perm_b32 v4, v24, v24, s80
    v_perm_b32 v5, v40, v40, s80
    v_and_b32 v52, v4, v10
    v_and_b32 v53, v4, v11
    v_and_b32 v54, v4, v12
    v_and_b32 v55, v4, v13
    v_and_b32 v56, v5, v10
    v_and_b32 v57, v5, v11
    v_and_b32 v58, v5, v12
    v_and_b32 v59, v5, v13
    v_mfma_f32_16x16x32_bf16 v[60:63], a[160:163], v[52:55], v[60:63]
    s_nop 0
    v_mfma_f32_16x16x32_bf16 v[64:67], a[160:163], v[56:59], v[64:67]
    s_waitcnt vmcnt(7)
    buffer_load_dwordx4 a[196:199], v14, s[40:43], s63 offen nt
    s_add_u32 s63, s63, 8192
    v_perm_b32 v4, v24, v24, s81
    v_perm_b32 v5, v40, v40, s81
    v_and_b32 v52, v4, v10
    v_and_b32 v53, v4, v11
    v_and_b32 v54, v4, v12
    v_and_b32 v55, v4, v13
    v_and_b32 v56, v5, v10
    v_and_b32 v57, v5, v11
    v_and_b32 v58, v5, v12
    v_and_b32 v59, v5, v13
    v_mfma_f32_16x16x32_bf16 v[60:63], a[164:167], v[52:55], v[60:63]
    s_nop 0
    v_mfma_f32_16x16x32_bf16 v[64:67], a[164:167], v[56:59], v[64:67]
    s_waitcnt vmcnt(7)
    buffer_load_dwordx4 a[200:203], v14, s[40:43], s63 offen nt
    s_add_u32 s63, s63, 8192
    v_perm_b32 v4, v25, v25, s80
    v_perm_b32 v5, v41, v41, s80
    v_and_b32 v52, v4, v10
    v_and_b32 v53, v4, v11
    v_and_b32 v54, v4, v12
    v_and_b32 v55, v4, v13
    v_and_b32 v56, v5, v10
    v_and_b32 v57, v5, v11
    v_and_b32 v58, v5, v12
    v_and_b32 v59, v5, v13
    v_mfma_f32_16x16x32_bf16 v[60:63], a[168:171], v[52:55], v[60:63]
    s_nop 0
    v_mfma_f32_16x16x32_bf16 v[64:67], a[168:171], v[56:59], v[64:67]
    s_waitcnt vmcnt(7)
    buffer_load_dwordx4 a[204:207], v14, s[40:43], s63 offen nt
    s_add_u32 s63, s63, 8192
    v_perm_b32 v4, v25, v25, s81
    v_perm_b32 v5, v41, v41, s81
    v_and_b32 v52, v4, v10
    v_and_b32 v53, v4, v11
    v_and_b32 v54, v4, v12
    v_and_b32 v55, v4, v13
    v_and_b32 v56, v5, v10
    v_and_b32 v57, v5, v11
    v_and_b32 v58, v5, v12
    v_and_b32 v59, v5, v13
    v_mfma_f32_16x16x32_bf16 v[60:63], a[172:175], v[52:55], v[60:63]
    s_nop 0
    v_mfma_f32_16x16x32_bf16 v[64:67], a[172:175], v[56:59], v[64:67]
    s_waitcnt vmcnt(7)
    buffer_load_dwordx4 a[208:211], v14, s[40:43], s63 offen nt
    s_add_u32 s63, s63, 8192
    v_mov_b32 v120, 0xff7f0000
    v_mov_b32 v121, 0
    v_mov_b32 v18, 1
    v_mov_b32 v116, 0
    v_mov_b32 v117, 0
    v_mov_b32 v118, 0
    v_mov_b32 v119, 0
    s_lshl_b32 s38, s32, 10
    s_add_u32 s96, s38, 65536
    s_lshl_b32 s38, s3, 8
    s_add_u32 s96, s38, s96
    v_mov_b32 v9, s96
    s_lshl_b32 s38, s32, 15
    s_add_u32 s96, s38, 1048576
    s_lshl_b32 s38, s3, 13
    s_add_u32 s96, s38, s96
    s_lshl_b32 s38, s33, 10
    s_add_u32 s96, s38, s96
    v_and_b32 v5, 3, v3
    v_lshlrev_b32 v78, 7, v2
    v_lshl_add_u32 v78, v5, 5, v78
    s_lshl_b32 s38, s32, 12
    s_add_u32 s91, s38, 262144
    s_lshl_b32 s38, s3, 9
    s_add_u32 s91, s38, s91
    v_lshlrev_b32 v4, 7, v2
    v_lshl_add_u32 v4, v3, 4, v4
    v_mov_b32 v5, 512
    v_cmp_gt_u32 vcc, 8, v3
    s_nop 1
    v_cndmask_b32 v79, v5, v4, vcc
    v_perm_b32 v4, v26, v26, s80
    v_perm_b32 v5, v42, v42, s80
    v_and_b32 v52, v4, v10
    v_and_b32 v53, v4, v11
    v_and_b32 v54, v4, v12
    v_and_b32 v55, v4, v13
    v_and_b32 v56, v5, v10
    v_and_b32 v57, v5, v11
    v_and_b32 v58, v5, v12
    v_and_b32 v59, v5, v13
    v_mfma_f32_16x16x32_bf16 v[60:63], a[176:179], v[52:55], v[60:63]
    s_nop 0
    v_mfma_f32_16x16x32_bf16 v[64:67], a[176:179], v[56:59], v[64:67]
    s_waitcnt vmcnt(7)
    buffer_load_dwordx4 a[212:215], v14, s[40:43], s63 offen nt
    s_add_u32 s63, s63, 8192
    v_perm_b32 v4, v26, v26, s81
    v_perm_b32 v5, v42, v42, s81
    v_and_b32 v52, v4, v10
    v_and_b32 v53, v4, v11
    v_and_b32 v54, v4, v12
    v_and_b32 v55, v4, v13
    v_and_b32 v56, v5, v10
    v_and_b32 v57, v5, v11
    v_and_b32 v58, v5, v12
    v_and_b32 v59, v5, v13
    v_mfma_f32_16x16x32_bf16 v[60:63], a[180:183], v[52:55], v[60:63]
    s_nop 0
    v_mfma_f32_16x16x32_bf16 v[64:67], a[180:183], v[56:59], v[64:67]
    s_waitcnt vmcnt(7)
    buffer_load_dwordx4 a[216:219], v14, s[40:43], s63 offen nt
    s_add_u32 s63, s63, 8192
    v_perm_b32 v4, v27, v27, s80
    v_perm_b32 v5, v43, v43, s80
    v_and_b32 v52, v4, v10
    v_and_b32 v53, v4, v11
    v_and_b32 v54, v4, v12
    v_and_b32 v55, v4, v13
    v_and_b32 v56, v5, v10
    v_and_b32 v57, v5, v11
    v_and_b32 v58, v5, v12
    v_and_b32 v59, v5, v13
    v_mfma_f32_16x16x32_bf16 v[60:63], a[184:187], v[52:55], v[60:63]
    s_nop 0
    v_mfma_f32_16x16x32_bf16 v[64:67], a[184:187], v[56:59], v[64:67]
    s_waitcnt vmcnt(7)
    buffer_load_dwordx4 a[220:223], v14, s[40:43], s63 offen nt
    s_add_u32 s63, s63, 8192
    v_perm_b32 v4, v27, v27, s81
    v_perm_b32 v5, v43, v43, s81
    v_and_b32 v52, v4, v10
    v_and_b32 v53, v4, v11
    v_and_b32 v54, v4, v12
    v_and_b32 v55, v4, v13
    v_and_b32 v56, v5, v10
    v_and_b32 v57, v5, v11
    v_and_b32 v58, v5, v12
    v_and_b32 v59, v5, v13
    v_mfma_f32_16x16x32_bf16 v[60:63], a[188:191], v[52:55], v[60:63]
    s_nop 0
    v_mfma_f32_16x16x32_bf16 v[64:67], a[188:191], v[56:59], v[64:67]
    s_waitcnt vmcnt(7)
    buffer_load_dwordx4 a[224:227], v14, s[40:43], s63 offen nt
    s_add_u32 s63, s63, 8192
    v_perm_b32 v4, v28, v28, s80
    v_perm_b32 v5, v44, v44, s80
    v_and_b32 v52, v4, v10
    v_and_b32 v53, v4, v11
    v_and_b32 v54, v4, v12
    v_and_b32 v55, v4, v13
    v_and_b32 v56, v5, v10
    v_and_b32 v57, v5, v11
    v_and_b32 v58, v5, v12
    v_and_b32 v59, v5, v13
    v_mfma_f32_16x16x32_bf16 v[60:63], a[192:195], v[52:55], v[60:63]
    s_nop 0
    v_mfma_f32_16x16x32_bf16 v[64:67], a[192:195], v[56:59], v[64:67]
    s_waitcnt vmcnt(7)
    buffer_load_dwordx4 a[228:231], v14, s[40:43], s63 offen nt
    s_add_u32 s63, s63, 8192
    v_perm_b32 v4, v28, v28, s81
    v_perm_b32 v5, v44, v44, s81
    v_and_b32 v52, v4, v10
    v_and_b32 v53, v4, v11
    v_and_b32 v54, v4, v12
    v_and_b32 v55, v4, v13
    v_and_b32 v56, v5, v10
    v_and_b32 v57, v5, v11
    v_and_b32 v58, v5, v12
    v_and_b32 v59, v5, v13
    v_mfma_f32_16x16x32_bf16 v[60:63], a[196:199], v[52:55], v[60:63]
    s_nop 0
    v_mfma_f32_16x16x32_bf16 v[64:67], a[196:199], v[56:59], v[64:67]
    s_waitcnt vmcnt(7)
    buffer_load_dwordx4 a[232:235], v14, s[40:43], s63 offen nt
    s_add_u32 s63, s63, 8192
    v_perm_b32 v4, v29, v29, s80
    v_perm_b32 v5, v45, v45, s80
    v_and_b32 v52, v4, v10
    v_and_b32 v53, v4, v11
    v_and_b32 v54, v4, v12
    v_and_b32 v55, v4, v13
    v_and_b32 v56, v5, v10
    v_and_b32 v57, v5, v11
    v_and_b32 v58, v5, v12
    v_and_b32 v59, v5, v13
    v_mfma_f32_16x16x32_bf16 v[60:63], a[200:203], v[52:55], v[60:63]
    s_nop 0
    v_mfma_f32_16x16x32_bf16 v[64:67], a[200:203], v[56:59], v[64:67]
    s_waitcnt vmcnt(7)
    buffer_load_dwordx4 a[236:239], v14, s[40:43], s63 offen nt
    s_add_u32 s63, s63, 8192
    v_perm_b32 v4, v29, v29, s81
    v_perm_b32 v5, v45, v45, s81
    v_and_b32 v52, v4, v10
    v_and_b32 v53, v4, v11
    v_and_b32 v54, v4, v12
    v_and_b32 v55, v4, v13
    v_and_b32 v56, v5, v10
    v_and_b32 v57, v5, v11
    v_and_b32 v58, v5, v12
    v_and_b32 v59, v5, v13
    v_mfma_f32_16x16x32_bf16 v[60:63], a[204:207], v[52:55], v[60:63]
    s_nop 0
    v_mfma_f32_16x16x32_bf16 v[64:67], a[204:207], v[56:59], v[64:67]
    s_waitcnt vmcnt(7)
    buffer_load_dwordx4 a[240:243], v14, s[40:43], s63 offen nt
    s_add_u32 s63, s63, 8192
    v_perm_b32 v4, v30, v30, s80
    v_perm_b32 v5, v46, v46, s80
    v_and_b32 v52, v4, v10
    v_and_b32 v53, v4, v11
    v_and_b32 v54, v4, v12
    v_and_b32 v55, v4, v13
    v_and_b32 v56, v5, v10
    v_and_b32 v57, v5, v11
    v_and_b32 v58, v5, v12
    v_and_b32 v59, v5, v13
    v_mfma_f32_16x16x32_bf16 v[60:63], a[208:211], v[52:55], v[60:63]
    s_nop 0
    v_mfma_f32_16x16x32_bf16 v[64:67], a[208:211], v[56:59], v[64:67]
    s_waitcnt vmcnt(7)
    buffer_load_dwordx4 a[244:247], v14, s[40:43], s63 offen nt
    s_add_u32 s63, s63, 8192
    v_perm_b32 v4, v30, v30, s81
    v_perm_b32 v5, v46, v46, s81
    v_and_b32 v52, v4, v10
    v_and_b32 v53, v4, v11
    v_and_b32 v54, v4, v12
    v_and_b32 v55, v4, v13
    v_and_b32 v56, v5, v10
    v_and_b32 v57, v5, v11
    v_and_b32 v58, v5, v12
    v_and_b32 v59, v5, v13
    v_mfma_f32_16x16x32_bf16 v[60:63], a[212:215], v[52:55], v[60:63]
    s_nop 0
    v_mfma_f32_16x16x32_bf16 v[64:67], a[212:215], v[56:59], v[64:67]
    s_waitcnt vmcnt(7)
    buffer_load_dwordx4 a[248:251], v14, s[40:43], s63 offen nt
    s_add_u32 s63, s63, 8192
    v_perm_b32 v4, v31, v31, s80
    v_perm_b32 v5, v47, v47, s80
    v_and_b32 v52, v4, v10
    v_and_b32 v53, v4, v11
    v_and_b32 v54, v4, v12
    v_and_b32 v55, v4, v13
    v_and_b32 v56, v5, v10
    v_and_b32 v57, v5, v11
    v_and_b32 v58, v5, v12
    v_and_b32 v59, v5, v13
    v_mfma_f32_16x16x32_bf16 v[60:63], a[216:219], v[52:55], v[60:63]
    s_nop 0
    v_mfma_f32_16x16x32_bf16 v[64:67], a[216:219], v[56:59], v[64:67]
    s_waitcnt vmcnt(7)
    buffer_load_dwordx4 a[252:255], v14, s[40:43], s63 offen nt
    s_add_u32 s63, s63, 8192
    v_perm_b32 v4, v31, v31, s81
    v_perm_b32 v5, v47, v47, s81
    v_and_b32 v52, v4, v10
    v_and_b32 v53, v4, v11
    v_and_b32 v54, v4, v12
    v_and_b32 v55, v4, v13
    v_and_b32 v56, v5, v10
    v_and_b32 v57, v5, v11
    v_and_b32 v58, v5, v12
    v_and_b32 v59, v5, v13
    v_mfma_f32_16x16x32_bf16 v[60:63], a[220:223], v[52:55], v[60:63]
    s_nop 0
    v_mfma_f32_16x16x32_bf16 v[64:67], a[220:223], v[56:59], v[64:67]
    s_waitcnt vmcnt(7)
    v_perm_b32 v4, v32, v32, s80
    v_perm_b32 v5, v48, v48, s80
    v_and_b32 v52, v4, v10
    v_and_b32 v53, v4, v11
    v_and_b32 v54, v4, v12
    v_and_b32 v55, v4, v13
    v_and_b32 v56, v5, v10
    v_and_b32 v57, v5, v11
    v_and_b32 v58, v5, v12
    v_and_b32 v59, v5, v13
    v_mfma_f32_16x16x32_bf16 v[60:63], a[224:227], v[52:55], v[60:63]
    s_nop 0
    v_mfma_f32_16x16x32_bf16 v[64:67], a[224:227], v[56:59], v[64:67]
    s_waitcnt vmcnt(6)
    s_add_u32 s39, s87, s88
    s_bfe_u32 s37, s39, 0x30000
    s_lshl_b32 s37, s37, 12
    s_add_u32 s85, s37, s89
    s_bfe_u32 s37, s39, 0x10003
    s_lshl_b32 s37, s37, 11
    s_add_u32 s85, s37, s85
    s_bfe_u32 s37, s39, 0x40004
    s_lshl_b32 s37, s37, 16
    s_add_u32 s85, s37, s85
    buffer_load_dwordx4 v[128:131], v76, s[52:55], s85 offen offset:0 nt
    v_perm_b32 v4, v32, v32, s81
    v_perm_b32 v5, v48, v48, s81
    v_and_b32 v52, v4, v10
    v_and_b32 v53, v4, v11
    v_and_b32 v54, v4, v12
    v_and_b32 v55, v4, v13
    v_and_b32 v56, v5, v10
    v_and_b32 v57, v5, v11
    v_and_b32 v58, v5, v12
    v_and_b32 v59, v5, v13
    v_mfma_f32_16x16x32_bf16 v[60:63], a[228:231], v[52:55], v[60:63]
    s_nop 0
    v_mfma_f32_16x16x32_bf16 v[64:67], a[228:231], v[56:59], v[64:67]
    s_waitcnt vmcnt(6)
    buffer_load_dwordx4 v[132:135], v77, s[52:55], s85 offen offset:0 nt
    v_perm_b32 v4, v33, v33, s80
    v_perm_b32 v5, v49, v49, s80
    v_and_b32 v52, v4, v10
    v_and_b32 v53, v4, v11
    v_and_b32 v54, v4, v12
    v_and_b32 v55, v4, v13
    v_and_b32 v56, v5, v10
    v_and_b32 v57, v5, v11
    v_and_b32 v58, v5, v12
    v_and_b32 v59, v5, v13
    v_mfma_f32_16x16x32_bf16 v[60:63], a[232:235], v[52:55], v[60:63]
    s_nop 0
    v_mfma_f32_16x16x32_bf16 v[64:67], a[232:235], v[56:59], v[64:67]
    s_waitcnt vmcnt(6)
    buffer_load_dwordx4 v[136:139], v76, s[52:55], s85 offen offset:1024 nt
    v_perm_b32 v4, v33, v33, s81
    v_perm_b32 v5, v49, v49, s81
    v_and_b32 v52, v4, v10
    v_and_b32 v53, v4, v11
    v_and_b32 v54, v4, v12
    v_and_b32 v55, v4, v13
    v_and_b32 v56, v5, v10
    v_and_b32 v57, v5, v11
    v_and_b32 v58, v5, v12
    v_and_b32 v59, v5, v13
    v_mfma_f32_16x16x32_bf16 v[60:63], a[236:239], v[52:55], v[60:63]
    s_nop 0
    v_mfma_f32_16x16x32_bf16 v[64:67], a[236:239], v[56:59], v[64:67]
    s_waitcnt vmcnt(6)
    buffer_load_dwordx4 v[140:143], v77, s[52:55], s85 offen offset:1024 nt
    s_add_u32 s87, s87, 7
    s_add_u32 s39, s87, s88
    s_bfe_u32 s37, s39, 0x30000
    s_lshl_b32 s37, s37, 12
    s_add_u32 s85, s37, s89
    s_bfe_u32 s37, s39, 0x10003
    s_lshl_b32 s37, s37, 11
    s_add_u32 s85, s37, s85
    s_bfe_u32 s37, s39, 0x40004
    s_lshl_b32 s37, s37, 16
    s_add_u32 s85, s37, s85
    v_perm_b32 v4, v34, v34, s80
    v_perm_b32 v5, v50, v50, s80
    v_and_b32 v52, v4, v10
    v_and_b32 v53, v4, v11
    v_and_b32 v54, v4, v12
    v_and_b32 v55, v4, v13
    v_and_b32 v56, v5, v10
    v_and_b32 v57, v5, v11
    v_and_b32 v58, v5, v12
    v_and_b32 v59, v5, v13
    v_mfma_f32_16x16x32_bf16 v[60:63], a[240:243], v[52:55], v[60:63]
    s_nop 0
    v_mfma_f32_16x16x32_bf16 v[64:67], a[240:243], v[56:59], v[64:67]
    s_waitcnt vmcnt(6)
    buffer_load_dwordx4 v[144:147], v76, s[52:55], s85 offen offset:0 nt
    v_perm_b32 v4, v34, v34, s81
    v_perm_b32 v5, v50, v50, s81
    v_and_b32 v52, v4, v10
    v_and_b32 v53, v4, v11
    v_and_b32 v54, v4, v12
    v_and_b32 v55, v4, v13
    v_and_b32 v56, v5, v10
    v_and_b32 v57, v5, v11
    v_and_b32 v58, v5, v12
    v_and_b32 v59, v5, v13
    v_mfma_f32_16x16x32_bf16 v[60:63], a[244:247], v[52:55], v[60:63]
    s_nop 0
    v_mfma_f32_16x16x32_bf16 v[64:67], a[244:247], v[56:59], v[64:67]
    s_waitcnt vmcnt(6)
    buffer_load_dwordx4 v[148:151], v77, s[52:55], s85 offen offset:0 nt
    v_perm_b32 v4, v35, v35, s80
    v_perm_b32 v5, v51, v51, s80
    v_and_b32 v52, v4, v10
    v_and_b32 v53, v4, v11
    v_and_b32 v54, v4, v12
    v_and_b32 v55, v4, v13
    v_and_b32 v56, v5, v10
    v_and_b32 v57, v5, v11
    v_and_b32 v58, v5, v12
    v_and_b32 v59, v5, v13
    v_mfma_f32_16x16x32_bf16 v[60:63], a[248:251], v[52:55], v[60:63]
    s_nop 0
    v_mfma_f32_16x16x32_bf16 v[64:67], a[248:251], v[56:59], v[64:67]
    s_waitcnt vmcnt(6)
    buffer_load_dwordx4 v[152:155], v76, s[52:55], s85 offen offset:1024 nt
    v_perm_b32 v4, v35, v35, s81
    v_perm_b32 v5, v51, v51, s81
    v_and_b32 v52, v4, v10
    v_and_b32 v53, v4, v11
    v_and_b32 v54, v4, v12
    v_and_b32 v55, v4, v13
    v_and_b32 v56, v5, v10
    v_and_b32 v57, v5, v11
    v_and_b32 v58, v5, v12
    v_and_b32 v59, v5, v13
    v_mfma_f32_16x16x32_bf16 v[60:63], a[252:255], v[52:55], v[60:63]
    s_nop 0
    v_mfma_f32_16x16x32_bf16 v[64:67], a[252:255], v[56:59], v[64:67]
    s_lshl_b32 s38, s34, 11
    v_lshrrev_b32 v4, 3, v3
    v_lshlrev_b32 v4, 9, v4
    v_lshl_add_u32 v4, v2, 7, v4
    v_and_b32 v5, 7, v3
    v_lshl_add_u32 v4, v5, 2, v4
    v_add_u32 v4, s38, v4
    ds_write_b32 v4, v60 offset:0
    ds_write_b32 v4, v61 offset:32
    ds_write_b32 v4, v62 offset:64
    ds_write_b32 v4, v63 offset:96
    ds_write_b32 v4, v64 offset:1024
    ds_write_b32 v4, v65 offset:1056
    ds_write_b32 v4, v66 offset:1088
    ds_write_b32 v4, v67 offset:1120
    s_lshl_b32 s38, s34, 9
    v_and_b32 v5, 31, v1
    v_lshl_add_u32 v5, v5, 4, s38
    s_waitcnt lgkmcnt(0)
    s_add_u32 s35, s35, 0x5b
    s_and_b32 s35, s35, 0xff
    v_mov_b32 v8, s35
    s_barrier
    ds_read_b128 v[20:23], v5 offset:0
    ds_read_b128 v[24:27], v5 offset:2048
    ds_read_b128 v[28:31], v5 offset:4096
    ds_read_b128 v[32:35], v5 offset:6144
    s_lshl_b32 s38, s61, 12
    s_add_u32 s36, s38, 262144
    s_lshl_b32 s38, s33, 11
    s_add_u32 s36, s38, s36
    s_waitcnt lgkmcnt(0)
    v_add_f32 v20, v20, v24
    v_add_f32 v28, v28, v32
    v_add_f32 v21, v21, v25
    v_add_f32 v29, v29, v33
    v_add_f32 v22, v22, v26
    v_add_f32 v30, v30, v34
    v_add_f32 v23, v23, v27
    v_add_f32 v31, v31, v35
    v_add_f32 v20, v20, v28
    v_add_f32 v21, v21, v29
    v_add_f32 v22, v22, v30
    v_add_f32 v23, v23, v31
    s_mov_b32 s38, 0xffff0000
    v_cvt_pk_bf16_f32 v20, v20, v20
    v_cvt_pk_bf16_f32 v21, v21, v21
    v_cvt_pk_bf16_f32 v22, v22, v22
    v_cvt_pk_bf16_f32 v23, v23, v23
    v_and_or_b32 v20, v20, s38, v8
    v_and_or_b32 v21, v21, s38, v8
    v_and_or_b32 v22, v22, s38, v8
    v_and_or_b32 v23, v23, s38, v8
    s_mov_b32 exec_lo, 0xffffffff
    s_mov_b32 exec_hi, 0x0
    buffer_store_dwordx4 v[20:23], v5, s[48:51], s36 offen sc1
    s_mov_b64 exec, -1
    s_waitcnt vmcnt(7)
    buffer_load_dwordx4 v[156:159], v77, s[52:55], s85 offen offset:1024 nt
    s_add_u32 s87, s87, 7
    s_add_u32 s39, s87, s88
    s_bfe_u32 s37, s39, 0x30000
    s_lshl_b32 s37, s37, 12
    s_add_u32 s85, s37, s89
    s_bfe_u32 s37, s39, 0x10003
    s_lshl_b32 s37, s37, 11
    s_add_u32 s85, s37, s85
    s_bfe_u32 s37, s39, 0x40004
    s_lshl_b32 s37, s37, 16
    s_add_u32 s85, s37, s85
    s_waitcnt vmcnt(7)
    buffer_load_dwordx4 v[160:163], v76, s[52:55], s85 offen offset:0 nt
    s_waitcnt vmcnt(7)
    buffer_load_dwordx4 v[164:167], v77, s[52:55], s85 offen offset:0 nt
    s_waitcnt vmcnt(7)
    buffer_load_dwordx4 v[168:171], v76, s[52:55], s85 offen offset:1024 nt
    s_waitcnt vmcnt(7)
    buffer_load_dwordx4 v[172:175], v77, s[52:55], s85 offen offset:1024 nt
    s_add_u32 s87, s87, 7
    s_add_u32 s39, s87, s88
    s_bfe_u32 s37, s39, 0x30000
    s_lshl_b32 s37, s37, 12
    s_add_u32 s85, s37, s89
    s_bfe_u32 s37, s39, 0x10003
    s_lshl_b32 s37, s37, 11
    s_add_u32 s85, s37, s85
    s_bfe_u32 s37, s39, 0x40004
    s_lshl_b32 s37, s37, 16
    s_add_u32 s85, s37, s85
    s_waitcnt vmcnt(7)
    buffer_load_dwordx4 v[176:179], v76, s[52:55], s85 offen offset:0 nt
    s_waitcnt vmcnt(7)
    buffer_load_dwordx4 v[180:183], v77, s[52:55], s85 offen offset:0 nt
    s_waitcnt vmcnt(6)
    buffer_load_dwordx4 v[184:187], v76, s[52:55], s85 offen offset:1024 nt
    s_waitcnt vmcnt(6)
    buffer_load_dwordx4 v[188:191], v77, s[52:55], s85 offen offset:1024 nt
    s_add_u32 s87, s87, 7
    s_add_u32 s39, s87, s88
    s_bfe_u32 s37, s39, 0x30000
    s_lshl_b32 s37, s37, 12
    s_add_u32 s85, s37, s89
    s_bfe_u32 s37, s39, 0x10003
    s_lshl_b32 s37, s37, 11
    s_add_u32 s85, s37, s85
    s_bfe_u32 s37, s39, 0x40004
    s_lshl_b32 s37, s37, 16
    s_add_u32 s85, s37, s85
    s_waitcnt vmcnt(6)
    buffer_load_dwordx4 v[192:195], v76, s[52:55], s85 offen offset:0 nt
    s_waitcnt vmcnt(6)
    buffer_load_dwordx4 v[196:199], v77, s[52:55], s85 offen offset:0 nt
    s_waitcnt vmcnt(6)
    buffer_load_dwordx4 v[200:203], v76, s[52:55], s85 offen offset:1024 nt
    s_waitcnt vmcnt(6)
    buffer_load_dwordx4 v[204:207], v77, s[52:55], s85 offen offset:1024 nt
    s_add_u32 s87, s87, 7
    s_add_u32 s39, s87, s88
    s_bfe_u32 s37, s39, 0x30000
    s_lshl_b32 s37, s37, 12
    s_add_u32 s85, s37, s89
    s_bfe_u32 s37, s39, 0x10003
    s_lshl_b32 s37, s37, 11
    s_add_u32 s85, s37, s85
    s_bfe_u32 s37, s39, 0x40004
    s_lshl_b32 s37, s37, 16
    s_add_u32 s85, s37, s85
    s_waitcnt vmcnt(6)
    buffer_load_dwordx4 v[208:211], v76, s[52:55], s85 offen offset:0 nt
    s_waitcnt vmcnt(6)
    buffer_load_dwordx4 v[212:215], v77, s[52:55], s85 offen offset:0 nt
    s_waitcnt vmcnt(6)
    buffer_load_dwordx4 v[216:219], v76, s[52:55], s85 offen offset:1024 nt
    s_waitcnt vmcnt(6)
    buffer_load_dwordx4 v[220:223], v77, s[52:55], s85 offen offset:1024 nt
    s_add_u32 s87, s87, 7
    s_add_u32 s39, s87, s88
    s_bfe_u32 s37, s39, 0x30000
    s_lshl_b32 s37, s37, 12
    s_add_u32 s85, s37, s89
    s_bfe_u32 s37, s39, 0x10003
    s_lshl_b32 s37, s37, 11
    s_add_u32 s85, s37, s85
    s_bfe_u32 s37, s39, 0x40004
    s_lshl_b32 s37, s37, 16
    s_add_u32 s85, s37, s85
    s_waitcnt vmcnt(6)
    buffer_load_dwordx4 v[224:227], v76, s[52:55], s85 offen offset:0 nt
    s_waitcnt vmcnt(6)
    buffer_load_dwordx4 v[228:231], v77, s[52:55], s85 offen offset:0 nt
    s_waitcnt vmcnt(6)
    buffer_load_dwordx4 v[232:235], v76, s[52:55], s85 offen offset:1024 nt
    s_waitcnt vmcnt(6)
    buffer_load_dwordx4 v[236:239], v77, s[52:55], s85 offen offset:1024 nt
    s_add_u32 s87, s87, 7
    s_add_u32 s39, s87, s88
    s_bfe_u32 s37, s39, 0x30000
    s_lshl_b32 s37, s37, 12
    s_add_u32 s85, s37, s89
    s_bfe_u32 s37, s39, 0x10003
    s_lshl_b32 s37, s37, 11
    s_add_u32 s85, s37, s85
    s_bfe_u32 s37, s39, 0x40004
    s_lshl_b32 s37, s37, 16
    s_add_u32 s85, s37, s85
    s_waitcnt vmcnt(6)
    buffer_load_dwordx4 v[240:243], v76, s[52:55], s85 offen offset:0 nt
    s_waitcnt vmcnt(6)
    buffer_load_dwordx4 v[244:247], v77, s[52:55], s85 offen offset:0 nt
    s_waitcnt vmcnt(6)
    buffer_load_dwordx4 v[248:251], v76, s[52:55], s85 offen offset:1024 nt
    s_waitcnt vmcnt(6)
    buffer_load_dwordx4 v[252:255], v77, s[52:55], s85 offen offset:1024 nt
    s_add_u32 s87, s87, 7
    s_add_u32 s39, s87, s88
    s_bfe_u32 s37, s39, 0x30000
    s_lshl_b32 s37, s37, 12
    s_add_u32 s85, s37, s89
    s_bfe_u32 s37, s39, 0x10003
    s_lshl_b32 s37, s37, 11
    s_add_u32 s85, s37, s85
    s_bfe_u32 s37, s39, 0x40004
    s_lshl_b32 s37, s37, 16
    s_add_u32 s85, s37, s85
    s_waitcnt vmcnt(6)
    buffer_load_dwordx4 a[0:3], v76, s[52:55], s85 offen offset:0 nt
    s_waitcnt vmcnt(6)
    buffer_load_dwordx4 a[4:7], v77, s[52:55], s85 offen offset:0 nt
    buffer_load_dwordx4 v[68:71], v78, s[48:51], s91 offen offset:0 sc1
    buffer_load_dwordx4 v[72:75], v78, s[48:51], s91 offen offset:16 sc1
    s_waitcnt vmcnt(8)
    buffer_load_dwordx4 a[8:11], v76, s[52:55], s85 offen offset:1024 nt
    s_waitcnt vmcnt(8)
    buffer_load_dwordx4 a[12:15], v77, s[52:55], s85 offen offset:1024 nt
    s_add_u32 s87, s87, 7
    s_add_u32 s39, s87, s88
    s_bfe_u32 s37, s39, 0x30000
    s_lshl_b32 s37, s37, 12
    s_add_u32 s85, s37, s89
    s_bfe_u32 s37, s39, 0x10003
    s_lshl_b32 s37, s37, 11
    s_add_u32 s85, s37, s85
    s_bfe_u32 s37, s39, 0x40004
    s_lshl_b32 s37, s37, 16
    s_add_u32 s85, s37, s85
    s_waitcnt vmcnt(8)
    buffer_load_dwordx4 a[16:19], v76, s[52:55], s85 offen offset:0 nt
    s_waitcnt vmcnt(8)
    buffer_load_dwordx4 a[20:23], v77, s[52:55], s85 offen offset:0 nt
    s_waitcnt vmcnt(8)
    buffer_load_dwordx4 a[24:27], v76, s[52:55], s85 offen offset:1024 nt
    s_waitcnt vmcnt(8)
    buffer_load_dwordx4 a[28:31], v77, s[52:55], s85 offen offset:1024 nt
    s_add_u32 s87, s87, 7
    s_add_u32 s39, s87, s88
    s_bfe_u32 s37, s39, 0x30000
    s_lshl_b32 s37, s37, 12
    s_add_u32 s85, s37, s89
    s_bfe_u32 s37, s39, 0x10003
    s_lshl_b32 s37, s37, 11
    s_add_u32 s85, s37, s85
    s_bfe_u32 s37, s39, 0x40004
    s_lshl_b32 s37, s37, 16
    s_add_u32 s85, s37, s85
    s_waitcnt vmcnt(6)
L_qcheck_17:
    v_xor_b32 v68, s35, v68
    v_xor_b32 v69, s35, v69
    v_xor_b32 v70, s35, v70
    v_xor_b32 v71, s35, v71
    v_xor_b32 v72, s35, v72
    v_xor_b32 v73, s35, v73
    v_xor_b32 v74, s35, v74
    v_xor_b32 v75, s35, v75
    v_or_b32 v4, v68, v69
    v_or3_b32 v4, v4, v70, v71
    v_or3_b32 v4, v4, v72, v73
    v_or3_b32 v4, v4, v74, v75
    v_and_b32 v4, 0xff, v4
    v_cmp_ne_u32 vcc, 0, v4
    s_cbranch_vccz L_qok_18
    buffer_load_dwordx4 v[68:71], v78, s[48:51], s91 offen offset:0 sc1
    buffer_load_dwordx4 v[72:75], v78, s[48:51], s91 offen offset:16 sc1
    s_waitcnt vmcnt(0)
    s_sub_u32 s84, s84, 1
    s_cmp_lg_u32 s84, 0
    s_cbranch_scc1 L_qcheck_17
    s_branch L_end
L_qok_18:
    v_cvt_pk_bf16_f32 v68, v68, v69
    v_cvt_pk_bf16_f32 v69, v70, v71
    v_cvt_pk_bf16_f32 v70, v72, v73
    v_cvt_pk_bf16_f32 v71, v74, v75
    s_mov_b32 vcc_lo, 0xf000f
    s_mov_b32 vcc_hi, 0xf000f
    v_cndmask_b32 v80, 0, v68, vcc
    v_cndmask_b32 v81, 0, v69, vcc
    v_cndmask_b32 v82, 0, v70, vcc
    v_cndmask_b32 v83, 0, v71, vcc
    s_mov_b32 vcc_lo, 0xf000f0
    s_mov_b32 vcc_hi, 0xf000f0
    v_cndmask_b32 v84, 0, v68, vcc
    v_cndmask_b32 v85, 0, v69, vcc
    v_cndmask_b32 v86, 0, v70, vcc
    v_cndmask_b32 v87, 0, v71, vcc
    s_mov_b32 vcc_lo, 0xf000f00
    s_mov_b32 vcc_hi, 0xf000f00
    v_cndmask_b32 v88, 0, v68, vcc
    v_cndmask_b32 v89, 0, v69, vcc
    v_cndmask_b32 v90, 0, v70, vcc
    v_cndmask_b32 v91, 0, v71, vcc
    s_mov_b32 vcc_lo, 0xf000f000
    s_mov_b32 vcc_hi, 0xf000f000
    v_cndmask_b32 v92, 0, v68, vcc
    v_cndmask_b32 v93, 0, v69, vcc
    v_cndmask_b32 v94, 0, v70, vcc
    v_cndmask_b32 v95, 0, v71, vcc
    v_mov_b32 v65, 0xff7f0000
    s_lshl_b32 s38, s34, 14
    s_add_u32 s38, s38, 16384
    v_lshl_add_u32 v64, v1, 2, s38
    buffer_load_dwordx4 a[32:35], v76, s[52:55], s85 offen offset:0 nt
    v_mfma_f32_16x16x32_bf16 v[112:115], v[128:131], v[80:83], 0
    v_mfma_f32_16x16x32_bf16 v[112:115], v[132:135], v[84:87], v[112:115]
    v_mfma_f32_16x16x32_bf16 v[112:115], v[136:139], v[88:91], v[112:115]
    s_waitcnt vmcnt(6)
    buffer_load_dwordx4 a[36:39], v77, s[52:55], s85 offen offset:0 nt
    v_mfma_f32_16x16x32_bf16 v[112:115], v[140:143], v[92:95], v[112:115]
    v_mfma_f32_16x16x32_bf16 v[96:99], v[144:147], v[80:83], 0
    v_mfma_f32_16x16x32_bf16 v[96:99], v[148:151], v[84:87], v[96:99]
    s_waitcnt vmcnt(6)
    buffer_load_dwordx4 a[40:43], v76, s[52:55], s85 offen offset:1024 nt
    v_mfma_f32_16x16x32_bf16 v[96:99], v[152:155], v[88:91], v[96:99]
    s_nop 2
    v_mov_b32_dpp v122, v112 quad_perm:[0,0,0,0] row_mask:0xf bank_mask:0xf
    v_mov_b32_dpp v124, v114 quad_perm:[2,2,2,2] row_mask:0xf bank_mask:0xf
    s_nop 0
    v_add_f32_dpp v122, v113, v122 quad_perm:[1,1,1,1] row_mask:0xf bank_mask:0xf
    v_add_f32_dpp v124, v115, v124 quad_perm:[3,3,3,3] row_mask:0xf bank_mask:0xf
    v_add_f32 v122, v122, v124
    v_max_f32 v65, v65, v122
    ds_write_b32 v64, v122 offset:0
    v_mfma_f32_16x16x32_bf16 v[96:99], v[156:159], v[92:95], v[96:99]
    v_mfma_f32_16x16x32_bf16 v[112:115], v[160:163], v[80:83], 0
    v_mfma_f32_16x16x32_bf16 v[112:115], v[164:167], v[84:87], v[112:115]
    s_waitcnt vmcnt(6)
    buffer_load_dwordx4 a[44:47], v77, s[52:55], s85 offen offset:1024 nt
    s_add_u32 s87, s87, 7
    s_add_u32 s39, s87, s88
    s_bfe_u32 s37, s39, 0x30000
    s_lshl_b32 s37, s37, 12
    s_add_u32 s85, s37, s89
    s_bfe_u32 s37, s39, 0x10003
    s_lshl_b32 s37, s37, 11
    s_add_u32 s85, s37, s85
    s_bfe_u32 s37, s39, 0x40004
    s_lshl_b32 s37, s37, 16
    s_add_u32 s85, s37, s85
    v_mfma_f32_16x16x32_bf16 v[112:115], v[168:171], v[88:91], v[112:115]
    v_mov_b32_dpp v122, v96 quad_perm:[0,0,0,0] row_mask:0xf bank_mask:0xf
    v_mov_b32_dpp v124, v98 quad_perm:[2,2,2,2] row_mask:0xf bank_mask:0xf
    s_nop 0
    v_add_f32_dpp v122, v97, v122 quad_perm:[1,1,1,1] row_mask:0xf bank_mask:0xf
    v_add_f32_dpp v124, v99, v124 quad_perm:[3,3,3,3] row_mask:0xf bank_mask:0xf
    v_add_f32 v122, v122, v124
    v_max_f32 v65, v65, v122
    ds_write_b32 v64, v122 offset:256
    v_mfma_f32_16x16x32_bf16 v[112:115], v[172:175], v[92:95], v[112:115]
    v_mfma_f32_16x16x32_bf16 v[96:99], v[176:179], v[80:83], 0
    s_waitcnt vmcnt(6)
    buffer_load_dwordx4 a[48:51], v76, s[52:55], s85 offen offset:0 nt
    v_mfma_f32_16x16x32_bf16 v[96:99], v[180:183], v[84:87], v[96:99]
    v_mfma_f32_16x16x32_bf16 v[96:99], v[184:187], v[88:91], v[96:99]
    s_nop 2
    v_mov_b32_dpp v122, v112 quad_perm:[0,0,0,0] row_mask:0xf bank_mask:0xf
    v_mov_b32_dpp v124, v114 quad_perm:[2,2,2,2] row_mask:0xf bank_mask:0xf
    s_nop 0
    v_add_f32_dpp v122, v113, v122 quad_perm:[1,1,1,1] row_mask:0xf bank_mask:0xf
    v_add_f32_dpp v124, v115, v124 quad_perm:[3,3,3,3] row_mask:0xf bank_mask:0xf
    v_add_f32 v122, v122, v124
    v_max_f32 v65, v65, v122
    ds_write_b32 v64, v122 offset:512
    v_mfma_f32_16x16x32_bf16 v[96:99], v[188:191], v[92:95], v[96:99]
    v_mfma_f32_16x16x32_bf16 v[112:115], v[192:195], v[80:83], 0
    s_waitcnt vmcnt(6)
    buffer_load_dwordx4 a[52:55], v77, s[52:55], s85 offen offset:0 nt
    v_mfma_f32_16x16x32_bf16 v[112:115], v[196:199], v[84:87], v[112:115]
    v_mfma_f32_16x16x32_bf16 v[112:115], v[200:203], v[88:91], v[112:115]
    s_nop 2
    v_mov_b32_dpp v122, v96 quad_perm:[0,0,0,0] row_mask:0xf bank_mask:0xf
    v_mov_b32_dpp v124, v98 quad_perm:[2,2,2,2] row_mask:0xf bank_mask:0xf
    s_nop 0
    v_add_f32_dpp v122, v97, v122 quad_perm:[1,1,1,1] row_mask:0xf bank_mask:0xf
    v_add_f32_dpp v124, v99, v124 quad_perm:[3,3,3,3] row_mask:0xf bank_mask:0xf
    v_add_f32 v122, v122, v124
    v_max_f32 v65, v65, v122
    ds_write_b32 v64, v122 offset:768
    v_mfma_f32_16x16x32_bf16 v[112:115], v[204:207], v[92:95], v[112:115]
    s_waitcnt vmcnt(6)
    buffer_load_dwordx4 a[56:59], v76, s[52:55], s85 offen offset:1024 nt
    v_mfma_f32_16x16x32_bf16 v[96:99], v[208:211], v[80:83], 0
    v_mfma_f32_16x16x32_bf16 v[96:99], v[212:215], v[84:87], v[96:99]
    v_mfma_f32_16x16x32_bf16 v[96:99], v[216:219], v[88:91], v[96:99]
    s_nop 2
    v_mov_b32_dpp v122, v112 quad_perm:[0,0,0,0] row_mask:0xf bank_mask:0xf
    v_mov_b32_dpp v124, v114 quad_perm:[2,2,2,2] row_mask:0xf bank_mask:0xf
    s_nop 0
    v_add_f32_dpp v122, v113, v122 quad_perm:[1,1,1,1] row_mask:0xf bank_mask:0xf
    v_add_f32_dpp v124, v115, v124 quad_perm:[3,3,3,3] row_mask:0xf bank_mask:0xf
    v_add_f32 v122, v122, v124
    v_max_f32 v65, v65, v122
    ds_write_b32 v64, v122 offset:1024
    v_mfma_f32_16x16x32_bf16 v[96:99], v[220:223], v[92:95], v[96:99]
    s_waitcnt vmcnt(6)
    buffer_load_dwordx4 a[60:63], v77, s[52:55], s85 offen offset:1024 nt
    s_add_u32 s87, s87, 7
    s_add_u32 s39, s87, s88
    s_bfe_u32 s37, s39, 0x30000
    s_lshl_b32 s37, s37, 12
    s_add_u32 s85, s37, s89
    s_bfe_u32 s37, s39, 0x10003
    s_lshl_b32 s37, s37, 11
    s_add_u32 s85, s37, s85
    s_bfe_u32 s37, s39, 0x40004
    s_lshl_b32 s37, s37, 16
    s_add_u32 s85, s37, s85
    v_mfma_f32_16x16x32_bf16 v[112:115], v[224:227], v[80:83], 0
    s_sub_u32 s36, s33, 3
    s_and_b32 s37, s33, 3
    s_cmp_lt_u32 s36, 4
    s_cselect_b64 s[40:41], s[24:25], s[14:15]
    s_cselect_b32 s36, s36, s37
    s_cselect_b32 s45, 262144, 0
    s_cselect_b32 s46, 8388608, 0
    s_add_u32 s45, s45, 524288
    s_add_u32 s46, s46, 196608
    s_mov_b32 s42, 4194304
    s_mov_b32 s43, 0x20000
    s_lshl_b32 s38, s32, 17
    s_add_u32 s44, s38, 0
    s_lshl_b32 s38, s34, 15
    s_add_u32 s44, s38, s44
    s_lshl_b32 s38, s36, 8
    s_add_u32 s44, s38, s44
    s_lshl_b32 s38, s36, 16
    s_add_u32 s45, s38, s45
    s_lshr_b32 s38, s34, 1
    s_lshl_b32 s38, s38, 15
    s_add_u32 s45, s38, s45
    s_lshl_b32 s38, s32, 8
    s_add_u32 s45, s38, s45
    s_bfe_u32 s38, s34, 0x10000
    s_lshl_b32 s38, s38, 7
    s_add_u32 s45, s38, s45
    s_lshl_b32 s38, s32, 11
    s_add_u32 s46, s38, s46
    s_lshl_b32 s38, s34, 9
    s_add_u32 s46, s38, s46
    s_mov_b32 s72, s26
    s_and_b32 s73, s27, 0xffff
    s_mov_b32 s74, 8192
    s_mov_b32 s75, 0x20000
    v_mfma_f32_16x16x32_bf16 v[112:115], v[228:231], v[84:87], v[112:115]
    v_mfma_f32_16x16x32_bf16 v[112:115], v[232:235], v[88:91], v[112:115]
    v_mov_b32_dpp v122, v96 quad_perm:[0,0,0,0] row_mask:0xf bank_mask:0xf
    v_mov_b32_dpp v124, v98 quad_perm:[2,2,2,2] row_mask:0xf bank_mask:0xf
    s_nop 0
    v_add_f32_dpp v122, v97, v122 quad_perm:[1,1,1,1] row_mask:0xf bank_mask:0xf
    v_add_f32_dpp v124, v99, v124 quad_perm:[3,3,3,3] row_mask:0xf bank_mask:0xf
    v_add_f32 v122, v122, v124
    v_max_f32 v65, v65, v122
    ds_write_b32 v64, v122 offset:1280
    s_waitcnt vmcnt(5)
    buffer_load_dwordx4 v[128:131], v76, s[52:55], s85 offen offset:0 nt
    v_mfma_f32_16x16x32_bf16 v[112:115], v[236:239], v[92:95], v[112:115]
    v_mfma_f32_16x16x32_bf16 v[96:99], v[240:243], v[80:83], 0
    v_mfma_f32_16x16x32_bf16 v[96:99], v[244:247], v[84:87], v[96:99]
    s_waitcnt vmcnt(5)
    buffer_load_dwordx4 v[132:135], v77, s[52:55], s85 offen offset:0 nt
    v_mfma_f32_16x16x32_bf16 v[96:99], v[248:251], v[88:91], v[96:99]
    s_nop 2
    v_mov_b32_dpp v122, v112 quad_perm:[0,0,0,0] row_mask:0xf bank_mask:0xf
    v_mov_b32_dpp v124, v114 quad_perm:[2,2,2,2] row_mask:0xf bank_mask:0xf
    s_nop 0
    v_add_f32_dpp v122, v113, v122 quad_perm:[1,1,1,1] row_mask:0xf bank_mask:0xf
    v_add_f32_dpp v124, v115, v124 quad_perm:[3,3,3,3] row_mask:0xf bank_mask:0xf
    v_add_f32 v122, v122, v124
    v_max_f32 v65, v65, v122
    ds_write_b32 v64, v122 offset:1536
    v_lshlrev_b32 v4, 2, v2
    v_xor_b32 v4, v4, v3
    v_xor_b32 v5, 0, v4
    v_lshlrev_b32 v5, 4, v5
    v_lshl_add_u32 v20, v2, 10, v5
    v_xor_b32 v5, 1, v4
    v_lshlrev_b32 v5, 4, v5
    v_lshl_add_u32 v21, v2, 10, v5
    v_add_u32 v21, 3072, v21
    v_xor_b32 v5, 2, v4
    v_lshlrev_b32 v5, 4, v5
    v_lshl_add_u32 v22, v2, 10, v5
    v_add_u32 v22, 6144, v22
    v_xor_b32 v5, 3, v4
    v_lshlrev_b32 v5, 4, v5
    v_lshl_add_u32 v23, v2, 10, v5
    v_add_u32 v23, 9216, v23
    s_lshl_b32 s38, s32, 15
    s_add_u32 s47, s38, 1048576
    s_lshl_b32 s38, s3, 13
    s_add_u32 s47, s38, s47
    s_mul_i32 s38, s3, 320
    s_add_u32 s38, s38, 135168
    v_lshlrev_b32 v4, 6, v2
    v_lshl_add_u32 v4, v3, 1, v4
    v_add_u32 v31, s38, v4
    v_mfma_f32_16x16x32_bf16 v[96:99], v[252:255], v[92:95], v[96:99]
    v_mfma_f32_16x16x32_bf16 v[112:115], a[0:3], v[80:83], 0
    v_mfma_f32_16x16x32_bf16 v[112:115], a[4:7], v[84:87], v[112:115]
    s_waitcnt vmcnt(5)
    buffer_load_dwordx4 v[136:139], v76, s[52:55], s85 offen offset:1024 nt
    v_mfma_f32_16x16x32_bf16 v[112:115], a[8:11], v[88:91], v[112:115]
    s_nop 2
    v_mov_b32_dpp v122, v96 quad_perm:[0,0,0,0] row_mask:0xf bank_mask:0xf
    v_mov_b32_dpp v124, v98 quad_perm:[2,2,2,2] row_mask:0xf bank_mask:0xf
    s_nop 0
    v_add_f32_dpp v122, v97, v122 quad_perm:[1,1,1,1] row_mask:0xf bank_mask:0xf
    v_add_f32_dpp v124, v99, v124 quad_perm:[3,3,3,3] row_mask:0xf bank_mask:0xf
    v_add_f32 v122, v122, v124
    v_max_f32 v65, v65, v122
    ds_write_b32 v64, v122 offset:1792
    v_mfma_f32_16x16x32_bf16 v[112:115], a[12:15], v[92:95], v[112:115]
    v_mfma_f32_16x16x32_bf16 v[96:99], a[16:19], v[80:83], 0
    v_lshlrev_b32 v4, 11, v2
    v_bfe_u32 v5, v1, 2, 2
    v_lshl_add_u32 v4, v5, 8, v4
    v_bfe_u32 v5, v1, 2, 2
    v_lshl_add_u32 v4, v5, 6, v4
    v_bfe_u32 v5, v1, 4, 1
    v_lshl_add_u32 v4, v5, 5, v4
    v_bfe_u32 v5, v1, 1, 1
    v_lshl_add_u32 v4, v5, 4, v4
    v_bfe_u32 v5, v1, 0, 1
    v_lshl_add_u32 v4, v5, 3, v4
    s_lshl_b32 s38, s34, 6
    s_add_u32 s38, s38, 98304
    v_xor_b32 v24, s38, v4
    v_xor_b32 v25, 16, v24
    v_xor_b32 v26, 32, v24
    v_xor_b32 v27, 48, v24
    v_and_b32 v4, 3, v3
    v_lshrrev_b32 v5, 2, v3
    v_lshlrev_b32 v6, 4, v2
    v_add_u32 v6, 135168, v6
    s_movk_i32 s36, 320
    v_cmp_eq_u32 vcc, 0, v5
    s_nop 1
    v_cndmask_b32 v28, 4, v4, vcc
    v_mad_u32_u24 v28, v28, s36, v6
    v_cmp_eq_u32 vcc, 1, v5
    s_nop 1
    v_cndmask_b32 v29, 4, v4, vcc
    v_mad_u32_u24 v29, v29, s36, v6
    v_lshlrev_b32 v5, 2, v1
    v_add_u32 v5, 136448, v5
    v_mov_b32 v6, 0
    ds_write_b32 v5, v6
    s_waitcnt vmcnt(5)
    buffer_load_dwordx4 v[140:143], v77, s[52:55], s85 offen offset:1024 nt
    s_add_u32 s87, s87, 7
    s_add_u32 s39, s87, s88
    s_bfe_u32 s37, s39, 0x30000
    s_lshl_b32 s37, s37, 12
    s_add_u32 s85, s37, s89
    s_bfe_u32 s37, s39, 0x10003
    s_lshl_b32 s37, s37, 11
    s_add_u32 s85, s37, s85
    s_bfe_u32 s37, s39, 0x40004
    s_lshl_b32 s37, s37, 16
    s_add_u32 s85, s37, s85
    v_mfma_f32_16x16x32_bf16 v[96:99], a[20:23], v[84:87], v[96:99]
    v_mfma_f32_16x16x32_bf16 v[96:99], a[24:27], v[88:91], v[96:99]
    v_mov_b32_dpp v122, v112 quad_perm:[0,0,0,0] row_mask:0xf bank_mask:0xf
    v_mov_b32_dpp v124, v114 quad_perm:[2,2,2,2] row_mask:0xf bank_mask:0xf
    s_nop 0
    v_add_f32_dpp v122, v113, v122 quad_perm:[1,1,1,1] row_mask:0xf bank_mask:0xf
    v_add_f32_dpp v124, v115, v124 quad_perm:[3,3,3,3] row_mask:0xf bank_mask:0xf
    v_add_f32 v122, v122, v124
    v_max_f32 v65, v65, v122
    ds_write_b32 v64, v122 offset:2048
    v_mfma_f32_16x16x32_bf16 v[96:99], a[28:31], v[92:95], v[96:99]
    v_mfma_f32_16x16x32_bf16 v[112:115], a[32:35], v[80:83], 0
    s_waitcnt vmcnt(5)
    buffer_load_dwordx4 v[144:147], v76, s[52:55], s85 offen offset:0 nt
    v_mfma_f32_16x16x32_bf16 v[112:115], a[36:39], v[84:87], v[112:115]
    v_mfma_f32_16x16x32_bf16 v[112:115], a[40:43], v[88:91], v[112:115]
    s_nop 2
    v_mov_b32_dpp v122, v96 quad_perm:[0,0,0,0] row_mask:0xf bank_mask:0xf
    v_mov_b32_dpp v124, v98 quad_perm:[2,2,2,2] row_mask:0xf bank_mask:0xf
    s_nop 0
    v_add_f32_dpp v122, v97, v122 quad_perm:[1,1,1,1] row_mask:0xf bank_mask:0xf
    v_add_f32_dpp v124, v99, v124 quad_perm:[3,3,3,3] row_mask:0xf bank_mask:0xf
    v_add_f32 v122, v122, v124
    v_max_f32 v65, v65, v122
    ds_write_b32 v64, v122 offset:2304
    v_lshlrev_b32 v30, 4, v3
    v_lshl_add_u32 v30, v2, 13, v30
    s_lshl_b32 s38, s32, 13
    s_add_u32 s36, s38, 0
    s_lshl_b32 s38, s34, 6
    s_add_u32 s36, s38, s36
    v_lshrrev_b32 v5, 2, v1
    v_lshlrev_b32 v32, 8, v5
    v_bfe_u32 v5, v1, 0, 2
    v_lshl_add_u32 v32, v5, 4, v32
    v_add_u32 v32, s36, v32
    s_lshr_b32 s38, s32, 2
    s_lshl_b32 s38, s38, 7
    s_add_u32 s36, s38, 0
    s_lshl_b32 s38, s34, 5
    s_add_u32 s36, s38, s36
    s_bfe_u32 s38, s32, 0x20000
    s_lshl_b32 s38, s38, 3
    s_add_u32 s36, s38, s36
    v_bfe_u32 v5, v1, 0, 2
    v_lshlrev_b32 v33, 11, v5
    v_lshl_add_u32 v33, v2, 1, v33
    v_add_u32 v33, s36, v33
    v_and_b32 v5, 31, v1
    v_lshlrev_b32 v34, 4, v5
    s_mul_i32 s38, s34, 320
    s_add_u32 s38, s38, 135168
    v_lshl_add_u32 v35, v5, 3, s38
    v_mfma_f32_16x16x32_bf16 v[112:115], a[44:47], v[92:95], v[112:115]
    s_waitcnt vmcnt(5)
    buffer_load_dwordx4 v[148:151], v77, s[52:55], s85 offen offset:0 nt
    v_mfma_f32_16x16x32_bf16 v[96:99], a[48:51], v[80:83], 0
    v_mfma_f32_16x16x32_bf16 v[96:99], a[52:55], v[84:87], v[96:99]
    v_mfma_f32_16x16x32_bf16 v[96:99], a[56:59], v[88:91], v[96:99]
    s_nop 2
    v_mov_b32_dpp v122, v112 quad_perm:[0,0,0,0] row_mask:0xf bank_mask:0xf
    v_mov_b32_dpp v124, v114 quad_perm:[2,2,2,2] row_mask:0xf bank_mask:0xf
    s_nop 0
    v_add_f32_dpp v122, v113, v122 quad_perm:[1,1,1,1] row_mask:0xf bank_mask:0xf
    v_add_f32_dpp v124, v115, v124 quad_perm:[3,3,3,3] row_mask:0xf bank_mask:0xf
    v_add_f32 v122, v122, v124
    v_max_f32 v65, v65, v122
    ds_write_b32 v64, v122 offset:2560
    v_mfma_f32_16x16x32_bf16 v[96:99], a[60:63], v[92:95], v[96:99]
    v_add_u32 v64, 2816, v64
    s_mov_b32 s97, 10
    s_mov_b32 s86, 32
    s_and_b32 s36, s32, 3
    s_sub_u32 s80, s36, 2
    s_cmp_ge_u32 s36, 2
    s_cselect_b32 s80, s80, 8
    s_cselect_b32 s81, 27, 25
    s_cmp_eq_u32 s80, s33
    s_cselect_b32 s36, 2, 0
    s_sub_u32 s86, s86, s36
    s_lshr_b32 s36, s36, 1
    s_sub_u32 s97, s97, s36
    s_add_u32 s80, s80, 35
    s_sub_u32 s92, s81, 1
    s_mov_b32 s66, 134217728
    s_mov_b32 s67, 0x20000
    s_mov_b64 s[64:65], s[52:53]
    v_mov_b32 v62, v76
    v_mov_b32 v63, v77
    s_branch L_bloop
L_ql:
    v_lshrrev_b32 v4, 2, v3
    v_and_b32 v5, 3, v3
    v_lshlrev_b32 v19, 6, v2
    v_lshl_add_u32 v19, v5, 4, v19
    v_lshl_add_u32 v14, v4, 18, v19
    s_and_b32 s61, s32, 28
    s_add_u32 s61, s61, s34
    s_and_b32 s60, s32, 3
    s_lshl_b32 s38, s60, 20
    s_add_u32 s63, s38, 0
    s_lshl_b32 s38, s61, 8
    s_add_u32 s63, s38, s63
    s_mov_b32 s74, 4194304
    s_mov_b32 s75, 0x20000
    s_waitcnt lgkmcnt(0)
    s_mov_b64 s[72:73], s[10:11]
    buffer_load_dwordx4 a[128:131], v14, s[72:75], s63 offen nt
    s_add_u32 s63, s63, 8192
    buffer_load_dwordx4 a[132:135], v14, s[72:75], s63 offen nt
    s_add_u32 s63, s63, 8192
    buffer_load_dwordx4 a[136:139], v14, s[72:75], s63 offen nt
    s_add_u32 s63, s63, 8192
    buffer_load_dwordx4 a[140:143], v14, s[72:75], s63 offen nt
    s_add_u32 s63, s63, 8192
    buffer_load_dwordx4 a[144:147], v14, s[72:75], s63 offen nt
    s_add_u32 s63, s63, 8192
    buffer_load_dwordx4 a[148:151], v14, s[72:75], s63 offen nt
    s_add_u32 s63, s63, 8192
    buffer_load_dwordx4 a[152:155], v14, s[72:75], s63 offen nt
    s_add_u32 s63, s63, 8192
    buffer_load_dwordx4 a[156:159], v14, s[72:75], s63 offen nt
    s_add_u32 s63, s63, 8192
    v_lshlrev_b32 v15, 1, v19
    v_lshl_add_u32 v15, v4, 9, v15
    v_lshl_add_u32 v19, v4, 15, v19
    s_load_dword s35, s[30:31], 0
    s_mov_b32 s48, s30
    s_and_b32 s49, s31, 0xffff
    s_mov_b32 s50, 8388608
    s_mov_b32 s51, 0x20000
    s_mov_b32 s82, 0xffffff00
    s_mov_b32 s83, 0x3e0293ee
    s_mov_b32 s84, 2097152
    s_lshl_b32 s38, s61, 12
    s_add_u32 s95, s38, 264192
    s_lshl_b32 s38, s61, 10
    s_add_u32 s94, s38, 393216
    s_lshl_b32 s38, s60, 8
    s_add_u32 s94, s38, s94
    s_waitcnt vmcnt(7)
    buffer_load_dwordx4 a[160:163], v14, s[72:75], s63 offen nt
    s_add_u32 s63, s63, 8192
    s_waitcnt vmcnt(7)
    buffer_load_dwordx4 a[164:167], v14, s[72:75], s63 offen nt
    s_add_u32 s63, s63, 8192
    s_waitcnt vmcnt(7)
    buffer_load_dwordx4 a[168:171], v14, s[72:75], s63 offen nt
    s_add_u32 s63, s63, 8192
    s_waitcnt vmcnt(7)
    buffer_load_dwordx4 a[172:175], v14, s[72:75], s63 offen nt
    s_add_u32 s63, s63, 8192
    s_waitcnt vmcnt(7)
    buffer_load_dwordx4 a[176:179], v14, s[72:75], s63 offen nt
    s_add_u32 s63, s63, 8192
    v_and_b32 v4, 1, v1
    v_lshlrev_b32 v4, 4, v4
    v_mov_b32 v5, 0xffff
    v_lshlrev_b32 v4, v4, v5
    v_bfe_u32 v5, v1, 1, 2
    v_cmp_eq_u32 vcc, 0, v5
    s_nop 1
    v_cndmask_b32 v10, 0, v4, vcc
    v_cmp_eq_u32 vcc, 1, v5
    s_nop 1
    v_cndmask_b32 v11, 0, v4, vcc
    v_cmp_eq_u32 vcc, 2, v5
    s_nop 1
    v_cndmask_b32 v12, 0, v4, vcc
    v_cmp_eq_u32 vcc, 3, v5
    s_nop 1
    v_cndmask_b32 v13, 0, v4, vcc
    s_waitcnt vmcnt(7)
    buffer_load_dwordx4 a[180:183], v14, s[72:75], s63 offen nt
    s_add_u32 s63, s63, 8192
    s_waitcnt vmcnt(7)
    buffer_load_dwordx4 a[184:187], v14, s[72:75], s63 offen nt
    s_add_u32 s63, s63, 8192
    s_waitcnt vmcnt(7)
    buffer_load_dwordx4 a[188:191], v14, s[72:75], s63 offen nt
    s_add_u32 s63, s63, 8192
    s_waitcnt vmcnt(7)
    buffer_load_dwordx4 a[192:195], v14, s[72:75], s63 offen nt
    s_add_u32 s63, s63, 8192
    v_lshrrev_b32 v4, 2, v3
    v_and_b32 v5, 3, v3
    v_lshlrev_b32 v76, 8, v4
    v_lshlrev_b32 v126, 8, v2
    v_lshl_add_u32 v76, v2, 6, v76
    v_lshl_add_u32 v76, v5, 4, v76
    v_lshl_add_u32 v126, v3, 4, v126
    v_xor_b32 v77, 32768, v76
    v_xor_b32 v127, 32768, v126
    s_add_u32 s3, s34, s33
    s_and_b32 s3, s3, 3
    s_lshl_b32 s89, s3, 5
    s_add_u32 s89, s89, s32
    s_lshl_b32 s89, s89, 20
    s_mul_i32 s88, s32, 8
    s_add_u32 s88, s88, s3
    s_lshl_b32 s87, s33, 0
    s_waitcnt vmcnt(7)
    buffer_load_dwordx4 a[196:199], v14, s[72:75], s63 offen nt
    s_add_u32 s63, s63, 8192
    s_waitcnt vmcnt(7)
    buffer_load_dwordx4 a[200:203], v14, s[72:75], s63 offen nt
    s_add_u32 s63, s63, 8192
    s_waitcnt vmcnt(7)
    buffer_load_dwordx4 a[204:207], v14, s[72:75], s63 offen nt
    s_add_u32 s63, s63, 8192
    s_waitcnt vmcnt(7)
    buffer_load_dwordx4 a[208:211], v14, s[72:75], s63 offen nt
    s_add_u32 s63, s63, 8192
    s_mov_b32 s52, s18
    s_and_b32 s53, s19, 0xffff
    s_mov_b32 s54, 134217728
    s_mov_b32 s55, 0x20000
    s_mov_b32 s56, s20
    s_and_b32 s57, s21, 0xffff
    s_mov_b32 s58, 134217728
    s_mov_b32 s59, 0x20000
    s_waitcnt vmcnt(7)
    buffer_load_dwordx4 a[212:215], v14, s[72:75], s63 offen nt
    s_add_u32 s63, s63, 8192
    s_waitcnt vmcnt(7)
    buffer_load_dwordx4 a[216:219], v14, s[72:75], s63 offen nt
    s_add_u32 s63, s63, 8192
    s_waitcnt vmcnt(7)
    buffer_load_dwordx4 a[220:223], v14, s[72:75], s63 offen nt
    s_add_u32 s63, s63, 8192
    s_waitcnt vmcnt(7)
    buffer_load_dwordx4 a[224:227], v14, s[72:75], s63 offen nt
    s_add_u32 s63, s63, 8192
    v_mov_b32 v120, 0xff7f0000
    v_mov_b32 v121, 0
    v_mov_b32 v18, 1
    v_mov_b32 v116, 0
    v_mov_b32 v117, 0
    v_mov_b32 v118, 0
    v_mov_b32 v119, 0
    s_lshl_b32 s38, s32, 10
    s_add_u32 s96, s38, 65536
    s_lshl_b32 s38, s3, 8
    s_add_u32 s96, s38, s96
    v_mov_b32 v9, s96
    s_lshl_b32 s38, s32, 15
    s_add_u32 s96, s38, 1048576
    s_lshl_b32 s38, s3, 13
    s_add_u32 s96, s38, s96
    s_lshl_b32 s38, s33, 10
    s_add_u32 s96, s38, s96
    v_and_b32 v5, 3, v3
    v_lshlrev_b32 v78, 7, v2
    v_lshl_add_u32 v78, v5, 5, v78
    s_lshl_b32 s38, s32, 12
    s_add_u32 s91, s38, 262144
    s_lshl_b32 s38, s3, 9
    s_add_u32 s91, s38, s91
    v_lshlrev_b32 v4, 7, v2
    v_lshl_add_u32 v4, v3, 4, v4
    v_mov_b32 v5, 512
    v_cmp_gt_u32 vcc, 8, v3
    s_nop 1
    v_cndmask_b32 v79, v5, v4, vcc
    s_waitcnt vmcnt(7)
    buffer_load_dwordx4 a[228:231], v14, s[72:75], s63 offen nt
    s_add_u32 s63, s63, 8192
    s_waitcnt vmcnt(7)
    buffer_load_dwordx4 a[232:235], v14, s[72:75], s63 offen nt
    s_add_u32 s63, s63, 8192
    s_waitcnt vmcnt(7)
    buffer_load_dwordx4 a[236:239], v14, s[72:75], s63 offen nt
    s_add_u32 s63, s63, 8192
    s_waitcnt vmcnt(7)
    buffer_load_dwordx4 a[240:243], v14, s[72:75], s63 offen nt
    s_add_u32 s63, s63, 8192
    s_waitcnt vmcnt(7)
    buffer_load_dwordx4 a[244:247], v14, s[72:75], s63 offen nt
    s_add_u32 s63, s63, 8192
    s_waitcnt vmcnt(7)
    buffer_load_dwordx4 a[248:251], v14, s[72:75], s63 offen nt
    s_add_u32 s63, s63, 8192
    s_waitcnt vmcnt(7)
    buffer_load_dwordx4 a[252:255], v14, s[72:75], s63 offen nt
    s_add_u32 s63, s63, 8192
    s_waitcnt lgkmcnt(0)
    s_add_u32 s35, s35, 0x5b
    s_and_b32 s35, s35, 0xff
    v_mov_b32 v8, s35
    s_or_b32 s68, s35, 0x6b3ac500
    s_waitcnt vmcnt(6)
    s_add_u32 s39, s87, s88
    s_bfe_u32 s37, s39, 0x30000
    s_lshl_b32 s37, s37, 12
    s_add_u32 s85, s37, s89
    s_bfe_u32 s37, s39, 0x10003
    s_lshl_b32 s37, s37, 11
    s_add_u32 s85, s37, s85
    s_bfe_u32 s37, s39, 0x40004
    s_lshl_b32 s37, s37, 16
    s_add_u32 s85, s37, s85
    buffer_load_dwordx4 v[128:131], v76, s[52:55], s85 offen offset:0 nt
    s_waitcnt vmcnt(6)
    buffer_load_dwordx4 v[132:135], v77, s[52:55], s85 offen offset:0 nt
    s_waitcnt vmcnt(6)
    buffer_load_dwordx4 v[136:139], v76, s[52:55], s85 offen offset:1024 nt
    s_waitcnt vmcnt(6)
    buffer_load_dwordx4 v[140:143], v77, s[52:55], s85 offen offset:1024 nt
    s_add_u32 s87, s87, 7
    s_add_u32 s39, s87, s88
    s_bfe_u32 s37, s39, 0x30000
    s_lshl_b32 s37, s37, 12
    s_add_u32 s85, s37, s89
    s_bfe_u32 s37, s39, 0x10003
    s_lshl_b32 s37, s37, 11
    s_add_u32 s85, s37, s85
    s_bfe_u32 s37, s39, 0x40004
    s_lshl_b32 s37, s37, 16
    s_add_u32 s85, s37, s85
    s_waitcnt vmcnt(6)
    buffer_load_dwordx4 v[144:147], v76, s[52:55], s85 offen offset:0 nt
    s_waitcnt vmcnt(6)
    buffer_load_dwordx4 v[148:151], v77, s[52:55], s85 offen offset:0 nt
    s_waitcnt vmcnt(6)
    buffer_load_dwordx4 v[152:155], v76, s[52:55], s85 offen offset:1024 nt
    s_waitcnt vmcnt(6)
    buffer_load_dwordx4 v[156:159], v77, s[52:55], s85 offen offset:1024 nt
    s_add_u32 s87, s87, 7
    s_add_u32 s39, s87, s88
    s_bfe_u32 s37, s39, 0x30000
    s_lshl_b32 s37, s37, 12
    s_add_u32 s85, s37, s89
    s_bfe_u32 s37, s39, 0x10003
    s_lshl_b32 s37, s37, 11
    s_add_u32 s85, s37, s85
    s_bfe_u32 s37, s39, 0x40004
    s_lshl_b32 s37, s37, 16
    s_add_u32 s85, s37, s85
    s_waitcnt vmcnt(6)
    buffer_load_dwordx4 v[160:163], v76, s[52:55], s85 offen offset:0 nt
    s_waitcnt vmcnt(6)
    buffer_load_dwordx4 v[164:167], v77, s[52:55], s85 offen offset:0 nt
    s_waitcnt vmcnt(6)
    buffer_load_dwordx4 v[168:171], v76, s[52:55], s85 offen offset:1024 nt
    s_waitcnt vmcnt(6)
    buffer_load_dwordx4 v[172:175], v77, s[52:55], s85 offen offset:1024 nt
    s_add_u32 s87, s87, 7
    s_add_u32 s39, s87, s88
    s_bfe_u32 s37, s39, 0x30000
    s_lshl_b32 s37, s37, 12
    s_add_u32 s85, s37, s89
    s_bfe_u32 s37, s39, 0x10003
    s_lshl_b32 s37, s37, 11
    s_add_u32 s85, s37, s85
    s_bfe_u32 s37, s39, 0x40004
    s_lshl_b32 s37, s37, 16
    s_add_u32 s85, s37, s85
    s_waitcnt vmcnt(6)
    buffer_load_dwordx4 v[176:179], v76, s[52:55], s85 offen offset:0 nt
    s_waitcnt vmcnt(6)
    buffer_load_dwordx4 v[180:183], v77, s[52:55], s85 offen offset:0 nt
    s_waitcnt vmcnt(6)
    buffer_load_dwordx4 v[184:187], v76, s[52:55], s85 offen offset:1024 nt
    s_waitcnt vmcnt(6)
    buffer_load_dwordx4 v[188:191], v77, s[52:55], s85 offen offset:1024 nt
    s_add_u32 s87, s87, 7
    s_add_u32 s39, s87, s88
    s_bfe_u32 s37, s39, 0x30000
    s_lshl_b32 s37, s37, 12
    s_add_u32 s85, s37, s89
    s_bfe_u32 s37, s39, 0x10003
    s_lshl_b32 s37, s37, 11
    s_add_u32 s85, s37, s85
    s_bfe_u32 s37, s39, 0x40004
    s_lshl_b32 s37, s37, 16
    s_add_u32 s85, s37, s85
    s_waitcnt vmcnt(6)
    buffer_load_dwordx4 v[192:195], v76, s[52:55], s85 offen offset:0 nt
    s_waitcnt vmcnt(6)
    buffer_load_dwordx4 v[196:199], v77, s[52:55], s85 offen offset:0 nt
    s_waitcnt vmcnt(6)
    buffer_load_dwordx4 v[200:203], v76, s[52:55], s85 offen offset:1024 nt
    s_waitcnt vmcnt(6)
    buffer_load_dwordx4 v[204:207], v77, s[52:55], s85 offen offset:1024 nt
    s_add_u32 s87, s87, 7
    s_add_u32 s39, s87, s88
    s_bfe_u32 s37, s39, 0x30000
    s_lshl_b32 s37, s37, 12
    s_add_u32 s85, s37, s89
    s_bfe_u32 s37, s39, 0x10003
    s_lshl_b32 s37, s37, 11
    s_add_u32 s85, s37, s85
    s_bfe_u32 s37, s39, 0x40004
    s_lshl_b32 s37, s37, 16
    s_add_u32 s85, s37, s85
    s_waitcnt vmcnt(6)
    buffer_load_dwordx4 v[208:211], v76, s[52:55], s85 offen offset:0 nt
    s_waitcnt vmcnt(6)
    buffer_load_dwordx4 v[212:215], v77, s[52:55], s85 offen offset:0 nt
    s_waitcnt vmcnt(6)
    buffer_load_dwordx4 v[216:219], v76, s[52:55], s85 offen offset:1024 nt
    s_waitcnt vmcnt(6)
    buffer_load_dwordx4 v[220:223], v77, s[52:55], s85 offen offset:1024 nt
    s_add_u32 s87, s87, 7
    s_add_u32 s39, s87, s88
    s_bfe_u32 s37, s39, 0x30000
    s_lshl_b32 s37, s37, 12
    s_add_u32 s85, s37, s89
    s_bfe_u32 s37, s39, 0x10003
    s_lshl_b32 s37, s37, 11
    s_add_u32 s85, s37, s85
    s_bfe_u32 s37, s39, 0x40004
    s_lshl_b32 s37, s37, 16
    s_add_u32 s85, s37, s85
    buffer_load_dwordx4 v[20:23], v15, s[48:51], s95 offen offset:0 sc1
    buffer_load_dwordx4 v[24:27], v15, s[48:51], s95 offen offset:16 sc1
    s_waitcnt vmcnt(8)
    buffer_load_dwordx4 v[224:227], v76, s[52:55], s85 offen offset:0 nt
    s_waitcnt vmcnt(8)
    buffer_load_dwordx4 v[228:231], v77, s[52:55], s85 offen offset:0 nt
    s_waitcnt vmcnt(8)
    buffer_load_dwordx4 v[232:235], v76, s[52:55], s85 offen offset:1024 nt
    s_waitcnt vmcnt(8)
    buffer_load_dwordx4 v[236:239], v77, s[52:55], s85 offen offset:1024 nt
    s_add_u32 s87, s87, 7
    s_add_u32 s39, s87, s88
    s_bfe_u32 s37, s39, 0x30000
    s_lshl_b32 s37, s37, 12
    s_add_u32 s85, s37, s89
    s_bfe_u32 s37, s39, 0x10003
    s_lshl_b32 s37, s37, 11
    s_add_u32 s85, s37, s85
    s_bfe_u32 s37, s39, 0x40004
    s_lshl_b32 s37, s37, 16
    s_add_u32 s85, s37, s85
    s_waitcnt vmcnt(8)
    buffer_load_dwordx4 v[240:243], v76, s[52:55], s85 offen offset:0 nt
    s_waitcnt vmcnt(8)
    buffer_load_dwordx4 v[244:247], v77, s[52:55], s85 offen offset:0 nt
    s_waitcnt vmcnt(6)
L_qacheck_19:
    v_xor_b32 v20, s35, v20
    v_xor_b32 v21, s35, v21
    v_xor_b32 v22, s35, v22
    v_xor_b32 v23, s35, v23
    v_xor_b32 v24, s35, v24
    v_xor_b32 v25, s35, v25
    v_xor_b32 v26, s35, v26
    v_xor_b32 v27, s35, v27
    v_or_b32 v4, v20, v21
    v_or3_b32 v4, v4, v22, v23
    v_or3_b32 v4, v4, v24, v25
    v_or3_b32 v4, v4, v26, v27
    v_and_b32 v4, 0xff, v4
    v_cmp_ne_u32 vcc, 0, v4
    s_cbranch_vccz L_qaok_20
    buffer_load_dwordx4 v[20:23], v15, s[48:51], s95 offen offset:0 sc1
    buffer_load_dwordx4 v[24:27], v15, s[48:51], s95 offen offset:16 sc1
    s_waitcnt vmcnt(0)
    s_sub_u32 s84, s84, 1
    s_cmp_lg_u32 s84, 0
    s_cbranch_scc1 L_qacheck_19
    s_branch L_end
L_qaok_20:
    buffer_load_dwordx4 v[68:71], v78, s[48:51], s91 offen offset:0 sc1
    buffer_load_dwordx4 v[72:75], v78, s[48:51], s91 offen offset:16 sc1
    v_cvt_pk_bf16_f32 v20, v20, v21
    v_cvt_pk_bf16_f32 v21, v22, v23
    v_cvt_pk_bf16_f32 v22, v24, v25
    v_cvt_pk_bf16_f32 v23, v26, v27
    s_nop 1
    v_mfma_f32_16x16x32_bf16 v[28:31], a[128:131], v[20:23], 0
    v_mfma_f32_16x16x32_bf16 v[32:35], a[132:135], v[20:23], 0
    v_mfma_f32_16x16x32_bf16 v[36:39], a[136:139], v[20:23], 0
    s_nop 5
    v_mov_b32_dpp v60, v28 quad_perm:[0,0,0,0] row_mask:0xf bank_mask:0xf
    v_mov_b32_dpp v4, v30 quad_perm:[2,2,2,2] row_mask:0xf bank_mask:0xf
    s_nop 0
    v_add_f32_dpp v60, v29, v60 quad_perm:[1,1,1,1] row_mask:0xf bank_mask:0xf
    v_add_f32_dpp v4, v31, v4 quad_perm:[3,3,3,3] row_mask:0xf bank_mask:0xf
    v_add_f32 v60, v60, v4
    v_mfma_f32_16x16x32_bf16 v[40:43], a[140:143], v[20:23], 0
    v_mov_b32_dpp v61, v32 quad_perm:[0,0,0,0] row_mask:0xf bank_mask:0xf
    v_mov_b32_dpp v4, v34 quad_perm:[2,2,2,2] row_mask:0xf bank_mask:0xf
    s_nop 0
    v_add_f32_dpp v61, v33, v61 quad_perm:[1,1,1,1] row_mask:0xf bank_mask:0xf
    v_add_f32_dpp v4, v35, v4 quad_perm:[3,3,3,3] row_mask:0xf bank_mask:0xf
    v_add_f32 v61, v61, v4
    v_cvt_pk_bf16_f32 v44, v60, v61
    v_mfma_f32_16x16x32_bf16 v[28:31], a[144:147], v[20:23], 0
    v_mov_b32_dpp v60, v36 quad_perm:[0,0,0,0] row_mask:0xf bank_mask:0xf
    v_mov_b32_dpp v4, v38 quad_perm:[2,2,2,2] row_mask:0xf bank_mask:0xf
    s_nop 0
    v_add_f32_dpp v60, v37, v60 quad_perm:[1,1,1,1] row_mask:0xf bank_mask:0xf
    v_add_f32_dpp v4, v39, v4 quad_perm:[3,3,3,3] row_mask:0xf bank_mask:0xf
    v_add_f32 v60, v60, v4
    buffer_load_dwordx4 v[248:251], v76, s[52:55], s85 offen offset:1024 nt
    v_mfma_f32_16x16x32_bf16 v[32:35], a[148:151], v[20:23], 0
    v_mov_b32_dpp v61, v40 quad_perm:[0,0,0,0] row_mask:0xf bank_mask:0xf
    v_mov_b32_dpp v4, v42 quad_perm:[2,2,2,2] row_mask:0xf bank_mask:0xf
    s_nop 0
    v_add_f32_dpp v61, v41, v61 quad_perm:[1,1,1,1] row_mask:0xf bank_mask:0xf
    v_add_f32_dpp v4, v43, v4 quad_perm:[3,3,3,3] row_mask:0xf bank_mask:0xf
    v_add_f32 v61, v61, v4
    v_cvt_pk_bf16_f32 v45, v60, v61
    v_mfma_f32_16x16x32_bf16 v[36:39], a[152:155], v[20:23], 0
    v_mov_b32_dpp v60, v28 quad_perm:[0,0,0,0] row_mask:0xf bank_mask:0xf
    v_mov_b32_dpp v4, v30 quad_perm:[2,2,2,2] row_mask:0xf bank_mask:0xf
    s_nop 0
    v_add_f32_dpp v60, v29, v60 quad_perm:[1,1,1,1] row_mask:0xf bank_mask:0xf
    v_add_f32_dpp v4, v31, v4 quad_perm:[3,3,3,3] row_mask:0xf bank_mask:0xf
    v_add_f32 v60, v60, v4
    v_mfma_f32_16x16x32_bf16 v[40:43], a[156:159], v[20:23], 0
    v_mov_b32_dpp v61, v32 quad_perm:[0,0,0,0] row_mask:0xf bank_mask:0xf
    v_mov_b32_dpp v4, v34 quad_perm:[2,2,2,2] row_mask:0xf bank_mask:0xf
    s_nop 0
    v_add_f32_dpp v61, v33, v61 quad_perm:[1,1,1,1] row_mask:0xf bank_mask:0xf
    v_add_f32_dpp v4, v35, v4 quad_perm:[3,3,3,3] row_mask:0xf bank_mask:0xf
    v_add_f32 v61, v61, v4
    v_cvt_pk_bf16_f32 v46, v60, v61
    v_mfma_f32_16x16x32_bf16 v[28:31], a[160:163], v[20:23], 0
    v_mov_b32_dpp v60, v36 quad_perm:[0,0,0,0] row_mask:0xf bank_mask:0xf
    v_mov_b32_dpp v4, v38 quad_perm:[2,2,2,2] row_mask:0xf bank_mask:0xf
    s_nop 0
    v_add_f32_dpp v60, v37, v60 quad_perm:[1,1,1,1] row_mask:0xf bank_mask:0xf
    v_add_f32_dpp v4, v39, v4 quad_perm:[3,3,3,3] row_mask:0xf bank_mask:0xf
    v_add_f32 v60, v60, v4
    v_mfma_f32_16x16x32_bf16 v[32:35], a[164:167], v[20:23], 0
    v_mov_b32_dpp v61, v40 quad_perm:[0,0,0,0] row_mask:0xf bank_mask:0xf
    v_mov_b32_dpp v4, v42 quad_perm:[2,2,2,2] row_mask:0xf bank_mask:0xf
    s_nop 0
    v_add_f32_dpp v61, v41, v61 quad_perm:[1,1,1,1] row_mask:0xf bank_mask:0xf
    v_add_f32_dpp v4, v43, v4 quad_perm:[3,3,3,3] row_mask:0xf bank_mask:0xf
    v_add_f32 v61, v61, v4
    v_cvt_pk_bf16_f32 v47, v60, v61
    v_mfma_f32_16x16x32_bf16 v[36:39], a[168:171], v[20:23], 0
    v_mov_b32_dpp v60, v28 quad_perm:[0,0,0,0] row_mask:0xf bank_mask:0xf
    v_mov_b32_dpp v4, v30 quad_perm:[2,2,2,2] row_mask:0xf bank_mask:0xf
    s_nop 0
    v_add_f32_dpp v60, v29, v60 quad_perm:[1,1,1,1] row_mask:0xf bank_mask:0xf
    v_add_f32_dpp v4, v31, v4 quad_perm:[3,3,3,3] row_mask:0xf bank_mask:0xf
    v_add_f32 v60, v60, v4
    v_mfma_f32_16x16x32_bf16 v[40:43], a[172:175], v[20:23], 0
    v_mov_b32_dpp v61, v32 quad_perm:[0,0,0,0] row_mask:0xf bank_mask:0xf
    v_mov_b32_dpp v4, v34 quad_perm:[2,2,2,2] row_mask:0xf bank_mask:0xf
    s_nop 0
    v_add_f32_dpp v61, v33, v61 quad_perm:[1,1,1,1] row_mask:0xf bank_mask:0xf
    v_add_f32_dpp v4, v35, v4 quad_perm:[3,3,3,3] row_mask:0xf bank_mask:0xf
    v_add_f32 v61, v61, v4
    v_cvt_pk_bf16_f32 v48, v60, v61
    v_mfma_f32_16x16x32_bf16 v[28:31], a[176:179], v[20:23], 0
    v_mov_b32_dpp v60, v36 quad_perm:[0,0,0,0] row_mask:0xf bank_mask:0xf
    v_mov_b32_dpp v4, v38 quad_perm:[2,2,2,2] row_mask:0xf bank_mask:0xf
    s_nop 0
    v_add_f32_dpp v60, v37, v60 quad_perm:[1,1,1,1] row_mask:0xf bank_mask:0xf
    v_add_f32_dpp v4, v39, v4 quad_perm:[3,3,3,3] row_mask:0xf bank_mask:0xf
    v_add_f32 v60, v60, v4
    buffer_load_dwordx4 v[252:255], v77, s[52:55], s85 offen offset:1024 nt
    s_add_u32 s87, s87, 7
    s_add_u32 s39, s87, s88
    s_bfe_u32 s37, s39, 0x30000
    s_lshl_b32 s37, s37, 12
    s_add_u32 s85, s37, s89
    s_bfe_u32 s37, s39, 0x10003
    s_lshl_b32 s37, s37, 11
    s_add_u32 s85, s37, s85
    s_bfe_u32 s37, s39, 0x40004
    s_lshl_b32 s37, s37, 16
    s_add_u32 s85, s37, s85
    v_mfma_f32_16x16x32_bf16 v[32:35], a[180:183], v[20:23], 0
    v_mov_b32_dpp v61, v40 quad_perm:[0,0,0,0] row_mask:0xf bank_mask:0xf
    v_mov_b32_dpp v4, v42 quad_perm:[2,2,2,2] row_mask:0xf bank_mask:0xf
    s_nop 0
    v_add_f32_dpp v61, v41, v61 quad_perm:[1,1,1,1] row_mask:0xf bank_mask:0xf
    v_add_f32_dpp v4, v43, v4 quad_perm:[3,3,3,3] row_mask:0xf bank_mask:0xf
    v_add_f32 v61, v61, v4
    v_cvt_pk_bf16_f32 v49, v60, v61
    v_mfma_f32_16x16x32_bf16 v[36:39], a[184:187], v[20:23], 0
    v_mov_b32_dpp v60, v28 quad_perm:[0,0,0,0] row_mask:0xf bank_mask:0xf
    v_mov_b32_dpp v4, v30 quad_perm:[2,2,2,2] row_mask:0xf bank_mask:0xf
    s_nop 0
    v_add_f32_dpp v60, v29, v60 quad_perm:[1,1,1,1] row_mask:0xf bank_mask:0xf
    v_add_f32_dpp v4, v31, v4 quad_perm:[3,3,3,3] row_mask:0xf bank_mask:0xf
    v_add_f32 v60, v60, v4
    v_mfma_f32_16x16x32_bf16 v[40:43], a[188:191], v[20:23], 0
    v_mov_b32_dpp v61, v32 quad_perm:[0,0,0,0] row_mask:0xf bank_mask:0xf
    v_mov_b32_dpp v4, v34 quad_perm:[2,2,2,2] row_mask:0xf bank_mask:0xf
    s_nop 0
    v_add_f32_dpp v61, v33, v61 quad_perm:[1,1,1,1] row_mask:0xf bank_mask:0xf
    v_add_f32_dpp v4, v35, v4 quad_perm:[3,3,3,3] row_mask:0xf bank_mask:0xf
    v_add_f32 v61, v61, v4
    v_cvt_pk_bf16_f32 v50, v60, v61
    v_mfma_f32_16x16x32_bf16 v[28:31], a[192:195], v[20:23], 0
    v_mov_b32_dpp v60, v36 quad_perm:[0,0,0,0] row_mask:0xf bank_mask:0xf
    v_mov_b32_dpp v4, v38 quad_perm:[2,2,2,2] row_mask:0xf bank_mask:0xf
    s_nop 0
    v_add_f32_dpp v60, v37, v60 quad_perm:[1,1,1,1] row_mask:0xf bank_mask:0xf
    v_add_f32_dpp v4, v39, v4 quad_perm:[3,3,3,3] row_mask:0xf bank_mask:0xf
    v_add_f32 v60, v60, v4
    v_mfma_f32_16x16x32_bf16 v[32:35], a[196:199], v[20:23], 0
    v_mov_b32_dpp v61, v40 quad_perm:[0,0,0,0] row_mask:0xf bank_mask:0xf
    v_mov_b32_dpp v4, v42 quad_perm:[2,2,2,2] row_mask:0xf bank_mask:0xf
    s_nop 0
    v_add_f32_dpp v61, v41, v61 quad_perm:[1,1,1,1] row_mask:0xf bank_mask:0xf
    v_add_f32_dpp v4, v43, v4 quad_perm:[3,3,3,3] row_mask:0xf bank_mask:0xf
    v_add_f32 v61, v61, v4
    v_cvt_pk_bf16_f32 v51, v60, v61
    v_mfma_f32_16x16x32_bf16 v[36:39], a[200:203], v[20:23], 0
    v_mov_b32_dpp v60, v28 quad_perm:[0,0,0,0] row_mask:0xf bank_mask:0xf
    v_mov_b32_dpp v4, v30 quad_perm:[2,2,2,2] row_mask:0xf bank_mask:0xf
    s_nop 0
    v_add_f32_dpp v60, v29, v60 quad_perm:[1,1,1,1] row_mask:0xf bank_mask:0xf
    v_add_f32_dpp v4, v31, v4 quad_perm:[3,3,3,3] row_mask:0xf bank_mask:0xf
    v_add_f32 v60, v60, v4
    v_mfma_f32_16x16x32_bf16 v[40:43], a[204:207], v[20:23], 0
    v_mov_b32_dpp v61, v32 quad_perm:[0,0,0,0] row_mask:0xf bank_mask:0xf
    v_mov_b32_dpp v4, v34 quad_perm:[2,2,2,2] row_mask:0xf bank_mask:0xf
    s_nop 0
    v_add_f32_dpp v61, v33, v61 quad_perm:[1,1,1,1] row_mask:0xf bank_mask:0xf
    v_add_f32_dpp v4, v35, v4 quad_perm:[3,3,3,3] row_mask:0xf bank_mask:0xf
    v_add_f32 v61, v61, v4
    v_cvt_pk_bf16_f32 v52, v60, v61
    v_mfma_f32_16x16x32_bf16 v[28:31], a[208:211], v[20:23], 0
    v_mov_b32_dpp v60, v36 quad_perm:[0,0,0,0] row_mask:0xf bank_mask:0xf
    v_mov_b32_dpp v4, v38 quad_perm:[2,2,2,2] row_mask:0xf bank_mask:0xf
    s_nop 0
    v_add_f32_dpp v60, v37, v60 quad_perm:[1,1,1,1] row_mask:0xf bank_mask:0xf
    v_add_f32_dpp v4, v39, v4 quad_perm:[3,3,3,3] row_mask:0xf bank_mask:0xf
    v_add_f32 v60, v60, v4
    buffer_load_dwordx4 a[0:3], v76, s[52:55], s85 offen offset:0 nt
    v_mfma_f32_16x16x32_bf16 v[32:35], a[212:215], v[20:23], 0
    v_mov_b32_dpp v61, v40 quad_perm:[0,0,0,0] row_mask:0xf bank_mask:0xf
    v_mov_b32_dpp v4, v42 quad_perm:[2,2,2,2] row_mask:0xf bank_mask:0xf
    s_nop 0
    v_add_f32_dpp v61, v41, v61 quad_perm:[1,1,1,1] row_mask:0xf bank_mask:0xf
    v_add_f32_dpp v4, v43, v4 quad_perm:[3,3,3,3] row_mask:0xf bank_mask:0xf
    v_add_f32 v61, v61, v4
    v_cvt_pk_bf16_f32 v53, v60, v61
    v_mfma_f32_16x16x32_bf16 v[36:39], a[216:219], v[20:23], 0
    v_mov_b32_dpp v60, v28 quad_perm:[0,0,0,0] row_mask:0xf bank_mask:0xf
    v_mov_b32_dpp v4, v30 quad_perm:[2,2,2,2] row_mask:0xf bank_mask:0xf
    s_nop 0
    v_add_f32_dpp v60, v29, v60 quad_perm:[1,1,1,1] row_mask:0xf bank_mask:0xf
    v_add_f32_dpp v4, v31, v4 quad_perm:[3,3,3,3] row_mask:0xf bank_mask:0xf
    v_add_f32 v60, v60, v4
    v_mfma_f32_16x16x32_bf16 v[40:43], a[220:223], v[20:23], 0
    v_mov_b32_dpp v61, v32 quad_perm:[0,0,0,0] row_mask:0xf bank_mask:0xf
    v_mov_b32_dpp v4, v34 quad_perm:[2,2,2,2] row_mask:0xf bank_mask:0xf
    s_nop 0
    v_add_f32_dpp v61, v33, v61 quad_perm:[1,1,1,1] row_mask:0xf bank_mask:0xf
    v_add_f32_dpp v4, v35, v4 quad_perm:[3,3,3,3] row_mask:0xf bank_mask:0xf
    v_add_f32 v61, v61, v4
    v_cvt_pk_bf16_f32 v54, v60, v61
    v_mfma_f32_16x16x32_bf16 v[28:31], a[224:227], v[20:23], 0
    v_mov_b32_dpp v60, v36 quad_perm:[0,0,0,0] row_mask:0xf bank_mask:0xf
    v_mov_b32_dpp v4, v38 quad_perm:[2,2,2,2] row_mask:0xf bank_mask:0xf
    s_nop 0
    v_add_f32_dpp v60, v37, v60 quad_perm:[1,1,1,1] row_mask:0xf bank_mask:0xf
    v_add_f32_dpp v4, v39, v4 quad_perm:[3,3,3,3] row_mask:0xf bank_mask:0xf
    v_add_f32 v60, v60, v4
    v_mfma_f32_16x16x32_bf16 v[32:35], a[228:231], v[20:23], 0
    v_mov_b32_dpp v61, v40 quad_perm:[0,0,0,0] row_mask:0xf bank_mask:0xf
    v_mov_b32_dpp v4, v42 quad_perm:[2,2,2,2] row_mask:0xf bank_mask:0xf
    s_nop 0
    v_add_f32_dpp v61, v41, v61 quad_perm:[1,1,1,1] row_mask:0xf bank_mask:0xf
    v_add_f32_dpp v4, v43, v4 quad_perm:[3,3,3,3] row_mask:0xf bank_mask:0xf
    v_add_f32 v61, v61, v4
    v_cvt_pk_bf16_f32 v55, v60, v61
    v_mfma_f32_16x16x32_bf16 v[36:39], a[232:235], v[20:23], 0
    v_mov_b32_dpp v60, v28 quad_perm:[0,0,0,0] row_mask:0xf bank_mask:0xf
    v_mov_b32_dpp v4, v30 quad_perm:[2,2,2,2] row_mask:0xf bank_mask:0xf
    s_nop 0
    v_add_f32_dpp v60, v29, v60 quad_perm:[1,1,1,1] row_mask:0xf bank_mask:0xf
    v_add_f32_dpp v4, v31, v4 quad_perm:[3,3,3,3] row_mask:0xf bank_mask:0xf
    v_add_f32 v60, v60, v4
    v_mfma_f32_16x16x32_bf16 v[40:43], a[236:239], v[20:23], 0
    v_mov_b32_dpp v61, v32 quad_perm:[0,0,0,0] row_mask:0xf bank_mask:0xf
    v_mov_b32_dpp v4, v34 quad_perm:[2,2,2,2] row_mask:0xf bank_mask:0xf
    s_nop 0
    v_add_f32_dpp v61, v33, v61 quad_perm:[1,1,1,1] row_mask:0xf bank_mask:0xf
    v_add_f32_dpp v4, v35, v4 quad_perm:[3,3,3,3] row_mask:0xf bank_mask:0xf
    v_add_f32 v61, v61, v4
    v_cvt_pk_bf16_f32 v56, v60, v61
    v_mfma_f32_16x16x32_bf16 v[28:31], a[240:243], v[20:23], 0
    v_mov_b32_dpp v60, v36 quad_perm:[0,0,0,0] row_mask:0xf bank_mask:0xf
    v_mov_b32_dpp v4, v38 quad_perm:[2,2,2,2] row_mask:0xf bank_mask:0xf
    s_nop 0
    v_add_f32_dpp v60, v37, v60 quad_perm:[1,1,1,1] row_mask:0xf bank_mask:0xf
    v_add_f32_dpp v4, v39, v4 quad_perm:[3,3,3,3] row_mask:0xf bank_mask:0xf
    v_add_f32 v60, v60, v4
    buffer_load_dwordx4 a[4:7], v77, s[52:55], s85 offen offset:0 nt
    v_mfma_f32_16x16x32_bf16 v[32:35], a[244:247], v[20:23], 0
    v_mov_b32_dpp v61, v40 quad_perm:[0,0,0,0] row_mask:0xf bank_mask:0xf
    v_mov_b32_dpp v4, v42 quad_perm:[2,2,2,2] row_mask:0xf bank_mask:0xf
    s_nop 0
    v_add_f32_dpp v61, v41, v61 quad_perm:[1,1,1,1] row_mask:0xf bank_mask:0xf
    v_add_f32_dpp v4, v43, v4 quad_perm:[3,3,3,3] row_mask:0xf bank_mask:0xf
    v_add_f32 v61, v61, v4
    v_cvt_pk_bf16_f32 v57, v60, v61
    v_mfma_f32_16x16x32_bf16 v[36:39], a[248:251], v[20:23], 0
    v_mov_b32_dpp v60, v28 quad_perm:[0,0,0,0] row_mask:0xf bank_mask:0xf
    v_mov_b32_dpp v4, v30 quad_perm:[2,2,2,2] row_mask:0xf bank_mask:0xf
    s_nop 0
    v_add_f32_dpp v60, v29, v60 quad_perm:[1,1,1,1] row_mask:0xf bank_mask:0xf
    v_add_f32_dpp v4, v31, v4 quad_perm:[3,3,3,3] row_mask:0xf bank_mask:0xf
    v_add_f32 v60, v60, v4
    v_mfma_f32_16x16x32_bf16 v[40:43], a[252:255], v[20:23], 0
    v_mov_b32_dpp v61, v32 quad_perm:[0,0,0,0] row_mask:0xf bank_mask:0xf
    v_mov_b32_dpp v4, v34 quad_perm:[2,2,2,2] row_mask:0xf bank_mask:0xf
    s_nop 0
    v_add_f32_dpp v61, v33, v61 quad_perm:[1,1,1,1] row_mask:0xf bank_mask:0xf
    v_add_f32_dpp v4, v35, v4 quad_perm:[3,3,3,3] row_mask:0xf bank_mask:0xf
    v_add_f32 v61, v61, v4
    v_cvt_pk_bf16_f32 v58, v60, v61
    v_mov_b32_dpp v60, v36 quad_perm:[0,0,0,0] row_mask:0xf bank_mask:0xf
    v_mov_b32_dpp v4, v38 quad_perm:[2,2,2,2] row_mask:0xf bank_mask:0xf
    s_nop 0
    v_add_f32_dpp v60, v37, v60 quad_perm:[1,1,1,1] row_mask:0xf bank_mask:0xf
    v_add_f32_dpp v4, v39, v4 quad_perm:[3,3,3,3] row_mask:0xf bank_mask:0xf
    v_add_f32 v60, v60, v4
    v_mov_b32_dpp v61, v40 quad_perm:[0,0,0,0] row_mask:0xf bank_mask:0xf
    v_mov_b32_dpp v4, v42 quad_perm:[2,2,2,2] row_mask:0xf bank_mask:0xf
    s_nop 0
    v_add_f32_dpp v61, v41, v61 quad_perm:[1,1,1,1] row_mask:0xf bank_mask:0xf
    v_add_f32_dpp v4, v43, v4 quad_perm:[3,3,3,3] row_mask:0xf bank_mask:0xf
    v_add_f32 v61, v61, v4
    v_cvt_pk_bf16_f32 v59, v60, v61
    s_mov_b32 exec_lo, 0x22222222
    s_mov_b32 exec_hi, 0x22222222
    v_mov_b32 v44, v48
    v_mov_b32 v45, v49
    v_mov_b32 v46, v50
    v_mov_b32 v47, v51
    s_mov_b32 exec_lo, 0x44444444
    s_mov_b32 exec_hi, 0x44444444
    v_mov_b32 v44, v52
    v_mov_b32 v45, v53
    v_mov_b32 v46, v54
    v_mov_b32 v47, v55
    s_mov_b32 exec_lo, 0x88888888
    s_mov_b32 exec_hi, 0x88888888
    v_mov_b32 v44, v56
    v_mov_b32 v45, v57
    v_mov_b32 v46, v58
    v_mov_b32 v47, v59
    s_mov_b64 exec, -1
    buffer_store_dwordx4 v[44:47], v19, s[48:51], s94 offen sc1
    s_waitcnt vmcnt(5)
L_qcheck_21:
    v_xor_b32 v68, s35, v68
    v_xor_b32 v69, s35, v69
    v_xor_b32 v70, s35, v70
    v_xor_b32 v71, s35, v71
    v_xor_b32 v72, s35, v72
    v_xor_b32 v73, s35, v73
    v_xor_b32 v74, s35, v74
    v_xor_b32 v75, s35, v75
    v_or_b32 v4, v68, v69
    v_or3_b32 v4, v4, v70, v71
    v_or3_b32 v4, v4, v72, v73
    v_or3_b32 v4, v4, v74, v75
    v_and_b32 v4, 0xff, v4
    v_cmp_ne_u32 vcc, 0, v4
    s_cbranch_vccz L_qok_22
    buffer_load_dwordx4 v[68:71], v78, s[48:51], s91 offen offset:0 sc1
    buffer_load_dwordx4 v[72:75], v78, s[48:51], s91 offen offset:16 sc1
    s_waitcnt vmcnt(0)
    s_sub_u32 s84, s84, 1
    s_cmp_lg_u32 s84, 0
    s_cbranch_scc1 L_qcheck_21
    s_branch L_end
L_qok_22:
    v_cvt_pk_bf16_f32 v68, v68, v69
    v_cvt_pk_bf16_f32 v69, v70, v71
    v_cvt_pk_bf16_f32 v70, v72, v73
    v_cvt_pk_bf16_f32 v71, v74, v75
    s_mov_b32 vcc_lo, 0xf000f
    s_mov_b32 vcc_hi, 0xf000f
    v_cndmask_b32 v80, 0, v68, vcc
    v_cndmask_b32 v81, 0, v69, vcc
    v_cndmask_b32 v82, 0, v70, vcc
    v_cndmask_b32 v83, 0, v71, vcc
    s_mov_b32 vcc_lo, 0xf000f0
    s_mov_b32 vcc_hi, 0xf000f0
    v_cndmask_b32 v84, 0, v68, vcc
    v_cndmask_b32 v85, 0, v69, vcc
    v_cndmask_b32 v86, 0, v70, vcc
    v_cndmask_b32 v87, 0, v71, vcc
    s_mov_b32 vcc_lo, 0xf000f00
    s_mov_b32 vcc_hi, 0xf000f00
    v_cndmask_b32 v88, 0, v68, vcc
    v_cndmask_b32 v89, 0, v69, vcc
    v_cndmask_b32 v90, 0, v70, vcc
    v_cndmask_b32 v91, 0, v71, vcc
    s_mov_b32 vcc_lo, 0xf000f000
    s_mov_b32 vcc_hi, 0xf000f000
    v_cndmask_b32 v92, 0, v68, vcc
    v_cndmask_b32 v93, 0, v69, vcc
    v_cndmask_b32 v94, 0, v70, vcc
    v_cndmask_b32 v95, 0, v71, vcc
    v_mov_b32 v65, 0xff7f0000
    s_lshl_b32 s38, s34, 14
    s_add_u32 s38, s38, 16384
    v_lshl_add_u32 v64, v1, 2, s38
    buffer_load_dwordx4 a[8:11], v76, s[52:55], s85 offen offset:1024 nt
    v_mfma_f32_16x16x32_bf16 v[112:115], v[128:131], v[80:83], 0
    v_mfma_f32_16x16x32_bf16 v[112:115], v[132:135], v[84:87], v[112:115]
    buffer_load_dwordx4 a[12:15], v77, s[52:55], s85 offen offset:1024 nt
    s_add_u32 s87, s87, 7
    s_add_u32 s39, s87, s88
    s_bfe_u32 s37, s39, 0x30000
    s_lshl_b32 s37, s37, 12
    s_add_u32 s85, s37, s89
    s_bfe_u32 s37, s39, 0x10003
    s_lshl_b32 s37, s37, 11
    s_add_u32 s85, s37, s85
    s_bfe_u32 s37, s39, 0x40004
    s_lshl_b32 s37, s37, 16
    s_add_u32 s85, s37, s85
    v_mfma_f32_16x16x32_bf16 v[112:115], v[136:139], v[88:91], v[112:115]
    v_mfma_f32_16x16x32_bf16 v[112:115], v[140:143], v[92:95], v[112:115]
    buffer_load_dwordx4 a[16:19], v76, s[52:55], s85 offen offset:0 nt
    v_mfma_f32_16x16x32_bf16 v[96:99], v[144:147], v[80:83], 0
    v_mfma_f32_16x16x32_bf16 v[96:99], v[148:151], v[84:87], v[96:99]
    v_mfma_f32_16x16x32_bf16 v[96:99], v[152:155], v[88:91], v[96:99]
    s_nop 3
    v_mov_b32_dpp v122, v112 quad_perm:[0,0,0,0] row_mask:0xf bank_mask:0xf
    v_mov_b32_dpp v124, v114 quad_perm:[2,2,2,2] row_mask:0xf bank_mask:0xf
    s_nop 0
    v_add_f32_dpp v122, v113, v122 quad_perm:[1,1,1,1] row_mask:0xf bank_mask:0xf
    v_add_f32_dpp v124, v115, v124 quad_perm:[3,3,3,3] row_mask:0xf bank_mask:0xf
    v_add_f32 v122, v122, v124
    v_max_f32 v65, v65, v122
    ds_write_b32 v64, v122 offset:0
    s_waitcnt vmcnt(7)
    buffer_load_dwordx4 a[20:23], v77, s[52:55], s85 offen offset:0 nt
    v_mfma_f32_16x16x32_bf16 v[96:99], v[156:159], v[92:95], v[96:99]
    v_mfma_f32_16x16x32_bf16 v[112:115], v[160:163], v[80:83], 0
    s_waitcnt vmcnt(7)
    buffer_load_dwordx4 a[24:27], v76, s[52:55], s85 offen offset:1024 nt
    v_mfma_f32_16x16x32_bf16 v[112:115], v[164:167], v[84:87], v[112:115]
    v_mfma_f32_16x16x32_bf16 v[112:115], v[168:171], v[88:91], v[112:115]
    s_nop 2
    v_mov_b32_dpp v122, v96 quad_perm:[0,0,0,0] row_mask:0xf bank_mask:0xf
    v_mov_b32_dpp v124, v98 quad_perm:[2,2,2,2] row_mask:0xf bank_mask:0xf
    s_nop 0
    v_add_f32_dpp v122, v97, v122 quad_perm:[1,1,1,1] row_mask:0xf bank_mask:0xf
    v_add_f32_dpp v124, v99, v124 quad_perm:[3,3,3,3] row_mask:0xf bank_mask:0xf
    v_add_f32 v122, v122, v124
    v_max_f32 v65, v65, v122
    ds_write_b32 v64, v122 offset:256
    v_mfma_f32_16x16x32_bf16 v[112:115], v[172:175], v[92:95], v[112:115]
    s_waitcnt vmcnt(7)
    buffer_load_dwordx4 a[28:31], v77, s[52:55], s85 offen offset:1024 nt
    s_add_u32 s87, s87, 7
    s_add_u32 s39, s87, s88
    s_bfe_u32 s37, s39, 0x30000
    s_lshl_b32 s37, s37, 12
    s_add_u32 s85, s37, s89
    s_bfe_u32 s37, s39, 0x10003
    s_lshl_b32 s37, s37, 11
    s_add_u32 s85, s37, s85
    s_bfe_u32 s37, s39, 0x40004
    s_lshl_b32 s37, s37, 16
    s_add_u32 s85, s37, s85
    v_mfma_f32_16x16x32_bf16 v[96:99], v[176:179], v[80:83], 0
    v_mfma_f32_16x16x32_bf16 v[96:99], v[180:183], v[84:87], v[96:99]
    s_waitcnt vmcnt(7)
    buffer_load_dwordx4 a[32:35], v76, s[52:55], s85 offen offset:0 nt
    v_mfma_f32_16x16x32_bf16 v[96:99], v[184:187], v[88:91], v[96:99]
    v_mov_b32_dpp v122, v112 quad_perm:[0,0,0,0] row_mask:0xf bank_mask:0xf
    v_mov_b32_dpp v124, v114 quad_perm:[2,2,2,2] row_mask:0xf bank_mask:0xf
    s_nop 0
    v_add_f32_dpp v122, v113, v122 quad_perm:[1,1,1,1] row_mask:0xf bank_mask:0xf
    v_add_f32_dpp v124, v115, v124 quad_perm:[3,3,3,3] row_mask:0xf bank_mask:0xf
    v_add_f32 v122, v122, v124
    v_max_f32 v65, v65, v122
    ds_write_b32 v64, v122 offset:512
    v_mfma_f32_16x16x32_bf16 v[96:99], v[188:191], v[92:95], v[96:99]
    s_lshl_b32 s38, s32, 8
    s_add_u32 s69, s38, 98304
    s_lshl_b32 s38, s34, 23
    s_add_u32 s69, s38, s69
    v_mov_b32 v48, s69
    v_mov_b32 v49, s68
    s_waitcnt vmcnt(7)
    s_barrier
    s_mov_b64 exec, 1
    buffer_store_dword v49, v48, s[48:51], 0 offen sc1
    s_mov_b64 exec, -1
    s_waitcnt vmcnt(7)
    buffer_load_dwordx4 a[36:39], v77, s[52:55], s85 offen offset:0 nt
    v_mfma_f32_16x16x32_bf16 v[112:115], v[192:195], v[80:83], 0
    v_mfma_f32_16x16x32_bf16 v[112:115], v[196:199], v[84:87], v[112:115]
    v_mfma_f32_16x16x32_bf16 v[112:115], v[200:203], v[88:91], v[112:115]
    v_mov_b32_dpp v122, v96 quad_perm:[0,0,0,0] row_mask:0xf bank_mask:0xf
    v_mov_b32_dpp v124, v98 quad_perm:[2,2,2,2] row_mask:0xf bank_mask:0xf
    s_nop 0
    v_add_f32_dpp v122, v97, v122 quad_perm:[1,1,1,1] row_mask:0xf bank_mask:0xf
    v_add_f32_dpp v124, v99, v124 quad_perm:[3,3,3,3] row_mask:0xf bank_mask:0xf
    v_add_f32 v122, v122, v124
    v_max_f32 v65, v65, v122
    ds_write_b32 v64, v122 offset:768
    s_waitcnt vmcnt(7)
    buffer_load_dwordx4 a[40:43], v76, s[52:55], s85 offen offset:1024 nt
    v_mfma_f32_16x16x32_bf16 v[112:115], v[204:207], v[92:95], v[112:115]
    v_mfma_f32_16x16x32_bf16 v[96:99], v[208:211], v[80:83], 0
    s_waitcnt vmcnt(7)
    buffer_load_dwordx4 a[44:47], v77, s[52:55], s85 offen offset:1024 nt
    s_add_u32 s87, s87, 7
    s_add_u32 s39, s87, s88
    s_bfe_u32 s37, s39, 0x30000
    s_lshl_b32 s37, s37, 12
    s_add_u32 s85, s37, s89
    s_bfe_u32 s37, s39, 0x10003
    s_lshl_b32 s37, s37, 11
    s_add_u32 s85, s37, s85
    s_bfe_u32 s37, s39, 0x40004
    s_lshl_b32 s37, s37, 16
    s_add_u32 s85, s37, s85
    v_mfma_f32_16x16x32_bf16 v[96:99], v[212:215], v[84:87], v[96:99]
    v_mfma_f32_16x16x32_bf16 v[96:99], v[216:219], v[88:91], v[96:99]
    v_mov_b32_dpp v122, v112 quad_perm:[0,0,0,0] row_mask:0xf bank_mask:0xf
    v_mov_b32_dpp v124, v114 quad_perm:[2,2,2,2] row_mask:0xf bank_mask:0xf
    s_nop 0
    v_add_f32_dpp v122, v113, v122 quad_perm:[1,1,1,1] row_mask:0xf bank_mask:0xf
    v_add_f32_dpp v124, v115, v124 quad_perm:[3,3,3,3] row_mask:0xf bank_mask:0xf
    v_add_f32 v122, v122, v124
    v_max_f32 v65, v65, v122
    ds_write_b32 v64, v122 offset:1024
    v_mfma_f32_16x16x32_bf16 v[96:99], v[220:223], v[92:95], v[96:99]
    s_waitcnt vmcnt(7)
    buffer_load_dwordx4 a[48:51], v76, s[52:55], s85 offen offset:0 nt
    v_mfma_f32_16x16x32_bf16 v[112:115], v[224:227], v[80:83], 0
    s_sub_u32 s36, s33, 3
    s_and_b32 s37, s33, 3
    s_cmp_lt_u32 s36, 4
    s_cselect_b64 s[40:41], s[24:25], s[14:15]
    s_cselect_b32 s36, s36, s37
    s_cselect_b32 s45, 262144, 0
    s_cselect_b32 s46, 8388608, 0
    s_add_u32 s45, s45, 524288
    s_add_u32 s46, s46, 196608
    s_mov_b32 s42, 4194304
    s_mov_b32 s43, 0x20000
    s_lshl_b32 s38, s32, 17
    s_add_u32 s44, s38, 0
    s_lshl_b32 s38, s34, 15
    s_add_u32 s44, s38, s44
    s_lshl_b32 s38, s36, 8
    s_add_u32 s44, s38, s44
    s_lshl_b32 s38, s36, 16
    s_add_u32 s45, s38, s45
    s_lshr_b32 s38, s34, 1
    s_lshl_b32 s38, s38, 15
    s_add_u32 s45, s38, s45
    s_lshl_b32 s38, s32, 8
    s_add_u32 s45, s38, s45
    s_bfe_u32 s38, s34, 0x10000
    s_lshl_b32 s38, s38, 7
    s_add_u32 s45, s38, s45
    s_lshl_b32 s38, s32, 11
    s_add_u32 s46, s38, s46
    s_lshl_b32 s38, s34, 9
    s_add_u32 s46, s38, s46
    s_mov_b32 s72, s26
    s_and_b32 s73, s27, 0xffff
    s_mov_b32 s74, 8192
    s_mov_b32 s75, 0x20000
    v_mfma_f32_16x16x32_bf16 v[112:115], v[228:231], v[84:87], v[112:115]
    s_waitcnt vmcnt(7)
    buffer_load_dwordx4 a[52:55], v77, s[52:55], s85 offen offset:0 nt
    v_mfma_f32_16x16x32_bf16 v[112:115], v[232:235], v[88:91], v[112:115]
    v_mov_b32_dpp v122, v96 quad_perm:[0,0,0,0] row_mask:0xf bank_mask:0xf
    v_mov_b32_dpp v124, v98 quad_perm:[2,2,2,2] row_mask:0xf bank_mask:0xf
    s_nop 0
    v_add_f32_dpp v122, v97, v122 quad_perm:[1,1,1,1] row_mask:0xf bank_mask:0xf
    v_add_f32_dpp v124, v99, v124 quad_perm:[3,3,3,3] row_mask:0xf bank_mask:0xf
    v_add_f32 v122, v122, v124
    v_max_f32 v65, v65, v122
    ds_write_b32 v64, v122 offset:1280
    v_mfma_f32_16x16x32_bf16 v[112:115], v[236:239], v[92:95], v[112:115]
    s_waitcnt vmcnt(7)
    buffer_load_dwordx4 a[56:59], v76, s[52:55], s85 offen offset:1024 nt
    v_mfma_f32_16x16x32_bf16 v[96:99], v[240:243], v[80:83], 0
    v_mfma_f32_16x16x32_bf16 v[96:99], v[244:247], v[84:87], v[96:99]
    v_mfma_f32_16x16x32_bf16 v[96:99], v[248:251], v[88:91], v[96:99]
    s_nop 2
    v_mov_b32_dpp v122, v112 quad_perm:[0,0,0,0] row_mask:0xf bank_mask:0xf
    v_mov_b32_dpp v124, v114 quad_perm:[2,2,2,2] row_mask:0xf bank_mask:0xf
    s_nop 0
    v_add_f32_dpp v122, v113, v122 quad_perm:[1,1,1,1] row_mask:0xf bank_mask:0xf
    v_add_f32_dpp v124, v115, v124 quad_perm:[3,3,3,3] row_mask:0xf bank_mask:0xf
    v_add_f32 v122, v122, v124
    v_max_f32 v65, v65, v122
    ds_write_b32 v64, v122 offset:1536
    v_lshlrev_b32 v4, 2, v2
    v_xor_b32 v4, v4, v3
    v_xor_b32 v5, 0, v4
    v_lshlrev_b32 v5, 4, v5
    v_lshl_add_u32 v20, v2, 10, v5
    v_xor_b32 v5, 1, v4
    v_lshlrev_b32 v5, 4, v5
    v_lshl_add_u32 v21, v2, 10, v5
    v_add_u32 v21, 3072, v21
    v_xor_b32 v5, 2, v4
    v_lshlrev_b32 v5, 4, v5
    v_lshl_add_u32 v22, v2, 10, v5
    v_add_u32 v22, 6144, v22
    v_xor_b32 v5, 3, v4
    v_lshlrev_b32 v5, 4, v5
    v_lshl_add_u32 v23, v2, 10, v5
    v_add_u32 v23, 9216, v23
    s_lshl_b32 s38, s32, 15
    s_add_u32 s47, s38, 1048576
    s_lshl_b32 s38, s3, 13
    s_add_u32 s47, s38, s47
    s_mul_i32 s38, s3, 320
    s_add_u32 s38, s38, 135168
    v_lshlrev_b32 v4, 6, v2
    v_lshl_add_u32 v4, v3, 1, v4
    v_add_u32 v31, s38, v4
    s_waitcnt vmcnt(7)
    buffer_load_dwordx4 a[60:63], v77, s[52:55], s85 offen offset:1024 nt
    s_add_u32 s87, s87, 7
    s_add_u32 s39, s87, s88
    s_bfe_u32 s37, s39, 0x30000
    s_lshl_b32 s37, s37, 12
    s_add_u32 s85, s37, s89
    s_bfe_u32 s37, s39, 0x10003
    s_lshl_b32 s37, s37, 11
    s_add_u32 s85, s37, s85
    s_bfe_u32 s37, s39, 0x40004
    s_lshl_b32 s37, s37, 16
    s_add_u32 s85, s37, s85
    v_mfma_f32_16x16x32_bf16 v[96:99], v[252:255], v[92:95], v[96:99]
    v_mfma_f32_16x16x32_bf16 v[112:115], a[0:3], v[80:83], 0
    s_waitcnt vmcnt(5)
    buffer_load_dwordx4 v[128:131], v76, s[52:55], s85 offen offset:0 nt
    v_mfma_f32_16x16x32_bf16 v[112:115], a[4:7], v[84:87], v[112:115]
    v_mfma_f32_16x16x32_bf16 v[112:115], a[8:11], v[88:91], v[112:115]
    s_nop 2
    v_mov_b32_dpp v122, v96 quad_perm:[0,0,0,0] row_mask:0xf bank_mask:0xf
    v_mov_b32_dpp v124, v98 quad_perm:[2,2,2,2] row_mask:0xf bank_mask:0xf
    s_nop 0
    v_add_f32_dpp v122, v97, v122 quad_perm:[1,1,1,1] row_mask:0xf bank_mask:0xf
    v_add_f32_dpp v124, v99, v124 quad_perm:[3,3,3,3] row_mask:0xf bank_mask:0xf
    v_add_f32 v122, v122, v124
    v_max_f32 v65, v65, v122
    ds_write_b32 v64, v122 offset:1792
    v_mfma_f32_16x16x32_bf16 v[112:115], a[12:15], v[92:95], v[112:115]
    s_waitcnt vmcnt(5)
    buffer_load_dwordx4 v[132:135], v77, s[52:55], s85 offen offset:0 nt
    v_mfma_f32_16x16x32_bf16 v[96:99], a[16:19], v[80:83], 0
    v_lshlrev_b32 v4, 11, v2
    v_bfe_u32 v5, v1, 2, 2
    v_lshl_add_u32 v4, v5, 8, v4
    v_bfe_u32 v5, v1, 2, 2
    v_lshl_add_u32 v4, v5, 6, v4
    v_bfe_u32 v5, v1, 4, 1
    v_lshl_add_u32 v4, v5, 5, v4
    v_bfe_u32 v5, v1, 1, 1
    v_lshl_add_u32 v4, v5, 4, v4
    v_bfe_u32 v5, v1, 0, 1
    v_lshl_add_u32 v4, v5, 3, v4
    s_lshl_b32 s38, s34, 6
    s_add_u32 s38, s38, 98304
    v_xor_b32 v24, s38, v4
    v_xor_b32 v25, 16, v24
    v_xor_b32 v26, 32, v24
    v_xor_b32 v27, 48, v24
    v_and_b32 v4, 3, v3
    v_lshrrev_b32 v5, 2, v3
    v_lshlrev_b32 v6, 4, v2
    v_add_u32 v6, 135168, v6
    s_movk_i32 s36, 320
    v_cmp_eq_u32 vcc, 0, v5
    s_nop 1
    v_cndmask_b32 v28, 4, v4, vcc
    v_mad_u32_u24 v28, v28, s36, v6
    v_cmp_eq_u32 vcc, 1, v5
    s_nop 1
    v_cndmask_b32 v29, 4, v4, vcc
    v_mad_u32_u24 v29, v29, s36, v6
    v_lshlrev_b32 v5, 2, v1
    v_add_u32 v5, 136448, v5
    v_mov_b32 v6, 0
    ds_write_b32 v5, v6
    v_mfma_f32_16x16x32_bf16 v[96:99], a[20:23], v[84:87], v[96:99]
    s_waitcnt vmcnt(5)
    buffer_load_dwordx4 v[136:139], v76, s[52:55], s85 offen offset:1024 nt
    v_mfma_f32_16x16x32_bf16 v[96:99], a[24:27], v[88:91], v[96:99]
    v_mov_b32_dpp v122, v112 quad_perm:[0,0,0,0] row_mask:0xf bank_mask:0xf
    v_mov_b32_dpp v124, v114 quad_perm:[2,2,2,2] row_mask:0xf bank_mask:0xf
    s_nop 0
    v_add_f32_dpp v122, v113, v122 quad_perm:[1,1,1,1] row_mask:0xf bank_mask:0xf
    v_add_f32_dpp v124, v115, v124 quad_perm:[3,3,3,3] row_mask:0xf bank_mask:0xf
    v_add_f32 v122, v122, v124
    v_max_f32 v65, v65, v122
    ds_write_b32 v64, v122 offset:2048
    v_mfma_f32_16x16x32_bf16 v[96:99], a[28:31], v[92:95], v[96:99]
    s_waitcnt vmcnt(5)
    buffer_load_dwordx4 v[140:143], v77, s[52:55], s85 offen offset:1024 nt
    s_add_u32 s87, s87, 7
    s_add_u32 s39, s87, s88
    s_bfe_u32 s37, s39, 0x30000
    s_lshl_b32 s37, s37, 12
    s_add_u32 s85, s37, s89
    s_bfe_u32 s37, s39, 0x10003
    s_lshl_b32 s37, s37, 11
    s_add_u32 s85, s37, s85
    s_bfe_u32 s37, s39, 0x40004
    s_lshl_b32 s37, s37, 16
    s_add_u32 s85, s37, s85
    v_mfma_f32_16x16x32_bf16 v[112:115], a[32:35], v[80:83], 0
    v_mfma_f32_16x16x32_bf16 v[112:115], a[36:39], v[84:87], v[112:115]
    v_mfma_f32_16x16x32_bf16 v[112:115], a[40:43], v[88:91], v[112:115]
    v_mov_b32_dpp v122, v96 quad_perm:[0,0,0,0] row_mask:0xf bank_mask:0xf
    v_mov_b32_dpp v124, v98 quad_perm:[2,2,2,2] row_mask:0xf bank_mask:0xf
    s_nop 0
    v_add_f32_dpp v122, v97, v122 quad_perm:[1,1,1,1] row_mask:0xf bank_mask:0xf
    v_add_f32_dpp v124, v99, v124 quad_perm:[3,3,3,3] row_mask:0xf bank_mask:0xf
    v_add_f32 v122, v122, v124
    v_max_f32 v65, v65, v122
    ds_write_b32 v64, v122 offset:2304
    v_lshlrev_b32 v30, 4, v3
    v_lshl_add_u32 v30, v2, 13, v30
    s_lshl_b32 s38, s32, 13
    s_add_u32 s36, s38, 0
    s_lshl_b32 s38, s34, 6
    s_add_u32 s36, s38, s36
    v_lshrrev_b32 v5, 2, v1
    v_lshlrev_b32 v32, 8, v5
    v_bfe_u32 v5, v1, 0, 2
    v_lshl_add_u32 v32, v5, 4, v32
    v_add_u32 v32, s36, v32
    s_lshr_b32 s38, s32, 2
    s_lshl_b32 s38, s38, 7
    s_add_u32 s36, s38, 0
    s_lshl_b32 s38, s34, 5
    s_add_u32 s36, s38, s36
    s_bfe_u32 s38, s32, 0x20000
    s_lshl_b32 s38, s38, 3
    s_add_u32 s36, s38, s36
    v_bfe_u32 v5, v1, 0, 2
    v_lshlrev_b32 v33, 11, v5
    v_lshl_add_u32 v33, v2, 1, v33
    v_add_u32 v33, s36, v33
    v_and_b32 v5, 31, v1
    v_lshlrev_b32 v34, 4, v5
    s_mul_i32 s38, s34, 320
    s_add_u32 s38, s38, 135168
    v_lshl_add_u32 v35, v5, 3, s38
    s_waitcnt vmcnt(5)
    buffer_load_dwordx4 v[144:147], v76, s[52:55], s85 offen offset:0 nt
    v_mfma_f32_16x16x32_bf16 v[112:115], a[44:47], v[92:95], v[112:115]
    v_mfma_f32_16x16x32_bf16 v[96:99], a[48:51], v[80:83], 0
    s_waitcnt vmcnt(5)
    buffer_load_dwordx4 v[148:151], v77, s[52:55], s85 offen offset:0 nt
    v_mfma_f32_16x16x32_bf16 v[96:99], a[52:55], v[84:87], v[96:99]
    v_mfma_f32_16x16x32_bf16 v[96:99], a[56:59], v[88:91], v[96:99]
    s_nop 2
    v_mov_b32_dpp v122, v112 quad_perm:[0,0,0,0] row_mask:0xf bank_mask:0xf
    v_mov_b32_dpp v124, v114 quad_perm:[2,2,2,2] row_mask:0xf bank_mask:0xf
    s_nop 0
    v_add_f32_dpp v122, v113, v122 quad_perm:[1,1,1,1] row_mask:0xf bank_mask:0xf
    v_add_f32_dpp v124, v115, v124 quad_perm:[3,3,3,3] row_mask:0xf bank_mask:0xf
    v_add_f32 v122, v122, v124
    v_max_f32 v65, v65, v122
    ds_write_b32 v64, v122 offset:2560
    v_mfma_f32_16x16x32_bf16 v[96:99], a[60:63], v[92:95], v[96:99]
    v_add_u32 v64, 2816, v64
    s_mov_b32 s97, 10
    s_mov_b32 s86, 32
    s_and_b32 s36, s32, 3
    s_sub_u32 s80, s36, 2
    s_cmp_ge_u32 s36, 2
    s_cselect_b32 s80, s80, 8
    s_cselect_b32 s81, 27, 25
    s_cmp_eq_u32 s80, s33
    s_cselect_b32 s36, 2, 0
    s_sub_u32 s86, s86, s36
    s_lshr_b32 s36, s36, 1
    s_sub_u32 s97, s97, s36
    s_add_u32 s80, s80, 35
    s_sub_u32 s92, s81, 1
    s_mov_b32 s66, 134217728
    s_mov_b32 s67, 0x20000
    s_mov_b64 s[64:65], s[52:53]
    v_mov_b32 v62, v76
    v_mov_b32 v63, v77
    s_branch L_bloop
L_aux:
    v_lshlrev_b32 v4, 2, v2
    v_xor_b32 v4, v4, v3
    v_xor_b32 v96, 0, v4
    v_lshlrev_b32 v96, 4, v96
    v_lshl_add_u32 v10, v2, 13, v96
    v_xor_b32 v97, 1, v4
    v_lshlrev_b32 v97, 4, v97
    v_lshl_add_u32 v11, v2, 13, v97
    v_add_u32 v11, 31744, v11
    v_xor_b32 v98, 2, v4
    v_lshlrev_b32 v98, 4, v98
    v_lshl_add_u32 v12, v2, 13, v98
    v_add_u32 v12, 63488, v12
    v_xor_b32 v99, 3, v4
    v_lshlrev_b32 v99, 4, v99
    v_lshl_add_u32 v13, v2, 13, v99
    v_add_u32 v13, 95232, v13
    s_lshl_b32 s90, s34, 15
    s_mov_b32 s62, 0
    s_lshl_b32 s38, s34, 20
    s_add_u32 s95, s38, 0
    s_lshl_b32 s38, s32, 8
    s_add_u32 s95, s38, s95
    s_waitcnt lgkmcnt(0)
    s_mov_b32 s52, s12
    s_and_b32 s53, s13, 0xffff
    s_mov_b32 s54, 4194304
    s_mov_b32 s55, 0x20000
    s_add_u32 s39, s90, s62
    s_mov_b32 m0, s39
    s_add_u32 s62, s62, 4096
    s_and_b32 s62, s62, 0x7fff
    buffer_load_dwordx4 v10, s[52:55], s95 offen offset:0 nt lds
    buffer_load_dwordx4 v11, s[52:55], s95 offen offset:1024 nt lds
    buffer_load_dwordx4 v12, s[52:55], s95 offen offset:2048 nt lds
    buffer_load_dwordx4 v13, s[52:55], s95 offen offset:3072 nt lds
    s_add_u32 s95, s95, 131072
    s_add_u32 s39, s90, s62
    s_mov_b32 m0, s39
    s_add_u32 s62, s62, 4096
    s_and_b32 s62, s62, 0x7fff
    buffer_load_dwordx4 v10, s[52:55], s95 offen offset:0 nt lds
    buffer_load_dwordx4 v11, s[52:55], s95 offen offset:1024 nt lds
    buffer_load_dwordx4 v12, s[52:55], s95 offen offset:2048 nt lds
    buffer_load_dwordx4 v13, s[52:55], s95 offen offset:3072 nt lds
    s_add_u32 s95, s95, 131072
    s_load_dword s35, s[30:31], 0
    s_mov_b32 s48, s30
    s_and_b32 s49, s31, 0xffff
    s_mov_b32 s50, 8388608
    s_mov_b32 s51, 0x20000
    s_mov_b32 s82, 0xffffff00
    s_mov_b32 s83, 0x3e0293ee
    s_mov_b32 s84, 2097152
    v_lshl_add_u32 v76, v2, 10, v96
    v_lshl_add_u32 v96, v2, 8, v96
    v_lshl_add_u32 v77, v2, 10, v97
    v_lshl_add_u32 v97, v2, 8, v97
    v_add_u32 v77, 3072, v77
    v_lshl_add_u32 v78, v2, 10, v98
    v_lshl_add_u32 v98, v2, 8, v98
    v_add_u32 v78, 6144, v78
    v_lshl_add_u32 v79, v2, 10, v99
    v_lshl_add_u32 v99, v2, 8, v99
    v_add_u32 v79, 9216, v79
    v_bfe_u32 v100, v1, 0, 5
    v_lshlrev_b32 v101, 8, v100
    v_lshlrev_b32 v9, 4, v3
    v_lshl_add_u32 v9, v2, 10, v9
    v_xor_b32 v5, v3, v2
    v_bfe_u32 v4, v3, 2, 1
    v_lshlrev_b32 v6, 11, v4
    v_bfe_u32 v4, v3, 3, 1
    v_lshl_add_u32 v6, v4, 10, v6
    v_bfe_u32 v4, v3, 0, 2
    v_lshl_add_u32 v6, v4, 8, v6
    v_bfe_u32 v4, v5, 0, 2
    v_lshl_add_u32 v6, v4, 6, v6
    v_bfe_u32 v4, v3, 2, 1
    v_lshl_add_u32 v6, v4, 5, v6
    v_bfe_u32 v4, v3, 3, 1
    v_lshl_add_u32 v6, v4, 4, v6
    v_add_u32 v60, s90, v6
    v_xor_b32 v61, 16, v60
    v_xor_b32 v62, 32, v60
    v_xor_b32 v63, 48, v60
    v_lshrrev_b32 v5, 4, v1
    v_xor_b32 v5, v5, v1
    v_bfe_u32 v4, v1, 4, 1
    v_lshlrev_b32 v6, 11, v4
    v_bfe_u32 v4, v1, 5, 1
    v_lshl_add_u32 v6, v4, 10, v6
    v_bfe_u32 v4, v1, 2, 2
    v_lshl_add_u32 v6, v4, 8, v6
    v_bfe_u32 v4, v1, 2, 2
    v_lshl_add_u32 v6, v4, 6, v6
    v_bfe_u32 v4, v1, 4, 1
    v_lshl_add_u32 v6, v4, 5, v6
    v_bfe_u32 v4, v5, 1, 1
    v_lshl_add_u32 v6, v4, 4, v6
    v_bfe_u32 v4, v1, 0, 1
    v_lshl_add_u32 v6, v4, 3, v6
    v_add_u32 v82, s90, v6
    v_xor_b32 v83, 32, v82
    v_xor_b32 v84, 64, v82
    v_xor_b32 v85, 96, v82
    v_xor_b32 v86, 128, v82
    v_xor_b32 v87, 160, v82
    v_xor_b32 v88, 192, v82
    v_xor_b32 v89, 224, v82
    v_lshlrev_b32 v6, 11, v2
    v_bfe_u32 v4, v1, 2, 2
    v_lshl_add_u32 v6, v4, 8, v6
    v_bfe_u32 v4, v1, 2, 2
    v_lshl_add_u32 v6, v4, 6, v6
    v_bfe_u32 v4, v1, 4, 1
    v_lshl_add_u32 v6, v4, 5, v6
    v_bfe_u32 v4, v1, 1, 1
    v_lshl_add_u32 v6, v4, 4, v6
    v_bfe_u32 v4, v1, 0, 1
    v_lshl_add_u32 v6, v4, 3, v6
    v_add_u32 v136, s90, v6
    v_xor_b32 v137, 16, v136
    v_xor_b32 v138, 32, v136
    v_xor_b32 v139, 48, v136
    v_xor_b32 v140, 64, v136
    v_xor_b32 v141, 80, v136
    v_xor_b32 v142, 96, v136
    v_xor_b32 v143, 112, v136
    v_xor_b32 v144, 128, v136
    v_xor_b32 v145, 144, v136
    v_xor_b32 v146, 160, v136
    v_xor_b32 v147, 176, v136
    v_xor_b32 v148, 192, v136
    v_xor_b32 v149, 208, v136
    v_xor_b32 v150, 224, v136
    v_xor_b32 v151, 240, v136
    s_lshl_b32 s85, s34, 13
    s_add_u32 s85, s85, 131072
    v_lshl_add_u32 v94, v1, 4, s85
    v_add_u32 v96, s85, v96
    v_add_u32 v97, s85, v97
    v_add_u32 v98, s85, v98
    v_add_u32 v99, s85, v99
    s_add_u32 s39, s90, s62
    s_mov_b32 m0, s39
    s_add_u32 s62, s62, 4096
    s_and_b32 s62, s62, 0x7fff
    buffer_load_dwordx4 v10, s[52:55], s95 offen offset:0 nt lds
    buffer_load_dwordx4 v11, s[52:55], s95 offen offset:1024 nt lds
    buffer_load_dwordx4 v12, s[52:55], s95 offen offset:2048 nt lds
    buffer_load_dwordx4 v13, s[52:55], s95 offen offset:3072 nt lds
    s_add_u32 s95, s95, 131072
    s_add_u32 s39, s90, s62
    s_mov_b32 m0, s39
    s_add_u32 s62, s62, 4096
    s_and_b32 s62, s62, 0x7fff
    buffer_load_dwordx4 v10, s[52:55], s95 offen offset:0 nt lds
    buffer_load_dwordx4 v11, s[52:55], s95 offen offset:1024 nt lds
    buffer_load_dwordx4 v12, s[52:55], s95 offen offset:2048 nt lds
    buffer_load_dwordx4 v13, s[52:55], s95 offen offset:3072 nt lds
    s_add_u32 s95, s95, 131072
    s_add_u32 s39, s90, s62
    s_mov_b32 m0, s39
    s_add_u32 s62, s62, 4096
    s_and_b32 s62, s62, 0x7fff
    buffer_load_dwordx4 v10, s[52:55], s95 offen offset:0 nt lds
    buffer_load_dwordx4 v11, s[52:55], s95 offen offset:1024 nt lds
    buffer_load_dwordx4 v12, s[52:55], s95 offen offset:2048 nt lds
    buffer_load_dwordx4 v13, s[52:55], s95 offen offset:3072 nt lds
    s_add_u32 s95, s95, 131072
    s_add_u32 s39, s90, s62
    s_mov_b32 m0, s39
    s_add_u32 s62, s62, 4096
    s_and_b32 s62, s62, 0x7fff
    buffer_load_dwordx4 v10, s[52:55], s95 offen offset:0 nt lds
    buffer_load_dwordx4 v11, s[52:55], s95 offen offset:1024 nt lds
    buffer_load_dwordx4 v12, s[52:55], s95 offen offset:2048 nt lds
    buffer_load_dwordx4 v13, s[52:55], s95 offen offset:3072 nt lds
    s_add_u32 s95, s95, 131072
    s_add_u32 s39, s90, s62
    s_mov_b32 m0, s39
    s_add_u32 s62, s62, 4096
    s_and_b32 s62, s62, 0x7fff
    buffer_load_dwordx4 v10, s[52:55], s95 offen offset:0 nt lds
    buffer_load_dwordx4 v11, s[52:55], s95 offen offset:1024 nt lds
    buffer_load_dwordx4 v12, s[52:55], s95 offen offset:2048 nt lds
    buffer_load_dwordx4 v13, s[52:55], s95 offen offset:3072 nt lds
    s_add_u32 s95, s95, 131072
    s_add_u32 s39, s90, s62
    s_mov_b32 m0, s39
    s_add_u32 s62, s62, 4096
    s_and_b32 s62, s62, 0x7fff
    buffer_load_dwordx4 v10, s[52:55], s95 offen offset:0 nt lds
    buffer_load_dwordx4 v11, s[52:55], s95 offen offset:1024 nt lds
    buffer_load_dwordx4 v12, s[52:55], s95 offen offset:2048 nt lds
    buffer_load_dwordx4 v13, s[52:55], s95 offen offset:3072 nt lds
    s_add_u32 s95, s95, 131072
    s_waitcnt lgkmcnt(0)
    s_add_u32 s35, s35, 0x5b
    s_and_b32 s35, s35, 0xff
    v_mov_b32 v8, s35
    s_or_b32 s68, s35, 0x6b3ac500
    s_mov_b32 s52, s6
    s_and_b32 s53, s7, 0xffff
    s_mov_b32 s54, 16777216
    s_mov_b32 s55, 0x20000
    s_bfe_u32 s38, s32, 0x30000
    s_lshl_b32 s38, s38, 1
    s_add_u32 s3, s38, 0
    s_lshr_b32 s38, s32, 4
    s_lshl_b32 s38, s38, 0
    s_add_u32 s3, s38, s3
    s_bfe_u32 s94, s32, 0x10003
    s_lshl_b32 s38, s3, 20
    s_add_u32 s95, s38, 0
    s_lshl_b32 s38, s34, 8
    s_add_u32 s95, s38, s95
    s_waitcnt vmcnt(24)
    ds_read_b64_tr_b16 a[128:129], v136 offset:0
    ds_read_b64_tr_b16 a[130:131], v137 offset:1024
    ds_read_b64_tr_b16 a[144:145], v138 offset:0
    ds_read_b64_tr_b16 a[146:147], v139 offset:1024
    ds_read_b64_tr_b16 a[160:161], v140 offset:0
    ds_read_b64_tr_b16 a[162:163], v141 offset:1024
    ds_read_b64_tr_b16 a[176:177], v142 offset:0
    ds_read_b64_tr_b16 a[178:179], v143 offset:1024
    ds_read_b64_tr_b16 a[192:193], v144 offset:0
    ds_read_b64_tr_b16 a[194:195], v145 offset:1024
    ds_read_b64_tr_b16 a[208:209], v146 offset:0
    ds_read_b64_tr_b16 a[210:211], v147 offset:1024
    ds_read_b64_tr_b16 a[224:225], v148 offset:0
    ds_read_b64_tr_b16 a[226:227], v149 offset:1024
    ds_read_b64_tr_b16 a[240:241], v150 offset:0
    ds_read_b64_tr_b16 a[242:243], v151 offset:1024
    s_waitcnt lgkmcnt(0)
    s_add_u32 s39, s90, s62
    s_mov_b32 m0, s39
    s_add_u32 s62, s62, 4096
    s_and_b32 s62, s62, 0x7fff
    buffer_load_dwordx4 v76, s[52:55], s95 offen offset:0 nt lds
    buffer_load_dwordx4 v77, s[52:55], s95 offen offset:1024 nt lds
    buffer_load_dwordx4 v78, s[52:55], s95 offen offset:2048 nt lds
    buffer_load_dwordx4 v79, s[52:55], s95 offen offset:3072 nt lds
    s_add_u32 s95, s95, 16384
    s_add_u32 s39, s90, s62
    s_mov_b32 m0, s39
    s_add_u32 s62, s62, 4096
    s_and_b32 s62, s62, 0x7fff
    buffer_load_dwordx4 v76, s[52:55], s95 offen offset:0 nt lds
    buffer_load_dwordx4 v77, s[52:55], s95 offen offset:1024 nt lds
    buffer_load_dwordx4 v78, s[52:55], s95 offen offset:2048 nt lds
    buffer_load_dwordx4 v79, s[52:55], s95 offen offset:3072 nt lds
    s_add_u32 s95, s95, 16384
    s_waitcnt vmcnt(24)
    ds_read_b64_tr_b16 a[132:133], v136 offset:8192
    ds_read_b64_tr_b16 a[134:135], v137 offset:9216
    ds_read_b64_tr_b16 a[148:149], v138 offset:8192
    ds_read_b64_tr_b16 a[150:151], v139 offset:9216
    ds_read_b64_tr_b16 a[164:165], v140 offset:8192
    ds_read_b64_tr_b16 a[166:167], v141 offset:9216
    ds_read_b64_tr_b16 a[180:181], v142 offset:8192
    ds_read_b64_tr_b16 a[182:183], v143 offset:9216
    ds_read_b64_tr_b16 a[196:197], v144 offset:8192
    ds_read_b64_tr_b16 a[198:199], v145 offset:9216
    ds_read_b64_tr_b16 a[212:213], v146 offset:8192
    ds_read_b64_tr_b16 a[214:215], v147 offset:9216
    ds_read_b64_tr_b16 a[228:229], v148 offset:8192
    ds_read_b64_tr_b16 a[230:231], v149 offset:9216
    ds_read_b64_tr_b16 a[244:245], v150 offset:8192
    ds_read_b64_tr_b16 a[246:247], v151 offset:9216
    s_waitcnt lgkmcnt(0)
    s_add_u32 s39, s90, s62
    s_mov_b32 m0, s39
    s_add_u32 s62, s62, 4096
    s_and_b32 s62, s62, 0x7fff
    buffer_load_dwordx4 v76, s[52:55], s95 offen offset:0 nt lds
    buffer_load_dwordx4 v77, s[52:55], s95 offen offset:1024 nt lds
    buffer_load_dwordx4 v78, s[52:55], s95 offen offset:2048 nt lds
    buffer_load_dwordx4 v79, s[52:55], s95 offen offset:3072 nt lds
    s_add_u32 s95, s95, 16384
    s_add_u32 s39, s90, s62
    s_mov_b32 m0, s39
    s_add_u32 s62, s62, 4096
    s_and_b32 s62, s62, 0x7fff
    buffer_load_dwordx4 v76, s[52:55], s95 offen offset:0 nt lds
    buffer_load_dwordx4 v77, s[52:55], s95 offen offset:1024 nt lds
    buffer_load_dwordx4 v78, s[52:55], s95 offen offset:2048 nt lds
    buffer_load_dwordx4 v79, s[52:55], s95 offen offset:3072 nt lds
    s_add_u32 s95, s95, 16384
    s_waitcnt vmcnt(24)
    ds_read_b64_tr_b16 a[136:137], v136 offset:16384
    ds_read_b64_tr_b16 a[138:139], v137 offset:17408
    ds_read_b64_tr_b16 a[152:153], v138 offset:16384
    ds_read_b64_tr_b16 a[154:155], v139 offset:17408
    ds_read_b64_tr_b16 a[168:169], v140 offset:16384
    ds_read_b64_tr_b16 a[170:171], v141 offset:17408
    ds_read_b64_tr_b16 a[184:185], v142 offset:16384
    ds_read_b64_tr_b16 a[186:187], v143 offset:17408
    ds_read_b64_tr_b16 a[200:201], v144 offset:16384
    ds_read_b64_tr_b16 a[202:203], v145 offset:17408
    ds_read_b64_tr_b16 a[216:217], v146 offset:16384
    ds_read_b64_tr_b16 a[218:219], v147 offset:17408
    ds_read_b64_tr_b16 a[232:233], v148 offset:16384
    ds_read_b64_tr_b16 a[234:235], v149 offset:17408
    ds_read_b64_tr_b16 a[248:249], v150 offset:16384
    ds_read_b64_tr_b16 a[250:251], v151 offset:17408
    s_waitcnt lgkmcnt(0)
    s_add_u32 s39, s90, s62
    s_mov_b32 m0, s39
    s_add_u32 s62, s62, 4096
    s_and_b32 s62, s62, 0x7fff
    buffer_load_dwordx4 v76, s[52:55], s95 offen offset:0 nt lds
    buffer_load_dwordx4 v77, s[52:55], s95 offen offset:1024 nt lds
    buffer_load_dwordx4 v78, s[52:55], s95 offen offset:2048 nt lds
    buffer_load_dwordx4 v79, s[52:55], s95 offen offset:3072 nt lds
    s_add_u32 s95, s95, 16384
    s_add_u32 s39, s90, s62
    s_mov_b32 m0, s39
    s_add_u32 s62, s62, 4096
    s_and_b32 s62, s62, 0x7fff
    buffer_load_dwordx4 v76, s[52:55], s95 offen offset:0 nt lds
    buffer_load_dwordx4 v77, s[52:55], s95 offen offset:1024 nt lds
    buffer_load_dwordx4 v78, s[52:55], s95 offen offset:2048 nt lds
    buffer_load_dwordx4 v79, s[52:55], s95 offen offset:3072 nt lds
    s_add_u32 s95, s95, 16384
    s_waitcnt vmcnt(24)
    ds_read_b64_tr_b16 a[140:141], v136 offset:24576
    ds_read_b64_tr_b16 a[142:143], v137 offset:25600
    ds_read_b64_tr_b16 a[156:157], v138 offset:24576
    ds_read_b64_tr_b16 a[158:159], v139 offset:25600
    ds_read_b64_tr_b16 a[172:173], v140 offset:24576
    ds_read_b64_tr_b16 a[174:175], v141 offset:25600
    ds_read_b64_tr_b16 a[188:189], v142 offset:24576
    ds_read_b64_tr_b16 a[190:191], v143 offset:25600
    ds_read_b64_tr_b16 a[204:205], v144 offset:24576
    ds_read_b64_tr_b16 a[206:207], v145 offset:25600
    ds_read_b64_tr_b16 a[220:221], v146 offset:24576
    ds_read_b64_tr_b16 a[222:223], v147 offset:25600
    ds_read_b64_tr_b16 a[236:237], v148 offset:24576
    ds_read_b64_tr_b16 a[238:239], v149 offset:25600
    ds_read_b64_tr_b16 a[252:253], v150 offset:24576
    ds_read_b64_tr_b16 a[254:255], v151 offset:25600
    s_waitcnt lgkmcnt(0)
    s_add_u32 s39, s90, s62
    s_mov_b32 m0, s39
    s_add_u32 s62, s62, 4096
    s_and_b32 s62, s62, 0x7fff
    buffer_load_dwordx4 v76, s[52:55], s95 offen offset:0 nt lds
    buffer_load_dwordx4 v77, s[52:55], s95 offen offset:1024 nt lds
    s_mov_b32 s86, 98304
    buffer_load_dword v7, v101, s[48:51], s86 offen sc1
    v_mov_b32 v104, 0
    v_mov_b32 v105, 0
    v_mov_b32 v106, 0
    v_mov_b32 v107, 0
    v_mov_b32 v108, 0
    v_mov_b32 v109, 0
    v_mov_b32 v110, 0
    v_mov_b32 v111, 0
    v_mov_b32 v112, 0
    v_mov_b32 v113, 0
    v_mov_b32 v114, 0
    v_mov_b32 v115, 0
    v_mov_b32 v116, 0
    v_mov_b32 v117, 0
    v_mov_b32 v118, 0
    v_mov_b32 v119, 0
    v_mov_b32 v120, 0
    v_mov_b32 v121, 0
    v_mov_b32 v122, 0
    v_mov_b32 v123, 0
    v_mov_b32 v124, 0
    v_mov_b32 v125, 0
    v_mov_b32 v126, 0
    v_mov_b32 v127, 0
    v_mov_b32 v128, 0
    v_mov_b32 v129, 0
    v_mov_b32 v130, 0
    v_mov_b32 v131, 0
    v_mov_b32 v132, 0
    v_mov_b32 v133, 0
    v_mov_b32 v134, 0
    v_mov_b32 v135, 0
    v_mov_b32 v90, 0xff7f0000
    s_mov_b32 s93, 0
    v_mov_b32 v102, 0
    v_mov_b32 v103, 0
    s_mov_b32 s60, s83
    s_mov_b32 s61, s83
    v_xor_b32 v5, v3, v2
    v_lshlrev_b32 v6, 8, v3
    v_bfe_u32 v4, v5, 0, 2
    v_lshl_add_u32 v6, v4, 6, v6
    v_lshrrev_b32 v4, 2, v3
    v_lshl_add_u32 v6, v4, 4, v6
    v_add_u32 v52, s85, v6
    v_xor_b32 v53, 16, v52
    v_xor_b32 v54, 32, v52
    v_xor_b32 v55, 48, v52
    s_lshr_b32 s38, s3, 2
    s_lshl_b32 s38, s38, 15
    s_add_u32 s36, s38, 393216
    s_lshl_b32 s38, s94, 14
    s_add_u32 s36, s38, s36
    s_lshl_b32 s38, s34, 8
    s_add_u32 s36, s38, s36
    s_waitcnt vmcnt(0)
L_fcheck_23:
    v_cmp_ne_u32 vcc, s68, v7
    s_cbranch_vccz L_fok_24
    s_sleep 2
    s_mov_b32 s86, 98304
    buffer_load_dword v7, v101, s[48:51], s86 offen sc1
    s_waitcnt vmcnt(0)
    s_sub_u32 s84, s84, 1
    s_cmp_lg_u32 s84, 0
    s_cbranch_scc1 L_fcheck_23
    s_branch L_end
L_fok_24:
    buffer_load_dwordx4 v[200:203], v9, s[48:51], s36 offen sc1
    s_add_u32 s36, s36, 4096
    buffer_load_dwordx4 v[204:207], v9, s[48:51], s36 offen sc1
    s_add_u32 s36, s36, 4096
    buffer_load_dwordx4 v[208:211], v9, s[48:51], s36 offen sc1
    s_add_u32 s36, s36, 4096
    buffer_load_dwordx4 v[212:215], v9, s[48:51], s36 offen sc1
    ds_read_b128 v[136:139], v60 offset:0
    ds_read_b128 v[140:143], v61 offset:0
    ds_read_b128 v[144:147], v62 offset:0
    ds_read_b128 v[148:151], v63 offset:0
    ds_read_b128 v[152:155], v60 offset:4096
    ds_read_b128 v[156:159], v61 offset:4096
    ds_read_b128 v[160:163], v62 offset:4096
    ds_read_b128 v[164:167], v63 offset:4096
    ds_read_b128 v[168:171], v60 offset:8192
    ds_read_b128 v[172:175], v61 offset:8192
    ds_read_b128 v[176:179], v62 offset:8192
    ds_read_b128 v[180:183], v63 offset:8192
    ds_read_b128 v[184:187], v60 offset:12288
    ds_read_b128 v[188:191], v61 offset:12288
    ds_read_b128 v[192:195], v62 offset:12288
    ds_read_b128 v[196:199], v63 offset:12288
    s_waitcnt vmcnt(3)
    ds_write_b128 v96, v[200:203] offset:0
    s_waitcnt vmcnt(2)
    ds_write_b128 v97, v[204:207] offset:1024
    s_waitcnt vmcnt(1)
    ds_write_b128 v98, v[208:211] offset:2048
    s_waitcnt vmcnt(0)
    ds_write_b128 v99, v[212:215] offset:3072
    s_waitcnt lgkmcnt(0)
    ds_read_b128 v[36:39], v52
    ds_read_b128 v[40:43], v53
    ds_read_b128 v[44:47], v54
    ds_read_b128 v[48:51], v55
L_att:
    s_waitcnt lgkmcnt(0)
    v_mfma_f32_16x16x32_bf16 v[200:203], v[136:139], v[36:39], 0
    ds_read_b64_tr_b16 a[0:1], v82 offset:0
    ds_read_b64_tr_b16 a[2:3], v82 offset:4096
    buffer_load_dwordx4 v78, s[52:55], s95 offen offset:2048 nt lds
    v_mfma_f32_16x16x32_bf16 v[200:203], v[140:143], v[40:43], v[200:203]
    ds_read_b64_tr_b16 a[4:5], v83 offset:0
    ds_read_b64_tr_b16 a[6:7], v83 offset:4096
    v_mfma_f32_16x16x32_bf16 v[200:203], v[144:147], v[44:47], v[200:203]
    ds_read_b64_tr_b16 a[8:9], v84 offset:0
    ds_read_b64_tr_b16 a[10:11], v84 offset:4096
    v_mfma_f32_16x16x32_bf16 v[200:203], v[148:151], v[48:51], v[200:203]
    ds_read_b64_tr_b16 a[12:13], v85 offset:0
    ds_read_b64_tr_b16 a[14:15], v85 offset:4096
    buffer_load_dwordx4 v79, s[52:55], s95 offen offset:3072 nt lds
    s_add_u32 s95, s95, 16384
    v_mfma_f32_16x16x32_bf16 v[204:207], v[152:155], v[36:39], 0
    ds_read_b64_tr_b16 a[16:17], v86 offset:0
    ds_read_b64_tr_b16 a[18:19], v86 offset:4096
    v_mfma_f32_16x16x32_bf16 v[204:207], v[156:159], v[40:43], v[204:207]
    ds_read_b64_tr_b16 a[20:21], v87 offset:0
    ds_read_b64_tr_b16 a[22:23], v87 offset:4096
    v_mfma_f32_16x16x32_bf16 v[204:207], v[160:163], v[44:47], v[204:207]
    ds_read_b64_tr_b16 a[24:25], v88 offset:0
    ds_read_b64_tr_b16 a[26:27], v88 offset:4096
    s_add_u32 s39, s90, s62
    s_mov_b32 m0, s39
    s_add_u32 s62, s62, 4096
    s_and_b32 s62, s62, 0x7fff
    buffer_load_dwordx4 v76, s[52:55], s95 offen offset:0 nt lds
    v_mfma_f32_16x16x32_bf16 v[204:207], v[164:167], v[48:51], v[204:207]
    ds_read_b64_tr_b16 a[28:29], v89 offset:0
    ds_read_b64_tr_b16 a[30:31], v89 offset:4096
    ds_write_b128 v94, v[200:203] offset:0
    v_mfma_f32_16x16x32_bf16 v[208:211], v[168:171], v[36:39], 0
    ds_read_b64_tr_b16 a[32:33], v82 offset:8192
    ds_read_b64_tr_b16 a[34:35], v82 offset:12288
    v_mfma_f32_16x16x32_bf16 v[208:211], v[172:175], v[40:43], v[208:211]
    ds_read_b64_tr_b16 a[36:37], v83 offset:8192
    ds_read_b64_tr_b16 a[38:39], v83 offset:12288
    buffer_load_dwordx4 v77, s[52:55], s95 offen offset:1024 nt lds
    v_mfma_f32_16x16x32_bf16 v[208:211], v[176:179], v[44:47], v[208:211]
    ds_read_b64_tr_b16 a[40:41], v84 offset:8192
    ds_read_b64_tr_b16 a[42:43], v84 offset:12288
    v_mfma_f32_16x16x32_bf16 v[208:211], v[180:183], v[48:51], v[208:211]
    ds_read_b64_tr_b16 a[44:45], v85 offset:8192
    ds_read_b64_tr_b16 a[46:47], v85 offset:12288
    ds_write_b128 v94, v[204:207] offset:1024
    v_mfma_f32_16x16x32_bf16 v[212:215], v[184:187], v[36:39], 0
    ds_read_b64_tr_b16 a[48:49], v86 offset:8192
    ds_read_b64_tr_b16 a[50:51], v86 offset:12288
    buffer_load_dwordx4 v78, s[52:55], s95 offen offset:2048 nt lds
    v_mfma_f32_16x16x32_bf16 v[212:215], v[188:191], v[40:43], v[212:215]
    ds_read_b64_tr_b16 a[52:53], v87 offset:8192
    ds_read_b64_tr_b16 a[54:55], v87 offset:12288
    v_mfma_f32_16x16x32_bf16 v[212:215], v[192:195], v[44:47], v[212:215]
    ds_read_b64_tr_b16 a[56:57], v88 offset:8192
    ds_read_b64_tr_b16 a[58:59], v88 offset:12288
    v_mfma_f32_16x16x32_bf16 v[212:215], v[196:199], v[48:51], v[212:215]
    ds_read_b64_tr_b16 a[60:61], v89 offset:8192
    ds_read_b64_tr_b16 a[62:63], v89 offset:12288
    buffer_load_dwordx4 v79, s[52:55], s95 offen offset:3072 nt lds
    s_add_u32 s95, s95, 16384
    ds_write_b128 v94, v[208:211] offset:2048
    v_xor_b32 v5, 0x2000, v94
    v_xor_b32 v6, 0x4000, v94
    v_xor_b32 v7, 0x6000, v94
    s_cmp_eq_u32 s93, 14
    s_cselect_b32 s95, 16777216, s95
    ds_write_b128 v94, v[212:215] offset:3072
    v_xor_b32 v82, 0x4000, v82
    v_xor_b32 v83, 0x4000, v83
    v_xor_b32 v84, 0x4000, v84
    v_xor_b32 v85, 0x4000, v85
    v_xor_b32 v86, 0x4000, v86
    v_xor_b32 v87, 0x4000, v87
    v_xor_b32 v88, 0x4000, v88
    v_xor_b32 v89, 0x4000, v89
    v_xor_b32 v60, 0x4000, v60
    v_xor_b32 v61, 0x4000, v61
    v_xor_b32 v62, 0x4000, v62
    v_xor_b32 v63, 0x4000, v63
    s_waitcnt lgkmcnt(0)
    s_barrier
    ds_read_b128 v[136:139], v5 offset:0
    ds_read_b128 v[152:155], v6 offset:0
    ds_read_b128 v[168:171], v7 offset:0
    ds_read_b128 v[140:143], v5 offset:1024
    ds_read_b128 v[156:159], v6 offset:1024
    ds_read_b128 v[172:175], v7 offset:1024
    ds_read_b128 v[144:147], v5 offset:2048
    ds_read_b128 v[160:163], v6 offset:2048
    ds_read_b128 v[176:179], v7 offset:2048
    ds_read_b128 v[148:151], v5 offset:3072
    ds_read_b128 v[164:167], v6 offset:3072
    ds_read_b128 v[180:183], v7 offset:3072
    v_xor_b32 v94, 0x1000, v94
    s_add_u32 s39, s90, s62
    s_mov_b32 m0, s39
    s_add_u32 s62, s62, 4096
    s_and_b32 s62, s62, 0x7fff
    buffer_load_dwordx4 v76, s[52:55], s95 offen offset:0 nt lds
    buffer_load_dwordx4 v77, s[52:55], s95 offen offset:1024 nt lds
    buffer_load_dwordx4 v78, s[52:55], s95 offen offset:2048 nt lds
    s_waitcnt lgkmcnt(9)
    v_pk_add_f32 v[200:201], v[200:201], v[136:137]
    v_pk_add_f32 v[152:153], v[152:153], v[168:169]
    v_pk_add_f32 v[202:203], v[202:203], v[138:139]
    v_pk_add_f32 v[154:155], v[154:155], v[170:171]
    v_pk_add_f32 v[200:201], v[200:201], v[152:153]
    v_pk_add_f32 v[202:203], v[202:203], v[154:155]
    s_waitcnt lgkmcnt(6)
    v_pk_add_f32 v[204:205], v[204:205], v[140:141]
    v_pk_add_f32 v[156:157], v[156:157], v[172:173]
    v_pk_add_f32 v[206:207], v[206:207], v[142:143]
    v_pk_add_f32 v[158:159], v[158:159], v[174:175]
    v_pk_add_f32 v[204:205], v[204:205], v[156:157]
    v_pk_add_f32 v[206:207], v[206:207], v[158:159]
    s_waitcnt lgkmcnt(3)
    v_pk_add_f32 v[208:209], v[208:209], v[144:145]
    v_pk_add_f32 v[160:161], v[160:161], v[176:177]
    v_pk_add_f32 v[210:211], v[210:211], v[146:147]
    v_pk_add_f32 v[162:163], v[162:163], v[178:179]
    v_pk_add_f32 v[208:209], v[208:209], v[160:161]
    v_pk_add_f32 v[210:211], v[210:211], v[162:163]
    s_waitcnt lgkmcnt(0)
    v_pk_add_f32 v[212:213], v[212:213], v[148:149]
    v_pk_add_f32 v[164:165], v[164:165], v[180:181]
    v_pk_add_f32 v[214:215], v[214:215], v[150:151]
    v_pk_add_f32 v[166:167], v[166:167], v[182:183]
    v_pk_add_f32 v[212:213], v[212:213], v[164:165]
    v_pk_add_f32 v[214:215], v[214:215], v[166:167]
    buffer_load_dwordx4 v79, s[52:55], s95 offen offset:3072 nt lds
    s_add_u32 s95, s95, 16384
    s_waitcnt vmcnt(4)
    v_max_f32 v4, v200, v201
    v_max3_f32 v4, v4, v202, v203
    v_max3_f32 v4, v4, v204, v205
    v_max3_f32 v4, v4, v206, v207
    v_max3_f32 v4, v4, v208, v209
    v_max3_f32 v4, v4, v210, v211
    v_max3_f32 v4, v4, v212, v213
    v_max3_f32 v4, v4, v214, v215
    v_mov_b32 v5, v4
    ds_read_b128 v[136:139], v60 offset:0
    ds_read_b128 v[140:143], v61 offset:0
    v_permlane16_swap_b32 v4, v5
    v_max_f32 v4, v4, v5
    v_mov_b32 v5, v4
    ds_read_b128 v[144:147], v62 offset:0
    ds_read_b128 v[148:151], v63 offset:0
    v_permlane32_swap_b32 v4, v5
    v_max_f32 v4, v4, v5
    v_mul_f32 v4, s83, v4
    v_max_f32 v4, v4, v90
    v_sub_f32 v92, v90, v4
    v_exp_f32 v92, v92
    v_mov_b32 v90, v4
    s_add_u32 s39, s90, s62
    s_mov_b32 m0, s39
    s_add_u32 s62, s62, 4096
    s_and_b32 s62, s62, 0x7fff
    buffer_load_dwordx4 v76, s[52:55], s95 offen offset:0 nt lds
    v_pk_fma_f32 v[200:201], v[200:201], s[60:61], v[90:91] op_sel_hi:[1,1,0] neg_lo:[0,0,1] neg_hi:[0,0,1]
    v_pk_fma_f32 v[202:203], v[202:203], s[60:61], v[90:91] op_sel_hi:[1,1,0] neg_lo:[0,0,1] neg_hi:[0,0,1]
    v_pk_fma_f32 v[204:205], v[204:205], s[60:61], v[90:91] op_sel_hi:[1,1,0] neg_lo:[0,0,1] neg_hi:[0,0,1]
    v_pk_fma_f32 v[206:207], v[206:207], s[60:61], v[90:91] op_sel_hi:[1,1,0] neg_lo:[0,0,1] neg_hi:[0,0,1]
    v_pk_fma_f32 v[208:209], v[208:209], s[60:61], v[90:91] op_sel_hi:[1,1,0] neg_lo:[0,0,1] neg_hi:[0,0,1]
    v_pk_fma_f32 v[210:211], v[210:211], s[60:61], v[90:91] op_sel_hi:[1,1,0] neg_lo:[0,0,1] neg_hi:[0,0,1]
    v_pk_fma_f32 v[212:213], v[212:213], s[60:61], v[90:91] op_sel_hi:[1,1,0] neg_lo:[0,0,1] neg_hi:[0,0,1]
    v_pk_fma_f32 v[214:215], v[214:215], s[60:61], v[90:91] op_sel_hi:[1,1,0] neg_lo:[0,0,1] neg_hi:[0,0,1]
    v_exp_f32 v200, v200
    v_exp_f32 v201, v201
    ds_read_b128 v[152:155], v60 offset:4096
    v_exp_f32 v202, v202
    v_exp_f32 v203, v203
    v_exp_f32 v204, v204
    v_exp_f32 v205, v205
    ds_read_b128 v[156:159], v61 offset:4096
    v_exp_f32 v206, v206
    v_exp_f32 v207, v207
    buffer_load_dwordx4 v77, s[52:55], s95 offen offset:1024 nt lds
    v_exp_f32 v208, v208
    v_exp_f32 v209, v209
    ds_read_b128 v[160:163], v62 offset:4096
    v_exp_f32 v210, v210
    v_exp_f32 v211, v211
    v_exp_f32 v212, v212
    v_exp_f32 v213, v213
    ds_read_b128 v[164:167], v63 offset:4096
    v_exp_f32 v214, v214
    v_exp_f32 v215, v215
    buffer_load_dwordx4 v78, s[52:55], s95 offen offset:2048 nt lds
    v_pk_mul_f32 v[102:103], v[102:103], v[92:93] op_sel_hi:[1,0]
    v_pk_mul_f32 v[104:105], v[104:105], v[92:93] op_sel_hi:[1,0]
    v_pk_mul_f32 v[106:107], v[106:107], v[92:93] op_sel_hi:[1,0]
    v_pk_mul_f32 v[108:109], v[108:109], v[92:93] op_sel_hi:[1,0]
    v_pk_mul_f32 v[110:111], v[110:111], v[92:93] op_sel_hi:[1,0]
    v_pk_mul_f32 v[112:113], v[112:113], v[92:93] op_sel_hi:[1,0]
    v_pk_mul_f32 v[114:115], v[114:115], v[92:93] op_sel_hi:[1,0]
    v_pk_mul_f32 v[116:117], v[116:117], v[92:93] op_sel_hi:[1,0]
    v_pk_mul_f32 v[118:119], v[118:119], v[92:93] op_sel_hi:[1,0]
    v_pk_mul_f32 v[120:121], v[120:121], v[92:93] op_sel_hi:[1,0]
    v_pk_mul_f32 v[122:123], v[122:123], v[92:93] op_sel_hi:[1,0]
    v_pk_mul_f32 v[124:125], v[124:125], v[92:93] op_sel_hi:[1,0]
    v_pk_mul_f32 v[126:127], v[126:127], v[92:93] op_sel_hi:[1,0]
    v_pk_mul_f32 v[128:129], v[128:129], v[92:93] op_sel_hi:[1,0]
    v_pk_mul_f32 v[130:131], v[130:131], v[92:93] op_sel_hi:[1,0]
    v_pk_mul_f32 v[132:133], v[132:133], v[92:93] op_sel_hi:[1,0]
    v_pk_mul_f32 v[134:135], v[134:135], v[92:93] op_sel_hi:[1,0]
    buffer_load_dwordx4 v79, s[52:55], s95 offen offset:3072 nt lds
    s_add_u32 s95, s95, 16384
    v_cvt_pk_bf16_f32 v52, v200, v201
    v_pk_add_f32 v[102:103], v[102:103], v[200:201]
    v_cvt_pk_bf16_f32 v53, v202, v203
    v_pk_add_f32 v[102:103], v[102:103], v[202:203]
    v_cvt_pk_bf16_f32 v54, v204, v205
    v_pk_add_f32 v[102:103], v[102:103], v[204:205]
    v_cvt_pk_bf16_f32 v55, v206, v207
    v_pk_add_f32 v[102:103], v[102:103], v[206:207]
    v_cvt_pk_bf16_f32 v56, v208, v209
    v_pk_add_f32 v[102:103], v[102:103], v[208:209]
    v_cvt_pk_bf16_f32 v57, v210, v211
    v_pk_add_f32 v[102:103], v[102:103], v[210:211]
    v_cvt_pk_bf16_f32 v58, v212, v213
    v_pk_add_f32 v[102:103], v[102:103], v[212:213]
    v_cvt_pk_bf16_f32 v59, v214, v215
    v_pk_add_f32 v[102:103], v[102:103], v[214:215]
    v_mfma_f32_16x16x32_bf16 v[104:107], a[0:3], v[52:55], v[104:107]
    ds_read_b128 v[168:171], v60 offset:8192
    v_mfma_f32_16x16x32_bf16 v[108:111], a[4:7], v[52:55], v[108:111]
    ds_read_b128 v[172:175], v61 offset:8192
    v_mfma_f32_16x16x32_bf16 v[112:115], a[8:11], v[52:55], v[112:115]
    ds_read_b128 v[176:179], v62 offset:8192
    v_mfma_f32_16x16x32_bf16 v[116:119], a[12:15], v[52:55], v[116:119]
    ds_read_b128 v[180:183], v63 offset:8192
    v_mfma_f32_16x16x32_bf16 v[120:123], a[16:19], v[52:55], v[120:123]
    ds_read_b128 v[184:187], v60 offset:12288
    v_mfma_f32_16x16x32_bf16 v[124:127], a[20:23], v[52:55], v[124:127]
    ds_read_b128 v[188:191], v61 offset:12288
    v_mfma_f32_16x16x32_bf16 v[128:131], a[24:27], v[52:55], v[128:131]
    ds_read_b128 v[192:195], v62 offset:12288
    v_mfma_f32_16x16x32_bf16 v[132:135], a[28:31], v[52:55], v[132:135]
    ds_read_b128 v[196:199], v63 offset:12288
    v_mfma_f32_16x16x32_bf16 v[104:107], a[32:35], v[56:59], v[104:107]
    v_mfma_f32_16x16x32_bf16 v[108:111], a[36:39], v[56:59], v[108:111]
    s_add_u32 s39, s90, s62
    s_mov_b32 m0, s39
    s_add_u32 s62, s62, 4096
    s_and_b32 s62, s62, 0x7fff
    buffer_load_dwordx4 v76, s[52:55], s95 offen offset:0 nt lds
    v_mfma_f32_16x16x32_bf16 v[112:115], a[40:43], v[56:59], v[112:115]
    v_mfma_f32_16x16x32_bf16 v[116:119], a[44:47], v[56:59], v[116:119]
    v_mfma_f32_16x16x32_bf16 v[120:123], a[48:51], v[56:59], v[120:123]
    v_mfma_f32_16x16x32_bf16 v[124:127], a[52:55], v[56:59], v[124:127]
    buffer_load_dwordx4 v77, s[52:55], s95 offen offset:1024 nt lds
    v_mfma_f32_16x16x32_bf16 v[128:131], a[56:59], v[56:59], v[128:131]
    v_mfma_f32_16x16x32_bf16 v[132:135], a[60:63], v[56:59], v[132:135]
    s_add_u32 s93, s93, 1
    s_cmp_lt_u32 s93, 16
    s_cbranch_scc1 L_att
    v_add_f32 v91, v102, v103
    v_mov_b32 v5, v91
    s_nop 1
    v_permlane16_swap_b32 v91, v5
    v_add_f32 v91, v91, v5
    v_mov_b32 v5, v91
    s_nop 1
    v_permlane32_swap_b32 v91, v5
    v_add_f32 v91, v91, v5
    v_lshrrev_b32 v6, 1, v2
    v_xor_b32 v6, v6, v3
    v_lshlrev_b32 v5, 8, v3
    v_lshl_add_u32 v5, v6, 4, v5
    v_bfe_u32 v4, v2, 0, 1
    v_lshl_add_u32 v5, v4, 3, v5
    v_add_u32 v5, s85, v5
    s_waitcnt vmcnt(0) lgkmcnt(0)
    s_barrier
    v_cvt_pk_bf16_f32 v216, v104, v105
    v_cvt_pk_bf16_f32 v217, v106, v107
    v_xor_b32 v82, 0, v5
    ds_write_b64 v82, v[216:217]
    v_cvt_pk_bf16_f32 v218, v108, v109
    v_cvt_pk_bf16_f32 v219, v110, v111
    v_xor_b32 v83, 32, v5
    ds_write_b64 v83, v[218:219]
    v_cvt_pk_bf16_f32 v220, v112, v113
    v_cvt_pk_bf16_f32 v221, v114, v115
    v_xor_b32 v84, 64, v5
    ds_write_b64 v84, v[220:221]
    v_cvt_pk_bf16_f32 v222, v116, v117
    v_cvt_pk_bf16_f32 v223, v118, v119
    v_xor_b32 v85, 96, v5
    ds_write_b64 v85, v[222:223]
    v_cvt_pk_bf16_f32 v224, v120, v121
    v_cvt_pk_bf16_f32 v225, v122, v123
    v_xor_b32 v86, 128, v5
    ds_write_b64 v86, v[224:225]
    v_cvt_pk_bf16_f32 v226, v124, v125
    v_cvt_pk_bf16_f32 v227, v126, v127
    v_xor_b32 v87, 160, v5
    ds_write_b64 v87, v[226:227]
    v_cvt_pk_bf16_f32 v228, v128, v129
    v_cvt_pk_bf16_f32 v229, v130, v131
    v_xor_b32 v88, 192, v5
    ds_write_b64 v88, v[228:229]
    v_cvt_pk_bf16_f32 v230, v132, v133
    v_cvt_pk_bf16_f32 v231, v134, v135
    v_xor_b32 v89, 224, v5
    ds_write_b64 v89, v[230:231]
    v_xor_b32 v6, v3, v2
    v_lshlrev_b32 v6, 4, v6
    v_lshl_add_u32 v4, v2, 8, v6
    v_add_u32 v4, s85, v4
    v_xor_b32 v60, 0, v4
    v_xor_b32 v61, 64, v4
    v_xor_b32 v62, 128, v4
    v_xor_b32 v63, 192, v4
    v_lshlrev_b32 v7, 4, v3
    v_lshl_add_u32 v7, v2, 14, v7
    s_lshl_b32 s38, s94, 18
    s_add_u32 s36, s38, 2097152
    s_lshl_b32 s38, s3, 10
    s_add_u32 s36, s38, s36
    s_lshl_b32 s38, s34, 8
    s_add_u32 s36, s38, s36
    s_waitcnt lgkmcnt(0)
    ds_read_b128 v[200:203], v60 offset:0
    ds_read_b128 v[204:207], v61 offset:1024
    ds_read_b128 v[208:211], v62 offset:2048
    ds_read_b128 v[212:215], v63 offset:3072
    v_lshlrev_b32 v4, 3, v3
    s_lshl_b32 s38, s3, 8
    s_add_u32 s37, s38, 163840
    s_lshl_b32 s38, s94, 7
    s_add_u32 s37, s38, s37
    s_lshl_b32 s38, s34, 23
    s_add_u32 s37, s38, s37
    s_mov_b32 exec_lo, 0xffff
    s_mov_b32 exec_hi, 0x0
    buffer_store_dwordx2 v[90:91], v4, s[48:51], s37 offen sc1
    s_mov_b64 exec, -1
    s_waitcnt lgkmcnt(3)
    buffer_store_dwordx4 v[200:203], v7, s[48:51], s36 offen sc1
    s_add_u32 s36, s36, 65536
    s_waitcnt lgkmcnt(2)
    buffer_store_dwordx4 v[204:207], v7, s[48:51], s36 offen sc1
    s_add_u32 s36, s36, 65536
    s_waitcnt lgkmcnt(1)
    buffer_store_dwordx4 v[208:211], v7, s[48:51], s36 offen sc1
    s_add_u32 s36, s36, 65536
    s_waitcnt lgkmcnt(0)
    buffer_store_dwordx4 v[212:215], v7, s[48:51], s36 offen sc1
    s_sub_u32 s36, s33, 3
    s_and_b32 s37, s33, 3
    s_cmp_lt_u32 s36, 4
    s_cselect_b64 s[40:41], s[24:25], s[14:15]
    s_cselect_b32 s36, s36, s37
    s_cselect_b32 s45, 262144, 0
    s_cselect_b32 s46, 8388608, 0
    s_add_u32 s45, s45, 524288
    s_add_u32 s46, s46, 196608
    s_mov_b32 s42, 4194304
    s_mov_b32 s43, 0x20000
    s_lshl_b32 s38, s32, 17
    s_add_u32 s44, s38, 0
    s_lshl_b32 s38, s34, 15
    s_add_u32 s44, s38, s44
    s_lshl_b32 s38, s36, 8
    s_add_u32 s44, s38, s44
    s_lshl_b32 s38, s36, 16
    s_add_u32 s45, s38, s45
    s_lshr_b32 s38, s34, 1
    s_lshl_b32 s38, s38, 15
    s_add_u32 s45, s38, s45
    s_lshl_b32 s38, s32, 8
    s_add_u32 s45, s38, s45
    s_bfe_u32 s38, s34, 0x10000
    s_lshl_b32 s38, s38, 7
    s_add_u32 s45, s38, s45
    s_lshl_b32 s38, s32, 11
    s_add_u32 s46, s38, s46
    s_lshl_b32 s38, s34, 9
    s_add_u32 s46, s38, s46
    s_mov_b32 s72, s26
    s_and_b32 s73, s27, 0xffff
    s_mov_b32 s74, 8192
    s_mov_b32 s75, 0x20000
    s_lshl_b32 s39, s34, 13
    s_add_u32 s39, s39, 98304
    s_mov_b32 m0, s39
    s_nop 0
    buffer_load_dwordx4 v76, s[40:43], s44 offen offset:0 nt lds
    buffer_load_dwordx4 v77, s[40:43], s44 offen offset:1024 nt lds
    buffer_load_dwordx4 v78, s[40:43], s44 offen offset:2048 nt lds
    buffer_load_dwordx4 v79, s[40:43], s44 offen offset:3072 nt lds
    s_lshl_b32 s39, s34, 13
    s_add_u32 s39, s39, 102400
    s_mov_b32 m0, s39
    s_add_u32 s44, s44, 16384
    buffer_load_dwordx4 v76, s[40:43], s44 offen offset:0 nt lds
    buffer_load_dwordx4 v77, s[40:43], s44 offen offset:1024 nt lds
    buffer_load_dwordx4 v78, s[40:43], s44 offen offset:2048 nt lds
    buffer_load_dwordx4 v79, s[40:43], s44 offen offset:3072 nt lds
    v_lshlrev_b32 v30, 4, v3
    v_lshl_add_u32 v30, v2, 13, v30
    s_lshl_b32 s38, s32, 13
    s_add_u32 s36, s38, 0
    s_lshl_b32 s38, s34, 6
    s_add_u32 s36, s38, s36
    v_lshrrev_b32 v5, 2, v1
    v_lshlrev_b32 v32, 8, v5
    v_bfe_u32 v5, v1, 0, 2
    v_lshl_add_u32 v32, v5, 4, v32
    v_add_u32 v32, s36, v32
    s_lshr_b32 s38, s32, 2
    s_lshl_b32 s38, s38, 7
    s_add_u32 s36, s38, 0
    s_lshl_b32 s38, s34, 5
    s_add_u32 s36, s38, s36
    s_bfe_u32 s38, s32, 0x20000
    s_lshl_b32 s38, s38, 3
    s_add_u32 s36, s38, s36
    v_bfe_u32 v5, v1, 0, 2
    v_lshlrev_b32 v33, 11, v5
    v_lshl_add_u32 v33, v2, 1, v33
    v_add_u32 v33, s36, v33
    v_and_b32 v5, 31, v1
    v_lshlrev_b32 v34, 4, v5
    s_mul_i32 s38, s34, 320
    s_add_u32 s38, s38, 135168
    v_lshl_add_u32 v35, v5, 3, s38
    v_bfe_u32 v5, v3, 0, 2
    v_lshlrev_b32 v81, 10, v5
    v_lshrrev_b32 v5, 2, v3
    v_lshl_add_u32 v81, v5, 8, v81
    v_add3_u32 v82, v81, v6, s85
    v_xor_b32 v83, 64, v82
    v_xor_b32 v84, 128, v82
    v_xor_b32 v85, 192, v82
    v_bfe_u32 v5, v3, 0, 2
    v_lshlrev_b32 v94, 9, v5
    v_lshl_add_u32 v94, v2, 4, v94
    v_add_u32 v94, s85, v94
    s_lshl_b32 s38, s34, 9
    s_add_u32 s38, s38, 131072
    v_add_u32 v102, s38, v34
    s_lshl_b32 s38, s32, 14
    s_add_u32 s36, s38, 2097152
    s_lshl_b32 s38, s34, 8
    s_add_u32 s36, s38, s36
    s_lshl_b32 s38, s32, 3
    s_add_u32 s37, s38, 163840
    s_lshl_b32 s38, s32, 8
    s_add_u32 s69, s38, 131072
    s_lshl_b32 s38, s34, 23
    s_add_u32 s69, s38, s69
    v_mov_b32 v4, s69
    v_mov_b32 v5, s68
    s_waitcnt vmcnt(8)
    s_barrier
    s_mov_b64 exec, 1
    buffer_store_dword v5, v4, s[48:51], 0 offen sc1
    s_mov_b64 exec, -1
    s_mov_b32 s86, 131072
    buffer_load_dword v7, v101, s[48:51], s86 offen sc1
    s_waitcnt vmcnt(0)
L_fcheck_25:
    v_cmp_ne_u32 vcc, s68, v7
    s_cbranch_vccz L_fok_26
    s_sleep 2
    s_mov_b32 s86, 131072
    buffer_load_dword v7, v101, s[48:51], s86 offen sc1
    s_waitcnt vmcnt(0)
    s_sub_u32 s84, s84, 1
    s_cmp_lg_u32 s84, 0
    s_cbranch_scc1 L_fcheck_25
    s_branch L_end
L_fok_26:
    buffer_load_dwordx2 v[52:53], v81, s[48:51], s37 offen sc1
    buffer_load_dwordx4 v[200:203], v9, s[48:51], s36 offen sc1
    s_add_u32 s36, s36, 4096
    buffer_load_dwordx4 v[204:207], v9, s[48:51], s36 offen sc1
    s_add_u32 s36, s36, 4096
    buffer_load_dwordx4 v[208:211], v9, s[48:51], s36 offen sc1
    s_add_u32 s36, s36, 4096
    buffer_load_dwordx4 v[212:215], v9, s[48:51], s36 offen sc1
    s_waitcnt vmcnt(4)
    v_max_f32_dpp v4, v52, v52 row_ror:8 row_mask:0xf bank_mask:0xf
    s_nop 1
    v_max_f32_dpp v4, v4, v4 row_ror:4 row_mask:0xf bank_mask:0xf
    v_sub_f32 v52, v52, v4
    v_exp_f32 v52, v52
    s_nop 0
    v_mul_f32 v5, v52, v53
    s_nop 1
    v_add_f32_dpp v5, v5, v5 row_ror:8 row_mask:0xf bank_mask:0xf
    s_nop 1
    v_add_f32_dpp v5, v5, v5 row_ror:4 row_mask:0xf bank_mask:0xf
    v_rcp_f32 v5, v5
    s_nop 0
    v_mul_f32 v52, v52, v5
    s_waitcnt vmcnt(3)
    ds_write_b128 v96, v[200:203] offset:0
    s_waitcnt vmcnt(2)
    ds_write_b128 v97, v[204:207] offset:1024
    s_waitcnt vmcnt(1)
    ds_write_b128 v98, v[208:211] offset:2048
    s_waitcnt vmcnt(0)
    ds_write_b128 v99, v[212:215] offset:3072
    s_waitcnt lgkmcnt(0)
    ds_read_b128 v[136:139], v82
    ds_read_b128 v[140:143], v83
    ds_read_b128 v[144:147], v84
    ds_read_b128 v[148:151], v85
    s_waitcnt lgkmcnt(0)
    v_mfma_f32_16x16x32_bf16 v[104:107], a[128:131], v[136:139], 0
    v_mfma_f32_16x16x32_bf16 v[104:107], a[132:135], v[140:143], v[104:107]
    v_mfma_f32_16x16x32_bf16 v[104:107], a[136:139], v[144:147], v[104:107]
    v_mfma_f32_16x16x32_bf16 v[104:107], a[140:143], v[148:151], v[104:107]
    v_mfma_f32_16x16x32_bf16 v[108:111], a[144:147], v[136:139], 0
    v_mfma_f32_16x16x32_bf16 v[108:111], a[148:151], v[140:143], v[108:111]
    v_mfma_f32_16x16x32_bf16 v[108:111], a[152:155], v[144:147], v[108:111]
    v_mfma_f32_16x16x32_bf16 v[108:111], a[156:159], v[148:151], v[108:111]
    v_mfma_f32_16x16x32_bf16 v[112:115], a[160:163], v[136:139], 0
    v_mfma_f32_16x16x32_bf16 v[112:115], a[164:167], v[140:143], v[112:115]
    v_mfma_f32_16x16x32_bf16 v[112:115], a[168:171], v[144:147], v[112:115]
    v_mfma_f32_16x16x32_bf16 v[112:115], a[172:175], v[148:151], v[112:115]
    v_mul_f32 v104, v104, v52
    v_mul_f32 v105, v105, v52
    v_mul_f32 v106, v106, v52
    v_mul_f32 v107, v107, v52
    v_add_f32_dpp v104, v104, v104 row_ror:8 row_mask:0xf bank_mask:0xf
    v_add_f32_dpp v105, v105, v105 row_ror:8 row_mask:0xf bank_mask:0xf
    v_add_f32_dpp v106, v106, v106 row_ror:8 row_mask:0xf bank_mask:0xf
    v_add_f32_dpp v107, v107, v107 row_ror:8 row_mask:0xf bank_mask:0xf
    v_add_f32_dpp v104, v104, v104 row_ror:4 row_mask:0xf bank_mask:0xf
    v_add_f32_dpp v105, v105, v105 row_ror:4 row_mask:0xf bank_mask:0xf
    v_add_f32_dpp v106, v106, v106 row_ror:4 row_mask:0xf bank_mask:0xf
    v_add_f32_dpp v107, v107, v107 row_ror:4 row_mask:0xf bank_mask:0xf
    ds_write_b128 v94, v[104:107] offset:0
    v_mfma_f32_16x16x32_bf16 v[116:119], a[176:179], v[136:139], 0
    v_mfma_f32_16x16x32_bf16 v[116:119], a[180:183], v[140:143], v[116:119]
    v_mfma_f32_16x16x32_bf16 v[116:119], a[184:187], v[144:147], v[116:119]
    v_mfma_f32_16x16x32_bf16 v[116:119], a[188:191], v[148:151], v[116:119]
    v_mul_f32 v108, v108, v52
    v_mul_f32 v109, v109, v52
    v_mul_f32 v110, v110, v52
    v_mul_f32 v111, v111, v52
    v_add_f32_dpp v108, v108, v108 row_ror:8 row_mask:0xf bank_mask:0xf
    v_add_f32_dpp v109, v109, v109 row_ror:8 row_mask:0xf bank_mask:0xf
    v_add_f32_dpp v110, v110, v110 row_ror:8 row_mask:0xf bank_mask:0xf
    v_add_f32_dpp v111, v111, v111 row_ror:8 row_mask:0xf bank_mask:0xf
    v_add_f32_dpp v108, v108, v108 row_ror:4 row_mask:0xf bank_mask:0xf
    v_add_f32_dpp v109, v109, v109 row_ror:4 row_mask:0xf bank_mask:0xf
    v_add_f32_dpp v110, v110, v110 row_ror:4 row_mask:0xf bank_mask:0xf
    v_add_f32_dpp v111, v111, v111 row_ror:4 row_mask:0xf bank_mask:0xf
    ds_write_b128 v94, v[108:111] offset:64
    v_mfma_f32_16x16x32_bf16 v[120:123], a[192:195], v[136:139], 0
    v_mfma_f32_16x16x32_bf16 v[120:123], a[196:199], v[140:143], v[120:123]
    v_mfma_f32_16x16x32_bf16 v[120:123], a[200:203], v[144:147], v[120:123]
    v_mfma_f32_16x16x32_bf16 v[120:123], a[204:207], v[148:151], v[120:123]
    v_mul_f32 v112, v112, v52
    v_mul_f32 v113, v113, v52
    v_mul_f32 v114, v114, v52
    v_mul_f32 v115, v115, v52
    v_add_f32_dpp v112, v112, v112 row_ror:8 row_mask:0xf bank_mask:0xf
    v_add_f32_dpp v113, v113, v113 row_ror:8 row_mask:0xf bank_mask:0xf
    v_add_f32_dpp v114, v114, v114 row_ror:8 row_mask:0xf bank_mask:0xf
    v_add_f32_dpp v115, v115, v115 row_ror:8 row_mask:0xf bank_mask:0xf
    v_add_f32_dpp v112, v112, v112 row_ror:4 row_mask:0xf bank_mask:0xf
    v_add_f32_dpp v113, v113, v113 row_ror:4 row_mask:0xf bank_mask:0xf
    v_add_f32_dpp v114, v114, v114 row_ror:4 row_mask:0xf bank_mask:0xf
    v_add_f32_dpp v115, v115, v115 row_ror:4 row_mask:0xf bank_mask:0xf
    ds_write_b128 v94, v[112:115] offset:128
    v_mfma_f32_16x16x32_bf16 v[124:127], a[208:211], v[136:139], 0
    v_mfma_f32_16x16x32_bf16 v[124:127], a[212:215], v[140:143], v[124:127]
    v_mfma_f32_16x16x32_bf16 v[124:127], a[216:219], v[144:147], v[124:127]
    v_mfma_f32_16x16x32_bf16 v[124:127], a[220:223], v[148:151], v[124:127]
    v_mul_f32 v116, v116, v52
    v_mul_f32 v117, v117, v52
    v_mul_f32 v118, v118, v52
    v_mul_f32 v119, v119, v52
    v_add_f32_dpp v116, v116, v116 row_ror:8 row_mask:0xf bank_mask:0xf
    v_add_f32_dpp v117, v117, v117 row_ror:8 row_mask:0xf bank_mask:0xf
    v_add_f32_dpp v118, v118, v118 row_ror:8 row_mask:0xf bank_mask:0xf
    v_add_f32_dpp v119, v119, v119 row_ror:8 row_mask:0xf bank_mask:0xf
    v_add_f32_dpp v116, v116, v116 row_ror:4 row_mask:0xf bank_mask:0xf
    v_add_f32_dpp v117, v117, v117 row_ror:4 row_mask:0xf bank_mask:0xf
    v_add_f32_dpp v118, v118, v118 row_ror:4 row_mask:0xf bank_mask:0xf
    v_add_f32_dpp v119, v119, v119 row_ror:4 row_mask:0xf bank_mask:0xf
    ds_write_b128 v94, v[116:119] offset:192
    v_mfma_f32_16x16x32_bf16 v[128:131], a[224:227], v[136:139], 0
    v_mfma_f32_16x16x32_bf16 v[128:131], a[228:231], v[140:143], v[128:131]
    v_mfma_f32_16x16x32_bf16 v[128:131], a[232:235], v[144:147], v[128:131]
    v_mfma_f32_16x16x32_bf16 v[128:131], a[236:239], v[148:151], v[128:131]
    v_mul_f32 v120, v120, v52
    v_mul_f32 v121, v121, v52
    v_mul_f32 v122, v122, v52
    v_mul_f32 v123, v123, v52
    v_add_f32_dpp v120, v120, v120 row_ror:8 row_mask:0xf bank_mask:0xf
    v_add_f32_dpp v121, v121, v121 row_ror:8 row_mask:0xf bank_mask:0xf
    v_add_f32_dpp v122, v122, v122 row_ror:8 row_mask:0xf bank_mask:0xf
    v_add_f32_dpp v123, v123, v123 row_ror:8 row_mask:0xf bank_mask:0xf
    v_add_f32_dpp v120, v120, v120 row_ror:4 row_mask:0xf bank_mask:0xf
    v_add_f32_dpp v121, v121, v121 row_ror:4 row_mask:0xf bank_mask:0xf
    v_add_f32_dpp v122, v122, v122 row_ror:4 row_mask:0xf bank_mask:0xf
    v_add_f32_dpp v123, v123, v123 row_ror:4 row_mask:0xf bank_mask:0xf
    ds_write_b128 v94, v[120:123] offset:256
    v_mfma_f32_16x16x32_bf16 v[132:135], a[240:243], v[136:139], 0
    v_mfma_f32_16x16x32_bf16 v[132:135], a[244:247], v[140:143], v[132:135]
    v_mfma_f32_16x16x32_bf16 v[132:135], a[248:251], v[144:147], v[132:135]
    v_mfma_f32_16x16x32_bf16 v[132:135], a[252:255], v[148:151], v[132:135]
    v_mul_f32 v124, v124, v52
    v_mul_f32 v125, v125, v52
    v_mul_f32 v126, v126, v52
    v_mul_f32 v127, v127, v52
    v_add_f32_dpp v124, v124, v124 row_ror:8 row_mask:0xf bank_mask:0xf
    v_add_f32_dpp v125, v125, v125 row_ror:8 row_mask:0xf bank_mask:0xf
    v_add_f32_dpp v126, v126, v126 row_ror:8 row_mask:0xf bank_mask:0xf
    v_add_f32_dpp v127, v127, v127 row_ror:8 row_mask:0xf bank_mask:0xf
    v_add_f32_dpp v124, v124, v124 row_ror:4 row_mask:0xf bank_mask:0xf
    v_add_f32_dpp v125, v125, v125 row_ror:4 row_mask:0xf bank_mask:0xf
    v_add_f32_dpp v126, v126, v126 row_ror:4 row_mask:0xf bank_mask:0xf
    v_add_f32_dpp v127, v127, v127 row_ror:4 row_mask:0xf bank_mask:0xf
    ds_write_b128 v94, v[124:127] offset:320
    v_mul_f32 v128, v128, v52
    v_mul_f32 v129, v129, v52
    v_mul_f32 v130, v130, v52
    v_mul_f32 v131, v131, v52
    v_add_f32_dpp v128, v128, v128 row_ror:8 row_mask:0xf bank_mask:0xf
    v_add_f32_dpp v129, v129, v129 row_ror:8 row_mask:0xf bank_mask:0xf
    v_add_f32_dpp v130, v130, v130 row_ror:8 row_mask:0xf bank_mask:0xf
    v_add_f32_dpp v131, v131, v131 row_ror:8 row_mask:0xf bank_mask:0xf
    v_add_f32_dpp v128, v128, v128 row_ror:4 row_mask:0xf bank_mask:0xf
    v_add_f32_dpp v129, v129, v129 row_ror:4 row_mask:0xf bank_mask:0xf
    v_add_f32_dpp v130, v130, v130 row_ror:4 row_mask:0xf bank_mask:0xf
    v_add_f32_dpp v131, v131, v131 row_ror:4 row_mask:0xf bank_mask:0xf
    ds_write_b128 v94, v[128:131] offset:384
    v_mul_f32 v132, v132, v52
    v_mul_f32 v133, v133, v52
    v_mul_f32 v134, v134, v52
    v_mul_f32 v135, v135, v52
    v_add_f32_dpp v132, v132, v132 row_ror:8 row_mask:0xf bank_mask:0xf
    v_add_f32_dpp v133, v133, v133 row_ror:8 row_mask:0xf bank_mask:0xf
    v_add_f32_dpp v134, v134, v134 row_ror:8 row_mask:0xf bank_mask:0xf
    v_add_f32_dpp v135, v135, v135 row_ror:8 row_mask:0xf bank_mask:0xf
    v_add_f32_dpp v132, v132, v132 row_ror:4 row_mask:0xf bank_mask:0xf
    v_add_f32_dpp v133, v133, v133 row_ror:4 row_mask:0xf bank_mask:0xf
    v_add_f32_dpp v134, v134, v134 row_ror:4 row_mask:0xf bank_mask:0xf
    v_add_f32_dpp v135, v135, v135 row_ror:4 row_mask:0xf bank_mask:0xf
    ds_write_b128 v94, v[132:135] offset:448
    s_waitcnt lgkmcnt(0)
    s_barrier
    ds_read_b128 v[136:139], v102 offset:0
    ds_read_b128 v[140:143], v102 offset:8192
    ds_read_b128 v[144:147], v102 offset:16384
    ds_read_b128 v[148:151], v102 offset:24576
    s_waitcnt lgkmcnt(0)
    v_add_f32 v136, v136, v140
    v_add_f32 v144, v144, v148
    v_add_f32 v137, v137, v141
    v_add_f32 v145, v145, v149
    v_add_f32 v138, v138, v142
    v_add_f32 v146, v146, v150
    v_add_f32 v139, v139, v143
    v_add_f32 v147, v147, v151
    v_add_f32 v136, v136, v144
    v_add_f32 v137, v137, v145
    v_add_f32 v138, v138, v146
    v_add_f32 v139, v139, v147
    s_mov_b32 s38, 0xffff0000
    v_cvt_pk_bf16_f32 v136, v136, v136
    v_cvt_pk_bf16_f32 v137, v137, v137
    v_cvt_pk_bf16_f32 v138, v138, v138
    v_cvt_pk_bf16_f32 v139, v139, v139
    v_and_or_b32 v136, v136, s38, v8
    v_and_or_b32 v137, v137, s38, v8
    v_and_or_b32 v138, v138, s38, v8
    v_and_or_b32 v139, v139, s38, v8
    s_mov_b32 exec_lo, 0xffffffff
    s_mov_b32 exec_hi, 0x0
    buffer_store_dwordx4 v[136:139], v34, s[48:51], s46 offen sc1
    s_mov_b64 exec, -1
    v_xor_b32 v224, s35, v136
    v_xor_b32 v225, s35, v137
    v_xor_b32 v226, s35, v138
    v_xor_b32 v227, s35, v139
    v_lshlrev_b32 v4, 11, v2
    v_bfe_u32 v5, v1, 2, 2
    v_lshl_add_u32 v4, v5, 8, v4
    v_bfe_u32 v5, v1, 2, 2
    v_lshl_add_u32 v4, v5, 6, v4
    v_bfe_u32 v5, v1, 4, 1
    v_lshl_add_u32 v4, v5, 5, v4
    v_bfe_u32 v5, v1, 1, 1
    v_lshl_add_u32 v4, v5, 4, v4
    v_bfe_u32 v5, v1, 0, 1
    v_lshl_add_u32 v4, v5, 3, v4
    s_lshl_b32 s38, s34, 6
    s_add_u32 s38, s38, 98304
    v_xor_b32 v24, s38, v4
    v_xor_b32 v25, 16, v24
    v_xor_b32 v26, 32, v24
    v_xor_b32 v27, 48, v24
    v_and_b32 v4, 3, v3
    v_lshrrev_b32 v5, 2, v3
    v_lshlrev_b32 v6, 4, v2
    v_add_u32 v6, 135168, v6
    s_movk_i32 s36, 320
    v_cmp_eq_u32 vcc, 0, v5
    s_nop 1
    v_cndmask_b32 v28, 4, v4, vcc
    v_mad_u32_u24 v28, v28, s36, v6
    v_cmp_eq_u32 vcc, 1, v5
    s_nop 1
    v_cndmask_b32 v29, 4, v4, vcc
    v_mad_u32_u24 v29, v29, s36, v6
    v_lshlrev_b32 v5, 2, v1
    v_add_u32 v5, 136448, v5
    v_mov_b32 v6, 0
    ds_write_b32 v5, v6
    s_branch L_ctxok
.section .rodata,"a"
.p2align 6
.amdhsa_kernel concat_heads__compressed_kv_cla__mha_block_cached__decode_kernel
  .amdhsa_next_free_vgpr 512
  .amdhsa_next_free_sgpr 102
  .amdhsa_accum_offset 256
  .amdhsa_group_segment_fixed_size 0
  .amdhsa_kernarg_size 112
  .amdhsa_user_sgpr_count 2
  .amdhsa_user_sgpr_kernarg_segment_ptr 1
  .amdhsa_system_sgpr_workgroup_id_x 1
.end_amdhsa_kernel
```

```asm
; @launch grid=(256,1,1) block=(256,1,1) lds=163840
    .amdgcn_target "amdgcn-amd-amdhsa--gfx950"
    .text
    .globl concat_heads__compressed_kv_cla__mha_block_cached__decode_kernel
    .p2align 8
    .type concat_heads__compressed_kv_cla__mha_block_cached__decode_kernel,@function
concat_heads__compressed_kv_cla__mha_block_cached__decode_kernel:
    s_cmp_ge_u32 s2, 256
    s_cbranch_scc1 L_end
    s_load_dwordx16 s[4:19], s[0:1], 0
    s_load_dwordx8 s[20:27], s[0:1], 64
    s_load_dwordx4 s[28:31], s[0:1], 96
    v_lshrrev_b32 v4, 6, v0
    v_and_b32 v1, 63, v0
    v_readfirstlane_b32 s34, v4
    s_lshr_b32 s32, s2, 3
    s_sub_u32 s33, s2, s32
    s_sub_u32 s33, s33, 1
    s_and_b32 s33, s33, 7
    v_lshrrev_b32 v2, 4, v1
    v_and_b32 v3, 15, v1
    s_cmp_lt_u32 s33, 2
    s_cbranch_scc1 L_qp
    s_cmp_eq_u32 s33, 2
    s_cbranch_scc1 L_ql
    s_cmp_eq_u32 s33, 7
    s_cbranch_scc1 L_aux
    s_bfe_u32 s38, s2, 0x30000
    s_lshl_b32 s38, s38, 21
    s_add_u32 s36, s38, -393216
    s_lshr_b32 s38, s32, 3
    s_lshl_b32 s38, s38, 19
    s_add_u32 s36, s38, s36
    s_lshl_b32 s38, s33, 17
    s_add_u32 s36, s38, s36
    s_lshl_b32 s38, s34, 12
    s_add_u32 s36, s38, s36
    v_bfe_u32 v5, v1, 0, 5
    v_lshlrev_b32 v4, 7, v5
    v_lshrrev_b32 v5, 5, v1
    v_lshl_add_u32 v4, v5, 15, v4
    s_mov_b32 s42, 16777216
    s_mov_b32 s43, 0x20000
    s_waitcnt lgkmcnt(0)
    s_mov_b64 s[40:41], s[6:7]
    buffer_load_dword v20, v4, s[40:43], s36 offen
    s_add_u32 s36, s36, 16384
    buffer_load_dword v21, v4, s[40:43], s36 offen
    s_add_u32 s36, s36, 49152
    buffer_load_dword v22, v4, s[40:43], s36 offen
    s_add_u32 s36, s36, 16384
    buffer_load_dword v23, v4, s[40:43], s36 offen
    s_load_dword s35, s[30:31], 0
    s_mov_b32 s48, s30
    s_and_b32 s49, s31, 0xffff
    s_mov_b32 s50, 8388608
    s_mov_b32 s51, 0x20000
    s_mov_b32 s82, 0xffffff00
    s_mov_b32 s83, 0x3e0293ee
    s_mov_b32 s84, 2097152
    v_lshrrev_b32 v4, 2, v3
    v_and_b32 v5, 3, v3
    v_lshlrev_b32 v76, 8, v4
    v_lshlrev_b32 v126, 8, v2
    v_lshl_add_u32 v76, v2, 6, v76
    v_lshl_add_u32 v76, v5, 4, v76
    v_lshl_add_u32 v126, v3, 4, v126
    v_xor_b32 v77, 32768, v76
    v_xor_b32 v127, 32768, v126
    s_add_u32 s3, s34, s33
    s_and_b32 s3, s3, 3
    s_lshl_b32 s89, s3, 5
    s_add_u32 s89, s89, s32
    s_lshl_b32 s89, s89, 20
    s_mul_i32 s88, s32, 8
    s_add_u32 s88, s88, s3
    s_lshl_b32 s87, s33, 0
    s_mov_b32 s52, s18
    s_and_b32 s53, s19, 0xffff
    s_mov_b32 s54, 134217728
    s_mov_b32 s55, 0x20000
    s_mov_b32 s56, s20
    s_and_b32 s57, s21, 0xffff
    s_mov_b32 s58, 134217728
    s_mov_b32 s59, 0x20000
    v_and_b32 v4, 1, v1
    v_lshlrev_b32 v4, 4, v4
    v_mov_b32 v5, 0xffff
    v_lshlrev_b32 v4, v4, v5
    v_bfe_u32 v5, v1, 1, 2
    v_cmp_eq_u32 vcc, 0, v5
    s_nop 1
    v_cndmask_b32 v10, 0, v4, vcc
    v_cmp_eq_u32 vcc, 1, v5
    s_nop 1
    v_cndmask_b32 v11, 0, v4, vcc
    v_cmp_eq_u32 vcc, 2, v5
    s_nop 1
    v_cndmask_b32 v12, 0, v4, vcc
    v_cmp_eq_u32 vcc, 3, v5
    s_nop 1
    v_cndmask_b32 v13, 0, v4, vcc
    v_mov_b32 v120, 0xff7f0000
    v_mov_b32 v121, 0
    v_mov_b32 v18, 1
    v_mov_b32 v116, 0
    v_mov_b32 v117, 0
    v_mov_b32 v118, 0
    v_mov_b32 v119, 0
    s_lshl_b32 s38, s32, 10
    s_add_u32 s96, s38, 65536
    s_lshl_b32 s38, s3, 8
    s_add_u32 s96, s38, s96
    v_mov_b32 v9, s96
    s_lshl_b32 s38, s32, 15
    s_add_u32 s96, s38, 1048576
    s_lshl_b32 s38, s3, 13
    s_add_u32 s96, s38, s96
    s_lshl_b32 s38, s33, 10
    s_add_u32 s96, s38, s96
    v_and_b32 v5, 3, v3
    v_lshlrev_b32 v78, 7, v2
    v_lshl_add_u32 v78, v5, 5, v78
    s_lshl_b32 s38, s32, 12
    s_add_u32 s91, s38, 262144
    s_lshl_b32 s38, s3, 9
    s_add_u32 s91, s38, s91
    v_lshlrev_b32 v4, 7, v2
    v_lshl_add_u32 v4, v3, 4, v4
    v_mov_b32 v5, 512
    v_cmp_gt_u32 vcc, 8, v3
    s_nop 1
    v_cndmask_b32 v79, v5, v4, vcc
    s_add_u32 s39, s87, s88
    s_bfe_u32 s37, s39, 0x30000
    s_lshl_b32 s37, s37, 12
    s_add_u32 s85, s37, s89
    s_bfe_u32 s37, s39, 0x10003
    s_lshl_b32 s37, s37, 11
    s_add_u32 s85, s37, s85
    s_bfe_u32 s37, s39, 0x40004
    s_lshl_b32 s37, s37, 16
    s_add_u32 s85, s37, s85
    buffer_load_dwordx4 v[128:131], v76, s[52:55], s85 offen offset:0 nt
    buffer_load_dwordx4 v[132:135], v77, s[52:55], s85 offen offset:0 nt
    buffer_load_dwordx4 v[136:139], v76, s[52:55], s85 offen offset:1024 nt
    buffer_load_dwordx4 v[140:143], v77, s[52:55], s85 offen offset:1024 nt
    s_add_u32 s87, s87, 7
    s_add_u32 s39, s87, s88
    s_bfe_u32 s37, s39, 0x30000
    s_lshl_b32 s37, s37, 12
    s_add_u32 s85, s37, s89
    s_bfe_u32 s37, s39, 0x10003
    s_lshl_b32 s37, s37, 11
    s_add_u32 s85, s37, s85
    s_bfe_u32 s37, s39, 0x40004
    s_lshl_b32 s37, s37, 16
    s_add_u32 s85, s37, s85
    buffer_load_dwordx4 v[144:147], v76, s[52:55], s85 offen offset:0 nt
    buffer_load_dwordx4 v[148:151], v77, s[52:55], s85 offen offset:0 nt
    buffer_load_dwordx4 v[152:155], v76, s[52:55], s85 offen offset:1024 nt
    s_waitcnt vmcnt(6)
    buffer_load_dwordx4 v[156:159], v77, s[52:55], s85 offen offset:1024 nt
    s_add_u32 s87, s87, 7
    s_add_u32 s39, s87, s88
    s_bfe_u32 s37, s39, 0x30000
    s_lshl_b32 s37, s37, 12
    s_add_u32 s85, s37, s89
    s_bfe_u32 s37, s39, 0x10003
    s_lshl_b32 s37, s37, 11
    s_add_u32 s85, s37, s85
    s_bfe_u32 s37, s39, 0x40004
    s_lshl_b32 s37, s37, 16
    s_add_u32 s85, s37, s85
    s_waitcnt vmcnt(6)
    buffer_load_dwordx4 v[160:163], v76, s[52:55], s85 offen offset:0 nt
    s_waitcnt vmcnt(6)
    buffer_load_dwordx4 v[164:167], v77, s[52:55], s85 offen offset:0 nt
    s_waitcnt vmcnt(6)
    buffer_load_dwordx4 v[168:171], v76, s[52:55], s85 offen offset:1024 nt
    s_waitcnt vmcnt(6)
    buffer_load_dwordx4 v[172:175], v77, s[52:55], s85 offen offset:1024 nt
    s_add_u32 s87, s87, 7
    s_add_u32 s39, s87, s88
    s_bfe_u32 s37, s39, 0x30000
    s_lshl_b32 s37, s37, 12
    s_add_u32 s85, s37, s89
    s_bfe_u32 s37, s39, 0x10003
    s_lshl_b32 s37, s37, 11
    s_add_u32 s85, s37, s85
    s_bfe_u32 s37, s39, 0x40004
    s_lshl_b32 s37, s37, 16
    s_add_u32 s85, s37, s85
    s_waitcnt vmcnt(6)
    buffer_load_dwordx4 v[176:179], v76, s[52:55], s85 offen offset:0 nt
    s_waitcnt vmcnt(6)
    buffer_load_dwordx4 v[180:183], v77, s[52:55], s85 offen offset:0 nt
    s_waitcnt vmcnt(6)
    buffer_load_dwordx4 v[184:187], v76, s[52:55], s85 offen offset:1024 nt
    s_waitcnt vmcnt(6)
    buffer_load_dwordx4 v[188:191], v77, s[52:55], s85 offen offset:1024 nt
    s_add_u32 s87, s87, 7
    s_add_u32 s39, s87, s88
    s_bfe_u32 s37, s39, 0x30000
    s_lshl_b32 s37, s37, 12
    s_add_u32 s85, s37, s89
    s_bfe_u32 s37, s39, 0x10003
    s_lshl_b32 s37, s37, 11
    s_add_u32 s85, s37, s85
    s_bfe_u32 s37, s39, 0x40004
    s_lshl_b32 s37, s37, 16
    s_add_u32 s85, s37, s85
    s_waitcnt vmcnt(6)
    buffer_load_dwordx4 v[192:195], v76, s[52:55], s85 offen offset:0 nt
    s_waitcnt vmcnt(6)
    buffer_load_dwordx4 v[196:199], v77, s[52:55], s85 offen offset:0 nt
    s_waitcnt vmcnt(6)
    buffer_load_dwordx4 v[200:203], v76, s[52:55], s85 offen offset:1024 nt
    s_waitcnt vmcnt(6)
    buffer_load_dwordx4 v[204:207], v77, s[52:55], s85 offen offset:1024 nt
    s_add_u32 s87, s87, 7
    s_add_u32 s39, s87, s88
    s_bfe_u32 s37, s39, 0x30000
    s_lshl_b32 s37, s37, 12
    s_add_u32 s85, s37, s89
    s_bfe_u32 s37, s39, 0x10003
    s_lshl_b32 s37, s37, 11
    s_add_u32 s85, s37, s85
    s_bfe_u32 s37, s39, 0x40004
    s_lshl_b32 s37, s37, 16
    s_add_u32 s85, s37, s85
    s_waitcnt vmcnt(6)
    buffer_load_dwordx4 v[208:211], v76, s[52:55], s85 offen offset:0 nt
    s_waitcnt vmcnt(6)
    buffer_load_dwordx4 v[212:215], v77, s[52:55], s85 offen offset:0 nt
    s_waitcnt vmcnt(6)
    buffer_load_dwordx4 v[216:219], v76, s[52:55], s85 offen offset:1024 nt
    s_waitcnt vmcnt(6)
    buffer_load_dwordx4 v[220:223], v77, s[52:55], s85 offen offset:1024 nt
    s_add_u32 s87, s87, 7
    s_add_u32 s39, s87, s88
    s_bfe_u32 s37, s39, 0x30000
    s_lshl_b32 s37, s37, 12
    s_add_u32 s85, s37, s89
    s_bfe_u32 s37, s39, 0x10003
    s_lshl_b32 s37, s37, 11
    s_add_u32 s85, s37, s85
    s_bfe_u32 s37, s39, 0x40004
    s_lshl_b32 s37, s37, 16
    s_add_u32 s85, s37, s85
    s_waitcnt vmcnt(6)
    buffer_load_dwordx4 v[224:227], v76, s[52:55], s85 offen offset:0 nt
    s_waitcnt vmcnt(6)
    buffer_load_dwordx4 v[228:231], v77, s[52:55], s85 offen offset:0 nt
    s_waitcnt vmcnt(6)
    buffer_load_dwordx4 v[232:235], v76, s[52:55], s85 offen offset:1024 nt
    s_waitcnt vmcnt(6)
    buffer_load_dwordx4 v[236:239], v77, s[52:55], s85 offen offset:1024 nt
    s_add_u32 s87, s87, 7
    s_add_u32 s39, s87, s88
    s_bfe_u32 s37, s39, 0x30000
    s_lshl_b32 s37, s37, 12
    s_add_u32 s85, s37, s89
    s_bfe_u32 s37, s39, 0x10003
    s_lshl_b32 s37, s37, 11
    s_add_u32 s85, s37, s85
    s_bfe_u32 s37, s39, 0x40004
    s_lshl_b32 s37, s37, 16
    s_add_u32 s85, s37, s85
    s_waitcnt vmcnt(6)
    buffer_load_dwordx4 v[240:243], v76, s[52:55], s85 offen offset:0 nt
    s_waitcnt vmcnt(6)
    buffer_load_dwordx4 v[244:247], v77, s[52:55], s85 offen offset:0 nt
    s_waitcnt vmcnt(6)
    buffer_load_dwordx4 v[248:251], v76, s[52:55], s85 offen offset:1024 nt
    s_waitcnt vmcnt(6)
    buffer_load_dwordx4 v[252:255], v77, s[52:55], s85 offen offset:1024 nt
    s_add_u32 s87, s87, 7
    s_add_u32 s39, s87, s88
    s_bfe_u32 s37, s39, 0x30000
    s_lshl_b32 s37, s37, 12
    s_add_u32 s85, s37, s89
    s_bfe_u32 s37, s39, 0x10003
    s_lshl_b32 s37, s37, 11
    s_add_u32 s85, s37, s85
    s_bfe_u32 s37, s39, 0x40004
    s_lshl_b32 s37, s37, 16
    s_add_u32 s85, s37, s85
    s_waitcnt vmcnt(6)
    buffer_load_dwordx4 a[0:3], v76, s[52:55], s85 offen offset:0 nt
    s_waitcnt vmcnt(6)
    buffer_load_dwordx4 a[4:7], v77, s[52:55], s85 offen offset:0 nt
    s_waitcnt vmcnt(6)
    buffer_load_dwordx4 a[8:11], v76, s[52:55], s85 offen offset:1024 nt
    s_waitcnt vmcnt(6)
    buffer_load_dwordx4 a[12:15], v77, s[52:55], s85 offen offset:1024 nt
    s_add_u32 s87, s87, 7
    s_add_u32 s39, s87, s88
    s_bfe_u32 s37, s39, 0x30000
    s_lshl_b32 s37, s37, 12
    s_add_u32 s85, s37, s89
    s_bfe_u32 s37, s39, 0x10003
    s_lshl_b32 s37, s37, 11
    s_add_u32 s85, s37, s85
    s_bfe_u32 s37, s39, 0x40004
    s_lshl_b32 s37, s37, 16
    s_add_u32 s85, s37, s85
    s_waitcnt vmcnt(6)
    buffer_load_dwordx4 a[16:19], v76, s[52:55], s85 offen offset:0 nt
    s_waitcnt vmcnt(6)
    buffer_load_dwordx4 a[20:23], v77, s[52:55], s85 offen offset:0 nt
    s_waitcnt vmcnt(6)
    buffer_load_dwordx4 a[24:27], v76, s[52:55], s85 offen offset:1024 nt
    s_waitcnt vmcnt(6)
    buffer_load_dwordx4 a[28:31], v77, s[52:55], s85 offen offset:1024 nt
    s_add_u32 s87, s87, 7
    s_add_u32 s39, s87, s88
    s_bfe_u32 s37, s39, 0x30000
    s_lshl_b32 s37, s37, 12
    s_add_u32 s85, s37, s89
    s_bfe_u32 s37, s39, 0x10003
    s_lshl_b32 s37, s37, 11
    s_add_u32 s85, s37, s85
    s_bfe_u32 s37, s39, 0x40004
    s_lshl_b32 s37, s37, 16
    s_add_u32 s85, s37, s85
    s_waitcnt vmcnt(6)
    buffer_load_dwordx4 a[32:35], v76, s[52:55], s85 offen offset:0 nt
    s_waitcnt vmcnt(6)
    buffer_load_dwordx4 a[36:39], v77, s[52:55], s85 offen offset:0 nt
    s_waitcnt vmcnt(6)
    buffer_load_dwordx4 a[40:43], v76, s[52:55], s85 offen offset:1024 nt
    s_waitcnt vmcnt(6)
    buffer_load_dwordx4 a[44:47], v77, s[52:55], s85 offen offset:1024 nt
    s_add_u32 s87, s87, 7
    s_add_u32 s39, s87, s88
    s_bfe_u32 s37, s39, 0x30000
    s_lshl_b32 s37, s37, 12
    s_add_u32 s85, s37, s89
    s_bfe_u32 s37, s39, 0x10003
    s_lshl_b32 s37, s37, 11
    s_add_u32 s85, s37, s85
    s_bfe_u32 s37, s39, 0x40004
    s_lshl_b32 s37, s37, 16
    s_add_u32 s85, s37, s85
    s_waitcnt vmcnt(6)
    buffer_load_dwordx4 a[48:51], v76, s[52:55], s85 offen offset:0 nt
    s_waitcnt vmcnt(6)
    buffer_load_dwordx4 a[52:55], v77, s[52:55], s85 offen offset:0 nt
    buffer_load_dwordx4 v[68:71], v78, s[48:51], s91 offen offset:0 sc1
    buffer_load_dwordx4 v[72:75], v78, s[48:51], s91 offen offset:16 sc1
    s_waitcnt vmcnt(8)
    buffer_load_dwordx4 a[56:59], v76, s[52:55], s85 offen offset:1024 nt
    s_waitcnt vmcnt(8)
    buffer_load_dwordx4 a[60:63], v77, s[52:55], s85 offen offset:1024 nt
    s_add_u32 s87, s87, 7
    s_add_u32 s39, s87, s88
    s_bfe_u32 s37, s39, 0x30000
    s_lshl_b32 s37, s37, 12
    s_add_u32 s85, s37, s89
    s_bfe_u32 s37, s39, 0x10003
    s_lshl_b32 s37, s37, 11
    s_add_u32 s85, s37, s85
    s_bfe_u32 s37, s39, 0x40004
    s_lshl_b32 s37, s37, 16
    s_add_u32 s85, s37, s85
    s_waitcnt vmcnt(8)
    buffer_load_dwordx4 a[64:67], v76, s[52:55], s85 offen offset:0 nt
    s_waitcnt vmcnt(8)
    buffer_load_dwordx4 a[68:71], v77, s[52:55], s85 offen offset:0 nt
    s_waitcnt vmcnt(8)
    buffer_load_dwordx4 a[72:75], v76, s[52:55], s85 offen offset:1024 nt
    s_waitcnt vmcnt(8)
    buffer_load_dwordx4 a[76:79], v77, s[52:55], s85 offen offset:1024 nt
    s_add_u32 s87, s87, 7
    s_add_u32 s39, s87, s88
    s_bfe_u32 s37, s39, 0x30000
    s_lshl_b32 s37, s37, 12
    s_add_u32 s85, s37, s89
    s_bfe_u32 s37, s39, 0x10003
    s_lshl_b32 s37, s37, 11
    s_add_u32 s85, s37, s85
    s_bfe_u32 s37, s39, 0x40004
    s_lshl_b32 s37, s37, 16
    s_add_u32 s85, s37, s85
    s_waitcnt lgkmcnt(0)
    s_add_u32 s35, s35, 0x5b
    s_and_b32 s35, s35, 0xff
    v_mov_b32 v8, s35
    s_waitcnt vmcnt(6)
L_qcheck_1:
    v_xor_b32 v68, s35, v68
    v_xor_b32 v69, s35, v69
    v_xor_b32 v70, s35, v70
    v_xor_b32 v71, s35, v71
    v_xor_b32 v72, s35, v72
    v_xor_b32 v73, s35, v73
    v_xor_b32 v74, s35, v74
    v_xor_b32 v75, s35, v75
    v_or_b32 v4, v68, v69
    v_or3_b32 v4, v4, v70, v71
    v_or3_b32 v4, v4, v72, v73
    v_or3_b32 v4, v4, v74, v75
    v_and_b32 v4, 0xff, v4
    v_cmp_ne_u32 vcc, 0, v4
    s_cbranch_vccz L_qok_2
    buffer_load_dwordx4 v[68:71], v78, s[48:51], s91 offen offset:0 sc1
    buffer_load_dwordx4 v[72:75], v78, s[48:51], s91 offen offset:16 sc1
    s_waitcnt vmcnt(0)
    s_sub_u32 s84, s84, 1
    s_cmp_lg_u32 s84, 0
    s_cbranch_scc1 L_qcheck_1
    s_branch L_end
L_qok_2:
    v_cvt_pk_bf16_f32 v68, v68, v69
    v_cvt_pk_bf16_f32 v69, v70, v71
    v_cvt_pk_bf16_f32 v70, v72, v73
    v_cvt_pk_bf16_f32 v71, v74, v75
    s_mov_b32 vcc_lo, 0xf000f
    s_mov_b32 vcc_hi, 0xf000f
    v_cndmask_b32 v80, 0, v68, vcc
    v_cndmask_b32 v81, 0, v69, vcc
    v_cndmask_b32 v82, 0, v70, vcc
    v_cndmask_b32 v83, 0, v71, vcc
    s_mov_b32 vcc_lo, 0xf000f0
    s_mov_b32 vcc_hi, 0xf000f0
    v_cndmask_b32 v84, 0, v68, vcc
    v_cndmask_b32 v85, 0, v69, vcc
    v_cndmask_b32 v86, 0, v70, vcc
    v_cndmask_b32 v87, 0, v71, vcc
    s_mov_b32 vcc_lo, 0xf000f00
    s_mov_b32 vcc_hi, 0xf000f00
    v_cndmask_b32 v88, 0, v68, vcc
    v_cndmask_b32 v89, 0, v69, vcc
    v_cndmask_b32 v90, 0, v70, vcc
    v_cndmask_b32 v91, 0, v71, vcc
    s_mov_b32 vcc_lo, 0xf000f000
    s_mov_b32 vcc_hi, 0xf000f000
    v_cndmask_b32 v92, 0, v68, vcc
    v_cndmask_b32 v93, 0, v69, vcc
    v_cndmask_b32 v94, 0, v70, vcc
    v_cndmask_b32 v95, 0, v71, vcc
    v_mov_b32 v65, 0xff7f0000
    s_lshl_b32 s38, s34, 14
    s_add_u32 s38, s38, 16384
    v_lshl_add_u32 v64, v1, 2, s38
    buffer_load_dwordx4 a[80:83], v76, s[52:55], s85 offen offset:0 nt
    v_mfma_f32_16x16x32_bf16 v[112:115], v[128:131], v[80:83], 0
    v_mfma_f32_16x16x32_bf16 v[112:115], v[132:135], v[84:87], v[112:115]
    v_mfma_f32_16x16x32_bf16 v[112:115], v[136:139], v[88:91], v[112:115]
    s_waitcnt vmcnt(6)
    buffer_load_dwordx4 a[84:87], v77, s[52:55], s85 offen offset:0 nt
    v_mfma_f32_16x16x32_bf16 v[112:115], v[140:143], v[92:95], v[112:115]
    v_mfma_f32_16x16x32_bf16 v[96:99], v[144:147], v[80:83], 0
    v_mfma_f32_16x16x32_bf16 v[96:99], v[148:151], v[84:87], v[96:99]
    v_mfma_f32_16x16x32_bf16 v[96:99], v[152:155], v[88:91], v[96:99]
    s_nop 4
    v_mov_b32_dpp v122, v112 quad_perm:[0,0,0,0] row_mask:0xf bank_mask:0xf
    v_mov_b32_dpp v124, v114 quad_perm:[2,2,2,2] row_mask:0xf bank_mask:0xf
    s_nop 0
    v_add_f32_dpp v122, v113, v122 quad_perm:[1,1,1,1] row_mask:0xf bank_mask:0xf
    v_add_f32_dpp v124, v115, v124 quad_perm:[3,3,3,3] row_mask:0xf bank_mask:0xf
    v_add_f32 v122, v122, v124
    v_max_f32 v65, v65, v122
    ds_write_b32 v64, v122 offset:0
    s_waitcnt vmcnt(6)
    buffer_load_dwordx4 a[88:91], v76, s[52:55], s85 offen offset:1024 nt
    v_mfma_f32_16x16x32_bf16 v[96:99], v[156:159], v[92:95], v[96:99]
    v_mfma_f32_16x16x32_bf16 v[112:115], v[160:163], v[80:83], 0
    v_mfma_f32_16x16x32_bf16 v[112:115], v[164:167], v[84:87], v[112:115]
    s_waitcnt vmcnt(6)
    buffer_load_dwordx4 a[92:95], v77, s[52:55], s85 offen offset:1024 nt
    s_add_u32 s87, s87, 7
    s_add_u32 s39, s87, s88
    s_bfe_u32 s37, s39, 0x30000
    s_lshl_b32 s37, s37, 12
    s_add_u32 s85, s37, s89
    s_bfe_u32 s37, s39, 0x10003
    s_lshl_b32 s37, s37, 11
    s_add_u32 s85, s37, s85
    s_bfe_u32 s37, s39, 0x40004
    s_lshl_b32 s37, s37, 16
    s_add_u32 s85, s37, s85
    v_mfma_f32_16x16x32_bf16 v[112:115], v[168:171], v[88:91], v[112:115]
    v_mov_b32_dpp v122, v96 quad_perm:[0,0,0,0] row_mask:0xf bank_mask:0xf
    v_mov_b32_dpp v124, v98 quad_perm:[2,2,2,2] row_mask:0xf bank_mask:0xf
    s_nop 0
    v_add_f32_dpp v122, v97, v122 quad_perm:[1,1,1,1] row_mask:0xf bank_mask:0xf
    v_add_f32_dpp v124, v99, v124 quad_perm:[3,3,3,3] row_mask:0xf bank_mask:0xf
    v_add_f32 v122, v122, v124
    v_max_f32 v65, v65, v122
    ds_write_b32 v64, v122 offset:256
    v_mfma_f32_16x16x32_bf16 v[112:115], v[172:175], v[92:95], v[112:115]
    v_mfma_f32_16x16x32_bf16 v[96:99], v[176:179], v[80:83], 0
    v_mfma_f32_16x16x32_bf16 v[96:99], v[180:183], v[84:87], v[96:99]
    s_waitcnt vmcnt(6)
    buffer_load_dwordx4 a[96:99], v76, s[52:55], s85 offen offset:0 nt
    v_mfma_f32_16x16x32_bf16 v[96:99], v[184:187], v[88:91], v[96:99]
    s_nop 2
    v_mov_b32_dpp v122, v112 quad_perm:[0,0,0,0] row_mask:0xf bank_mask:0xf
    v_mov_b32_dpp v124, v114 quad_perm:[2,2,2,2] row_mask:0xf bank_mask:0xf
    s_nop 0
    v_add_f32_dpp v122, v113, v122 quad_perm:[1,1,1,1] row_mask:0xf bank_mask:0xf
    v_add_f32_dpp v124, v115, v124 quad_perm:[3,3,3,3] row_mask:0xf bank_mask:0xf
    v_add_f32 v122, v122, v124
    v_max_f32 v65, v65, v122
    ds_write_b32 v64, v122 offset:512
    v_mfma_f32_16x16x32_bf16 v[96:99], v[188:191], v[92:95], v[96:99]
    v_mfma_f32_16x16x32_bf16 v[112:115], v[192:195], v[80:83], 0
    s_waitcnt vmcnt(6)
    buffer_load_dwordx4 a[100:103], v77, s[52:55], s85 offen offset:0 nt
    v_mfma_f32_16x16x32_bf16 v[112:115], v[196:199], v[84:87], v[112:115]
    v_mfma_f32_16x16x32_bf16 v[112:115], v[200:203], v[88:91], v[112:115]
    s_nop 2
    v_mov_b32_dpp v122, v96 quad_perm:[0,0,0,0] row_mask:0xf bank_mask:0xf
    v_mov_b32_dpp v124, v98 quad_perm:[2,2,2,2] row_mask:0xf bank_mask:0xf
    s_nop 0
    v_add_f32_dpp v122, v97, v122 quad_perm:[1,1,1,1] row_mask:0xf bank_mask:0xf
    v_add_f32_dpp v124, v99, v124 quad_perm:[3,3,3,3] row_mask:0xf bank_mask:0xf
    v_add_f32 v122, v122, v124
    v_max_f32 v65, v65, v122
    ds_write_b32 v64, v122 offset:768
    v_mfma_f32_16x16x32_bf16 v[112:115], v[204:207], v[92:95], v[112:115]
    v_mfma_f32_16x16x32_bf16 v[96:99], v[208:211], v[80:83], 0
    s_waitcnt vmcnt(6)
    buffer_load_dwordx4 a[104:107], v76, s[52:55], s85 offen offset:1024 nt
    v_mfma_f32_16x16x32_bf16 v[96:99], v[212:215], v[84:87], v[96:99]
    v_mfma_f32_16x16x32_bf16 v[96:99], v[216:219], v[88:91], v[96:99]
    s_nop 2
    v_mov_b32_dpp v122, v112 quad_perm:[0,0,0,0] row_mask:0xf bank_mask:0xf
    v_mov_b32_dpp v124, v114 quad_perm:[2,2,2,2] row_mask:0xf bank_mask:0xf
    s_nop 0
    v_add_f32_dpp v122, v113, v122 quad_perm:[1,1,1,1] row_mask:0xf bank_mask:0xf
    v_add_f32_dpp v124, v115, v124 quad_perm:[3,3,3,3] row_mask:0xf bank_mask:0xf
    v_add_f32 v122, v122, v124
    v_max_f32 v65, v65, v122
    ds_write_b32 v64, v122 offset:1024
    v_mfma_f32_16x16x32_bf16 v[96:99], v[220:223], v[92:95], v[96:99]
    s_waitcnt vmcnt(6)
    buffer_load_dwordx4 a[108:111], v77, s[52:55], s85 offen offset:1024 nt
    s_add_u32 s87, s87, 7
    s_add_u32 s39, s87, s88
    s_bfe_u32 s37, s39, 0x30000
    s_lshl_b32 s37, s37, 12
    s_add_u32 s85, s37, s89
    s_bfe_u32 s37, s39, 0x10003
    s_lshl_b32 s37, s37, 11
    s_add_u32 s85, s37, s85
    s_bfe_u32 s37, s39, 0x40004
    s_lshl_b32 s37, s37, 16
    s_add_u32 s85, s37, s85
    v_mfma_f32_16x16x32_bf16 v[112:115], v[224:227], v[80:83], 0
    v_mfma_f32_16x16x32_bf16 v[112:115], v[228:231], v[84:87], v[112:115]
    v_mfma_f32_16x16x32_bf16 v[112:115], v[232:235], v[88:91], v[112:115]
    v_mov_b32_dpp v122, v96 quad_perm:[0,0,0,0] row_mask:0xf bank_mask:0xf
    v_mov_b32_dpp v124, v98 quad_perm:[2,2,2,2] row_mask:0xf bank_mask:0xf
    s_nop 0
    v_add_f32_dpp v122, v97, v122 quad_perm:[1,1,1,1] row_mask:0xf bank_mask:0xf
    v_add_f32_dpp v124, v99, v124 quad_perm:[3,3,3,3] row_mask:0xf bank_mask:0xf
    v_add_f32 v122, v122, v124
    v_max_f32 v65, v65, v122
    ds_write_b32 v64, v122 offset:1280
    v_mfma_f32_16x16x32_bf16 v[112:115], v[236:239], v[92:95], v[112:115]
    s_waitcnt vmcnt(6)
    buffer_load_dwordx4 a[112:115], v76, s[52:55], s85 offen offset:0 nt
    v_mfma_f32_16x16x32_bf16 v[96:99], v[240:243], v[80:83], 0
    v_mfma_f32_16x16x32_bf16 v[96:99], v[244:247], v[84:87], v[96:99]
    v_mfma_f32_16x16x32_bf16 v[96:99], v[248:251], v[88:91], v[96:99]
    s_nop 2
    v_mov_b32_dpp v122, v112 quad_perm:[0,0,0,0] row_mask:0xf bank_mask:0xf
    v_mov_b32_dpp v124, v114 quad_perm:[2,2,2,2] row_mask:0xf bank_mask:0xf
    s_nop 0
    v_add_f32_dpp v122, v113, v122 quad_perm:[1,1,1,1] row_mask:0xf bank_mask:0xf
    v_add_f32_dpp v124, v115, v124 quad_perm:[3,3,3,3] row_mask:0xf bank_mask:0xf
    v_add_f32 v122, v122, v124
    v_max_f32 v65, v65, v122
    ds_write_b32 v64, v122 offset:1536
    v_mfma_f32_16x16x32_bf16 v[96:99], v[252:255], v[92:95], v[96:99]
    s_waitcnt vmcnt(6)
    buffer_load_dwordx4 a[116:119], v77, s[52:55], s85 offen offset:0 nt
    v_mfma_f32_16x16x32_bf16 v[112:115], a[0:3], v[80:83], 0
    v_mfma_f32_16x16x32_bf16 v[112:115], a[4:7], v[84:87], v[112:115]
    v_mfma_f32_16x16x32_bf16 v[112:115], a[8:11], v[88:91], v[112:115]
    s_nop 2
    v_mov_b32_dpp v122, v96 quad_perm:[0,0,0,0] row_mask:0xf bank_mask:0xf
    v_mov_b32_dpp v124, v98 quad_perm:[2,2,2,2] row_mask:0xf bank_mask:0xf
    s_nop 0
    v_add_f32_dpp v122, v97, v122 quad_perm:[1,1,1,1] row_mask:0xf bank_mask:0xf
    v_add_f32_dpp v124, v99, v124 quad_perm:[3,3,3,3] row_mask:0xf bank_mask:0xf
    v_add_f32 v122, v122, v124
    v_max_f32 v65, v65, v122
    ds_write_b32 v64, v122 offset:1792
    s_waitcnt vmcnt(6)
    buffer_load_dwordx4 a[120:123], v76, s[52:55], s85 offen offset:1024 nt
    v_mfma_f32_16x16x32_bf16 v[112:115], a[12:15], v[92:95], v[112:115]
    v_mfma_f32_16x16x32_bf16 v[96:99], a[16:19], v[80:83], 0
    v_mfma_f32_16x16x32_bf16 v[96:99], a[20:23], v[84:87], v[96:99]
    v_mfma_f32_16x16x32_bf16 v[96:99], a[24:27], v[88:91], v[96:99]
    s_nop 4
    v_mov_b32_dpp v122, v112 quad_perm:[0,0,0,0] row_mask:0xf bank_mask:0xf
    v_mov_b32_dpp v124, v114 quad_perm:[2,2,2,2] row_mask:0xf bank_mask:0xf
    s_nop 0
    v_add_f32_dpp v122, v113, v122 quad_perm:[1,1,1,1] row_mask:0xf bank_mask:0xf
    v_add_f32_dpp v124, v115, v124 quad_perm:[3,3,3,3] row_mask:0xf bank_mask:0xf
    v_add_f32 v122, v122, v124
    v_max_f32 v65, v65, v122
    ds_write_b32 v64, v122 offset:2048
    s_waitcnt vmcnt(6)
    buffer_load_dwordx4 a[124:127], v77, s[52:55], s85 offen offset:1024 nt
    s_add_u32 s87, s87, 7
    s_add_u32 s39, s87, s88
    s_bfe_u32 s37, s39, 0x30000
    s_lshl_b32 s37, s37, 12
    s_add_u32 s85, s37, s89
    s_bfe_u32 s37, s39, 0x10003
    s_lshl_b32 s37, s37, 11
    s_add_u32 s85, s37, s85
    s_bfe_u32 s37, s39, 0x40004
    s_lshl_b32 s37, s37, 16
    s_add_u32 s85, s37, s85
    v_mfma_f32_16x16x32_bf16 v[96:99], a[28:31], v[92:95], v[96:99]
    v_mfma_f32_16x16x32_bf16 v[112:115], a[32:35], v[80:83], 0
    s_sub_u32 s36, s33, 3
    s_and_b32 s37, s33, 3
    s_cmp_lt_u32 s36, 4
    s_cselect_b64 s[40:41], s[24:25], s[14:15]
    s_cselect_b32 s36, s36, s37
    s_cselect_b32 s45, 262144, 0
    s_cselect_b32 s46, 8388608, 0
    s_add_u32 s45, s45, 524288
    s_add_u32 s46, s46, 196608
    s_mov_b32 s42, 4194304
    s_mov_b32 s43, 0x20000
    s_lshl_b32 s38, s32, 17
    s_add_u32 s44, s38, 0
    s_lshl_b32 s38, s34, 15
    s_add_u32 s44, s38, s44
    s_lshl_b32 s38, s36, 8
    s_add_u32 s44, s38, s44
    s_lshl_b32 s38, s36, 16
    s_add_u32 s45, s38, s45
    s_lshr_b32 s38, s34, 1
    s_lshl_b32 s38, s38, 15
    s_add_u32 s45, s38, s45
    s_lshl_b32 s38, s32, 8
    s_add_u32 s45, s38, s45
    s_bfe_u32 s38, s34, 0x10000
    s_lshl_b32 s38, s38, 7
    s_add_u32 s45, s38, s45
    s_lshl_b32 s38, s32, 11
    s_add_u32 s46, s38, s46
    s_lshl_b32 s38, s34, 9
    s_add_u32 s46, s38, s46
    s_mov_b32 s72, s26
    s_and_b32 s73, s27, 0xffff
    s_mov_b32 s74, 8192
    s_mov_b32 s75, 0x20000
    v_mfma_f32_16x16x32_bf16 v[112:115], a[36:39], v[84:87], v[112:115]
    s_waitcnt vmcnt(5)
    buffer_load_dwordx4 v[128:131], v76, s[52:55], s85 offen offset:0 nt
    v_mfma_f32_16x16x32_bf16 v[112:115], a[40:43], v[88:91], v[112:115]
    v_mov_b32_dpp v122, v96 quad_perm:[0,0,0,0] row_mask:0xf bank_mask:0xf
    v_mov_b32_dpp v124, v98 quad_perm:[2,2,2,2] row_mask:0xf bank_mask:0xf
    s_nop 0
    v_add_f32_dpp v122, v97, v122 quad_perm:[1,1,1,1] row_mask:0xf bank_mask:0xf
    v_add_f32_dpp v124, v99, v124 quad_perm:[3,3,3,3] row_mask:0xf bank_mask:0xf
    v_add_f32 v122, v122, v124
    v_max_f32 v65, v65, v122
    ds_write_b32 v64, v122 offset:2304
    v_mfma_f32_16x16x32_bf16 v[112:115], a[44:47], v[92:95], v[112:115]
    v_mfma_f32_16x16x32_bf16 v[96:99], a[48:51], v[80:83], 0
    v_mfma_f32_16x16x32_bf16 v[96:99], a[52:55], v[84:87], v[96:99]
    s_waitcnt vmcnt(5)
    buffer_load_dwordx4 v[132:135], v77, s[52:55], s85 offen offset:0 nt
    v_mfma_f32_16x16x32_bf16 v[96:99], a[56:59], v[88:91], v[96:99]
    s_nop 2
    v_mov_b32_dpp v122, v112 quad_perm:[0,0,0,0] row_mask:0xf bank_mask:0xf
    v_mov_b32_dpp v124, v114 quad_perm:[2,2,2,2] row_mask:0xf bank_mask:0xf
    s_nop 0
    v_add_f32_dpp v122, v113, v122 quad_perm:[1,1,1,1] row_mask:0xf bank_mask:0xf
    v_add_f32_dpp v124, v115, v124 quad_perm:[3,3,3,3] row_mask:0xf bank_mask:0xf
    v_add_f32 v122, v122, v124
    v_max_f32 v65, v65, v122
    ds_write_b32 v64, v122 offset:2560
    v_lshlrev_b32 v4, 2, v2
    v_xor_b32 v4, v4, v3
    v_xor_b32 v5, 0, v4
    v_lshlrev_b32 v5, 4, v5
    v_lshl_add_u32 v20, v2, 10, v5
    v_xor_b32 v5, 1, v4
    v_lshlrev_b32 v5, 4, v5
    v_lshl_add_u32 v21, v2, 10, v5
    v_add_u32 v21, 3072, v21
    v_xor_b32 v5, 2, v4
    v_lshlrev_b32 v5, 4, v5
    v_lshl_add_u32 v22, v2, 10, v5
    v_add_u32 v22, 6144, v22
    v_xor_b32 v5, 3, v4
    v_lshlrev_b32 v5, 4, v5
    v_lshl_add_u32 v23, v2, 10, v5
    v_add_u32 v23, 9216, v23
    s_lshl_b32 s38, s32, 15
    s_add_u32 s47, s38, 1048576
    s_lshl_b32 s38, s3, 13
    s_add_u32 s47, s38, s47
    v_lshlrev_b32 v6, 7, v2
    v_bfe_u32 v5, v3, 0, 3
    v_lshl_add_u32 v6, v5, 4, v6
    v_lshrrev_b32 v4, 3, v3
    v_and_b32 v7, 3, v3
    v_min_u32 v7, 2, v7
    v_lshl_add_u32 v7, v7, 1, v4
    v_add_u32 v5, 0, v4
    v_cmp_le_u32 vcc, s33, v5
    s_nop 1
    v_addc_co_u32 v5, vcc, 0, v5, vcc
    v_lshl_add_u32 v50, v5, 10, v6
    v_add_u32 v5, 2, v4
    v_cmp_le_u32 vcc, s33, v5
    s_nop 1
    v_addc_co_u32 v5, vcc, 0, v5, vcc
    v_lshl_add_u32 v51, v5, 10, v6
    v_add_u32 v5, 4, v4
    v_cmp_le_u32 vcc, s33, v5
    s_nop 1
    v_addc_co_u32 v5, vcc, 0, v5, vcc
    v_lshl_add_u32 v52, v5, 10, v6
    v_mov_b32 v5, v7
    v_mov_b32 v6, 512
    v_cmp_le_u32 vcc, s33, v5
    s_nop 1
    v_addc_co_u32 v5, vcc, 0, v5, vcc
    v_lshl_add_u32 v53, v5, 10, v6
    s_mul_i32 s38, s3, 320
    s_add_u32 s38, s38, 135168
    v_lshlrev_b32 v4, 6, v2
    v_lshl_add_u32 v4, v3, 1, v4
    v_add_u32 v31, s38, v4
    v_mfma_f32_16x16x32_bf16 v[96:99], a[60:63], v[92:95], v[96:99]
    v_mfma_f32_16x16x32_bf16 v[112:115], a[64:67], v[80:83], 0
    s_waitcnt vmcnt(5)
    buffer_load_dwordx4 v[136:139], v76, s[52:55], s85 offen offset:1024 nt
    v_mfma_f32_16x16x32_bf16 v[112:115], a[68:71], v[84:87], v[112:115]
    v_mfma_f32_16x16x32_bf16 v[112:115], a[72:75], v[88:91], v[112:115]
    s_nop 2
    v_mov_b32_dpp v122, v96 quad_perm:[0,0,0,0] row_mask:0xf bank_mask:0xf
    v_mov_b32_dpp v124, v98 quad_perm:[2,2,2,2] row_mask:0xf bank_mask:0xf
    s_nop 0
    v_add_f32_dpp v122, v97, v122 quad_perm:[1,1,1,1] row_mask:0xf bank_mask:0xf
    v_add_f32_dpp v124, v99, v124 quad_perm:[3,3,3,3] row_mask:0xf bank_mask:0xf
    v_add_f32 v122, v122, v124
    v_max_f32 v65, v65, v122
    ds_write_b32 v64, v122 offset:2816
    v_mfma_f32_16x16x32_bf16 v[112:115], a[76:79], v[92:95], v[112:115]
    v_mfma_f32_16x16x32_bf16 v[96:99], a[80:83], v[80:83], 0
    v_lshlrev_b32 v4, 11, v2
    v_bfe_u32 v5, v1, 2, 2
    v_lshl_add_u32 v4, v5, 8, v4
    v_bfe_u32 v5, v1, 2, 2
    v_lshl_add_u32 v4, v5, 6, v4
    v_bfe_u32 v5, v1, 4, 1
    v_lshl_add_u32 v4, v5, 5, v4
    v_bfe_u32 v5, v1, 1, 1
    v_lshl_add_u32 v4, v5, 4, v4
    v_bfe_u32 v5, v1, 0, 1
    v_lshl_add_u32 v4, v5, 3, v4
    s_lshl_b32 s38, s34, 6
    s_add_u32 s38, s38, 98304
    v_xor_b32 v24, s38, v4
    v_xor_b32 v25, 16, v24
    v_xor_b32 v26, 32, v24
    v_xor_b32 v27, 48, v24
    v_and_b32 v4, 3, v3
    v_lshrrev_b32 v5, 2, v3
    v_lshlrev_b32 v6, 4, v2
    v_add_u32 v6, 135168, v6
    s_movk_i32 s36, 320
    v_cmp_eq_u32 vcc, 0, v5
    s_nop 1
    v_cndmask_b32 v28, 4, v4, vcc
    v_mad_u32_u24 v28, v28, s36, v6
    v_cmp_eq_u32 vcc, 1, v5
    s_nop 1
    v_cndmask_b32 v29, 4, v4, vcc
    v_mad_u32_u24 v29, v29, s36, v6
    v_lshlrev_b32 v5, 2, v1
    v_add_u32 v5, 136448, v5
    v_mov_b32 v6, 0
    ds_write_b32 v5, v6
    s_waitcnt vmcnt(5)
    buffer_load_dwordx4 v[140:143], v77, s[52:55], s85 offen offset:1024 nt
    s_add_u32 s87, s87, 7
    s_add_u32 s39, s87, s88
    s_bfe_u32 s37, s39, 0x30000
    s_lshl_b32 s37, s37, 12
    s_add_u32 s85, s37, s89
    s_bfe_u32 s37, s39, 0x10003
    s_lshl_b32 s37, s37, 11
    s_add_u32 s85, s37, s85
    s_bfe_u32 s37, s39, 0x40004
    s_lshl_b32 s37, s37, 16
    s_add_u32 s85, s37, s85
    v_mfma_f32_16x16x32_bf16 v[96:99], a[84:87], v[84:87], v[96:99]
    v_mfma_f32_16x16x32_bf16 v[96:99], a[88:91], v[88:91], v[96:99]
    v_mov_b32_dpp v122, v112 quad_perm:[0,0,0,0] row_mask:0xf bank_mask:0xf
    v_mov_b32_dpp v124, v114 quad_perm:[2,2,2,2] row_mask:0xf bank_mask:0xf
    s_nop 0
    v_add_f32_dpp v122, v113, v122 quad_perm:[1,1,1,1] row_mask:0xf bank_mask:0xf
    v_add_f32_dpp v124, v115, v124 quad_perm:[3,3,3,3] row_mask:0xf bank_mask:0xf
    v_add_f32 v122, v122, v124
    v_max_f32 v65, v65, v122
    ds_write_b32 v64, v122 offset:3072
    v_mfma_f32_16x16x32_bf16 v[96:99], a[92:95], v[92:95], v[96:99]
    s_waitcnt vmcnt(5)
    buffer_load_dwordx4 v[144:147], v76, s[52:55], s85 offen offset:0 nt
    v_mfma_f32_16x16x32_bf16 v[112:115], a[96:99], v[80:83], 0
    v_mfma_f32_16x16x32_bf16 v[112:115], a[100:103], v[84:87], v[112:115]
    v_mfma_f32_16x16x32_bf16 v[112:115], a[104:107], v[88:91], v[112:115]
    s_nop 2
    v_mov_b32_dpp v122, v96 quad_perm:[0,0,0,0] row_mask:0xf bank_mask:0xf
    v_mov_b32_dpp v124, v98 quad_perm:[2,2,2,2] row_mask:0xf bank_mask:0xf
    s_nop 0
    v_add_f32_dpp v122, v97, v122 quad_perm:[1,1,1,1] row_mask:0xf bank_mask:0xf
    v_add_f32_dpp v124, v99, v124 quad_perm:[3,3,3,3] row_mask:0xf bank_mask:0xf
    v_add_f32 v122, v122, v124
    v_max_f32 v65, v65, v122
    ds_write_b32 v64, v122 offset:3328
    v_lshlrev_b32 v30, 4, v3
    v_lshl_add_u32 v30, v2, 13, v30
    s_lshl_b32 s38, s32, 13
    s_add_u32 s36, s38, 0
    s_lshl_b32 s38, s34, 6
    s_add_u32 s36, s38, s36
    v_lshrrev_b32 v5, 2, v1
    v_lshlrev_b32 v32, 8, v5
    v_bfe_u32 v5, v1, 0, 2
    v_lshl_add_u32 v32, v5, 4, v32
    v_add_u32 v32, s36, v32
    s_lshr_b32 s38, s32, 2
    s_lshl_b32 s38, s38, 7
    s_add_u32 s36, s38, 0
    s_lshl_b32 s38, s34, 5
    s_add_u32 s36, s38, s36
    s_bfe_u32 s38, s32, 0x20000
    s_lshl_b32 s38, s38, 3
    s_add_u32 s36, s38, s36
    v_bfe_u32 v5, v1, 0, 2
    v_lshlrev_b32 v33, 11, v5
    v_lshl_add_u32 v33, v2, 1, v33
    v_add_u32 v33, s36, v33
    v_and_b32 v5, 31, v1
    v_lshlrev_b32 v34, 4, v5
    s_mul_i32 s38, s34, 320
    s_add_u32 s38, s38, 135168
    v_lshl_add_u32 v35, v5, 3, s38
    v_mfma_f32_16x16x32_bf16 v[112:115], a[108:111], v[92:95], v[112:115]
    s_waitcnt vmcnt(5)
    buffer_load_dwordx4 v[148:151], v77, s[52:55], s85 offen offset:0 nt
    v_mfma_f32_16x16x32_bf16 v[96:99], a[112:115], v[80:83], 0
    v_mfma_f32_16x16x32_bf16 v[96:99], a[116:119], v[84:87], v[96:99]
    v_mfma_f32_16x16x32_bf16 v[96:99], a[120:123], v[88:91], v[96:99]
    s_nop 2
    v_mov_b32_dpp v122, v112 quad_perm:[0,0,0,0] row_mask:0xf bank_mask:0xf
    v_mov_b32_dpp v124, v114 quad_perm:[2,2,2,2] row_mask:0xf bank_mask:0xf
    s_nop 0
    v_add_f32_dpp v122, v113, v122 quad_perm:[1,1,1,1] row_mask:0xf bank_mask:0xf
    v_add_f32_dpp v124, v115, v124 quad_perm:[3,3,3,3] row_mask:0xf bank_mask:0xf
    v_add_f32 v122, v122, v124
    v_max_f32 v65, v65, v122
    ds_write_b32 v64, v122 offset:3584
    v_mfma_f32_16x16x32_bf16 v[96:99], a[124:127], v[92:95], v[96:99]
    v_add_u32 v64, 3840, v64
    s_mov_b32 s97, 8
    s_mov_b32 s86, 32
    s_and_b32 s36, s32, 3
    s_sub_u32 s80, s36, 2
    s_cmp_ge_u32 s36, 2
    s_cselect_b32 s80, s80, 8
    s_cselect_b32 s81, 27, 25
    s_cmp_eq_u32 s80, s33
    s_cselect_b32 s36, 2, 0
    s_sub_u32 s86, s86, s36
    s_lshr_b32 s36, s36, 1
    s_sub_u32 s97, s97, s36
    s_add_u32 s80, s80, 35
    s_sub_u32 s92, s81, 1
    s_mov_b32 s66, 134217728
    s_mov_b32 s67, 0x20000
    s_mov_b64 s[64:65], s[52:53]
    v_mov_b32 v62, v76
    v_mov_b32 v63, v77
L_bloop:
    s_waitcnt vmcnt(5)
    buffer_load_dwordx4 v[152:155], v62, s[64:67], s85 offen offset:1024 nt
    v_mfma_f32_16x16x32_bf16 v[112:115], v[128:131], v[80:83], 0
    s_waitcnt vmcnt(5)
    buffer_load_dwordx4 v[156:159], v63, s[64:67], s85 offen offset:1024 nt
    v_mfma_f32_16x16x32_bf16 v[112:115], v[132:135], v[84:87], v[112:115]
    s_add_u32 s87, s87, 7
    s_cmp_lg_u32 s97, 1
    s_cbranch_scc1 L_stayk_3
    s_mov_b64 s[64:65], s[56:57]
    v_mov_b32 v62, v126
    v_mov_b32 v63, v127
    s_mul_i32 s37, s86, 7
    s_sub_u32 s87, s87, s37
L_stayk_3:
    s_add_u32 s39, s87, s88
    s_bfe_u32 s37, s39, 0x30000
    s_lshl_b32 s37, s37, 12
    s_add_u32 s85, s37, s89
    s_bfe_u32 s37, s39, 0x10003
    s_lshl_b32 s37, s37, 11
    s_add_u32 s85, s37, s85
    s_bfe_u32 s37, s39, 0x40004
    s_lshl_b32 s37, s37, 16
    s_add_u32 s85, s37, s85
    v_mov_b32_dpp v122, v96 quad_perm:[0,0,0,0] row_mask:0xf bank_mask:0xf
    v_mov_b32_dpp v124, v98 quad_perm:[2,2,2,2] row_mask:0xf bank_mask:0xf
    s_nop 0
    v_add_f32_dpp v122, v97, v122 quad_perm:[1,1,1,1] row_mask:0xf bank_mask:0xf
    v_add_f32_dpp v124, v99, v124 quad_perm:[3,3,3,3] row_mask:0xf bank_mask:0xf
    v_add_f32 v122, v122, v124
    v_max_f32 v65, v65, v122
    ds_write_b32 v64, v122 offset:0
    s_waitcnt vmcnt(5)
    buffer_load_dwordx4 v[128:131], v62, s[64:67], s85 offen offset:0 nt
    v_mfma_f32_16x16x32_bf16 v[112:115], v[136:139], v[88:91], v[112:115]
    s_waitcnt vmcnt(5)
    buffer_load_dwordx4 v[132:135], v63, s[64:67], s85 offen offset:0 nt
    v_mfma_f32_16x16x32_bf16 v[112:115], v[140:143], v[92:95], v[112:115]
    s_waitcnt vmcnt(5)
    buffer_load_dwordx4 v[136:139], v62, s[64:67], s85 offen offset:1024 nt
    v_mfma_f32_16x16x32_bf16 v[96:99], v[144:147], v[80:83], 0
    s_waitcnt vmcnt(5)
    buffer_load_dwordx4 v[140:143], v63, s[64:67], s85 offen offset:1024 nt
    v_mfma_f32_16x16x32_bf16 v[96:99], v[148:151], v[84:87], v[96:99]
    s_add_u32 s87, s87, 7
    s_add_u32 s39, s87, s88
    s_bfe_u32 s37, s39, 0x30000
    s_lshl_b32 s37, s37, 12
    s_add_u32 s85, s37, s89
    s_bfe_u32 s37, s39, 0x10003
    s_lshl_b32 s37, s37, 11
    s_add_u32 s85, s37, s85
    s_bfe_u32 s37, s39, 0x40004
    s_lshl_b32 s37, s37, 16
    s_add_u32 s85, s37, s85
    v_mov_b32_dpp v122, v112 quad_perm:[0,0,0,0] row_mask:0xf bank_mask:0xf
    v_mov_b32_dpp v124, v114 quad_perm:[2,2,2,2] row_mask:0xf bank_mask:0xf
    s_nop 0
    v_add_f32_dpp v122, v113, v122 quad_perm:[1,1,1,1] row_mask:0xf bank_mask:0xf
    v_add_f32_dpp v124, v115, v124 quad_perm:[3,3,3,3] row_mask:0xf bank_mask:0xf
    v_add_f32 v122, v122, v124
    v_max_f32 v65, v65, v122
    ds_write_b32 v64, v122 offset:256
    s_waitcnt vmcnt(5)
    buffer_load_dwordx4 v[144:147], v62, s[64:67], s85 offen offset:0 nt
    v_mfma_f32_16x16x32_bf16 v[96:99], v[152:155], v[88:91], v[96:99]
    s_waitcnt vmcnt(5)
    buffer_load_dwordx4 v[148:151], v63, s[64:67], s85 offen offset:0 nt
    v_mfma_f32_16x16x32_bf16 v[96:99], v[156:159], v[92:95], v[96:99]
    v_add_u32 v64, 512, v64
    s_sub_u32 s97, s97, 1
    s_cmp_lg_u32 s97, 0
    s_cbranch_scc1 L_bloop
    s_nop 3
    v_mov_b32_dpp v122, v96 quad_perm:[0,0,0,0] row_mask:0xf bank_mask:0xf
    v_mov_b32_dpp v124, v98 quad_perm:[2,2,2,2] row_mask:0xf bank_mask:0xf
    s_nop 0
    v_add_f32_dpp v122, v97, v122 quad_perm:[1,1,1,1] row_mask:0xf bank_mask:0xf
    v_add_f32_dpp v124, v99, v124 quad_perm:[3,3,3,3] row_mask:0xf bank_mask:0xf
    v_add_f32 v122, v122, v124
    v_max_f32 v65, v65, v122
    ds_write_b32 v64, v122 offset:0
    v_mov_b32 v123, 0xff7f0000
    ds_write_b32 v64, v123 offset:256
    s_lshl_b32 s38, s34, 14
    s_add_u32 s38, s38, 16384
    v_lshl_add_u32 v64, v1, 2, s38
    ds_read_b32 v66, v64
    ds_read_b32 v67, v64 offset:256
    v_mul_f32 v65, s83, v65
    s_nop 1
    v_max_f32_dpp v124, v65, v65 row_ror:4 row_mask:0xf bank_mask:0xf
    s_nop 1
    v_max_f32_dpp v124, v124, v124 row_ror:8 row_mask:0xf bank_mask:0xf
    v_mov_b32 v125, v124
    s_nop 1
    v_permlane16_swap_b32 v124, v125
    v_max_f32 v124, v124, v125
    v_mov_b32 v125, v124
    s_nop 1
    v_permlane32_swap_b32 v124, v125
    v_max_f32 v124, v124, v125
    v_mov_b32 v120, v124
    s_lshr_b32 s97, s86, 1
    s_waitcnt lgkmcnt(1)
    v_fma_f32 v123, v66, s83, -v120
    v_exp_f32 v123, v123
    ds_read_b32 v66, v64 offset:512
    v_cvt_pk_bf16_f32 v100, v123, v123
    v_add_f32 v121, v121, v123
L_vloop:
    s_nop 0
    v_and_b32_dpp v104, v100, v10 row_newbcast:0 row_mask:0xf bank_mask:0xf
    v_and_b32_dpp v105, v100, v11 row_newbcast:0 row_mask:0xf bank_mask:0xf
    v_and_b32_dpp v106, v100, v12 row_newbcast:0 row_mask:0xf bank_mask:0xf
    v_and_b32_dpp v107, v100, v13 row_newbcast:0 row_mask:0xf bank_mask:0xf
    s_waitcnt vmcnt(5)
    buffer_load_dwordx4 v[152:155], v62, s[64:67], s85 offen offset:1024 nt
    v_mfma_f32_16x16x32_bf16 v[116:119], v[128:131], v[104:107], v[116:119]
    v_and_b32_dpp v108, v100, v10 row_newbcast:4 row_mask:0xf bank_mask:0xf
    v_and_b32_dpp v109, v100, v11 row_newbcast:4 row_mask:0xf bank_mask:0xf
    v_and_b32_dpp v110, v100, v12 row_newbcast:4 row_mask:0xf bank_mask:0xf
    v_and_b32_dpp v111, v100, v13 row_newbcast:4 row_mask:0xf bank_mask:0xf
    s_waitcnt vmcnt(5)
    buffer_load_dwordx4 v[156:159], v63, s[64:67], s85 offen offset:1024 nt
    v_mfma_f32_16x16x32_bf16 v[116:119], v[132:135], v[108:111], v[116:119]
    s_add_u32 s87, s87, 7
    s_cmp_lg_u32 s97, 1
    s_cbranch_scc1 L_stayv_4
    s_mov_b64 s[64:65], s[52:53]
    v_mov_b32 v62, v76
    v_mov_b32 v63, v77
    s_mov_b64 exec, 1
    global_atomic_add v19, v9, v18, s[30:31] sc0 sc1
    s_mov_b64 exec, -1
    s_add_u32 s87, s33, 224
L_stayv_4:
    s_add_u32 s39, s87, s88
    s_bfe_u32 s37, s39, 0x30000
    s_lshl_b32 s37, s37, 12
    s_add_u32 s85, s37, s89
    s_bfe_u32 s37, s39, 0x10003
    s_lshl_b32 s37, s37, 11
    s_add_u32 s85, s37, s85
    s_bfe_u32 s37, s39, 0x40004
    s_lshl_b32 s37, s37, 16
    s_add_u32 s85, s37, s85
    s_waitcnt lgkmcnt(1)
    v_fma_f32 v123, v67, s83, -v120
    v_exp_f32 v123, v123
    ds_read_b32 v67, v64 offset:768
    v_cvt_pk_bf16_f32 v101, v123, v123
    v_add_f32 v121, v121, v123
    v_and_b32_dpp v104, v100, v10 row_newbcast:8 row_mask:0xf bank_mask:0xf
    v_and_b32_dpp v105, v100, v11 row_newbcast:8 row_mask:0xf bank_mask:0xf
    v_and_b32_dpp v106, v100, v12 row_newbcast:8 row_mask:0xf bank_mask:0xf
    v_and_b32_dpp v107, v100, v13 row_newbcast:8 row_mask:0xf bank_mask:0xf
    s_waitcnt vmcnt(5)
    buffer_load_dwordx4 v[128:131], v62, s[64:67], s85 offen offset:0 nt
    v_mfma_f32_16x16x32_bf16 v[116:119], v[136:139], v[104:107], v[116:119]
    v_and_b32_dpp v108, v100, v10 row_newbcast:12 row_mask:0xf bank_mask:0xf
    v_and_b32_dpp v109, v100, v11 row_newbcast:12 row_mask:0xf bank_mask:0xf
    v_and_b32_dpp v110, v100, v12 row_newbcast:12 row_mask:0xf bank_mask:0xf
    v_and_b32_dpp v111, v100, v13 row_newbcast:12 row_mask:0xf bank_mask:0xf
    s_waitcnt vmcnt(5)
    buffer_load_dwordx4 v[132:135], v63, s[64:67], s85 offen offset:0 nt
    v_mfma_f32_16x16x32_bf16 v[116:119], v[140:143], v[108:111], v[116:119]
    v_and_b32_dpp v104, v101, v10 row_newbcast:0 row_mask:0xf bank_mask:0xf
    v_and_b32_dpp v105, v101, v11 row_newbcast:0 row_mask:0xf bank_mask:0xf
    v_and_b32_dpp v106, v101, v12 row_newbcast:0 row_mask:0xf bank_mask:0xf
    v_and_b32_dpp v107, v101, v13 row_newbcast:0 row_mask:0xf bank_mask:0xf
    s_waitcnt vmcnt(5)
    buffer_load_dwordx4 v[136:139], v62, s[64:67], s85 offen offset:1024 nt
    v_mfma_f32_16x16x32_bf16 v[116:119], v[144:147], v[104:107], v[116:119]
    v_and_b32_dpp v108, v101, v10 row_newbcast:4 row_mask:0xf bank_mask:0xf
    v_and_b32_dpp v109, v101, v11 row_newbcast:4 row_mask:0xf bank_mask:0xf
    v_and_b32_dpp v110, v101, v12 row_newbcast:4 row_mask:0xf bank_mask:0xf
    v_and_b32_dpp v111, v101, v13 row_newbcast:4 row_mask:0xf bank_mask:0xf
    s_waitcnt vmcnt(5)
    buffer_load_dwordx4 v[140:143], v63, s[64:67], s85 offen offset:1024 nt
    v_mfma_f32_16x16x32_bf16 v[116:119], v[148:151], v[108:111], v[116:119]
    s_add_u32 s87, s87, 7
    s_cmp_lg_u32 s97, 1
    s_cbranch_scc1 L_stayv_5
    s_mov_b64 s[64:65], s[56:57]
    v_mov_b32 v62, v126
    v_mov_b32 v63, v127
    s_add_u32 s87, s33, 224
L_stayv_5:
    s_add_u32 s39, s87, s88
    s_bfe_u32 s37, s39, 0x30000
    s_lshl_b32 s37, s37, 12
    s_add_u32 s85, s37, s89
    s_bfe_u32 s37, s39, 0x10003
    s_lshl_b32 s37, s37, 11
    s_add_u32 s85, s37, s85
    s_bfe_u32 s37, s39, 0x40004
    s_lshl_b32 s37, s37, 16
    s_add_u32 s85, s37, s85
    v_add_u32 v64, 512, v64
    s_waitcnt lgkmcnt(1)
    v_fma_f32 v123, v66, s83, -v120
    v_exp_f32 v123, v123
    ds_read_b32 v66, v64 offset:512
    v_cvt_pk_bf16_f32 v100, v123, v123
    v_add_f32 v121, v121, v123
    v_and_b32_dpp v104, v101, v10 row_newbcast:8 row_mask:0xf bank_mask:0xf
    v_and_b32_dpp v105, v101, v11 row_newbcast:8 row_mask:0xf bank_mask:0xf
    v_and_b32_dpp v106, v101, v12 row_newbcast:8 row_mask:0xf bank_mask:0xf
    v_and_b32_dpp v107, v101, v13 row_newbcast:8 row_mask:0xf bank_mask:0xf
    s_waitcnt vmcnt(5)
    buffer_load_dwordx4 v[144:147], v62, s[64:67], s85 offen offset:0 nt
    v_mfma_f32_16x16x32_bf16 v[116:119], v[152:155], v[104:107], v[116:119]
    v_and_b32_dpp v108, v101, v10 row_newbcast:12 row_mask:0xf bank_mask:0xf
    v_and_b32_dpp v109, v101, v11 row_newbcast:12 row_mask:0xf bank_mask:0xf
    v_and_b32_dpp v110, v101, v12 row_newbcast:12 row_mask:0xf bank_mask:0xf
    v_and_b32_dpp v111, v101, v13 row_newbcast:12 row_mask:0xf bank_mask:0xf
    s_waitcnt vmcnt(5)
    buffer_load_dwordx4 v[148:151], v63, s[64:67], s85 offen offset:0 nt
    v_mfma_f32_16x16x32_bf16 v[116:119], v[156:159], v[108:111], v[116:119]
    s_sub_u32 s97, s97, 1
    s_cmp_lg_u32 s97, 0
    s_cbranch_scc1 L_vloop
    buffer_load_dwordx4 v[152:155], v126, s[56:59], s85 offen offset:1024 nt
    buffer_load_dwordx4 v[156:159], v127, s[56:59], s85 offen offset:1024 nt
L_dloop:
    s_waitcnt vmcnt(7)
    v_readfirstlane_b32 s93, v19
    v_mov_b32 v19, 64
    s_cmp_ge_u32 s93, s81
    s_cbranch_scc1 L_last0
    s_add_u32 s87, s93, 231
    s_mul_i32 s36, s93, 7
    s_add_u32 s36, s36, s80
    s_cmp_ge_u32 s93, 25
    s_cselect_b32 s87, s36, s87
    s_add_u32 s39, s87, s88
    s_bfe_u32 s37, s39, 0x30000
    s_lshl_b32 s37, s37, 12
    s_add_u32 s85, s37, s89
    s_bfe_u32 s37, s39, 0x10003
    s_lshl_b32 s37, s37, 11
    s_add_u32 s85, s37, s85
    s_bfe_u32 s37, s39, 0x40004
    s_lshl_b32 s37, s37, 16
    s_add_u32 s85, s37, s85
    s_cmp_ge_u32 s93, s92
    s_cbranch_scc1 L_noclaim_6
    s_mov_b64 exec, 1
    global_atomic_add v19, v9, v18, s[30:31] sc0 sc1
    s_mov_b64 exec, -1
L_noclaim_6:
    buffer_load_dwordx4 v[160:163], v76, s[52:55], s85 offen offset:0 nt
    v_mfma_f32_16x16x32_bf16 v[112:115], v[128:131], v[80:83], 0
    s_waitcnt vmcnt(7)
    buffer_load_dwordx4 v[164:167], v77, s[52:55], s85 offen offset:0 nt
    v_mfma_f32_16x16x32_bf16 v[112:115], v[132:135], v[84:87], v[112:115]
    s_waitcnt vmcnt(7)
    buffer_load_dwordx4 v[168:171], v76, s[52:55], s85 offen offset:1024 nt
    v_mfma_f32_16x16x32_bf16 v[112:115], v[136:139], v[88:91], v[112:115]
    s_waitcnt vmcnt(7)
    buffer_load_dwordx4 v[172:175], v77, s[52:55], s85 offen offset:1024 nt
    v_mfma_f32_16x16x32_bf16 v[112:115], v[140:143], v[92:95], v[112:115]
    s_nop 7
    v_mov_b32_dpp v122, v112 quad_perm:[0,0,0,0] row_mask:0xf bank_mask:0xf
    v_mov_b32_dpp v124, v114 quad_perm:[2,2,2,2] row_mask:0xf bank_mask:0xf
    s_nop 0
    v_add_f32_dpp v122, v113, v122 quad_perm:[1,1,1,1] row_mask:0xf bank_mask:0xf
    v_add_f32_dpp v124, v115, v124 quad_perm:[3,3,3,3] row_mask:0xf bank_mask:0xf
    v_add_f32 v122, v122, v124
    v_fma_f32 v123, v122, s83, -v120
    v_cmp_lt_f32 vcc, 0, v123
    s_cbranch_vccz L_nomax_7
    v_mul_f32 v122, s83, v122
    s_nop 1
    v_max_f32_dpp v124, v122, v122 row_ror:4 row_mask:0xf bank_mask:0xf
    s_nop 1
    v_max_f32_dpp v124, v124, v124 row_ror:8 row_mask:0xf bank_mask:0xf
    v_mov_b32 v125, v124
    s_nop 1
    v_permlane16_swap_b32 v124, v125
    v_max_f32 v124, v124, v125
    v_mov_b32 v125, v124
    s_nop 1
    v_permlane32_swap_b32 v124, v125
    v_max_f32 v124, v124, v125
    v_max_f32 v124, v124, v120
    v_sub_f32 v125, v120, v124
    v_exp_f32 v125, v125
    v_mov_b32 v120, v124
    v_sub_f32 v123, v122, v124
    v_mul_f32 v121, v121, v125
    v_mul_f32 v116, v116, v125
    v_mul_f32 v117, v117, v125
    v_mul_f32 v118, v118, v125
    v_mul_f32 v119, v119, v125
L_nomax_7:
    v_exp_f32 v123, v123
    s_nop 0
    v_cvt_pk_bf16_f32 v124, v123, v123
    v_add_f32 v121, v121, v123
    s_nop 0
    v_and_b32_dpp v96, v124, v10 row_newbcast:0 row_mask:0xf bank_mask:0xf
    v_and_b32_dpp v97, v124, v11 row_newbcast:0 row_mask:0xf bank_mask:0xf
    v_and_b32_dpp v98, v124, v12 row_newbcast:0 row_mask:0xf bank_mask:0xf
    v_and_b32_dpp v99, v124, v13 row_newbcast:0 row_mask:0xf bank_mask:0xf
    v_and_b32_dpp v100, v124, v10 row_newbcast:4 row_mask:0xf bank_mask:0xf
    v_and_b32_dpp v101, v124, v11 row_newbcast:4 row_mask:0xf bank_mask:0xf
    v_and_b32_dpp v102, v124, v12 row_newbcast:4 row_mask:0xf bank_mask:0xf
    v_and_b32_dpp v103, v124, v13 row_newbcast:4 row_mask:0xf bank_mask:0xf
    v_and_b32_dpp v104, v124, v10 row_newbcast:8 row_mask:0xf bank_mask:0xf
    v_and_b32_dpp v105, v124, v11 row_newbcast:8 row_mask:0xf bank_mask:0xf
    v_and_b32_dpp v106, v124, v12 row_newbcast:8 row_mask:0xf bank_mask:0xf
    v_and_b32_dpp v107, v124, v13 row_newbcast:8 row_mask:0xf bank_mask:0xf
    v_and_b32_dpp v108, v124, v10 row_newbcast:12 row_mask:0xf bank_mask:0xf
    v_and_b32_dpp v109, v124, v11 row_newbcast:12 row_mask:0xf bank_mask:0xf
    v_and_b32_dpp v110, v124, v12 row_newbcast:12 row_mask:0xf bank_mask:0xf
    v_and_b32_dpp v111, v124, v13 row_newbcast:12 row_mask:0xf bank_mask:0xf
    s_waitcnt vmcnt(7)
    buffer_load_dwordx4 v[176:179], v126, s[56:59], s85 offen offset:0 nt
    v_mfma_f32_16x16x32_bf16 v[116:119], v[144:147], v[96:99], v[116:119]
    s_waitcnt vmcnt(7)
    buffer_load_dwordx4 v[180:183], v127, s[56:59], s85 offen offset:0 nt
    v_mfma_f32_16x16x32_bf16 v[116:119], v[148:151], v[100:103], v[116:119]
    s_waitcnt vmcnt(7)
    buffer_load_dwordx4 v[184:187], v126, s[56:59], s85 offen offset:1024 nt
    v_mfma_f32_16x16x32_bf16 v[116:119], v[152:155], v[104:107], v[116:119]
    s_waitcnt vmcnt(7)
    buffer_load_dwordx4 v[188:191], v127, s[56:59], s85 offen offset:1024 nt
    v_mfma_f32_16x16x32_bf16 v[116:119], v[156:159], v[108:111], v[116:119]
    s_waitcnt vmcnt(7)
    v_readfirstlane_b32 s93, v19
    v_mov_b32 v19, 64
    s_cmp_ge_u32 s93, s81
    s_cbranch_scc1 L_last1
    s_add_u32 s87, s93, 231
    s_mul_i32 s36, s93, 7
    s_add_u32 s36, s36, s80
    s_cmp_ge_u32 s93, 25
    s_cselect_b32 s87, s36, s87
    s_add_u32 s39, s87, s88
    s_bfe_u32 s37, s39, 0x30000
    s_lshl_b32 s37, s37, 12
    s_add_u32 s85, s37, s89
    s_bfe_u32 s37, s39, 0x10003
    s_lshl_b32 s37, s37, 11
    s_add_u32 s85, s37, s85
    s_bfe_u32 s37, s39, 0x40004
    s_lshl_b32 s37, s37, 16
    s_add_u32 s85, s37, s85
    s_cmp_ge_u32 s93, s92
    s_cbranch_scc1 L_noclaim_8
    s_mov_b64 exec, 1
    global_atomic_add v19, v9, v18, s[30:31] sc0 sc1
    s_mov_b64 exec, -1
L_noclaim_8:
    buffer_load_dwordx4 v[128:131], v76, s[52:55], s85 offen offset:0 nt
    v_mfma_f32_16x16x32_bf16 v[112:115], v[160:163], v[80:83], 0
    s_waitcnt vmcnt(7)
    buffer_load_dwordx4 v[132:135], v77, s[52:55], s85 offen offset:0 nt
    v_mfma_f32_16x16x32_bf16 v[112:115], v[164:167], v[84:87], v[112:115]
    s_waitcnt vmcnt(7)
    buffer_load_dwordx4 v[136:139], v76, s[52:55], s85 offen offset:1024 nt
    v_mfma_f32_16x16x32_bf16 v[112:115], v[168:171], v[88:91], v[112:115]
    s_waitcnt vmcnt(7)
    buffer_load_dwordx4 v[140:143], v77, s[52:55], s85 offen offset:1024 nt
    v_mfma_f32_16x16x32_bf16 v[112:115], v[172:175], v[92:95], v[112:115]
    s_nop 7
    v_mov_b32_dpp v122, v112 quad_perm:[0,0,0,0] row_mask:0xf bank_mask:0xf
    v_mov_b32_dpp v124, v114 quad_perm:[2,2,2,2] row_mask:0xf bank_mask:0xf
    s_nop 0
    v_add_f32_dpp v122, v113, v122 quad_perm:[1,1,1,1] row_mask:0xf bank_mask:0xf
    v_add_f32_dpp v124, v115, v124 quad_perm:[3,3,3,3] row_mask:0xf bank_mask:0xf
    v_add_f32 v122, v122, v124
    v_fma_f32 v123, v122, s83, -v120
    v_cmp_lt_f32 vcc, 0, v123
    s_cbranch_vccz L_nomax_9
    v_mul_f32 v122, s83, v122
    s_nop 1
    v_max_f32_dpp v124, v122, v122 row_ror:4 row_mask:0xf bank_mask:0xf
    s_nop 1
    v_max_f32_dpp v124, v124, v124 row_ror:8 row_mask:0xf bank_mask:0xf
    v_mov_b32 v125, v124
    s_nop 1
    v_permlane16_swap_b32 v124, v125
    v_max_f32 v124, v124, v125
    v_mov_b32 v125, v124
    s_nop 1
    v_permlane32_swap_b32 v124, v125
    v_max_f32 v124, v124, v125
    v_max_f32 v124, v124, v120
    v_sub_f32 v125, v120, v124
    v_exp_f32 v125, v125
    v_mov_b32 v120, v124
    v_sub_f32 v123, v122, v124
    v_mul_f32 v121, v121, v125
    v_mul_f32 v116, v116, v125
    v_mul_f32 v117, v117, v125
    v_mul_f32 v118, v118, v125
    v_mul_f32 v119, v119, v125
L_nomax_9:
    v_exp_f32 v123, v123
    s_nop 0
    v_cvt_pk_bf16_f32 v124, v123, v123
    v_add_f32 v121, v121, v123
    s_nop 0
    v_and_b32_dpp v96, v124, v10 row_newbcast:0 row_mask:0xf bank_mask:0xf
    v_and_b32_dpp v97, v124, v11 row_newbcast:0 row_mask:0xf bank_mask:0xf
    v_and_b32_dpp v98, v124, v12 row_newbcast:0 row_mask:0xf bank_mask:0xf
    v_and_b32_dpp v99, v124, v13 row_newbcast:0 row_mask:0xf bank_mask:0xf
    v_and_b32_dpp v100, v124, v10 row_newbcast:4 row_mask:0xf bank_mask:0xf
    v_and_b32_dpp v101, v124, v11 row_newbcast:4 row_mask:0xf bank_mask:0xf
    v_and_b32_dpp v102, v124, v12 row_newbcast:4 row_mask:0xf bank_mask:0xf
    v_and_b32_dpp v103, v124, v13 row_newbcast:4 row_mask:0xf bank_mask:0xf
    v_and_b32_dpp v104, v124, v10 row_newbcast:8 row_mask:0xf bank_mask:0xf
    v_and_b32_dpp v105, v124, v11 row_newbcast:8 row_mask:0xf bank_mask:0xf
    v_and_b32_dpp v106, v124, v12 row_newbcast:8 row_mask:0xf bank_mask:0xf
    v_and_b32_dpp v107, v124, v13 row_newbcast:8 row_mask:0xf bank_mask:0xf
    v_and_b32_dpp v108, v124, v10 row_newbcast:12 row_mask:0xf bank_mask:0xf
    v_and_b32_dpp v109, v124, v11 row_newbcast:12 row_mask:0xf bank_mask:0xf
    v_and_b32_dpp v110, v124, v12 row_newbcast:12 row_mask:0xf bank_mask:0xf
    v_and_b32_dpp v111, v124, v13 row_newbcast:12 row_mask:0xf bank_mask:0xf
    s_waitcnt vmcnt(7)
    buffer_load_dwordx4 v[144:147], v126, s[56:59], s85 offen offset:0 nt
    v_mfma_f32_16x16x32_bf16 v[116:119], v[176:179], v[96:99], v[116:119]
    s_waitcnt vmcnt(7)
    buffer_load_dwordx4 v[148:151], v127, s[56:59], s85 offen offset:0 nt
    v_mfma_f32_16x16x32_bf16 v[116:119], v[180:183], v[100:103], v[116:119]
    s_waitcnt vmcnt(7)
    buffer_load_dwordx4 v[152:155], v126, s[56:59], s85 offen offset:1024 nt
    v_mfma_f32_16x16x32_bf16 v[116:119], v[184:187], v[104:107], v[116:119]
    s_waitcnt vmcnt(7)
    buffer_load_dwordx4 v[156:159], v127, s[56:59], s85 offen offset:1024 nt
    v_mfma_f32_16x16x32_bf16 v[116:119], v[188:191], v[108:111], v[116:119]
    s_branch L_dloop
L_last1:
    buffer_load_dwordx4 v[224:227], v34, s[48:51], s46 offen sc1
    s_mov_b32 s86, s44
    s_cmp_lt_u32 s33, 3
    s_cselect_b32 s44, 4194304, s44
    v_mfma_f32_16x16x32_bf16 v[112:115], v[160:163], v[80:83], 0
    s_waitcnt vmcnt(7)
    v_mfma_f32_16x16x32_bf16 v[112:115], v[164:167], v[84:87], v[112:115]
    s_waitcnt vmcnt(6)
    v_mfma_f32_16x16x32_bf16 v[112:115], v[168:171], v[88:91], v[112:115]
    s_waitcnt vmcnt(5)
    v_mfma_f32_16x16x32_bf16 v[112:115], v[172:175], v[92:95], v[112:115]
    s_nop 7
    v_mov_b32_dpp v122, v112 quad_perm:[0,0,0,0] row_mask:0xf bank_mask:0xf
    v_mov_b32_dpp v124, v114 quad_perm:[2,2,2,2] row_mask:0xf bank_mask:0xf
    s_nop 0
    v_add_f32_dpp v122, v113, v122 quad_perm:[1,1,1,1] row_mask:0xf bank_mask:0xf
    v_add_f32_dpp v124, v115, v124 quad_perm:[3,3,3,3] row_mask:0xf bank_mask:0xf
    v_add_f32 v122, v122, v124
    v_fma_f32 v123, v122, s83, -v120
    v_cmp_lt_f32 vcc, 0, v123
    s_cbranch_vccz L_nomax_10
    v_mul_f32 v122, s83, v122
    s_nop 1
    v_max_f32_dpp v124, v122, v122 row_ror:4 row_mask:0xf bank_mask:0xf
    s_nop 1
    v_max_f32_dpp v124, v124, v124 row_ror:8 row_mask:0xf bank_mask:0xf
    v_mov_b32 v125, v124
    s_nop 1
    v_permlane16_swap_b32 v124, v125
    v_max_f32 v124, v124, v125
    v_mov_b32 v125, v124
    s_nop 1
    v_permlane32_swap_b32 v124, v125
    v_max_f32 v124, v124, v125
    v_max_f32 v124, v124, v120
    v_sub_f32 v125, v120, v124
    v_exp_f32 v125, v125
    v_mov_b32 v120, v124
    v_sub_f32 v123, v122, v124
    v_mul_f32 v121, v121, v125
    v_mul_f32 v116, v116, v125
    v_mul_f32 v117, v117, v125
    v_mul_f32 v118, v118, v125
    v_mul_f32 v119, v119, v125
L_nomax_10:
    v_exp_f32 v123, v123
    s_nop 0
    v_cvt_pk_bf16_f32 v124, v123, v123
    v_add_f32 v121, v121, v123
    s_nop 0
    v_and_b32_dpp v96, v124, v10 row_newbcast:0 row_mask:0xf bank_mask:0xf
    v_and_b32_dpp v97, v124, v11 row_newbcast:0 row_mask:0xf bank_mask:0xf
    v_and_b32_dpp v98, v124, v12 row_newbcast:0 row_mask:0xf bank_mask:0xf
    v_and_b32_dpp v99, v124, v13 row_newbcast:0 row_mask:0xf bank_mask:0xf
    v_and_b32_dpp v100, v124, v10 row_newbcast:4 row_mask:0xf bank_mask:0xf
    v_and_b32_dpp v101, v124, v11 row_newbcast:4 row_mask:0xf bank_mask:0xf
    v_and_b32_dpp v102, v124, v12 row_newbcast:4 row_mask:0xf bank_mask:0xf
    v_and_b32_dpp v103, v124, v13 row_newbcast:4 row_mask:0xf bank_mask:0xf
    v_and_b32_dpp v104, v124, v10 row_newbcast:8 row_mask:0xf bank_mask:0xf
    v_and_b32_dpp v105, v124, v11 row_newbcast:8 row_mask:0xf bank_mask:0xf
    v_and_b32_dpp v106, v124, v12 row_newbcast:8 row_mask:0xf bank_mask:0xf
    v_and_b32_dpp v107, v124, v13 row_newbcast:8 row_mask:0xf bank_mask:0xf
    v_and_b32_dpp v108, v124, v10 row_newbcast:12 row_mask:0xf bank_mask:0xf
    v_and_b32_dpp v109, v124, v11 row_newbcast:12 row_mask:0xf bank_mask:0xf
    v_and_b32_dpp v110, v124, v12 row_newbcast:12 row_mask:0xf bank_mask:0xf
    v_and_b32_dpp v111, v124, v13 row_newbcast:12 row_mask:0xf bank_mask:0xf
    s_waitcnt vmcnt(4)
    s_lshl_b32 s39, s34, 13
    s_add_u32 s39, s39, 98304
    s_mov_b32 m0, s39
    s_nop 0
    buffer_load_dwordx4 v20, s[40:43], s44 offen offset:0 nt lds
    v_mfma_f32_16x16x32_bf16 v[116:119], v[176:179], v[96:99], v[116:119]
    v_add_f32_dpp v121, v121, v121 row_ror:8 row_mask:0xf bank_mask:0xf
    s_nop 1
    v_add_f32_dpp v121, v121, v121 row_ror:4 row_mask:0xf bank_mask:0xf
    v_mov_b32 v125, v121
    s_nop 1
    v_permlane16_swap_b32 v121, v125
    v_add_f32 v121, v121, v125
    v_mov_b32 v125, v121
    s_nop 1
    v_permlane32_swap_b32 v121, v125
    v_add_f32 v121, v121, v125
    v_and_b32 v125, s82, v120
    v_sub_f32 v125, v120, v125
    s_mov_b32 vcc_lo, 0xff00ff00
    s_mov_b32 vcc_hi, 0xff00ff00
    s_waitcnt vmcnt(4)
    buffer_load_dwordx4 v21, s[40:43], s44 offen offset:1024 nt lds
    v_mfma_f32_16x16x32_bf16 v[116:119], v[180:183], v[100:103], v[116:119]
    s_waitcnt vmcnt(4)
    buffer_load_dwordx4 v22, s[40:43], s44 offen offset:2048 nt lds
    v_mfma_f32_16x16x32_bf16 v[116:119], v[184:187], v[104:107], v[116:119]
    s_waitcnt vmcnt(4)
    buffer_load_dwordx4 v23, s[40:43], s44 offen offset:3072 nt lds
    v_mfma_f32_16x16x32_bf16 v[116:119], v[188:191], v[108:111], v[116:119]
    s_branch L_bdone
L_last0:
    buffer_load_dwordx4 v[224:227], v34, s[48:51], s46 offen sc1
    s_mov_b32 s86, s44
    s_cmp_lt_u32 s33, 3
    s_cselect_b32 s44, 4194304, s44
    v_mfma_f32_16x16x32_bf16 v[112:115], v[128:131], v[80:83], 0
    s_waitcnt vmcnt(7)
    v_mfma_f32_16x16x32_bf16 v[112:115], v[132:135], v[84:87], v[112:115]
    s_waitcnt vmcnt(6)
    v_mfma_f32_16x16x32_bf16 v[112:115], v[136:139], v[88:91], v[112:115]
    s_waitcnt vmcnt(5)
    v_mfma_f32_16x16x32_bf16 v[112:115], v[140:143], v[92:95], v[112:115]
    s_nop 7
    v_mov_b32_dpp v122, v112 quad_perm:[0,0,0,0] row_mask:0xf bank_mask:0xf
    v_mov_b32_dpp v124, v114 quad_perm:[2,2,2,2] row_mask:0xf bank_mask:0xf
    s_nop 0
    v_add_f32_dpp v122, v113, v122 quad_perm:[1,1,1,1] row_mask:0xf bank_mask:0xf
    v_add_f32_dpp v124, v115, v124 quad_perm:[3,3,3,3] row_mask:0xf bank_mask:0xf
    v_add_f32 v122, v122, v124
    v_fma_f32 v123, v122, s83, -v120
    v_cmp_lt_f32 vcc, 0, v123
    s_cbranch_vccz L_nomax_11
    v_mul_f32 v122, s83, v122
    s_nop 1
    v_max_f32_dpp v124, v122, v122 row_ror:4 row_mask:0xf bank_mask:0xf
    s_nop 1
    v_max_f32_dpp v124, v124, v124 row_ror:8 row_mask:0xf bank_mask:0xf
    v_mov_b32 v125, v124
    s_nop 1
    v_permlane16_swap_b32 v124, v125
    v_max_f32 v124, v124, v125
    v_mov_b32 v125, v124
    s_nop 1
    v_permlane32_swap_b32 v124, v125
    v_max_f32 v124, v124, v125
    v_max_f32 v124, v124, v120
    v_sub_f32 v125, v120, v124
    v_exp_f32 v125, v125
    v_mov_b32 v120, v124
    v_sub_f32 v123, v122, v124
    v_mul_f32 v121, v121, v125
    v_mul_f32 v116, v116, v125
    v_mul_f32 v117, v117, v125
    v_mul_f32 v118, v118, v125
    v_mul_f32 v119, v119, v125
L_nomax_11:
    v_exp_f32 v123, v123
    s_nop 0
    v_cvt_pk_bf16_f32 v124, v123, v123
    v_add_f32 v121, v121, v123
    s_nop 0
    v_and_b32_dpp v96, v124, v10 row_newbcast:0 row_mask:0xf bank_mask:0xf
    v_and_b32_dpp v97, v124, v11 row_newbcast:0 row_mask:0xf bank_mask:0xf
    v_and_b32_dpp v98, v124, v12 row_newbcast:0 row_mask:0xf bank_mask:0xf
    v_and_b32_dpp v99, v124, v13 row_newbcast:0 row_mask:0xf bank_mask:0xf
    v_and_b32_dpp v100, v124, v10 row_newbcast:4 row_mask:0xf bank_mask:0xf
    v_and_b32_dpp v101, v124, v11 row_newbcast:4 row_mask:0xf bank_mask:0xf
    v_and_b32_dpp v102, v124, v12 row_newbcast:4 row_mask:0xf bank_mask:0xf
    v_and_b32_dpp v103, v124, v13 row_newbcast:4 row_mask:0xf bank_mask:0xf
    v_and_b32_dpp v104, v124, v10 row_newbcast:8 row_mask:0xf bank_mask:0xf
    v_and_b32_dpp v105, v124, v11 row_newbcast:8 row_mask:0xf bank_mask:0xf
    v_and_b32_dpp v106, v124, v12 row_newbcast:8 row_mask:0xf bank_mask:0xf
    v_and_b32_dpp v107, v124, v13 row_newbcast:8 row_mask:0xf bank_mask:0xf
    v_and_b32_dpp v108, v124, v10 row_newbcast:12 row_mask:0xf bank_mask:0xf
    v_and_b32_dpp v109, v124, v11 row_newbcast:12 row_mask:0xf bank_mask:0xf
    v_and_b32_dpp v110, v124, v12 row_newbcast:12 row_mask:0xf bank_mask:0xf
    v_and_b32_dpp v111, v124, v13 row_newbcast:12 row_mask:0xf bank_mask:0xf
    s_waitcnt vmcnt(4)
    s_lshl_b32 s39, s34, 13
    s_add_u32 s39, s39, 98304
    s_mov_b32 m0, s39
    s_nop 0
    buffer_load_dwordx4 v20, s[40:43], s44 offen offset:0 nt lds
    v_mfma_f32_16x16x32_bf16 v[116:119], v[144:147], v[96:99], v[116:119]
    v_add_f32_dpp v121, v121, v121 row_ror:8 row_mask:0xf bank_mask:0xf
    s_nop 1
    v_add_f32_dpp v121, v121, v121 row_ror:4 row_mask:0xf bank_mask:0xf
    v_mov_b32 v125, v121
    s_nop 1
    v_permlane16_swap_b32 v121, v125
    v_add_f32 v121, v121, v125
    v_mov_b32 v125, v121
    s_nop 1
    v_permlane32_swap_b32 v121, v125
    v_add_f32 v121, v121, v125
    v_and_b32 v125, s82, v120
    v_sub_f32 v125, v120, v125
    s_mov_b32 vcc_lo, 0xff00ff00
    s_mov_b32 vcc_hi, 0xff00ff00
    s_waitcnt vmcnt(4)
    buffer_load_dwordx4 v21, s[40:43], s44 offen offset:1024 nt lds
    v_mfma_f32_16x16x32_bf16 v[116:119], v[148:151], v[100:103], v[116:119]
    s_waitcnt vmcnt(4)
    buffer_load_dwordx4 v22, s[40:43], s44 offen offset:2048 nt lds
    v_mfma_f32_16x16x32_bf16 v[116:119], v[152:155], v[104:107], v[116:119]
    s_waitcnt vmcnt(4)
    buffer_load_dwordx4 v23, s[40:43], s44 offen offset:3072 nt lds
    v_mfma_f32_16x16x32_bf16 v[116:119], v[156:159], v[108:111], v[116:119]
L_bdone:
    s_nop 7
    v_cndmask_b32 v116, v116, v120, vcc
    v_cndmask_b32 v117, v117, v121, vcc
    v_cndmask_b32 v118, v118, v125, vcc
    v_and_or_b32 v119, v119, s82, v8
    v_and_or_b32 v116, v116, s82, v8
    v_and_or_b32 v117, v117, s82, v8
    v_and_or_b32 v118, v118, s82, v8
    s_mov_b32 exec_lo, 0xff01ff
    s_mov_b32 exec_hi, 0xff00ff
    buffer_store_dwordx4 v[116:119], v79, s[48:51], s96 offen sc1
    s_mov_b64 exec, -1
    s_cmp_lt_u32 s33, 3
    s_cbranch_scc1 L_ctx
    buffer_load_dwordx4 v[204:207], v53, s[48:51], s47 offen sc1
    buffer_load_dwordx4 v[192:195], v50, s[48:51], s47 offen sc1
    buffer_load_dwordx4 v[196:199], v51, s[48:51], s47 offen sc1
    buffer_load_dwordx4 v[200:203], v52, s[48:51], s47 offen sc1
    s_lshl_b32 s39, s34, 13
    s_add_u32 s39, s39, 102400
    s_mov_b32 m0, s39
    s_add_u32 s44, s44, 16384
    buffer_load_dwordx4 v20, s[40:43], s44 offen offset:0 nt lds
    buffer_load_dwordx4 v21, s[40:43], s44 offen offset:1024 nt lds
    buffer_load_dwordx4 v22, s[40:43], s44 offen offset:2048 nt lds
    buffer_load_dwordx4 v23, s[40:43], s44 offen offset:3072 nt lds
    v_xor_b32 v104, s35, v116
    v_xor_b32 v105, s35, v117
    v_xor_b32 v106, s35, v118
    v_xor_b32 v107, s35, v119
    v_mov_b32 v5, 0xff7f0000
    v_cndmask_b32 v120, v120, v5, vcc
    v_and_b32 v121, s82, v121
    s_mov_b32 s86, 0x88888888
    s_mov_b32 s87, 0x88888888
    s_waitcnt vmcnt(4)
L_hop1poll:
    v_xor_b32 v192, s35, v192
    v_xor_b32 v193, s35, v193
    v_xor_b32 v194, s35, v194
    v_xor_b32 v195, s35, v195
    v_xor_b32 v196, s35, v196
    v_xor_b32 v197, s35, v197
    v_xor_b32 v198, s35, v198
    v_xor_b32 v199, s35, v199
    v_xor_b32 v200, s35, v200
    v_xor_b32 v201, s35, v201
    v_xor_b32 v202, s35, v202
    v_xor_b32 v203, s35, v203
    v_xor_b32 v204, s35, v204
    v_xor_b32 v205, s35, v205
    v_xor_b32 v206, s35, v206
    v_xor_b32 v207, s35, v207
    v_or_b32 v4, v192, v193
    v_or3_b32 v4, v4, v194, v195
    v_or3_b32 v4, v4, v196, v197
    v_or3_b32 v4, v4, v198, v199
    v_or3_b32 v4, v4, v200, v201
    v_or3_b32 v4, v4, v202, v203
    v_or3_b32 v4, v4, v204, v205
    v_or3_b32 v4, v4, v206, v207
    v_and_b32 v4, 0xff, v4
    v_cmp_ne_u32 vcc, 0, v4
    v_add_f32 v122, v204, v206
    s_cbranch_vccz L_hop1ok
    buffer_load_dwordx4 v[204:207], v53, s[48:51], s47 offen sc1
    buffer_load_dwordx4 v[192:195], v50, s[48:51], s47 offen sc1
    buffer_load_dwordx4 v[196:199], v51, s[48:51], s47 offen sc1
    buffer_load_dwordx4 v[200:203], v52, s[48:51], s47 offen sc1
    s_waitcnt vmcnt(0)
    s_sub_u32 s84, s84, 1
    s_cmp_lg_u32 s84, 0
    s_cbranch_scc1 L_hop1poll
    s_branch L_end
L_ctx:
    s_mov_b32 s44, s86
    s_lshl_b32 s39, s34, 13
    s_add_u32 s39, s39, 98304
    s_mov_b32 m0, s39
    s_nop 0
    buffer_load_dwordx4 v20, s[40:43], s44 offen offset:0 nt lds
    buffer_load_dwordx4 v21, s[40:43], s44 offen offset:1024 nt lds
    buffer_load_dwordx4 v22, s[40:43], s44 offen offset:2048 nt lds
    buffer_load_dwordx4 v23, s[40:43], s44 offen offset:3072 nt lds
    s_lshl_b32 s39, s34, 13
    s_add_u32 s39, s39, 102400
    s_mov_b32 m0, s39
    s_add_u32 s44, s44, 16384
    buffer_load_dwordx4 v20, s[40:43], s44 offen offset:0 nt lds
    buffer_load_dwordx4 v21, s[40:43], s44 offen offset:1024 nt lds
    buffer_load_dwordx4 v22, s[40:43], s44 offen offset:2048 nt lds
    buffer_load_dwordx4 v23, s[40:43], s44 offen offset:3072 nt lds
    s_waitcnt vmcnt(9)
L_ctxcheck:
    v_xor_b32 v224, s35, v224
    v_xor_b32 v225, s35, v225
    v_xor_b32 v226, s35, v226
    v_xor_b32 v227, s35, v227
    v_or_b32 v4, v224, v225
    v_or3_b32 v4, v4, v226, v227
    v_and_b32 v4, 0xff, v4
    v_cmp_ne_u32 vcc, 0, v4
    s_cbranch_vccz L_ctxok
    buffer_load_dwordx4 v[224:227], v34, s[48:51], s46 offen sc1
    s_waitcnt vmcnt(0)
    s_sub_u32 s84, s84, 1
    s_cmp_lg_u32 s84, 0
    s_cbranch_scc1 L_ctxcheck
    s_branch L_end
L_ctxok:
    v_cvt_pk_bf16_f32 v224, v224, v225
    v_cvt_pk_bf16_f32 v225, v226, v227
    ds_write_b64 v35, v[224:225]
    s_branch L_final
L_hop1ok:
    v_cndmask_b32 v122, v122, v120, s[86:87]
    v_cndmask_b32 v123, v205, v121, s[86:87]
    s_nop 0
    v_max_f32_dpp v5, v122, v122 quad_perm:[1,0,3,2] row_mask:0xf bank_mask:0xf
    s_nop 1
    v_max_f32_dpp v5, v5, v5 quad_perm:[2,3,0,1] row_mask:0xf bank_mask:0xf
    s_nop 1
    v_max_f32_dpp v5, v5, v5 row_ror:8 row_mask:0xf bank_mask:0xf
    v_sub_f32 v122, v122, v5
    v_exp_f32 v122, v122
    s_nop 0
    v_mul_f32 v123, v123, v122
    v_mul_f32_dpp v104, v122, v104 quad_perm:[3,3,3,3] row_mask:0xf bank_mask:0xf
    v_mul_f32_dpp v105, v122, v105 quad_perm:[3,3,3,3] row_mask:0xf bank_mask:0xf
    v_mul_f32_dpp v106, v122, v106 quad_perm:[3,3,3,3] row_mask:0xf bank_mask:0xf
    v_mul_f32_dpp v107, v122, v107 quad_perm:[3,3,3,3] row_mask:0xf bank_mask:0xf
    v_add_f32_dpp v123, v123, v123 quad_perm:[1,0,3,2] row_mask:0xf bank_mask:0xf
    v_fmac_f32_dpp v104, v122, v192 quad_perm:[0,0,0,0] row_mask:0xf bank_mask:0xf
    v_fmac_f32_dpp v105, v122, v193 quad_perm:[0,0,0,0] row_mask:0xf bank_mask:0xf
    v_fmac_f32_dpp v106, v122, v194 quad_perm:[0,0,0,0] row_mask:0xf bank_mask:0xf
    v_fmac_f32_dpp v107, v122, v195 quad_perm:[0,0,0,0] row_mask:0xf bank_mask:0xf
    v_add_f32_dpp v123, v123, v123 quad_perm:[2,3,0,1] row_mask:0xf bank_mask:0xf
    v_fmac_f32_dpp v104, v122, v196 quad_perm:[1,1,1,1] row_mask:0xf bank_mask:0xf
    v_fmac_f32_dpp v105, v122, v197 quad_perm:[1,1,1,1] row_mask:0xf bank_mask:0xf
    v_fmac_f32_dpp v106, v122, v198 quad_perm:[1,1,1,1] row_mask:0xf bank_mask:0xf
    v_fmac_f32_dpp v107, v122, v199 quad_perm:[1,1,1,1] row_mask:0xf bank_mask:0xf
    v_add_f32_dpp v123, v123, v123 row_ror:8 row_mask:0xf bank_mask:0xf
    v_fmac_f32_dpp v104, v122, v200 quad_perm:[2,2,2,2] row_mask:0xf bank_mask:0xf
    v_fmac_f32_dpp v105, v122, v201 quad_perm:[2,2,2,2] row_mask:0xf bank_mask:0xf
    v_fmac_f32_dpp v106, v122, v202 quad_perm:[2,2,2,2] row_mask:0xf bank_mask:0xf
    v_fmac_f32_dpp v107, v122, v203 quad_perm:[2,2,2,2] row_mask:0xf bank_mask:0xf
    v_rcp_f32 v123, v123
    v_add_f32_dpp v104, v104, v104 row_ror:8 row_mask:0xf bank_mask:0xf
    v_add_f32_dpp v105, v105, v105 row_ror:8 row_mask:0xf bank_mask:0xf
    v_add_f32_dpp v106, v106, v106 row_ror:8 row_mask:0xf bank_mask:0xf
    v_add_f32_dpp v107, v107, v107 row_ror:8 row_mask:0xf bank_mask:0xf
    v_mul_f32 v104, v104, v123
    v_mul_f32 v105, v105, v123
    v_mul_f32 v106, v106, v123
    v_mul_f32 v107, v107, v123
    v_cvt_pk_bf16_f32 v104, v104, v105
    v_cvt_pk_bf16_f32 v106, v106, v107
    s_mov_b32 exec_lo, 0xff00ff
    s_mov_b32 exec_hi, 0xff00ff
    ds_write_b16 v31, v104
    ds_write_b16_d16_hi v31, v104 offset:16
    ds_write_b16 v31, v106 offset:32
    ds_write_b16_d16_hi v31, v106 offset:48
    s_mov_b64 exec, -1
L_final:
    s_waitcnt vmcnt(0) lgkmcnt(0)
    s_barrier
    ds_read_b64_tr_b16 v[128:129], v24 offset:0
    ds_read_b64_tr_b16 v[130:131], v25 offset:1024
    ds_read_b128 v[160:163], v28 offset:0
    ds_read_b64_tr_b16 v[132:133], v24 offset:8192
    ds_read_b64_tr_b16 v[134:135], v25 offset:9216
    ds_read_b128 v[164:167], v28 offset:64
    ds_read_b64_tr_b16 v[136:137], v24 offset:16384
    ds_read_b64_tr_b16 v[138:139], v25 offset:17408
    ds_read_b128 v[168:171], v28 offset:128
    ds_read_b64_tr_b16 v[140:141], v24 offset:24576
    ds_read_b64_tr_b16 v[142:143], v25 offset:25600
    ds_read_b128 v[172:175], v28 offset:192
    ds_read_b64_tr_b16 v[144:145], v26 offset:0
    ds_read_b64_tr_b16 v[146:147], v27 offset:1024
    ds_read_b128 v[176:179], v29 offset:0
    s_waitcnt lgkmcnt(12)
    v_mfma_f32_16x16x32_bf16 v[112:115], v[128:131], v[160:163], 0
    ds_read_b64_tr_b16 v[148:149], v26 offset:8192
    ds_read_b64_tr_b16 v[150:151], v27 offset:9216
    ds_read_b128 v[180:183], v29 offset:64
    s_waitcnt lgkmcnt(12)
    v_mfma_f32_16x16x32_bf16 v[112:115], v[132:135], v[164:167], v[112:115]
    ds_read_b64_tr_b16 v[152:153], v26 offset:16384
    ds_read_b64_tr_b16 v[154:155], v27 offset:17408
    ds_read_b128 v[184:187], v29 offset:128
    s_waitcnt lgkmcnt(12)
    v_mfma_f32_16x16x32_bf16 v[112:115], v[136:139], v[168:171], v[112:115]
    ds_read_b64_tr_b16 v[156:157], v26 offset:24576
    ds_read_b64_tr_b16 v[158:159], v27 offset:25600
    ds_read_b128 v[188:191], v29 offset:192
    s_waitcnt lgkmcnt(12)
    v_mfma_f32_16x16x32_bf16 v[112:115], v[140:143], v[172:175], v[112:115]
    s_waitcnt lgkmcnt(9)
    v_mfma_f32_16x16x32_bf16 v[112:115], v[144:147], v[176:179], v[112:115]
    s_waitcnt lgkmcnt(6)
    v_mfma_f32_16x16x32_bf16 v[112:115], v[148:151], v[180:183], v[112:115]
    s_waitcnt lgkmcnt(3)
    v_mfma_f32_16x16x32_bf16 v[112:115], v[152:155], v[184:187], v[112:115]
    s_waitcnt lgkmcnt(0)
    v_mfma_f32_16x16x32_bf16 v[112:115], v[156:159], v[188:191], v[112:115]
    s_cmp_eq_u32 s33, 0
    s_cselect_b32 s36, 0, 262144
    s_cselect_b32 s39, 0, 1024
    s_add_u32 s36, s36, 524288
    s_add_u32 s37, s36, 4096
    s_mov_b32 exec_lo, 0xff00ff
    s_mov_b32 exec_hi, 0xff00ff
    s_nop 0
    v_and_or_b32 v112, v112, s82, v8
    v_and_or_b32 v113, v113, s82, v8
    v_and_or_b32 v114, v114, s82, v8
    v_and_or_b32 v115, v115, s82, v8
    buffer_store_dwordx4 v[112:115], v30, s[48:51], s45 offen sc1
    s_mov_b64 exec, -1
    s_sub_u32 s38, s33, 1
    s_cmp_lt_u32 s38, 6
    s_cbranch_scc1 L_done
L_hop2:
    buffer_load_dwordx4 v[224:227], v32, s[48:51], s36 offen sc1
    buffer_load_dwordx4 v[228:231], v32, s[48:51], s37 offen sc1
    s_waitcnt vmcnt(0)
    v_xor_b32 v224, s35, v224
    v_xor_b32 v225, s35, v225
    v_xor_b32 v226, s35, v226
    v_xor_b32 v227, s35, v227
    v_xor_b32 v228, s35, v228
    v_xor_b32 v229, s35, v229
    v_xor_b32 v230, s35, v230
    v_xor_b32 v231, s35, v231
    v_or_b32 v4, v224, v225
    v_or3_b32 v4, v4, v226, v227
    v_or3_b32 v4, v4, v228, v229
    v_or3_b32 v4, v4, v230, v231
    v_and_b32 v4, 0xff, v4
    v_cmp_ne_u32 vcc, 0, v4
    v_add_f32 v232, v224, v228
    v_add_f32 v233, v225, v229
    v_add_f32 v234, v226, v230
    v_add_f32 v235, v227, v231
    s_cbranch_vccz L_hop2ok
    s_sub_u32 s84, s84, 1
    s_cmp_lg_u32 s84, 0
    s_cbranch_scc1 L_hop2
    s_branch L_end
L_hop2ok:
    v_permlane16_swap_b32 v232, v233
    v_permlane16_swap_b32 v234, v235
    v_add_f32 v232, v232, v233
    v_add_f32 v234, v234, v235
    s_nop 1
    v_permlane32_swap_b32 v232, v234
    v_add_f32 v232, v232, v234
    s_nop 1
    v_add_f32_dpp v232, v232, v232 row_ror:8 row_mask:0xf bank_mask:0xf
    s_nop 1
    v_add_f32_dpp v232, v232, v232 row_ror:4 row_mask:0xf bank_mask:0xf
    v_cvt_pk_bf16_f32 v232, v232, v232
    s_mov_b32 exec_lo, 0xf000f
    s_mov_b32 exec_hi, 0xf000f
    buffer_store_short v232, v33, s[72:75], s39 offen
    s_or_b32 s36, s2, s34
    s_cmp_lg_u32 s36, 0
    s_cbranch_scc1 L_done
    v_mov_b32 v4, 0
    s_mov_b64 exec, 1
    buffer_store_dword v8, v4, s[48:51], 0 offen
L_done:
L_end:
    s_endpgm
L_qp:
    v_lshlrev_b32 v4, 18, v2
    v_lshl_add_u32 v14, v3, 4, v4
    v_lshrrev_b32 v5, 3, v3
    v_lshlrev_b32 v5, 10, v5
    v_lshl_add_u32 v15, v2, 6, v5
    s_cmp_eq_u32 s33, 0
    s_cselect_b32 s61, 3, 2
    s_xor_b32 s61, s61, s32
    s_lshl_b32 s86, s34, 8
    s_lshl_b32 s63, s34, 20
    s_lshl_b32 s38, s61, 8
    s_add_u32 s63, s63, s38
    s_mov_b32 s42, 4194304
    s_mov_b32 s43, 0x20000
    s_mov_b32 s46, 4096
    s_mov_b32 s47, 0x20000
    s_cmp_eq_u32 s33, 0
    s_waitcnt lgkmcnt(0)
    s_cselect_b64 s[40:41], s[22:23], s[8:9]
    s_cselect_b64 s[44:45], s[16:17], s[4:5]
    buffer_load_dwordx4 a[128:131], v14, s[40:43], s63 offen nt
    s_add_u32 s63, s63, 8192
    buffer_load_dwordx4 a[132:135], v14, s[40:43], s63 offen nt
    s_add_u32 s63, s63, 8192
    buffer_load_dwordx4 v[20:23], v15, s[44:47], s86 offen offset:0
    buffer_load_dwordx4 v[36:39], v15, s[44:47], s86 offen offset:2048
    buffer_load_dwordx4 a[136:139], v14, s[40:43], s63 offen nt
    s_add_u32 s63, s63, 8192
    buffer_load_dwordx4 a[140:143], v14, s[40:43], s63 offen nt
    s_add_u32 s63, s63, 8192
    buffer_load_dwordx4 a[144:147], v14, s[40:43], s63 offen nt
    s_add_u32 s63, s63, 8192
    buffer_load_dwordx4 a[148:151], v14, s[40:43], s63 offen nt
    s_add_u32 s63, s63, 8192
    buffer_load_dwordx4 a[152:155], v14, s[40:43], s63 offen nt
    s_add_u32 s63, s63, 8192
    buffer_load_dwordx4 a[156:159], v14, s[40:43], s63 offen nt
    s_add_u32 s63, s63, 8192
    s_load_dword s35, s[30:31], 0
    s_mov_b32 s48, s30
    s_and_b32 s49, s31, 0xffff
    s_mov_b32 s50, 8388608
    s_mov_b32 s51, 0x20000
    s_mov_b32 s82, 0xffffff00
    s_mov_b32 s83, 0x3e0293ee
    s_mov_b32 s84, 2097152
    v_and_b32 v4, 1, v1
    v_lshlrev_b32 v4, 4, v4
    v_mov_b32 v5, 0xffff
    v_lshlrev_b32 v4, v4, v5
    v_bfe_u32 v5, v1, 1, 2
    v_cmp_eq_u32 vcc, 0, v5
    s_nop 1
    v_cndmask_b32 v10, 0, v4, vcc
    v_cmp_eq_u32 vcc, 1, v5
    s_nop 1
    v_cndmask_b32 v11, 0, v4, vcc
    v_cmp_eq_u32 vcc, 2, v5
    s_nop 1
    v_cndmask_b32 v12, 0, v4, vcc
    v_cmp_eq_u32 vcc, 3, v5
    s_nop 1
    v_cndmask_b32 v13, 0, v4, vcc
    buffer_load_dwordx4 v[24:27], v15, s[44:47], s86 offen offset:16
    buffer_load_dwordx4 v[40:43], v15, s[44:47], s86 offen offset:2064
    buffer_load_dwordx4 v[28:31], v15, s[44:47], s86 offen offset:32
    buffer_load_dwordx4 v[44:47], v15, s[44:47], s86 offen offset:2080
    buffer_load_dwordx4 v[32:35], v15, s[44:47], s86 offen offset:48
    buffer_load_dwordx4 v[48:51], v15, s[44:47], s86 offen offset:2096
    s_lshl_b32 s38, s61, 10
    s_add_u32 s36, s38, 65536
    s_lshl_b32 s38, s34, 8
    s_add_u32 s36, s38, s36
    v_mov_b32 v19, 0
    s_cmp_eq_u32 s33, 0
    s_cselect_b32 s38, s36, 8388608
    s_mov_b64 exec, 1
    buffer_store_dword v19, v19, s[48:51], s38 offen sc1
    s_mov_b64 exec, -1
    s_mov_b32 s80, 0x01000100
    s_mov_b32 s81, 0x03020302
    s_waitcnt vmcnt(13)
    buffer_load_dwordx4 a[160:163], v14, s[40:43], s63 offen nt
    s_add_u32 s63, s63, 8192
    v_perm_b32 v4, v20, v20, s80
    v_perm_b32 v5, v36, v36, s80
    v_and_b32 v52, v4, v10
    v_and_b32 v53, v4, v11
    v_and_b32 v54, v4, v12
    v_and_b32 v55, v4, v13
    v_and_b32 v56, v5, v10
    v_and_b32 v57, v5, v11
    v_and_b32 v58, v5, v12
    v_and_b32 v59, v5, v13
    v_mfma_f32_16x16x32_bf16 v[60:63], a[128:131], v[52:55], 0
    s_nop 0
    v_mfma_f32_16x16x32_bf16 v[64:67], a[128:131], v[56:59], 0
    buffer_load_dwordx4 a[164:167], v14, s[40:43], s63 offen nt
    s_add_u32 s63, s63, 8192
    v_perm_b32 v4, v20, v20, s81
    v_perm_b32 v5, v36, v36, s81
    v_and_b32 v52, v4, v10
    v_and_b32 v53, v4, v11
    v_and_b32 v54, v4, v12
    v_and_b32 v55, v4, v13
    v_and_b32 v56, v5, v10
    v_and_b32 v57, v5, v11
    v_and_b32 v58, v5, v12
    v_and_b32 v59, v5, v13
    v_mfma_f32_16x16x32_bf16 v[60:63], a[132:135], v[52:55], v[60:63]
    s_nop 0
    v_mfma_f32_16x16x32_bf16 v[64:67], a[132:135], v[56:59], v[64:67]
    s_waitcnt vmcnt(14)
    buffer_load_dwordx4 a[168:171], v14, s[40:43], s63 offen nt
    s_add_u32 s63, s63, 8192
    v_perm_b32 v4, v21, v21, s80
    v_perm_b32 v5, v37, v37, s80
    v_and_b32 v52, v4, v10
    v_and_b32 v53, v4, v11
    v_and_b32 v54, v4, v12
    v_and_b32 v55, v4, v13
    v_and_b32 v56, v5, v10
    v_and_b32 v57, v5, v11
    v_and_b32 v58, v5, v12
    v_and_b32 v59, v5, v13
    v_mfma_f32_16x16x32_bf16 v[60:63], a[136:139], v[52:55], v[60:63]
    s_nop 0
    v_mfma_f32_16x16x32_bf16 v[64:67], a[136:139], v[56:59], v[64:67]
    s_waitcnt vmcnt(14)
    buffer_load_dwordx4 a[172:175], v14, s[40:43], s63 offen nt
    s_add_u32 s63, s63, 8192
    v_perm_b32 v4, v21, v21, s81
    v_perm_b32 v5, v37, v37, s81
    v_and_b32 v52, v4, v10
    v_and_b32 v53, v4, v11
    v_and_b32 v54, v4, v12
    v_and_b32 v55, v4, v13
    v_and_b32 v56, v5, v10
    v_and_b32 v57, v5, v11
    v_and_b32 v58, v5, v12
    v_and_b32 v59, v5, v13
    v_mfma_f32_16x16x32_bf16 v[60:63], a[140:143], v[52:55], v[60:63]
    s_nop 0
    v_mfma_f32_16x16x32_bf16 v[64:67], a[140:143], v[56:59], v[64:67]
    s_waitcnt vmcnt(14)
    buffer_load_dwordx4 a[176:179], v14, s[40:43], s63 offen nt
    s_add_u32 s63, s63, 8192
    v_lshrrev_b32 v4, 2, v3
    v_and_b32 v5, 3, v3
    v_lshlrev_b32 v76, 8, v4
    v_lshlrev_b32 v126, 8, v2
    v_lshl_add_u32 v76, v2, 6, v76
    v_lshl_add_u32 v76, v5, 4, v76
    v_lshl_add_u32 v126, v3, 4, v126
    v_xor_b32 v77, 32768, v76
    v_xor_b32 v127, 32768, v126
    s_add_u32 s3, s34, s33
    s_and_b32 s3, s3, 3
    s_lshl_b32 s89, s3, 5
    s_add_u32 s89, s89, s32
    s_lshl_b32 s89, s89, 20
    s_mul_i32 s88, s32, 8
    s_add_u32 s88, s88, s3
    s_lshl_b32 s87, s33, 0
    v_perm_b32 v4, v22, v22, s80
    v_perm_b32 v5, v38, v38, s80
    v_and_b32 v52, v4, v10
    v_and_b32 v53, v4, v11
    v_and_b32 v54, v4, v12
    v_and_b32 v55, v4, v13
    v_and_b32 v56, v5, v10
    v_and_b32 v57, v5, v11
    v_and_b32 v58, v5, v12
    v_and_b32 v59, v5, v13
    v_mfma_f32_16x16x32_bf16 v[60:63], a[144:147], v[52:55], v[60:63]
    s_nop 0
    v_mfma_f32_16x16x32_bf16 v[64:67], a[144:147], v[56:59], v[64:67]
    s_waitcnt vmcnt(14)
    buffer_load_dwordx4 a[180:183], v14, s[40:43], s63 offen nt
    s_add_u32 s63, s63, 8192
    v_perm_b32 v4, v22, v22, s81
    v_perm_b32 v5, v38, v38, s81
    v_and_b32 v52, v4, v10
    v_and_b32 v53, v4, v11
    v_and_b32 v54, v4, v12
    v_and_b32 v55, v4, v13
    v_and_b32 v56, v5, v10
    v_and_b32 v57, v5, v11
    v_and_b32 v58, v5, v12
    v_and_b32 v59, v5, v13
    v_mfma_f32_16x16x32_bf16 v[60:63], a[148:151], v[52:55], v[60:63]
    s_nop 0
    v_mfma_f32_16x16x32_bf16 v[64:67], a[148:151], v[56:59], v[64:67]
    s_waitcnt vmcnt(14)
    buffer_load_dwordx4 a[184:187], v14, s[40:43], s63 offen nt
    s_add_u32 s63, s63, 8192
    v_perm_b32 v4, v23, v23, s80
    v_perm_b32 v5, v39, v39, s80
    v_and_b32 v52, v4, v10
    v_and_b32 v53, v4, v11
    v_and_b32 v54, v4, v12
    v_and_b32 v55, v4, v13
    v_and_b32 v56, v5, v10
    v_and_b32 v57, v5, v11
    v_and_b32 v58, v5, v12
    v_and_b32 v59, v5, v13
    v_mfma_f32_16x16x32_bf16 v[60:63], a[152:155], v[52:55], v[60:63]
    s_nop 0
    v_mfma_f32_16x16x32_bf16 v[64:67], a[152:155], v[56:59], v[64:67]
    s_waitcnt vmcnt(14)
    buffer_load_dwordx4 a[188:191], v14, s[40:43], s63 offen nt
    s_add_u32 s63, s63, 8192
    v_perm_b32 v4, v23, v23, s81
    v_perm_b32 v5, v39, v39, s81
    v_and_b32 v52, v4, v10
    v_and_b32 v53, v4, v11
    v_and_b32 v54, v4, v12
    v_and_b32 v55, v4, v13
    v_and_b32 v56, v5, v10
    v_and_b32 v57, v5, v11
    v_and_b32 v58, v5, v12
    v_and_b32 v59, v5, v13
    v_mfma_f32_16x16x32_bf16 v[60:63], a[156:159], v[52:55], v[60:63]
    s_nop 0
    v_mfma_f32_16x16x32_bf16 v[64:67], a[156:159], v[56:59], v[64:67]
    s_waitcnt vmcnt(13)
    s_waitcnt vmcnt(7)
    buffer_load_dwordx4 a[192:195], v14, s[40:43], s63 offen nt
    s_add_u32 s63, s63, 8192
    s_mov_b32 s52, s18
    s_and_b32 s53, s19, 0xffff
    s_mov_b32 s54, 134217728
    s_mov_b32 s55, 0x20000
    s_mov_b32 s56, s20
    s_and_b32 s57, s21, 0xffff
    s_mov_b32 s58, 134217728
    s_mov_b32 s59, 0x20000
    v_perm_b32 v4, v24, v24, s80
    v_perm_b32 v5, v40, v40, s80
    v_and_b32 v52, v4, v10
    v_and_b32 v53, v4, v11
    v_and_b32 v54, v4, v12
    v_and_b32 v55, v4, v13
    v_and_b32 v56, v5, v10
    v_and_b32 v57, v5, v11
    v_and_b32 v58, v5, v12
    v_and_b32 v59, v5, v13
    v_mfma_f32_16x16x32_bf16 v[60:63], a[160:163], v[52:55], v[60:63]
    s_nop 0
    v_mfma_f32_16x16x32_bf16 v[64:67], a[160:163], v[56:59], v[64:67]
    s_waitcnt vmcnt(7)
    buffer_load_dwordx4 a[196:199], v14, s[40:43], s63 offen nt
    s_add_u32 s63, s63, 8192
    v_perm_b32 v4, v24, v24, s81
    v_perm_b32 v5, v40, v40, s81
    v_and_b32 v52, v4, v10
    v_and_b32 v53, v4, v11
    v_and_b32 v54, v4, v12
    v_and_b32 v55, v4, v13
    v_and_b32 v56, v5, v10
    v_and_b32 v57, v5, v11
    v_and_b32 v58, v5, v12
    v_and_b32 v59, v5, v13
    v_mfma_f32_16x16x32_bf16 v[60:63], a[164:167], v[52:55], v[60:63]
    s_nop 0
    v_mfma_f32_16x16x32_bf16 v[64:67], a[164:167], v[56:59], v[64:67]
    s_waitcnt vmcnt(7)
    buffer_load_dwordx4 a[200:203], v14, s[40:43], s63 offen nt
    s_add_u32 s63, s63, 8192
    v_perm_b32 v4, v25, v25, s80
    v_perm_b32 v5, v41, v41, s80
    v_and_b32 v52, v4, v10
    v_and_b32 v53, v4, v11
    v_and_b32 v54, v4, v12
    v_and_b32 v55, v4, v13
    v_and_b32 v56, v5, v10
    v_and_b32 v57, v5, v11
    v_and_b32 v58, v5, v12
    v_and_b32 v59, v5, v13
    v_mfma_f32_16x16x32_bf16 v[60:63], a[168:171], v[52:55], v[60:63]
    s_nop 0
    v_mfma_f32_16x16x32_bf16 v[64:67], a[168:171], v[56:59], v[64:67]
    s_waitcnt vmcnt(7)
    buffer_load_dwordx4 a[204:207], v14, s[40:43], s63 offen nt
    s_add_u32 s63, s63, 8192
    v_perm_b32 v4, v25, v25, s81
    v_perm_b32 v5, v41, v41, s81
    v_and_b32 v52, v4, v10
    v_and_b32 v53, v4, v11
    v_and_b32 v54, v4, v12
    v_and_b32 v55, v4, v13
    v_and_b32 v56, v5, v10
    v_and_b32 v57, v5, v11
    v_and_b32 v58, v5, v12
    v_and_b32 v59, v5, v13
    v_mfma_f32_16x16x32_bf16 v[60:63], a[172:175], v[52:55], v[60:63]
    s_nop 0
    v_mfma_f32_16x16x32_bf16 v[64:67], a[172:175], v[56:59], v[64:67]
    s_waitcnt vmcnt(7)
    buffer_load_dwordx4 a[208:211], v14, s[40:43], s63 offen nt
    s_add_u32 s63, s63, 8192
    v_mov_b32 v120, 0xff7f0000
    v_mov_b32 v121, 0
    v_mov_b32 v18, 1
    v_mov_b32 v116, 0
    v_mov_b32 v117, 0
    v_mov_b32 v118, 0
    v_mov_b32 v119, 0
    s_lshl_b32 s38, s32, 10
    s_add_u32 s96, s38, 65536
    s_lshl_b32 s38, s3, 8
    s_add_u32 s96, s38, s96
    v_mov_b32 v9, s96
    s_lshl_b32 s38, s32, 15
    s_add_u32 s96, s38, 1048576
    s_lshl_b32 s38, s3, 13
    s_add_u32 s96, s38, s96
    s_lshl_b32 s38, s33, 10
    s_add_u32 s96, s38, s96
    v_and_b32 v5, 3, v3
    v_lshlrev_b32 v78, 7, v2
    v_lshl_add_u32 v78, v5, 5, v78
    s_lshl_b32 s38, s32, 12
    s_add_u32 s91, s38, 262144
    s_lshl_b32 s38, s3, 9
    s_add_u32 s91, s38, s91
    v_lshlrev_b32 v4, 7, v2
    v_lshl_add_u32 v4, v3, 4, v4
    v_mov_b32 v5, 512
    v_cmp_gt_u32 vcc, 8, v3
    s_nop 1
    v_cndmask_b32 v79, v5, v4, vcc
    v_perm_b32 v4, v26, v26, s80
    v_perm_b32 v5, v42, v42, s80
    v_and_b32 v52, v4, v10
    v_and_b32 v53, v4, v11
    v_and_b32 v54, v4, v12
    v_and_b32 v55, v4, v13
    v_and_b32 v56, v5, v10
    v_and_b32 v57, v5, v11
    v_and_b32 v58, v5, v12
    v_and_b32 v59, v5, v13
    v_mfma_f32_16x16x32_bf16 v[60:63], a[176:179], v[52:55], v[60:63]
    s_nop 0
    v_mfma_f32_16x16x32_bf16 v[64:67], a[176:179], v[56:59], v[64:67]
    s_waitcnt vmcnt(7)
    buffer_load_dwordx4 a[212:215], v14, s[40:43], s63 offen nt
    s_add_u32 s63, s63, 8192
    v_perm_b32 v4, v26, v26, s81
    v_perm_b32 v5, v42, v42, s81
    v_and_b32 v52, v4, v10
    v_and_b32 v53, v4, v11
    v_and_b32 v54, v4, v12
    v_and_b32 v55, v4, v13
    v_and_b32 v56, v5, v10
    v_and_b32 v57, v5, v11
    v_and_b32 v58, v5, v12
    v_and_b32 v59, v5, v13
    v_mfma_f32_16x16x32_bf16 v[60:63], a[180:183], v[52:55], v[60:63]
    s_nop 0
    v_mfma_f32_16x16x32_bf16 v[64:67], a[180:183], v[56:59], v[64:67]
    s_waitcnt vmcnt(7)
    buffer_load_dwordx4 a[216:219], v14, s[40:43], s63 offen nt
    s_add_u32 s63, s63, 8192
    v_perm_b32 v4, v27, v27, s80
    v_perm_b32 v5, v43, v43, s80
    v_and_b32 v52, v4, v10
    v_and_b32 v53, v4, v11
    v_and_b32 v54, v4, v12
    v_and_b32 v55, v4, v13
    v_and_b32 v56, v5, v10
    v_and_b32 v57, v5, v11
    v_and_b32 v58, v5, v12
    v_and_b32 v59, v5, v13
    v_mfma_f32_16x16x32_bf16 v[60:63], a[184:187], v[52:55], v[60:63]
    s_nop 0
    v_mfma_f32_16x16x32_bf16 v[64:67], a[184:187], v[56:59], v[64:67]
    s_waitcnt vmcnt(7)
    buffer_load_dwordx4 a[220:223], v14, s[40:43], s63 offen nt
    s_add_u32 s63, s63, 8192
    v_perm_b32 v4, v27, v27, s81
    v_perm_b32 v5, v43, v43, s81
    v_and_b32 v52, v4, v10
    v_and_b32 v53, v4, v11
    v_and_b32 v54, v4, v12
    v_and_b32 v55, v4, v13
    v_and_b32 v56, v5, v10
    v_and_b32 v57, v5, v11
    v_and_b32 v58, v5, v12
    v_and_b32 v59, v5, v13
    v_mfma_f32_16x16x32_bf16 v[60:63], a[188:191], v[52:55], v[60:63]
    s_nop 0
    v_mfma_f32_16x16x32_bf16 v[64:67], a[188:191], v[56:59], v[64:67]
    s_waitcnt vmcnt(7)
    buffer_load_dwordx4 a[224:227], v14, s[40:43], s63 offen nt
    s_add_u32 s63, s63, 8192
    v_perm_b32 v4, v28, v28, s80
    v_perm_b32 v5, v44, v44, s80
    v_and_b32 v52, v4, v10
    v_and_b32 v53, v4, v11
    v_and_b32 v54, v4, v12
    v_and_b32 v55, v4, v13
    v_and_b32 v56, v5, v10
    v_and_b32 v57, v5, v11
    v_and_b32 v58, v5, v12
    v_and_b32 v59, v5, v13
    v_mfma_f32_16x16x32_bf16 v[60:63], a[192:195], v[52:55], v[60:63]
    s_nop 0
    v_mfma_f32_16x16x32_bf16 v[64:67], a[192:195], v[56:59], v[64:67]
    s_waitcnt vmcnt(7)
    buffer_load_dwordx4 a[228:231], v14, s[40:43], s63 offen nt
    s_add_u32 s63, s63, 8192
    v_perm_b32 v4, v28, v28, s81
    v_perm_b32 v5, v44, v44, s81
    v_and_b32 v52, v4, v10
    v_and_b32 v53, v4, v11
    v_and_b32 v54, v4, v12
    v_and_b32 v55, v4, v13
    v_and_b32 v56, v5, v10
    v_and_b32 v57, v5, v11
    v_and_b32 v58, v5, v12
    v_and_b32 v59, v5, v13
    v_mfma_f32_16x16x32_bf16 v[60:63], a[196:199], v[52:55], v[60:63]
    s_nop 0
    v_mfma_f32_16x16x32_bf16 v[64:67], a[196:199], v[56:59], v[64:67]
    s_waitcnt vmcnt(7)
    buffer_load_dwordx4 a[232:235], v14, s[40:43], s63 offen nt
    s_add_u32 s63, s63, 8192
    v_perm_b32 v4, v29, v29, s80
    v_perm_b32 v5, v45, v45, s80
    v_and_b32 v52, v4, v10
    v_and_b32 v53, v4, v11
    v_and_b32 v54, v4, v12
    v_and_b32 v55, v4, v13
    v_and_b32 v56, v5, v10
    v_and_b32 v57, v5, v11
    v_and_b32 v58, v5, v12
    v_and_b32 v59, v5, v13
    v_mfma_f32_16x16x32_bf16 v[60:63], a[200:203], v[52:55], v[60:63]
    s_nop 0
    v_mfma_f32_16x16x32_bf16 v[64:67], a[200:203], v[56:59], v[64:67]
    s_waitcnt vmcnt(7)
    buffer_load_dwordx4 a[236:239], v14, s[40:43], s63 offen nt
    s_add_u32 s63, s63, 8192
    v_perm_b32 v4, v29, v29, s81
    v_perm_b32 v5, v45, v45, s81
    v_and_b32 v52, v4, v10
    v_and_b32 v53, v4, v11
    v_and_b32 v54, v4, v12
    v_and_b32 v55, v4, v13
    v_and_b32 v56, v5, v10
    v_and_b32 v57, v5, v11
    v_and_b32 v58, v5, v12
    v_and_b32 v59, v5, v13
    v_mfma_f32_16x16x32_bf16 v[60:63], a[204:207], v[52:55], v[60:63]
    s_nop 0
    v_mfma_f32_16x16x32_bf16 v[64:67], a[204:207], v[56:59], v[64:67]
    s_waitcnt vmcnt(7)
    buffer_load_dwordx4 a[240:243], v14, s[40:43], s63 offen nt
    s_add_u32 s63, s63, 8192
    v_perm_b32 v4, v30, v30, s80
    v_perm_b32 v5, v46, v46, s80
    v_and_b32 v52, v4, v10
    v_and_b32 v53, v4, v11
    v_and_b32 v54, v4, v12
    v_and_b32 v55, v4, v13
    v_and_b32 v56, v5, v10
    v_and_b32 v57, v5, v11
    v_and_b32 v58, v5, v12
    v_and_b32 v59, v5, v13
    v_mfma_f32_16x16x32_bf16 v[60:63], a[208:211], v[52:55], v[60:63]
    s_nop 0
    v_mfma_f32_16x16x32_bf16 v[64:67], a[208:211], v[56:59], v[64:67]
    s_waitcnt vmcnt(7)
    buffer_load_dwordx4 a[244:247], v14, s[40:43], s63 offen nt
    s_add_u32 s63, s63, 8192
    v_perm_b32 v4, v30, v30, s81
    v_perm_b32 v5, v46, v46, s81
    v_and_b32 v52, v4, v10
    v_and_b32 v53, v4, v11
    v_and_b32 v54, v4, v12
    v_and_b32 v55, v4, v13
    v_and_b32 v56, v5, v10
    v_and_b32 v57, v5, v11
    v_and_b32 v58, v5, v12
    v_and_b32 v59, v5, v13
    v_mfma_f32_16x16x32_bf16 v[60:63], a[212:215], v[52:55], v[60:63]
    s_nop 0
    v_mfma_f32_16x16x32_bf16 v[64:67], a[212:215], v[56:59], v[64:67]
    s_waitcnt vmcnt(7)
    buffer_load_dwordx4 a[248:251], v14, s[40:43], s63 offen nt
    s_add_u32 s63, s63, 8192
    v_perm_b32 v4, v31, v31, s80
    v_perm_b32 v5, v47, v47, s80
    v_and_b32 v52, v4, v10
    v_and_b32 v53, v4, v11
    v_and_b32 v54, v4, v12
    v_and_b32 v55, v4, v13
    v_and_b32 v56, v5, v10
    v_and_b32 v57, v5, v11
    v_and_b32 v58, v5, v12
    v_and_b32 v59, v5, v13
    v_mfma_f32_16x16x32_bf16 v[60:63], a[216:219], v[52:55], v[60:63]
    s_nop 0
    v_mfma_f32_16x16x32_bf16 v[64:67], a[216:219], v[56:59], v[64:67]
    s_waitcnt vmcnt(7)
    buffer_load_dwordx4 a[252:255], v14, s[40:43], s63 offen nt
    s_add_u32 s63, s63, 8192
    v_perm_b32 v4, v31, v31, s81
    v_perm_b32 v5, v47, v47, s81
    v_and_b32 v52, v4, v10
    v_and_b32 v53, v4, v11
    v_and_b32 v54, v4, v12
    v_and_b32 v55, v4, v13
    v_and_b32 v56, v5, v10
    v_and_b32 v57, v5, v11
    v_and_b32 v58, v5, v12
    v_and_b32 v59, v5, v13
    v_mfma_f32_16x16x32_bf16 v[60:63], a[220:223], v[52:55], v[60:63]
    s_nop 0
    v_mfma_f32_16x16x32_bf16 v[64:67], a[220:223], v[56:59], v[64:67]
    s_waitcnt vmcnt(7)
    v_perm_b32 v4, v32, v32, s80
    v_perm_b32 v5, v48, v48, s80
    v_and_b32 v52, v4, v10
    v_and_b32 v53, v4, v11
    v_and_b32 v54, v4, v12
    v_and_b32 v55, v4, v13
    v_and_b32 v56, v5, v10
    v_and_b32 v57, v5, v11
    v_and_b32 v58, v5, v12
    v_and_b32 v59, v5, v13
    v_mfma_f32_16x16x32_bf16 v[60:63], a[224:227], v[52:55], v[60:63]
    s_nop 0
    v_mfma_f32_16x16x32_bf16 v[64:67], a[224:227], v[56:59], v[64:67]
    s_waitcnt vmcnt(6)
    s_add_u32 s39, s87, s88
    s_bfe_u32 s37, s39, 0x30000
    s_lshl_b32 s37, s37, 12
    s_add_u32 s85, s37, s89
    s_bfe_u32 s37, s39, 0x10003
    s_lshl_b32 s37, s37, 11
    s_add_u32 s85, s37, s85
    s_bfe_u32 s37, s39, 0x40004
    s_lshl_b32 s37, s37, 16
    s_add_u32 s85, s37, s85
    buffer_load_dwordx4 v[128:131], v76, s[52:55], s85 offen offset:0 nt
    v_perm_b32 v4, v32, v32, s81
    v_perm_b32 v5, v48, v48, s81
    v_and_b32 v52, v4, v10
    v_and_b32 v53, v4, v11
    v_and_b32 v54, v4, v12
    v_and_b32 v55, v4, v13
    v_and_b32 v56, v5, v10
    v_and_b32 v57, v5, v11
    v_and_b32 v58, v5, v12
    v_and_b32 v59, v5, v13
    v_mfma_f32_16x16x32_bf16 v[60:63], a[228:231], v[52:55], v[60:63]
    s_nop 0
    v_mfma_f32_16x16x32_bf16 v[64:67], a[228:231], v[56:59], v[64:67]
    s_waitcnt vmcnt(6)
    buffer_load_dwordx4 v[132:135], v77, s[52:55], s85 offen offset:0 nt
    v_perm_b32 v4, v33, v33, s80
    v_perm_b32 v5, v49, v49, s80
    v_and_b32 v52, v4, v10
    v_and_b32 v53, v4, v11
    v_and_b32 v54, v4, v12
    v_and_b32 v55, v4, v13
    v_and_b32 v56, v5, v10
    v_and_b32 v57, v5, v11
    v_and_b32 v58, v5, v12
    v_and_b32 v59, v5, v13
    v_mfma_f32_16x16x32_bf16 v[60:63], a[232:235], v[52:55], v[60:63]
    s_nop 0
    v_mfma_f32_16x16x32_bf16 v[64:67], a[232:235], v[56:59], v[64:67]
    s_waitcnt vmcnt(6)
    buffer_load_dwordx4 v[136:139], v76, s[52:55], s85 offen offset:1024 nt
    v_perm_b32 v4, v33, v33, s81
    v_perm_b32 v5, v49, v49, s81
    v_and_b32 v52, v4, v10
    v_and_b32 v53, v4, v11
    v_and_b32 v54, v4, v12
    v_and_b32 v55, v4, v13
    v_and_b32 v56, v5, v10
    v_and_b32 v57, v5, v11
    v_and_b32 v58, v5, v12
    v_and_b32 v59, v5, v13
    v_mfma_f32_16x16x32_bf16 v[60:63], a[236:239], v[52:55], v[60:63]
    s_nop 0
    v_mfma_f32_16x16x32_bf16 v[64:67], a[236:239], v[56:59], v[64:67]
    s_waitcnt vmcnt(6)
    buffer_load_dwordx4 v[140:143], v77, s[52:55], s85 offen offset:1024 nt
    s_add_u32 s87, s87, 7
    s_add_u32 s39, s87, s88
    s_bfe_u32 s37, s39, 0x30000
    s_lshl_b32 s37, s37, 12
    s_add_u32 s85, s37, s89
    s_bfe_u32 s37, s39, 0x10003
    s_lshl_b32 s37, s37, 11
    s_add_u32 s85, s37, s85
    s_bfe_u32 s37, s39, 0x40004
    s_lshl_b32 s37, s37, 16
    s_add_u32 s85, s37, s85
    v_perm_b32 v4, v34, v34, s80
    v_perm_b32 v5, v50, v50, s80
    v_and_b32 v52, v4, v10
    v_and_b32 v53, v4, v11
    v_and_b32 v54, v4, v12
    v_and_b32 v55, v4, v13
    v_and_b32 v56, v5, v10
    v_and_b32 v57, v5, v11
    v_and_b32 v58, v5, v12
    v_and_b32 v59, v5, v13
    v_mfma_f32_16x16x32_bf16 v[60:63], a[240:243], v[52:55], v[60:63]
    s_nop 0
    v_mfma_f32_16x16x32_bf16 v[64:67], a[240:243], v[56:59], v[64:67]
    s_waitcnt vmcnt(6)
    buffer_load_dwordx4 v[144:147], v76, s[52:55], s85 offen offset:0 nt
    v_perm_b32 v4, v34, v34, s81
    v_perm_b32 v5, v50, v50, s81
    v_and_b32 v52, v4, v10
    v_and_b32 v53, v4, v11
    v_and_b32 v54, v4, v12
    v_and_b32 v55, v4, v13
    v_and_b32 v56, v5, v10
    v_and_b32 v57, v5, v11
    v_and_b32 v58, v5, v12
    v_and_b32 v59, v5, v13
    v_mfma_f32_16x16x32_bf16 v[60:63], a[244:247], v[52:55], v[60:63]
    s_nop 0
    v_mfma_f32_16x16x32_bf16 v[64:67], a[244:247], v[56:59], v[64:67]
    s_waitcnt vmcnt(6)
    buffer_load_dwordx4 v[148:151], v77, s[52:55], s85 offen offset:0 nt
    v_perm_b32 v4, v35, v35, s80
    v_perm_b32 v5, v51, v51, s80
    v_and_b32 v52, v4, v10
    v_and_b32 v53, v4, v11
    v_and_b32 v54, v4, v12
    v_and_b32 v55, v4, v13
    v_and_b32 v56, v5, v10
    v_and_b32 v57, v5, v11
    v_and_b32 v58, v5, v12
    v_and_b32 v59, v5, v13
    v_mfma_f32_16x16x32_bf16 v[60:63], a[248:251], v[52:55], v[60:63]
    s_nop 0
    v_mfma_f32_16x16x32_bf16 v[64:67], a[248:251], v[56:59], v[64:67]
    s_waitcnt vmcnt(6)
    buffer_load_dwordx4 v[152:155], v76, s[52:55], s85 offen offset:1024 nt
    v_perm_b32 v4, v35, v35, s81
    v_perm_b32 v5, v51, v51, s81
    v_and_b32 v52, v4, v10
    v_and_b32 v53, v4, v11
    v_and_b32 v54, v4, v12
    v_and_b32 v55, v4, v13
    v_and_b32 v56, v5, v10
    v_and_b32 v57, v5, v11
    v_and_b32 v58, v5, v12
    v_and_b32 v59, v5, v13
    v_mfma_f32_16x16x32_bf16 v[60:63], a[252:255], v[52:55], v[60:63]
    s_nop 0
    v_mfma_f32_16x16x32_bf16 v[64:67], a[252:255], v[56:59], v[64:67]
    s_lshl_b32 s38, s34, 11
    v_lshrrev_b32 v4, 3, v3
    v_lshlrev_b32 v4, 9, v4
    v_lshl_add_u32 v4, v2, 7, v4
    v_and_b32 v5, 7, v3
    v_lshl_add_u32 v4, v5, 2, v4
    v_add_u32 v4, s38, v4
    ds_write_b32 v4, v60 offset:0
    ds_write_b32 v4, v61 offset:32
    ds_write_b32 v4, v62 offset:64
    ds_write_b32 v4, v63 offset:96
    ds_write_b32 v4, v64 offset:1024
    ds_write_b32 v4, v65 offset:1056
    ds_write_b32 v4, v66 offset:1088
    ds_write_b32 v4, v67 offset:1120
    s_lshl_b32 s38, s34, 9
    v_and_b32 v5, 31, v1
    v_lshl_add_u32 v5, v5, 4, s38
    s_waitcnt lgkmcnt(0)
    s_add_u32 s35, s35, 0x5b
    s_and_b32 s35, s35, 0xff
    v_mov_b32 v8, s35
    s_barrier
    ds_read_b128 v[20:23], v5 offset:0
    ds_read_b128 v[24:27], v5 offset:2048
    ds_read_b128 v[28:31], v5 offset:4096
    ds_read_b128 v[32:35], v5 offset:6144
    s_lshl_b32 s38, s61, 12
    s_add_u32 s36, s38, 262144
    s_lshl_b32 s38, s33, 11
    s_add_u32 s36, s38, s36
    s_waitcnt lgkmcnt(0)
    v_add_f32 v20, v20, v24
    v_add_f32 v28, v28, v32
    v_add_f32 v21, v21, v25
    v_add_f32 v29, v29, v33
    v_add_f32 v22, v22, v26
    v_add_f32 v30, v30, v34
    v_add_f32 v23, v23, v27
    v_add_f32 v31, v31, v35
    v_add_f32 v20, v20, v28
    v_add_f32 v21, v21, v29
    v_add_f32 v22, v22, v30
    v_add_f32 v23, v23, v31
    s_mov_b32 s38, 0xffff0000
    v_cvt_pk_bf16_f32 v20, v20, v20
    v_cvt_pk_bf16_f32 v21, v21, v21
    v_cvt_pk_bf16_f32 v22, v22, v22
    v_cvt_pk_bf16_f32 v23, v23, v23
    v_and_or_b32 v20, v20, s38, v8
    v_and_or_b32 v21, v21, s38, v8
    v_and_or_b32 v22, v22, s38, v8
    v_and_or_b32 v23, v23, s38, v8
    s_mov_b32 exec_lo, 0xffffffff
    s_mov_b32 exec_hi, 0x0
    buffer_store_dwordx4 v[20:23], v5, s[48:51], s36 offen sc1
    s_mov_b64 exec, -1
    s_waitcnt vmcnt(7)
    buffer_load_dwordx4 v[156:159], v77, s[52:55], s85 offen offset:1024 nt
    s_add_u32 s87, s87, 7
    s_add_u32 s39, s87, s88
    s_bfe_u32 s37, s39, 0x30000
    s_lshl_b32 s37, s37, 12
    s_add_u32 s85, s37, s89
    s_bfe_u32 s37, s39, 0x10003
    s_lshl_b32 s37, s37, 11
    s_add_u32 s85, s37, s85
    s_bfe_u32 s37, s39, 0x40004
    s_lshl_b32 s37, s37, 16
    s_add_u32 s85, s37, s85
    s_waitcnt vmcnt(7)
    buffer_load_dwordx4 v[160:163], v76, s[52:55], s85 offen offset:0 nt
    s_waitcnt vmcnt(7)
    buffer_load_dwordx4 v[164:167], v77, s[52:55], s85 offen offset:0 nt
    s_waitcnt vmcnt(7)
    buffer_load_dwordx4 v[168:171], v76, s[52:55], s85 offen offset:1024 nt
    s_waitcnt vmcnt(7)
    buffer_load_dwordx4 v[172:175], v77, s[52:55], s85 offen offset:1024 nt
    s_add_u32 s87, s87, 7
    s_add_u32 s39, s87, s88
    s_bfe_u32 s37, s39, 0x30000
    s_lshl_b32 s37, s37, 12
    s_add_u32 s85, s37, s89
    s_bfe_u32 s37, s39, 0x10003
    s_lshl_b32 s37, s37, 11
    s_add_u32 s85, s37, s85
    s_bfe_u32 s37, s39, 0x40004
    s_lshl_b32 s37, s37, 16
    s_add_u32 s85, s37, s85
    s_waitcnt vmcnt(7)
    buffer_load_dwordx4 v[176:179], v76, s[52:55], s85 offen offset:0 nt
    s_waitcnt vmcnt(7)
    buffer_load_dwordx4 v[180:183], v77, s[52:55], s85 offen offset:0 nt
    s_waitcnt vmcnt(6)
    buffer_load_dwordx4 v[184:187], v76, s[52:55], s85 offen offset:1024 nt
    s_waitcnt vmcnt(6)
    buffer_load_dwordx4 v[188:191], v77, s[52:55], s85 offen offset:1024 nt
    s_add_u32 s87, s87, 7
    s_add_u32 s39, s87, s88
    s_bfe_u32 s37, s39, 0x30000
    s_lshl_b32 s37, s37, 12
    s_add_u32 s85, s37, s89
    s_bfe_u32 s37, s39, 0x10003
    s_lshl_b32 s37, s37, 11
    s_add_u32 s85, s37, s85
    s_bfe_u32 s37, s39, 0x40004
    s_lshl_b32 s37, s37, 16
    s_add_u32 s85, s37, s85
    s_waitcnt vmcnt(6)
    buffer_load_dwordx4 v[192:195], v76, s[52:55], s85 offen offset:0 nt
    s_waitcnt vmcnt(6)
    buffer_load_dwordx4 v[196:199], v77, s[52:55], s85 offen offset:0 nt
    s_waitcnt vmcnt(6)
    buffer_load_dwordx4 v[200:203], v76, s[52:55], s85 offen offset:1024 nt
    s_waitcnt vmcnt(6)
    buffer_load_dwordx4 v[204:207], v77, s[52:55], s85 offen offset:1024 nt
    s_add_u32 s87, s87, 7
    s_add_u32 s39, s87, s88
    s_bfe_u32 s37, s39, 0x30000
    s_lshl_b32 s37, s37, 12
    s_add_u32 s85, s37, s89
    s_bfe_u32 s37, s39, 0x10003
    s_lshl_b32 s37, s37, 11
    s_add_u32 s85, s37, s85
    s_bfe_u32 s37, s39, 0x40004
    s_lshl_b32 s37, s37, 16
    s_add_u32 s85, s37, s85
    s_waitcnt vmcnt(6)
    buffer_load_dwordx4 v[208:211], v76, s[52:55], s85 offen offset:0 nt
    s_waitcnt vmcnt(6)
    buffer_load_dwordx4 v[212:215], v77, s[52:55], s85 offen offset:0 nt
    s_waitcnt vmcnt(6)
    buffer_load_dwordx4 v[216:219], v76, s[52:55], s85 offen offset:1024 nt
    s_waitcnt vmcnt(6)
    buffer_load_dwordx4 v[220:223], v77, s[52:55], s85 offen offset:1024 nt
    s_add_u32 s87, s87, 7
    s_add_u32 s39, s87, s88
    s_bfe_u32 s37, s39, 0x30000
    s_lshl_b32 s37, s37, 12
    s_add_u32 s85, s37, s89
    s_bfe_u32 s37, s39, 0x10003
    s_lshl_b32 s37, s37, 11
    s_add_u32 s85, s37, s85
    s_bfe_u32 s37, s39, 0x40004
    s_lshl_b32 s37, s37, 16
    s_add_u32 s85, s37, s85
    s_waitcnt vmcnt(6)
    buffer_load_dwordx4 v[224:227], v76, s[52:55], s85 offen offset:0 nt
    s_waitcnt vmcnt(6)
    buffer_load_dwordx4 v[228:231], v77, s[52:55], s85 offen offset:0 nt
    s_waitcnt vmcnt(6)
    buffer_load_dwordx4 v[232:235], v76, s[52:55], s85 offen offset:1024 nt
    s_waitcnt vmcnt(6)
    buffer_load_dwordx4 v[236:239], v77, s[52:55], s85 offen offset:1024 nt
    s_add_u32 s87, s87, 7
    s_add_u32 s39, s87, s88
    s_bfe_u32 s37, s39, 0x30000
    s_lshl_b32 s37, s37, 12
    s_add_u32 s85, s37, s89
    s_bfe_u32 s37, s39, 0x10003
    s_lshl_b32 s37, s37, 11
    s_add_u32 s85, s37, s85
    s_bfe_u32 s37, s39, 0x40004
    s_lshl_b32 s37, s37, 16
    s_add_u32 s85, s37, s85
    s_waitcnt vmcnt(6)
    buffer_load_dwordx4 v[240:243], v76, s[52:55], s85 offen offset:0 nt
    s_waitcnt vmcnt(6)
    buffer_load_dwordx4 v[244:247], v77, s[52:55], s85 offen offset:0 nt
    s_waitcnt vmcnt(6)
    buffer_load_dwordx4 v[248:251], v76, s[52:55], s85 offen offset:1024 nt
    s_waitcnt vmcnt(6)
    buffer_load_dwordx4 v[252:255], v77, s[52:55], s85 offen offset:1024 nt
    s_add_u32 s87, s87, 7
    s_add_u32 s39, s87, s88
    s_bfe_u32 s37, s39, 0x30000
    s_lshl_b32 s37, s37, 12
    s_add_u32 s85, s37, s89
    s_bfe_u32 s37, s39, 0x10003
    s_lshl_b32 s37, s37, 11
    s_add_u32 s85, s37, s85
    s_bfe_u32 s37, s39, 0x40004
    s_lshl_b32 s37, s37, 16
    s_add_u32 s85, s37, s85
    s_waitcnt vmcnt(6)
    buffer_load_dwordx4 a[0:3], v76, s[52:55], s85 offen offset:0 nt
    s_waitcnt vmcnt(6)
    buffer_load_dwordx4 a[4:7], v77, s[52:55], s85 offen offset:0 nt
    s_waitcnt vmcnt(6)
    buffer_load_dwordx4 a[8:11], v76, s[52:55], s85 offen offset:1024 nt
    s_waitcnt vmcnt(6)
    buffer_load_dwordx4 a[12:15], v77, s[52:55], s85 offen offset:1024 nt
    s_add_u32 s87, s87, 7
    s_add_u32 s39, s87, s88
    s_bfe_u32 s37, s39, 0x30000
    s_lshl_b32 s37, s37, 12
    s_add_u32 s85, s37, s89
    s_bfe_u32 s37, s39, 0x10003
    s_lshl_b32 s37, s37, 11
    s_add_u32 s85, s37, s85
    s_bfe_u32 s37, s39, 0x40004
    s_lshl_b32 s37, s37, 16
    s_add_u32 s85, s37, s85
    s_waitcnt vmcnt(6)
    buffer_load_dwordx4 a[16:19], v76, s[52:55], s85 offen offset:0 nt
    s_waitcnt vmcnt(6)
    buffer_load_dwordx4 a[20:23], v77, s[52:55], s85 offen offset:0 nt
    s_waitcnt vmcnt(6)
    buffer_load_dwordx4 a[24:27], v76, s[52:55], s85 offen offset:1024 nt
    s_waitcnt vmcnt(6)
    buffer_load_dwordx4 a[28:31], v77, s[52:55], s85 offen offset:1024 nt
    s_add_u32 s87, s87, 7
    s_add_u32 s39, s87, s88
    s_bfe_u32 s37, s39, 0x30000
    s_lshl_b32 s37, s37, 12
    s_add_u32 s85, s37, s89
    s_bfe_u32 s37, s39, 0x10003
    s_lshl_b32 s37, s37, 11
    s_add_u32 s85, s37, s85
    s_bfe_u32 s37, s39, 0x40004
    s_lshl_b32 s37, s37, 16
    s_add_u32 s85, s37, s85
    s_waitcnt vmcnt(6)
    buffer_load_dwordx4 a[32:35], v76, s[52:55], s85 offen offset:0 nt
    s_waitcnt vmcnt(6)
    buffer_load_dwordx4 a[36:39], v77, s[52:55], s85 offen offset:0 nt
    s_waitcnt vmcnt(6)
    buffer_load_dwordx4 a[40:43], v76, s[52:55], s85 offen offset:1024 nt
    s_waitcnt vmcnt(6)
    buffer_load_dwordx4 a[44:47], v77, s[52:55], s85 offen offset:1024 nt
    s_add_u32 s87, s87, 7
    s_add_u32 s39, s87, s88
    s_bfe_u32 s37, s39, 0x30000
    s_lshl_b32 s37, s37, 12
    s_add_u32 s85, s37, s89
    s_bfe_u32 s37, s39, 0x10003
    s_lshl_b32 s37, s37, 11
    s_add_u32 s85, s37, s85
    s_bfe_u32 s37, s39, 0x40004
    s_lshl_b32 s37, s37, 16
    s_add_u32 s85, s37, s85
    s_waitcnt vmcnt(6)
    buffer_load_dwordx4 a[48:51], v76, s[52:55], s85 offen offset:0 nt
    s_waitcnt vmcnt(6)
    buffer_load_dwordx4 a[52:55], v77, s[52:55], s85 offen offset:0 nt
    buffer_load_dwordx4 v[68:71], v78, s[48:51], s91 offen offset:0 sc1
    buffer_load_dwordx4 v[72:75], v78, s[48:51], s91 offen offset:16 sc1
    s_waitcnt vmcnt(8)
    buffer_load_dwordx4 a[56:59], v76, s[52:55], s85 offen offset:1024 nt
    s_waitcnt vmcnt(8)
    buffer_load_dwordx4 a[60:63], v77, s[52:55], s85 offen offset:1024 nt
    s_add_u32 s87, s87, 7
    s_add_u32 s39, s87, s88
    s_bfe_u32 s37, s39, 0x30000
    s_lshl_b32 s37, s37, 12
    s_add_u32 s85, s37, s89
    s_bfe_u32 s37, s39, 0x10003
    s_lshl_b32 s37, s37, 11
    s_add_u32 s85, s37, s85
    s_bfe_u32 s37, s39, 0x40004
    s_lshl_b32 s37, s37, 16
    s_add_u32 s85, s37, s85
    s_waitcnt vmcnt(8)
    buffer_load_dwordx4 a[64:67], v76, s[52:55], s85 offen offset:0 nt
    s_waitcnt vmcnt(8)
    buffer_load_dwordx4 a[68:71], v77, s[52:55], s85 offen offset:0 nt
    s_waitcnt vmcnt(8)
    buffer_load_dwordx4 a[72:75], v76, s[52:55], s85 offen offset:1024 nt
    s_waitcnt vmcnt(8)
    buffer_load_dwordx4 a[76:79], v77, s[52:55], s85 offen offset:1024 nt
    s_add_u32 s87, s87, 7
    s_add_u32 s39, s87, s88
    s_bfe_u32 s37, s39, 0x30000
    s_lshl_b32 s37, s37, 12
    s_add_u32 s85, s37, s89
    s_bfe_u32 s37, s39, 0x10003
    s_lshl_b32 s37, s37, 11
    s_add_u32 s85, s37, s85
    s_bfe_u32 s37, s39, 0x40004
    s_lshl_b32 s37, s37, 16
    s_add_u32 s85, s37, s85
    s_waitcnt vmcnt(6)
L_qcheck_12:
    v_xor_b32 v68, s35, v68
    v_xor_b32 v69, s35, v69
    v_xor_b32 v70, s35, v70
    v_xor_b32 v71, s35, v71
    v_xor_b32 v72, s35, v72
    v_xor_b32 v73, s35, v73
    v_xor_b32 v74, s35, v74
    v_xor_b32 v75, s35, v75
    v_or_b32 v4, v68, v69
    v_or3_b32 v4, v4, v70, v71
    v_or3_b32 v4, v4, v72, v73
    v_or3_b32 v4, v4, v74, v75
    v_and_b32 v4, 0xff, v4
    v_cmp_ne_u32 vcc, 0, v4
    s_cbranch_vccz L_qok_13
    buffer_load_dwordx4 v[68:71], v78, s[48:51], s91 offen offset:0 sc1
    buffer_load_dwordx4 v[72:75], v78, s[48:51], s91 offen offset:16 sc1
    s_waitcnt vmcnt(0)
    s_sub_u32 s84, s84, 1
    s_cmp_lg_u32 s84, 0
    s_cbranch_scc1 L_qcheck_12
    s_branch L_end
L_qok_13:
    v_cvt_pk_bf16_f32 v68, v68, v69
    v_cvt_pk_bf16_f32 v69, v70, v71
    v_cvt_pk_bf16_f32 v70, v72, v73
    v_cvt_pk_bf16_f32 v71, v74, v75
    s_mov_b32 vcc_lo, 0xf000f
    s_mov_b32 vcc_hi, 0xf000f
    v_cndmask_b32 v80, 0, v68, vcc
    v_cndmask_b32 v81, 0, v69, vcc
    v_cndmask_b32 v82, 0, v70, vcc
    v_cndmask_b32 v83, 0, v71, vcc
    s_mov_b32 vcc_lo, 0xf000f0
    s_mov_b32 vcc_hi, 0xf000f0
    v_cndmask_b32 v84, 0, v68, vcc
    v_cndmask_b32 v85, 0, v69, vcc
    v_cndmask_b32 v86, 0, v70, vcc
    v_cndmask_b32 v87, 0, v71, vcc
    s_mov_b32 vcc_lo, 0xf000f00
    s_mov_b32 vcc_hi, 0xf000f00
    v_cndmask_b32 v88, 0, v68, vcc
    v_cndmask_b32 v89, 0, v69, vcc
    v_cndmask_b32 v90, 0, v70, vcc
    v_cndmask_b32 v91, 0, v71, vcc
    s_mov_b32 vcc_lo, 0xf000f000
    s_mov_b32 vcc_hi, 0xf000f000
    v_cndmask_b32 v92, 0, v68, vcc
    v_cndmask_b32 v93, 0, v69, vcc
    v_cndmask_b32 v94, 0, v70, vcc
    v_cndmask_b32 v95, 0, v71, vcc
    v_mov_b32 v65, 0xff7f0000
    s_lshl_b32 s38, s34, 14
    s_add_u32 s38, s38, 16384
    v_lshl_add_u32 v64, v1, 2, s38
    buffer_load_dwordx4 a[80:83], v76, s[52:55], s85 offen offset:0 nt
    v_mfma_f32_16x16x32_bf16 v[112:115], v[128:131], v[80:83], 0
    v_mfma_f32_16x16x32_bf16 v[112:115], v[132:135], v[84:87], v[112:115]
    v_mfma_f32_16x16x32_bf16 v[112:115], v[136:139], v[88:91], v[112:115]
    s_waitcnt vmcnt(6)
    buffer_load_dwordx4 a[84:87], v77, s[52:55], s85 offen offset:0 nt
    v_mfma_f32_16x16x32_bf16 v[112:115], v[140:143], v[92:95], v[112:115]
    v_mfma_f32_16x16x32_bf16 v[96:99], v[144:147], v[80:83], 0
    v_mfma_f32_16x16x32_bf16 v[96:99], v[148:151], v[84:87], v[96:99]
    v_mfma_f32_16x16x32_bf16 v[96:99], v[152:155], v[88:91], v[96:99]
    s_nop 4
    v_mov_b32_dpp v122, v112 quad_perm:[0,0,0,0] row_mask:0xf bank_mask:0xf
    v_mov_b32_dpp v124, v114 quad_perm:[2,2,2,2] row_mask:0xf bank_mask:0xf
    s_nop 0
    v_add_f32_dpp v122, v113, v122 quad_perm:[1,1,1,1] row_mask:0xf bank_mask:0xf
    v_add_f32_dpp v124, v115, v124 quad_perm:[3,3,3,3] row_mask:0xf bank_mask:0xf
    v_add_f32 v122, v122, v124
    v_max_f32 v65, v65, v122
    ds_write_b32 v64, v122 offset:0
    s_waitcnt vmcnt(6)
    buffer_load_dwordx4 a[88:91], v76, s[52:55], s85 offen offset:1024 nt
    v_mfma_f32_16x16x32_bf16 v[96:99], v[156:159], v[92:95], v[96:99]
    v_mfma_f32_16x16x32_bf16 v[112:115], v[160:163], v[80:83], 0
    v_mfma_f32_16x16x32_bf16 v[112:115], v[164:167], v[84:87], v[112:115]
    s_waitcnt vmcnt(6)
    buffer_load_dwordx4 a[92:95], v77, s[52:55], s85 offen offset:1024 nt
    s_add_u32 s87, s87, 7
    s_add_u32 s39, s87, s88
    s_bfe_u32 s37, s39, 0x30000
    s_lshl_b32 s37, s37, 12
    s_add_u32 s85, s37, s89
    s_bfe_u32 s37, s39, 0x10003
    s_lshl_b32 s37, s37, 11
    s_add_u32 s85, s37, s85
    s_bfe_u32 s37, s39, 0x40004
    s_lshl_b32 s37, s37, 16
    s_add_u32 s85, s37, s85
    v_mfma_f32_16x16x32_bf16 v[112:115], v[168:171], v[88:91], v[112:115]
    v_mov_b32_dpp v122, v96 quad_perm:[0,0,0,0] row_mask:0xf bank_mask:0xf
    v_mov_b32_dpp v124, v98 quad_perm:[2,2,2,2] row_mask:0xf bank_mask:0xf
    s_nop 0
    v_add_f32_dpp v122, v97, v122 quad_perm:[1,1,1,1] row_mask:0xf bank_mask:0xf
    v_add_f32_dpp v124, v99, v124 quad_perm:[3,3,3,3] row_mask:0xf bank_mask:0xf
    v_add_f32 v122, v122, v124
    v_max_f32 v65, v65, v122
    ds_write_b32 v64, v122 offset:256
    v_mfma_f32_16x16x32_bf16 v[112:115], v[172:175], v[92:95], v[112:115]
    v_mfma_f32_16x16x32_bf16 v[96:99], v[176:179], v[80:83], 0
    v_mfma_f32_16x16x32_bf16 v[96:99], v[180:183], v[84:87], v[96:99]
    s_waitcnt vmcnt(6)
    buffer_load_dwordx4 a[96:99], v76, s[52:55], s85 offen offset:0 nt
    v_mfma_f32_16x16x32_bf16 v[96:99], v[184:187], v[88:91], v[96:99]
    s_nop 2
    v_mov_b32_dpp v122, v112 quad_perm:[0,0,0,0] row_mask:0xf bank_mask:0xf
    v_mov_b32_dpp v124, v114 quad_perm:[2,2,2,2] row_mask:0xf bank_mask:0xf
    s_nop 0
    v_add_f32_dpp v122, v113, v122 quad_perm:[1,1,1,1] row_mask:0xf bank_mask:0xf
    v_add_f32_dpp v124, v115, v124 quad_perm:[3,3,3,3] row_mask:0xf bank_mask:0xf
    v_add_f32 v122, v122, v124
    v_max_f32 v65, v65, v122
    ds_write_b32 v64, v122 offset:512
    v_mfma_f32_16x16x32_bf16 v[96:99], v[188:191], v[92:95], v[96:99]
    v_mfma_f32_16x16x32_bf16 v[112:115], v[192:195], v[80:83], 0
    s_waitcnt vmcnt(6)
    buffer_load_dwordx4 a[100:103], v77, s[52:55], s85 offen offset:0 nt
    v_mfma_f32_16x16x32_bf16 v[112:115], v[196:199], v[84:87], v[112:115]
    v_mfma_f32_16x16x32_bf16 v[112:115], v[200:203], v[88:91], v[112:115]
    s_nop 2
    v_mov_b32_dpp v122, v96 quad_perm:[0,0,0,0] row_mask:0xf bank_mask:0xf
    v_mov_b32_dpp v124, v98 quad_perm:[2,2,2,2] row_mask:0xf bank_mask:0xf
    s_nop 0
    v_add_f32_dpp v122, v97, v122 quad_perm:[1,1,1,1] row_mask:0xf bank_mask:0xf
    v_add_f32_dpp v124, v99, v124 quad_perm:[3,3,3,3] row_mask:0xf bank_mask:0xf
    v_add_f32 v122, v122, v124
    v_max_f32 v65, v65, v122
    ds_write_b32 v64, v122 offset:768
    v_mfma_f32_16x16x32_bf16 v[112:115], v[204:207], v[92:95], v[112:115]
    v_mfma_f32_16x16x32_bf16 v[96:99], v[208:211], v[80:83], 0
    s_waitcnt vmcnt(6)
    buffer_load_dwordx4 a[104:107], v76, s[52:55], s85 offen offset:1024 nt
    v_mfma_f32_16x16x32_bf16 v[96:99], v[212:215], v[84:87], v[96:99]
    v_mfma_f32_16x16x32_bf16 v[96:99], v[216:219], v[88:91], v[96:99]
    s_nop 2
    v_mov_b32_dpp v122, v112 quad_perm:[0,0,0,0] row_mask:0xf bank_mask:0xf
    v_mov_b32_dpp v124, v114 quad_perm:[2,2,2,2] row_mask:0xf bank_mask:0xf
    s_nop 0
    v_add_f32_dpp v122, v113, v122 quad_perm:[1,1,1,1] row_mask:0xf bank_mask:0xf
    v_add_f32_dpp v124, v115, v124 quad_perm:[3,3,3,3] row_mask:0xf bank_mask:0xf
    v_add_f32 v122, v122, v124
    v_max_f32 v65, v65, v122
    ds_write_b32 v64, v122 offset:1024
    v_mfma_f32_16x16x32_bf16 v[96:99], v[220:223], v[92:95], v[96:99]
    s_waitcnt vmcnt(6)
    buffer_load_dwordx4 a[108:111], v77, s[52:55], s85 offen offset:1024 nt
    s_add_u32 s87, s87, 7
    s_add_u32 s39, s87, s88
    s_bfe_u32 s37, s39, 0x30000
    s_lshl_b32 s37, s37, 12
    s_add_u32 s85, s37, s89
    s_bfe_u32 s37, s39, 0x10003
    s_lshl_b32 s37, s37, 11
    s_add_u32 s85, s37, s85
    s_bfe_u32 s37, s39, 0x40004
    s_lshl_b32 s37, s37, 16
    s_add_u32 s85, s37, s85
    v_mfma_f32_16x16x32_bf16 v[112:115], v[224:227], v[80:83], 0
    v_mfma_f32_16x16x32_bf16 v[112:115], v[228:231], v[84:87], v[112:115]
    v_mfma_f32_16x16x32_bf16 v[112:115], v[232:235], v[88:91], v[112:115]
    v_mov_b32_dpp v122, v96 quad_perm:[0,0,0,0] row_mask:0xf bank_mask:0xf
    v_mov_b32_dpp v124, v98 quad_perm:[2,2,2,2] row_mask:0xf bank_mask:0xf
    s_nop 0
    v_add_f32_dpp v122, v97, v122 quad_perm:[1,1,1,1] row_mask:0xf bank_mask:0xf
    v_add_f32_dpp v124, v99, v124 quad_perm:[3,3,3,3] row_mask:0xf bank_mask:0xf
    v_add_f32 v122, v122, v124
    v_max_f32 v65, v65, v122
    ds_write_b32 v64, v122 offset:1280
    v_mfma_f32_16x16x32_bf16 v[112:115], v[236:239], v[92:95], v[112:115]
    s_waitcnt vmcnt(6)
    buffer_load_dwordx4 a[112:115], v76, s[52:55], s85 offen offset:0 nt
    v_mfma_f32_16x16x32_bf16 v[96:99], v[240:243], v[80:83], 0
    v_mfma_f32_16x16x32_bf16 v[96:99], v[244:247], v[84:87], v[96:99]
    v_mfma_f32_16x16x32_bf16 v[96:99], v[248:251], v[88:91], v[96:99]
    s_nop 2
    v_mov_b32_dpp v122, v112 quad_perm:[0,0,0,0] row_mask:0xf bank_mask:0xf
    v_mov_b32_dpp v124, v114 quad_perm:[2,2,2,2] row_mask:0xf bank_mask:0xf
    s_nop 0
    v_add_f32_dpp v122, v113, v122 quad_perm:[1,1,1,1] row_mask:0xf bank_mask:0xf
    v_add_f32_dpp v124, v115, v124 quad_perm:[3,3,3,3] row_mask:0xf bank_mask:0xf
    v_add_f32 v122, v122, v124
    v_max_f32 v65, v65, v122
    ds_write_b32 v64, v122 offset:1536
    v_mfma_f32_16x16x32_bf16 v[96:99], v[252:255], v[92:95], v[96:99]
    s_waitcnt vmcnt(6)
    buffer_load_dwordx4 a[116:119], v77, s[52:55], s85 offen offset:0 nt
    v_mfma_f32_16x16x32_bf16 v[112:115], a[0:3], v[80:83], 0
    v_mfma_f32_16x16x32_bf16 v[112:115], a[4:7], v[84:87], v[112:115]
    v_mfma_f32_16x16x32_bf16 v[112:115], a[8:11], v[88:91], v[112:115]
    s_nop 2
    v_mov_b32_dpp v122, v96 quad_perm:[0,0,0,0] row_mask:0xf bank_mask:0xf
    v_mov_b32_dpp v124, v98 quad_perm:[2,2,2,2] row_mask:0xf bank_mask:0xf
    s_nop 0
    v_add_f32_dpp v122, v97, v122 quad_perm:[1,1,1,1] row_mask:0xf bank_mask:0xf
    v_add_f32_dpp v124, v99, v124 quad_perm:[3,3,3,3] row_mask:0xf bank_mask:0xf
    v_add_f32 v122, v122, v124
    v_max_f32 v65, v65, v122
    ds_write_b32 v64, v122 offset:1792
    s_waitcnt vmcnt(6)
    buffer_load_dwordx4 a[120:123], v76, s[52:55], s85 offen offset:1024 nt
    v_mfma_f32_16x16x32_bf16 v[112:115], a[12:15], v[92:95], v[112:115]
    v_mfma_f32_16x16x32_bf16 v[96:99], a[16:19], v[80:83], 0
    v_mfma_f32_16x16x32_bf16 v[96:99], a[20:23], v[84:87], v[96:99]
    v_mfma_f32_16x16x32_bf16 v[96:99], a[24:27], v[88:91], v[96:99]
    s_nop 4
    v_mov_b32_dpp v122, v112 quad_perm:[0,0,0,0] row_mask:0xf bank_mask:0xf
    v_mov_b32_dpp v124, v114 quad_perm:[2,2,2,2] row_mask:0xf bank_mask:0xf
    s_nop 0
    v_add_f32_dpp v122, v113, v122 quad_perm:[1,1,1,1] row_mask:0xf bank_mask:0xf
    v_add_f32_dpp v124, v115, v124 quad_perm:[3,3,3,3] row_mask:0xf bank_mask:0xf
    v_add_f32 v122, v122, v124
    v_max_f32 v65, v65, v122
    ds_write_b32 v64, v122 offset:2048
    s_waitcnt vmcnt(6)
    buffer_load_dwordx4 a[124:127], v77, s[52:55], s85 offen offset:1024 nt
    s_add_u32 s87, s87, 7
    s_add_u32 s39, s87, s88
    s_bfe_u32 s37, s39, 0x30000
    s_lshl_b32 s37, s37, 12
    s_add_u32 s85, s37, s89
    s_bfe_u32 s37, s39, 0x10003
    s_lshl_b32 s37, s37, 11
    s_add_u32 s85, s37, s85
    s_bfe_u32 s37, s39, 0x40004
    s_lshl_b32 s37, s37, 16
    s_add_u32 s85, s37, s85
    v_mfma_f32_16x16x32_bf16 v[96:99], a[28:31], v[92:95], v[96:99]
    v_mfma_f32_16x16x32_bf16 v[112:115], a[32:35], v[80:83], 0
    s_sub_u32 s36, s33, 3
    s_and_b32 s37, s33, 3
    s_cmp_lt_u32 s36, 4
    s_cselect_b64 s[40:41], s[24:25], s[14:15]
    s_cselect_b32 s36, s36, s37
    s_cselect_b32 s45, 262144, 0
    s_cselect_b32 s46, 8388608, 0
    s_add_u32 s45, s45, 524288
    s_add_u32 s46, s46, 196608
    s_mov_b32 s42, 4194304
    s_mov_b32 s43, 0x20000
    s_lshl_b32 s38, s32, 17
    s_add_u32 s44, s38, 0
    s_lshl_b32 s38, s34, 15
    s_add_u32 s44, s38, s44
    s_lshl_b32 s38, s36, 8
    s_add_u32 s44, s38, s44
    s_lshl_b32 s38, s36, 16
    s_add_u32 s45, s38, s45
    s_lshr_b32 s38, s34, 1
    s_lshl_b32 s38, s38, 15
    s_add_u32 s45, s38, s45
    s_lshl_b32 s38, s32, 8
    s_add_u32 s45, s38, s45
    s_bfe_u32 s38, s34, 0x10000
    s_lshl_b32 s38, s38, 7
    s_add_u32 s45, s38, s45
    s_lshl_b32 s38, s32, 11
    s_add_u32 s46, s38, s46
    s_lshl_b32 s38, s34, 9
    s_add_u32 s46, s38, s46
    s_mov_b32 s72, s26
    s_and_b32 s73, s27, 0xffff
    s_mov_b32 s74, 8192
    s_mov_b32 s75, 0x20000
    v_mfma_f32_16x16x32_bf16 v[112:115], a[36:39], v[84:87], v[112:115]
    s_waitcnt vmcnt(5)
    buffer_load_dwordx4 v[128:131], v76, s[52:55], s85 offen offset:0 nt
    v_mfma_f32_16x16x32_bf16 v[112:115], a[40:43], v[88:91], v[112:115]
    v_mov_b32_dpp v122, v96 quad_perm:[0,0,0,0] row_mask:0xf bank_mask:0xf
    v_mov_b32_dpp v124, v98 quad_perm:[2,2,2,2] row_mask:0xf bank_mask:0xf
    s_nop 0
    v_add_f32_dpp v122, v97, v122 quad_perm:[1,1,1,1] row_mask:0xf bank_mask:0xf
    v_add_f32_dpp v124, v99, v124 quad_perm:[3,3,3,3] row_mask:0xf bank_mask:0xf
    v_add_f32 v122, v122, v124
    v_max_f32 v65, v65, v122
    ds_write_b32 v64, v122 offset:2304
    v_mfma_f32_16x16x32_bf16 v[112:115], a[44:47], v[92:95], v[112:115]
    v_mfma_f32_16x16x32_bf16 v[96:99], a[48:51], v[80:83], 0
    v_mfma_f32_16x16x32_bf16 v[96:99], a[52:55], v[84:87], v[96:99]
    s_waitcnt vmcnt(5)
    buffer_load_dwordx4 v[132:135], v77, s[52:55], s85 offen offset:0 nt
    v_mfma_f32_16x16x32_bf16 v[96:99], a[56:59], v[88:91], v[96:99]
    s_nop 2
    v_mov_b32_dpp v122, v112 quad_perm:[0,0,0,0] row_mask:0xf bank_mask:0xf
    v_mov_b32_dpp v124, v114 quad_perm:[2,2,2,2] row_mask:0xf bank_mask:0xf
    s_nop 0
    v_add_f32_dpp v122, v113, v122 quad_perm:[1,1,1,1] row_mask:0xf bank_mask:0xf
    v_add_f32_dpp v124, v115, v124 quad_perm:[3,3,3,3] row_mask:0xf bank_mask:0xf
    v_add_f32 v122, v122, v124
    v_max_f32 v65, v65, v122
    ds_write_b32 v64, v122 offset:2560
    v_lshlrev_b32 v4, 2, v2
    v_xor_b32 v4, v4, v3
    v_xor_b32 v5, 0, v4
    v_lshlrev_b32 v5, 4, v5
    v_lshl_add_u32 v20, v2, 10, v5
    v_xor_b32 v5, 1, v4
    v_lshlrev_b32 v5, 4, v5
    v_lshl_add_u32 v21, v2, 10, v5
    v_add_u32 v21, 3072, v21
    v_xor_b32 v5, 2, v4
    v_lshlrev_b32 v5, 4, v5
    v_lshl_add_u32 v22, v2, 10, v5
    v_add_u32 v22, 6144, v22
    v_xor_b32 v5, 3, v4
    v_lshlrev_b32 v5, 4, v5
    v_lshl_add_u32 v23, v2, 10, v5
    v_add_u32 v23, 9216, v23
    s_lshl_b32 s38, s32, 15
    s_add_u32 s47, s38, 1048576
    s_lshl_b32 s38, s3, 13
    s_add_u32 s47, s38, s47
    v_lshlrev_b32 v6, 7, v2
    v_bfe_u32 v5, v3, 0, 3
    v_lshl_add_u32 v6, v5, 4, v6
    v_lshrrev_b32 v4, 3, v3
    v_and_b32 v7, 3, v3
    v_min_u32 v7, 2, v7
    v_lshl_add_u32 v7, v7, 1, v4
    v_add_u32 v5, 0, v4
    v_cmp_le_u32 vcc, s33, v5
    s_nop 1
    v_addc_co_u32 v5, vcc, 0, v5, vcc
    v_lshl_add_u32 v50, v5, 10, v6
    v_add_u32 v5, 2, v4
    v_cmp_le_u32 vcc, s33, v5
    s_nop 1
    v_addc_co_u32 v5, vcc, 0, v5, vcc
    v_lshl_add_u32 v51, v5, 10, v6
    v_add_u32 v5, 4, v4
    v_cmp_le_u32 vcc, s33, v5
    s_nop 1
    v_addc_co_u32 v5, vcc, 0, v5, vcc
    v_lshl_add_u32 v52, v5, 10, v6
    v_mov_b32 v5, v7
    v_mov_b32 v6, 512
    v_cmp_le_u32 vcc, s33, v5
    s_nop 1
    v_addc_co_u32 v5, vcc, 0, v5, vcc
    v_lshl_add_u32 v53, v5, 10, v6
    s_mul_i32 s38, s3, 320
    s_add_u32 s38, s38, 135168
    v_lshlrev_b32 v4, 6, v2
    v_lshl_add_u32 v4, v3, 1, v4
    v_add_u32 v31, s38, v4
    v_mfma_f32_16x16x32_bf16 v[96:99], a[60:63], v[92:95], v[96:99]
    v_mfma_f32_16x16x32_bf16 v[112:115], a[64:67], v[80:83], 0
    s_waitcnt vmcnt(5)
    buffer_load_dwordx4 v[136:139], v76, s[52:55], s85 offen offset:1024 nt
    v_mfma_f32_16x16x32_bf16 v[112:115], a[68:71], v[84:87], v[112:115]
    v_mfma_f32_16x16x32_bf16 v[112:115], a[72:75], v[88:91], v[112:115]
    s_nop 2
    v_mov_b32_dpp v122, v96 quad_perm:[0,0,0,0] row_mask:0xf bank_mask:0xf
    v_mov_b32_dpp v124, v98 quad_perm:[2,2,2,2] row_mask:0xf bank_mask:0xf
    s_nop 0
    v_add_f32_dpp v122, v97, v122 quad_perm:[1,1,1,1] row_mask:0xf bank_mask:0xf
    v_add_f32_dpp v124, v99, v124 quad_perm:[3,3,3,3] row_mask:0xf bank_mask:0xf
    v_add_f32 v122, v122, v124
    v_max_f32 v65, v65, v122
    ds_write_b32 v64, v122 offset:2816
    v_mfma_f32_16x16x32_bf16 v[112:115], a[76:79], v[92:95], v[112:115]
    v_mfma_f32_16x16x32_bf16 v[96:99], a[80:83], v[80:83], 0
    v_lshlrev_b32 v4, 11, v2
    v_bfe_u32 v5, v1, 2, 2
    v_lshl_add_u32 v4, v5, 8, v4
    v_bfe_u32 v5, v1, 2, 2
    v_lshl_add_u32 v4, v5, 6, v4
    v_bfe_u32 v5, v1, 4, 1
    v_lshl_add_u32 v4, v5, 5, v4
    v_bfe_u32 v5, v1, 1, 1
    v_lshl_add_u32 v4, v5, 4, v4
    v_bfe_u32 v5, v1, 0, 1
    v_lshl_add_u32 v4, v5, 3, v4
    s_lshl_b32 s38, s34, 6
    s_add_u32 s38, s38, 98304
    v_xor_b32 v24, s38, v4
    v_xor_b32 v25, 16, v24
    v_xor_b32 v26, 32, v24
    v_xor_b32 v27, 48, v24
    v_and_b32 v4, 3, v3
    v_lshrrev_b32 v5, 2, v3
    v_lshlrev_b32 v6, 4, v2
    v_add_u32 v6, 135168, v6
    s_movk_i32 s36, 320
    v_cmp_eq_u32 vcc, 0, v5
    s_nop 1
    v_cndmask_b32 v28, 4, v4, vcc
    v_mad_u32_u24 v28, v28, s36, v6
    v_cmp_eq_u32 vcc, 1, v5
    s_nop 1
    v_cndmask_b32 v29, 4, v4, vcc
    v_mad_u32_u24 v29, v29, s36, v6
    v_lshlrev_b32 v5, 2, v1
    v_add_u32 v5, 136448, v5
    v_mov_b32 v6, 0
    ds_write_b32 v5, v6
    s_waitcnt vmcnt(5)
    buffer_load_dwordx4 v[140:143], v77, s[52:55], s85 offen offset:1024 nt
    s_add_u32 s87, s87, 7
    s_add_u32 s39, s87, s88
    s_bfe_u32 s37, s39, 0x30000
    s_lshl_b32 s37, s37, 12
    s_add_u32 s85, s37, s89
    s_bfe_u32 s37, s39, 0x10003
    s_lshl_b32 s37, s37, 11
    s_add_u32 s85, s37, s85
    s_bfe_u32 s37, s39, 0x40004
    s_lshl_b32 s37, s37, 16
    s_add_u32 s85, s37, s85
    v_mfma_f32_16x16x32_bf16 v[96:99], a[84:87], v[84:87], v[96:99]
    v_mfma_f32_16x16x32_bf16 v[96:99], a[88:91], v[88:91], v[96:99]
    v_mov_b32_dpp v122, v112 quad_perm:[0,0,0,0] row_mask:0xf bank_mask:0xf
    v_mov_b32_dpp v124, v114 quad_perm:[2,2,2,2] row_mask:0xf bank_mask:0xf
    s_nop 0
    v_add_f32_dpp v122, v113, v122 quad_perm:[1,1,1,1] row_mask:0xf bank_mask:0xf
    v_add_f32_dpp v124, v115, v124 quad_perm:[3,3,3,3] row_mask:0xf bank_mask:0xf
    v_add_f32 v122, v122, v124
    v_max_f32 v65, v65, v122
    ds_write_b32 v64, v122 offset:3072
    v_mfma_f32_16x16x32_bf16 v[96:99], a[92:95], v[92:95], v[96:99]
    s_waitcnt vmcnt(5)
    buffer_load_dwordx4 v[144:147], v76, s[52:55], s85 offen offset:0 nt
    v_mfma_f32_16x16x32_bf16 v[112:115], a[96:99], v[80:83], 0
    v_mfma_f32_16x16x32_bf16 v[112:115], a[100:103], v[84:87], v[112:115]
    v_mfma_f32_16x16x32_bf16 v[112:115], a[104:107], v[88:91], v[112:115]
    s_nop 2
    v_mov_b32_dpp v122, v96 quad_perm:[0,0,0,0] row_mask:0xf bank_mask:0xf
    v_mov_b32_dpp v124, v98 quad_perm:[2,2,2,2] row_mask:0xf bank_mask:0xf
    s_nop 0
    v_add_f32_dpp v122, v97, v122 quad_perm:[1,1,1,1] row_mask:0xf bank_mask:0xf
    v_add_f32_dpp v124, v99, v124 quad_perm:[3,3,3,3] row_mask:0xf bank_mask:0xf
    v_add_f32 v122, v122, v124
    v_max_f32 v65, v65, v122
    ds_write_b32 v64, v122 offset:3328
    v_lshlrev_b32 v30, 4, v3
    v_lshl_add_u32 v30, v2, 13, v30
    s_lshl_b32 s38, s32, 13
    s_add_u32 s36, s38, 0
    s_lshl_b32 s38, s34, 6
    s_add_u32 s36, s38, s36
    v_lshrrev_b32 v5, 2, v1
    v_lshlrev_b32 v32, 8, v5
    v_bfe_u32 v5, v1, 0, 2
    v_lshl_add_u32 v32, v5, 4, v32
    v_add_u32 v32, s36, v32
    s_lshr_b32 s38, s32, 2
    s_lshl_b32 s38, s38, 7
    s_add_u32 s36, s38, 0
    s_lshl_b32 s38, s34, 5
    s_add_u32 s36, s38, s36
    s_bfe_u32 s38, s32, 0x20000
    s_lshl_b32 s38, s38, 3
    s_add_u32 s36, s38, s36
    v_bfe_u32 v5, v1, 0, 2
    v_lshlrev_b32 v33, 11, v5
    v_lshl_add_u32 v33, v2, 1, v33
    v_add_u32 v33, s36, v33
    v_and_b32 v5, 31, v1
    v_lshlrev_b32 v34, 4, v5
    s_mul_i32 s38, s34, 320
    s_add_u32 s38, s38, 135168
    v_lshl_add_u32 v35, v5, 3, s38
    v_mfma_f32_16x16x32_bf16 v[112:115], a[108:111], v[92:95], v[112:115]
    s_waitcnt vmcnt(5)
    buffer_load_dwordx4 v[148:151], v77, s[52:55], s85 offen offset:0 nt
    v_mfma_f32_16x16x32_bf16 v[96:99], a[112:115], v[80:83], 0
    v_mfma_f32_16x16x32_bf16 v[96:99], a[116:119], v[84:87], v[96:99]
    v_mfma_f32_16x16x32_bf16 v[96:99], a[120:123], v[88:91], v[96:99]
    s_nop 2
    v_mov_b32_dpp v122, v112 quad_perm:[0,0,0,0] row_mask:0xf bank_mask:0xf
    v_mov_b32_dpp v124, v114 quad_perm:[2,2,2,2] row_mask:0xf bank_mask:0xf
    s_nop 0
    v_add_f32_dpp v122, v113, v122 quad_perm:[1,1,1,1] row_mask:0xf bank_mask:0xf
    v_add_f32_dpp v124, v115, v124 quad_perm:[3,3,3,3] row_mask:0xf bank_mask:0xf
    v_add_f32 v122, v122, v124
    v_max_f32 v65, v65, v122
    ds_write_b32 v64, v122 offset:3584
    v_mfma_f32_16x16x32_bf16 v[96:99], a[124:127], v[92:95], v[96:99]
    v_add_u32 v64, 3840, v64
    s_mov_b32 s97, 8
    s_mov_b32 s86, 32
    s_and_b32 s36, s32, 3
    s_sub_u32 s80, s36, 2
    s_cmp_ge_u32 s36, 2
    s_cselect_b32 s80, s80, 8
    s_cselect_b32 s81, 27, 25
    s_cmp_eq_u32 s80, s33
    s_cselect_b32 s36, 2, 0
    s_sub_u32 s86, s86, s36
    s_lshr_b32 s36, s36, 1
    s_sub_u32 s97, s97, s36
    s_add_u32 s80, s80, 35
    s_sub_u32 s92, s81, 1
    s_mov_b32 s66, 134217728
    s_mov_b32 s67, 0x20000
    s_mov_b64 s[64:65], s[52:53]
    v_mov_b32 v62, v76
    v_mov_b32 v63, v77
    s_branch L_bloop
L_ql:
    v_lshrrev_b32 v4, 2, v3
    v_and_b32 v5, 3, v3
    v_lshlrev_b32 v19, 6, v2
    v_lshl_add_u32 v19, v5, 4, v19
    v_lshl_add_u32 v14, v4, 18, v19
    s_and_b32 s61, s32, 28
    s_add_u32 s61, s61, s34
    s_and_b32 s60, s32, 3
    s_lshl_b32 s38, s60, 20
    s_add_u32 s63, s38, 0
    s_lshl_b32 s38, s61, 8
    s_add_u32 s63, s38, s63
    s_mov_b32 s74, 4194304
    s_mov_b32 s75, 0x20000
    s_waitcnt lgkmcnt(0)
    s_mov_b64 s[72:73], s[10:11]
    buffer_load_dwordx4 a[128:131], v14, s[72:75], s63 offen nt
    s_add_u32 s63, s63, 8192
    buffer_load_dwordx4 a[132:135], v14, s[72:75], s63 offen nt
    s_add_u32 s63, s63, 8192
    buffer_load_dwordx4 a[136:139], v14, s[72:75], s63 offen nt
    s_add_u32 s63, s63, 8192
    buffer_load_dwordx4 a[140:143], v14, s[72:75], s63 offen nt
    s_add_u32 s63, s63, 8192
    buffer_load_dwordx4 a[144:147], v14, s[72:75], s63 offen nt
    s_add_u32 s63, s63, 8192
    buffer_load_dwordx4 a[148:151], v14, s[72:75], s63 offen nt
    s_add_u32 s63, s63, 8192
    buffer_load_dwordx4 a[152:155], v14, s[72:75], s63 offen nt
    s_add_u32 s63, s63, 8192
    buffer_load_dwordx4 a[156:159], v14, s[72:75], s63 offen nt
    s_add_u32 s63, s63, 8192
    v_lshlrev_b32 v15, 1, v19
    v_lshl_add_u32 v15, v4, 9, v15
    v_lshl_add_u32 v19, v4, 15, v19
    s_load_dword s35, s[30:31], 0
    s_mov_b32 s48, s30
    s_and_b32 s49, s31, 0xffff
    s_mov_b32 s50, 8388608
    s_mov_b32 s51, 0x20000
    s_mov_b32 s82, 0xffffff00
    s_mov_b32 s83, 0x3e0293ee
    s_mov_b32 s84, 2097152
    s_lshl_b32 s38, s61, 12
    s_add_u32 s95, s38, 264192
    s_lshl_b32 s38, s61, 10
    s_add_u32 s94, s38, 393216
    s_lshl_b32 s38, s60, 8
    s_add_u32 s94, s38, s94
    s_waitcnt vmcnt(7)
    buffer_load_dwordx4 a[160:163], v14, s[72:75], s63 offen nt
    s_add_u32 s63, s63, 8192
    s_waitcnt vmcnt(7)
    buffer_load_dwordx4 a[164:167], v14, s[72:75], s63 offen nt
    s_add_u32 s63, s63, 8192
    s_waitcnt vmcnt(7)
    buffer_load_dwordx4 a[168:171], v14, s[72:75], s63 offen nt
    s_add_u32 s63, s63, 8192
    s_waitcnt vmcnt(7)
    buffer_load_dwordx4 a[172:175], v14, s[72:75], s63 offen nt
    s_add_u32 s63, s63, 8192
    s_waitcnt vmcnt(7)
    buffer_load_dwordx4 a[176:179], v14, s[72:75], s63 offen nt
    s_add_u32 s63, s63, 8192
    v_and_b32 v4, 1, v1
    v_lshlrev_b32 v4, 4, v4
    v_mov_b32 v5, 0xffff
    v_lshlrev_b32 v4, v4, v5
    v_bfe_u32 v5, v1, 1, 2
    v_cmp_eq_u32 vcc, 0, v5
    s_nop 1
    v_cndmask_b32 v10, 0, v4, vcc
    v_cmp_eq_u32 vcc, 1, v5
    s_nop 1
    v_cndmask_b32 v11, 0, v4, vcc
    v_cmp_eq_u32 vcc, 2, v5
    s_nop 1
    v_cndmask_b32 v12, 0, v4, vcc
    v_cmp_eq_u32 vcc, 3, v5
    s_nop 1
    v_cndmask_b32 v13, 0, v4, vcc
    s_waitcnt vmcnt(7)
    buffer_load_dwordx4 a[180:183], v14, s[72:75], s63 offen nt
    s_add_u32 s63, s63, 8192
    s_waitcnt vmcnt(7)
    buffer_load_dwordx4 a[184:187], v14, s[72:75], s63 offen nt
    s_add_u32 s63, s63, 8192
    s_waitcnt vmcnt(7)
    buffer_load_dwordx4 a[188:191], v14, s[72:75], s63 offen nt
    s_add_u32 s63, s63, 8192
    s_waitcnt vmcnt(7)
    buffer_load_dwordx4 a[192:195], v14, s[72:75], s63 offen nt
    s_add_u32 s63, s63, 8192
    v_lshrrev_b32 v4, 2, v3
    v_and_b32 v5, 3, v3
    v_lshlrev_b32 v76, 8, v4
    v_lshlrev_b32 v126, 8, v2
    v_lshl_add_u32 v76, v2, 6, v76
    v_lshl_add_u32 v76, v5, 4, v76
    v_lshl_add_u32 v126, v3, 4, v126
    v_xor_b32 v77, 32768, v76
    v_xor_b32 v127, 32768, v126
    s_add_u32 s3, s34, s33
    s_and_b32 s3, s3, 3
    s_lshl_b32 s89, s3, 5
    s_add_u32 s89, s89, s32
    s_lshl_b32 s89, s89, 20
    s_mul_i32 s88, s32, 8
    s_add_u32 s88, s88, s3
    s_lshl_b32 s87, s33, 0
    s_waitcnt vmcnt(7)
    buffer_load_dwordx4 a[196:199], v14, s[72:75], s63 offen nt
    s_add_u32 s63, s63, 8192
    s_waitcnt vmcnt(7)
    buffer_load_dwordx4 a[200:203], v14, s[72:75], s63 offen nt
    s_add_u32 s63, s63, 8192
    s_waitcnt vmcnt(7)
    buffer_load_dwordx4 a[204:207], v14, s[72:75], s63 offen nt
    s_add_u32 s63, s63, 8192
    s_waitcnt vmcnt(7)
    buffer_load_dwordx4 a[208:211], v14, s[72:75], s63 offen nt
    s_add_u32 s63, s63, 8192
    s_mov_b32 s52, s18
    s_and_b32 s53, s19, 0xffff
    s_mov_b32 s54, 134217728
    s_mov_b32 s55, 0x20000
    s_mov_b32 s56, s20
    s_and_b32 s57, s21, 0xffff
    s_mov_b32 s58, 134217728
    s_mov_b32 s59, 0x20000
    s_waitcnt vmcnt(7)
    buffer_load_dwordx4 a[212:215], v14, s[72:75], s63 offen nt
    s_add_u32 s63, s63, 8192
    s_waitcnt vmcnt(7)
    buffer_load_dwordx4 a[216:219], v14, s[72:75], s63 offen nt
    s_add_u32 s63, s63, 8192
    s_waitcnt vmcnt(7)
    buffer_load_dwordx4 a[220:223], v14, s[72:75], s63 offen nt
    s_add_u32 s63, s63, 8192
    s_waitcnt vmcnt(7)
    buffer_load_dwordx4 a[224:227], v14, s[72:75], s63 offen nt
    s_add_u32 s63, s63, 8192
    v_mov_b32 v120, 0xff7f0000
    v_mov_b32 v121, 0
    v_mov_b32 v18, 1
    v_mov_b32 v116, 0
    v_mov_b32 v117, 0
    v_mov_b32 v118, 0
    v_mov_b32 v119, 0
    s_lshl_b32 s38, s32, 10
    s_add_u32 s96, s38, 65536
    s_lshl_b32 s38, s3, 8
    s_add_u32 s96, s38, s96
    v_mov_b32 v9, s96
    s_lshl_b32 s38, s32, 15
    s_add_u32 s96, s38, 1048576
    s_lshl_b32 s38, s3, 13
    s_add_u32 s96, s38, s96
    s_lshl_b32 s38, s33, 10
    s_add_u32 s96, s38, s96
    v_and_b32 v5, 3, v3
    v_lshlrev_b32 v78, 7, v2
    v_lshl_add_u32 v78, v5, 5, v78
    s_lshl_b32 s38, s32, 12
    s_add_u32 s91, s38, 262144
    s_lshl_b32 s38, s3, 9
    s_add_u32 s91, s38, s91
    v_lshlrev_b32 v4, 7, v2
    v_lshl_add_u32 v4, v3, 4, v4
    v_mov_b32 v5, 512
    v_cmp_gt_u32 vcc, 8, v3
    s_nop 1
    v_cndmask_b32 v79, v5, v4, vcc
    s_waitcnt vmcnt(7)
    buffer_load_dwordx4 a[228:231], v14, s[72:75], s63 offen nt
    s_add_u32 s63, s63, 8192
    s_waitcnt vmcnt(7)
    buffer_load_dwordx4 a[232:235], v14, s[72:75], s63 offen nt
    s_add_u32 s63, s63, 8192
    s_waitcnt vmcnt(7)
    buffer_load_dwordx4 a[236:239], v14, s[72:75], s63 offen nt
    s_add_u32 s63, s63, 8192
    s_waitcnt vmcnt(7)
    buffer_load_dwordx4 a[240:243], v14, s[72:75], s63 offen nt
    s_add_u32 s63, s63, 8192
    s_waitcnt vmcnt(7)
    buffer_load_dwordx4 a[244:247], v14, s[72:75], s63 offen nt
    s_add_u32 s63, s63, 8192
    s_waitcnt vmcnt(7)
    buffer_load_dwordx4 a[248:251], v14, s[72:75], s63 offen nt
    s_add_u32 s63, s63, 8192
    s_waitcnt vmcnt(7)
    buffer_load_dwordx4 a[252:255], v14, s[72:75], s63 offen nt
    s_add_u32 s63, s63, 8192
    s_waitcnt lgkmcnt(0)
    s_add_u32 s35, s35, 0x5b
    s_and_b32 s35, s35, 0xff
    v_mov_b32 v8, s35
    s_or_b32 s68, s35, 0x6b3ac500
    s_waitcnt vmcnt(6)
    s_add_u32 s39, s87, s88
    s_bfe_u32 s37, s39, 0x30000
    s_lshl_b32 s37, s37, 12
    s_add_u32 s85, s37, s89
    s_bfe_u32 s37, s39, 0x10003
    s_lshl_b32 s37, s37, 11
    s_add_u32 s85, s37, s85
    s_bfe_u32 s37, s39, 0x40004
    s_lshl_b32 s37, s37, 16
    s_add_u32 s85, s37, s85
    buffer_load_dwordx4 v[128:131], v76, s[52:55], s85 offen offset:0 nt
    s_waitcnt vmcnt(6)
    buffer_load_dwordx4 v[132:135], v77, s[52:55], s85 offen offset:0 nt
    s_waitcnt vmcnt(6)
    buffer_load_dwordx4 v[136:139], v76, s[52:55], s85 offen offset:1024 nt
    s_waitcnt vmcnt(6)
    buffer_load_dwordx4 v[140:143], v77, s[52:55], s85 offen offset:1024 nt
    s_add_u32 s87, s87, 7
    s_add_u32 s39, s87, s88
    s_bfe_u32 s37, s39, 0x30000
    s_lshl_b32 s37, s37, 12
    s_add_u32 s85, s37, s89
    s_bfe_u32 s37, s39, 0x10003
    s_lshl_b32 s37, s37, 11
    s_add_u32 s85, s37, s85
    s_bfe_u32 s37, s39, 0x40004
    s_lshl_b32 s37, s37, 16
    s_add_u32 s85, s37, s85
    s_waitcnt vmcnt(6)
    buffer_load_dwordx4 v[144:147], v76, s[52:55], s85 offen offset:0 nt
    s_waitcnt vmcnt(6)
    buffer_load_dwordx4 v[148:151], v77, s[52:55], s85 offen offset:0 nt
    s_waitcnt vmcnt(6)
    buffer_load_dwordx4 v[152:155], v76, s[52:55], s85 offen offset:1024 nt
    s_waitcnt vmcnt(6)
    buffer_load_dwordx4 v[156:159], v77, s[52:55], s85 offen offset:1024 nt
    s_add_u32 s87, s87, 7
    s_add_u32 s39, s87, s88
    s_bfe_u32 s37, s39, 0x30000
    s_lshl_b32 s37, s37, 12
    s_add_u32 s85, s37, s89
    s_bfe_u32 s37, s39, 0x10003
    s_lshl_b32 s37, s37, 11
    s_add_u32 s85, s37, s85
    s_bfe_u32 s37, s39, 0x40004
    s_lshl_b32 s37, s37, 16
    s_add_u32 s85, s37, s85
    s_waitcnt vmcnt(6)
    buffer_load_dwordx4 v[160:163], v76, s[52:55], s85 offen offset:0 nt
    s_waitcnt vmcnt(6)
    buffer_load_dwordx4 v[164:167], v77, s[52:55], s85 offen offset:0 nt
    s_waitcnt vmcnt(6)
    buffer_load_dwordx4 v[168:171], v76, s[52:55], s85 offen offset:1024 nt
    s_waitcnt vmcnt(6)
    buffer_load_dwordx4 v[172:175], v77, s[52:55], s85 offen offset:1024 nt
    s_add_u32 s87, s87, 7
    s_add_u32 s39, s87, s88
    s_bfe_u32 s37, s39, 0x30000
    s_lshl_b32 s37, s37, 12
    s_add_u32 s85, s37, s89
    s_bfe_u32 s37, s39, 0x10003
    s_lshl_b32 s37, s37, 11
    s_add_u32 s85, s37, s85
    s_bfe_u32 s37, s39, 0x40004
    s_lshl_b32 s37, s37, 16
    s_add_u32 s85, s37, s85
    s_waitcnt vmcnt(6)
    buffer_load_dwordx4 v[176:179], v76, s[52:55], s85 offen offset:0 nt
    s_waitcnt vmcnt(6)
    buffer_load_dwordx4 v[180:183], v77, s[52:55], s85 offen offset:0 nt
    s_waitcnt vmcnt(6)
    buffer_load_dwordx4 v[184:187], v76, s[52:55], s85 offen offset:1024 nt
    s_waitcnt vmcnt(6)
    buffer_load_dwordx4 v[188:191], v77, s[52:55], s85 offen offset:1024 nt
    s_add_u32 s87, s87, 7
    s_add_u32 s39, s87, s88
    s_bfe_u32 s37, s39, 0x30000
    s_lshl_b32 s37, s37, 12
    s_add_u32 s85, s37, s89
    s_bfe_u32 s37, s39, 0x10003
    s_lshl_b32 s37, s37, 11
    s_add_u32 s85, s37, s85
    s_bfe_u32 s37, s39, 0x40004
    s_lshl_b32 s37, s37, 16
    s_add_u32 s85, s37, s85
    s_waitcnt vmcnt(6)
    buffer_load_dwordx4 v[192:195], v76, s[52:55], s85 offen offset:0 nt
    s_waitcnt vmcnt(6)
    buffer_load_dwordx4 v[196:199], v77, s[52:55], s85 offen offset:0 nt
    s_waitcnt vmcnt(6)
    buffer_load_dwordx4 v[200:203], v76, s[52:55], s85 offen offset:1024 nt
    s_waitcnt vmcnt(6)
    buffer_load_dwordx4 v[204:207], v77, s[52:55], s85 offen offset:1024 nt
    s_add_u32 s87, s87, 7
    s_add_u32 s39, s87, s88
    s_bfe_u32 s37, s39, 0x30000
    s_lshl_b32 s37, s37, 12
    s_add_u32 s85, s37, s89
    s_bfe_u32 s37, s39, 0x10003
    s_lshl_b32 s37, s37, 11
    s_add_u32 s85, s37, s85
    s_bfe_u32 s37, s39, 0x40004
    s_lshl_b32 s37, s37, 16
    s_add_u32 s85, s37, s85
    s_waitcnt vmcnt(6)
    buffer_load_dwordx4 v[208:211], v76, s[52:55], s85 offen offset:0 nt
    s_waitcnt vmcnt(6)
    buffer_load_dwordx4 v[212:215], v77, s[52:55], s85 offen offset:0 nt
    s_waitcnt vmcnt(6)
    buffer_load_dwordx4 v[216:219], v76, s[52:55], s85 offen offset:1024 nt
    s_waitcnt vmcnt(6)
    buffer_load_dwordx4 v[220:223], v77, s[52:55], s85 offen offset:1024 nt
    s_add_u32 s87, s87, 7
    s_add_u32 s39, s87, s88
    s_bfe_u32 s37, s39, 0x30000
    s_lshl_b32 s37, s37, 12
    s_add_u32 s85, s37, s89
    s_bfe_u32 s37, s39, 0x10003
    s_lshl_b32 s37, s37, 11
    s_add_u32 s85, s37, s85
    s_bfe_u32 s37, s39, 0x40004
    s_lshl_b32 s37, s37, 16
    s_add_u32 s85, s37, s85
    s_waitcnt vmcnt(6)
    buffer_load_dwordx4 v[224:227], v76, s[52:55], s85 offen offset:0 nt
    s_waitcnt vmcnt(6)
    buffer_load_dwordx4 v[228:231], v77, s[52:55], s85 offen offset:0 nt
    s_waitcnt vmcnt(6)
    buffer_load_dwordx4 v[232:235], v76, s[52:55], s85 offen offset:1024 nt
    s_waitcnt vmcnt(6)
    buffer_load_dwordx4 v[236:239], v77, s[52:55], s85 offen offset:1024 nt
    s_add_u32 s87, s87, 7
    s_add_u32 s39, s87, s88
    s_bfe_u32 s37, s39, 0x30000
    s_lshl_b32 s37, s37, 12
    s_add_u32 s85, s37, s89
    s_bfe_u32 s37, s39, 0x10003
    s_lshl_b32 s37, s37, 11
    s_add_u32 s85, s37, s85
    s_bfe_u32 s37, s39, 0x40004
    s_lshl_b32 s37, s37, 16
    s_add_u32 s85, s37, s85
    s_waitcnt vmcnt(6)
    buffer_load_dwordx4 v[240:243], v76, s[52:55], s85 offen offset:0 nt
    s_waitcnt vmcnt(6)
    buffer_load_dwordx4 v[244:247], v77, s[52:55], s85 offen offset:0 nt
    buffer_load_dwordx4 v[20:23], v15, s[48:51], s95 offen offset:0 sc1
    buffer_load_dwordx4 v[24:27], v15, s[48:51], s95 offen offset:16 sc1
    s_waitcnt vmcnt(8)
    buffer_load_dwordx4 v[248:251], v76, s[52:55], s85 offen offset:1024 nt
    s_waitcnt vmcnt(8)
    buffer_load_dwordx4 v[252:255], v77, s[52:55], s85 offen offset:1024 nt
    s_add_u32 s87, s87, 7
    s_add_u32 s39, s87, s88
    s_bfe_u32 s37, s39, 0x30000
    s_lshl_b32 s37, s37, 12
    s_add_u32 s85, s37, s89
    s_bfe_u32 s37, s39, 0x10003
    s_lshl_b32 s37, s37, 11
    s_add_u32 s85, s37, s85
    s_bfe_u32 s37, s39, 0x40004
    s_lshl_b32 s37, s37, 16
    s_add_u32 s85, s37, s85
    s_waitcnt vmcnt(8)
    buffer_load_dwordx4 a[0:3], v76, s[52:55], s85 offen offset:0 nt
    s_waitcnt vmcnt(8)
    buffer_load_dwordx4 a[4:7], v77, s[52:55], s85 offen offset:0 nt
    s_waitcnt vmcnt(8)
    buffer_load_dwordx4 a[8:11], v76, s[52:55], s85 offen offset:1024 nt
    s_waitcnt vmcnt(8)
    buffer_load_dwordx4 a[12:15], v77, s[52:55], s85 offen offset:1024 nt
    s_add_u32 s87, s87, 7
    s_add_u32 s39, s87, s88
    s_bfe_u32 s37, s39, 0x30000
    s_lshl_b32 s37, s37, 12
    s_add_u32 s85, s37, s89
    s_bfe_u32 s37, s39, 0x10003
    s_lshl_b32 s37, s37, 11
    s_add_u32 s85, s37, s85
    s_bfe_u32 s37, s39, 0x40004
    s_lshl_b32 s37, s37, 16
    s_add_u32 s85, s37, s85
    s_waitcnt vmcnt(6)
L_qacheck_14:
    v_xor_b32 v20, s35, v20
    v_xor_b32 v21, s35, v21
    v_xor_b32 v22, s35, v22
    v_xor_b32 v23, s35, v23
    v_xor_b32 v24, s35, v24
    v_xor_b32 v25, s35, v25
    v_xor_b32 v26, s35, v26
    v_xor_b32 v27, s35, v27
    v_or_b32 v4, v20, v21
    v_or3_b32 v4, v4, v22, v23
    v_or3_b32 v4, v4, v24, v25
    v_or3_b32 v4, v4, v26, v27
    v_and_b32 v4, 0xff, v4
    v_cmp_ne_u32 vcc, 0, v4
    s_cbranch_vccz L_qaok_15
    buffer_load_dwordx4 v[20:23], v15, s[48:51], s95 offen offset:0 sc1
    buffer_load_dwordx4 v[24:27], v15, s[48:51], s95 offen offset:16 sc1
    s_waitcnt vmcnt(0)
    s_sub_u32 s84, s84, 1
    s_cmp_lg_u32 s84, 0
    s_cbranch_scc1 L_qacheck_14
    s_branch L_end
L_qaok_15:
    buffer_load_dwordx4 v[68:71], v78, s[48:51], s91 offen offset:0 sc1
    buffer_load_dwordx4 v[72:75], v78, s[48:51], s91 offen offset:16 sc1
    v_cvt_pk_bf16_f32 v20, v20, v21
    v_cvt_pk_bf16_f32 v21, v22, v23
    v_cvt_pk_bf16_f32 v22, v24, v25
    v_cvt_pk_bf16_f32 v23, v26, v27
    s_nop 1
    v_mfma_f32_16x16x32_bf16 v[28:31], a[128:131], v[20:23], 0
    v_mfma_f32_16x16x32_bf16 v[32:35], a[132:135], v[20:23], 0
    v_mfma_f32_16x16x32_bf16 v[36:39], a[136:139], v[20:23], 0
    s_nop 5
    v_mov_b32_dpp v60, v28 quad_perm:[0,0,0,0] row_mask:0xf bank_mask:0xf
    v_mov_b32_dpp v4, v30 quad_perm:[2,2,2,2] row_mask:0xf bank_mask:0xf
    s_nop 0
    v_add_f32_dpp v60, v29, v60 quad_perm:[1,1,1,1] row_mask:0xf bank_mask:0xf
    v_add_f32_dpp v4, v31, v4 quad_perm:[3,3,3,3] row_mask:0xf bank_mask:0xf
    v_add_f32 v60, v60, v4
    v_mfma_f32_16x16x32_bf16 v[40:43], a[140:143], v[20:23], 0
    v_mov_b32_dpp v61, v32 quad_perm:[0,0,0,0] row_mask:0xf bank_mask:0xf
    v_mov_b32_dpp v4, v34 quad_perm:[2,2,2,2] row_mask:0xf bank_mask:0xf
    s_nop 0
    v_add_f32_dpp v61, v33, v61 quad_perm:[1,1,1,1] row_mask:0xf bank_mask:0xf
    v_add_f32_dpp v4, v35, v4 quad_perm:[3,3,3,3] row_mask:0xf bank_mask:0xf
    v_add_f32 v61, v61, v4
    v_cvt_pk_bf16_f32 v44, v60, v61
    v_mfma_f32_16x16x32_bf16 v[28:31], a[144:147], v[20:23], 0
    v_mov_b32_dpp v60, v36 quad_perm:[0,0,0,0] row_mask:0xf bank_mask:0xf
    v_mov_b32_dpp v4, v38 quad_perm:[2,2,2,2] row_mask:0xf bank_mask:0xf
    s_nop 0
    v_add_f32_dpp v60, v37, v60 quad_perm:[1,1,1,1] row_mask:0xf bank_mask:0xf
    v_add_f32_dpp v4, v39, v4 quad_perm:[3,3,3,3] row_mask:0xf bank_mask:0xf
    v_add_f32 v60, v60, v4
    buffer_load_dwordx4 a[16:19], v76, s[52:55], s85 offen offset:0 nt
    v_mfma_f32_16x16x32_bf16 v[32:35], a[148:151], v[20:23], 0
    v_mov_b32_dpp v61, v40 quad_perm:[0,0,0,0] row_mask:0xf bank_mask:0xf
    v_mov_b32_dpp v4, v42 quad_perm:[2,2,2,2] row_mask:0xf bank_mask:0xf
    s_nop 0
    v_add_f32_dpp v61, v41, v61 quad_perm:[1,1,1,1] row_mask:0xf bank_mask:0xf
    v_add_f32_dpp v4, v43, v4 quad_perm:[3,3,3,3] row_mask:0xf bank_mask:0xf
    v_add_f32 v61, v61, v4
    v_cvt_pk_bf16_f32 v45, v60, v61
    v_mfma_f32_16x16x32_bf16 v[36:39], a[152:155], v[20:23], 0
    v_mov_b32_dpp v60, v28 quad_perm:[0,0,0,0] row_mask:0xf bank_mask:0xf
    v_mov_b32_dpp v4, v30 quad_perm:[2,2,2,2] row_mask:0xf bank_mask:0xf
    s_nop 0
    v_add_f32_dpp v60, v29, v60 quad_perm:[1,1,1,1] row_mask:0xf bank_mask:0xf
    v_add_f32_dpp v4, v31, v4 quad_perm:[3,3,3,3] row_mask:0xf bank_mask:0xf
    v_add_f32 v60, v60, v4
    v_mfma_f32_16x16x32_bf16 v[40:43], a[156:159], v[20:23], 0
    v_mov_b32_dpp v61, v32 quad_perm:[0,0,0,0] row_mask:0xf bank_mask:0xf
    v_mov_b32_dpp v4, v34 quad_perm:[2,2,2,2] row_mask:0xf bank_mask:0xf
    s_nop 0
    v_add_f32_dpp v61, v33, v61 quad_perm:[1,1,1,1] row_mask:0xf bank_mask:0xf
    v_add_f32_dpp v4, v35, v4 quad_perm:[3,3,3,3] row_mask:0xf bank_mask:0xf
    v_add_f32 v61, v61, v4
    v_cvt_pk_bf16_f32 v46, v60, v61
    v_mfma_f32_16x16x32_bf16 v[28:31], a[160:163], v[20:23], 0
    v_mov_b32_dpp v60, v36 quad_perm:[0,0,0,0] row_mask:0xf bank_mask:0xf
    v_mov_b32_dpp v4, v38 quad_perm:[2,2,2,2] row_mask:0xf bank_mask:0xf
    s_nop 0
    v_add_f32_dpp v60, v37, v60 quad_perm:[1,1,1,1] row_mask:0xf bank_mask:0xf
    v_add_f32_dpp v4, v39, v4 quad_perm:[3,3,3,3] row_mask:0xf bank_mask:0xf
    v_add_f32 v60, v60, v4
    v_mfma_f32_16x16x32_bf16 v[32:35], a[164:167], v[20:23], 0
    v_mov_b32_dpp v61, v40 quad_perm:[0,0,0,0] row_mask:0xf bank_mask:0xf
    v_mov_b32_dpp v4, v42 quad_perm:[2,2,2,2] row_mask:0xf bank_mask:0xf
    s_nop 0
    v_add_f32_dpp v61, v41, v61 quad_perm:[1,1,1,1] row_mask:0xf bank_mask:0xf
    v_add_f32_dpp v4, v43, v4 quad_perm:[3,3,3,3] row_mask:0xf bank_mask:0xf
    v_add_f32 v61, v61, v4
    v_cvt_pk_bf16_f32 v47, v60, v61
    v_mfma_f32_16x16x32_bf16 v[36:39], a[168:171], v[20:23], 0
    v_mov_b32_dpp v60, v28 quad_perm:[0,0,0,0] row_mask:0xf bank_mask:0xf
    v_mov_b32_dpp v4, v30 quad_perm:[2,2,2,2] row_mask:0xf bank_mask:0xf
    s_nop 0
    v_add_f32_dpp v60, v29, v60 quad_perm:[1,1,1,1] row_mask:0xf bank_mask:0xf
    v_add_f32_dpp v4, v31, v4 quad_perm:[3,3,3,3] row_mask:0xf bank_mask:0xf
    v_add_f32 v60, v60, v4
    v_mfma_f32_16x16x32_bf16 v[40:43], a[172:175], v[20:23], 0
    v_mov_b32_dpp v61, v32 quad_perm:[0,0,0,0] row_mask:0xf bank_mask:0xf
    v_mov_b32_dpp v4, v34 quad_perm:[2,2,2,2] row_mask:0xf bank_mask:0xf
    s_nop 0
    v_add_f32_dpp v61, v33, v61 quad_perm:[1,1,1,1] row_mask:0xf bank_mask:0xf
    v_add_f32_dpp v4, v35, v4 quad_perm:[3,3,3,3] row_mask:0xf bank_mask:0xf
    v_add_f32 v61, v61, v4
    v_cvt_pk_bf16_f32 v48, v60, v61
    v_mfma_f32_16x16x32_bf16 v[28:31], a[176:179], v[20:23], 0
    v_mov_b32_dpp v60, v36 quad_perm:[0,0,0,0] row_mask:0xf bank_mask:0xf
    v_mov_b32_dpp v4, v38 quad_perm:[2,2,2,2] row_mask:0xf bank_mask:0xf
    s_nop 0
    v_add_f32_dpp v60, v37, v60 quad_perm:[1,1,1,1] row_mask:0xf bank_mask:0xf
    v_add_f32_dpp v4, v39, v4 quad_perm:[3,3,3,3] row_mask:0xf bank_mask:0xf
    v_add_f32 v60, v60, v4
    buffer_load_dwordx4 a[20:23], v77, s[52:55], s85 offen offset:0 nt
    v_mfma_f32_16x16x32_bf16 v[32:35], a[180:183], v[20:23], 0
    v_mov_b32_dpp v61, v40 quad_perm:[0,0,0,0] row_mask:0xf bank_mask:0xf
    v_mov_b32_dpp v4, v42 quad_perm:[2,2,2,2] row_mask:0xf bank_mask:0xf
    s_nop 0
    v_add_f32_dpp v61, v41, v61 quad_perm:[1,1,1,1] row_mask:0xf bank_mask:0xf
    v_add_f32_dpp v4, v43, v4 quad_perm:[3,3,3,3] row_mask:0xf bank_mask:0xf
    v_add_f32 v61, v61, v4
    v_cvt_pk_bf16_f32 v49, v60, v61
    v_mfma_f32_16x16x32_bf16 v[36:39], a[184:187], v[20:23], 0
    v_mov_b32_dpp v60, v28 quad_perm:[0,0,0,0] row_mask:0xf bank_mask:0xf
    v_mov_b32_dpp v4, v30 quad_perm:[2,2,2,2] row_mask:0xf bank_mask:0xf
    s_nop 0
    v_add_f32_dpp v60, v29, v60 quad_perm:[1,1,1,1] row_mask:0xf bank_mask:0xf
    v_add_f32_dpp v4, v31, v4 quad_perm:[3,3,3,3] row_mask:0xf bank_mask:0xf
    v_add_f32 v60, v60, v4
    v_mfma_f32_16x16x32_bf16 v[40:43], a[188:191], v[20:23], 0
    v_mov_b32_dpp v61, v32 quad_perm:[0,0,0,0] row_mask:0xf bank_mask:0xf
    v_mov_b32_dpp v4, v34 quad_perm:[2,2,2,2] row_mask:0xf bank_mask:0xf
    s_nop 0
    v_add_f32_dpp v61, v33, v61 quad_perm:[1,1,1,1] row_mask:0xf bank_mask:0xf
    v_add_f32_dpp v4, v35, v4 quad_perm:[3,3,3,3] row_mask:0xf bank_mask:0xf
    v_add_f32 v61, v61, v4
    v_cvt_pk_bf16_f32 v50, v60, v61
    v_mfma_f32_16x16x32_bf16 v[28:31], a[192:195], v[20:23], 0
    v_mov_b32_dpp v60, v36 quad_perm:[0,0,0,0] row_mask:0xf bank_mask:0xf
    v_mov_b32_dpp v4, v38 quad_perm:[2,2,2,2] row_mask:0xf bank_mask:0xf
    s_nop 0
    v_add_f32_dpp v60, v37, v60 quad_perm:[1,1,1,1] row_mask:0xf bank_mask:0xf
    v_add_f32_dpp v4, v39, v4 quad_perm:[3,3,3,3] row_mask:0xf bank_mask:0xf
    v_add_f32 v60, v60, v4
    v_mfma_f32_16x16x32_bf16 v[32:35], a[196:199], v[20:23], 0
    v_mov_b32_dpp v61, v40 quad_perm:[0,0,0,0] row_mask:0xf bank_mask:0xf
    v_mov_b32_dpp v4, v42 quad_perm:[2,2,2,2] row_mask:0xf bank_mask:0xf
    s_nop 0
    v_add_f32_dpp v61, v41, v61 quad_perm:[1,1,1,1] row_mask:0xf bank_mask:0xf
    v_add_f32_dpp v4, v43, v4 quad_perm:[3,3,3,3] row_mask:0xf bank_mask:0xf
    v_add_f32 v61, v61, v4
    v_cvt_pk_bf16_f32 v51, v60, v61
    v_mfma_f32_16x16x32_bf16 v[36:39], a[200:203], v[20:23], 0
    v_mov_b32_dpp v60, v28 quad_perm:[0,0,0,0] row_mask:0xf bank_mask:0xf
    v_mov_b32_dpp v4, v30 quad_perm:[2,2,2,2] row_mask:0xf bank_mask:0xf
    s_nop 0
    v_add_f32_dpp v60, v29, v60 quad_perm:[1,1,1,1] row_mask:0xf bank_mask:0xf
    v_add_f32_dpp v4, v31, v4 quad_perm:[3,3,3,3] row_mask:0xf bank_mask:0xf
    v_add_f32 v60, v60, v4
    v_mfma_f32_16x16x32_bf16 v[40:43], a[204:207], v[20:23], 0
    v_mov_b32_dpp v61, v32 quad_perm:[0,0,0,0] row_mask:0xf bank_mask:0xf
    v_mov_b32_dpp v4, v34 quad_perm:[2,2,2,2] row_mask:0xf bank_mask:0xf
    s_nop 0
    v_add_f32_dpp v61, v33, v61 quad_perm:[1,1,1,1] row_mask:0xf bank_mask:0xf
    v_add_f32_dpp v4, v35, v4 quad_perm:[3,3,3,3] row_mask:0xf bank_mask:0xf
    v_add_f32 v61, v61, v4
    v_cvt_pk_bf16_f32 v52, v60, v61
    v_mfma_f32_16x16x32_bf16 v[28:31], a[208:211], v[20:23], 0
    v_mov_b32_dpp v60, v36 quad_perm:[0,0,0,0] row_mask:0xf bank_mask:0xf
    v_mov_b32_dpp v4, v38 quad_perm:[2,2,2,2] row_mask:0xf bank_mask:0xf
    s_nop 0
    v_add_f32_dpp v60, v37, v60 quad_perm:[1,1,1,1] row_mask:0xf bank_mask:0xf
    v_add_f32_dpp v4, v39, v4 quad_perm:[3,3,3,3] row_mask:0xf bank_mask:0xf
    v_add_f32 v60, v60, v4
    buffer_load_dwordx4 a[24:27], v76, s[52:55], s85 offen offset:1024 nt
    v_mfma_f32_16x16x32_bf16 v[32:35], a[212:215], v[20:23], 0
    v_mov_b32_dpp v61, v40 quad_perm:[0,0,0,0] row_mask:0xf bank_mask:0xf
    v_mov_b32_dpp v4, v42 quad_perm:[2,2,2,2] row_mask:0xf bank_mask:0xf
    s_nop 0
    v_add_f32_dpp v61, v41, v61 quad_perm:[1,1,1,1] row_mask:0xf bank_mask:0xf
    v_add_f32_dpp v4, v43, v4 quad_perm:[3,3,3,3] row_mask:0xf bank_mask:0xf
    v_add_f32 v61, v61, v4
    v_cvt_pk_bf16_f32 v53, v60, v61
    v_mfma_f32_16x16x32_bf16 v[36:39], a[216:219], v[20:23], 0
    v_mov_b32_dpp v60, v28 quad_perm:[0,0,0,0] row_mask:0xf bank_mask:0xf
    v_mov_b32_dpp v4, v30 quad_perm:[2,2,2,2] row_mask:0xf bank_mask:0xf
    s_nop 0
    v_add_f32_dpp v60, v29, v60 quad_perm:[1,1,1,1] row_mask:0xf bank_mask:0xf
    v_add_f32_dpp v4, v31, v4 quad_perm:[3,3,3,3] row_mask:0xf bank_mask:0xf
    v_add_f32 v60, v60, v4
    v_mfma_f32_16x16x32_bf16 v[40:43], a[220:223], v[20:23], 0
    v_mov_b32_dpp v61, v32 quad_perm:[0,0,0,0] row_mask:0xf bank_mask:0xf
    v_mov_b32_dpp v4, v34 quad_perm:[2,2,2,2] row_mask:0xf bank_mask:0xf
    s_nop 0
    v_add_f32_dpp v61, v33, v61 quad_perm:[1,1,1,1] row_mask:0xf bank_mask:0xf
    v_add_f32_dpp v4, v35, v4 quad_perm:[3,3,3,3] row_mask:0xf bank_mask:0xf
    v_add_f32 v61, v61, v4
    v_cvt_pk_bf16_f32 v54, v60, v61
    v_mfma_f32_16x16x32_bf16 v[28:31], a[224:227], v[20:23], 0
    v_mov_b32_dpp v60, v36 quad_perm:[0,0,0,0] row_mask:0xf bank_mask:0xf
    v_mov_b32_dpp v4, v38 quad_perm:[2,2,2,2] row_mask:0xf bank_mask:0xf
    s_nop 0
    v_add_f32_dpp v60, v37, v60 quad_perm:[1,1,1,1] row_mask:0xf bank_mask:0xf
    v_add_f32_dpp v4, v39, v4 quad_perm:[3,3,3,3] row_mask:0xf bank_mask:0xf
    v_add_f32 v60, v60, v4
    v_mfma_f32_16x16x32_bf16 v[32:35], a[228:231], v[20:23], 0
    v_mov_b32_dpp v61, v40 quad_perm:[0,0,0,0] row_mask:0xf bank_mask:0xf
    v_mov_b32_dpp v4, v42 quad_perm:[2,2,2,2] row_mask:0xf bank_mask:0xf
    s_nop 0
    v_add_f32_dpp v61, v41, v61 quad_perm:[1,1,1,1] row_mask:0xf bank_mask:0xf
    v_add_f32_dpp v4, v43, v4 quad_perm:[3,3,3,3] row_mask:0xf bank_mask:0xf
    v_add_f32 v61, v61, v4
    v_cvt_pk_bf16_f32 v55, v60, v61
    v_mfma_f32_16x16x32_bf16 v[36:39], a[232:235], v[20:23], 0
    v_mov_b32_dpp v60, v28 quad_perm:[0,0,0,0] row_mask:0xf bank_mask:0xf
    v_mov_b32_dpp v4, v30 quad_perm:[2,2,2,2] row_mask:0xf bank_mask:0xf
    s_nop 0
    v_add_f32_dpp v60, v29, v60 quad_perm:[1,1,1,1] row_mask:0xf bank_mask:0xf
    v_add_f32_dpp v4, v31, v4 quad_perm:[3,3,3,3] row_mask:0xf bank_mask:0xf
    v_add_f32 v60, v60, v4
    v_mfma_f32_16x16x32_bf16 v[40:43], a[236:239], v[20:23], 0
    v_mov_b32_dpp v61, v32 quad_perm:[0,0,0,0] row_mask:0xf bank_mask:0xf
    v_mov_b32_dpp v4, v34 quad_perm:[2,2,2,2] row_mask:0xf bank_mask:0xf
    s_nop 0
    v_add_f32_dpp v61, v33, v61 quad_perm:[1,1,1,1] row_mask:0xf bank_mask:0xf
    v_add_f32_dpp v4, v35, v4 quad_perm:[3,3,3,3] row_mask:0xf bank_mask:0xf
    v_add_f32 v61, v61, v4
    v_cvt_pk_bf16_f32 v56, v60, v61
    v_mfma_f32_16x16x32_bf16 v[28:31], a[240:243], v[20:23], 0
    v_mov_b32_dpp v60, v36 quad_perm:[0,0,0,0] row_mask:0xf bank_mask:0xf
    v_mov_b32_dpp v4, v38 quad_perm:[2,2,2,2] row_mask:0xf bank_mask:0xf
    s_nop 0
    v_add_f32_dpp v60, v37, v60 quad_perm:[1,1,1,1] row_mask:0xf bank_mask:0xf
    v_add_f32_dpp v4, v39, v4 quad_perm:[3,3,3,3] row_mask:0xf bank_mask:0xf
    v_add_f32 v60, v60, v4
    buffer_load_dwordx4 a[28:31], v77, s[52:55], s85 offen offset:1024 nt
    s_add_u32 s87, s87, 7
    s_add_u32 s39, s87, s88
    s_bfe_u32 s37, s39, 0x30000
    s_lshl_b32 s37, s37, 12
    s_add_u32 s85, s37, s89
    s_bfe_u32 s37, s39, 0x10003
    s_lshl_b32 s37, s37, 11
    s_add_u32 s85, s37, s85
    s_bfe_u32 s37, s39, 0x40004
    s_lshl_b32 s37, s37, 16
    s_add_u32 s85, s37, s85
    v_mfma_f32_16x16x32_bf16 v[32:35], a[244:247], v[20:23], 0
    v_mov_b32_dpp v61, v40 quad_perm:[0,0,0,0] row_mask:0xf bank_mask:0xf
    v_mov_b32_dpp v4, v42 quad_perm:[2,2,2,2] row_mask:0xf bank_mask:0xf
    s_nop 0
    v_add_f32_dpp v61, v41, v61 quad_perm:[1,1,1,1] row_mask:0xf bank_mask:0xf
    v_add_f32_dpp v4, v43, v4 quad_perm:[3,3,3,3] row_mask:0xf bank_mask:0xf
    v_add_f32 v61, v61, v4
    v_cvt_pk_bf16_f32 v57, v60, v61
    v_mfma_f32_16x16x32_bf16 v[36:39], a[248:251], v[20:23], 0
    v_mov_b32_dpp v60, v28 quad_perm:[0,0,0,0] row_mask:0xf bank_mask:0xf
    v_mov_b32_dpp v4, v30 quad_perm:[2,2,2,2] row_mask:0xf bank_mask:0xf
    s_nop 0
    v_add_f32_dpp v60, v29, v60 quad_perm:[1,1,1,1] row_mask:0xf bank_mask:0xf
    v_add_f32_dpp v4, v31, v4 quad_perm:[3,3,3,3] row_mask:0xf bank_mask:0xf
    v_add_f32 v60, v60, v4
    v_mfma_f32_16x16x32_bf16 v[40:43], a[252:255], v[20:23], 0
    v_mov_b32_dpp v61, v32 quad_perm:[0,0,0,0] row_mask:0xf bank_mask:0xf
    v_mov_b32_dpp v4, v34 quad_perm:[2,2,2,2] row_mask:0xf bank_mask:0xf
    s_nop 0
    v_add_f32_dpp v61, v33, v61 quad_perm:[1,1,1,1] row_mask:0xf bank_mask:0xf
    v_add_f32_dpp v4, v35, v4 quad_perm:[3,3,3,3] row_mask:0xf bank_mask:0xf
    v_add_f32 v61, v61, v4
    v_cvt_pk_bf16_f32 v58, v60, v61
    v_mov_b32_dpp v60, v36 quad_perm:[0,0,0,0] row_mask:0xf bank_mask:0xf
    v_mov_b32_dpp v4, v38 quad_perm:[2,2,2,2] row_mask:0xf bank_mask:0xf
    s_nop 0
    v_add_f32_dpp v60, v37, v60 quad_perm:[1,1,1,1] row_mask:0xf bank_mask:0xf
    v_add_f32_dpp v4, v39, v4 quad_perm:[3,3,3,3] row_mask:0xf bank_mask:0xf
    v_add_f32 v60, v60, v4
    v_mov_b32_dpp v61, v40 quad_perm:[0,0,0,0] row_mask:0xf bank_mask:0xf
    v_mov_b32_dpp v4, v42 quad_perm:[2,2,2,2] row_mask:0xf bank_mask:0xf
    s_nop 0
    v_add_f32_dpp v61, v41, v61 quad_perm:[1,1,1,1] row_mask:0xf bank_mask:0xf
    v_add_f32_dpp v4, v43, v4 quad_perm:[3,3,3,3] row_mask:0xf bank_mask:0xf
    v_add_f32 v61, v61, v4
    v_cvt_pk_bf16_f32 v59, v60, v61
    s_mov_b32 exec_lo, 0x22222222
    s_mov_b32 exec_hi, 0x22222222
    v_mov_b32 v44, v48
    v_mov_b32 v45, v49
    v_mov_b32 v46, v50
    v_mov_b32 v47, v51
    s_mov_b32 exec_lo, 0x44444444
    s_mov_b32 exec_hi, 0x44444444
    v_mov_b32 v44, v52
    v_mov_b32 v45, v53
    v_mov_b32 v46, v54
    v_mov_b32 v47, v55
    s_mov_b32 exec_lo, 0x88888888
    s_mov_b32 exec_hi, 0x88888888
    v_mov_b32 v44, v56
    v_mov_b32 v45, v57
    v_mov_b32 v46, v58
    v_mov_b32 v47, v59
    s_mov_b64 exec, -1
    buffer_store_dwordx4 v[44:47], v19, s[48:51], s94 offen sc1
    s_waitcnt vmcnt(5)
L_qcheck_16:
    v_xor_b32 v68, s35, v68
    v_xor_b32 v69, s35, v69
    v_xor_b32 v70, s35, v70
    v_xor_b32 v71, s35, v71
    v_xor_b32 v72, s35, v72
    v_xor_b32 v73, s35, v73
    v_xor_b32 v74, s35, v74
    v_xor_b32 v75, s35, v75
    v_or_b32 v4, v68, v69
    v_or3_b32 v4, v4, v70, v71
    v_or3_b32 v4, v4, v72, v73
    v_or3_b32 v4, v4, v74, v75
    v_and_b32 v4, 0xff, v4
    v_cmp_ne_u32 vcc, 0, v4
    s_cbranch_vccz L_qok_17
    buffer_load_dwordx4 v[68:71], v78, s[48:51], s91 offen offset:0 sc1
    buffer_load_dwordx4 v[72:75], v78, s[48:51], s91 offen offset:16 sc1
    s_waitcnt vmcnt(0)
    s_sub_u32 s84, s84, 1
    s_cmp_lg_u32 s84, 0
    s_cbranch_scc1 L_qcheck_16
    s_branch L_end
L_qok_17:
    v_cvt_pk_bf16_f32 v68, v68, v69
    v_cvt_pk_bf16_f32 v69, v70, v71
    v_cvt_pk_bf16_f32 v70, v72, v73
    v_cvt_pk_bf16_f32 v71, v74, v75
    s_mov_b32 vcc_lo, 0xf000f
    s_mov_b32 vcc_hi, 0xf000f
    v_cndmask_b32 v80, 0, v68, vcc
    v_cndmask_b32 v81, 0, v69, vcc
    v_cndmask_b32 v82, 0, v70, vcc
    v_cndmask_b32 v83, 0, v71, vcc
    s_mov_b32 vcc_lo, 0xf000f0
    s_mov_b32 vcc_hi, 0xf000f0
    v_cndmask_b32 v84, 0, v68, vcc
    v_cndmask_b32 v85, 0, v69, vcc
    v_cndmask_b32 v86, 0, v70, vcc
    v_cndmask_b32 v87, 0, v71, vcc
    s_mov_b32 vcc_lo, 0xf000f00
    s_mov_b32 vcc_hi, 0xf000f00
    v_cndmask_b32 v88, 0, v68, vcc
    v_cndmask_b32 v89, 0, v69, vcc
    v_cndmask_b32 v90, 0, v70, vcc
    v_cndmask_b32 v91, 0, v71, vcc
    s_mov_b32 vcc_lo, 0xf000f000
    s_mov_b32 vcc_hi, 0xf000f000
    v_cndmask_b32 v92, 0, v68, vcc
    v_cndmask_b32 v93, 0, v69, vcc
    v_cndmask_b32 v94, 0, v70, vcc
    v_cndmask_b32 v95, 0, v71, vcc
    v_mov_b32 v65, 0xff7f0000
    s_lshl_b32 s38, s34, 14
    s_add_u32 s38, s38, 16384
    v_lshl_add_u32 v64, v1, 2, s38
    buffer_load_dwordx4 a[32:35], v76, s[52:55], s85 offen offset:0 nt
    v_mfma_f32_16x16x32_bf16 v[112:115], v[128:131], v[80:83], 0
    v_mfma_f32_16x16x32_bf16 v[112:115], v[132:135], v[84:87], v[112:115]
    buffer_load_dwordx4 a[36:39], v77, s[52:55], s85 offen offset:0 nt
    v_mfma_f32_16x16x32_bf16 v[112:115], v[136:139], v[88:91], v[112:115]
    v_mfma_f32_16x16x32_bf16 v[112:115], v[140:143], v[92:95], v[112:115]
    buffer_load_dwordx4 a[40:43], v76, s[52:55], s85 offen offset:1024 nt
    v_mfma_f32_16x16x32_bf16 v[96:99], v[144:147], v[80:83], 0
    v_mfma_f32_16x16x32_bf16 v[96:99], v[148:151], v[84:87], v[96:99]
    s_waitcnt vmcnt(7)
    buffer_load_dwordx4 a[44:47], v77, s[52:55], s85 offen offset:1024 nt
    s_add_u32 s87, s87, 7
    s_add_u32 s39, s87, s88
    s_bfe_u32 s37, s39, 0x30000
    s_lshl_b32 s37, s37, 12
    s_add_u32 s85, s37, s89
    s_bfe_u32 s37, s39, 0x10003
    s_lshl_b32 s37, s37, 11
    s_add_u32 s85, s37, s85
    s_bfe_u32 s37, s39, 0x40004
    s_lshl_b32 s37, s37, 16
    s_add_u32 s85, s37, s85
    v_mfma_f32_16x16x32_bf16 v[96:99], v[152:155], v[88:91], v[96:99]
    v_mov_b32_dpp v122, v112 quad_perm:[0,0,0,0] row_mask:0xf bank_mask:0xf
    v_mov_b32_dpp v124, v114 quad_perm:[2,2,2,2] row_mask:0xf bank_mask:0xf
    s_nop 0
    v_add_f32_dpp v122, v113, v122 quad_perm:[1,1,1,1] row_mask:0xf bank_mask:0xf
    v_add_f32_dpp v124, v115, v124 quad_perm:[3,3,3,3] row_mask:0xf bank_mask:0xf
    v_add_f32 v122, v122, v124
    v_max_f32 v65, v65, v122
    ds_write_b32 v64, v122 offset:0
    v_mfma_f32_16x16x32_bf16 v[96:99], v[156:159], v[92:95], v[96:99]
    s_waitcnt vmcnt(7)
    buffer_load_dwordx4 a[48:51], v76, s[52:55], s85 offen offset:0 nt
    v_mfma_f32_16x16x32_bf16 v[112:115], v[160:163], v[80:83], 0
    v_mfma_f32_16x16x32_bf16 v[112:115], v[164:167], v[84:87], v[112:115]
    s_waitcnt vmcnt(7)
    buffer_load_dwordx4 a[52:55], v77, s[52:55], s85 offen offset:0 nt
    v_mfma_f32_16x16x32_bf16 v[112:115], v[168:171], v[88:91], v[112:115]
    s_nop 0
    v_mov_b32_dpp v122, v96 quad_perm:[0,0,0,0] row_mask:0xf bank_mask:0xf
    v_mov_b32_dpp v124, v98 quad_perm:[2,2,2,2] row_mask:0xf bank_mask:0xf
    s_nop 0
    v_add_f32_dpp v122, v97, v122 quad_perm:[1,1,1,1] row_mask:0xf bank_mask:0xf
    v_add_f32_dpp v124, v99, v124 quad_perm:[3,3,3,3] row_mask:0xf bank_mask:0xf
    v_add_f32 v122, v122, v124
    v_max_f32 v65, v65, v122
    ds_write_b32 v64, v122 offset:256
    v_mfma_f32_16x16x32_bf16 v[112:115], v[172:175], v[92:95], v[112:115]
    s_waitcnt vmcnt(7)
    buffer_load_dwordx4 a[56:59], v76, s[52:55], s85 offen offset:1024 nt
    v_mfma_f32_16x16x32_bf16 v[96:99], v[176:179], v[80:83], 0
    v_mfma_f32_16x16x32_bf16 v[96:99], v[180:183], v[84:87], v[96:99]
    s_waitcnt vmcnt(6)
    buffer_load_dwordx4 a[60:63], v77, s[52:55], s85 offen offset:1024 nt
    s_add_u32 s87, s87, 7
    s_add_u32 s39, s87, s88
    s_bfe_u32 s37, s39, 0x30000
    s_lshl_b32 s37, s37, 12
    s_add_u32 s85, s37, s89
    s_bfe_u32 s37, s39, 0x10003
    s_lshl_b32 s37, s37, 11
    s_add_u32 s85, s37, s85
    s_bfe_u32 s37, s39, 0x40004
    s_lshl_b32 s37, s37, 16
    s_add_u32 s85, s37, s85
    v_mfma_f32_16x16x32_bf16 v[96:99], v[184:187], v[88:91], v[96:99]
    v_mov_b32_dpp v122, v112 quad_perm:[0,0,0,0] row_mask:0xf bank_mask:0xf
    v_mov_b32_dpp v124, v114 quad_perm:[2,2,2,2] row_mask:0xf bank_mask:0xf
    s_nop 0
    v_add_f32_dpp v122, v113, v122 quad_perm:[1,1,1,1] row_mask:0xf bank_mask:0xf
    v_add_f32_dpp v124, v115, v124 quad_perm:[3,3,3,3] row_mask:0xf bank_mask:0xf
    v_add_f32 v122, v122, v124
    v_max_f32 v65, v65, v122
    ds_write_b32 v64, v122 offset:512
    s_lshl_b32 s38, s32, 8
    s_add_u32 s69, s38, 98304
    s_lshl_b32 s38, s34, 23
    s_add_u32 s69, s38, s69
    v_mov_b32 v48, s69
    v_mov_b32 v49, s68
    s_barrier
    s_mov_b64 exec, 1
    buffer_store_dword v49, v48, s[48:51], 0 offen sc1
    s_mov_b64 exec, -1
    v_mfma_f32_16x16x32_bf16 v[96:99], v[188:191], v[92:95], v[96:99]
    v_mfma_f32_16x16x32_bf16 v[112:115], v[192:195], v[80:83], 0
    s_waitcnt vmcnt(7)
    buffer_load_dwordx4 a[64:67], v76, s[52:55], s85 offen offset:0 nt
    v_mfma_f32_16x16x32_bf16 v[112:115], v[196:199], v[84:87], v[112:115]
    v_mfma_f32_16x16x32_bf16 v[112:115], v[200:203], v[88:91], v[112:115]
    s_nop 2
    v_mov_b32_dpp v122, v96 quad_perm:[0,0,0,0] row_mask:0xf bank_mask:0xf
    v_mov_b32_dpp v124, v98 quad_perm:[2,2,2,2] row_mask:0xf bank_mask:0xf
    s_nop 0
    v_add_f32_dpp v122, v97, v122 quad_perm:[1,1,1,1] row_mask:0xf bank_mask:0xf
    v_add_f32_dpp v124, v99, v124 quad_perm:[3,3,3,3] row_mask:0xf bank_mask:0xf
    v_add_f32 v122, v122, v124
    v_max_f32 v65, v65, v122
    ds_write_b32 v64, v122 offset:768
    s_waitcnt vmcnt(7)
    buffer_load_dwordx4 a[68:71], v77, s[52:55], s85 offen offset:0 nt
    v_mfma_f32_16x16x32_bf16 v[112:115], v[204:207], v[92:95], v[112:115]
    v_mfma_f32_16x16x32_bf16 v[96:99], v[208:211], v[80:83], 0
    s_waitcnt vmcnt(7)
    buffer_load_dwordx4 a[72:75], v76, s[52:55], s85 offen offset:1024 nt
    v_mfma_f32_16x16x32_bf16 v[96:99], v[212:215], v[84:87], v[96:99]
    v_mfma_f32_16x16x32_bf16 v[96:99], v[216:219], v[88:91], v[96:99]
    s_nop 2
    v_mov_b32_dpp v122, v112 quad_perm:[0,0,0,0] row_mask:0xf bank_mask:0xf
    v_mov_b32_dpp v124, v114 quad_perm:[2,2,2,2] row_mask:0xf bank_mask:0xf
    s_nop 0
    v_add_f32_dpp v122, v113, v122 quad_perm:[1,1,1,1] row_mask:0xf bank_mask:0xf
    v_add_f32_dpp v124, v115, v124 quad_perm:[3,3,3,3] row_mask:0xf bank_mask:0xf
    v_add_f32 v122, v122, v124
    v_max_f32 v65, v65, v122
    ds_write_b32 v64, v122 offset:1024
    s_waitcnt vmcnt(7)
    buffer_load_dwordx4 a[76:79], v77, s[52:55], s85 offen offset:1024 nt
    s_add_u32 s87, s87, 7
    s_add_u32 s39, s87, s88
    s_bfe_u32 s37, s39, 0x30000
    s_lshl_b32 s37, s37, 12
    s_add_u32 s85, s37, s89
    s_bfe_u32 s37, s39, 0x10003
    s_lshl_b32 s37, s37, 11
    s_add_u32 s85, s37, s85
    s_bfe_u32 s37, s39, 0x40004
    s_lshl_b32 s37, s37, 16
    s_add_u32 s85, s37, s85
    v_mfma_f32_16x16x32_bf16 v[96:99], v[220:223], v[92:95], v[96:99]
    v_mfma_f32_16x16x32_bf16 v[112:115], v[224:227], v[80:83], 0
    s_waitcnt vmcnt(7)
    buffer_load_dwordx4 a[80:83], v76, s[52:55], s85 offen offset:0 nt
    v_mfma_f32_16x16x32_bf16 v[112:115], v[228:231], v[84:87], v[112:115]
    v_mfma_f32_16x16x32_bf16 v[112:115], v[232:235], v[88:91], v[112:115]
    s_nop 2
    v_mov_b32_dpp v122, v96 quad_perm:[0,0,0,0] row_mask:0xf bank_mask:0xf
    v_mov_b32_dpp v124, v98 quad_perm:[2,2,2,2] row_mask:0xf bank_mask:0xf
    s_nop 0
    v_add_f32_dpp v122, v97, v122 quad_perm:[1,1,1,1] row_mask:0xf bank_mask:0xf
    v_add_f32_dpp v124, v99, v124 quad_perm:[3,3,3,3] row_mask:0xf bank_mask:0xf
    v_add_f32 v122, v122, v124
    v_max_f32 v65, v65, v122
    ds_write_b32 v64, v122 offset:1280
    s_waitcnt vmcnt(7)
    buffer_load_dwordx4 a[84:87], v77, s[52:55], s85 offen offset:0 nt
    v_mfma_f32_16x16x32_bf16 v[112:115], v[236:239], v[92:95], v[112:115]
    v_mfma_f32_16x16x32_bf16 v[96:99], v[240:243], v[80:83], 0
    s_waitcnt vmcnt(7)
    buffer_load_dwordx4 a[88:91], v76, s[52:55], s85 offen offset:1024 nt
    v_mfma_f32_16x16x32_bf16 v[96:99], v[244:247], v[84:87], v[96:99]
    v_mfma_f32_16x16x32_bf16 v[96:99], v[248:251], v[88:91], v[96:99]
    s_nop 2
    v_mov_b32_dpp v122, v112 quad_perm:[0,0,0,0] row_mask:0xf bank_mask:0xf
    v_mov_b32_dpp v124, v114 quad_perm:[2,2,2,2] row_mask:0xf bank_mask:0xf
    s_nop 0
    v_add_f32_dpp v122, v113, v122 quad_perm:[1,1,1,1] row_mask:0xf bank_mask:0xf
    v_add_f32_dpp v124, v115, v124 quad_perm:[3,3,3,3] row_mask:0xf bank_mask:0xf
    v_add_f32 v122, v122, v124
    v_max_f32 v65, v65, v122
    ds_write_b32 v64, v122 offset:1536
    v_mfma_f32_16x16x32_bf16 v[96:99], v[252:255], v[92:95], v[96:99]
    s_waitcnt vmcnt(6)
    buffer_load_dwordx4 a[92:95], v77, s[52:55], s85 offen offset:1024 nt
    s_add_u32 s87, s87, 7
    s_add_u32 s39, s87, s88
    s_bfe_u32 s37, s39, 0x30000
    s_lshl_b32 s37, s37, 12
    s_add_u32 s85, s37, s89
    s_bfe_u32 s37, s39, 0x10003
    s_lshl_b32 s37, s37, 11
    s_add_u32 s85, s37, s85
    s_bfe_u32 s37, s39, 0x40004
    s_lshl_b32 s37, s37, 16
    s_add_u32 s85, s37, s85
    v_mfma_f32_16x16x32_bf16 v[112:115], a[0:3], v[80:83], 0
    v_mfma_f32_16x16x32_bf16 v[112:115], a[4:7], v[84:87], v[112:115]
    s_waitcnt vmcnt(6)
    buffer_load_dwordx4 a[96:99], v76, s[52:55], s85 offen offset:0 nt
    v_mfma_f32_16x16x32_bf16 v[112:115], a[8:11], v[88:91], v[112:115]
    v_mov_b32_dpp v122, v96 quad_perm:[0,0,0,0] row_mask:0xf bank_mask:0xf
    v_mov_b32_dpp v124, v98 quad_perm:[2,2,2,2] row_mask:0xf bank_mask:0xf
    s_nop 0
    v_add_f32_dpp v122, v97, v122 quad_perm:[1,1,1,1] row_mask:0xf bank_mask:0xf
    v_add_f32_dpp v124, v99, v124 quad_perm:[3,3,3,3] row_mask:0xf bank_mask:0xf
    v_add_f32 v122, v122, v124
    v_max_f32 v65, v65, v122
    ds_write_b32 v64, v122 offset:1792
    v_mfma_f32_16x16x32_bf16 v[112:115], a[12:15], v[92:95], v[112:115]
    s_waitcnt vmcnt(6)
    buffer_load_dwordx4 a[100:103], v77, s[52:55], s85 offen offset:0 nt
    v_mfma_f32_16x16x32_bf16 v[96:99], a[16:19], v[80:83], 0
    v_mfma_f32_16x16x32_bf16 v[96:99], a[20:23], v[84:87], v[96:99]
    s_waitcnt vmcnt(6)
    buffer_load_dwordx4 a[104:107], v76, s[52:55], s85 offen offset:1024 nt
    v_mfma_f32_16x16x32_bf16 v[96:99], a[24:27], v[88:91], v[96:99]
    s_nop 0
    v_mov_b32_dpp v122, v112 quad_perm:[0,0,0,0] row_mask:0xf bank_mask:0xf
    v_mov_b32_dpp v124, v114 quad_perm:[2,2,2,2] row_mask:0xf bank_mask:0xf
    s_nop 0
    v_add_f32_dpp v122, v113, v122 quad_perm:[1,1,1,1] row_mask:0xf bank_mask:0xf
    v_add_f32_dpp v124, v115, v124 quad_perm:[3,3,3,3] row_mask:0xf bank_mask:0xf
    v_add_f32 v122, v122, v124
    v_max_f32 v65, v65, v122
    ds_write_b32 v64, v122 offset:2048
    v_mfma_f32_16x16x32_bf16 v[96:99], a[28:31], v[92:95], v[96:99]
    s_waitcnt vmcnt(6)
    buffer_load_dwordx4 a[108:111], v77, s[52:55], s85 offen offset:1024 nt
    s_add_u32 s87, s87, 7
    s_add_u32 s39, s87, s88
    s_bfe_u32 s37, s39, 0x30000
    s_lshl_b32 s37, s37, 12
    s_add_u32 s85, s37, s89
    s_bfe_u32 s37, s39, 0x10003
    s_lshl_b32 s37, s37, 11
    s_add_u32 s85, s37, s85
    s_bfe_u32 s37, s39, 0x40004
    s_lshl_b32 s37, s37, 16
    s_add_u32 s85, s37, s85
    v_mfma_f32_16x16x32_bf16 v[112:115], a[32:35], v[80:83], 0
    s_sub_u32 s36, s33, 3
    s_and_b32 s37, s33, 3
    s_cmp_lt_u32 s36, 4
    s_cselect_b64 s[40:41], s[24:25], s[14:15]
    s_cselect_b32 s36, s36, s37
    s_cselect_b32 s45, 262144, 0
    s_cselect_b32 s46, 8388608, 0
    s_add_u32 s45, s45, 524288
    s_add_u32 s46, s46, 196608
    s_mov_b32 s42, 4194304
    s_mov_b32 s43, 0x20000
    s_lshl_b32 s38, s32, 17
    s_add_u32 s44, s38, 0
    s_lshl_b32 s38, s34, 15
    s_add_u32 s44, s38, s44
    s_lshl_b32 s38, s36, 8
    s_add_u32 s44, s38, s44
    s_lshl_b32 s38, s36, 16
    s_add_u32 s45, s38, s45
    s_lshr_b32 s38, s34, 1
    s_lshl_b32 s38, s38, 15
    s_add_u32 s45, s38, s45
    s_lshl_b32 s38, s32, 8
    s_add_u32 s45, s38, s45
    s_bfe_u32 s38, s34, 0x10000
    s_lshl_b32 s38, s38, 7
    s_add_u32 s45, s38, s45
    s_lshl_b32 s38, s32, 11
    s_add_u32 s46, s38, s46
    s_lshl_b32 s38, s34, 9
    s_add_u32 s46, s38, s46
    s_mov_b32 s72, s26
    s_and_b32 s73, s27, 0xffff
    s_mov_b32 s74, 8192
    s_mov_b32 s75, 0x20000
    v_mfma_f32_16x16x32_bf16 v[112:115], a[36:39], v[84:87], v[112:115]
    s_waitcnt vmcnt(6)
    buffer_load_dwordx4 a[112:115], v76, s[52:55], s85 offen offset:0 nt
    v_mfma_f32_16x16x32_bf16 v[112:115], a[40:43], v[88:91], v[112:115]
    v_mov_b32_dpp v122, v96 quad_perm:[0,0,0,0] row_mask:0xf bank_mask:0xf
    v_mov_b32_dpp v124, v98 quad_perm:[2,2,2,2] row_mask:0xf bank_mask:0xf
    s_nop 0
    v_add_f32_dpp v122, v97, v122 quad_perm:[1,1,1,1] row_mask:0xf bank_mask:0xf
    v_add_f32_dpp v124, v99, v124 quad_perm:[3,3,3,3] row_mask:0xf bank_mask:0xf
    v_add_f32 v122, v122, v124
    v_max_f32 v65, v65, v122
    ds_write_b32 v64, v122 offset:2304
    v_mfma_f32_16x16x32_bf16 v[112:115], a[44:47], v[92:95], v[112:115]
    s_waitcnt vmcnt(6)
    buffer_load_dwordx4 a[116:119], v77, s[52:55], s85 offen offset:0 nt
    v_mfma_f32_16x16x32_bf16 v[96:99], a[48:51], v[80:83], 0
    v_mfma_f32_16x16x32_bf16 v[96:99], a[52:55], v[84:87], v[96:99]
    s_waitcnt vmcnt(6)
    buffer_load_dwordx4 a[120:123], v76, s[52:55], s85 offen offset:1024 nt
    v_mfma_f32_16x16x32_bf16 v[96:99], a[56:59], v[88:91], v[96:99]
    s_nop 0
    v_mov_b32_dpp v122, v112 quad_perm:[0,0,0,0] row_mask:0xf bank_mask:0xf
    v_mov_b32_dpp v124, v114 quad_perm:[2,2,2,2] row_mask:0xf bank_mask:0xf
    s_nop 0
    v_add_f32_dpp v122, v113, v122 quad_perm:[1,1,1,1] row_mask:0xf bank_mask:0xf
    v_add_f32_dpp v124, v115, v124 quad_perm:[3,3,3,3] row_mask:0xf bank_mask:0xf
    v_add_f32 v122, v122, v124
    v_max_f32 v65, v65, v122
    ds_write_b32 v64, v122 offset:2560
    v_lshlrev_b32 v4, 2, v2
    v_xor_b32 v4, v4, v3
    v_xor_b32 v5, 0, v4
    v_lshlrev_b32 v5, 4, v5
    v_lshl_add_u32 v20, v2, 10, v5
    v_xor_b32 v5, 1, v4
    v_lshlrev_b32 v5, 4, v5
    v_lshl_add_u32 v21, v2, 10, v5
    v_add_u32 v21, 3072, v21
    v_xor_b32 v5, 2, v4
    v_lshlrev_b32 v5, 4, v5
    v_lshl_add_u32 v22, v2, 10, v5
    v_add_u32 v22, 6144, v22
    v_xor_b32 v5, 3, v4
    v_lshlrev_b32 v5, 4, v5
    v_lshl_add_u32 v23, v2, 10, v5
    v_add_u32 v23, 9216, v23
    s_lshl_b32 s38, s32, 15
    s_add_u32 s47, s38, 1048576
    s_lshl_b32 s38, s3, 13
    s_add_u32 s47, s38, s47
    v_lshlrev_b32 v6, 7, v2
    v_bfe_u32 v5, v3, 0, 3
    v_lshl_add_u32 v6, v5, 4, v6
    v_lshrrev_b32 v4, 3, v3
    v_and_b32 v7, 3, v3
    v_min_u32 v7, 2, v7
    v_lshl_add_u32 v7, v7, 1, v4
    v_add_u32 v5, 0, v4
    v_cmp_le_u32 vcc, s33, v5
    s_nop 1
    v_addc_co_u32 v5, vcc, 0, v5, vcc
    v_lshl_add_u32 v50, v5, 10, v6
    v_add_u32 v5, 2, v4
    v_cmp_le_u32 vcc, s33, v5
    s_nop 1
    v_addc_co_u32 v5, vcc, 0, v5, vcc
    v_lshl_add_u32 v51, v5, 10, v6
    v_add_u32 v5, 4, v4
    v_cmp_le_u32 vcc, s33, v5
    s_nop 1
    v_addc_co_u32 v5, vcc, 0, v5, vcc
    v_lshl_add_u32 v52, v5, 10, v6
    v_mov_b32 v5, v7
    v_mov_b32 v6, 512
    v_cmp_le_u32 vcc, s33, v5
    s_nop 1
    v_addc_co_u32 v5, vcc, 0, v5, vcc
    v_lshl_add_u32 v53, v5, 10, v6
    s_mul_i32 s38, s3, 320
    s_add_u32 s38, s38, 135168
    v_lshlrev_b32 v4, 6, v2
    v_lshl_add_u32 v4, v3, 1, v4
    v_add_u32 v31, s38, v4
    v_mfma_f32_16x16x32_bf16 v[96:99], a[60:63], v[92:95], v[96:99]
    v_mfma_f32_16x16x32_bf16 v[112:115], a[64:67], v[80:83], 0
    s_waitcnt vmcnt(6)
    buffer_load_dwordx4 a[124:127], v77, s[52:55], s85 offen offset:1024 nt
    s_add_u32 s87, s87, 7
    s_add_u32 s39, s87, s88
    s_bfe_u32 s37, s39, 0x30000
    s_lshl_b32 s37, s37, 12
    s_add_u32 s85, s37, s89
    s_bfe_u32 s37, s39, 0x10003
    s_lshl_b32 s37, s37, 11
    s_add_u32 s85, s37, s85
    s_bfe_u32 s37, s39, 0x40004
    s_lshl_b32 s37, s37, 16
    s_add_u32 s85, s37, s85
    v_mfma_f32_16x16x32_bf16 v[112:115], a[68:71], v[84:87], v[112:115]
    v_mfma_f32_16x16x32_bf16 v[112:115], a[72:75], v[88:91], v[112:115]
    v_mov_b32_dpp v122, v96 quad_perm:[0,0,0,0] row_mask:0xf bank_mask:0xf
    v_mov_b32_dpp v124, v98 quad_perm:[2,2,2,2] row_mask:0xf bank_mask:0xf
    s_nop 0
    v_add_f32_dpp v122, v97, v122 quad_perm:[1,1,1,1] row_mask:0xf bank_mask:0xf
    v_add_f32_dpp v124, v99, v124 quad_perm:[3,3,3,3] row_mask:0xf bank_mask:0xf
    v_add_f32 v122, v122, v124
    v_max_f32 v65, v65, v122
    ds_write_b32 v64, v122 offset:2816
    s_waitcnt vmcnt(5)
    buffer_load_dwordx4 v[128:131], v76, s[52:55], s85 offen offset:0 nt
    v_mfma_f32_16x16x32_bf16 v[112:115], a[76:79], v[92:95], v[112:115]
    v_mfma_f32_16x16x32_bf16 v[96:99], a[80:83], v[80:83], 0
    v_lshlrev_b32 v4, 11, v2
    v_bfe_u32 v5, v1, 2, 2
    v_lshl_add_u32 v4, v5, 8, v4
    v_bfe_u32 v5, v1, 2, 2
    v_lshl_add_u32 v4, v5, 6, v4
    v_bfe_u32 v5, v1, 4, 1
    v_lshl_add_u32 v4, v5, 5, v4
    v_bfe_u32 v5, v1, 1, 1
    v_lshl_add_u32 v4, v5, 4, v4
    v_bfe_u32 v5, v1, 0, 1
    v_lshl_add_u32 v4, v5, 3, v4
    s_lshl_b32 s38, s34, 6
    s_add_u32 s38, s38, 98304
    v_xor_b32 v24, s38, v4
    v_xor_b32 v25, 16, v24
    v_xor_b32 v26, 32, v24
    v_xor_b32 v27, 48, v24
    v_and_b32 v4, 3, v3
    v_lshrrev_b32 v5, 2, v3
    v_lshlrev_b32 v6, 4, v2
    v_add_u32 v6, 135168, v6
    s_movk_i32 s36, 320
    v_cmp_eq_u32 vcc, 0, v5
    s_nop 1
    v_cndmask_b32 v28, 4, v4, vcc
    v_mad_u32_u24 v28, v28, s36, v6
    v_cmp_eq_u32 vcc, 1, v5
    s_nop 1
    v_cndmask_b32 v29, 4, v4, vcc
    v_mad_u32_u24 v29, v29, s36, v6
    v_lshlrev_b32 v5, 2, v1
    v_add_u32 v5, 136448, v5
    v_mov_b32 v6, 0
    ds_write_b32 v5, v6
    s_waitcnt vmcnt(5)
    buffer_load_dwordx4 v[132:135], v77, s[52:55], s85 offen offset:0 nt
    v_mfma_f32_16x16x32_bf16 v[96:99], a[84:87], v[84:87], v[96:99]
    v_mfma_f32_16x16x32_bf16 v[96:99], a[88:91], v[88:91], v[96:99]
    v_mov_b32_dpp v122, v112 quad_perm:[0,0,0,0] row_mask:0xf bank_mask:0xf
    v_mov_b32_dpp v124, v114 quad_perm:[2,2,2,2] row_mask:0xf bank_mask:0xf
    s_nop 0
    v_add_f32_dpp v122, v113, v122 quad_perm:[1,1,1,1] row_mask:0xf bank_mask:0xf
    v_add_f32_dpp v124, v115, v124 quad_perm:[3,3,3,3] row_mask:0xf bank_mask:0xf
    v_add_f32 v122, v122, v124
    v_max_f32 v65, v65, v122
    ds_write_b32 v64, v122 offset:3072
    s_waitcnt vmcnt(5)
    buffer_load_dwordx4 v[136:139], v76, s[52:55], s85 offen offset:1024 nt
    v_mfma_f32_16x16x32_bf16 v[96:99], a[92:95], v[92:95], v[96:99]
    v_mfma_f32_16x16x32_bf16 v[112:115], a[96:99], v[80:83], 0
    s_waitcnt vmcnt(5)
    buffer_load_dwordx4 v[140:143], v77, s[52:55], s85 offen offset:1024 nt
    s_add_u32 s87, s87, 7
    s_add_u32 s39, s87, s88
    s_bfe_u32 s37, s39, 0x30000
    s_lshl_b32 s37, s37, 12
    s_add_u32 s85, s37, s89
    s_bfe_u32 s37, s39, 0x10003
    s_lshl_b32 s37, s37, 11
    s_add_u32 s85, s37, s85
    s_bfe_u32 s37, s39, 0x40004
    s_lshl_b32 s37, s37, 16
    s_add_u32 s85, s37, s85
    v_mfma_f32_16x16x32_bf16 v[112:115], a[100:103], v[84:87], v[112:115]
    v_mfma_f32_16x16x32_bf16 v[112:115], a[104:107], v[88:91], v[112:115]
    v_mov_b32_dpp v122, v96 quad_perm:[0,0,0,0] row_mask:0xf bank_mask:0xf
    v_mov_b32_dpp v124, v98 quad_perm:[2,2,2,2] row_mask:0xf bank_mask:0xf
    s_nop 0
    v_add_f32_dpp v122, v97, v122 quad_perm:[1,1,1,1] row_mask:0xf bank_mask:0xf
    v_add_f32_dpp v124, v99, v124 quad_perm:[3,3,3,3] row_mask:0xf bank_mask:0xf
    v_add_f32 v122, v122, v124
    v_max_f32 v65, v65, v122
    ds_write_b32 v64, v122 offset:3328
    v_lshlrev_b32 v30, 4, v3
    v_lshl_add_u32 v30, v2, 13, v30
    s_lshl_b32 s38, s32, 13
    s_add_u32 s36, s38, 0
    s_lshl_b32 s38, s34, 6
    s_add_u32 s36, s38, s36
    v_lshrrev_b32 v5, 2, v1
    v_lshlrev_b32 v32, 8, v5
    v_bfe_u32 v5, v1, 0, 2
    v_lshl_add_u32 v32, v5, 4, v32
    v_add_u32 v32, s36, v32
    s_lshr_b32 s38, s32, 2
    s_lshl_b32 s38, s38, 7
    s_add_u32 s36, s38, 0
    s_lshl_b32 s38, s34, 5
    s_add_u32 s36, s38, s36
    s_bfe_u32 s38, s32, 0x20000
    s_lshl_b32 s38, s38, 3
    s_add_u32 s36, s38, s36
    v_bfe_u32 v5, v1, 0, 2
    v_lshlrev_b32 v33, 11, v5
    v_lshl_add_u32 v33, v2, 1, v33
    v_add_u32 v33, s36, v33
    v_and_b32 v5, 31, v1
    v_lshlrev_b32 v34, 4, v5
    s_mul_i32 s38, s34, 320
    s_add_u32 s38, s38, 135168
    v_lshl_add_u32 v35, v5, 3, s38
    s_waitcnt vmcnt(5)
    buffer_load_dwordx4 v[144:147], v76, s[52:55], s85 offen offset:0 nt
    v_mfma_f32_16x16x32_bf16 v[112:115], a[108:111], v[92:95], v[112:115]
    v_mfma_f32_16x16x32_bf16 v[96:99], a[112:115], v[80:83], 0
    s_waitcnt vmcnt(5)
    buffer_load_dwordx4 v[148:151], v77, s[52:55], s85 offen offset:0 nt
    v_mfma_f32_16x16x32_bf16 v[96:99], a[116:119], v[84:87], v[96:99]
    v_mfma_f32_16x16x32_bf16 v[96:99], a[120:123], v[88:91], v[96:99]
    s_nop 2
    v_mov_b32_dpp v122, v112 quad_perm:[0,0,0,0] row_mask:0xf bank_mask:0xf
    v_mov_b32_dpp v124, v114 quad_perm:[2,2,2,2] row_mask:0xf bank_mask:0xf
    s_nop 0
    v_add_f32_dpp v122, v113, v122 quad_perm:[1,1,1,1] row_mask:0xf bank_mask:0xf
    v_add_f32_dpp v124, v115, v124 quad_perm:[3,3,3,3] row_mask:0xf bank_mask:0xf
    v_add_f32 v122, v122, v124
    v_max_f32 v65, v65, v122
    ds_write_b32 v64, v122 offset:3584
    v_mfma_f32_16x16x32_bf16 v[96:99], a[124:127], v[92:95], v[96:99]
    v_add_u32 v64, 3840, v64
    s_mov_b32 s97, 8
    s_mov_b32 s86, 32
    s_and_b32 s36, s32, 3
    s_sub_u32 s80, s36, 2
    s_cmp_ge_u32 s36, 2
    s_cselect_b32 s80, s80, 8
    s_cselect_b32 s81, 27, 25
    s_cmp_eq_u32 s80, s33
    s_cselect_b32 s36, 2, 0
    s_sub_u32 s86, s86, s36
    s_lshr_b32 s36, s36, 1
    s_sub_u32 s97, s97, s36
    s_add_u32 s80, s80, 35
    s_sub_u32 s92, s81, 1
    s_mov_b32 s66, 134217728
    s_mov_b32 s67, 0x20000
    s_mov_b64 s[64:65], s[52:53]
    v_mov_b32 v62, v76
    v_mov_b32 v63, v77
    s_branch L_bloop
L_aux:
    v_lshlrev_b32 v4, 2, v2
    v_xor_b32 v4, v4, v3
    v_xor_b32 v96, 0, v4
    v_lshlrev_b32 v96, 4, v96
    v_lshl_add_u32 v10, v2, 13, v96
    v_xor_b32 v97, 1, v4
    v_lshlrev_b32 v97, 4, v97
    v_lshl_add_u32 v11, v2, 13, v97
    v_add_u32 v11, 31744, v11
    v_xor_b32 v98, 2, v4
    v_lshlrev_b32 v98, 4, v98
    v_lshl_add_u32 v12, v2, 13, v98
    v_add_u32 v12, 63488, v12
    v_xor_b32 v99, 3, v4
    v_lshlrev_b32 v99, 4, v99
    v_lshl_add_u32 v13, v2, 13, v99
    v_add_u32 v13, 95232, v13
    s_lshl_b32 s90, s34, 15
    s_mov_b32 s62, 0
    s_lshl_b32 s38, s34, 20
    s_add_u32 s95, s38, 0
    s_lshl_b32 s38, s32, 8
    s_add_u32 s95, s38, s95
    s_waitcnt lgkmcnt(0)
    s_mov_b32 s52, s12
    s_and_b32 s53, s13, 0xffff
    s_mov_b32 s54, 4194304
    s_mov_b32 s55, 0x20000
    s_add_u32 s39, s90, s62
    s_mov_b32 m0, s39
    s_add_u32 s62, s62, 4096
    s_and_b32 s62, s62, 0x7fff
    buffer_load_dwordx4 v10, s[52:55], s95 offen offset:0 nt lds
    buffer_load_dwordx4 v11, s[52:55], s95 offen offset:1024 nt lds
    buffer_load_dwordx4 v12, s[52:55], s95 offen offset:2048 nt lds
    buffer_load_dwordx4 v13, s[52:55], s95 offen offset:3072 nt lds
    s_add_u32 s95, s95, 131072
    s_add_u32 s39, s90, s62
    s_mov_b32 m0, s39
    s_add_u32 s62, s62, 4096
    s_and_b32 s62, s62, 0x7fff
    buffer_load_dwordx4 v10, s[52:55], s95 offen offset:0 nt lds
    buffer_load_dwordx4 v11, s[52:55], s95 offen offset:1024 nt lds
    buffer_load_dwordx4 v12, s[52:55], s95 offen offset:2048 nt lds
    buffer_load_dwordx4 v13, s[52:55], s95 offen offset:3072 nt lds
    s_add_u32 s95, s95, 131072
    s_load_dword s35, s[30:31], 0
    s_mov_b32 s48, s30
    s_and_b32 s49, s31, 0xffff
    s_mov_b32 s50, 8388608
    s_mov_b32 s51, 0x20000
    s_mov_b32 s82, 0xffffff00
    s_mov_b32 s83, 0x3e0293ee
    s_mov_b32 s84, 2097152
    v_lshl_add_u32 v76, v2, 10, v96
    v_lshl_add_u32 v96, v2, 8, v96
    v_lshl_add_u32 v77, v2, 10, v97
    v_lshl_add_u32 v97, v2, 8, v97
    v_add_u32 v77, 3072, v77
    v_lshl_add_u32 v78, v2, 10, v98
    v_lshl_add_u32 v98, v2, 8, v98
    v_add_u32 v78, 6144, v78
    v_lshl_add_u32 v79, v2, 10, v99
    v_lshl_add_u32 v99, v2, 8, v99
    v_add_u32 v79, 9216, v79
    v_bfe_u32 v100, v1, 0, 5
    v_lshlrev_b32 v101, 8, v100
    v_lshlrev_b32 v9, 4, v3
    v_lshl_add_u32 v9, v2, 10, v9
    v_xor_b32 v5, v3, v2
    v_bfe_u32 v4, v3, 2, 1
    v_lshlrev_b32 v6, 11, v4
    v_bfe_u32 v4, v3, 3, 1
    v_lshl_add_u32 v6, v4, 10, v6
    v_bfe_u32 v4, v3, 0, 2
    v_lshl_add_u32 v6, v4, 8, v6
    v_bfe_u32 v4, v5, 0, 2
    v_lshl_add_u32 v6, v4, 6, v6
    v_bfe_u32 v4, v3, 2, 1
    v_lshl_add_u32 v6, v4, 5, v6
    v_bfe_u32 v4, v3, 3, 1
    v_lshl_add_u32 v6, v4, 4, v6
    v_add_u32 v60, s90, v6
    v_xor_b32 v61, 16, v60
    v_xor_b32 v62, 32, v60
    v_xor_b32 v63, 48, v60
    v_lshrrev_b32 v5, 4, v1
    v_xor_b32 v5, v5, v1
    v_bfe_u32 v4, v1, 4, 1
    v_lshlrev_b32 v6, 11, v4
    v_bfe_u32 v4, v1, 5, 1
    v_lshl_add_u32 v6, v4, 10, v6
    v_bfe_u32 v4, v1, 2, 2
    v_lshl_add_u32 v6, v4, 8, v6
    v_bfe_u32 v4, v1, 2, 2
    v_lshl_add_u32 v6, v4, 6, v6
    v_bfe_u32 v4, v1, 4, 1
    v_lshl_add_u32 v6, v4, 5, v6
    v_bfe_u32 v4, v5, 1, 1
    v_lshl_add_u32 v6, v4, 4, v6
    v_bfe_u32 v4, v1, 0, 1
    v_lshl_add_u32 v6, v4, 3, v6
    v_add_u32 v82, s90, v6
    v_xor_b32 v83, 32, v82
    v_xor_b32 v84, 64, v82
    v_xor_b32 v85, 96, v82
    v_xor_b32 v86, 128, v82
    v_xor_b32 v87, 160, v82
    v_xor_b32 v88, 192, v82
    v_xor_b32 v89, 224, v82
    v_lshlrev_b32 v6, 11, v2
    v_bfe_u32 v4, v1, 2, 2
    v_lshl_add_u32 v6, v4, 8, v6
    v_bfe_u32 v4, v1, 2, 2
    v_lshl_add_u32 v6, v4, 6, v6
    v_bfe_u32 v4, v1, 4, 1
    v_lshl_add_u32 v6, v4, 5, v6
    v_bfe_u32 v4, v1, 1, 1
    v_lshl_add_u32 v6, v4, 4, v6
    v_bfe_u32 v4, v1, 0, 1
    v_lshl_add_u32 v6, v4, 3, v6
    v_add_u32 v136, s90, v6
    v_xor_b32 v137, 16, v136
    v_xor_b32 v138, 32, v136
    v_xor_b32 v139, 48, v136
    v_xor_b32 v140, 64, v136
    v_xor_b32 v141, 80, v136
    v_xor_b32 v142, 96, v136
    v_xor_b32 v143, 112, v136
    v_xor_b32 v144, 128, v136
    v_xor_b32 v145, 144, v136
    v_xor_b32 v146, 160, v136
    v_xor_b32 v147, 176, v136
    v_xor_b32 v148, 192, v136
    v_xor_b32 v149, 208, v136
    v_xor_b32 v150, 224, v136
    v_xor_b32 v151, 240, v136
    s_lshl_b32 s85, s34, 13
    s_add_u32 s85, s85, 131072
    v_lshl_add_u32 v94, v1, 4, s85
    v_add_u32 v96, s85, v96
    v_add_u32 v97, s85, v97
    v_add_u32 v98, s85, v98
    v_add_u32 v99, s85, v99
    s_add_u32 s39, s90, s62
    s_mov_b32 m0, s39
    s_add_u32 s62, s62, 4096
    s_and_b32 s62, s62, 0x7fff
    buffer_load_dwordx4 v10, s[52:55], s95 offen offset:0 nt lds
    buffer_load_dwordx4 v11, s[52:55], s95 offen offset:1024 nt lds
    buffer_load_dwordx4 v12, s[52:55], s95 offen offset:2048 nt lds
    buffer_load_dwordx4 v13, s[52:55], s95 offen offset:3072 nt lds
    s_add_u32 s95, s95, 131072
    s_add_u32 s39, s90, s62
    s_mov_b32 m0, s39
    s_add_u32 s62, s62, 4096
    s_and_b32 s62, s62, 0x7fff
    buffer_load_dwordx4 v10, s[52:55], s95 offen offset:0 nt lds
    buffer_load_dwordx4 v11, s[52:55], s95 offen offset:1024 nt lds
    buffer_load_dwordx4 v12, s[52:55], s95 offen offset:2048 nt lds
    buffer_load_dwordx4 v13, s[52:55], s95 offen offset:3072 nt lds
    s_add_u32 s95, s95, 131072
    s_add_u32 s39, s90, s62
    s_mov_b32 m0, s39
    s_add_u32 s62, s62, 4096
    s_and_b32 s62, s62, 0x7fff
    buffer_load_dwordx4 v10, s[52:55], s95 offen offset:0 nt lds
    buffer_load_dwordx4 v11, s[52:55], s95 offen offset:1024 nt lds
    buffer_load_dwordx4 v12, s[52:55], s95 offen offset:2048 nt lds
    buffer_load_dwordx4 v13, s[52:55], s95 offen offset:3072 nt lds
    s_add_u32 s95, s95, 131072
    s_add_u32 s39, s90, s62
    s_mov_b32 m0, s39
    s_add_u32 s62, s62, 4096
    s_and_b32 s62, s62, 0x7fff
    buffer_load_dwordx4 v10, s[52:55], s95 offen offset:0 nt lds
    buffer_load_dwordx4 v11, s[52:55], s95 offen offset:1024 nt lds
    buffer_load_dwordx4 v12, s[52:55], s95 offen offset:2048 nt lds
    buffer_load_dwordx4 v13, s[52:55], s95 offen offset:3072 nt lds
    s_add_u32 s95, s95, 131072
    s_add_u32 s39, s90, s62
    s_mov_b32 m0, s39
    s_add_u32 s62, s62, 4096
    s_and_b32 s62, s62, 0x7fff
    buffer_load_dwordx4 v10, s[52:55], s95 offen offset:0 nt lds
    buffer_load_dwordx4 v11, s[52:55], s95 offen offset:1024 nt lds
    buffer_load_dwordx4 v12, s[52:55], s95 offen offset:2048 nt lds
    buffer_load_dwordx4 v13, s[52:55], s95 offen offset:3072 nt lds
    s_add_u32 s95, s95, 131072
    s_add_u32 s39, s90, s62
    s_mov_b32 m0, s39
    s_add_u32 s62, s62, 4096
    s_and_b32 s62, s62, 0x7fff
    buffer_load_dwordx4 v10, s[52:55], s95 offen offset:0 nt lds
    buffer_load_dwordx4 v11, s[52:55], s95 offen offset:1024 nt lds
    buffer_load_dwordx4 v12, s[52:55], s95 offen offset:2048 nt lds
    buffer_load_dwordx4 v13, s[52:55], s95 offen offset:3072 nt lds
    s_add_u32 s95, s95, 131072
    s_waitcnt lgkmcnt(0)
    s_add_u32 s35, s35, 0x5b
    s_and_b32 s35, s35, 0xff
    v_mov_b32 v8, s35
    s_or_b32 s68, s35, 0x6b3ac500
    s_mov_b32 s52, s6
    s_and_b32 s53, s7, 0xffff
    s_mov_b32 s54, 16777216
    s_mov_b32 s55, 0x20000
    s_bfe_u32 s38, s32, 0x30000
    s_lshl_b32 s38, s38, 1
    s_add_u32 s3, s38, 0
    s_lshr_b32 s38, s32, 4
    s_lshl_b32 s38, s38, 0
    s_add_u32 s3, s38, s3
    s_bfe_u32 s94, s32, 0x10003
    s_lshl_b32 s38, s3, 20
    s_add_u32 s95, s38, 0
    s_lshl_b32 s38, s34, 8
    s_add_u32 s95, s38, s95
    s_waitcnt vmcnt(24)
    ds_read_b64_tr_b16 a[128:129], v136 offset:0
    ds_read_b64_tr_b16 a[130:131], v137 offset:1024
    ds_read_b64_tr_b16 a[144:145], v138 offset:0
    ds_read_b64_tr_b16 a[146:147], v139 offset:1024
    ds_read_b64_tr_b16 a[160:161], v140 offset:0
    ds_read_b64_tr_b16 a[162:163], v141 offset:1024
    ds_read_b64_tr_b16 a[176:177], v142 offset:0
    ds_read_b64_tr_b16 a[178:179], v143 offset:1024
    ds_read_b64_tr_b16 a[192:193], v144 offset:0
    ds_read_b64_tr_b16 a[194:195], v145 offset:1024
    ds_read_b64_tr_b16 a[208:209], v146 offset:0
    ds_read_b64_tr_b16 a[210:211], v147 offset:1024
    ds_read_b64_tr_b16 a[224:225], v148 offset:0
    ds_read_b64_tr_b16 a[226:227], v149 offset:1024
    ds_read_b64_tr_b16 a[240:241], v150 offset:0
    ds_read_b64_tr_b16 a[242:243], v151 offset:1024
    s_waitcnt lgkmcnt(0)
    s_add_u32 s39, s90, s62
    s_mov_b32 m0, s39
    s_add_u32 s62, s62, 4096
    s_and_b32 s62, s62, 0x7fff
    buffer_load_dwordx4 v76, s[52:55], s95 offen offset:0 nt lds
    buffer_load_dwordx4 v77, s[52:55], s95 offen offset:1024 nt lds
    buffer_load_dwordx4 v78, s[52:55], s95 offen offset:2048 nt lds
    buffer_load_dwordx4 v79, s[52:55], s95 offen offset:3072 nt lds
    s_add_u32 s95, s95, 16384
    s_add_u32 s39, s90, s62
    s_mov_b32 m0, s39
    s_add_u32 s62, s62, 4096
    s_and_b32 s62, s62, 0x7fff
    buffer_load_dwordx4 v76, s[52:55], s95 offen offset:0 nt lds
    buffer_load_dwordx4 v77, s[52:55], s95 offen offset:1024 nt lds
    buffer_load_dwordx4 v78, s[52:55], s95 offen offset:2048 nt lds
    buffer_load_dwordx4 v79, s[52:55], s95 offen offset:3072 nt lds
    s_add_u32 s95, s95, 16384
    s_waitcnt vmcnt(24)
    ds_read_b64_tr_b16 a[132:133], v136 offset:8192
    ds_read_b64_tr_b16 a[134:135], v137 offset:9216
    ds_read_b64_tr_b16 a[148:149], v138 offset:8192
    ds_read_b64_tr_b16 a[150:151], v139 offset:9216
    ds_read_b64_tr_b16 a[164:165], v140 offset:8192
    ds_read_b64_tr_b16 a[166:167], v141 offset:9216
    ds_read_b64_tr_b16 a[180:181], v142 offset:8192
    ds_read_b64_tr_b16 a[182:183], v143 offset:9216
    ds_read_b64_tr_b16 a[196:197], v144 offset:8192
    ds_read_b64_tr_b16 a[198:199], v145 offset:9216
    ds_read_b64_tr_b16 a[212:213], v146 offset:8192
    ds_read_b64_tr_b16 a[214:215], v147 offset:9216
    ds_read_b64_tr_b16 a[228:229], v148 offset:8192
    ds_read_b64_tr_b16 a[230:231], v149 offset:9216
    ds_read_b64_tr_b16 a[244:245], v150 offset:8192
    ds_read_b64_tr_b16 a[246:247], v151 offset:9216
    s_waitcnt lgkmcnt(0)
    s_add_u32 s39, s90, s62
    s_mov_b32 m0, s39
    s_add_u32 s62, s62, 4096
    s_and_b32 s62, s62, 0x7fff
    buffer_load_dwordx4 v76, s[52:55], s95 offen offset:0 nt lds
    buffer_load_dwordx4 v77, s[52:55], s95 offen offset:1024 nt lds
    buffer_load_dwordx4 v78, s[52:55], s95 offen offset:2048 nt lds
    buffer_load_dwordx4 v79, s[52:55], s95 offen offset:3072 nt lds
    s_add_u32 s95, s95, 16384
    s_add_u32 s39, s90, s62
    s_mov_b32 m0, s39
    s_add_u32 s62, s62, 4096
    s_and_b32 s62, s62, 0x7fff
    buffer_load_dwordx4 v76, s[52:55], s95 offen offset:0 nt lds
    buffer_load_dwordx4 v77, s[52:55], s95 offen offset:1024 nt lds
    buffer_load_dwordx4 v78, s[52:55], s95 offen offset:2048 nt lds
    buffer_load_dwordx4 v79, s[52:55], s95 offen offset:3072 nt lds
    s_add_u32 s95, s95, 16384
    s_waitcnt vmcnt(24)
    ds_read_b64_tr_b16 a[136:137], v136 offset:16384
    ds_read_b64_tr_b16 a[138:139], v137 offset:17408
    ds_read_b64_tr_b16 a[152:153], v138 offset:16384
    ds_read_b64_tr_b16 a[154:155], v139 offset:17408
    ds_read_b64_tr_b16 a[168:169], v140 offset:16384
    ds_read_b64_tr_b16 a[170:171], v141 offset:17408
    ds_read_b64_tr_b16 a[184:185], v142 offset:16384
    ds_read_b64_tr_b16 a[186:187], v143 offset:17408
    ds_read_b64_tr_b16 a[200:201], v144 offset:16384
    ds_read_b64_tr_b16 a[202:203], v145 offset:17408
    ds_read_b64_tr_b16 a[216:217], v146 offset:16384
    ds_read_b64_tr_b16 a[218:219], v147 offset:17408
    ds_read_b64_tr_b16 a[232:233], v148 offset:16384
    ds_read_b64_tr_b16 a[234:235], v149 offset:17408
    ds_read_b64_tr_b16 a[248:249], v150 offset:16384
    ds_read_b64_tr_b16 a[250:251], v151 offset:17408
    s_waitcnt lgkmcnt(0)
    s_add_u32 s39, s90, s62
    s_mov_b32 m0, s39
    s_add_u32 s62, s62, 4096
    s_and_b32 s62, s62, 0x7fff
    buffer_load_dwordx4 v76, s[52:55], s95 offen offset:0 nt lds
    buffer_load_dwordx4 v77, s[52:55], s95 offen offset:1024 nt lds
    buffer_load_dwordx4 v78, s[52:55], s95 offen offset:2048 nt lds
    buffer_load_dwordx4 v79, s[52:55], s95 offen offset:3072 nt lds
    s_add_u32 s95, s95, 16384
    s_add_u32 s39, s90, s62
    s_mov_b32 m0, s39
    s_add_u32 s62, s62, 4096
    s_and_b32 s62, s62, 0x7fff
    buffer_load_dwordx4 v76, s[52:55], s95 offen offset:0 nt lds
    buffer_load_dwordx4 v77, s[52:55], s95 offen offset:1024 nt lds
    buffer_load_dwordx4 v78, s[52:55], s95 offen offset:2048 nt lds
    buffer_load_dwordx4 v79, s[52:55], s95 offen offset:3072 nt lds
    s_add_u32 s95, s95, 16384
    s_waitcnt vmcnt(24)
    ds_read_b64_tr_b16 a[140:141], v136 offset:24576
    ds_read_b64_tr_b16 a[142:143], v137 offset:25600
    ds_read_b64_tr_b16 a[156:157], v138 offset:24576
    ds_read_b64_tr_b16 a[158:159], v139 offset:25600
    ds_read_b64_tr_b16 a[172:173], v140 offset:24576
    ds_read_b64_tr_b16 a[174:175], v141 offset:25600
    ds_read_b64_tr_b16 a[188:189], v142 offset:24576
    ds_read_b64_tr_b16 a[190:191], v143 offset:25600
    ds_read_b64_tr_b16 a[204:205], v144 offset:24576
    ds_read_b64_tr_b16 a[206:207], v145 offset:25600
    ds_read_b64_tr_b16 a[220:221], v146 offset:24576
    ds_read_b64_tr_b16 a[222:223], v147 offset:25600
    ds_read_b64_tr_b16 a[236:237], v148 offset:24576
    ds_read_b64_tr_b16 a[238:239], v149 offset:25600
    ds_read_b64_tr_b16 a[252:253], v150 offset:24576
    ds_read_b64_tr_b16 a[254:255], v151 offset:25600
    s_waitcnt lgkmcnt(0)
    s_add_u32 s39, s90, s62
    s_mov_b32 m0, s39
    s_add_u32 s62, s62, 4096
    s_and_b32 s62, s62, 0x7fff
    buffer_load_dwordx4 v76, s[52:55], s95 offen offset:0 nt lds
    buffer_load_dwordx4 v77, s[52:55], s95 offen offset:1024 nt lds
    s_mov_b32 s86, 98304
    buffer_load_dword v7, v101, s[48:51], s86 offen sc1
    v_mov_b32 v104, 0
    v_mov_b32 v105, 0
    v_mov_b32 v106, 0
    v_mov_b32 v107, 0
    v_mov_b32 v108, 0
    v_mov_b32 v109, 0
    v_mov_b32 v110, 0
    v_mov_b32 v111, 0
    v_mov_b32 v112, 0
    v_mov_b32 v113, 0
    v_mov_b32 v114, 0
    v_mov_b32 v115, 0
    v_mov_b32 v116, 0
    v_mov_b32 v117, 0
    v_mov_b32 v118, 0
    v_mov_b32 v119, 0
    v_mov_b32 v120, 0
    v_mov_b32 v121, 0
    v_mov_b32 v122, 0
    v_mov_b32 v123, 0
    v_mov_b32 v124, 0
    v_mov_b32 v125, 0
    v_mov_b32 v126, 0
    v_mov_b32 v127, 0
    v_mov_b32 v128, 0
    v_mov_b32 v129, 0
    v_mov_b32 v130, 0
    v_mov_b32 v131, 0
    v_mov_b32 v132, 0
    v_mov_b32 v133, 0
    v_mov_b32 v134, 0
    v_mov_b32 v135, 0
    v_mov_b32 v90, 0xff7f0000
    s_mov_b32 s93, 0
    v_mov_b32 v102, 0
    v_mov_b32 v103, 0
    s_mov_b32 s60, s83
    s_mov_b32 s61, s83
    v_xor_b32 v5, v3, v2
    v_lshlrev_b32 v6, 8, v3
    v_bfe_u32 v4, v5, 0, 2
    v_lshl_add_u32 v6, v4, 6, v6
    v_lshrrev_b32 v4, 2, v3
    v_lshl_add_u32 v6, v4, 4, v6
    v_add_u32 v52, s85, v6
    v_xor_b32 v53, 16, v52
    v_xor_b32 v54, 32, v52
    v_xor_b32 v55, 48, v52
    s_lshr_b32 s38, s3, 2
    s_lshl_b32 s38, s38, 15
    s_add_u32 s36, s38, 393216
    s_lshl_b32 s38, s94, 14
    s_add_u32 s36, s38, s36
    s_lshl_b32 s38, s34, 8
    s_add_u32 s36, s38, s36
    s_waitcnt vmcnt(0)
L_fcheck_18:
    v_cmp_ne_u32 vcc, s68, v7
    s_cbranch_vccz L_fok_19
    s_sleep 2
    s_mov_b32 s86, 98304
    buffer_load_dword v7, v101, s[48:51], s86 offen sc1
    s_waitcnt vmcnt(0)
    s_sub_u32 s84, s84, 1
    s_cmp_lg_u32 s84, 0
    s_cbranch_scc1 L_fcheck_18
    s_branch L_end
L_fok_19:
    buffer_load_dwordx4 v[200:203], v9, s[48:51], s36 offen sc1
    s_add_u32 s36, s36, 4096
    buffer_load_dwordx4 v[204:207], v9, s[48:51], s36 offen sc1
    s_add_u32 s36, s36, 4096
    buffer_load_dwordx4 v[208:211], v9, s[48:51], s36 offen sc1
    s_add_u32 s36, s36, 4096
    buffer_load_dwordx4 v[212:215], v9, s[48:51], s36 offen sc1
    ds_read_b128 v[136:139], v60 offset:0
    ds_read_b128 v[140:143], v61 offset:0
    ds_read_b128 v[144:147], v62 offset:0
    ds_read_b128 v[148:151], v63 offset:0
    ds_read_b128 v[152:155], v60 offset:4096
    ds_read_b128 v[156:159], v61 offset:4096
    ds_read_b128 v[160:163], v62 offset:4096
    ds_read_b128 v[164:167], v63 offset:4096
    ds_read_b128 v[168:171], v60 offset:8192
    ds_read_b128 v[172:175], v61 offset:8192
    ds_read_b128 v[176:179], v62 offset:8192
    ds_read_b128 v[180:183], v63 offset:8192
    ds_read_b128 v[184:187], v60 offset:12288
    ds_read_b128 v[188:191], v61 offset:12288
    ds_read_b128 v[192:195], v62 offset:12288
    ds_read_b128 v[196:199], v63 offset:12288
    s_waitcnt vmcnt(3)
    ds_write_b128 v96, v[200:203] offset:0
    s_waitcnt vmcnt(2)
    ds_write_b128 v97, v[204:207] offset:1024
    s_waitcnt vmcnt(1)
    ds_write_b128 v98, v[208:211] offset:2048
    s_waitcnt vmcnt(0)
    ds_write_b128 v99, v[212:215] offset:3072
    s_waitcnt lgkmcnt(0)
    ds_read_b128 v[36:39], v52
    ds_read_b128 v[40:43], v53
    ds_read_b128 v[44:47], v54
    ds_read_b128 v[48:51], v55
L_att:
    s_waitcnt lgkmcnt(0)
    v_mfma_f32_16x16x32_bf16 v[200:203], v[136:139], v[36:39], 0
    ds_read_b64_tr_b16 a[0:1], v82 offset:0
    ds_read_b64_tr_b16 a[2:3], v82 offset:4096
    buffer_load_dwordx4 v78, s[52:55], s95 offen offset:2048 nt lds
    v_mfma_f32_16x16x32_bf16 v[200:203], v[140:143], v[40:43], v[200:203]
    ds_read_b64_tr_b16 a[4:5], v83 offset:0
    ds_read_b64_tr_b16 a[6:7], v83 offset:4096
    v_mfma_f32_16x16x32_bf16 v[200:203], v[144:147], v[44:47], v[200:203]
    ds_read_b64_tr_b16 a[8:9], v84 offset:0
    ds_read_b64_tr_b16 a[10:11], v84 offset:4096
    v_mfma_f32_16x16x32_bf16 v[200:203], v[148:151], v[48:51], v[200:203]
    ds_read_b64_tr_b16 a[12:13], v85 offset:0
    ds_read_b64_tr_b16 a[14:15], v85 offset:4096
    buffer_load_dwordx4 v79, s[52:55], s95 offen offset:3072 nt lds
    s_add_u32 s95, s95, 16384
    v_mfma_f32_16x16x32_bf16 v[204:207], v[152:155], v[36:39], 0
    ds_read_b64_tr_b16 a[16:17], v86 offset:0
    ds_read_b64_tr_b16 a[18:19], v86 offset:4096
    v_mfma_f32_16x16x32_bf16 v[204:207], v[156:159], v[40:43], v[204:207]
    ds_read_b64_tr_b16 a[20:21], v87 offset:0
    ds_read_b64_tr_b16 a[22:23], v87 offset:4096
    v_mfma_f32_16x16x32_bf16 v[204:207], v[160:163], v[44:47], v[204:207]
    ds_read_b64_tr_b16 a[24:25], v88 offset:0
    ds_read_b64_tr_b16 a[26:27], v88 offset:4096
    s_add_u32 s39, s90, s62
    s_mov_b32 m0, s39
    s_add_u32 s62, s62, 4096
    s_and_b32 s62, s62, 0x7fff
    buffer_load_dwordx4 v76, s[52:55], s95 offen offset:0 nt lds
    v_mfma_f32_16x16x32_bf16 v[204:207], v[164:167], v[48:51], v[204:207]
    ds_read_b64_tr_b16 a[28:29], v89 offset:0
    ds_read_b64_tr_b16 a[30:31], v89 offset:4096
    ds_write_b128 v94, v[200:203] offset:0
    v_mfma_f32_16x16x32_bf16 v[208:211], v[168:171], v[36:39], 0
    ds_read_b64_tr_b16 a[32:33], v82 offset:8192
    ds_read_b64_tr_b16 a[34:35], v82 offset:12288
    v_mfma_f32_16x16x32_bf16 v[208:211], v[172:175], v[40:43], v[208:211]
    ds_read_b64_tr_b16 a[36:37], v83 offset:8192
    ds_read_b64_tr_b16 a[38:39], v83 offset:12288
    buffer_load_dwordx4 v77, s[52:55], s95 offen offset:1024 nt lds
    v_mfma_f32_16x16x32_bf16 v[208:211], v[176:179], v[44:47], v[208:211]
    ds_read_b64_tr_b16 a[40:41], v84 offset:8192
    ds_read_b64_tr_b16 a[42:43], v84 offset:12288
    v_mfma_f32_16x16x32_bf16 v[208:211], v[180:183], v[48:51], v[208:211]
    ds_read_b64_tr_b16 a[44:45], v85 offset:8192
    ds_read_b64_tr_b16 a[46:47], v85 offset:12288
    ds_write_b128 v94, v[204:207] offset:1024
    v_mfma_f32_16x16x32_bf16 v[212:215], v[184:187], v[36:39], 0
    ds_read_b64_tr_b16 a[48:49], v86 offset:8192
    ds_read_b64_tr_b16 a[50:51], v86 offset:12288
    buffer_load_dwordx4 v78, s[52:55], s95 offen offset:2048 nt lds
    v_mfma_f32_16x16x32_bf16 v[212:215], v[188:191], v[40:43], v[212:215]
    ds_read_b64_tr_b16 a[52:53], v87 offset:8192
    ds_read_b64_tr_b16 a[54:55], v87 offset:12288
    v_mfma_f32_16x16x32_bf16 v[212:215], v[192:195], v[44:47], v[212:215]
    ds_read_b64_tr_b16 a[56:57], v88 offset:8192
    ds_read_b64_tr_b16 a[58:59], v88 offset:12288
    v_mfma_f32_16x16x32_bf16 v[212:215], v[196:199], v[48:51], v[212:215]
    ds_read_b64_tr_b16 a[60:61], v89 offset:8192
    ds_read_b64_tr_b16 a[62:63], v89 offset:12288
    buffer_load_dwordx4 v79, s[52:55], s95 offen offset:3072 nt lds
    s_add_u32 s95, s95, 16384
    ds_write_b128 v94, v[208:211] offset:2048
    v_xor_b32 v5, 0x2000, v94
    v_xor_b32 v6, 0x4000, v94
    v_xor_b32 v7, 0x6000, v94
    s_cmp_eq_u32 s93, 14
    s_cselect_b32 s95, 16777216, s95
    ds_write_b128 v94, v[212:215] offset:3072
    v_xor_b32 v82, 0x4000, v82
    v_xor_b32 v83, 0x4000, v83
    v_xor_b32 v84, 0x4000, v84
    v_xor_b32 v85, 0x4000, v85
    v_xor_b32 v86, 0x4000, v86
    v_xor_b32 v87, 0x4000, v87
    v_xor_b32 v88, 0x4000, v88
    v_xor_b32 v89, 0x4000, v89
    v_xor_b32 v60, 0x4000, v60
    v_xor_b32 v61, 0x4000, v61
    v_xor_b32 v62, 0x4000, v62
    v_xor_b32 v63, 0x4000, v63
    s_waitcnt lgkmcnt(0)
    s_barrier
    ds_read_b128 v[136:139], v5 offset:0
    ds_read_b128 v[152:155], v6 offset:0
    ds_read_b128 v[168:171], v7 offset:0
    ds_read_b128 v[140:143], v5 offset:1024
    ds_read_b128 v[156:159], v6 offset:1024
    ds_read_b128 v[172:175], v7 offset:1024
    ds_read_b128 v[144:147], v5 offset:2048
    ds_read_b128 v[160:163], v6 offset:2048
    ds_read_b128 v[176:179], v7 offset:2048
    ds_read_b128 v[148:151], v5 offset:3072
    ds_read_b128 v[164:167], v6 offset:3072
    ds_read_b128 v[180:183], v7 offset:3072
    v_xor_b32 v94, 0x1000, v94
    s_add_u32 s39, s90, s62
    s_mov_b32 m0, s39
    s_add_u32 s62, s62, 4096
    s_and_b32 s62, s62, 0x7fff
    buffer_load_dwordx4 v76, s[52:55], s95 offen offset:0 nt lds
    buffer_load_dwordx4 v77, s[52:55], s95 offen offset:1024 nt lds
    buffer_load_dwordx4 v78, s[52:55], s95 offen offset:2048 nt lds
    s_waitcnt lgkmcnt(9)
    v_pk_add_f32 v[200:201], v[200:201], v[136:137]
    v_pk_add_f32 v[152:153], v[152:153], v[168:169]
    v_pk_add_f32 v[202:203], v[202:203], v[138:139]
    v_pk_add_f32 v[154:155], v[154:155], v[170:171]
    v_pk_add_f32 v[200:201], v[200:201], v[152:153]
    v_pk_add_f32 v[202:203], v[202:203], v[154:155]
    s_waitcnt lgkmcnt(6)
    v_pk_add_f32 v[204:205], v[204:205], v[140:141]
    v_pk_add_f32 v[156:157], v[156:157], v[172:173]
    v_pk_add_f32 v[206:207], v[206:207], v[142:143]
    v_pk_add_f32 v[158:159], v[158:159], v[174:175]
    v_pk_add_f32 v[204:205], v[204:205], v[156:157]
    v_pk_add_f32 v[206:207], v[206:207], v[158:159]
    s_waitcnt lgkmcnt(3)
    v_pk_add_f32 v[208:209], v[208:209], v[144:145]
    v_pk_add_f32 v[160:161], v[160:161], v[176:177]
    v_pk_add_f32 v[210:211], v[210:211], v[146:147]
    v_pk_add_f32 v[162:163], v[162:163], v[178:179]
    v_pk_add_f32 v[208:209], v[208:209], v[160:161]
    v_pk_add_f32 v[210:211], v[210:211], v[162:163]
    s_waitcnt lgkmcnt(0)
    v_pk_add_f32 v[212:213], v[212:213], v[148:149]
    v_pk_add_f32 v[164:165], v[164:165], v[180:181]
    v_pk_add_f32 v[214:215], v[214:215], v[150:151]
    v_pk_add_f32 v[166:167], v[166:167], v[182:183]
    v_pk_add_f32 v[212:213], v[212:213], v[164:165]
    v_pk_add_f32 v[214:215], v[214:215], v[166:167]
    buffer_load_dwordx4 v79, s[52:55], s95 offen offset:3072 nt lds
    s_add_u32 s95, s95, 16384
    s_waitcnt vmcnt(4)
    v_max_f32 v4, v200, v201
    v_max3_f32 v4, v4, v202, v203
    v_max3_f32 v4, v4, v204, v205
    v_max3_f32 v4, v4, v206, v207
    v_max3_f32 v4, v4, v208, v209
    v_max3_f32 v4, v4, v210, v211
    v_max3_f32 v4, v4, v212, v213
    v_max3_f32 v4, v4, v214, v215
    v_mov_b32 v5, v4
    ds_read_b128 v[136:139], v60 offset:0
    ds_read_b128 v[140:143], v61 offset:0
    v_permlane16_swap_b32 v4, v5
    v_max_f32 v4, v4, v5
    v_mov_b32 v5, v4
    ds_read_b128 v[144:147], v62 offset:0
    ds_read_b128 v[148:151], v63 offset:0
    v_permlane32_swap_b32 v4, v5
    v_max_f32 v4, v4, v5
    v_mul_f32 v4, s83, v4
    v_max_f32 v4, v4, v90
    v_sub_f32 v92, v90, v4
    v_exp_f32 v92, v92
    v_mov_b32 v90, v4
    s_add_u32 s39, s90, s62
    s_mov_b32 m0, s39
    s_add_u32 s62, s62, 4096
    s_and_b32 s62, s62, 0x7fff
    buffer_load_dwordx4 v76, s[52:55], s95 offen offset:0 nt lds
    v_pk_fma_f32 v[200:201], v[200:201], s[60:61], v[90:91] op_sel_hi:[1,1,0] neg_lo:[0,0,1] neg_hi:[0,0,1]
    v_pk_fma_f32 v[202:203], v[202:203], s[60:61], v[90:91] op_sel_hi:[1,1,0] neg_lo:[0,0,1] neg_hi:[0,0,1]
    v_pk_fma_f32 v[204:205], v[204:205], s[60:61], v[90:91] op_sel_hi:[1,1,0] neg_lo:[0,0,1] neg_hi:[0,0,1]
    v_pk_fma_f32 v[206:207], v[206:207], s[60:61], v[90:91] op_sel_hi:[1,1,0] neg_lo:[0,0,1] neg_hi:[0,0,1]
    v_pk_fma_f32 v[208:209], v[208:209], s[60:61], v[90:91] op_sel_hi:[1,1,0] neg_lo:[0,0,1] neg_hi:[0,0,1]
    v_pk_fma_f32 v[210:211], v[210:211], s[60:61], v[90:91] op_sel_hi:[1,1,0] neg_lo:[0,0,1] neg_hi:[0,0,1]
    v_pk_fma_f32 v[212:213], v[212:213], s[60:61], v[90:91] op_sel_hi:[1,1,0] neg_lo:[0,0,1] neg_hi:[0,0,1]
    v_pk_fma_f32 v[214:215], v[214:215], s[60:61], v[90:91] op_sel_hi:[1,1,0] neg_lo:[0,0,1] neg_hi:[0,0,1]
    v_exp_f32 v200, v200
    v_exp_f32 v201, v201
    ds_read_b128 v[152:155], v60 offset:4096
    v_exp_f32 v202, v202
    v_exp_f32 v203, v203
    v_exp_f32 v204, v204
    v_exp_f32 v205, v205
    ds_read_b128 v[156:159], v61 offset:4096
    v_exp_f32 v206, v206
    v_exp_f32 v207, v207
    buffer_load_dwordx4 v77, s[52:55], s95 offen offset:1024 nt lds
    v_exp_f32 v208, v208
    v_exp_f32 v209, v209
    ds_read_b128 v[160:163], v62 offset:4096
    v_exp_f32 v210, v210
    v_exp_f32 v211, v211
    v_exp_f32 v212, v212
    v_exp_f32 v213, v213
    ds_read_b128 v[164:167], v63 offset:4096
    v_exp_f32 v214, v214
    v_exp_f32 v215, v215
    buffer_load_dwordx4 v78, s[52:55], s95 offen offset:2048 nt lds
    v_pk_mul_f32 v[102:103], v[102:103], v[92:93] op_sel_hi:[1,0]
    v_pk_mul_f32 v[104:105], v[104:105], v[92:93] op_sel_hi:[1,0]
    v_pk_mul_f32 v[106:107], v[106:107], v[92:93] op_sel_hi:[1,0]
    v_pk_mul_f32 v[108:109], v[108:109], v[92:93] op_sel_hi:[1,0]
    v_pk_mul_f32 v[110:111], v[110:111], v[92:93] op_sel_hi:[1,0]
    v_pk_mul_f32 v[112:113], v[112:113], v[92:93] op_sel_hi:[1,0]
    v_pk_mul_f32 v[114:115], v[114:115], v[92:93] op_sel_hi:[1,0]
    v_pk_mul_f32 v[116:117], v[116:117], v[92:93] op_sel_hi:[1,0]
    v_pk_mul_f32 v[118:119], v[118:119], v[92:93] op_sel_hi:[1,0]
    v_pk_mul_f32 v[120:121], v[120:121], v[92:93] op_sel_hi:[1,0]
    v_pk_mul_f32 v[122:123], v[122:123], v[92:93] op_sel_hi:[1,0]
    v_pk_mul_f32 v[124:125], v[124:125], v[92:93] op_sel_hi:[1,0]
    v_pk_mul_f32 v[126:127], v[126:127], v[92:93] op_sel_hi:[1,0]
    v_pk_mul_f32 v[128:129], v[128:129], v[92:93] op_sel_hi:[1,0]
    v_pk_mul_f32 v[130:131], v[130:131], v[92:93] op_sel_hi:[1,0]
    v_pk_mul_f32 v[132:133], v[132:133], v[92:93] op_sel_hi:[1,0]
    v_pk_mul_f32 v[134:135], v[134:135], v[92:93] op_sel_hi:[1,0]
    buffer_load_dwordx4 v79, s[52:55], s95 offen offset:3072 nt lds
    s_add_u32 s95, s95, 16384
    v_cvt_pk_bf16_f32 v52, v200, v201
    v_pk_add_f32 v[102:103], v[102:103], v[200:201]
    v_cvt_pk_bf16_f32 v53, v202, v203
    v_pk_add_f32 v[102:103], v[102:103], v[202:203]
    v_cvt_pk_bf16_f32 v54, v204, v205
    v_pk_add_f32 v[102:103], v[102:103], v[204:205]
    v_cvt_pk_bf16_f32 v55, v206, v207
    v_pk_add_f32 v[102:103], v[102:103], v[206:207]
    v_cvt_pk_bf16_f32 v56, v208, v209
    v_pk_add_f32 v[102:103], v[102:103], v[208:209]
    v_cvt_pk_bf16_f32 v57, v210, v211
    v_pk_add_f32 v[102:103], v[102:103], v[210:211]
    v_cvt_pk_bf16_f32 v58, v212, v213
    v_pk_add_f32 v[102:103], v[102:103], v[212:213]
    v_cvt_pk_bf16_f32 v59, v214, v215
    v_pk_add_f32 v[102:103], v[102:103], v[214:215]
    v_mfma_f32_16x16x32_bf16 v[104:107], a[0:3], v[52:55], v[104:107]
    ds_read_b128 v[168:171], v60 offset:8192
    v_mfma_f32_16x16x32_bf16 v[108:111], a[4:7], v[52:55], v[108:111]
    ds_read_b128 v[172:175], v61 offset:8192
    v_mfma_f32_16x16x32_bf16 v[112:115], a[8:11], v[52:55], v[112:115]
    ds_read_b128 v[176:179], v62 offset:8192
    v_mfma_f32_16x16x32_bf16 v[116:119], a[12:15], v[52:55], v[116:119]
    ds_read_b128 v[180:183], v63 offset:8192
    v_mfma_f32_16x16x32_bf16 v[120:123], a[16:19], v[52:55], v[120:123]
    ds_read_b128 v[184:187], v60 offset:12288
    v_mfma_f32_16x16x32_bf16 v[124:127], a[20:23], v[52:55], v[124:127]
    ds_read_b128 v[188:191], v61 offset:12288
    v_mfma_f32_16x16x32_bf16 v[128:131], a[24:27], v[52:55], v[128:131]
    ds_read_b128 v[192:195], v62 offset:12288
    v_mfma_f32_16x16x32_bf16 v[132:135], a[28:31], v[52:55], v[132:135]
    ds_read_b128 v[196:199], v63 offset:12288
    v_mfma_f32_16x16x32_bf16 v[104:107], a[32:35], v[56:59], v[104:107]
    v_mfma_f32_16x16x32_bf16 v[108:111], a[36:39], v[56:59], v[108:111]
    s_add_u32 s39, s90, s62
    s_mov_b32 m0, s39
    s_add_u32 s62, s62, 4096
    s_and_b32 s62, s62, 0x7fff
    buffer_load_dwordx4 v76, s[52:55], s95 offen offset:0 nt lds
    v_mfma_f32_16x16x32_bf16 v[112:115], a[40:43], v[56:59], v[112:115]
    v_mfma_f32_16x16x32_bf16 v[116:119], a[44:47], v[56:59], v[116:119]
    v_mfma_f32_16x16x32_bf16 v[120:123], a[48:51], v[56:59], v[120:123]
    v_mfma_f32_16x16x32_bf16 v[124:127], a[52:55], v[56:59], v[124:127]
    buffer_load_dwordx4 v77, s[52:55], s95 offen offset:1024 nt lds
    v_mfma_f32_16x16x32_bf16 v[128:131], a[56:59], v[56:59], v[128:131]
    v_mfma_f32_16x16x32_bf16 v[132:135], a[60:63], v[56:59], v[132:135]
    s_add_u32 s93, s93, 1
    s_cmp_lt_u32 s93, 16
    s_cbranch_scc1 L_att
    v_add_f32 v91, v102, v103
    v_mov_b32 v5, v91
    s_nop 1
    v_permlane16_swap_b32 v91, v5
    v_add_f32 v91, v91, v5
    v_mov_b32 v5, v91
    s_nop 1
    v_permlane32_swap_b32 v91, v5
    v_add_f32 v91, v91, v5
    v_lshrrev_b32 v6, 1, v2
    v_xor_b32 v6, v6, v3
    v_lshlrev_b32 v5, 8, v3
    v_lshl_add_u32 v5, v6, 4, v5
    v_bfe_u32 v4, v2, 0, 1
    v_lshl_add_u32 v5, v4, 3, v5
    v_add_u32 v5, s85, v5
    s_waitcnt vmcnt(0) lgkmcnt(0)
    s_barrier
    v_cvt_pk_bf16_f32 v216, v104, v105
    v_cvt_pk_bf16_f32 v217, v106, v107
    v_xor_b32 v82, 0, v5
    ds_write_b64 v82, v[216:217]
    v_cvt_pk_bf16_f32 v218, v108, v109
    v_cvt_pk_bf16_f32 v219, v110, v111
    v_xor_b32 v83, 32, v5
    ds_write_b64 v83, v[218:219]
    v_cvt_pk_bf16_f32 v220, v112, v113
    v_cvt_pk_bf16_f32 v221, v114, v115
    v_xor_b32 v84, 64, v5
    ds_write_b64 v84, v[220:221]
    v_cvt_pk_bf16_f32 v222, v116, v117
    v_cvt_pk_bf16_f32 v223, v118, v119
    v_xor_b32 v85, 96, v5
    ds_write_b64 v85, v[222:223]
    v_cvt_pk_bf16_f32 v224, v120, v121
    v_cvt_pk_bf16_f32 v225, v122, v123
    v_xor_b32 v86, 128, v5
    ds_write_b64 v86, v[224:225]
    v_cvt_pk_bf16_f32 v226, v124, v125
    v_cvt_pk_bf16_f32 v227, v126, v127
    v_xor_b32 v87, 160, v5
    ds_write_b64 v87, v[226:227]
    v_cvt_pk_bf16_f32 v228, v128, v129
    v_cvt_pk_bf16_f32 v229, v130, v131
    v_xor_b32 v88, 192, v5
    ds_write_b64 v88, v[228:229]
    v_cvt_pk_bf16_f32 v230, v132, v133
    v_cvt_pk_bf16_f32 v231, v134, v135
    v_xor_b32 v89, 224, v5
    ds_write_b64 v89, v[230:231]
    v_xor_b32 v6, v3, v2
    v_lshlrev_b32 v6, 4, v6
    v_lshl_add_u32 v4, v2, 8, v6
    v_add_u32 v4, s85, v4
    v_xor_b32 v60, 0, v4
    v_xor_b32 v61, 64, v4
    v_xor_b32 v62, 128, v4
    v_xor_b32 v63, 192, v4
    v_lshlrev_b32 v7, 4, v3
    v_lshl_add_u32 v7, v2, 14, v7
    s_lshl_b32 s38, s94, 18
    s_add_u32 s36, s38, 2097152
    s_lshl_b32 s38, s3, 10
    s_add_u32 s36, s38, s36
    s_lshl_b32 s38, s34, 8
    s_add_u32 s36, s38, s36
    s_waitcnt lgkmcnt(0)
    ds_read_b128 v[200:203], v60 offset:0
    ds_read_b128 v[204:207], v61 offset:1024
    ds_read_b128 v[208:211], v62 offset:2048
    ds_read_b128 v[212:215], v63 offset:3072
    v_lshlrev_b32 v4, 3, v3
    s_lshl_b32 s38, s3, 8
    s_add_u32 s37, s38, 163840
    s_lshl_b32 s38, s94, 7
    s_add_u32 s37, s38, s37
    s_lshl_b32 s38, s34, 23
    s_add_u32 s37, s38, s37
    s_mov_b32 exec_lo, 0xffff
    s_mov_b32 exec_hi, 0x0
    buffer_store_dwordx2 v[90:91], v4, s[48:51], s37 offen sc1
    s_mov_b64 exec, -1
    s_waitcnt lgkmcnt(3)
    buffer_store_dwordx4 v[200:203], v7, s[48:51], s36 offen sc1
    s_add_u32 s36, s36, 65536
    s_waitcnt lgkmcnt(2)
    buffer_store_dwordx4 v[204:207], v7, s[48:51], s36 offen sc1
    s_add_u32 s36, s36, 65536
    s_waitcnt lgkmcnt(1)
    buffer_store_dwordx4 v[208:211], v7, s[48:51], s36 offen sc1
    s_add_u32 s36, s36, 65536
    s_waitcnt lgkmcnt(0)
    buffer_store_dwordx4 v[212:215], v7, s[48:51], s36 offen sc1
    s_sub_u32 s36, s33, 3
    s_and_b32 s37, s33, 3
    s_cmp_lt_u32 s36, 4
    s_cselect_b64 s[40:41], s[24:25], s[14:15]
    s_cselect_b32 s36, s36, s37
    s_cselect_b32 s45, 262144, 0
    s_cselect_b32 s46, 8388608, 0
    s_add_u32 s45, s45, 524288
    s_add_u32 s46, s46, 196608
    s_mov_b32 s42, 4194304
    s_mov_b32 s43, 0x20000
    s_lshl_b32 s38, s32, 17
    s_add_u32 s44, s38, 0
    s_lshl_b32 s38, s34, 15
    s_add_u32 s44, s38, s44
    s_lshl_b32 s38, s36, 8
    s_add_u32 s44, s38, s44
    s_lshl_b32 s38, s36, 16
    s_add_u32 s45, s38, s45
    s_lshr_b32 s38, s34, 1
    s_lshl_b32 s38, s38, 15
    s_add_u32 s45, s38, s45
    s_lshl_b32 s38, s32, 8
    s_add_u32 s45, s38, s45
    s_bfe_u32 s38, s34, 0x10000
    s_lshl_b32 s38, s38, 7
    s_add_u32 s45, s38, s45
    s_lshl_b32 s38, s32, 11
    s_add_u32 s46, s38, s46
    s_lshl_b32 s38, s34, 9
    s_add_u32 s46, s38, s46
    s_mov_b32 s72, s26
    s_and_b32 s73, s27, 0xffff
    s_mov_b32 s74, 8192
    s_mov_b32 s75, 0x20000
    s_lshl_b32 s39, s34, 13
    s_add_u32 s39, s39, 98304
    s_mov_b32 m0, s39
    s_nop 0
    buffer_load_dwordx4 v76, s[40:43], s44 offen offset:0 nt lds
    buffer_load_dwordx4 v77, s[40:43], s44 offen offset:1024 nt lds
    buffer_load_dwordx4 v78, s[40:43], s44 offen offset:2048 nt lds
    buffer_load_dwordx4 v79, s[40:43], s44 offen offset:3072 nt lds
    s_lshl_b32 s39, s34, 13
    s_add_u32 s39, s39, 102400
    s_mov_b32 m0, s39
    s_add_u32 s44, s44, 16384
    buffer_load_dwordx4 v76, s[40:43], s44 offen offset:0 nt lds
    buffer_load_dwordx4 v77, s[40:43], s44 offen offset:1024 nt lds
    buffer_load_dwordx4 v78, s[40:43], s44 offen offset:2048 nt lds
    buffer_load_dwordx4 v79, s[40:43], s44 offen offset:3072 nt lds
    v_lshlrev_b32 v30, 4, v3
    v_lshl_add_u32 v30, v2, 13, v30
    s_lshl_b32 s38, s32, 13
    s_add_u32 s36, s38, 0
    s_lshl_b32 s38, s34, 6
    s_add_u32 s36, s38, s36
    v_lshrrev_b32 v5, 2, v1
    v_lshlrev_b32 v32, 8, v5
    v_bfe_u32 v5, v1, 0, 2
    v_lshl_add_u32 v32, v5, 4, v32
    v_add_u32 v32, s36, v32
    s_lshr_b32 s38, s32, 2
    s_lshl_b32 s38, s38, 7
    s_add_u32 s36, s38, 0
    s_lshl_b32 s38, s34, 5
    s_add_u32 s36, s38, s36
    s_bfe_u32 s38, s32, 0x20000
    s_lshl_b32 s38, s38, 3
    s_add_u32 s36, s38, s36
    v_bfe_u32 v5, v1, 0, 2
    v_lshlrev_b32 v33, 11, v5
    v_lshl_add_u32 v33, v2, 1, v33
    v_add_u32 v33, s36, v33
    v_and_b32 v5, 31, v1
    v_lshlrev_b32 v34, 4, v5
    s_mul_i32 s38, s34, 320
    s_add_u32 s38, s38, 135168
    v_lshl_add_u32 v35, v5, 3, s38
    v_bfe_u32 v5, v3, 0, 2
    v_lshlrev_b32 v81, 10, v5
    v_lshrrev_b32 v5, 2, v3
    v_lshl_add_u32 v81, v5, 8, v81
    v_add3_u32 v82, v81, v6, s85
    v_xor_b32 v83, 64, v82
    v_xor_b32 v84, 128, v82
    v_xor_b32 v85, 192, v82
    v_bfe_u32 v5, v3, 0, 2
    v_lshlrev_b32 v94, 9, v5
    v_lshl_add_u32 v94, v2, 4, v94
    v_add_u32 v94, s85, v94
    s_lshl_b32 s38, s34, 9
    s_add_u32 s38, s38, 131072
    v_add_u32 v102, s38, v34
    s_lshl_b32 s38, s32, 14
    s_add_u32 s36, s38, 2097152
    s_lshl_b32 s38, s34, 8
    s_add_u32 s36, s38, s36
    s_lshl_b32 s38, s32, 3
    s_add_u32 s37, s38, 163840
    s_lshl_b32 s38, s32, 8
    s_add_u32 s69, s38, 131072
    s_lshl_b32 s38, s34, 23
    s_add_u32 s69, s38, s69
    v_mov_b32 v4, s69
    v_mov_b32 v5, s68
    s_waitcnt vmcnt(8)
    s_barrier
    s_mov_b64 exec, 1
    buffer_store_dword v5, v4, s[48:51], 0 offen sc1
    s_mov_b64 exec, -1
    s_mov_b32 s86, 131072
    buffer_load_dword v7, v101, s[48:51], s86 offen sc1
    s_waitcnt vmcnt(0)
L_fcheck_20:
    v_cmp_ne_u32 vcc, s68, v7
    s_cbranch_vccz L_fok_21
    s_sleep 2
    s_mov_b32 s86, 131072
    buffer_load_dword v7, v101, s[48:51], s86 offen sc1
    s_waitcnt vmcnt(0)
    s_sub_u32 s84, s84, 1
    s_cmp_lg_u32 s84, 0
    s_cbranch_scc1 L_fcheck_20
    s_branch L_end
L_fok_21:
    buffer_load_dwordx2 v[52:53], v81, s[48:51], s37 offen sc1
    buffer_load_dwordx4 v[200:203], v9, s[48:51], s36 offen sc1
    s_add_u32 s36, s36, 4096
    buffer_load_dwordx4 v[204:207], v9, s[48:51], s36 offen sc1
    s_add_u32 s36, s36, 4096
    buffer_load_dwordx4 v[208:211], v9, s[48:51], s36 offen sc1
    s_add_u32 s36, s36, 4096
    buffer_load_dwordx4 v[212:215], v9, s[48:51], s36 offen sc1
    s_waitcnt vmcnt(4)
    v_max_f32_dpp v4, v52, v52 row_ror:8 row_mask:0xf bank_mask:0xf
    s_nop 1
    v_max_f32_dpp v4, v4, v4 row_ror:4 row_mask:0xf bank_mask:0xf
    v_sub_f32 v52, v52, v4
    v_exp_f32 v52, v52
    s_nop 0
    v_mul_f32 v5, v52, v53
    s_nop 1
    v_add_f32_dpp v5, v5, v5 row_ror:8 row_mask:0xf bank_mask:0xf
    s_nop 1
    v_add_f32_dpp v5, v5, v5 row_ror:4 row_mask:0xf bank_mask:0xf
    v_rcp_f32 v5, v5
    s_nop 0
    v_mul_f32 v52, v52, v5
    s_waitcnt vmcnt(3)
    ds_write_b128 v96, v[200:203] offset:0
    s_waitcnt vmcnt(2)
    ds_write_b128 v97, v[204:207] offset:1024
    s_waitcnt vmcnt(1)
    ds_write_b128 v98, v[208:211] offset:2048
    s_waitcnt vmcnt(0)
    ds_write_b128 v99, v[212:215] offset:3072
    s_waitcnt lgkmcnt(0)
    ds_read_b128 v[136:139], v82
    ds_read_b128 v[140:143], v83
    ds_read_b128 v[144:147], v84
    ds_read_b128 v[148:151], v85
    s_waitcnt lgkmcnt(0)
    v_mfma_f32_16x16x32_bf16 v[104:107], a[128:131], v[136:139], 0
    v_mfma_f32_16x16x32_bf16 v[104:107], a[132:135], v[140:143], v[104:107]
    v_mfma_f32_16x16x32_bf16 v[104:107], a[136:139], v[144:147], v[104:107]
    v_mfma_f32_16x16x32_bf16 v[104:107], a[140:143], v[148:151], v[104:107]
    v_mfma_f32_16x16x32_bf16 v[108:111], a[144:147], v[136:139], 0
    v_mfma_f32_16x16x32_bf16 v[108:111], a[148:151], v[140:143], v[108:111]
    v_mfma_f32_16x16x32_bf16 v[108:111], a[152:155], v[144:147], v[108:111]
    v_mfma_f32_16x16x32_bf16 v[108:111], a[156:159], v[148:151], v[108:111]
    v_mfma_f32_16x16x32_bf16 v[112:115], a[160:163], v[136:139], 0
    v_mfma_f32_16x16x32_bf16 v[112:115], a[164:167], v[140:143], v[112:115]
    v_mfma_f32_16x16x32_bf16 v[112:115], a[168:171], v[144:147], v[112:115]
    v_mfma_f32_16x16x32_bf16 v[112:115], a[172:175], v[148:151], v[112:115]
    v_mul_f32 v104, v104, v52
    v_mul_f32 v105, v105, v52
    v_mul_f32 v106, v106, v52
    v_mul_f32 v107, v107, v52
    v_add_f32_dpp v104, v104, v104 row_ror:8 row_mask:0xf bank_mask:0xf
    v_add_f32_dpp v105, v105, v105 row_ror:8 row_mask:0xf bank_mask:0xf
    v_add_f32_dpp v106, v106, v106 row_ror:8 row_mask:0xf bank_mask:0xf
    v_add_f32_dpp v107, v107, v107 row_ror:8 row_mask:0xf bank_mask:0xf
    v_add_f32_dpp v104, v104, v104 row_ror:4 row_mask:0xf bank_mask:0xf
    v_add_f32_dpp v105, v105, v105 row_ror:4 row_mask:0xf bank_mask:0xf
    v_add_f32_dpp v106, v106, v106 row_ror:4 row_mask:0xf bank_mask:0xf
    v_add_f32_dpp v107, v107, v107 row_ror:4 row_mask:0xf bank_mask:0xf
    ds_write_b128 v94, v[104:107] offset:0
    v_mfma_f32_16x16x32_bf16 v[116:119], a[176:179], v[136:139], 0
    v_mfma_f32_16x16x32_bf16 v[116:119], a[180:183], v[140:143], v[116:119]
    v_mfma_f32_16x16x32_bf16 v[116:119], a[184:187], v[144:147], v[116:119]
    v_mfma_f32_16x16x32_bf16 v[116:119], a[188:191], v[148:151], v[116:119]
    v_mul_f32 v108, v108, v52
    v_mul_f32 v109, v109, v52
    v_mul_f32 v110, v110, v52
    v_mul_f32 v111, v111, v52
    v_add_f32_dpp v108, v108, v108 row_ror:8 row_mask:0xf bank_mask:0xf
    v_add_f32_dpp v109, v109, v109 row_ror:8 row_mask:0xf bank_mask:0xf
    v_add_f32_dpp v110, v110, v110 row_ror:8 row_mask:0xf bank_mask:0xf
    v_add_f32_dpp v111, v111, v111 row_ror:8 row_mask:0xf bank_mask:0xf
    v_add_f32_dpp v108, v108, v108 row_ror:4 row_mask:0xf bank_mask:0xf
    v_add_f32_dpp v109, v109, v109 row_ror:4 row_mask:0xf bank_mask:0xf
    v_add_f32_dpp v110, v110, v110 row_ror:4 row_mask:0xf bank_mask:0xf
    v_add_f32_dpp v111, v111, v111 row_ror:4 row_mask:0xf bank_mask:0xf
    ds_write_b128 v94, v[108:111] offset:64
    v_mfma_f32_16x16x32_bf16 v[120:123], a[192:195], v[136:139], 0
    v_mfma_f32_16x16x32_bf16 v[120:123], a[196:199], v[140:143], v[120:123]
    v_mfma_f32_16x16x32_bf16 v[120:123], a[200:203], v[144:147], v[120:123]
    v_mfma_f32_16x16x32_bf16 v[120:123], a[204:207], v[148:151], v[120:123]
    v_mul_f32 v112, v112, v52
    v_mul_f32 v113, v113, v52
    v_mul_f32 v114, v114, v52
    v_mul_f32 v115, v115, v52
    v_add_f32_dpp v112, v112, v112 row_ror:8 row_mask:0xf bank_mask:0xf
    v_add_f32_dpp v113, v113, v113 row_ror:8 row_mask:0xf bank_mask:0xf
    v_add_f32_dpp v114, v114, v114 row_ror:8 row_mask:0xf bank_mask:0xf
    v_add_f32_dpp v115, v115, v115 row_ror:8 row_mask:0xf bank_mask:0xf
    v_add_f32_dpp v112, v112, v112 row_ror:4 row_mask:0xf bank_mask:0xf
    v_add_f32_dpp v113, v113, v113 row_ror:4 row_mask:0xf bank_mask:0xf
    v_add_f32_dpp v114, v114, v114 row_ror:4 row_mask:0xf bank_mask:0xf
    v_add_f32_dpp v115, v115, v115 row_ror:4 row_mask:0xf bank_mask:0xf
    ds_write_b128 v94, v[112:115] offset:128
    v_mfma_f32_16x16x32_bf16 v[124:127], a[208:211], v[136:139], 0
    v_mfma_f32_16x16x32_bf16 v[124:127], a[212:215], v[140:143], v[124:127]
    v_mfma_f32_16x16x32_bf16 v[124:127], a[216:219], v[144:147], v[124:127]
    v_mfma_f32_16x16x32_bf16 v[124:127], a[220:223], v[148:151], v[124:127]
    v_mul_f32 v116, v116, v52
    v_mul_f32 v117, v117, v52
    v_mul_f32 v118, v118, v52
    v_mul_f32 v119, v119, v52
    v_add_f32_dpp v116, v116, v116 row_ror:8 row_mask:0xf bank_mask:0xf
    v_add_f32_dpp v117, v117, v117 row_ror:8 row_mask:0xf bank_mask:0xf
    v_add_f32_dpp v118, v118, v118 row_ror:8 row_mask:0xf bank_mask:0xf
    v_add_f32_dpp v119, v119, v119 row_ror:8 row_mask:0xf bank_mask:0xf
    v_add_f32_dpp v116, v116, v116 row_ror:4 row_mask:0xf bank_mask:0xf
    v_add_f32_dpp v117, v117, v117 row_ror:4 row_mask:0xf bank_mask:0xf
    v_add_f32_dpp v118, v118, v118 row_ror:4 row_mask:0xf bank_mask:0xf
    v_add_f32_dpp v119, v119, v119 row_ror:4 row_mask:0xf bank_mask:0xf
    ds_write_b128 v94, v[116:119] offset:192
    v_mfma_f32_16x16x32_bf16 v[128:131], a[224:227], v[136:139], 0
    v_mfma_f32_16x16x32_bf16 v[128:131], a[228:231], v[140:143], v[128:131]
    v_mfma_f32_16x16x32_bf16 v[128:131], a[232:235], v[144:147], v[128:131]
    v_mfma_f32_16x16x32_bf16 v[128:131], a[236:239], v[148:151], v[128:131]
    v_mul_f32 v120, v120, v52
    v_mul_f32 v121, v121, v52
    v_mul_f32 v122, v122, v52
    v_mul_f32 v123, v123, v52
    v_add_f32_dpp v120, v120, v120 row_ror:8 row_mask:0xf bank_mask:0xf
    v_add_f32_dpp v121, v121, v121 row_ror:8 row_mask:0xf bank_mask:0xf
    v_add_f32_dpp v122, v122, v122 row_ror:8 row_mask:0xf bank_mask:0xf
    v_add_f32_dpp v123, v123, v123 row_ror:8 row_mask:0xf bank_mask:0xf
    v_add_f32_dpp v120, v120, v120 row_ror:4 row_mask:0xf bank_mask:0xf
    v_add_f32_dpp v121, v121, v121 row_ror:4 row_mask:0xf bank_mask:0xf
    v_add_f32_dpp v122, v122, v122 row_ror:4 row_mask:0xf bank_mask:0xf
    v_add_f32_dpp v123, v123, v123 row_ror:4 row_mask:0xf bank_mask:0xf
    ds_write_b128 v94, v[120:123] offset:256
    v_mfma_f32_16x16x32_bf16 v[132:135], a[240:243], v[136:139], 0
    v_mfma_f32_16x16x32_bf16 v[132:135], a[244:247], v[140:143], v[132:135]
    v_mfma_f32_16x16x32_bf16 v[132:135], a[248:251], v[144:147], v[132:135]
    v_mfma_f32_16x16x32_bf16 v[132:135], a[252:255], v[148:151], v[132:135]
    v_mul_f32 v124, v124, v52
    v_mul_f32 v125, v125, v52
    v_mul_f32 v126, v126, v52
    v_mul_f32 v127, v127, v52
    v_add_f32_dpp v124, v124, v124 row_ror:8 row_mask:0xf bank_mask:0xf
    v_add_f32_dpp v125, v125, v125 row_ror:8 row_mask:0xf bank_mask:0xf
    v_add_f32_dpp v126, v126, v126 row_ror:8 row_mask:0xf bank_mask:0xf
    v_add_f32_dpp v127, v127, v127 row_ror:8 row_mask:0xf bank_mask:0xf
    v_add_f32_dpp v124, v124, v124 row_ror:4 row_mask:0xf bank_mask:0xf
    v_add_f32_dpp v125, v125, v125 row_ror:4 row_mask:0xf bank_mask:0xf
    v_add_f32_dpp v126, v126, v126 row_ror:4 row_mask:0xf bank_mask:0xf
    v_add_f32_dpp v127, v127, v127 row_ror:4 row_mask:0xf bank_mask:0xf
    ds_write_b128 v94, v[124:127] offset:320
    v_mul_f32 v128, v128, v52
    v_mul_f32 v129, v129, v52
    v_mul_f32 v130, v130, v52
    v_mul_f32 v131, v131, v52
    v_add_f32_dpp v128, v128, v128 row_ror:8 row_mask:0xf bank_mask:0xf
    v_add_f32_dpp v129, v129, v129 row_ror:8 row_mask:0xf bank_mask:0xf
    v_add_f32_dpp v130, v130, v130 row_ror:8 row_mask:0xf bank_mask:0xf
    v_add_f32_dpp v131, v131, v131 row_ror:8 row_mask:0xf bank_mask:0xf
    v_add_f32_dpp v128, v128, v128 row_ror:4 row_mask:0xf bank_mask:0xf
    v_add_f32_dpp v129, v129, v129 row_ror:4 row_mask:0xf bank_mask:0xf
    v_add_f32_dpp v130, v130, v130 row_ror:4 row_mask:0xf bank_mask:0xf
    v_add_f32_dpp v131, v131, v131 row_ror:4 row_mask:0xf bank_mask:0xf
    ds_write_b128 v94, v[128:131] offset:384
    v_mul_f32 v132, v132, v52
    v_mul_f32 v133, v133, v52
    v_mul_f32 v134, v134, v52
    v_mul_f32 v135, v135, v52
    v_add_f32_dpp v132, v132, v132 row_ror:8 row_mask:0xf bank_mask:0xf
    v_add_f32_dpp v133, v133, v133 row_ror:8 row_mask:0xf bank_mask:0xf
    v_add_f32_dpp v134, v134, v134 row_ror:8 row_mask:0xf bank_mask:0xf
    v_add_f32_dpp v135, v135, v135 row_ror:8 row_mask:0xf bank_mask:0xf
    v_add_f32_dpp v132, v132, v132 row_ror:4 row_mask:0xf bank_mask:0xf
    v_add_f32_dpp v133, v133, v133 row_ror:4 row_mask:0xf bank_mask:0xf
    v_add_f32_dpp v134, v134, v134 row_ror:4 row_mask:0xf bank_mask:0xf
    v_add_f32_dpp v135, v135, v135 row_ror:4 row_mask:0xf bank_mask:0xf
    ds_write_b128 v94, v[132:135] offset:448
    s_waitcnt lgkmcnt(0)
    s_barrier
    ds_read_b128 v[136:139], v102 offset:0
    ds_read_b128 v[140:143], v102 offset:8192
    ds_read_b128 v[144:147], v102 offset:16384
    ds_read_b128 v[148:151], v102 offset:24576
    s_waitcnt lgkmcnt(0)
    v_add_f32 v136, v136, v140
    v_add_f32 v144, v144, v148
    v_add_f32 v137, v137, v141
    v_add_f32 v145, v145, v149
    v_add_f32 v138, v138, v142
    v_add_f32 v146, v146, v150
    v_add_f32 v139, v139, v143
    v_add_f32 v147, v147, v151
    v_add_f32 v136, v136, v144
    v_add_f32 v137, v137, v145
    v_add_f32 v138, v138, v146
    v_add_f32 v139, v139, v147
    s_mov_b32 s38, 0xffff0000
    v_cvt_pk_bf16_f32 v136, v136, v136
    v_cvt_pk_bf16_f32 v137, v137, v137
    v_cvt_pk_bf16_f32 v138, v138, v138
    v_cvt_pk_bf16_f32 v139, v139, v139
    v_and_or_b32 v136, v136, s38, v8
    v_and_or_b32 v137, v137, s38, v8
    v_and_or_b32 v138, v138, s38, v8
    v_and_or_b32 v139, v139, s38, v8
    s_mov_b32 exec_lo, 0xffffffff
    s_mov_b32 exec_hi, 0x0
    buffer_store_dwordx4 v[136:139], v34, s[48:51], s46 offen sc1
    s_mov_b64 exec, -1
    v_xor_b32 v224, s35, v136
    v_xor_b32 v225, s35, v137
    v_xor_b32 v226, s35, v138
    v_xor_b32 v227, s35, v139
    v_lshlrev_b32 v4, 11, v2
    v_bfe_u32 v5, v1, 2, 2
    v_lshl_add_u32 v4, v5, 8, v4
    v_bfe_u32 v5, v1, 2, 2
    v_lshl_add_u32 v4, v5, 6, v4
    v_bfe_u32 v5, v1, 4, 1
    v_lshl_add_u32 v4, v5, 5, v4
    v_bfe_u32 v5, v1, 1, 1
    v_lshl_add_u32 v4, v5, 4, v4
    v_bfe_u32 v5, v1, 0, 1
    v_lshl_add_u32 v4, v5, 3, v4
    s_lshl_b32 s38, s34, 6
    s_add_u32 s38, s38, 98304
    v_xor_b32 v24, s38, v4
    v_xor_b32 v25, 16, v24
    v_xor_b32 v26, 32, v24
    v_xor_b32 v27, 48, v24
    v_and_b32 v4, 3, v3
    v_lshrrev_b32 v5, 2, v3
    v_lshlrev_b32 v6, 4, v2
    v_add_u32 v6, 135168, v6
    s_movk_i32 s36, 320
    v_cmp_eq_u32 vcc, 0, v5
    s_nop 1
    v_cndmask_b32 v28, 4, v4, vcc
    v_mad_u32_u24 v28, v28, s36, v6
    v_cmp_eq_u32 vcc, 1, v5
    s_nop 1
    v_cndmask_b32 v29, 4, v4, vcc
    v_mad_u32_u24 v29, v29, s36, v6
    v_lshlrev_b32 v5, 2, v1
    v_add_u32 v5, 136448, v5
    v_mov_b32 v6, 0
    ds_write_b32 v5, v6
    s_branch L_ctxok
.section .rodata,"a"
.p2align 6
.amdhsa_kernel concat_heads__compressed_kv_cla__mha_block_cached__decode_kernel
  .amdhsa_next_free_vgpr 512
  .amdhsa_next_free_sgpr 102
  .amdhsa_accum_offset 256
  .amdhsa_group_segment_fixed_size 0
  .amdhsa_kernarg_size 112
  .amdhsa_user_sgpr_count 2
  .amdhsa_user_sgpr_kernarg_segment_ptr 1
  .amdhsa_system_sgpr_workgroup_id_x 1
.end_amdhsa_kernel
```

```asm
; @launch grid=(256,1,1) block=(256,1,1) lds=163840
    .amdgcn_target "amdgcn-amd-amdhsa--gfx950"
    .text
    .globl concat_heads__compressed_kv_cla__mha_block_cached__decode_kernel
    .p2align 8
    .type concat_heads__compressed_kv_cla__mha_block_cached__decode_kernel,@function
concat_heads__compressed_kv_cla__mha_block_cached__decode_kernel:
    s_cmp_ge_u32 s2, 256
    s_cbranch_scc1 L_end
    s_load_dwordx16 s[4:19], s[0:1], 0
    s_load_dwordx8 s[20:27], s[0:1], 64
    s_load_dwordx4 s[28:31], s[0:1], 96
    v_lshrrev_b32 v4, 6, v0
    v_and_b32 v1, 63, v0
    v_readfirstlane_b32 s34, v4
    s_lshr_b32 s32, s2, 3
    s_sub_u32 s33, s2, s32
    s_sub_u32 s33, s33, 1
    s_and_b32 s33, s33, 7
    v_lshrrev_b32 v2, 4, v1
    v_and_b32 v3, 15, v1
    s_cmp_lt_u32 s33, 2
    s_cbranch_scc1 L_qp
    s_cmp_eq_u32 s33, 2
    s_cbranch_scc1 L_ql
    s_cmp_eq_u32 s33, 7
    s_cbranch_scc1 L_aux
    s_bfe_u32 s38, s2, 0x30000
    s_lshl_b32 s38, s38, 21
    s_add_u32 s36, s38, -393216
    s_lshr_b32 s38, s32, 3
    s_lshl_b32 s38, s38, 19
    s_add_u32 s36, s38, s36
    s_lshl_b32 s38, s33, 17
    s_add_u32 s36, s38, s36
    s_lshl_b32 s38, s34, 12
    s_add_u32 s36, s38, s36
    v_bfe_u32 v5, v1, 0, 5
    v_lshlrev_b32 v4, 7, v5
    v_lshrrev_b32 v5, 5, v1
    v_lshl_add_u32 v4, v5, 15, v4
    s_mov_b32 s42, 16777216
    s_mov_b32 s43, 0x20000
    s_waitcnt lgkmcnt(0)
    s_mov_b64 s[40:41], s[6:7]
    buffer_load_dword v20, v4, s[40:43], s36 offen
    s_add_u32 s36, s36, 16384
    buffer_load_dword v21, v4, s[40:43], s36 offen
    s_add_u32 s36, s36, 49152
    buffer_load_dword v22, v4, s[40:43], s36 offen
    s_add_u32 s36, s36, 16384
    buffer_load_dword v23, v4, s[40:43], s36 offen
    s_load_dword s35, s[30:31], 0
    s_mov_b32 s48, s30
    s_and_b32 s49, s31, 0xffff
    s_mov_b32 s50, 8388608
    s_mov_b32 s51, 0x20000
    s_mov_b32 s82, 0xffffff00
    s_mov_b32 s83, 0x3e0293ee
    s_mov_b32 s84, 2097152
    v_lshrrev_b32 v4, 2, v3
    v_and_b32 v5, 3, v3
    v_lshlrev_b32 v76, 8, v4
    v_lshlrev_b32 v126, 8, v2
    v_lshl_add_u32 v76, v2, 6, v76
    v_lshl_add_u32 v76, v5, 4, v76
    v_lshl_add_u32 v126, v3, 4, v126
    v_xor_b32 v77, 32768, v76
    v_xor_b32 v127, 32768, v126
    s_add_u32 s3, s34, s33
    s_and_b32 s3, s3, 3
    s_lshl_b32 s89, s3, 5
    s_add_u32 s89, s89, s32
    s_lshl_b32 s89, s89, 20
    s_mul_i32 s88, s32, 8
    s_add_u32 s88, s88, s3
    s_lshl_b32 s87, s33, 0
    s_mov_b32 s52, s18
    s_and_b32 s53, s19, 0xffff
    s_mov_b32 s54, 134217728
    s_mov_b32 s55, 0x20000
    s_mov_b32 s56, s20
    s_and_b32 s57, s21, 0xffff
    s_mov_b32 s58, 134217728
    s_mov_b32 s59, 0x20000
    v_and_b32 v4, 1, v1
    v_lshlrev_b32 v4, 4, v4
    v_mov_b32 v5, 0xffff
    v_lshlrev_b32 v4, v4, v5
    v_bfe_u32 v5, v1, 1, 2
    v_cmp_eq_u32 vcc, 0, v5
    s_nop 1
    v_cndmask_b32 v10, 0, v4, vcc
    v_cmp_eq_u32 vcc, 1, v5
    s_nop 1
    v_cndmask_b32 v11, 0, v4, vcc
    v_cmp_eq_u32 vcc, 2, v5
    s_nop 1
    v_cndmask_b32 v12, 0, v4, vcc
    v_cmp_eq_u32 vcc, 3, v5
    s_nop 1
    v_cndmask_b32 v13, 0, v4, vcc
    v_mov_b32 v120, 0xff7f0000
    v_mov_b32 v121, 0
    v_mov_b32 v18, 1
    v_mov_b32 v116, 0
    v_mov_b32 v117, 0
    v_mov_b32 v118, 0
    v_mov_b32 v119, 0
    s_lshl_b32 s38, s32, 10
    s_add_u32 s96, s38, 65536
    s_lshl_b32 s38, s3, 8
    s_add_u32 s96, s38, s96
    v_mov_b32 v9, s96
    s_lshl_b32 s38, s32, 15
    s_add_u32 s96, s38, 1048576
    s_lshl_b32 s38, s3, 13
    s_add_u32 s96, s38, s96
    s_lshl_b32 s38, s33, 10
    s_add_u32 s96, s38, s96
    v_and_b32 v5, 3, v3
    v_lshlrev_b32 v78, 7, v2
    v_lshl_add_u32 v78, v5, 5, v78
    s_lshl_b32 s38, s32, 12
    s_add_u32 s91, s38, 262144
    s_lshl_b32 s38, s3, 9
    s_add_u32 s91, s38, s91
    v_lshlrev_b32 v4, 7, v2
    v_lshl_add_u32 v4, v3, 4, v4
    v_mov_b32 v5, 512
    v_cmp_gt_u32 vcc, 8, v3
    s_nop 1
    v_cndmask_b32 v79, v5, v4, vcc
    s_add_u32 s39, s87, s88
    s_bfe_u32 s37, s39, 0x30000
    s_lshl_b32 s37, s37, 12
    s_add_u32 s85, s37, s89
    s_bfe_u32 s37, s39, 0x10003
    s_lshl_b32 s37, s37, 11
    s_add_u32 s85, s37, s85
    s_bfe_u32 s37, s39, 0x40004
    s_lshl_b32 s37, s37, 16
    s_add_u32 s85, s37, s85
    buffer_load_dwordx4 v[128:131], v76, s[52:55], s85 offen offset:0 nt
    buffer_load_dwordx4 v[132:135], v77, s[52:55], s85 offen offset:0 nt
    buffer_load_dwordx4 v[136:139], v76, s[52:55], s85 offen offset:1024 nt
    buffer_load_dwordx4 v[140:143], v77, s[52:55], s85 offen offset:1024 nt
    s_add_u32 s87, s87, 7
    s_add_u32 s39, s87, s88
    s_bfe_u32 s37, s39, 0x30000
    s_lshl_b32 s37, s37, 12
    s_add_u32 s85, s37, s89
    s_bfe_u32 s37, s39, 0x10003
    s_lshl_b32 s37, s37, 11
    s_add_u32 s85, s37, s85
    s_bfe_u32 s37, s39, 0x40004
    s_lshl_b32 s37, s37, 16
    s_add_u32 s85, s37, s85
    buffer_load_dwordx4 v[144:147], v76, s[52:55], s85 offen offset:0 nt
    buffer_load_dwordx4 v[148:151], v77, s[52:55], s85 offen offset:0 nt
    buffer_load_dwordx4 v[152:155], v76, s[52:55], s85 offen offset:1024 nt
    s_waitcnt vmcnt(6)
    buffer_load_dwordx4 v[156:159], v77, s[52:55], s85 offen offset:1024 nt
    s_add_u32 s87, s87, 7
    s_add_u32 s39, s87, s88
    s_bfe_u32 s37, s39, 0x30000
    s_lshl_b32 s37, s37, 12
    s_add_u32 s85, s37, s89
    s_bfe_u32 s37, s39, 0x10003
    s_lshl_b32 s37, s37, 11
    s_add_u32 s85, s37, s85
    s_bfe_u32 s37, s39, 0x40004
    s_lshl_b32 s37, s37, 16
    s_add_u32 s85, s37, s85
    s_waitcnt vmcnt(6)
    buffer_load_dwordx4 v[160:163], v76, s[52:55], s85 offen offset:0 nt
    s_waitcnt vmcnt(6)
    buffer_load_dwordx4 v[164:167], v77, s[52:55], s85 offen offset:0 nt
    s_waitcnt vmcnt(6)
    buffer_load_dwordx4 v[168:171], v76, s[52:55], s85 offen offset:1024 nt
    s_waitcnt vmcnt(6)
    buffer_load_dwordx4 v[172:175], v77, s[52:55], s85 offen offset:1024 nt
    s_add_u32 s87, s87, 7
    s_add_u32 s39, s87, s88
    s_bfe_u32 s37, s39, 0x30000
    s_lshl_b32 s37, s37, 12
    s_add_u32 s85, s37, s89
    s_bfe_u32 s37, s39, 0x10003
    s_lshl_b32 s37, s37, 11
    s_add_u32 s85, s37, s85
    s_bfe_u32 s37, s39, 0x40004
    s_lshl_b32 s37, s37, 16
    s_add_u32 s85, s37, s85
    s_waitcnt vmcnt(6)
    buffer_load_dwordx4 v[176:179], v76, s[52:55], s85 offen offset:0 nt
    s_waitcnt vmcnt(6)
    buffer_load_dwordx4 v[180:183], v77, s[52:55], s85 offen offset:0 nt
    s_waitcnt vmcnt(6)
    buffer_load_dwordx4 v[184:187], v76, s[52:55], s85 offen offset:1024 nt
    s_waitcnt vmcnt(6)
    buffer_load_dwordx4 v[188:191], v77, s[52:55], s85 offen offset:1024 nt
    s_add_u32 s87, s87, 7
    s_add_u32 s39, s87, s88
    s_bfe_u32 s37, s39, 0x30000
    s_lshl_b32 s37, s37, 12
    s_add_u32 s85, s37, s89
    s_bfe_u32 s37, s39, 0x10003
    s_lshl_b32 s37, s37, 11
    s_add_u32 s85, s37, s85
    s_bfe_u32 s37, s39, 0x40004
    s_lshl_b32 s37, s37, 16
    s_add_u32 s85, s37, s85
    s_waitcnt vmcnt(6)
    buffer_load_dwordx4 v[192:195], v76, s[52:55], s85 offen offset:0 nt
    s_waitcnt vmcnt(6)
    buffer_load_dwordx4 v[196:199], v77, s[52:55], s85 offen offset:0 nt
    s_waitcnt vmcnt(6)
    buffer_load_dwordx4 v[200:203], v76, s[52:55], s85 offen offset:1024 nt
    s_waitcnt vmcnt(6)
    buffer_load_dwordx4 v[204:207], v77, s[52:55], s85 offen offset:1024 nt
    s_add_u32 s87, s87, 7
    s_add_u32 s39, s87, s88
    s_bfe_u32 s37, s39, 0x30000
    s_lshl_b32 s37, s37, 12
    s_add_u32 s85, s37, s89
    s_bfe_u32 s37, s39, 0x10003
    s_lshl_b32 s37, s37, 11
    s_add_u32 s85, s37, s85
    s_bfe_u32 s37, s39, 0x40004
    s_lshl_b32 s37, s37, 16
    s_add_u32 s85, s37, s85
    s_waitcnt vmcnt(6)
    buffer_load_dwordx4 v[208:211], v76, s[52:55], s85 offen offset:0 nt
    s_waitcnt vmcnt(6)
    buffer_load_dwordx4 v[212:215], v77, s[52:55], s85 offen offset:0 nt
    s_waitcnt vmcnt(6)
    buffer_load_dwordx4 v[216:219], v76, s[52:55], s85 offen offset:1024 nt
    s_waitcnt vmcnt(6)
    buffer_load_dwordx4 v[220:223], v77, s[52:55], s85 offen offset:1024 nt
    s_add_u32 s87, s87, 7
    s_add_u32 s39, s87, s88
    s_bfe_u32 s37, s39, 0x30000
    s_lshl_b32 s37, s37, 12
    s_add_u32 s85, s37, s89
    s_bfe_u32 s37, s39, 0x10003
    s_lshl_b32 s37, s37, 11
    s_add_u32 s85, s37, s85
    s_bfe_u32 s37, s39, 0x40004
    s_lshl_b32 s37, s37, 16
    s_add_u32 s85, s37, s85
    s_waitcnt vmcnt(6)
    buffer_load_dwordx4 v[224:227], v76, s[52:55], s85 offen offset:0 nt
    s_waitcnt vmcnt(6)
    buffer_load_dwordx4 v[228:231], v77, s[52:55], s85 offen offset:0 nt
    s_waitcnt vmcnt(6)
    buffer_load_dwordx4 v[232:235], v76, s[52:55], s85 offen offset:1024 nt
    s_waitcnt vmcnt(6)
    buffer_load_dwordx4 v[236:239], v77, s[52:55], s85 offen offset:1024 nt
    s_add_u32 s87, s87, 7
    s_add_u32 s39, s87, s88
    s_bfe_u32 s37, s39, 0x30000
    s_lshl_b32 s37, s37, 12
    s_add_u32 s85, s37, s89
    s_bfe_u32 s37, s39, 0x10003
    s_lshl_b32 s37, s37, 11
    s_add_u32 s85, s37, s85
    s_bfe_u32 s37, s39, 0x40004
    s_lshl_b32 s37, s37, 16
    s_add_u32 s85, s37, s85
    s_waitcnt vmcnt(6)
    buffer_load_dwordx4 v[240:243], v76, s[52:55], s85 offen offset:0 nt
    s_waitcnt vmcnt(6)
    buffer_load_dwordx4 v[244:247], v77, s[52:55], s85 offen offset:0 nt
    s_waitcnt vmcnt(6)
    buffer_load_dwordx4 v[248:251], v76, s[52:55], s85 offen offset:1024 nt
    s_waitcnt vmcnt(6)
    buffer_load_dwordx4 v[252:255], v77, s[52:55], s85 offen offset:1024 nt
    s_add_u32 s87, s87, 7
    s_add_u32 s39, s87, s88
    s_bfe_u32 s37, s39, 0x30000
    s_lshl_b32 s37, s37, 12
    s_add_u32 s85, s37, s89
    s_bfe_u32 s37, s39, 0x10003
    s_lshl_b32 s37, s37, 11
    s_add_u32 s85, s37, s85
    s_bfe_u32 s37, s39, 0x40004
    s_lshl_b32 s37, s37, 16
    s_add_u32 s85, s37, s85
    s_waitcnt vmcnt(6)
    buffer_load_dwordx4 a[0:3], v76, s[52:55], s85 offen offset:0 nt
    s_waitcnt vmcnt(6)
    buffer_load_dwordx4 a[4:7], v77, s[52:55], s85 offen offset:0 nt
    s_waitcnt vmcnt(6)
    buffer_load_dwordx4 a[8:11], v76, s[52:55], s85 offen offset:1024 nt
    s_waitcnt vmcnt(6)
    buffer_load_dwordx4 a[12:15], v77, s[52:55], s85 offen offset:1024 nt
    s_add_u32 s87, s87, 7
    s_add_u32 s39, s87, s88
    s_bfe_u32 s37, s39, 0x30000
    s_lshl_b32 s37, s37, 12
    s_add_u32 s85, s37, s89
    s_bfe_u32 s37, s39, 0x10003
    s_lshl_b32 s37, s37, 11
    s_add_u32 s85, s37, s85
    s_bfe_u32 s37, s39, 0x40004
    s_lshl_b32 s37, s37, 16
    s_add_u32 s85, s37, s85
    s_waitcnt vmcnt(6)
    buffer_load_dwordx4 a[16:19], v76, s[52:55], s85 offen offset:0 nt
    s_waitcnt vmcnt(6)
    buffer_load_dwordx4 a[20:23], v77, s[52:55], s85 offen offset:0 nt
    s_waitcnt vmcnt(6)
    buffer_load_dwordx4 a[24:27], v76, s[52:55], s85 offen offset:1024 nt
    s_waitcnt vmcnt(6)
    buffer_load_dwordx4 a[28:31], v77, s[52:55], s85 offen offset:1024 nt
    s_add_u32 s87, s87, 7
    s_add_u32 s39, s87, s88
    s_bfe_u32 s37, s39, 0x30000
    s_lshl_b32 s37, s37, 12
    s_add_u32 s85, s37, s89
    s_bfe_u32 s37, s39, 0x10003
    s_lshl_b32 s37, s37, 11
    s_add_u32 s85, s37, s85
    s_bfe_u32 s37, s39, 0x40004
    s_lshl_b32 s37, s37, 16
    s_add_u32 s85, s37, s85
    s_waitcnt vmcnt(6)
    buffer_load_dwordx4 a[32:35], v76, s[52:55], s85 offen offset:0 nt
    s_waitcnt vmcnt(6)
    buffer_load_dwordx4 a[36:39], v77, s[52:55], s85 offen offset:0 nt
    s_waitcnt vmcnt(6)
    buffer_load_dwordx4 a[40:43], v76, s[52:55], s85 offen offset:1024 nt
    s_waitcnt vmcnt(6)
    buffer_load_dwordx4 a[44:47], v77, s[52:55], s85 offen offset:1024 nt
    s_add_u32 s87, s87, 7
    s_add_u32 s39, s87, s88
    s_bfe_u32 s37, s39, 0x30000
    s_lshl_b32 s37, s37, 12
    s_add_u32 s85, s37, s89
    s_bfe_u32 s37, s39, 0x10003
    s_lshl_b32 s37, s37, 11
    s_add_u32 s85, s37, s85
    s_bfe_u32 s37, s39, 0x40004
    s_lshl_b32 s37, s37, 16
    s_add_u32 s85, s37, s85
    s_waitcnt vmcnt(6)
    buffer_load_dwordx4 a[48:51], v76, s[52:55], s85 offen offset:0 nt
    s_waitcnt vmcnt(6)
    buffer_load_dwordx4 a[52:55], v77, s[52:55], s85 offen offset:0 nt
    buffer_load_dwordx4 v[68:71], v78, s[48:51], s91 offen offset:0 sc1
    buffer_load_dwordx4 v[72:75], v78, s[48:51], s91 offen offset:16 sc1
    s_waitcnt vmcnt(8)
    buffer_load_dwordx4 a[56:59], v76, s[52:55], s85 offen offset:1024 nt
    s_waitcnt vmcnt(8)
    buffer_load_dwordx4 a[60:63], v77, s[52:55], s85 offen offset:1024 nt
    s_add_u32 s87, s87, 7
    s_add_u32 s39, s87, s88
    s_bfe_u32 s37, s39, 0x30000
    s_lshl_b32 s37, s37, 12
    s_add_u32 s85, s37, s89
    s_bfe_u32 s37, s39, 0x10003
    s_lshl_b32 s37, s37, 11
    s_add_u32 s85, s37, s85
    s_bfe_u32 s37, s39, 0x40004
    s_lshl_b32 s37, s37, 16
    s_add_u32 s85, s37, s85
    s_waitcnt vmcnt(8)
    buffer_load_dwordx4 a[64:67], v76, s[52:55], s85 offen offset:0 nt
    s_waitcnt vmcnt(8)
    buffer_load_dwordx4 a[68:71], v77, s[52:55], s85 offen offset:0 nt
    s_waitcnt vmcnt(8)
    buffer_load_dwordx4 a[72:75], v76, s[52:55], s85 offen offset:1024 nt
    s_waitcnt vmcnt(8)
    buffer_load_dwordx4 a[76:79], v77, s[52:55], s85 offen offset:1024 nt
    s_add_u32 s87, s87, 7
    s_add_u32 s39, s87, s88
    s_bfe_u32 s37, s39, 0x30000
    s_lshl_b32 s37, s37, 12
    s_add_u32 s85, s37, s89
    s_bfe_u32 s37, s39, 0x10003
    s_lshl_b32 s37, s37, 11
    s_add_u32 s85, s37, s85
    s_bfe_u32 s37, s39, 0x40004
    s_lshl_b32 s37, s37, 16
    s_add_u32 s85, s37, s85
    s_waitcnt lgkmcnt(0)
    s_add_u32 s35, s35, 0x5b
    s_and_b32 s35, s35, 0xff
    v_mov_b32 v8, s35
    s_waitcnt vmcnt(6)
L_qcheck_1:
    v_xor_b32 v68, s35, v68
    v_xor_b32 v69, s35, v69
    v_xor_b32 v70, s35, v70
    v_xor_b32 v71, s35, v71
    v_xor_b32 v72, s35, v72
    v_xor_b32 v73, s35, v73
    v_xor_b32 v74, s35, v74
    v_xor_b32 v75, s35, v75
    v_or_b32 v4, v68, v69
    v_or3_b32 v4, v4, v70, v71
    v_or3_b32 v4, v4, v72, v73
    v_or3_b32 v4, v4, v74, v75
    v_and_b32 v4, 0xff, v4
    v_cmp_ne_u32 vcc, 0, v4
    s_cbranch_vccz L_qok_2
    buffer_load_dwordx4 v[68:71], v78, s[48:51], s91 offen offset:0 sc1
    buffer_load_dwordx4 v[72:75], v78, s[48:51], s91 offen offset:16 sc1
    s_waitcnt vmcnt(0)
    s_sub_u32 s84, s84, 1
    s_cmp_lg_u32 s84, 0
    s_cbranch_scc1 L_qcheck_1
    s_branch L_end
L_qok_2:
    v_cvt_pk_bf16_f32 v68, v68, v69
    v_cvt_pk_bf16_f32 v69, v70, v71
    v_cvt_pk_bf16_f32 v70, v72, v73
    v_cvt_pk_bf16_f32 v71, v74, v75
    s_mov_b32 vcc_lo, 0xf000f
    s_mov_b32 vcc_hi, 0xf000f
    v_cndmask_b32 v80, 0, v68, vcc
    v_cndmask_b32 v81, 0, v69, vcc
    v_cndmask_b32 v82, 0, v70, vcc
    v_cndmask_b32 v83, 0, v71, vcc
    s_mov_b32 vcc_lo, 0xf000f0
    s_mov_b32 vcc_hi, 0xf000f0
    v_cndmask_b32 v84, 0, v68, vcc
    v_cndmask_b32 v85, 0, v69, vcc
    v_cndmask_b32 v86, 0, v70, vcc
    v_cndmask_b32 v87, 0, v71, vcc
    s_mov_b32 vcc_lo, 0xf000f00
    s_mov_b32 vcc_hi, 0xf000f00
    v_cndmask_b32 v88, 0, v68, vcc
    v_cndmask_b32 v89, 0, v69, vcc
    v_cndmask_b32 v90, 0, v70, vcc
    v_cndmask_b32 v91, 0, v71, vcc
    s_mov_b32 vcc_lo, 0xf000f000
    s_mov_b32 vcc_hi, 0xf000f000
    v_cndmask_b32 v92, 0, v68, vcc
    v_cndmask_b32 v93, 0, v69, vcc
    v_cndmask_b32 v94, 0, v70, vcc
    v_cndmask_b32 v95, 0, v71, vcc
    s_getreg_b32 s70, hwreg(HW_REG_XCC_ID, 0, 4)
    s_lshl_b32 s70, s70, 8
    s_or_b32 s70, s70, s35
    s_or_b32 s70, s70, 0x5e9d0000
    s_bfe_u32 s38, s2, 0x30000
    s_lshl_b32 s38, s38, 8
    s_add_u32 s69, s38, 32768
    s_lshl_b32 s38, s32, 2
    s_add_u32 s69, s38, s69
    s_lshl_b32 s38, s34, 24
    s_add_u32 s69, s38, s69
    v_mov_b32 v72, s69
    v_mov_b32 v73, s70
    s_mov_b64 exec, 1
    buffer_store_dword v73, v72, s[48:51], 0 offen sc1
    s_mov_b64 exec, -1
    v_mov_b32 v65, 0xff7f0000
    s_lshl_b32 s38, s34, 14
    s_add_u32 s38, s38, 16384
    v_lshl_add_u32 v64, v1, 2, s38
    buffer_load_dwordx4 a[80:83], v76, s[52:55], s85 offen offset:0 nt
    v_mfma_f32_16x16x32_bf16 v[112:115], v[128:131], v[80:83], 0
    v_mfma_f32_16x16x32_bf16 v[112:115], v[132:135], v[84:87], v[112:115]
    v_mfma_f32_16x16x32_bf16 v[112:115], v[136:139], v[88:91], v[112:115]
    s_waitcnt vmcnt(7)
    buffer_load_dwordx4 a[84:87], v77, s[52:55], s85 offen offset:0 nt
    v_mfma_f32_16x16x32_bf16 v[112:115], v[140:143], v[92:95], v[112:115]
    v_mfma_f32_16x16x32_bf16 v[96:99], v[144:147], v[80:83], 0
    v_mfma_f32_16x16x32_bf16 v[96:99], v[148:151], v[84:87], v[96:99]
    v_mfma_f32_16x16x32_bf16 v[96:99], v[152:155], v[88:91], v[96:99]
    s_nop 4
    v_mov_b32_dpp v122, v112 quad_perm:[0,0,0,0] row_mask:0xf bank_mask:0xf
    v_mov_b32_dpp v124, v114 quad_perm:[2,2,2,2] row_mask:0xf bank_mask:0xf
    s_nop 0
    v_add_f32_dpp v122, v113, v122 quad_perm:[1,1,1,1] row_mask:0xf bank_mask:0xf
    v_add_f32_dpp v124, v115, v124 quad_perm:[3,3,3,3] row_mask:0xf bank_mask:0xf
    v_add_f32 v122, v122, v124
    v_max_f32 v65, v65, v122
    ds_write_b32 v64, v122 offset:0
    s_waitcnt vmcnt(7)
    buffer_load_dwordx4 a[88:91], v76, s[52:55], s85 offen offset:1024 nt
    v_mfma_f32_16x16x32_bf16 v[96:99], v[156:159], v[92:95], v[96:99]
    v_mfma_f32_16x16x32_bf16 v[112:115], v[160:163], v[80:83], 0
    v_mfma_f32_16x16x32_bf16 v[112:115], v[164:167], v[84:87], v[112:115]
    s_waitcnt vmcnt(7)
    buffer_load_dwordx4 a[92:95], v77, s[52:55], s85 offen offset:1024 nt
    s_add_u32 s87, s87, 7
    s_add_u32 s39, s87, s88
    s_bfe_u32 s37, s39, 0x30000
    s_lshl_b32 s37, s37, 12
    s_add_u32 s85, s37, s89
    s_bfe_u32 s37, s39, 0x10003
    s_lshl_b32 s37, s37, 11
    s_add_u32 s85, s37, s85
    s_bfe_u32 s37, s39, 0x40004
    s_lshl_b32 s37, s37, 16
    s_add_u32 s85, s37, s85
    v_mfma_f32_16x16x32_bf16 v[112:115], v[168:171], v[88:91], v[112:115]
    v_mov_b32_dpp v122, v96 quad_perm:[0,0,0,0] row_mask:0xf bank_mask:0xf
    v_mov_b32_dpp v124, v98 quad_perm:[2,2,2,2] row_mask:0xf bank_mask:0xf
    s_nop 0
    v_add_f32_dpp v122, v97, v122 quad_perm:[1,1,1,1] row_mask:0xf bank_mask:0xf
    v_add_f32_dpp v124, v99, v124 quad_perm:[3,3,3,3] row_mask:0xf bank_mask:0xf
    v_add_f32 v122, v122, v124
    v_max_f32 v65, v65, v122
    ds_write_b32 v64, v122 offset:256
    v_mfma_f32_16x16x32_bf16 v[112:115], v[172:175], v[92:95], v[112:115]
    v_mfma_f32_16x16x32_bf16 v[96:99], v[176:179], v[80:83], 0
    v_mfma_f32_16x16x32_bf16 v[96:99], v[180:183], v[84:87], v[96:99]
    s_waitcnt vmcnt(7)
    buffer_load_dwordx4 a[96:99], v76, s[52:55], s85 offen offset:0 nt
    v_mfma_f32_16x16x32_bf16 v[96:99], v[184:187], v[88:91], v[96:99]
    s_nop 2
    v_mov_b32_dpp v122, v112 quad_perm:[0,0,0,0] row_mask:0xf bank_mask:0xf
    v_mov_b32_dpp v124, v114 quad_perm:[2,2,2,2] row_mask:0xf bank_mask:0xf
    s_nop 0
    v_add_f32_dpp v122, v113, v122 quad_perm:[1,1,1,1] row_mask:0xf bank_mask:0xf
    v_add_f32_dpp v124, v115, v124 quad_perm:[3,3,3,3] row_mask:0xf bank_mask:0xf
    v_add_f32 v122, v122, v124
    v_max_f32 v65, v65, v122
    ds_write_b32 v64, v122 offset:512
    v_mfma_f32_16x16x32_bf16 v[96:99], v[188:191], v[92:95], v[96:99]
    v_mfma_f32_16x16x32_bf16 v[112:115], v[192:195], v[80:83], 0
    s_waitcnt vmcnt(7)
    buffer_load_dwordx4 a[100:103], v77, s[52:55], s85 offen offset:0 nt
    v_mfma_f32_16x16x32_bf16 v[112:115], v[196:199], v[84:87], v[112:115]
    v_mfma_f32_16x16x32_bf16 v[112:115], v[200:203], v[88:91], v[112:115]
    s_nop 2
    v_mov_b32_dpp v122, v96 quad_perm:[0,0,0,0] row_mask:0xf bank_mask:0xf
    v_mov_b32_dpp v124, v98 quad_perm:[2,2,2,2] row_mask:0xf bank_mask:0xf
    s_nop 0
    v_add_f32_dpp v122, v97, v122 quad_perm:[1,1,1,1] row_mask:0xf bank_mask:0xf
    v_add_f32_dpp v124, v99, v124 quad_perm:[3,3,3,3] row_mask:0xf bank_mask:0xf
    v_add_f32 v122, v122, v124
    v_max_f32 v65, v65, v122
    ds_write_b32 v64, v122 offset:768
    v_mfma_f32_16x16x32_bf16 v[112:115], v[204:207], v[92:95], v[112:115]
    v_mfma_f32_16x16x32_bf16 v[96:99], v[208:211], v[80:83], 0
    s_waitcnt vmcnt(7)
    buffer_load_dwordx4 a[104:107], v76, s[52:55], s85 offen offset:1024 nt
    v_mfma_f32_16x16x32_bf16 v[96:99], v[212:215], v[84:87], v[96:99]
    v_mfma_f32_16x16x32_bf16 v[96:99], v[216:219], v[88:91], v[96:99]
    s_nop 2
    v_mov_b32_dpp v122, v112 quad_perm:[0,0,0,0] row_mask:0xf bank_mask:0xf
    v_mov_b32_dpp v124, v114 quad_perm:[2,2,2,2] row_mask:0xf bank_mask:0xf
    s_nop 0
    v_add_f32_dpp v122, v113, v122 quad_perm:[1,1,1,1] row_mask:0xf bank_mask:0xf
    v_add_f32_dpp v124, v115, v124 quad_perm:[3,3,3,3] row_mask:0xf bank_mask:0xf
    v_add_f32 v122, v122, v124
    v_max_f32 v65, v65, v122
    ds_write_b32 v64, v122 offset:1024
    v_mfma_f32_16x16x32_bf16 v[96:99], v[220:223], v[92:95], v[96:99]
    s_waitcnt vmcnt(6)
    buffer_load_dwordx4 a[108:111], v77, s[52:55], s85 offen offset:1024 nt
    s_add_u32 s87, s87, 7
    s_add_u32 s39, s87, s88
    s_bfe_u32 s37, s39, 0x30000
    s_lshl_b32 s37, s37, 12
    s_add_u32 s85, s37, s89
    s_bfe_u32 s37, s39, 0x10003
    s_lshl_b32 s37, s37, 11
    s_add_u32 s85, s37, s85
    s_bfe_u32 s37, s39, 0x40004
    s_lshl_b32 s37, s37, 16
    s_add_u32 s85, s37, s85
    v_mfma_f32_16x16x32_bf16 v[112:115], v[224:227], v[80:83], 0
    v_mfma_f32_16x16x32_bf16 v[112:115], v[228:231], v[84:87], v[112:115]
    v_mfma_f32_16x16x32_bf16 v[112:115], v[232:235], v[88:91], v[112:115]
    v_mov_b32_dpp v122, v96 quad_perm:[0,0,0,0] row_mask:0xf bank_mask:0xf
    v_mov_b32_dpp v124, v98 quad_perm:[2,2,2,2] row_mask:0xf bank_mask:0xf
    s_nop 0
    v_add_f32_dpp v122, v97, v122 quad_perm:[1,1,1,1] row_mask:0xf bank_mask:0xf
    v_add_f32_dpp v124, v99, v124 quad_perm:[3,3,3,3] row_mask:0xf bank_mask:0xf
    v_add_f32 v122, v122, v124
    v_max_f32 v65, v65, v122
    ds_write_b32 v64, v122 offset:1280
    v_mfma_f32_16x16x32_bf16 v[112:115], v[236:239], v[92:95], v[112:115]
    s_waitcnt vmcnt(6)
    buffer_load_dwordx4 a[112:115], v76, s[52:55], s85 offen offset:0 nt
    v_mfma_f32_16x16x32_bf16 v[96:99], v[240:243], v[80:83], 0
    v_mfma_f32_16x16x32_bf16 v[96:99], v[244:247], v[84:87], v[96:99]
    v_mfma_f32_16x16x32_bf16 v[96:99], v[248:251], v[88:91], v[96:99]
    s_nop 2
    v_mov_b32_dpp v122, v112 quad_perm:[0,0,0,0] row_mask:0xf bank_mask:0xf
    v_mov_b32_dpp v124, v114 quad_perm:[2,2,2,2] row_mask:0xf bank_mask:0xf
    s_nop 0
    v_add_f32_dpp v122, v113, v122 quad_perm:[1,1,1,1] row_mask:0xf bank_mask:0xf
    v_add_f32_dpp v124, v115, v124 quad_perm:[3,3,3,3] row_mask:0xf bank_mask:0xf
    v_add_f32 v122, v122, v124
    v_max_f32 v65, v65, v122
    ds_write_b32 v64, v122 offset:1536
    v_mfma_f32_16x16x32_bf16 v[96:99], v[252:255], v[92:95], v[96:99]
    s_waitcnt vmcnt(6)
    buffer_load_dwordx4 a[116:119], v77, s[52:55], s85 offen offset:0 nt
    v_mfma_f32_16x16x32_bf16 v[112:115], a[0:3], v[80:83], 0
    v_mfma_f32_16x16x32_bf16 v[112:115], a[4:7], v[84:87], v[112:115]
    v_mfma_f32_16x16x32_bf16 v[112:115], a[8:11], v[88:91], v[112:115]
    s_nop 2
    v_mov_b32_dpp v122, v96 quad_perm:[0,0,0,0] row_mask:0xf bank_mask:0xf
    v_mov_b32_dpp v124, v98 quad_perm:[2,2,2,2] row_mask:0xf bank_mask:0xf
    s_nop 0
    v_add_f32_dpp v122, v97, v122 quad_perm:[1,1,1,1] row_mask:0xf bank_mask:0xf
    v_add_f32_dpp v124, v99, v124 quad_perm:[3,3,3,3] row_mask:0xf bank_mask:0xf
    v_add_f32 v122, v122, v124
    v_max_f32 v65, v65, v122
    ds_write_b32 v64, v122 offset:1792
    s_waitcnt vmcnt(6)
    buffer_load_dwordx4 a[120:123], v76, s[52:55], s85 offen offset:1024 nt
    v_mfma_f32_16x16x32_bf16 v[112:115], a[12:15], v[92:95], v[112:115]
    v_mfma_f32_16x16x32_bf16 v[96:99], a[16:19], v[80:83], 0
    v_mfma_f32_16x16x32_bf16 v[96:99], a[20:23], v[84:87], v[96:99]
    v_mfma_f32_16x16x32_bf16 v[96:99], a[24:27], v[88:91], v[96:99]
    s_nop 4
    v_mov_b32_dpp v122, v112 quad_perm:[0,0,0,0] row_mask:0xf bank_mask:0xf
    v_mov_b32_dpp v124, v114 quad_perm:[2,2,2,2] row_mask:0xf bank_mask:0xf
    s_nop 0
    v_add_f32_dpp v122, v113, v122 quad_perm:[1,1,1,1] row_mask:0xf bank_mask:0xf
    v_add_f32_dpp v124, v115, v124 quad_perm:[3,3,3,3] row_mask:0xf bank_mask:0xf
    v_add_f32 v122, v122, v124
    v_max_f32 v65, v65, v122
    ds_write_b32 v64, v122 offset:2048
    s_waitcnt vmcnt(6)
    buffer_load_dwordx4 a[124:127], v77, s[52:55], s85 offen offset:1024 nt
    s_add_u32 s87, s87, 7
    s_add_u32 s39, s87, s88
    s_bfe_u32 s37, s39, 0x30000
    s_lshl_b32 s37, s37, 12
    s_add_u32 s85, s37, s89
    s_bfe_u32 s37, s39, 0x10003
    s_lshl_b32 s37, s37, 11
    s_add_u32 s85, s37, s85
    s_bfe_u32 s37, s39, 0x40004
    s_lshl_b32 s37, s37, 16
    s_add_u32 s85, s37, s85
    v_mfma_f32_16x16x32_bf16 v[96:99], a[28:31], v[92:95], v[96:99]
    v_mfma_f32_16x16x32_bf16 v[112:115], a[32:35], v[80:83], 0
    s_bfe_u32 s38, s2, 0x20001
    s_lshl_b32 s38, s38, 0
    s_add_u32 s90, s38, 0
    s_bfe_u32 s38, s2, 0x10000
    s_lshl_b32 s38, s38, 2
    s_add_u32 s90, s38, s90
    s_and_b32 s36, s90, 3
    s_bitcmp0_b32 s90, 2
    s_cselect_b64 s[40:41], s[24:25], s[14:15]
    s_cselect_b32 s45, 262144, 0
    s_add_u32 s45, s45, 524288
    s_lshl_b32 s38, s36, 16
    s_add_u32 s71, s38, s45
    s_lshr_b32 s38, s32, 2
    s_lshl_b32 s38, s38, 13
    s_add_u32 s71, s38, s71
    s_bfe_u32 s38, s32, 0x20000
    s_lshl_b32 s38, s38, 6
    s_add_u32 s71, s38, s71
    s_mov_b32 s42, 4194304
    s_mov_b32 s43, 0x20000
    s_lshl_b32 s38, s32, 17
    s_add_u32 s44, s38, 0
    s_lshl_b32 s38, s34, 15
    s_add_u32 s44, s38, s44
    s_lshl_b32 s38, s36, 8
    s_add_u32 s44, s38, s44
    s_lshl_b32 s38, s36, 16
    s_add_u32 s45, s38, s45
    s_lshr_b32 s38, s34, 1
    s_lshl_b32 s38, s38, 15
    s_add_u32 s45, s38, s45
    s_lshl_b32 s38, s32, 8
    s_add_u32 s45, s38, s45
    s_bfe_u32 s38, s34, 0x10000
    s_lshl_b32 s38, s38, 7
    s_add_u32 s45, s38, s45
    s_lshl_b32 s38, s32, 11
    s_add_u32 s46, s38, 196608
    s_lshl_b32 s38, s34, 9
    s_add_u32 s46, s38, s46
    s_mov_b32 s72, s26
    s_and_b32 s73, s27, 0xffff
    s_mov_b32 s74, 8192
    s_mov_b32 s75, 0x20000
    v_mfma_f32_16x16x32_bf16 v[112:115], a[36:39], v[84:87], v[112:115]
    s_waitcnt vmcnt(5)
    buffer_load_dwordx4 v[128:131], v76, s[52:55], s85 offen offset:0 nt
    v_mfma_f32_16x16x32_bf16 v[112:115], a[40:43], v[88:91], v[112:115]
    v_mov_b32_dpp v122, v96 quad_perm:[0,0,0,0] row_mask:0xf bank_mask:0xf
    v_mov_b32_dpp v124, v98 quad_perm:[2,2,2,2] row_mask:0xf bank_mask:0xf
    s_nop 0
    v_add_f32_dpp v122, v97, v122 quad_perm:[1,1,1,1] row_mask:0xf bank_mask:0xf
    v_add_f32_dpp v124, v99, v124 quad_perm:[3,3,3,3] row_mask:0xf bank_mask:0xf
    v_add_f32 v122, v122, v124
    v_max_f32 v65, v65, v122
    ds_write_b32 v64, v122 offset:2304
    v_mfma_f32_16x16x32_bf16 v[112:115], a[44:47], v[92:95], v[112:115]
    v_mfma_f32_16x16x32_bf16 v[96:99], a[48:51], v[80:83], 0
    v_mfma_f32_16x16x32_bf16 v[96:99], a[52:55], v[84:87], v[96:99]
    s_waitcnt vmcnt(5)
    buffer_load_dwordx4 v[132:135], v77, s[52:55], s85 offen offset:0 nt
    v_mfma_f32_16x16x32_bf16 v[96:99], a[56:59], v[88:91], v[96:99]
    s_nop 2
    v_mov_b32_dpp v122, v112 quad_perm:[0,0,0,0] row_mask:0xf bank_mask:0xf
    v_mov_b32_dpp v124, v114 quad_perm:[2,2,2,2] row_mask:0xf bank_mask:0xf
    s_nop 0
    v_add_f32_dpp v122, v113, v122 quad_perm:[1,1,1,1] row_mask:0xf bank_mask:0xf
    v_add_f32_dpp v124, v115, v124 quad_perm:[3,3,3,3] row_mask:0xf bank_mask:0xf
    v_add_f32 v122, v122, v124
    v_max_f32 v65, v65, v122
    ds_write_b32 v64, v122 offset:2560
    v_lshlrev_b32 v4, 2, v2
    v_xor_b32 v4, v4, v3
    v_xor_b32 v5, 0, v4
    v_lshlrev_b32 v5, 4, v5
    v_lshl_add_u32 v20, v2, 10, v5
    v_xor_b32 v5, 1, v4
    v_lshlrev_b32 v5, 4, v5
    v_lshl_add_u32 v21, v2, 10, v5
    v_add_u32 v21, 3072, v21
    v_xor_b32 v5, 2, v4
    v_lshlrev_b32 v5, 4, v5
    v_lshl_add_u32 v22, v2, 10, v5
    v_add_u32 v22, 6144, v22
    v_xor_b32 v5, 3, v4
    v_lshlrev_b32 v5, 4, v5
    v_lshl_add_u32 v23, v2, 10, v5
    v_add_u32 v23, 9216, v23
    s_lshl_b32 s38, s32, 15
    s_add_u32 s47, s38, 1048576
    s_lshl_b32 s38, s3, 13
    s_add_u32 s47, s38, s47
    v_lshlrev_b32 v6, 7, v2
    v_bfe_u32 v5, v3, 0, 3
    v_lshl_add_u32 v6, v5, 4, v6
    v_lshrrev_b32 v4, 3, v3
    v_and_b32 v7, 3, v3
    v_min_u32 v7, 2, v7
    v_lshl_add_u32 v7, v7, 1, v4
    v_add_u32 v5, 0, v4
    v_cmp_le_u32 vcc, s33, v5
    s_nop 1
    v_addc_co_u32 v5, vcc, 0, v5, vcc
    v_lshl_add_u32 v50, v5, 10, v6
    v_add_u32 v5, 2, v4
    v_cmp_le_u32 vcc, s33, v5
    s_nop 1
    v_addc_co_u32 v5, vcc, 0, v5, vcc
    v_lshl_add_u32 v51, v5, 10, v6
    v_add_u32 v5, 4, v4
    v_cmp_le_u32 vcc, s33, v5
    s_nop 1
    v_addc_co_u32 v5, vcc, 0, v5, vcc
    v_lshl_add_u32 v52, v5, 10, v6
    v_mov_b32 v5, v7
    v_mov_b32 v6, 512
    v_cmp_le_u32 vcc, s33, v5
    s_nop 1
    v_addc_co_u32 v5, vcc, 0, v5, vcc
    v_lshl_add_u32 v53, v5, 10, v6
    s_mul_i32 s38, s3, 320
    s_add_u32 s38, s38, 135168
    v_lshlrev_b32 v4, 6, v2
    v_lshl_add_u32 v4, v3, 1, v4
    v_add_u32 v31, s38, v4
    v_mfma_f32_16x16x32_bf16 v[96:99], a[60:63], v[92:95], v[96:99]
    v_mfma_f32_16x16x32_bf16 v[112:115], a[64:67], v[80:83], 0
    s_waitcnt vmcnt(5)
    buffer_load_dwordx4 v[136:139], v76, s[52:55], s85 offen offset:1024 nt
    v_mfma_f32_16x16x32_bf16 v[112:115], a[68:71], v[84:87], v[112:115]
    v_mfma_f32_16x16x32_bf16 v[112:115], a[72:75], v[88:91], v[112:115]
    s_nop 2
    v_mov_b32_dpp v122, v96 quad_perm:[0,0,0,0] row_mask:0xf bank_mask:0xf
    v_mov_b32_dpp v124, v98 quad_perm:[2,2,2,2] row_mask:0xf bank_mask:0xf
    s_nop 0
    v_add_f32_dpp v122, v97, v122 quad_perm:[1,1,1,1] row_mask:0xf bank_mask:0xf
    v_add_f32_dpp v124, v99, v124 quad_perm:[3,3,3,3] row_mask:0xf bank_mask:0xf
    v_add_f32 v122, v122, v124
    v_max_f32 v65, v65, v122
    ds_write_b32 v64, v122 offset:2816
    v_mfma_f32_16x16x32_bf16 v[112:115], a[76:79], v[92:95], v[112:115]
    v_mfma_f32_16x16x32_bf16 v[96:99], a[80:83], v[80:83], 0
    v_lshlrev_b32 v4, 11, v2
    v_bfe_u32 v5, v1, 2, 2
    v_lshl_add_u32 v4, v5, 8, v4
    v_bfe_u32 v5, v1, 2, 2
    v_lshl_add_u32 v4, v5, 6, v4
    v_bfe_u32 v5, v1, 4, 1
    v_lshl_add_u32 v4, v5, 5, v4
    v_bfe_u32 v5, v1, 1, 1
    v_lshl_add_u32 v4, v5, 4, v4
    v_bfe_u32 v5, v1, 0, 1
    v_lshl_add_u32 v4, v5, 3, v4
    s_lshl_b32 s38, s34, 6
    s_add_u32 s38, s38, 98304
    v_xor_b32 v24, s38, v4
    v_xor_b32 v25, 16, v24
    v_xor_b32 v26, 32, v24
    v_xor_b32 v27, 48, v24
    v_and_b32 v4, 3, v3
    v_lshrrev_b32 v5, 2, v3
    v_lshlrev_b32 v6, 4, v2
    v_add_u32 v6, 135168, v6
    s_movk_i32 s36, 320
    v_cmp_eq_u32 vcc, 0, v5
    s_nop 1
    v_cndmask_b32 v28, 4, v4, vcc
    v_mad_u32_u24 v28, v28, s36, v6
    v_cmp_eq_u32 vcc, 1, v5
    s_nop 1
    v_cndmask_b32 v29, 4, v4, vcc
    v_mad_u32_u24 v29, v29, s36, v6
    v_lshlrev_b32 v5, 2, v1
    v_add_u32 v5, 136448, v5
    v_mov_b32 v6, 0
    ds_write_b32 v5, v6
    s_waitcnt vmcnt(5)
    buffer_load_dwordx4 v[140:143], v77, s[52:55], s85 offen offset:1024 nt
    s_add_u32 s87, s87, 7
    s_add_u32 s39, s87, s88
    s_bfe_u32 s37, s39, 0x30000
    s_lshl_b32 s37, s37, 12
    s_add_u32 s85, s37, s89
    s_bfe_u32 s37, s39, 0x10003
    s_lshl_b32 s37, s37, 11
    s_add_u32 s85, s37, s85
    s_bfe_u32 s37, s39, 0x40004
    s_lshl_b32 s37, s37, 16
    s_add_u32 s85, s37, s85
    v_mfma_f32_16x16x32_bf16 v[96:99], a[84:87], v[84:87], v[96:99]
    v_mfma_f32_16x16x32_bf16 v[96:99], a[88:91], v[88:91], v[96:99]
    v_mov_b32_dpp v122, v112 quad_perm:[0,0,0,0] row_mask:0xf bank_mask:0xf
    v_mov_b32_dpp v124, v114 quad_perm:[2,2,2,2] row_mask:0xf bank_mask:0xf
    s_nop 0
    v_add_f32_dpp v122, v113, v122 quad_perm:[1,1,1,1] row_mask:0xf bank_mask:0xf
    v_add_f32_dpp v124, v115, v124 quad_perm:[3,3,3,3] row_mask:0xf bank_mask:0xf
    v_add_f32 v122, v122, v124
    v_max_f32 v65, v65, v122
    ds_write_b32 v64, v122 offset:3072
    v_mfma_f32_16x16x32_bf16 v[96:99], a[92:95], v[92:95], v[96:99]
    s_waitcnt vmcnt(5)
    buffer_load_dwordx4 v[144:147], v76, s[52:55], s85 offen offset:0 nt
    v_mfma_f32_16x16x32_bf16 v[112:115], a[96:99], v[80:83], 0
    v_mfma_f32_16x16x32_bf16 v[112:115], a[100:103], v[84:87], v[112:115]
    v_mfma_f32_16x16x32_bf16 v[112:115], a[104:107], v[88:91], v[112:115]
    s_nop 2
    v_mov_b32_dpp v122, v96 quad_perm:[0,0,0,0] row_mask:0xf bank_mask:0xf
    v_mov_b32_dpp v124, v98 quad_perm:[2,2,2,2] row_mask:0xf bank_mask:0xf
    s_nop 0
    v_add_f32_dpp v122, v97, v122 quad_perm:[1,1,1,1] row_mask:0xf bank_mask:0xf
    v_add_f32_dpp v124, v99, v124 quad_perm:[3,3,3,3] row_mask:0xf bank_mask:0xf
    v_add_f32 v122, v122, v124
    v_max_f32 v65, v65, v122
    ds_write_b32 v64, v122 offset:3328
    v_lshlrev_b32 v30, 4, v3
    v_lshl_add_u32 v30, v2, 13, v30
    v_lshrrev_b32 v5, 2, v1
    v_lshlrev_b32 v32, 8, v5
    v_bfe_u32 v5, v1, 0, 2
    v_lshl_add_u32 v32, v5, 4, v32
    s_xor_b32 s37, s90, 4
    s_bfe_u32 s38, s37, 0x30000
    s_lshl_b32 s38, s38, 8
    s_add_u32 s36, s38, 0
    s_lshr_b32 s38, s32, 4
    s_lshl_b32 s38, s38, 7
    s_add_u32 s36, s38, s36
    s_bfe_u32 s38, s32, 0x20000
    s_lshl_b32 s38, s38, 5
    s_add_u32 s36, s38, s36
    s_bfe_u32 s38, s32, 0x20002
    s_lshl_b32 s38, s38, 3
    s_add_u32 s36, s38, s36
    v_bfe_u32 v5, v1, 0, 2
    v_lshlrev_b32 v33, 11, v5
    v_lshl_add_u32 v33, v2, 1, v33
    v_add_u32 v33, s36, v33
    v_and_b32 v5, 31, v1
    v_lshlrev_b32 v34, 4, v5
    s_mul_i32 s38, s34, 320
    s_add_u32 s38, s38, 135168
    v_lshl_add_u32 v35, v5, 3, s38
    s_bfe_u32 s38, s34, 0x10000
    s_lshl_b32 s38, s38, 12
    s_add_u32 s36, s38, s71
    s_lshr_b32 s38, s34, 1
    s_lshl_b32 s38, s38, 24
    s_add_u32 s36, s38, s36
    s_bitcmp1_b32 s90, 2
    s_cselect_b32 s46, s46, s36
    s_cselect_b64 vcc, -1, 0
    v_cndmask_b32 v54, v32, v34, vcc
    v_mfma_f32_16x16x32_bf16 v[112:115], a[108:111], v[92:95], v[112:115]
    s_waitcnt vmcnt(5)
    buffer_load_dwordx4 v[148:151], v77, s[52:55], s85 offen offset:0 nt
    v_mfma_f32_16x16x32_bf16 v[96:99], a[112:115], v[80:83], 0
    v_mfma_f32_16x16x32_bf16 v[96:99], a[116:119], v[84:87], v[96:99]
    v_mfma_f32_16x16x32_bf16 v[96:99], a[120:123], v[88:91], v[96:99]
    s_nop 2
    v_mov_b32_dpp v122, v112 quad_perm:[0,0,0,0] row_mask:0xf bank_mask:0xf
    v_mov_b32_dpp v124, v114 quad_perm:[2,2,2,2] row_mask:0xf bank_mask:0xf
    s_nop 0
    v_add_f32_dpp v122, v113, v122 quad_perm:[1,1,1,1] row_mask:0xf bank_mask:0xf
    v_add_f32_dpp v124, v115, v124 quad_perm:[3,3,3,3] row_mask:0xf bank_mask:0xf
    v_add_f32 v122, v122, v124
    v_max_f32 v65, v65, v122
    ds_write_b32 v64, v122 offset:3584
    v_mfma_f32_16x16x32_bf16 v[96:99], a[124:127], v[92:95], v[96:99]
    v_add_u32 v64, 3840, v64
    s_mov_b32 s97, 8
    s_mov_b32 s86, 32
    s_and_b32 s36, s32, 3
    s_sub_u32 s80, s36, 2
    s_cmp_ge_u32 s36, 2
    s_cselect_b32 s80, s80, 8
    s_cselect_b32 s81, 27, 25
    s_cmp_eq_u32 s80, s33
    s_cselect_b32 s36, 2, 0
    s_sub_u32 s86, s86, s36
    s_lshr_b32 s36, s36, 1
    s_sub_u32 s97, s97, s36
    s_add_u32 s80, s80, 35
    s_sub_u32 s92, s81, 1
    s_mov_b32 s66, 134217728
    s_mov_b32 s67, 0x20000
    s_mov_b64 s[64:65], s[52:53]
    v_mov_b32 v62, v76
    v_mov_b32 v63, v77
L_bloop:
    s_waitcnt vmcnt(5)
    buffer_load_dwordx4 v[152:155], v62, s[64:67], s85 offen offset:1024 nt
    v_mfma_f32_16x16x32_bf16 v[112:115], v[128:131], v[80:83], 0
    s_waitcnt vmcnt(5)
    buffer_load_dwordx4 v[156:159], v63, s[64:67], s85 offen offset:1024 nt
    v_mfma_f32_16x16x32_bf16 v[112:115], v[132:135], v[84:87], v[112:115]
    s_add_u32 s87, s87, 7
    s_cmp_lg_u32 s97, 1
    s_cbranch_scc1 L_stayk_3
    s_mov_b64 s[64:65], s[56:57]
    v_mov_b32 v62, v126
    v_mov_b32 v63, v127
    s_mul_i32 s37, s86, 7
    s_sub_u32 s87, s87, s37
L_stayk_3:
    s_add_u32 s39, s87, s88
    s_bfe_u32 s37, s39, 0x30000
    s_lshl_b32 s37, s37, 12
    s_add_u32 s85, s37, s89
    s_bfe_u32 s37, s39, 0x10003
    s_lshl_b32 s37, s37, 11
    s_add_u32 s85, s37, s85
    s_bfe_u32 s37, s39, 0x40004
    s_lshl_b32 s37, s37, 16
    s_add_u32 s85, s37, s85
    v_mov_b32_dpp v122, v96 quad_perm:[0,0,0,0] row_mask:0xf bank_mask:0xf
    v_mov_b32_dpp v124, v98 quad_perm:[2,2,2,2] row_mask:0xf bank_mask:0xf
    s_nop 0
    v_add_f32_dpp v122, v97, v122 quad_perm:[1,1,1,1] row_mask:0xf bank_mask:0xf
    v_add_f32_dpp v124, v99, v124 quad_perm:[3,3,3,3] row_mask:0xf bank_mask:0xf
    v_add_f32 v122, v122, v124
    v_max_f32 v65, v65, v122
    ds_write_b32 v64, v122 offset:0
    s_waitcnt vmcnt(5)
    buffer_load_dwordx4 v[128:131], v62, s[64:67], s85 offen offset:0 nt
    v_mfma_f32_16x16x32_bf16 v[112:115], v[136:139], v[88:91], v[112:115]
    s_waitcnt vmcnt(5)
    buffer_load_dwordx4 v[132:135], v63, s[64:67], s85 offen offset:0 nt
    v_mfma_f32_16x16x32_bf16 v[112:115], v[140:143], v[92:95], v[112:115]
    s_waitcnt vmcnt(5)
    buffer_load_dwordx4 v[136:139], v62, s[64:67], s85 offen offset:1024 nt
    v_mfma_f32_16x16x32_bf16 v[96:99], v[144:147], v[80:83], 0
    s_waitcnt vmcnt(5)
    buffer_load_dwordx4 v[140:143], v63, s[64:67], s85 offen offset:1024 nt
    v_mfma_f32_16x16x32_bf16 v[96:99], v[148:151], v[84:87], v[96:99]
    s_add_u32 s87, s87, 7
    s_add_u32 s39, s87, s88
    s_bfe_u32 s37, s39, 0x30000
    s_lshl_b32 s37, s37, 12
    s_add_u32 s85, s37, s89
    s_bfe_u32 s37, s39, 0x10003
    s_lshl_b32 s37, s37, 11
    s_add_u32 s85, s37, s85
    s_bfe_u32 s37, s39, 0x40004
    s_lshl_b32 s37, s37, 16
    s_add_u32 s85, s37, s85
    v_mov_b32_dpp v122, v112 quad_perm:[0,0,0,0] row_mask:0xf bank_mask:0xf
    v_mov_b32_dpp v124, v114 quad_perm:[2,2,2,2] row_mask:0xf bank_mask:0xf
    s_nop 0
    v_add_f32_dpp v122, v113, v122 quad_perm:[1,1,1,1] row_mask:0xf bank_mask:0xf
    v_add_f32_dpp v124, v115, v124 quad_perm:[3,3,3,3] row_mask:0xf bank_mask:0xf
    v_add_f32 v122, v122, v124
    v_max_f32 v65, v65, v122
    ds_write_b32 v64, v122 offset:256
    s_waitcnt vmcnt(5)
    buffer_load_dwordx4 v[144:147], v62, s[64:67], s85 offen offset:0 nt
    v_mfma_f32_16x16x32_bf16 v[96:99], v[152:155], v[88:91], v[96:99]
    s_waitcnt vmcnt(5)
    buffer_load_dwordx4 v[148:151], v63, s[64:67], s85 offen offset:0 nt
    v_mfma_f32_16x16x32_bf16 v[96:99], v[156:159], v[92:95], v[96:99]
    v_add_u32 v64, 512, v64
    s_sub_u32 s97, s97, 1
    s_cmp_lg_u32 s97, 0
    s_cbranch_scc1 L_bloop
    s_bfe_u32 s38, s2, 0x30000
    s_lshl_b32 s38, s38, 8
    s_add_u32 s69, s38, 32768
    v_lshrrev_b32 v68, 2, v34
    buffer_load_dword v68, v68, s[48:51], s69 offen sc1
    v_mov_b32_dpp v122, v96 quad_perm:[0,0,0,0] row_mask:0xf bank_mask:0xf
    v_mov_b32_dpp v124, v98 quad_perm:[2,2,2,2] row_mask:0xf bank_mask:0xf
    s_nop 0
    v_add_f32_dpp v122, v97, v122 quad_perm:[1,1,1,1] row_mask:0xf bank_mask:0xf
    v_add_f32_dpp v124, v99, v124 quad_perm:[3,3,3,3] row_mask:0xf bank_mask:0xf
    v_add_f32 v122, v122, v124
    v_max_f32 v65, v65, v122
    ds_write_b32 v64, v122 offset:0
    v_mov_b32 v123, 0xff7f0000
    ds_write_b32 v64, v123 offset:256
    s_lshl_b32 s38, s34, 14
    s_add_u32 s38, s38, 16384
    v_lshl_add_u32 v64, v1, 2, s38
    ds_read_b32 v66, v64
    ds_read_b32 v67, v64 offset:256
    v_mul_f32 v65, s83, v65
    s_nop 1
    v_max_f32_dpp v124, v65, v65 row_ror:4 row_mask:0xf bank_mask:0xf
    s_nop 1
    v_max_f32_dpp v124, v124, v124 row_ror:8 row_mask:0xf bank_mask:0xf
    v_mov_b32 v125, v124
    s_nop 1
    v_permlane16_swap_b32 v124, v125
    v_max_f32 v124, v124, v125
    v_mov_b32 v125, v124
    s_nop 1
    v_permlane32_swap_b32 v124, v125
    v_max_f32 v124, v124, v125
    v_mov_b32 v120, v124
    s_lshr_b32 s97, s86, 1
    s_waitcnt lgkmcnt(1)
    v_fma_f32 v123, v66, s83, -v120
    v_exp_f32 v123, v123
    ds_read_b32 v66, v64 offset:512
    v_cvt_pk_bf16_f32 v100, v123, v123
    v_add_f32 v121, v121, v123
L_vloop:
    s_nop 0
    v_and_b32_dpp v104, v100, v10 row_newbcast:0 row_mask:0xf bank_mask:0xf
    v_and_b32_dpp v105, v100, v11 row_newbcast:0 row_mask:0xf bank_mask:0xf
    v_and_b32_dpp v106, v100, v12 row_newbcast:0 row_mask:0xf bank_mask:0xf
    v_and_b32_dpp v107, v100, v13 row_newbcast:0 row_mask:0xf bank_mask:0xf
    s_waitcnt vmcnt(5)
    buffer_load_dwordx4 v[152:155], v62, s[64:67], s85 offen offset:1024 nt
    v_mfma_f32_16x16x32_bf16 v[116:119], v[128:131], v[104:107], v[116:119]
    v_and_b32_dpp v108, v100, v10 row_newbcast:4 row_mask:0xf bank_mask:0xf
    v_and_b32_dpp v109, v100, v11 row_newbcast:4 row_mask:0xf bank_mask:0xf
    v_and_b32_dpp v110, v100, v12 row_newbcast:4 row_mask:0xf bank_mask:0xf
    v_and_b32_dpp v111, v100, v13 row_newbcast:4 row_mask:0xf bank_mask:0xf
    s_waitcnt vmcnt(5)
    buffer_load_dwordx4 v[156:159], v63, s[64:67], s85 offen offset:1024 nt
    v_mfma_f32_16x16x32_bf16 v[116:119], v[132:135], v[108:111], v[116:119]
    s_add_u32 s87, s87, 7
    s_cmp_lg_u32 s97, 1
    s_cbranch_scc1 L_stayv_4
    s_mov_b64 s[64:65], s[52:53]
    v_mov_b32 v62, v76
    v_mov_b32 v63, v77
    s_mov_b64 exec, 1
    global_atomic_add v19, v9, v18, s[30:31] sc0 sc1
    s_mov_b64 exec, -1
    s_add_u32 s87, s33, 224
L_stayv_4:
    s_add_u32 s39, s87, s88
    s_bfe_u32 s37, s39, 0x30000
    s_lshl_b32 s37, s37, 12
    s_add_u32 s85, s37, s89
    s_bfe_u32 s37, s39, 0x10003
    s_lshl_b32 s37, s37, 11
    s_add_u32 s85, s37, s85
    s_bfe_u32 s37, s39, 0x40004
    s_lshl_b32 s37, s37, 16
    s_add_u32 s85, s37, s85
    s_waitcnt lgkmcnt(1)
    v_fma_f32 v123, v67, s83, -v120
    v_exp_f32 v123, v123
    ds_read_b32 v67, v64 offset:768
    v_cvt_pk_bf16_f32 v101, v123, v123
    v_add_f32 v121, v121, v123
    v_and_b32_dpp v104, v100, v10 row_newbcast:8 row_mask:0xf bank_mask:0xf
    v_and_b32_dpp v105, v100, v11 row_newbcast:8 row_mask:0xf bank_mask:0xf
    v_and_b32_dpp v106, v100, v12 row_newbcast:8 row_mask:0xf bank_mask:0xf
    v_and_b32_dpp v107, v100, v13 row_newbcast:8 row_mask:0xf bank_mask:0xf
    s_waitcnt vmcnt(5)
    buffer_load_dwordx4 v[128:131], v62, s[64:67], s85 offen offset:0 nt
    v_mfma_f32_16x16x32_bf16 v[116:119], v[136:139], v[104:107], v[116:119]
    v_and_b32_dpp v108, v100, v10 row_newbcast:12 row_mask:0xf bank_mask:0xf
    v_and_b32_dpp v109, v100, v11 row_newbcast:12 row_mask:0xf bank_mask:0xf
    v_and_b32_dpp v110, v100, v12 row_newbcast:12 row_mask:0xf bank_mask:0xf
    v_and_b32_dpp v111, v100, v13 row_newbcast:12 row_mask:0xf bank_mask:0xf
    s_waitcnt vmcnt(5)
    buffer_load_dwordx4 v[132:135], v63, s[64:67], s85 offen offset:0 nt
    v_mfma_f32_16x16x32_bf16 v[116:119], v[140:143], v[108:111], v[116:119]
    v_and_b32_dpp v104, v101, v10 row_newbcast:0 row_mask:0xf bank_mask:0xf
    v_and_b32_dpp v105, v101, v11 row_newbcast:0 row_mask:0xf bank_mask:0xf
    v_and_b32_dpp v106, v101, v12 row_newbcast:0 row_mask:0xf bank_mask:0xf
    v_and_b32_dpp v107, v101, v13 row_newbcast:0 row_mask:0xf bank_mask:0xf
    s_waitcnt vmcnt(5)
    buffer_load_dwordx4 v[136:139], v62, s[64:67], s85 offen offset:1024 nt
    v_mfma_f32_16x16x32_bf16 v[116:119], v[144:147], v[104:107], v[116:119]
    v_and_b32_dpp v108, v101, v10 row_newbcast:4 row_mask:0xf bank_mask:0xf
    v_and_b32_dpp v109, v101, v11 row_newbcast:4 row_mask:0xf bank_mask:0xf
    v_and_b32_dpp v110, v101, v12 row_newbcast:4 row_mask:0xf bank_mask:0xf
    v_and_b32_dpp v111, v101, v13 row_newbcast:4 row_mask:0xf bank_mask:0xf
    s_waitcnt vmcnt(5)
    buffer_load_dwordx4 v[140:143], v63, s[64:67], s85 offen offset:1024 nt
    v_mfma_f32_16x16x32_bf16 v[116:119], v[148:151], v[108:111], v[116:119]
    s_add_u32 s87, s87, 7
    s_cmp_lg_u32 s97, 1
    s_cbranch_scc1 L_stayv_5
    s_mov_b64 s[64:65], s[56:57]
    v_mov_b32 v62, v126
    v_mov_b32 v63, v127
    s_add_u32 s87, s33, 224
L_stayv_5:
    s_add_u32 s39, s87, s88
    s_bfe_u32 s37, s39, 0x30000
    s_lshl_b32 s37, s37, 12
    s_add_u32 s85, s37, s89
    s_bfe_u32 s37, s39, 0x10003
    s_lshl_b32 s37, s37, 11
    s_add_u32 s85, s37, s85
    s_bfe_u32 s37, s39, 0x40004
    s_lshl_b32 s37, s37, 16
    s_add_u32 s85, s37, s85
    v_add_u32 v64, 512, v64
    s_waitcnt lgkmcnt(1)
    v_fma_f32 v123, v66, s83, -v120
    v_exp_f32 v123, v123
    ds_read_b32 v66, v64 offset:512
    v_cvt_pk_bf16_f32 v100, v123, v123
    v_add_f32 v121, v121, v123
    v_and_b32_dpp v104, v101, v10 row_newbcast:8 row_mask:0xf bank_mask:0xf
    v_and_b32_dpp v105, v101, v11 row_newbcast:8 row_mask:0xf bank_mask:0xf
    v_and_b32_dpp v106, v101, v12 row_newbcast:8 row_mask:0xf bank_mask:0xf
    v_and_b32_dpp v107, v101, v13 row_newbcast:8 row_mask:0xf bank_mask:0xf
    s_waitcnt vmcnt(5)
    buffer_load_dwordx4 v[144:147], v62, s[64:67], s85 offen offset:0 nt
    v_mfma_f32_16x16x32_bf16 v[116:119], v[152:155], v[104:107], v[116:119]
    v_and_b32_dpp v108, v101, v10 row_newbcast:12 row_mask:0xf bank_mask:0xf
    v_and_b32_dpp v109, v101, v11 row_newbcast:12 row_mask:0xf bank_mask:0xf
    v_and_b32_dpp v110, v101, v12 row_newbcast:12 row_mask:0xf bank_mask:0xf
    v_and_b32_dpp v111, v101, v13 row_newbcast:12 row_mask:0xf bank_mask:0xf
    s_waitcnt vmcnt(5)
    buffer_load_dwordx4 v[148:151], v63, s[64:67], s85 offen offset:0 nt
    v_mfma_f32_16x16x32_bf16 v[116:119], v[156:159], v[108:111], v[116:119]
    s_sub_u32 s97, s97, 1
    s_cmp_lg_u32 s97, 0
    s_cbranch_scc1 L_vloop
    buffer_load_dwordx4 v[152:155], v126, s[56:59], s85 offen offset:1024 nt
    buffer_load_dwordx4 v[156:159], v127, s[56:59], s85 offen offset:1024 nt
    v_cmp_ne_u32 vcc, s70, v68
    s_nop 0
    s_cmp_eq_u64 vcc, 0
    s_cselect_b32 s70, 1, 0
L_dloop:
    s_waitcnt vmcnt(7)
    v_readfirstlane_b32 s93, v19
    v_mov_b32 v19, 64
    s_cmp_ge_u32 s93, s81
    s_cbranch_scc1 L_last0
    s_add_u32 s87, s93, 231
    s_mul_i32 s36, s93, 7
    s_add_u32 s36, s36, s80
    s_cmp_ge_u32 s93, 25
    s_cselect_b32 s87, s36, s87
    s_add_u32 s39, s87, s88
    s_bfe_u32 s37, s39, 0x30000
    s_lshl_b32 s37, s37, 12
    s_add_u32 s85, s37, s89
    s_bfe_u32 s37, s39, 0x10003
    s_lshl_b32 s37, s37, 11
    s_add_u32 s85, s37, s85
    s_bfe_u32 s37, s39, 0x40004
    s_lshl_b32 s37, s37, 16
    s_add_u32 s85, s37, s85
    s_cmp_ge_u32 s93, s92
    s_cbranch_scc1 L_noclaim_6
    s_mov_b64 exec, 1
    global_atomic_add v19, v9, v18, s[30:31] sc0 sc1
    s_mov_b64 exec, -1
L_noclaim_6:
    buffer_load_dwordx4 v[160:163], v76, s[52:55], s85 offen offset:0 nt
    v_mfma_f32_16x16x32_bf16 v[112:115], v[128:131], v[80:83], 0
    s_waitcnt vmcnt(7)
    buffer_load_dwordx4 v[164:167], v77, s[52:55], s85 offen offset:0 nt
    v_mfma_f32_16x16x32_bf16 v[112:115], v[132:135], v[84:87], v[112:115]
    s_waitcnt vmcnt(7)
    buffer_load_dwordx4 v[168:171], v76, s[52:55], s85 offen offset:1024 nt
    v_mfma_f32_16x16x32_bf16 v[112:115], v[136:139], v[88:91], v[112:115]
    s_waitcnt vmcnt(7)
    buffer_load_dwordx4 v[172:175], v77, s[52:55], s85 offen offset:1024 nt
    v_mfma_f32_16x16x32_bf16 v[112:115], v[140:143], v[92:95], v[112:115]
    s_nop 7
    v_mov_b32_dpp v122, v112 quad_perm:[0,0,0,0] row_mask:0xf bank_mask:0xf
    v_mov_b32_dpp v124, v114 quad_perm:[2,2,2,2] row_mask:0xf bank_mask:0xf
    s_nop 0
    v_add_f32_dpp v122, v113, v122 quad_perm:[1,1,1,1] row_mask:0xf bank_mask:0xf
    v_add_f32_dpp v124, v115, v124 quad_perm:[3,3,3,3] row_mask:0xf bank_mask:0xf
    v_add_f32 v122, v122, v124
    v_fma_f32 v123, v122, s83, -v120
    v_cmp_lt_f32 vcc, 0, v123
    s_cbranch_vccz L_nomax_7
    v_mul_f32 v122, s83, v122
    s_nop 1
    v_max_f32_dpp v124, v122, v122 row_ror:4 row_mask:0xf bank_mask:0xf
    s_nop 1
    v_max_f32_dpp v124, v124, v124 row_ror:8 row_mask:0xf bank_mask:0xf
    v_mov_b32 v125, v124
    s_nop 1
    v_permlane16_swap_b32 v124, v125
    v_max_f32 v124, v124, v125
    v_mov_b32 v125, v124
    s_nop 1
    v_permlane32_swap_b32 v124, v125
    v_max_f32 v124, v124, v125
    v_max_f32 v124, v124, v120
    v_sub_f32 v125, v120, v124
    v_exp_f32 v125, v125
    v_mov_b32 v120, v124
    v_sub_f32 v123, v122, v124
    v_mul_f32 v121, v121, v125
    v_mul_f32 v116, v116, v125
    v_mul_f32 v117, v117, v125
    v_mul_f32 v118, v118, v125
    v_mul_f32 v119, v119, v125
L_nomax_7:
    v_exp_f32 v123, v123
    s_nop 0
    v_cvt_pk_bf16_f32 v124, v123, v123
    v_add_f32 v121, v121, v123
    s_nop 0
    v_and_b32_dpp v96, v124, v10 row_newbcast:0 row_mask:0xf bank_mask:0xf
    v_and_b32_dpp v97, v124, v11 row_newbcast:0 row_mask:0xf bank_mask:0xf
    v_and_b32_dpp v98, v124, v12 row_newbcast:0 row_mask:0xf bank_mask:0xf
    v_and_b32_dpp v99, v124, v13 row_newbcast:0 row_mask:0xf bank_mask:0xf
    v_and_b32_dpp v100, v124, v10 row_newbcast:4 row_mask:0xf bank_mask:0xf
    v_and_b32_dpp v101, v124, v11 row_newbcast:4 row_mask:0xf bank_mask:0xf
    v_and_b32_dpp v102, v124, v12 row_newbcast:4 row_mask:0xf bank_mask:0xf
    v_and_b32_dpp v103, v124, v13 row_newbcast:4 row_mask:0xf bank_mask:0xf
    v_and_b32_dpp v104, v124, v10 row_newbcast:8 row_mask:0xf bank_mask:0xf
    v_and_b32_dpp v105, v124, v11 row_newbcast:8 row_mask:0xf bank_mask:0xf
    v_and_b32_dpp v106, v124, v12 row_newbcast:8 row_mask:0xf bank_mask:0xf
    v_and_b32_dpp v107, v124, v13 row_newbcast:8 row_mask:0xf bank_mask:0xf
    v_and_b32_dpp v108, v124, v10 row_newbcast:12 row_mask:0xf bank_mask:0xf
    v_and_b32_dpp v109, v124, v11 row_newbcast:12 row_mask:0xf bank_mask:0xf
    v_and_b32_dpp v110, v124, v12 row_newbcast:12 row_mask:0xf bank_mask:0xf
    v_and_b32_dpp v111, v124, v13 row_newbcast:12 row_mask:0xf bank_mask:0xf
    s_waitcnt vmcnt(7)
    buffer_load_dwordx4 v[176:179], v126, s[56:59], s85 offen offset:0 nt
    v_mfma_f32_16x16x32_bf16 v[116:119], v[144:147], v[96:99], v[116:119]
    s_waitcnt vmcnt(7)
    buffer_load_dwordx4 v[180:183], v127, s[56:59], s85 offen offset:0 nt
    v_mfma_f32_16x16x32_bf16 v[116:119], v[148:151], v[100:103], v[116:119]
    s_waitcnt vmcnt(7)
    buffer_load_dwordx4 v[184:187], v126, s[56:59], s85 offen offset:1024 nt
    v_mfma_f32_16x16x32_bf16 v[116:119], v[152:155], v[104:107], v[116:119]
    s_waitcnt vmcnt(7)
    buffer_load_dwordx4 v[188:191], v127, s[56:59], s85 offen offset:1024 nt
    v_mfma_f32_16x16x32_bf16 v[116:119], v[156:159], v[108:111], v[116:119]
    s_waitcnt vmcnt(7)
    v_readfirstlane_b32 s93, v19
    v_mov_b32 v19, 64
    s_cmp_ge_u32 s93, s81
    s_cbranch_scc1 L_last1
    s_add_u32 s87, s93, 231
    s_mul_i32 s36, s93, 7
    s_add_u32 s36, s36, s80
    s_cmp_ge_u32 s93, 25
    s_cselect_b32 s87, s36, s87
    s_add_u32 s39, s87, s88
    s_bfe_u32 s37, s39, 0x30000
    s_lshl_b32 s37, s37, 12
    s_add_u32 s85, s37, s89
    s_bfe_u32 s37, s39, 0x10003
    s_lshl_b32 s37, s37, 11
    s_add_u32 s85, s37, s85
    s_bfe_u32 s37, s39, 0x40004
    s_lshl_b32 s37, s37, 16
    s_add_u32 s85, s37, s85
    s_cmp_ge_u32 s93, s92
    s_cbranch_scc1 L_noclaim_8
    s_mov_b64 exec, 1
    global_atomic_add v19, v9, v18, s[30:31] sc0 sc1
    s_mov_b64 exec, -1
L_noclaim_8:
    buffer_load_dwordx4 v[128:131], v76, s[52:55], s85 offen offset:0 nt
    v_mfma_f32_16x16x32_bf16 v[112:115], v[160:163], v[80:83], 0
    s_waitcnt vmcnt(7)
    buffer_load_dwordx4 v[132:135], v77, s[52:55], s85 offen offset:0 nt
    v_mfma_f32_16x16x32_bf16 v[112:115], v[164:167], v[84:87], v[112:115]
    s_waitcnt vmcnt(7)
    buffer_load_dwordx4 v[136:139], v76, s[52:55], s85 offen offset:1024 nt
    v_mfma_f32_16x16x32_bf16 v[112:115], v[168:171], v[88:91], v[112:115]
    s_waitcnt vmcnt(7)
    buffer_load_dwordx4 v[140:143], v77, s[52:55], s85 offen offset:1024 nt
    v_mfma_f32_16x16x32_bf16 v[112:115], v[172:175], v[92:95], v[112:115]
    s_nop 7
    v_mov_b32_dpp v122, v112 quad_perm:[0,0,0,0] row_mask:0xf bank_mask:0xf
    v_mov_b32_dpp v124, v114 quad_perm:[2,2,2,2] row_mask:0xf bank_mask:0xf
    s_nop 0
    v_add_f32_dpp v122, v113, v122 quad_perm:[1,1,1,1] row_mask:0xf bank_mask:0xf
    v_add_f32_dpp v124, v115, v124 quad_perm:[3,3,3,3] row_mask:0xf bank_mask:0xf
    v_add_f32 v122, v122, v124
    v_fma_f32 v123, v122, s83, -v120
    v_cmp_lt_f32 vcc, 0, v123
    s_cbranch_vccz L_nomax_9
    v_mul_f32 v122, s83, v122
    s_nop 1
    v_max_f32_dpp v124, v122, v122 row_ror:4 row_mask:0xf bank_mask:0xf
    s_nop 1
    v_max_f32_dpp v124, v124, v124 row_ror:8 row_mask:0xf bank_mask:0xf
    v_mov_b32 v125, v124
    s_nop 1
    v_permlane16_swap_b32 v124, v125
    v_max_f32 v124, v124, v125
    v_mov_b32 v125, v124
    s_nop 1
    v_permlane32_swap_b32 v124, v125
    v_max_f32 v124, v124, v125
    v_max_f32 v124, v124, v120
    v_sub_f32 v125, v120, v124
    v_exp_f32 v125, v125
    v_mov_b32 v120, v124
    v_sub_f32 v123, v122, v124
    v_mul_f32 v121, v121, v125
    v_mul_f32 v116, v116, v125
    v_mul_f32 v117, v117, v125
    v_mul_f32 v118, v118, v125
    v_mul_f32 v119, v119, v125
L_nomax_9:
    v_exp_f32 v123, v123
    s_nop 0
    v_cvt_pk_bf16_f32 v124, v123, v123
    v_add_f32 v121, v121, v123
    s_nop 0
    v_and_b32_dpp v96, v124, v10 row_newbcast:0 row_mask:0xf bank_mask:0xf
    v_and_b32_dpp v97, v124, v11 row_newbcast:0 row_mask:0xf bank_mask:0xf
    v_and_b32_dpp v98, v124, v12 row_newbcast:0 row_mask:0xf bank_mask:0xf
    v_and_b32_dpp v99, v124, v13 row_newbcast:0 row_mask:0xf bank_mask:0xf
    v_and_b32_dpp v100, v124, v10 row_newbcast:4 row_mask:0xf bank_mask:0xf
    v_and_b32_dpp v101, v124, v11 row_newbcast:4 row_mask:0xf bank_mask:0xf
    v_and_b32_dpp v102, v124, v12 row_newbcast:4 row_mask:0xf bank_mask:0xf
    v_and_b32_dpp v103, v124, v13 row_newbcast:4 row_mask:0xf bank_mask:0xf
    v_and_b32_dpp v104, v124, v10 row_newbcast:8 row_mask:0xf bank_mask:0xf
    v_and_b32_dpp v105, v124, v11 row_newbcast:8 row_mask:0xf bank_mask:0xf
    v_and_b32_dpp v106, v124, v12 row_newbcast:8 row_mask:0xf bank_mask:0xf
    v_and_b32_dpp v107, v124, v13 row_newbcast:8 row_mask:0xf bank_mask:0xf
    v_and_b32_dpp v108, v124, v10 row_newbcast:12 row_mask:0xf bank_mask:0xf
    v_and_b32_dpp v109, v124, v11 row_newbcast:12 row_mask:0xf bank_mask:0xf
    v_and_b32_dpp v110, v124, v12 row_newbcast:12 row_mask:0xf bank_mask:0xf
    v_and_b32_dpp v111, v124, v13 row_newbcast:12 row_mask:0xf bank_mask:0xf
    s_waitcnt vmcnt(7)
    buffer_load_dwordx4 v[144:147], v126, s[56:59], s85 offen offset:0 nt
    v_mfma_f32_16x16x32_bf16 v[116:119], v[176:179], v[96:99], v[116:119]
    s_waitcnt vmcnt(7)
    buffer_load_dwordx4 v[148:151], v127, s[56:59], s85 offen offset:0 nt
    v_mfma_f32_16x16x32_bf16 v[116:119], v[180:183], v[100:103], v[116:119]
    s_waitcnt vmcnt(7)
    buffer_load_dwordx4 v[152:155], v126, s[56:59], s85 offen offset:1024 nt
    v_mfma_f32_16x16x32_bf16 v[116:119], v[184:187], v[104:107], v[116:119]
    s_waitcnt vmcnt(7)
    buffer_load_dwordx4 v[156:159], v127, s[56:59], s85 offen offset:1024 nt
    v_mfma_f32_16x16x32_bf16 v[116:119], v[188:191], v[108:111], v[116:119]
    s_branch L_dloop
L_last1:
    buffer_load_dwordx4 v[224:227], v54, s[48:51], s46 offen sc1
    s_mov_b32 s86, s44
    s_bitcmp1_b32 s90, 2
    s_cselect_b32 s44, 4194304, s44
    s_lshl_b32 s39, s34, 13
    s_add_u32 s39, s39, 98304
    s_mov_b32 m0, s39
    s_nop 0
    buffer_load_dwordx4 v20, s[40:43], s44 offen offset:0 nt lds
    v_mfma_f32_16x16x32_bf16 v[112:115], v[160:163], v[80:83], 0
    s_waitcnt vmcnt(8)
    buffer_load_dwordx4 v21, s[40:43], s44 offen offset:1024 nt lds
    v_mfma_f32_16x16x32_bf16 v[112:115], v[164:167], v[84:87], v[112:115]
    s_waitcnt vmcnt(8)
    buffer_load_dwordx4 v22, s[40:43], s44 offen offset:2048 nt lds
    v_mfma_f32_16x16x32_bf16 v[112:115], v[168:171], v[88:91], v[112:115]
    s_waitcnt vmcnt(8)
    buffer_load_dwordx4 v23, s[40:43], s44 offen offset:3072 nt lds
    v_mfma_f32_16x16x32_bf16 v[112:115], v[172:175], v[92:95], v[112:115]
    s_nop 7
    v_mov_b32_dpp v122, v112 quad_perm:[0,0,0,0] row_mask:0xf bank_mask:0xf
    v_mov_b32_dpp v124, v114 quad_perm:[2,2,2,2] row_mask:0xf bank_mask:0xf
    s_nop 0
    v_add_f32_dpp v122, v113, v122 quad_perm:[1,1,1,1] row_mask:0xf bank_mask:0xf
    v_add_f32_dpp v124, v115, v124 quad_perm:[3,3,3,3] row_mask:0xf bank_mask:0xf
    v_add_f32 v122, v122, v124
    v_fma_f32 v123, v122, s83, -v120
    v_cmp_lt_f32 vcc, 0, v123
    s_cbranch_vccz L_nomax_10
    v_mul_f32 v122, s83, v122
    s_nop 1
    v_max_f32_dpp v124, v122, v122 row_ror:4 row_mask:0xf bank_mask:0xf
    s_nop 1
    v_max_f32_dpp v124, v124, v124 row_ror:8 row_mask:0xf bank_mask:0xf
    v_mov_b32 v125, v124
    s_nop 1
    v_permlane16_swap_b32 v124, v125
    v_max_f32 v124, v124, v125
    v_mov_b32 v125, v124
    s_nop 1
    v_permlane32_swap_b32 v124, v125
    v_max_f32 v124, v124, v125
    v_max_f32 v124, v124, v120
    v_sub_f32 v125, v120, v124
    v_exp_f32 v125, v125
    v_mov_b32 v120, v124
    v_sub_f32 v123, v122, v124
    v_mul_f32 v121, v121, v125
    v_mul_f32 v116, v116, v125
    v_mul_f32 v117, v117, v125
    v_mul_f32 v118, v118, v125
    v_mul_f32 v119, v119, v125
L_nomax_10:
    v_exp_f32 v123, v123
    s_nop 0
    v_cvt_pk_bf16_f32 v124, v123, v123
    v_add_f32 v121, v121, v123
    s_nop 0
    v_and_b32_dpp v96, v124, v10 row_newbcast:0 row_mask:0xf bank_mask:0xf
    v_and_b32_dpp v97, v124, v11 row_newbcast:0 row_mask:0xf bank_mask:0xf
    v_and_b32_dpp v98, v124, v12 row_newbcast:0 row_mask:0xf bank_mask:0xf
    v_and_b32_dpp v99, v124, v13 row_newbcast:0 row_mask:0xf bank_mask:0xf
    v_and_b32_dpp v100, v124, v10 row_newbcast:4 row_mask:0xf bank_mask:0xf
    v_and_b32_dpp v101, v124, v11 row_newbcast:4 row_mask:0xf bank_mask:0xf
    v_and_b32_dpp v102, v124, v12 row_newbcast:4 row_mask:0xf bank_mask:0xf
    v_and_b32_dpp v103, v124, v13 row_newbcast:4 row_mask:0xf bank_mask:0xf
    v_and_b32_dpp v104, v124, v10 row_newbcast:8 row_mask:0xf bank_mask:0xf
    v_and_b32_dpp v105, v124, v11 row_newbcast:8 row_mask:0xf bank_mask:0xf
    v_and_b32_dpp v106, v124, v12 row_newbcast:8 row_mask:0xf bank_mask:0xf
    v_and_b32_dpp v107, v124, v13 row_newbcast:8 row_mask:0xf bank_mask:0xf
    v_and_b32_dpp v108, v124, v10 row_newbcast:12 row_mask:0xf bank_mask:0xf
    v_and_b32_dpp v109, v124, v11 row_newbcast:12 row_mask:0xf bank_mask:0xf
    v_and_b32_dpp v110, v124, v12 row_newbcast:12 row_mask:0xf bank_mask:0xf
    v_and_b32_dpp v111, v124, v13 row_newbcast:12 row_mask:0xf bank_mask:0xf
    s_waitcnt vmcnt(8)
    s_lshl_b32 s39, s34, 13
    s_add_u32 s39, s39, 102400
    s_mov_b32 m0, s39
    s_add_u32 s44, s44, 16384
    buffer_load_dwordx4 v20, s[40:43], s44 offen offset:0 nt lds
    v_mfma_f32_16x16x32_bf16 v[116:119], v[176:179], v[96:99], v[116:119]
    v_add_f32_dpp v121, v121, v121 row_ror:8 row_mask:0xf bank_mask:0xf
    s_nop 1
    v_add_f32_dpp v121, v121, v121 row_ror:4 row_mask:0xf bank_mask:0xf
    v_mov_b32 v125, v121
    s_nop 1
    v_permlane16_swap_b32 v121, v125
    v_add_f32 v121, v121, v125
    v_mov_b32 v125, v121
    s_nop 1
    v_permlane32_swap_b32 v121, v125
    v_add_f32 v121, v121, v125
    v_and_b32 v125, s82, v120
    v_sub_f32 v125, v120, v125
    s_mov_b32 vcc_lo, 0xff00ff00
    s_mov_b32 vcc_hi, 0xff00ff00
    s_waitcnt vmcnt(8)
    buffer_load_dwordx4 v21, s[40:43], s44 offen offset:1024 nt lds
    v_mfma_f32_16x16x32_bf16 v[116:119], v[180:183], v[100:103], v[116:119]
    s_waitcnt vmcnt(8)
    buffer_load_dwordx4 v22, s[40:43], s44 offen offset:2048 nt lds
    v_mfma_f32_16x16x32_bf16 v[116:119], v[184:187], v[104:107], v[116:119]
    s_waitcnt vmcnt(8)
    buffer_load_dwordx4 v23, s[40:43], s44 offen offset:3072 nt lds
    v_mfma_f32_16x16x32_bf16 v[116:119], v[188:191], v[108:111], v[116:119]
    s_branch L_bdone
L_last0:
    buffer_load_dwordx4 v[224:227], v54, s[48:51], s46 offen sc1
    s_mov_b32 s86, s44
    s_bitcmp1_b32 s90, 2
    s_cselect_b32 s44, 4194304, s44
    s_lshl_b32 s39, s34, 13
    s_add_u32 s39, s39, 98304
    s_mov_b32 m0, s39
    s_nop 0
    buffer_load_dwordx4 v20, s[40:43], s44 offen offset:0 nt lds
    v_mfma_f32_16x16x32_bf16 v[112:115], v[128:131], v[80:83], 0
    s_waitcnt vmcnt(8)
    buffer_load_dwordx4 v21, s[40:43], s44 offen offset:1024 nt lds
    v_mfma_f32_16x16x32_bf16 v[112:115], v[132:135], v[84:87], v[112:115]
    s_waitcnt vmcnt(8)
    buffer_load_dwordx4 v22, s[40:43], s44 offen offset:2048 nt lds
    v_mfma_f32_16x16x32_bf16 v[112:115], v[136:139], v[88:91], v[112:115]
    s_waitcnt vmcnt(8)
    buffer_load_dwordx4 v23, s[40:43], s44 offen offset:3072 nt lds
    v_mfma_f32_16x16x32_bf16 v[112:115], v[140:143], v[92:95], v[112:115]
    s_nop 7
    v_mov_b32_dpp v122, v112 quad_perm:[0,0,0,0] row_mask:0xf bank_mask:0xf
    v_mov_b32_dpp v124, v114 quad_perm:[2,2,2,2] row_mask:0xf bank_mask:0xf
    s_nop 0
    v_add_f32_dpp v122, v113, v122 quad_perm:[1,1,1,1] row_mask:0xf bank_mask:0xf
    v_add_f32_dpp v124, v115, v124 quad_perm:[3,3,3,3] row_mask:0xf bank_mask:0xf
    v_add_f32 v122, v122, v124
    v_fma_f32 v123, v122, s83, -v120
    v_cmp_lt_f32 vcc, 0, v123
    s_cbranch_vccz L_nomax_11
    v_mul_f32 v122, s83, v122
    s_nop 1
    v_max_f32_dpp v124, v122, v122 row_ror:4 row_mask:0xf bank_mask:0xf
    s_nop 1
    v_max_f32_dpp v124, v124, v124 row_ror:8 row_mask:0xf bank_mask:0xf
    v_mov_b32 v125, v124
    s_nop 1
    v_permlane16_swap_b32 v124, v125
    v_max_f32 v124, v124, v125
    v_mov_b32 v125, v124
    s_nop 1
    v_permlane32_swap_b32 v124, v125
    v_max_f32 v124, v124, v125
    v_max_f32 v124, v124, v120
    v_sub_f32 v125, v120, v124
    v_exp_f32 v125, v125
    v_mov_b32 v120, v124
    v_sub_f32 v123, v122, v124
    v_mul_f32 v121, v121, v125
    v_mul_f32 v116, v116, v125
    v_mul_f32 v117, v117, v125
    v_mul_f32 v118, v118, v125
    v_mul_f32 v119, v119, v125
L_nomax_11:
    v_exp_f32 v123, v123
    s_nop 0
    v_cvt_pk_bf16_f32 v124, v123, v123
    v_add_f32 v121, v121, v123
    s_nop 0
    v_and_b32_dpp v96, v124, v10 row_newbcast:0 row_mask:0xf bank_mask:0xf
    v_and_b32_dpp v97, v124, v11 row_newbcast:0 row_mask:0xf bank_mask:0xf
    v_and_b32_dpp v98, v124, v12 row_newbcast:0 row_mask:0xf bank_mask:0xf
    v_and_b32_dpp v99, v124, v13 row_newbcast:0 row_mask:0xf bank_mask:0xf
    v_and_b32_dpp v100, v124, v10 row_newbcast:4 row_mask:0xf bank_mask:0xf
    v_and_b32_dpp v101, v124, v11 row_newbcast:4 row_mask:0xf bank_mask:0xf
    v_and_b32_dpp v102, v124, v12 row_newbcast:4 row_mask:0xf bank_mask:0xf
    v_and_b32_dpp v103, v124, v13 row_newbcast:4 row_mask:0xf bank_mask:0xf
    v_and_b32_dpp v104, v124, v10 row_newbcast:8 row_mask:0xf bank_mask:0xf
    v_and_b32_dpp v105, v124, v11 row_newbcast:8 row_mask:0xf bank_mask:0xf
    v_and_b32_dpp v106, v124, v12 row_newbcast:8 row_mask:0xf bank_mask:0xf
    v_and_b32_dpp v107, v124, v13 row_newbcast:8 row_mask:0xf bank_mask:0xf
    v_and_b32_dpp v108, v124, v10 row_newbcast:12 row_mask:0xf bank_mask:0xf
    v_and_b32_dpp v109, v124, v11 row_newbcast:12 row_mask:0xf bank_mask:0xf
    v_and_b32_dpp v110, v124, v12 row_newbcast:12 row_mask:0xf bank_mask:0xf
    v_and_b32_dpp v111, v124, v13 row_newbcast:12 row_mask:0xf bank_mask:0xf
    s_waitcnt vmcnt(8)
    s_lshl_b32 s39, s34, 13
    s_add_u32 s39, s39, 102400
    s_mov_b32 m0, s39
    s_add_u32 s44, s44, 16384
    buffer_load_dwordx4 v20, s[40:43], s44 offen offset:0 nt lds
    v_mfma_f32_16x16x32_bf16 v[116:119], v[144:147], v[96:99], v[116:119]
    v_add_f32_dpp v121, v121, v121 row_ror:8 row_mask:0xf bank_mask:0xf
    s_nop 1
    v_add_f32_dpp v121, v121, v121 row_ror:4 row_mask:0xf bank_mask:0xf
    v_mov_b32 v125, v121
    s_nop 1
    v_permlane16_swap_b32 v121, v125
    v_add_f32 v121, v121, v125
    v_mov_b32 v125, v121
    s_nop 1
    v_permlane32_swap_b32 v121, v125
    v_add_f32 v121, v121, v125
    v_and_b32 v125, s82, v120
    v_sub_f32 v125, v120, v125
    s_mov_b32 vcc_lo, 0xff00ff00
    s_mov_b32 vcc_hi, 0xff00ff00
    s_waitcnt vmcnt(8)
    buffer_load_dwordx4 v21, s[40:43], s44 offen offset:1024 nt lds
    v_mfma_f32_16x16x32_bf16 v[116:119], v[148:151], v[100:103], v[116:119]
    s_waitcnt vmcnt(8)
    buffer_load_dwordx4 v22, s[40:43], s44 offen offset:2048 nt lds
    v_mfma_f32_16x16x32_bf16 v[116:119], v[152:155], v[104:107], v[116:119]
    s_waitcnt vmcnt(8)
    buffer_load_dwordx4 v23, s[40:43], s44 offen offset:3072 nt lds
    v_mfma_f32_16x16x32_bf16 v[116:119], v[156:159], v[108:111], v[116:119]
L_bdone:
    s_nop 7
    v_cndmask_b32 v116, v116, v120, vcc
    v_cndmask_b32 v117, v117, v121, vcc
    v_cndmask_b32 v118, v118, v125, vcc
    v_and_or_b32 v119, v119, s82, v8
    v_and_or_b32 v116, v116, s82, v8
    v_and_or_b32 v117, v117, s82, v8
    v_and_or_b32 v118, v118, s82, v8
    s_mov_b32 exec_lo, 0xff01ff
    s_mov_b32 exec_hi, 0xff00ff
    buffer_store_dwordx4 v[116:119], v79, s[48:51], s96 offen sc1
    s_mov_b64 exec, -1
    s_bitcmp1_b32 s90, 2
    s_cbranch_scc1 L_ctx
    buffer_load_dwordx4 v[204:207], v53, s[48:51], s47 offen sc1
    buffer_load_dwordx4 v[192:195], v50, s[48:51], s47 offen sc1
    buffer_load_dwordx4 v[196:199], v51, s[48:51], s47 offen sc1
    buffer_load_dwordx4 v[200:203], v52, s[48:51], s47 offen sc1
    v_xor_b32 v104, s35, v116
    v_xor_b32 v105, s35, v117
    v_xor_b32 v106, s35, v118
    v_xor_b32 v107, s35, v119
    v_mov_b32 v5, 0xff7f0000
    v_cndmask_b32 v120, v120, v5, vcc
    v_and_b32 v121, s82, v121
    s_mov_b32 s86, 0x88888888
    s_mov_b32 s87, 0x88888888
    s_waitcnt vmcnt(0)
L_hop1poll:
    v_xor_b32 v192, s35, v192
    v_xor_b32 v193, s35, v193
    v_xor_b32 v194, s35, v194
    v_xor_b32 v195, s35, v195
    v_xor_b32 v196, s35, v196
    v_xor_b32 v197, s35, v197
    v_xor_b32 v198, s35, v198
    v_xor_b32 v199, s35, v199
    v_xor_b32 v200, s35, v200
    v_xor_b32 v201, s35, v201
    v_xor_b32 v202, s35, v202
    v_xor_b32 v203, s35, v203
    v_xor_b32 v204, s35, v204
    v_xor_b32 v205, s35, v205
    v_xor_b32 v206, s35, v206
    v_xor_b32 v207, s35, v207
    v_or_b32 v4, v192, v193
    v_or3_b32 v4, v4, v194, v195
    v_or3_b32 v4, v4, v196, v197
    v_or3_b32 v4, v4, v198, v199
    v_or3_b32 v4, v4, v200, v201
    v_or3_b32 v4, v4, v202, v203
    v_or3_b32 v4, v4, v204, v205
    v_or3_b32 v4, v4, v206, v207
    v_and_b32 v4, 0xff, v4
    v_cmp_ne_u32 vcc, 0, v4
    v_add_f32 v122, v204, v206
    s_cbranch_vccz L_hop1ok
    buffer_load_dwordx4 v[204:207], v53, s[48:51], s47 offen sc1
    buffer_load_dwordx4 v[192:195], v50, s[48:51], s47 offen sc1
    buffer_load_dwordx4 v[196:199], v51, s[48:51], s47 offen sc1
    buffer_load_dwordx4 v[200:203], v52, s[48:51], s47 offen sc1
    s_waitcnt vmcnt(0)
    s_sub_u32 s84, s84, 1
    s_cmp_lg_u32 s84, 0
    s_cbranch_scc1 L_hop1poll
    s_branch L_end
L_ctx:
    s_mov_b32 s44, s86
    s_lshl_b32 s39, s34, 13
    s_add_u32 s39, s39, 98304
    s_mov_b32 m0, s39
    s_nop 0
    buffer_load_dwordx4 v20, s[40:43], s44 offen offset:0 nt lds
    buffer_load_dwordx4 v21, s[40:43], s44 offen offset:1024 nt lds
    buffer_load_dwordx4 v22, s[40:43], s44 offen offset:2048 nt lds
    buffer_load_dwordx4 v23, s[40:43], s44 offen offset:3072 nt lds
    s_lshl_b32 s39, s34, 13
    s_add_u32 s39, s39, 102400
    s_mov_b32 m0, s39
    s_add_u32 s44, s44, 16384
    buffer_load_dwordx4 v20, s[40:43], s44 offen offset:0 nt lds
    buffer_load_dwordx4 v21, s[40:43], s44 offen offset:1024 nt lds
    buffer_load_dwordx4 v22, s[40:43], s44 offen offset:2048 nt lds
    buffer_load_dwordx4 v23, s[40:43], s44 offen offset:3072 nt lds
    s_waitcnt vmcnt(9)
L_ctxcheck:
    v_xor_b32 v224, s35, v224
    v_xor_b32 v225, s35, v225
    v_xor_b32 v226, s35, v226
    v_xor_b32 v227, s35, v227
    v_or_b32 v4, v224, v225
    v_or3_b32 v4, v4, v226, v227
    v_and_b32 v4, 0xff, v4
    v_cmp_ne_u32 vcc, 0, v4
    s_cbranch_vccz L_ctxok
    buffer_load_dwordx4 v[224:227], v54, s[48:51], s46 offen sc1
    s_waitcnt vmcnt(0)
    s_sub_u32 s84, s84, 1
    s_cmp_lg_u32 s84, 0
    s_cbranch_scc1 L_ctxcheck
    s_branch L_end
L_ctxok:
    v_cvt_pk_bf16_f32 v224, v224, v225
    v_cvt_pk_bf16_f32 v225, v226, v227
    ds_write_b64 v35, v[224:225]
    s_branch L_final
L_hop1ok:
    v_cndmask_b32 v122, v122, v120, s[86:87]
    v_cndmask_b32 v123, v205, v121, s[86:87]
    s_nop 0
    v_max_f32_dpp v5, v122, v122 quad_perm:[1,0,3,2] row_mask:0xf bank_mask:0xf
    s_nop 1
    v_max_f32_dpp v5, v5, v5 quad_perm:[2,3,0,1] row_mask:0xf bank_mask:0xf
    s_nop 1
    v_max_f32_dpp v5, v5, v5 row_ror:8 row_mask:0xf bank_mask:0xf
    v_sub_f32 v122, v122, v5
    v_exp_f32 v122, v122
    s_nop 0
    v_mul_f32 v123, v123, v122
    v_mul_f32_dpp v104, v122, v104 quad_perm:[3,3,3,3] row_mask:0xf bank_mask:0xf
    v_mul_f32_dpp v105, v122, v105 quad_perm:[3,3,3,3] row_mask:0xf bank_mask:0xf
    v_mul_f32_dpp v106, v122, v106 quad_perm:[3,3,3,3] row_mask:0xf bank_mask:0xf
    v_mul_f32_dpp v107, v122, v107 quad_perm:[3,3,3,3] row_mask:0xf bank_mask:0xf
    v_add_f32_dpp v123, v123, v123 quad_perm:[1,0,3,2] row_mask:0xf bank_mask:0xf
    v_fmac_f32_dpp v104, v122, v192 quad_perm:[0,0,0,0] row_mask:0xf bank_mask:0xf
    v_fmac_f32_dpp v105, v122, v193 quad_perm:[0,0,0,0] row_mask:0xf bank_mask:0xf
    v_fmac_f32_dpp v106, v122, v194 quad_perm:[0,0,0,0] row_mask:0xf bank_mask:0xf
    v_fmac_f32_dpp v107, v122, v195 quad_perm:[0,0,0,0] row_mask:0xf bank_mask:0xf
    v_add_f32_dpp v123, v123, v123 quad_perm:[2,3,0,1] row_mask:0xf bank_mask:0xf
    v_fmac_f32_dpp v104, v122, v196 quad_perm:[1,1,1,1] row_mask:0xf bank_mask:0xf
    v_fmac_f32_dpp v105, v122, v197 quad_perm:[1,1,1,1] row_mask:0xf bank_mask:0xf
    v_fmac_f32_dpp v106, v122, v198 quad_perm:[1,1,1,1] row_mask:0xf bank_mask:0xf
    v_fmac_f32_dpp v107, v122, v199 quad_perm:[1,1,1,1] row_mask:0xf bank_mask:0xf
    v_add_f32_dpp v123, v123, v123 row_ror:8 row_mask:0xf bank_mask:0xf
    v_fmac_f32_dpp v104, v122, v200 quad_perm:[2,2,2,2] row_mask:0xf bank_mask:0xf
    v_fmac_f32_dpp v105, v122, v201 quad_perm:[2,2,2,2] row_mask:0xf bank_mask:0xf
    v_fmac_f32_dpp v106, v122, v202 quad_perm:[2,2,2,2] row_mask:0xf bank_mask:0xf
    v_fmac_f32_dpp v107, v122, v203 quad_perm:[2,2,2,2] row_mask:0xf bank_mask:0xf
    v_rcp_f32 v123, v123
    v_add_f32_dpp v104, v104, v104 row_ror:8 row_mask:0xf bank_mask:0xf
    v_add_f32_dpp v105, v105, v105 row_ror:8 row_mask:0xf bank_mask:0xf
    v_add_f32_dpp v106, v106, v106 row_ror:8 row_mask:0xf bank_mask:0xf
    v_add_f32_dpp v107, v107, v107 row_ror:8 row_mask:0xf bank_mask:0xf
    v_mul_f32 v104, v104, v123
    v_mul_f32 v105, v105, v123
    v_mul_f32 v106, v106, v123
    v_mul_f32 v107, v107, v123
    v_cvt_pk_bf16_f32 v104, v104, v105
    v_cvt_pk_bf16_f32 v106, v106, v107
    s_mov_b32 exec_lo, 0xff00ff
    s_mov_b32 exec_hi, 0xff00ff
    ds_write_b16 v31, v104
    ds_write_b16_d16_hi v31, v104 offset:16
    ds_write_b16 v31, v106 offset:32
    ds_write_b16_d16_hi v31, v106 offset:48
    s_mov_b64 exec, -1
L_final:
    s_waitcnt vmcnt(0) lgkmcnt(0)
    s_barrier
    ds_read_b64_tr_b16 v[128:129], v24 offset:0
    ds_read_b64_tr_b16 v[130:131], v25 offset:1024
    ds_read_b128 v[160:163], v28 offset:0
    ds_read_b64_tr_b16 v[132:133], v24 offset:8192
    ds_read_b64_tr_b16 v[134:135], v25 offset:9216
    ds_read_b128 v[164:167], v28 offset:64
    ds_read_b64_tr_b16 v[136:137], v24 offset:16384
    ds_read_b64_tr_b16 v[138:139], v25 offset:17408
    ds_read_b128 v[168:171], v28 offset:128
    ds_read_b64_tr_b16 v[140:141], v24 offset:24576
    ds_read_b64_tr_b16 v[142:143], v25 offset:25600
    ds_read_b128 v[172:175], v28 offset:192
    ds_read_b64_tr_b16 v[144:145], v26 offset:0
    ds_read_b64_tr_b16 v[146:147], v27 offset:1024
    ds_read_b128 v[176:179], v29 offset:0
    s_waitcnt lgkmcnt(12)
    v_mfma_f32_16x16x32_bf16 v[112:115], v[128:131], v[160:163], 0
    ds_read_b64_tr_b16 v[148:149], v26 offset:8192
    ds_read_b64_tr_b16 v[150:151], v27 offset:9216
    ds_read_b128 v[180:183], v29 offset:64
    s_waitcnt lgkmcnt(12)
    v_mfma_f32_16x16x32_bf16 v[112:115], v[132:135], v[164:167], v[112:115]
    ds_read_b64_tr_b16 v[152:153], v26 offset:16384
    ds_read_b64_tr_b16 v[154:155], v27 offset:17408
    ds_read_b128 v[184:187], v29 offset:128
    s_waitcnt lgkmcnt(12)
    v_mfma_f32_16x16x32_bf16 v[112:115], v[136:139], v[168:171], v[112:115]
    ds_read_b64_tr_b16 v[156:157], v26 offset:24576
    ds_read_b64_tr_b16 v[158:159], v27 offset:25600
    ds_read_b128 v[188:191], v29 offset:192
    s_waitcnt lgkmcnt(12)
    v_mfma_f32_16x16x32_bf16 v[112:115], v[140:143], v[172:175], v[112:115]
    s_waitcnt lgkmcnt(9)
    v_mfma_f32_16x16x32_bf16 v[112:115], v[144:147], v[176:179], v[112:115]
    s_waitcnt lgkmcnt(6)
    v_mfma_f32_16x16x32_bf16 v[112:115], v[148:151], v[180:183], v[112:115]
    s_waitcnt lgkmcnt(3)
    v_mfma_f32_16x16x32_bf16 v[112:115], v[152:155], v[184:187], v[112:115]
    s_waitcnt lgkmcnt(0)
    v_mfma_f32_16x16x32_bf16 v[112:115], v[156:159], v[188:191], v[112:115]
    s_add_u32 s37, s71, 4096
    s_cmp_eq_u32 s70, 1
    s_mov_b32 exec_lo, 0xff00ff
    s_mov_b32 exec_hi, 0xff00ff
    s_nop 3
    v_and_or_b32 v112, v112, s82, v8
    v_and_or_b32 v113, v113, s82, v8
    v_and_or_b32 v114, v114, s82, v8
    v_and_or_b32 v115, v115, s82, v8
    s_cbranch_scc1 L_ylocal
    buffer_store_dwordx4 v[112:115], v30, s[48:51], s45 offen sc1
    s_branch L_ydone
L_ylocal:
    buffer_store_dwordx4 v[112:115], v30, s[48:51], s45 offen
L_ydone:
    s_mov_b64 exec, -1
    s_cmp_lg_u32 s34, 0
    s_cbranch_scc1 L_done
L_hop2:
    buffer_load_dwordx4 v[224:227], v32, s[48:51], s71 offen sc1
    buffer_load_dwordx4 v[228:231], v32, s[48:51], s37 offen sc1
    s_waitcnt vmcnt(0)
    v_xor_b32 v224, s35, v224
    v_xor_b32 v225, s35, v225
    v_xor_b32 v226, s35, v226
    v_xor_b32 v227, s35, v227
    v_xor_b32 v228, s35, v228
    v_xor_b32 v229, s35, v229
    v_xor_b32 v230, s35, v230
    v_xor_b32 v231, s35, v231
    v_or_b32 v4, v224, v225
    v_or3_b32 v4, v4, v226, v227
    v_or3_b32 v4, v4, v228, v229
    v_or3_b32 v4, v4, v230, v231
    v_and_b32 v4, 0xff, v4
    v_cmp_ne_u32 vcc, 0, v4
    v_add_f32 v232, v224, v228
    v_add_f32 v233, v225, v229
    v_add_f32 v234, v226, v230
    v_add_f32 v235, v227, v231
    s_cbranch_vccz L_hop2ok
    s_sub_u32 s84, s84, 1
    s_cmp_lg_u32 s84, 0
    s_cbranch_scc1 L_hop2
    s_branch L_end
L_hop2ok:
    v_permlane16_swap_b32 v232, v233
    v_permlane16_swap_b32 v234, v235
    v_add_f32 v232, v232, v233
    v_add_f32 v234, v234, v235
    s_nop 1
    v_permlane32_swap_b32 v232, v234
    v_add_f32 v232, v232, v234
    s_nop 1
    v_add_f32_dpp v232, v232, v232 row_ror:8 row_mask:0xf bank_mask:0xf
    s_nop 1
    v_add_f32_dpp v232, v232, v232 row_ror:4 row_mask:0xf bank_mask:0xf
    v_cvt_pk_bf16_f32 v232, v232, v232
    s_mov_b32 exec_lo, 0xf000f
    s_mov_b32 exec_hi, 0xf000f
    buffer_store_short v232, v33, s[72:75], 0 offen
    s_cmp_lg_u32 s2, 0
    s_cbranch_scc1 L_done
    v_mov_b32 v4, 0
    s_mov_b64 exec, 1
    buffer_store_dword v8, v4, s[48:51], 0 offen
L_done:
L_end:
    s_endpgm
L_qp:
    v_lshlrev_b32 v4, 18, v2
    v_lshl_add_u32 v14, v3, 4, v4
    v_lshrrev_b32 v5, 3, v3
    v_lshlrev_b32 v5, 10, v5
    v_lshl_add_u32 v15, v2, 6, v5
    s_cmp_eq_u32 s33, 0
    s_cselect_b32 s61, 3, 2
    s_xor_b32 s61, s61, s32
    s_lshl_b32 s86, s34, 8
    s_lshl_b32 s63, s34, 20
    s_lshl_b32 s38, s61, 8
    s_add_u32 s63, s63, s38
    s_mov_b32 s42, 4194304
    s_mov_b32 s43, 0x20000
    s_mov_b32 s46, 4096
    s_mov_b32 s47, 0x20000
    s_cmp_eq_u32 s33, 0
    s_waitcnt lgkmcnt(0)
    s_cselect_b64 s[40:41], s[22:23], s[8:9]
    s_cselect_b64 s[44:45], s[16:17], s[4:5]
    buffer_load_dwordx4 a[128:131], v14, s[40:43], s63 offen nt
    s_add_u32 s63, s63, 8192
    buffer_load_dwordx4 a[132:135], v14, s[40:43], s63 offen nt
    s_add_u32 s63, s63, 8192
    buffer_load_dwordx4 v[20:23], v15, s[44:47], s86 offen offset:0
    buffer_load_dwordx4 v[36:39], v15, s[44:47], s86 offen offset:2048
    buffer_load_dwordx4 a[136:139], v14, s[40:43], s63 offen nt
    s_add_u32 s63, s63, 8192
    buffer_load_dwordx4 a[140:143], v14, s[40:43], s63 offen nt
    s_add_u32 s63, s63, 8192
    buffer_load_dwordx4 a[144:147], v14, s[40:43], s63 offen nt
    s_add_u32 s63, s63, 8192
    buffer_load_dwordx4 a[148:151], v14, s[40:43], s63 offen nt
    s_add_u32 s63, s63, 8192
    buffer_load_dwordx4 a[152:155], v14, s[40:43], s63 offen nt
    s_add_u32 s63, s63, 8192
    buffer_load_dwordx4 a[156:159], v14, s[40:43], s63 offen nt
    s_add_u32 s63, s63, 8192
    s_load_dword s35, s[30:31], 0
    s_mov_b32 s48, s30
    s_and_b32 s49, s31, 0xffff
    s_mov_b32 s50, 8388608
    s_mov_b32 s51, 0x20000
    s_mov_b32 s82, 0xffffff00
    s_mov_b32 s83, 0x3e0293ee
    s_mov_b32 s84, 2097152
    v_and_b32 v4, 1, v1
    v_lshlrev_b32 v4, 4, v4
    v_mov_b32 v5, 0xffff
    v_lshlrev_b32 v4, v4, v5
    v_bfe_u32 v5, v1, 1, 2
    v_cmp_eq_u32 vcc, 0, v5
    s_nop 1
    v_cndmask_b32 v10, 0, v4, vcc
    v_cmp_eq_u32 vcc, 1, v5
    s_nop 1
    v_cndmask_b32 v11, 0, v4, vcc
    v_cmp_eq_u32 vcc, 2, v5
    s_nop 1
    v_cndmask_b32 v12, 0, v4, vcc
    v_cmp_eq_u32 vcc, 3, v5
    s_nop 1
    v_cndmask_b32 v13, 0, v4, vcc
    buffer_load_dwordx4 v[24:27], v15, s[44:47], s86 offen offset:16
    buffer_load_dwordx4 v[40:43], v15, s[44:47], s86 offen offset:2064
    buffer_load_dwordx4 v[28:31], v15, s[44:47], s86 offen offset:32
    buffer_load_dwordx4 v[44:47], v15, s[44:47], s86 offen offset:2080
    buffer_load_dwordx4 v[32:35], v15, s[44:47], s86 offen offset:48
    buffer_load_dwordx4 v[48:51], v15, s[44:47], s86 offen offset:2096
    s_lshl_b32 s38, s61, 10
    s_add_u32 s36, s38, 65536
    s_lshl_b32 s38, s34, 8
    s_add_u32 s36, s38, s36
    v_mov_b32 v19, 0
    s_cmp_eq_u32 s33, 0
    s_cselect_b32 s38, s36, 8388608
    s_mov_b64 exec, 1
    buffer_store_dword v19, v19, s[48:51], s38 offen sc1
    s_mov_b64 exec, -1
    s_mov_b32 s80, 0x01000100
    s_mov_b32 s81, 0x03020302
    s_waitcnt vmcnt(13)
    buffer_load_dwordx4 a[160:163], v14, s[40:43], s63 offen nt
    s_add_u32 s63, s63, 8192
    v_perm_b32 v4, v20, v20, s80
    v_perm_b32 v5, v36, v36, s80
    v_and_b32 v52, v4, v10
    v_and_b32 v53, v4, v11
    v_and_b32 v54, v4, v12
    v_and_b32 v55, v4, v13
    v_and_b32 v56, v5, v10
    v_and_b32 v57, v5, v11
    v_and_b32 v58, v5, v12
    v_and_b32 v59, v5, v13
    v_mfma_f32_16x16x32_bf16 v[60:63], a[128:131], v[52:55], 0
    s_nop 0
    v_mfma_f32_16x16x32_bf16 v[64:67], a[128:131], v[56:59], 0
    buffer_load_dwordx4 a[164:167], v14, s[40:43], s63 offen nt
    s_add_u32 s63, s63, 8192
    v_perm_b32 v4, v20, v20, s81
    v_perm_b32 v5, v36, v36, s81
    v_and_b32 v52, v4, v10
    v_and_b32 v53, v4, v11
    v_and_b32 v54, v4, v12
    v_and_b32 v55, v4, v13
    v_and_b32 v56, v5, v10
    v_and_b32 v57, v5, v11
    v_and_b32 v58, v5, v12
    v_and_b32 v59, v5, v13
    v_mfma_f32_16x16x32_bf16 v[60:63], a[132:135], v[52:55], v[60:63]
    s_nop 0
    v_mfma_f32_16x16x32_bf16 v[64:67], a[132:135], v[56:59], v[64:67]
    s_waitcnt vmcnt(14)
    buffer_load_dwordx4 a[168:171], v14, s[40:43], s63 offen nt
    s_add_u32 s63, s63, 8192
    v_perm_b32 v4, v21, v21, s80
    v_perm_b32 v5, v37, v37, s80
    v_and_b32 v52, v4, v10
    v_and_b32 v53, v4, v11
    v_and_b32 v54, v4, v12
    v_and_b32 v55, v4, v13
    v_and_b32 v56, v5, v10
    v_and_b32 v57, v5, v11
    v_and_b32 v58, v5, v12
    v_and_b32 v59, v5, v13
    v_mfma_f32_16x16x32_bf16 v[60:63], a[136:139], v[52:55], v[60:63]
    s_nop 0
    v_mfma_f32_16x16x32_bf16 v[64:67], a[136:139], v[56:59], v[64:67]
    s_waitcnt vmcnt(14)
    buffer_load_dwordx4 a[172:175], v14, s[40:43], s63 offen nt
    s_add_u32 s63, s63, 8192
    v_perm_b32 v4, v21, v21, s81
    v_perm_b32 v5, v37, v37, s81
    v_and_b32 v52, v4, v10
    v_and_b32 v53, v4, v11
    v_and_b32 v54, v4, v12
    v_and_b32 v55, v4, v13
    v_and_b32 v56, v5, v10
    v_and_b32 v57, v5, v11
    v_and_b32 v58, v5, v12
    v_and_b32 v59, v5, v13
    v_mfma_f32_16x16x32_bf16 v[60:63], a[140:143], v[52:55], v[60:63]
    s_nop 0
    v_mfma_f32_16x16x32_bf16 v[64:67], a[140:143], v[56:59], v[64:67]
    s_waitcnt vmcnt(14)
    buffer_load_dwordx4 a[176:179], v14, s[40:43], s63 offen nt
    s_add_u32 s63, s63, 8192
    v_lshrrev_b32 v4, 2, v3
    v_and_b32 v5, 3, v3
    v_lshlrev_b32 v76, 8, v4
    v_lshlrev_b32 v126, 8, v2
    v_lshl_add_u32 v76, v2, 6, v76
    v_lshl_add_u32 v76, v5, 4, v76
    v_lshl_add_u32 v126, v3, 4, v126
    v_xor_b32 v77, 32768, v76
    v_xor_b32 v127, 32768, v126
    s_add_u32 s3, s34, s33
    s_and_b32 s3, s3, 3
    s_lshl_b32 s89, s3, 5
    s_add_u32 s89, s89, s32
    s_lshl_b32 s89, s89, 20
    s_mul_i32 s88, s32, 8
    s_add_u32 s88, s88, s3
    s_lshl_b32 s87, s33, 0
    v_perm_b32 v4, v22, v22, s80
    v_perm_b32 v5, v38, v38, s80
    v_and_b32 v52, v4, v10
    v_and_b32 v53, v4, v11
    v_and_b32 v54, v4, v12
    v_and_b32 v55, v4, v13
    v_and_b32 v56, v5, v10
    v_and_b32 v57, v5, v11
    v_and_b32 v58, v5, v12
    v_and_b32 v59, v5, v13
    v_mfma_f32_16x16x32_bf16 v[60:63], a[144:147], v[52:55], v[60:63]
    s_nop 0
    v_mfma_f32_16x16x32_bf16 v[64:67], a[144:147], v[56:59], v[64:67]
    s_waitcnt vmcnt(14)
    buffer_load_dwordx4 a[180:183], v14, s[40:43], s63 offen nt
    s_add_u32 s63, s63, 8192
    v_perm_b32 v4, v22, v22, s81
    v_perm_b32 v5, v38, v38, s81
    v_and_b32 v52, v4, v10
    v_and_b32 v53, v4, v11
    v_and_b32 v54, v4, v12
    v_and_b32 v55, v4, v13
    v_and_b32 v56, v5, v10
    v_and_b32 v57, v5, v11
    v_and_b32 v58, v5, v12
    v_and_b32 v59, v5, v13
    v_mfma_f32_16x16x32_bf16 v[60:63], a[148:151], v[52:55], v[60:63]
    s_nop 0
    v_mfma_f32_16x16x32_bf16 v[64:67], a[148:151], v[56:59], v[64:67]
    s_waitcnt vmcnt(14)
    buffer_load_dwordx4 a[184:187], v14, s[40:43], s63 offen nt
    s_add_u32 s63, s63, 8192
    v_perm_b32 v4, v23, v23, s80
    v_perm_b32 v5, v39, v39, s80
    v_and_b32 v52, v4, v10
    v_and_b32 v53, v4, v11
    v_and_b32 v54, v4, v12
    v_and_b32 v55, v4, v13
    v_and_b32 v56, v5, v10
    v_and_b32 v57, v5, v11
    v_and_b32 v58, v5, v12
    v_and_b32 v59, v5, v13
    v_mfma_f32_16x16x32_bf16 v[60:63], a[152:155], v[52:55], v[60:63]
    s_nop 0
    v_mfma_f32_16x16x32_bf16 v[64:67], a[152:155], v[56:59], v[64:67]
    s_waitcnt vmcnt(14)
    buffer_load_dwordx4 a[188:191], v14, s[40:43], s63 offen nt
    s_add_u32 s63, s63, 8192
    v_perm_b32 v4, v23, v23, s81
    v_perm_b32 v5, v39, v39, s81
    v_and_b32 v52, v4, v10
    v_and_b32 v53, v4, v11
    v_and_b32 v54, v4, v12
    v_and_b32 v55, v4, v13
    v_and_b32 v56, v5, v10
    v_and_b32 v57, v5, v11
    v_and_b32 v58, v5, v12
    v_and_b32 v59, v5, v13
    v_mfma_f32_16x16x32_bf16 v[60:63], a[156:159], v[52:55], v[60:63]
    s_nop 0
    v_mfma_f32_16x16x32_bf16 v[64:67], a[156:159], v[56:59], v[64:67]
    s_waitcnt vmcnt(13)
    s_waitcnt vmcnt(7)
    buffer_load_dwordx4 a[192:195], v14, s[40:43], s63 offen nt
    s_add_u32 s63, s63, 8192
    s_mov_b32 s52, s18
    s_and_b32 s53, s19, 0xffff
    s_mov_b32 s54, 134217728
    s_mov_b32 s55, 0x20000
    s_mov_b32 s56, s20
    s_and_b32 s57, s21, 0xffff
    s_mov_b32 s58, 134217728
    s_mov_b32 s59, 0x20000
    v_perm_b32 v4, v24, v24, s80
    v_perm_b32 v5, v40, v40, s80
    v_and_b32 v52, v4, v10
    v_and_b32 v53, v4, v11
    v_and_b32 v54, v4, v12
    v_and_b32 v55, v4, v13
    v_and_b32 v56, v5, v10
    v_and_b32 v57, v5, v11
    v_and_b32 v58, v5, v12
    v_and_b32 v59, v5, v13
    v_mfma_f32_16x16x32_bf16 v[60:63], a[160:163], v[52:55], v[60:63]
    s_nop 0
    v_mfma_f32_16x16x32_bf16 v[64:67], a[160:163], v[56:59], v[64:67]
    s_waitcnt vmcnt(7)
    buffer_load_dwordx4 a[196:199], v14, s[40:43], s63 offen nt
    s_add_u32 s63, s63, 8192
    v_perm_b32 v4, v24, v24, s81
    v_perm_b32 v5, v40, v40, s81
    v_and_b32 v52, v4, v10
    v_and_b32 v53, v4, v11
    v_and_b32 v54, v4, v12
    v_and_b32 v55, v4, v13
    v_and_b32 v56, v5, v10
    v_and_b32 v57, v5, v11
    v_and_b32 v58, v5, v12
    v_and_b32 v59, v5, v13
    v_mfma_f32_16x16x32_bf16 v[60:63], a[164:167], v[52:55], v[60:63]
    s_nop 0
    v_mfma_f32_16x16x32_bf16 v[64:67], a[164:167], v[56:59], v[64:67]
    s_waitcnt vmcnt(7)
    buffer_load_dwordx4 a[200:203], v14, s[40:43], s63 offen nt
    s_add_u32 s63, s63, 8192
    v_perm_b32 v4, v25, v25, s80
    v_perm_b32 v5, v41, v41, s80
    v_and_b32 v52, v4, v10
    v_and_b32 v53, v4, v11
    v_and_b32 v54, v4, v12
    v_and_b32 v55, v4, v13
    v_and_b32 v56, v5, v10
    v_and_b32 v57, v5, v11
    v_and_b32 v58, v5, v12
    v_and_b32 v59, v5, v13
    v_mfma_f32_16x16x32_bf16 v[60:63], a[168:171], v[52:55], v[60:63]
    s_nop 0
    v_mfma_f32_16x16x32_bf16 v[64:67], a[168:171], v[56:59], v[64:67]
    s_waitcnt vmcnt(7)
    buffer_load_dwordx4 a[204:207], v14, s[40:43], s63 offen nt
    s_add_u32 s63, s63, 8192
    v_perm_b32 v4, v25, v25, s81
    v_perm_b32 v5, v41, v41, s81
    v_and_b32 v52, v4, v10
    v_and_b32 v53, v4, v11
    v_and_b32 v54, v4, v12
    v_and_b32 v55, v4, v13
    v_and_b32 v56, v5, v10
    v_and_b32 v57, v5, v11
    v_and_b32 v58, v5, v12
    v_and_b32 v59, v5, v13
    v_mfma_f32_16x16x32_bf16 v[60:63], a[172:175], v[52:55], v[60:63]
    s_nop 0
    v_mfma_f32_16x16x32_bf16 v[64:67], a[172:175], v[56:59], v[64:67]
    s_waitcnt vmcnt(7)
    buffer_load_dwordx4 a[208:211], v14, s[40:43], s63 offen nt
    s_add_u32 s63, s63, 8192
    v_mov_b32 v120, 0xff7f0000
    v_mov_b32 v121, 0
    v_mov_b32 v18, 1
    v_mov_b32 v116, 0
    v_mov_b32 v117, 0
    v_mov_b32 v118, 0
    v_mov_b32 v119, 0
    s_lshl_b32 s38, s32, 10
    s_add_u32 s96, s38, 65536
    s_lshl_b32 s38, s3, 8
    s_add_u32 s96, s38, s96
    v_mov_b32 v9, s96
    s_lshl_b32 s38, s32, 15
    s_add_u32 s96, s38, 1048576
    s_lshl_b32 s38, s3, 13
    s_add_u32 s96, s38, s96
    s_lshl_b32 s38, s33, 10
    s_add_u32 s96, s38, s96
    v_and_b32 v5, 3, v3
    v_lshlrev_b32 v78, 7, v2
    v_lshl_add_u32 v78, v5, 5, v78
    s_lshl_b32 s38, s32, 12
    s_add_u32 s91, s38, 262144
    s_lshl_b32 s38, s3, 9
    s_add_u32 s91, s38, s91
    v_lshlrev_b32 v4, 7, v2
    v_lshl_add_u32 v4, v3, 4, v4
    v_mov_b32 v5, 512
    v_cmp_gt_u32 vcc, 8, v3
    s_nop 1
    v_cndmask_b32 v79, v5, v4, vcc
    v_perm_b32 v4, v26, v26, s80
    v_perm_b32 v5, v42, v42, s80
    v_and_b32 v52, v4, v10
    v_and_b32 v53, v4, v11
    v_and_b32 v54, v4, v12
    v_and_b32 v55, v4, v13
    v_and_b32 v56, v5, v10
    v_and_b32 v57, v5, v11
    v_and_b32 v58, v5, v12
    v_and_b32 v59, v5, v13
    v_mfma_f32_16x16x32_bf16 v[60:63], a[176:179], v[52:55], v[60:63]
    s_nop 0
    v_mfma_f32_16x16x32_bf16 v[64:67], a[176:179], v[56:59], v[64:67]
    s_waitcnt vmcnt(7)
    buffer_load_dwordx4 a[212:215], v14, s[40:43], s63 offen nt
    s_add_u32 s63, s63, 8192
    v_perm_b32 v4, v26, v26, s81
    v_perm_b32 v5, v42, v42, s81
    v_and_b32 v52, v4, v10
    v_and_b32 v53, v4, v11
    v_and_b32 v54, v4, v12
    v_and_b32 v55, v4, v13
    v_and_b32 v56, v5, v10
    v_and_b32 v57, v5, v11
    v_and_b32 v58, v5, v12
    v_and_b32 v59, v5, v13
    v_mfma_f32_16x16x32_bf16 v[60:63], a[180:183], v[52:55], v[60:63]
    s_nop 0
    v_mfma_f32_16x16x32_bf16 v[64:67], a[180:183], v[56:59], v[64:67]
    s_waitcnt vmcnt(7)
    buffer_load_dwordx4 a[216:219], v14, s[40:43], s63 offen nt
    s_add_u32 s63, s63, 8192
    v_perm_b32 v4, v27, v27, s80
    v_perm_b32 v5, v43, v43, s80
    v_and_b32 v52, v4, v10
    v_and_b32 v53, v4, v11
    v_and_b32 v54, v4, v12
    v_and_b32 v55, v4, v13
    v_and_b32 v56, v5, v10
    v_and_b32 v57, v5, v11
    v_and_b32 v58, v5, v12
    v_and_b32 v59, v5, v13
    v_mfma_f32_16x16x32_bf16 v[60:63], a[184:187], v[52:55], v[60:63]
    s_nop 0
    v_mfma_f32_16x16x32_bf16 v[64:67], a[184:187], v[56:59], v[64:67]
    s_waitcnt vmcnt(7)
    buffer_load_dwordx4 a[220:223], v14, s[40:43], s63 offen nt
    s_add_u32 s63, s63, 8192
    v_perm_b32 v4, v27, v27, s81
    v_perm_b32 v5, v43, v43, s81
    v_and_b32 v52, v4, v10
    v_and_b32 v53, v4, v11
    v_and_b32 v54, v4, v12
    v_and_b32 v55, v4, v13
    v_and_b32 v56, v5, v10
    v_and_b32 v57, v5, v11
    v_and_b32 v58, v5, v12
    v_and_b32 v59, v5, v13
    v_mfma_f32_16x16x32_bf16 v[60:63], a[188:191], v[52:55], v[60:63]
    s_nop 0
    v_mfma_f32_16x16x32_bf16 v[64:67], a[188:191], v[56:59], v[64:67]
    s_waitcnt vmcnt(7)
    buffer_load_dwordx4 a[224:227], v14, s[40:43], s63 offen nt
    s_add_u32 s63, s63, 8192
    v_perm_b32 v4, v28, v28, s80
    v_perm_b32 v5, v44, v44, s80
    v_and_b32 v52, v4, v10
    v_and_b32 v53, v4, v11
    v_and_b32 v54, v4, v12
    v_and_b32 v55, v4, v13
    v_and_b32 v56, v5, v10
    v_and_b32 v57, v5, v11
    v_and_b32 v58, v5, v12
    v_and_b32 v59, v5, v13
    v_mfma_f32_16x16x32_bf16 v[60:63], a[192:195], v[52:55], v[60:63]
    s_nop 0
    v_mfma_f32_16x16x32_bf16 v[64:67], a[192:195], v[56:59], v[64:67]
    s_waitcnt vmcnt(7)
    buffer_load_dwordx4 a[228:231], v14, s[40:43], s63 offen nt
    s_add_u32 s63, s63, 8192
    v_perm_b32 v4, v28, v28, s81
    v_perm_b32 v5, v44, v44, s81
    v_and_b32 v52, v4, v10
    v_and_b32 v53, v4, v11
    v_and_b32 v54, v4, v12
    v_and_b32 v55, v4, v13
    v_and_b32 v56, v5, v10
    v_and_b32 v57, v5, v11
    v_and_b32 v58, v5, v12
    v_and_b32 v59, v5, v13
    v_mfma_f32_16x16x32_bf16 v[60:63], a[196:199], v[52:55], v[60:63]
    s_nop 0
    v_mfma_f32_16x16x32_bf16 v[64:67], a[196:199], v[56:59], v[64:67]
    s_waitcnt vmcnt(7)
    buffer_load_dwordx4 a[232:235], v14, s[40:43], s63 offen nt
    s_add_u32 s63, s63, 8192
    v_perm_b32 v4, v29, v29, s80
    v_perm_b32 v5, v45, v45, s80
    v_and_b32 v52, v4, v10
    v_and_b32 v53, v4, v11
    v_and_b32 v54, v4, v12
    v_and_b32 v55, v4, v13
    v_and_b32 v56, v5, v10
    v_and_b32 v57, v5, v11
    v_and_b32 v58, v5, v12
    v_and_b32 v59, v5, v13
    v_mfma_f32_16x16x32_bf16 v[60:63], a[200:203], v[52:55], v[60:63]
    s_nop 0
    v_mfma_f32_16x16x32_bf16 v[64:67], a[200:203], v[56:59], v[64:67]
    s_waitcnt vmcnt(7)
    buffer_load_dwordx4 a[236:239], v14, s[40:43], s63 offen nt
    s_add_u32 s63, s63, 8192
    v_perm_b32 v4, v29, v29, s81
    v_perm_b32 v5, v45, v45, s81
    v_and_b32 v52, v4, v10
    v_and_b32 v53, v4, v11
    v_and_b32 v54, v4, v12
    v_and_b32 v55, v4, v13
    v_and_b32 v56, v5, v10
    v_and_b32 v57, v5, v11
    v_and_b32 v58, v5, v12
    v_and_b32 v59, v5, v13
    v_mfma_f32_16x16x32_bf16 v[60:63], a[204:207], v[52:55], v[60:63]
    s_nop 0
    v_mfma_f32_16x16x32_bf16 v[64:67], a[204:207], v[56:59], v[64:67]
    s_waitcnt vmcnt(7)
    buffer_load_dwordx4 a[240:243], v14, s[40:43], s63 offen nt
    s_add_u32 s63, s63, 8192
    v_perm_b32 v4, v30, v30, s80
    v_perm_b32 v5, v46, v46, s80
    v_and_b32 v52, v4, v10
    v_and_b32 v53, v4, v11
    v_and_b32 v54, v4, v12
    v_and_b32 v55, v4, v13
    v_and_b32 v56, v5, v10
    v_and_b32 v57, v5, v11
    v_and_b32 v58, v5, v12
    v_and_b32 v59, v5, v13
    v_mfma_f32_16x16x32_bf16 v[60:63], a[208:211], v[52:55], v[60:63]
    s_nop 0
    v_mfma_f32_16x16x32_bf16 v[64:67], a[208:211], v[56:59], v[64:67]
    s_waitcnt vmcnt(7)
    buffer_load_dwordx4 a[244:247], v14, s[40:43], s63 offen nt
    s_add_u32 s63, s63, 8192
    v_perm_b32 v4, v30, v30, s81
    v_perm_b32 v5, v46, v46, s81
    v_and_b32 v52, v4, v10
    v_and_b32 v53, v4, v11
    v_and_b32 v54, v4, v12
    v_and_b32 v55, v4, v13
    v_and_b32 v56, v5, v10
    v_and_b32 v57, v5, v11
    v_and_b32 v58, v5, v12
    v_and_b32 v59, v5, v13
    v_mfma_f32_16x16x32_bf16 v[60:63], a[212:215], v[52:55], v[60:63]
    s_nop 0
    v_mfma_f32_16x16x32_bf16 v[64:67], a[212:215], v[56:59], v[64:67]
    s_waitcnt vmcnt(7)
    buffer_load_dwordx4 a[248:251], v14, s[40:43], s63 offen nt
    s_add_u32 s63, s63, 8192
    v_perm_b32 v4, v31, v31, s80
    v_perm_b32 v5, v47, v47, s80
    v_and_b32 v52, v4, v10
    v_and_b32 v53, v4, v11
    v_and_b32 v54, v4, v12
    v_and_b32 v55, v4, v13
    v_and_b32 v56, v5, v10
    v_and_b32 v57, v5, v11
    v_and_b32 v58, v5, v12
    v_and_b32 v59, v5, v13
    v_mfma_f32_16x16x32_bf16 v[60:63], a[216:219], v[52:55], v[60:63]
    s_nop 0
    v_mfma_f32_16x16x32_bf16 v[64:67], a[216:219], v[56:59], v[64:67]
    s_waitcnt vmcnt(7)
    buffer_load_dwordx4 a[252:255], v14, s[40:43], s63 offen nt
    s_add_u32 s63, s63, 8192
    v_perm_b32 v4, v31, v31, s81
    v_perm_b32 v5, v47, v47, s81
    v_and_b32 v52, v4, v10
    v_and_b32 v53, v4, v11
    v_and_b32 v54, v4, v12
    v_and_b32 v55, v4, v13
    v_and_b32 v56, v5, v10
    v_and_b32 v57, v5, v11
    v_and_b32 v58, v5, v12
    v_and_b32 v59, v5, v13
    v_mfma_f32_16x16x32_bf16 v[60:63], a[220:223], v[52:55], v[60:63]
    s_nop 0
    v_mfma_f32_16x16x32_bf16 v[64:67], a[220:223], v[56:59], v[64:67]
    s_waitcnt vmcnt(7)
    v_perm_b32 v4, v32, v32, s80
    v_perm_b32 v5, v48, v48, s80
    v_and_b32 v52, v4, v10
    v_and_b32 v53, v4, v11
    v_and_b32 v54, v4, v12
    v_and_b32 v55, v4, v13
    v_and_b32 v56, v5, v10
    v_and_b32 v57, v5, v11
    v_and_b32 v58, v5, v12
    v_and_b32 v59, v5, v13
    v_mfma_f32_16x16x32_bf16 v[60:63], a[224:227], v[52:55], v[60:63]
    s_nop 0
    v_mfma_f32_16x16x32_bf16 v[64:67], a[224:227], v[56:59], v[64:67]
    s_waitcnt vmcnt(6)
    s_add_u32 s39, s87, s88
    s_bfe_u32 s37, s39, 0x30000
    s_lshl_b32 s37, s37, 12
    s_add_u32 s85, s37, s89
    s_bfe_u32 s37, s39, 0x10003
    s_lshl_b32 s37, s37, 11
    s_add_u32 s85, s37, s85
    s_bfe_u32 s37, s39, 0x40004
    s_lshl_b32 s37, s37, 16
    s_add_u32 s85, s37, s85
    buffer_load_dwordx4 v[128:131], v76, s[52:55], s85 offen offset:0 nt
    v_perm_b32 v4, v32, v32, s81
    v_perm_b32 v5, v48, v48, s81
    v_and_b32 v52, v4, v10
    v_and_b32 v53, v4, v11
    v_and_b32 v54, v4, v12
    v_and_b32 v55, v4, v13
    v_and_b32 v56, v5, v10
    v_and_b32 v57, v5, v11
    v_and_b32 v58, v5, v12
    v_and_b32 v59, v5, v13
    v_mfma_f32_16x16x32_bf16 v[60:63], a[228:231], v[52:55], v[60:63]
    s_nop 0
    v_mfma_f32_16x16x32_bf16 v[64:67], a[228:231], v[56:59], v[64:67]
    s_waitcnt vmcnt(6)
    buffer_load_dwordx4 v[132:135], v77, s[52:55], s85 offen offset:0 nt
    v_perm_b32 v4, v33, v33, s80
    v_perm_b32 v5, v49, v49, s80
    v_and_b32 v52, v4, v10
    v_and_b32 v53, v4, v11
    v_and_b32 v54, v4, v12
    v_and_b32 v55, v4, v13
    v_and_b32 v56, v5, v10
    v_and_b32 v57, v5, v11
    v_and_b32 v58, v5, v12
    v_and_b32 v59, v5, v13
    v_mfma_f32_16x16x32_bf16 v[60:63], a[232:235], v[52:55], v[60:63]
    s_nop 0
    v_mfma_f32_16x16x32_bf16 v[64:67], a[232:235], v[56:59], v[64:67]
    s_waitcnt vmcnt(6)
    buffer_load_dwordx4 v[136:139], v76, s[52:55], s85 offen offset:1024 nt
    v_perm_b32 v4, v33, v33, s81
    v_perm_b32 v5, v49, v49, s81
    v_and_b32 v52, v4, v10
    v_and_b32 v53, v4, v11
    v_and_b32 v54, v4, v12
    v_and_b32 v55, v4, v13
    v_and_b32 v56, v5, v10
    v_and_b32 v57, v5, v11
    v_and_b32 v58, v5, v12
    v_and_b32 v59, v5, v13
    v_mfma_f32_16x16x32_bf16 v[60:63], a[236:239], v[52:55], v[60:63]
    s_nop 0
    v_mfma_f32_16x16x32_bf16 v[64:67], a[236:239], v[56:59], v[64:67]
    s_waitcnt vmcnt(6)
    buffer_load_dwordx4 v[140:143], v77, s[52:55], s85 offen offset:1024 nt
    s_add_u32 s87, s87, 7
    s_add_u32 s39, s87, s88
    s_bfe_u32 s37, s39, 0x30000
    s_lshl_b32 s37, s37, 12
    s_add_u32 s85, s37, s89
    s_bfe_u32 s37, s39, 0x10003
    s_lshl_b32 s37, s37, 11
    s_add_u32 s85, s37, s85
    s_bfe_u32 s37, s39, 0x40004
    s_lshl_b32 s37, s37, 16
    s_add_u32 s85, s37, s85
    v_perm_b32 v4, v34, v34, s80
    v_perm_b32 v5, v50, v50, s80
    v_and_b32 v52, v4, v10
    v_and_b32 v53, v4, v11
    v_and_b32 v54, v4, v12
    v_and_b32 v55, v4, v13
    v_and_b32 v56, v5, v10
    v_and_b32 v57, v5, v11
    v_and_b32 v58, v5, v12
    v_and_b32 v59, v5, v13
    v_mfma_f32_16x16x32_bf16 v[60:63], a[240:243], v[52:55], v[60:63]
    s_nop 0
    v_mfma_f32_16x16x32_bf16 v[64:67], a[240:243], v[56:59], v[64:67]
    s_waitcnt vmcnt(6)
    buffer_load_dwordx4 v[144:147], v76, s[52:55], s85 offen offset:0 nt
    v_perm_b32 v4, v34, v34, s81
    v_perm_b32 v5, v50, v50, s81
    v_and_b32 v52, v4, v10
    v_and_b32 v53, v4, v11
    v_and_b32 v54, v4, v12
    v_and_b32 v55, v4, v13
    v_and_b32 v56, v5, v10
    v_and_b32 v57, v5, v11
    v_and_b32 v58, v5, v12
    v_and_b32 v59, v5, v13
    v_mfma_f32_16x16x32_bf16 v[60:63], a[244:247], v[52:55], v[60:63]
    s_nop 0
    v_mfma_f32_16x16x32_bf16 v[64:67], a[244:247], v[56:59], v[64:67]
    s_waitcnt vmcnt(6)
    buffer_load_dwordx4 v[148:151], v77, s[52:55], s85 offen offset:0 nt
    v_perm_b32 v4, v35, v35, s80
    v_perm_b32 v5, v51, v51, s80
    v_and_b32 v52, v4, v10
    v_and_b32 v53, v4, v11
    v_and_b32 v54, v4, v12
    v_and_b32 v55, v4, v13
    v_and_b32 v56, v5, v10
    v_and_b32 v57, v5, v11
    v_and_b32 v58, v5, v12
    v_and_b32 v59, v5, v13
    v_mfma_f32_16x16x32_bf16 v[60:63], a[248:251], v[52:55], v[60:63]
    s_nop 0
    v_mfma_f32_16x16x32_bf16 v[64:67], a[248:251], v[56:59], v[64:67]
    s_waitcnt vmcnt(6)
    buffer_load_dwordx4 v[152:155], v76, s[52:55], s85 offen offset:1024 nt
    v_perm_b32 v4, v35, v35, s81
    v_perm_b32 v5, v51, v51, s81
    v_and_b32 v52, v4, v10
    v_and_b32 v53, v4, v11
    v_and_b32 v54, v4, v12
    v_and_b32 v55, v4, v13
    v_and_b32 v56, v5, v10
    v_and_b32 v57, v5, v11
    v_and_b32 v58, v5, v12
    v_and_b32 v59, v5, v13
    v_mfma_f32_16x16x32_bf16 v[60:63], a[252:255], v[52:55], v[60:63]
    s_nop 0
    v_mfma_f32_16x16x32_bf16 v[64:67], a[252:255], v[56:59], v[64:67]
    s_lshl_b32 s38, s34, 11
    v_lshrrev_b32 v4, 3, v3
    v_lshlrev_b32 v4, 9, v4
    v_lshl_add_u32 v4, v2, 7, v4
    v_and_b32 v5, 7, v3
    v_lshl_add_u32 v4, v5, 2, v4
    v_add_u32 v4, s38, v4
    ds_write_b32 v4, v60 offset:0
    ds_write_b32 v4, v61 offset:32
    ds_write_b32 v4, v62 offset:64
    ds_write_b32 v4, v63 offset:96
    ds_write_b32 v4, v64 offset:1024
    ds_write_b32 v4, v65 offset:1056
    ds_write_b32 v4, v66 offset:1088
    ds_write_b32 v4, v67 offset:1120
    s_lshl_b32 s38, s34, 9
    v_and_b32 v5, 31, v1
    v_lshl_add_u32 v5, v5, 4, s38
    s_waitcnt lgkmcnt(0)
    s_add_u32 s35, s35, 0x5b
    s_and_b32 s35, s35, 0xff
    v_mov_b32 v8, s35
    s_barrier
    ds_read_b128 v[20:23], v5 offset:0
    ds_read_b128 v[24:27], v5 offset:2048
    ds_read_b128 v[28:31], v5 offset:4096
    ds_read_b128 v[32:35], v5 offset:6144
    s_lshl_b32 s38, s61, 12
    s_add_u32 s36, s38, 262144
    s_lshl_b32 s38, s33, 11
    s_add_u32 s36, s38, s36
    s_waitcnt lgkmcnt(0)
    v_add_f32 v20, v20, v24
    v_add_f32 v28, v28, v32
    v_add_f32 v21, v21, v25
    v_add_f32 v29, v29, v33
    v_add_f32 v22, v22, v26
    v_add_f32 v30, v30, v34
    v_add_f32 v23, v23, v27
    v_add_f32 v31, v31, v35
    v_add_f32 v20, v20, v28
    v_add_f32 v21, v21, v29
    v_add_f32 v22, v22, v30
    v_add_f32 v23, v23, v31
    s_mov_b32 s38, 0xffff0000
    v_cvt_pk_bf16_f32 v20, v20, v20
    v_cvt_pk_bf16_f32 v21, v21, v21
    v_cvt_pk_bf16_f32 v22, v22, v22
    v_cvt_pk_bf16_f32 v23, v23, v23
    v_and_or_b32 v20, v20, s38, v8
    v_and_or_b32 v21, v21, s38, v8
    v_and_or_b32 v22, v22, s38, v8
    v_and_or_b32 v23, v23, s38, v8
    s_mov_b32 exec_lo, 0xffffffff
    s_mov_b32 exec_hi, 0x0
    buffer_store_dwordx4 v[20:23], v5, s[48:51], s36 offen sc1
    s_mov_b64 exec, -1
    s_waitcnt vmcnt(7)
    buffer_load_dwordx4 v[156:159], v77, s[52:55], s85 offen offset:1024 nt
    s_add_u32 s87, s87, 7
    s_add_u32 s39, s87, s88
    s_bfe_u32 s37, s39, 0x30000
    s_lshl_b32 s37, s37, 12
    s_add_u32 s85, s37, s89
    s_bfe_u32 s37, s39, 0x10003
    s_lshl_b32 s37, s37, 11
    s_add_u32 s85, s37, s85
    s_bfe_u32 s37, s39, 0x40004
    s_lshl_b32 s37, s37, 16
    s_add_u32 s85, s37, s85
    s_waitcnt vmcnt(7)
    buffer_load_dwordx4 v[160:163], v76, s[52:55], s85 offen offset:0 nt
    s_waitcnt vmcnt(7)
    buffer_load_dwordx4 v[164:167], v77, s[52:55], s85 offen offset:0 nt
    s_waitcnt vmcnt(7)
    buffer_load_dwordx4 v[168:171], v76, s[52:55], s85 offen offset:1024 nt
    s_waitcnt vmcnt(7)
    buffer_load_dwordx4 v[172:175], v77, s[52:55], s85 offen offset:1024 nt
    s_add_u32 s87, s87, 7
    s_add_u32 s39, s87, s88
    s_bfe_u32 s37, s39, 0x30000
    s_lshl_b32 s37, s37, 12
    s_add_u32 s85, s37, s89
    s_bfe_u32 s37, s39, 0x10003
    s_lshl_b32 s37, s37, 11
    s_add_u32 s85, s37, s85
    s_bfe_u32 s37, s39, 0x40004
    s_lshl_b32 s37, s37, 16
    s_add_u32 s85, s37, s85
    s_waitcnt vmcnt(7)
    buffer_load_dwordx4 v[176:179], v76, s[52:55], s85 offen offset:0 nt
    s_waitcnt vmcnt(7)
    buffer_load_dwordx4 v[180:183], v77, s[52:55], s85 offen offset:0 nt
    s_waitcnt vmcnt(6)
    buffer_load_dwordx4 v[184:187], v76, s[52:55], s85 offen offset:1024 nt
    s_waitcnt vmcnt(6)
    buffer_load_dwordx4 v[188:191], v77, s[52:55], s85 offen offset:1024 nt
    s_add_u32 s87, s87, 7
    s_add_u32 s39, s87, s88
    s_bfe_u32 s37, s39, 0x30000
    s_lshl_b32 s37, s37, 12
    s_add_u32 s85, s37, s89
    s_bfe_u32 s37, s39, 0x10003
    s_lshl_b32 s37, s37, 11
    s_add_u32 s85, s37, s85
    s_bfe_u32 s37, s39, 0x40004
    s_lshl_b32 s37, s37, 16
    s_add_u32 s85, s37, s85
    s_waitcnt vmcnt(6)
    buffer_load_dwordx4 v[192:195], v76, s[52:55], s85 offen offset:0 nt
    s_waitcnt vmcnt(6)
    buffer_load_dwordx4 v[196:199], v77, s[52:55], s85 offen offset:0 nt
    s_waitcnt vmcnt(6)
    buffer_load_dwordx4 v[200:203], v76, s[52:55], s85 offen offset:1024 nt
    s_waitcnt vmcnt(6)
    buffer_load_dwordx4 v[204:207], v77, s[52:55], s85 offen offset:1024 nt
    s_add_u32 s87, s87, 7
    s_add_u32 s39, s87, s88
    s_bfe_u32 s37, s39, 0x30000
    s_lshl_b32 s37, s37, 12
    s_add_u32 s85, s37, s89
    s_bfe_u32 s37, s39, 0x10003
    s_lshl_b32 s37, s37, 11
    s_add_u32 s85, s37, s85
    s_bfe_u32 s37, s39, 0x40004
    s_lshl_b32 s37, s37, 16
    s_add_u32 s85, s37, s85
    s_waitcnt vmcnt(6)
    buffer_load_dwordx4 v[208:211], v76, s[52:55], s85 offen offset:0 nt
    s_waitcnt vmcnt(6)
    buffer_load_dwordx4 v[212:215], v77, s[52:55], s85 offen offset:0 nt
    s_waitcnt vmcnt(6)
    buffer_load_dwordx4 v[216:219], v76, s[52:55], s85 offen offset:1024 nt
    s_waitcnt vmcnt(6)
    buffer_load_dwordx4 v[220:223], v77, s[52:55], s85 offen offset:1024 nt
    s_add_u32 s87, s87, 7
    s_add_u32 s39, s87, s88
    s_bfe_u32 s37, s39, 0x30000
    s_lshl_b32 s37, s37, 12
    s_add_u32 s85, s37, s89
    s_bfe_u32 s37, s39, 0x10003
    s_lshl_b32 s37, s37, 11
    s_add_u32 s85, s37, s85
    s_bfe_u32 s37, s39, 0x40004
    s_lshl_b32 s37, s37, 16
    s_add_u32 s85, s37, s85
    s_waitcnt vmcnt(6)
    buffer_load_dwordx4 v[224:227], v76, s[52:55], s85 offen offset:0 nt
    s_waitcnt vmcnt(6)
    buffer_load_dwordx4 v[228:231], v77, s[52:55], s85 offen offset:0 nt
    s_waitcnt vmcnt(6)
    buffer_load_dwordx4 v[232:235], v76, s[52:55], s85 offen offset:1024 nt
    s_waitcnt vmcnt(6)
    buffer_load_dwordx4 v[236:239], v77, s[52:55], s85 offen offset:1024 nt
    s_add_u32 s87, s87, 7
    s_add_u32 s39, s87, s88
    s_bfe_u32 s37, s39, 0x30000
    s_lshl_b32 s37, s37, 12
    s_add_u32 s85, s37, s89
    s_bfe_u32 s37, s39, 0x10003
    s_lshl_b32 s37, s37, 11
    s_add_u32 s85, s37, s85
    s_bfe_u32 s37, s39, 0x40004
    s_lshl_b32 s37, s37, 16
    s_add_u32 s85, s37, s85
    s_waitcnt vmcnt(6)
    buffer_load_dwordx4 v[240:243], v76, s[52:55], s85 offen offset:0 nt
    s_waitcnt vmcnt(6)
    buffer_load_dwordx4 v[244:247], v77, s[52:55], s85 offen offset:0 nt
    s_waitcnt vmcnt(6)
    buffer_load_dwordx4 v[248:251], v76, s[52:55], s85 offen offset:1024 nt
    s_waitcnt vmcnt(6)
    buffer_load_dwordx4 v[252:255], v77, s[52:55], s85 offen offset:1024 nt
    s_add_u32 s87, s87, 7
    s_add_u32 s39, s87, s88
    s_bfe_u32 s37, s39, 0x30000
    s_lshl_b32 s37, s37, 12
    s_add_u32 s85, s37, s89
    s_bfe_u32 s37, s39, 0x10003
    s_lshl_b32 s37, s37, 11
    s_add_u32 s85, s37, s85
    s_bfe_u32 s37, s39, 0x40004
    s_lshl_b32 s37, s37, 16
    s_add_u32 s85, s37, s85
    s_waitcnt vmcnt(6)
    buffer_load_dwordx4 a[0:3], v76, s[52:55], s85 offen offset:0 nt
    s_waitcnt vmcnt(6)
    buffer_load_dwordx4 a[4:7], v77, s[52:55], s85 offen offset:0 nt
    s_waitcnt vmcnt(6)
    buffer_load_dwordx4 a[8:11], v76, s[52:55], s85 offen offset:1024 nt
    s_waitcnt vmcnt(6)
    buffer_load_dwordx4 a[12:15], v77, s[52:55], s85 offen offset:1024 nt
    s_add_u32 s87, s87, 7
    s_add_u32 s39, s87, s88
    s_bfe_u32 s37, s39, 0x30000
    s_lshl_b32 s37, s37, 12
    s_add_u32 s85, s37, s89
    s_bfe_u32 s37, s39, 0x10003
    s_lshl_b32 s37, s37, 11
    s_add_u32 s85, s37, s85
    s_bfe_u32 s37, s39, 0x40004
    s_lshl_b32 s37, s37, 16
    s_add_u32 s85, s37, s85
    s_waitcnt vmcnt(6)
    buffer_load_dwordx4 a[16:19], v76, s[52:55], s85 offen offset:0 nt
    s_waitcnt vmcnt(6)
    buffer_load_dwordx4 a[20:23], v77, s[52:55], s85 offen offset:0 nt
    s_waitcnt vmcnt(6)
    buffer_load_dwordx4 a[24:27], v76, s[52:55], s85 offen offset:1024 nt
    s_waitcnt vmcnt(6)
    buffer_load_dwordx4 a[28:31], v77, s[52:55], s85 offen offset:1024 nt
    s_add_u32 s87, s87, 7
    s_add_u32 s39, s87, s88
    s_bfe_u32 s37, s39, 0x30000
    s_lshl_b32 s37, s37, 12
    s_add_u32 s85, s37, s89
    s_bfe_u32 s37, s39, 0x10003
    s_lshl_b32 s37, s37, 11
    s_add_u32 s85, s37, s85
    s_bfe_u32 s37, s39, 0x40004
    s_lshl_b32 s37, s37, 16
    s_add_u32 s85, s37, s85
    s_waitcnt vmcnt(6)
    buffer_load_dwordx4 a[32:35], v76, s[52:55], s85 offen offset:0 nt
    s_waitcnt vmcnt(6)
    buffer_load_dwordx4 a[36:39], v77, s[52:55], s85 offen offset:0 nt
    s_waitcnt vmcnt(6)
    buffer_load_dwordx4 a[40:43], v76, s[52:55], s85 offen offset:1024 nt
    s_waitcnt vmcnt(6)
    buffer_load_dwordx4 a[44:47], v77, s[52:55], s85 offen offset:1024 nt
    s_add_u32 s87, s87, 7
    s_add_u32 s39, s87, s88
    s_bfe_u32 s37, s39, 0x30000
    s_lshl_b32 s37, s37, 12
    s_add_u32 s85, s37, s89
    s_bfe_u32 s37, s39, 0x10003
    s_lshl_b32 s37, s37, 11
    s_add_u32 s85, s37, s85
    s_bfe_u32 s37, s39, 0x40004
    s_lshl_b32 s37, s37, 16
    s_add_u32 s85, s37, s85
    s_waitcnt vmcnt(6)
    buffer_load_dwordx4 a[48:51], v76, s[52:55], s85 offen offset:0 nt
    s_waitcnt vmcnt(6)
    buffer_load_dwordx4 a[52:55], v77, s[52:55], s85 offen offset:0 nt
    buffer_load_dwordx4 v[68:71], v78, s[48:51], s91 offen offset:0 sc1
    buffer_load_dwordx4 v[72:75], v78, s[48:51], s91 offen offset:16 sc1
    s_waitcnt vmcnt(8)
    buffer_load_dwordx4 a[56:59], v76, s[52:55], s85 offen offset:1024 nt
    s_waitcnt vmcnt(8)
    buffer_load_dwordx4 a[60:63], v77, s[52:55], s85 offen offset:1024 nt
    s_add_u32 s87, s87, 7
    s_add_u32 s39, s87, s88
    s_bfe_u32 s37, s39, 0x30000
    s_lshl_b32 s37, s37, 12
    s_add_u32 s85, s37, s89
    s_bfe_u32 s37, s39, 0x10003
    s_lshl_b32 s37, s37, 11
    s_add_u32 s85, s37, s85
    s_bfe_u32 s37, s39, 0x40004
    s_lshl_b32 s37, s37, 16
    s_add_u32 s85, s37, s85
    s_waitcnt vmcnt(8)
    buffer_load_dwordx4 a[64:67], v76, s[52:55], s85 offen offset:0 nt
    s_waitcnt vmcnt(8)
    buffer_load_dwordx4 a[68:71], v77, s[52:55], s85 offen offset:0 nt
    s_waitcnt vmcnt(8)
    buffer_load_dwordx4 a[72:75], v76, s[52:55], s85 offen offset:1024 nt
    s_waitcnt vmcnt(8)
    buffer_load_dwordx4 a[76:79], v77, s[52:55], s85 offen offset:1024 nt
    s_add_u32 s87, s87, 7
    s_add_u32 s39, s87, s88
    s_bfe_u32 s37, s39, 0x30000
    s_lshl_b32 s37, s37, 12
    s_add_u32 s85, s37, s89
    s_bfe_u32 s37, s39, 0x10003
    s_lshl_b32 s37, s37, 11
    s_add_u32 s85, s37, s85
    s_bfe_u32 s37, s39, 0x40004
    s_lshl_b32 s37, s37, 16
    s_add_u32 s85, s37, s85
    s_waitcnt vmcnt(6)
L_qcheck_12:
    v_xor_b32 v68, s35, v68
    v_xor_b32 v69, s35, v69
    v_xor_b32 v70, s35, v70
    v_xor_b32 v71, s35, v71
    v_xor_b32 v72, s35, v72
    v_xor_b32 v73, s35, v73
    v_xor_b32 v74, s35, v74
    v_xor_b32 v75, s35, v75
    v_or_b32 v4, v68, v69
    v_or3_b32 v4, v4, v70, v71
    v_or3_b32 v4, v4, v72, v73
    v_or3_b32 v4, v4, v74, v75
    v_and_b32 v4, 0xff, v4
    v_cmp_ne_u32 vcc, 0, v4
    s_cbranch_vccz L_qok_13
    buffer_load_dwordx4 v[68:71], v78, s[48:51], s91 offen offset:0 sc1
    buffer_load_dwordx4 v[72:75], v78, s[48:51], s91 offen offset:16 sc1
    s_waitcnt vmcnt(0)
    s_sub_u32 s84, s84, 1
    s_cmp_lg_u32 s84, 0
    s_cbranch_scc1 L_qcheck_12
    s_branch L_end
L_qok_13:
    v_cvt_pk_bf16_f32 v68, v68, v69
    v_cvt_pk_bf16_f32 v69, v70, v71
    v_cvt_pk_bf16_f32 v70, v72, v73
    v_cvt_pk_bf16_f32 v71, v74, v75
    s_mov_b32 vcc_lo, 0xf000f
    s_mov_b32 vcc_hi, 0xf000f
    v_cndmask_b32 v80, 0, v68, vcc
    v_cndmask_b32 v81, 0, v69, vcc
    v_cndmask_b32 v82, 0, v70, vcc
    v_cndmask_b32 v83, 0, v71, vcc
    s_mov_b32 vcc_lo, 0xf000f0
    s_mov_b32 vcc_hi, 0xf000f0
    v_cndmask_b32 v84, 0, v68, vcc
    v_cndmask_b32 v85, 0, v69, vcc
    v_cndmask_b32 v86, 0, v70, vcc
    v_cndmask_b32 v87, 0, v71, vcc
    s_mov_b32 vcc_lo, 0xf000f00
    s_mov_b32 vcc_hi, 0xf000f00
    v_cndmask_b32 v88, 0, v68, vcc
    v_cndmask_b32 v89, 0, v69, vcc
    v_cndmask_b32 v90, 0, v70, vcc
    v_cndmask_b32 v91, 0, v71, vcc
    s_mov_b32 vcc_lo, 0xf000f000
    s_mov_b32 vcc_hi, 0xf000f000
    v_cndmask_b32 v92, 0, v68, vcc
    v_cndmask_b32 v93, 0, v69, vcc
    v_cndmask_b32 v94, 0, v70, vcc
    v_cndmask_b32 v95, 0, v71, vcc
    s_getreg_b32 s70, hwreg(HW_REG_XCC_ID, 0, 4)
    s_lshl_b32 s70, s70, 8
    s_or_b32 s70, s70, s35
    s_or_b32 s70, s70, 0x5e9d0000
    s_bfe_u32 s38, s2, 0x30000
    s_lshl_b32 s38, s38, 8
    s_add_u32 s69, s38, 32768
    s_lshl_b32 s38, s32, 2
    s_add_u32 s69, s38, s69
    s_lshl_b32 s38, s34, 24
    s_add_u32 s69, s38, s69
    v_mov_b32 v72, s69
    v_mov_b32 v73, s70
    s_mov_b64 exec, 1
    buffer_store_dword v73, v72, s[48:51], 0 offen sc1
    s_mov_b64 exec, -1
    v_mov_b32 v65, 0xff7f0000
    s_lshl_b32 s38, s34, 14
    s_add_u32 s38, s38, 16384
    v_lshl_add_u32 v64, v1, 2, s38
    buffer_load_dwordx4 a[80:83], v76, s[52:55], s85 offen offset:0 nt
    v_mfma_f32_16x16x32_bf16 v[112:115], v[128:131], v[80:83], 0
    v_mfma_f32_16x16x32_bf16 v[112:115], v[132:135], v[84:87], v[112:115]
    v_mfma_f32_16x16x32_bf16 v[112:115], v[136:139], v[88:91], v[112:115]
    s_waitcnt vmcnt(7)
    buffer_load_dwordx4 a[84:87], v77, s[52:55], s85 offen offset:0 nt
    v_mfma_f32_16x16x32_bf16 v[112:115], v[140:143], v[92:95], v[112:115]
    v_mfma_f32_16x16x32_bf16 v[96:99], v[144:147], v[80:83], 0
    v_mfma_f32_16x16x32_bf16 v[96:99], v[148:151], v[84:87], v[96:99]
    v_mfma_f32_16x16x32_bf16 v[96:99], v[152:155], v[88:91], v[96:99]
    s_nop 4
    v_mov_b32_dpp v122, v112 quad_perm:[0,0,0,0] row_mask:0xf bank_mask:0xf
    v_mov_b32_dpp v124, v114 quad_perm:[2,2,2,2] row_mask:0xf bank_mask:0xf
    s_nop 0
    v_add_f32_dpp v122, v113, v122 quad_perm:[1,1,1,1] row_mask:0xf bank_mask:0xf
    v_add_f32_dpp v124, v115, v124 quad_perm:[3,3,3,3] row_mask:0xf bank_mask:0xf
    v_add_f32 v122, v122, v124
    v_max_f32 v65, v65, v122
    ds_write_b32 v64, v122 offset:0
    s_waitcnt vmcnt(7)
    buffer_load_dwordx4 a[88:91], v76, s[52:55], s85 offen offset:1024 nt
    v_mfma_f32_16x16x32_bf16 v[96:99], v[156:159], v[92:95], v[96:99]
    v_mfma_f32_16x16x32_bf16 v[112:115], v[160:163], v[80:83], 0
    v_mfma_f32_16x16x32_bf16 v[112:115], v[164:167], v[84:87], v[112:115]
    s_waitcnt vmcnt(7)
    buffer_load_dwordx4 a[92:95], v77, s[52:55], s85 offen offset:1024 nt
    s_add_u32 s87, s87, 7
    s_add_u32 s39, s87, s88
    s_bfe_u32 s37, s39, 0x30000
    s_lshl_b32 s37, s37, 12
    s_add_u32 s85, s37, s89
    s_bfe_u32 s37, s39, 0x10003
    s_lshl_b32 s37, s37, 11
    s_add_u32 s85, s37, s85
    s_bfe_u32 s37, s39, 0x40004
    s_lshl_b32 s37, s37, 16
    s_add_u32 s85, s37, s85
    v_mfma_f32_16x16x32_bf16 v[112:115], v[168:171], v[88:91], v[112:115]
    v_mov_b32_dpp v122, v96 quad_perm:[0,0,0,0] row_mask:0xf bank_mask:0xf
    v_mov_b32_dpp v124, v98 quad_perm:[2,2,2,2] row_mask:0xf bank_mask:0xf
    s_nop 0
    v_add_f32_dpp v122, v97, v122 quad_perm:[1,1,1,1] row_mask:0xf bank_mask:0xf
    v_add_f32_dpp v124, v99, v124 quad_perm:[3,3,3,3] row_mask:0xf bank_mask:0xf
    v_add_f32 v122, v122, v124
    v_max_f32 v65, v65, v122
    ds_write_b32 v64, v122 offset:256
    v_mfma_f32_16x16x32_bf16 v[112:115], v[172:175], v[92:95], v[112:115]
    v_mfma_f32_16x16x32_bf16 v[96:99], v[176:179], v[80:83], 0
    v_mfma_f32_16x16x32_bf16 v[96:99], v[180:183], v[84:87], v[96:99]
    s_waitcnt vmcnt(7)
    buffer_load_dwordx4 a[96:99], v76, s[52:55], s85 offen offset:0 nt
    v_mfma_f32_16x16x32_bf16 v[96:99], v[184:187], v[88:91], v[96:99]
    s_nop 2
    v_mov_b32_dpp v122, v112 quad_perm:[0,0,0,0] row_mask:0xf bank_mask:0xf
    v_mov_b32_dpp v124, v114 quad_perm:[2,2,2,2] row_mask:0xf bank_mask:0xf
    s_nop 0
    v_add_f32_dpp v122, v113, v122 quad_perm:[1,1,1,1] row_mask:0xf bank_mask:0xf
    v_add_f32_dpp v124, v115, v124 quad_perm:[3,3,3,3] row_mask:0xf bank_mask:0xf
    v_add_f32 v122, v122, v124
    v_max_f32 v65, v65, v122
    ds_write_b32 v64, v122 offset:512
    v_mfma_f32_16x16x32_bf16 v[96:99], v[188:191], v[92:95], v[96:99]
    v_mfma_f32_16x16x32_bf16 v[112:115], v[192:195], v[80:83], 0
    s_waitcnt vmcnt(7)
    buffer_load_dwordx4 a[100:103], v77, s[52:55], s85 offen offset:0 nt
    v_mfma_f32_16x16x32_bf16 v[112:115], v[196:199], v[84:87], v[112:115]
    v_mfma_f32_16x16x32_bf16 v[112:115], v[200:203], v[88:91], v[112:115]
    s_nop 2
    v_mov_b32_dpp v122, v96 quad_perm:[0,0,0,0] row_mask:0xf bank_mask:0xf
    v_mov_b32_dpp v124, v98 quad_perm:[2,2,2,2] row_mask:0xf bank_mask:0xf
    s_nop 0
    v_add_f32_dpp v122, v97, v122 quad_perm:[1,1,1,1] row_mask:0xf bank_mask:0xf
    v_add_f32_dpp v124, v99, v124 quad_perm:[3,3,3,3] row_mask:0xf bank_mask:0xf
    v_add_f32 v122, v122, v124
    v_max_f32 v65, v65, v122
    ds_write_b32 v64, v122 offset:768
    v_mfma_f32_16x16x32_bf16 v[112:115], v[204:207], v[92:95], v[112:115]
    v_mfma_f32_16x16x32_bf16 v[96:99], v[208:211], v[80:83], 0
    s_waitcnt vmcnt(7)
    buffer_load_dwordx4 a[104:107], v76, s[52:55], s85 offen offset:1024 nt
    v_mfma_f32_16x16x32_bf16 v[96:99], v[212:215], v[84:87], v[96:99]
    v_mfma_f32_16x16x32_bf16 v[96:99], v[216:219], v[88:91], v[96:99]
    s_nop 2
    v_mov_b32_dpp v122, v112 quad_perm:[0,0,0,0] row_mask:0xf bank_mask:0xf
    v_mov_b32_dpp v124, v114 quad_perm:[2,2,2,2] row_mask:0xf bank_mask:0xf
    s_nop 0
    v_add_f32_dpp v122, v113, v122 quad_perm:[1,1,1,1] row_mask:0xf bank_mask:0xf
    v_add_f32_dpp v124, v115, v124 quad_perm:[3,3,3,3] row_mask:0xf bank_mask:0xf
    v_add_f32 v122, v122, v124
    v_max_f32 v65, v65, v122
    ds_write_b32 v64, v122 offset:1024
    v_mfma_f32_16x16x32_bf16 v[96:99], v[220:223], v[92:95], v[96:99]
    s_waitcnt vmcnt(6)
    buffer_load_dwordx4 a[108:111], v77, s[52:55], s85 offen offset:1024 nt
    s_add_u32 s87, s87, 7
    s_add_u32 s39, s87, s88
    s_bfe_u32 s37, s39, 0x30000
    s_lshl_b32 s37, s37, 12
    s_add_u32 s85, s37, s89
    s_bfe_u32 s37, s39, 0x10003
    s_lshl_b32 s37, s37, 11
    s_add_u32 s85, s37, s85
    s_bfe_u32 s37, s39, 0x40004
    s_lshl_b32 s37, s37, 16
    s_add_u32 s85, s37, s85
    v_mfma_f32_16x16x32_bf16 v[112:115], v[224:227], v[80:83], 0
    v_mfma_f32_16x16x32_bf16 v[112:115], v[228:231], v[84:87], v[112:115]
    v_mfma_f32_16x16x32_bf16 v[112:115], v[232:235], v[88:91], v[112:115]
    v_mov_b32_dpp v122, v96 quad_perm:[0,0,0,0] row_mask:0xf bank_mask:0xf
    v_mov_b32_dpp v124, v98 quad_perm:[2,2,2,2] row_mask:0xf bank_mask:0xf
    s_nop 0
    v_add_f32_dpp v122, v97, v122 quad_perm:[1,1,1,1] row_mask:0xf bank_mask:0xf
    v_add_f32_dpp v124, v99, v124 quad_perm:[3,3,3,3] row_mask:0xf bank_mask:0xf
    v_add_f32 v122, v122, v124
    v_max_f32 v65, v65, v122
    ds_write_b32 v64, v122 offset:1280
    v_mfma_f32_16x16x32_bf16 v[112:115], v[236:239], v[92:95], v[112:115]
    s_waitcnt vmcnt(6)
    buffer_load_dwordx4 a[112:115], v76, s[52:55], s85 offen offset:0 nt
    v_mfma_f32_16x16x32_bf16 v[96:99], v[240:243], v[80:83], 0
    v_mfma_f32_16x16x32_bf16 v[96:99], v[244:247], v[84:87], v[96:99]
    v_mfma_f32_16x16x32_bf16 v[96:99], v[248:251], v[88:91], v[96:99]
    s_nop 2
    v_mov_b32_dpp v122, v112 quad_perm:[0,0,0,0] row_mask:0xf bank_mask:0xf
    v_mov_b32_dpp v124, v114 quad_perm:[2,2,2,2] row_mask:0xf bank_mask:0xf
    s_nop 0
    v_add_f32_dpp v122, v113, v122 quad_perm:[1,1,1,1] row_mask:0xf bank_mask:0xf
    v_add_f32_dpp v124, v115, v124 quad_perm:[3,3,3,3] row_mask:0xf bank_mask:0xf
    v_add_f32 v122, v122, v124
    v_max_f32 v65, v65, v122
    ds_write_b32 v64, v122 offset:1536
    v_mfma_f32_16x16x32_bf16 v[96:99], v[252:255], v[92:95], v[96:99]
    s_waitcnt vmcnt(6)
    buffer_load_dwordx4 a[116:119], v77, s[52:55], s85 offen offset:0 nt
    v_mfma_f32_16x16x32_bf16 v[112:115], a[0:3], v[80:83], 0
    v_mfma_f32_16x16x32_bf16 v[112:115], a[4:7], v[84:87], v[112:115]
    v_mfma_f32_16x16x32_bf16 v[112:115], a[8:11], v[88:91], v[112:115]
    s_nop 2
    v_mov_b32_dpp v122, v96 quad_perm:[0,0,0,0] row_mask:0xf bank_mask:0xf
    v_mov_b32_dpp v124, v98 quad_perm:[2,2,2,2] row_mask:0xf bank_mask:0xf
    s_nop 0
    v_add_f32_dpp v122, v97, v122 quad_perm:[1,1,1,1] row_mask:0xf bank_mask:0xf
    v_add_f32_dpp v124, v99, v124 quad_perm:[3,3,3,3] row_mask:0xf bank_mask:0xf
    v_add_f32 v122, v122, v124
    v_max_f32 v65, v65, v122
    ds_write_b32 v64, v122 offset:1792
    s_waitcnt vmcnt(6)
    buffer_load_dwordx4 a[120:123], v76, s[52:55], s85 offen offset:1024 nt
    v_mfma_f32_16x16x32_bf16 v[112:115], a[12:15], v[92:95], v[112:115]
    v_mfma_f32_16x16x32_bf16 v[96:99], a[16:19], v[80:83], 0
    v_mfma_f32_16x16x32_bf16 v[96:99], a[20:23], v[84:87], v[96:99]
    v_mfma_f32_16x16x32_bf16 v[96:99], a[24:27], v[88:91], v[96:99]
    s_nop 4
    v_mov_b32_dpp v122, v112 quad_perm:[0,0,0,0] row_mask:0xf bank_mask:0xf
    v_mov_b32_dpp v124, v114 quad_perm:[2,2,2,2] row_mask:0xf bank_mask:0xf
    s_nop 0
    v_add_f32_dpp v122, v113, v122 quad_perm:[1,1,1,1] row_mask:0xf bank_mask:0xf
    v_add_f32_dpp v124, v115, v124 quad_perm:[3,3,3,3] row_mask:0xf bank_mask:0xf
    v_add_f32 v122, v122, v124
    v_max_f32 v65, v65, v122
    ds_write_b32 v64, v122 offset:2048
    s_waitcnt vmcnt(6)
    buffer_load_dwordx4 a[124:127], v77, s[52:55], s85 offen offset:1024 nt
    s_add_u32 s87, s87, 7
    s_add_u32 s39, s87, s88
    s_bfe_u32 s37, s39, 0x30000
    s_lshl_b32 s37, s37, 12
    s_add_u32 s85, s37, s89
    s_bfe_u32 s37, s39, 0x10003
    s_lshl_b32 s37, s37, 11
    s_add_u32 s85, s37, s85
    s_bfe_u32 s37, s39, 0x40004
    s_lshl_b32 s37, s37, 16
    s_add_u32 s85, s37, s85
    v_mfma_f32_16x16x32_bf16 v[96:99], a[28:31], v[92:95], v[96:99]
    v_mfma_f32_16x16x32_bf16 v[112:115], a[32:35], v[80:83], 0
    s_bfe_u32 s38, s2, 0x20001
    s_lshl_b32 s38, s38, 0
    s_add_u32 s90, s38, 0
    s_bfe_u32 s38, s2, 0x10000
    s_lshl_b32 s38, s38, 2
    s_add_u32 s90, s38, s90
    s_and_b32 s36, s90, 3
    s_bitcmp0_b32 s90, 2
    s_cselect_b64 s[40:41], s[24:25], s[14:15]
    s_cselect_b32 s45, 262144, 0
    s_add_u32 s45, s45, 524288
    s_lshl_b32 s38, s36, 16
    s_add_u32 s71, s38, s45
    s_lshr_b32 s38, s32, 2
    s_lshl_b32 s38, s38, 13
    s_add_u32 s71, s38, s71
    s_bfe_u32 s38, s32, 0x20000
    s_lshl_b32 s38, s38, 6
    s_add_u32 s71, s38, s71
    s_mov_b32 s42, 4194304
    s_mov_b32 s43, 0x20000
    s_lshl_b32 s38, s32, 17
    s_add_u32 s44, s38, 0
    s_lshl_b32 s38, s34, 15
    s_add_u32 s44, s38, s44
    s_lshl_b32 s38, s36, 8
    s_add_u32 s44, s38, s44
    s_lshl_b32 s38, s36, 16
    s_add_u32 s45, s38, s45
    s_lshr_b32 s38, s34, 1
    s_lshl_b32 s38, s38, 15
    s_add_u32 s45, s38, s45
    s_lshl_b32 s38, s32, 8
    s_add_u32 s45, s38, s45
    s_bfe_u32 s38, s34, 0x10000
    s_lshl_b32 s38, s38, 7
    s_add_u32 s45, s38, s45
    s_lshl_b32 s38, s32, 11
    s_add_u32 s46, s38, 196608
    s_lshl_b32 s38, s34, 9
    s_add_u32 s46, s38, s46
    s_mov_b32 s72, s26
    s_and_b32 s73, s27, 0xffff
    s_mov_b32 s74, 8192
    s_mov_b32 s75, 0x20000
    v_mfma_f32_16x16x32_bf16 v[112:115], a[36:39], v[84:87], v[112:115]
    s_waitcnt vmcnt(5)
    buffer_load_dwordx4 v[128:131], v76, s[52:55], s85 offen offset:0 nt
    v_mfma_f32_16x16x32_bf16 v[112:115], a[40:43], v[88:91], v[112:115]
    v_mov_b32_dpp v122, v96 quad_perm:[0,0,0,0] row_mask:0xf bank_mask:0xf
    v_mov_b32_dpp v124, v98 quad_perm:[2,2,2,2] row_mask:0xf bank_mask:0xf
    s_nop 0
    v_add_f32_dpp v122, v97, v122 quad_perm:[1,1,1,1] row_mask:0xf bank_mask:0xf
    v_add_f32_dpp v124, v99, v124 quad_perm:[3,3,3,3] row_mask:0xf bank_mask:0xf
    v_add_f32 v122, v122, v124
    v_max_f32 v65, v65, v122
    ds_write_b32 v64, v122 offset:2304
    v_mfma_f32_16x16x32_bf16 v[112:115], a[44:47], v[92:95], v[112:115]
    v_mfma_f32_16x16x32_bf16 v[96:99], a[48:51], v[80:83], 0
    v_mfma_f32_16x16x32_bf16 v[96:99], a[52:55], v[84:87], v[96:99]
    s_waitcnt vmcnt(5)
    buffer_load_dwordx4 v[132:135], v77, s[52:55], s85 offen offset:0 nt
    v_mfma_f32_16x16x32_bf16 v[96:99], a[56:59], v[88:91], v[96:99]
    s_nop 2
    v_mov_b32_dpp v122, v112 quad_perm:[0,0,0,0] row_mask:0xf bank_mask:0xf
    v_mov_b32_dpp v124, v114 quad_perm:[2,2,2,2] row_mask:0xf bank_mask:0xf
    s_nop 0
    v_add_f32_dpp v122, v113, v122 quad_perm:[1,1,1,1] row_mask:0xf bank_mask:0xf
    v_add_f32_dpp v124, v115, v124 quad_perm:[3,3,3,3] row_mask:0xf bank_mask:0xf
    v_add_f32 v122, v122, v124
    v_max_f32 v65, v65, v122
    ds_write_b32 v64, v122 offset:2560
    v_lshlrev_b32 v4, 2, v2
    v_xor_b32 v4, v4, v3
    v_xor_b32 v5, 0, v4
    v_lshlrev_b32 v5, 4, v5
    v_lshl_add_u32 v20, v2, 10, v5
    v_xor_b32 v5, 1, v4
    v_lshlrev_b32 v5, 4, v5
    v_lshl_add_u32 v21, v2, 10, v5
    v_add_u32 v21, 3072, v21
    v_xor_b32 v5, 2, v4
    v_lshlrev_b32 v5, 4, v5
    v_lshl_add_u32 v22, v2, 10, v5
    v_add_u32 v22, 6144, v22
    v_xor_b32 v5, 3, v4
    v_lshlrev_b32 v5, 4, v5
    v_lshl_add_u32 v23, v2, 10, v5
    v_add_u32 v23, 9216, v23
    s_lshl_b32 s38, s32, 15
    s_add_u32 s47, s38, 1048576
    s_lshl_b32 s38, s3, 13
    s_add_u32 s47, s38, s47
    v_lshlrev_b32 v6, 7, v2
    v_bfe_u32 v5, v3, 0, 3
    v_lshl_add_u32 v6, v5, 4, v6
    v_lshrrev_b32 v4, 3, v3
    v_and_b32 v7, 3, v3
    v_min_u32 v7, 2, v7
    v_lshl_add_u32 v7, v7, 1, v4
    v_add_u32 v5, 0, v4
    v_cmp_le_u32 vcc, s33, v5
    s_nop 1
    v_addc_co_u32 v5, vcc, 0, v5, vcc
    v_lshl_add_u32 v50, v5, 10, v6
    v_add_u32 v5, 2, v4
    v_cmp_le_u32 vcc, s33, v5
    s_nop 1
    v_addc_co_u32 v5, vcc, 0, v5, vcc
    v_lshl_add_u32 v51, v5, 10, v6
    v_add_u32 v5, 4, v4
    v_cmp_le_u32 vcc, s33, v5
    s_nop 1
    v_addc_co_u32 v5, vcc, 0, v5, vcc
    v_lshl_add_u32 v52, v5, 10, v6
    v_mov_b32 v5, v7
    v_mov_b32 v6, 512
    v_cmp_le_u32 vcc, s33, v5
    s_nop 1
    v_addc_co_u32 v5, vcc, 0, v5, vcc
    v_lshl_add_u32 v53, v5, 10, v6
    s_mul_i32 s38, s3, 320
    s_add_u32 s38, s38, 135168
    v_lshlrev_b32 v4, 6, v2
    v_lshl_add_u32 v4, v3, 1, v4
    v_add_u32 v31, s38, v4
    v_mfma_f32_16x16x32_bf16 v[96:99], a[60:63], v[92:95], v[96:99]
    v_mfma_f32_16x16x32_bf16 v[112:115], a[64:67], v[80:83], 0
    s_waitcnt vmcnt(5)
    buffer_load_dwordx4 v[136:139], v76, s[52:55], s85 offen offset:1024 nt
    v_mfma_f32_16x16x32_bf16 v[112:115], a[68:71], v[84:87], v[112:115]
    v_mfma_f32_16x16x32_bf16 v[112:115], a[72:75], v[88:91], v[112:115]
    s_nop 2
    v_mov_b32_dpp v122, v96 quad_perm:[0,0,0,0] row_mask:0xf bank_mask:0xf
    v_mov_b32_dpp v124, v98 quad_perm:[2,2,2,2] row_mask:0xf bank_mask:0xf
    s_nop 0
    v_add_f32_dpp v122, v97, v122 quad_perm:[1,1,1,1] row_mask:0xf bank_mask:0xf
    v_add_f32_dpp v124, v99, v124 quad_perm:[3,3,3,3] row_mask:0xf bank_mask:0xf
    v_add_f32 v122, v122, v124
    v_max_f32 v65, v65, v122
    ds_write_b32 v64, v122 offset:2816
    v_mfma_f32_16x16x32_bf16 v[112:115], a[76:79], v[92:95], v[112:115]
    v_mfma_f32_16x16x32_bf16 v[96:99], a[80:83], v[80:83], 0
    v_lshlrev_b32 v4, 11, v2
    v_bfe_u32 v5, v1, 2, 2
    v_lshl_add_u32 v4, v5, 8, v4
    v_bfe_u32 v5, v1, 2, 2
    v_lshl_add_u32 v4, v5, 6, v4
    v_bfe_u32 v5, v1, 4, 1
    v_lshl_add_u32 v4, v5, 5, v4
    v_bfe_u32 v5, v1, 1, 1
    v_lshl_add_u32 v4, v5, 4, v4
    v_bfe_u32 v5, v1, 0, 1
    v_lshl_add_u32 v4, v5, 3, v4
    s_lshl_b32 s38, s34, 6
    s_add_u32 s38, s38, 98304
    v_xor_b32 v24, s38, v4
    v_xor_b32 v25, 16, v24
    v_xor_b32 v26, 32, v24
    v_xor_b32 v27, 48, v24
    v_and_b32 v4, 3, v3
    v_lshrrev_b32 v5, 2, v3
    v_lshlrev_b32 v6, 4, v2
    v_add_u32 v6, 135168, v6
    s_movk_i32 s36, 320
    v_cmp_eq_u32 vcc, 0, v5
    s_nop 1
    v_cndmask_b32 v28, 4, v4, vcc
    v_mad_u32_u24 v28, v28, s36, v6
    v_cmp_eq_u32 vcc, 1, v5
    s_nop 1
    v_cndmask_b32 v29, 4, v4, vcc
    v_mad_u32_u24 v29, v29, s36, v6
    v_lshlrev_b32 v5, 2, v1
    v_add_u32 v5, 136448, v5
    v_mov_b32 v6, 0
    ds_write_b32 v5, v6
    s_waitcnt vmcnt(5)
    buffer_load_dwordx4 v[140:143], v77, s[52:55], s85 offen offset:1024 nt
    s_add_u32 s87, s87, 7
    s_add_u32 s39, s87, s88
    s_bfe_u32 s37, s39, 0x30000
    s_lshl_b32 s37, s37, 12
    s_add_u32 s85, s37, s89
    s_bfe_u32 s37, s39, 0x10003
    s_lshl_b32 s37, s37, 11
    s_add_u32 s85, s37, s85
    s_bfe_u32 s37, s39, 0x40004
    s_lshl_b32 s37, s37, 16
    s_add_u32 s85, s37, s85
    v_mfma_f32_16x16x32_bf16 v[96:99], a[84:87], v[84:87], v[96:99]
    v_mfma_f32_16x16x32_bf16 v[96:99], a[88:91], v[88:91], v[96:99]
    v_mov_b32_dpp v122, v112 quad_perm:[0,0,0,0] row_mask:0xf bank_mask:0xf
    v_mov_b32_dpp v124, v114 quad_perm:[2,2,2,2] row_mask:0xf bank_mask:0xf
    s_nop 0
    v_add_f32_dpp v122, v113, v122 quad_perm:[1,1,1,1] row_mask:0xf bank_mask:0xf
    v_add_f32_dpp v124, v115, v124 quad_perm:[3,3,3,3] row_mask:0xf bank_mask:0xf
    v_add_f32 v122, v122, v124
    v_max_f32 v65, v65, v122
    ds_write_b32 v64, v122 offset:3072
    v_mfma_f32_16x16x32_bf16 v[96:99], a[92:95], v[92:95], v[96:99]
    s_waitcnt vmcnt(5)
    buffer_load_dwordx4 v[144:147], v76, s[52:55], s85 offen offset:0 nt
    v_mfma_f32_16x16x32_bf16 v[112:115], a[96:99], v[80:83], 0
    v_mfma_f32_16x16x32_bf16 v[112:115], a[100:103], v[84:87], v[112:115]
    v_mfma_f32_16x16x32_bf16 v[112:115], a[104:107], v[88:91], v[112:115]
    s_nop 2
    v_mov_b32_dpp v122, v96 quad_perm:[0,0,0,0] row_mask:0xf bank_mask:0xf
    v_mov_b32_dpp v124, v98 quad_perm:[2,2,2,2] row_mask:0xf bank_mask:0xf
    s_nop 0
    v_add_f32_dpp v122, v97, v122 quad_perm:[1,1,1,1] row_mask:0xf bank_mask:0xf
    v_add_f32_dpp v124, v99, v124 quad_perm:[3,3,3,3] row_mask:0xf bank_mask:0xf
    v_add_f32 v122, v122, v124
    v_max_f32 v65, v65, v122
    ds_write_b32 v64, v122 offset:3328
    v_lshlrev_b32 v30, 4, v3
    v_lshl_add_u32 v30, v2, 13, v30
    v_lshrrev_b32 v5, 2, v1
    v_lshlrev_b32 v32, 8, v5
    v_bfe_u32 v5, v1, 0, 2
    v_lshl_add_u32 v32, v5, 4, v32
    s_xor_b32 s37, s90, 4
    s_bfe_u32 s38, s37, 0x30000
    s_lshl_b32 s38, s38, 8
    s_add_u32 s36, s38, 0
    s_lshr_b32 s38, s32, 4
    s_lshl_b32 s38, s38, 7
    s_add_u32 s36, s38, s36
    s_bfe_u32 s38, s32, 0x20000
    s_lshl_b32 s38, s38, 5
    s_add_u32 s36, s38, s36
    s_bfe_u32 s38, s32, 0x20002
    s_lshl_b32 s38, s38, 3
    s_add_u32 s36, s38, s36
    v_bfe_u32 v5, v1, 0, 2
    v_lshlrev_b32 v33, 11, v5
    v_lshl_add_u32 v33, v2, 1, v33
    v_add_u32 v33, s36, v33
    v_and_b32 v5, 31, v1
    v_lshlrev_b32 v34, 4, v5
    s_mul_i32 s38, s34, 320
    s_add_u32 s38, s38, 135168
    v_lshl_add_u32 v35, v5, 3, s38
    s_bfe_u32 s38, s34, 0x10000
    s_lshl_b32 s38, s38, 12
    s_add_u32 s36, s38, s71
    s_lshr_b32 s38, s34, 1
    s_lshl_b32 s38, s38, 24
    s_add_u32 s36, s38, s36
    s_bitcmp1_b32 s90, 2
    s_cselect_b32 s46, s46, s36
    s_cselect_b64 vcc, -1, 0
    v_cndmask_b32 v54, v32, v34, vcc
    v_mfma_f32_16x16x32_bf16 v[112:115], a[108:111], v[92:95], v[112:115]
    s_waitcnt vmcnt(5)
    buffer_load_dwordx4 v[148:151], v77, s[52:55], s85 offen offset:0 nt
    v_mfma_f32_16x16x32_bf16 v[96:99], a[112:115], v[80:83], 0
    v_mfma_f32_16x16x32_bf16 v[96:99], a[116:119], v[84:87], v[96:99]
    v_mfma_f32_16x16x32_bf16 v[96:99], a[120:123], v[88:91], v[96:99]
    s_nop 2
    v_mov_b32_dpp v122, v112 quad_perm:[0,0,0,0] row_mask:0xf bank_mask:0xf
    v_mov_b32_dpp v124, v114 quad_perm:[2,2,2,2] row_mask:0xf bank_mask:0xf
    s_nop 0
    v_add_f32_dpp v122, v113, v122 quad_perm:[1,1,1,1] row_mask:0xf bank_mask:0xf
    v_add_f32_dpp v124, v115, v124 quad_perm:[3,3,3,3] row_mask:0xf bank_mask:0xf
    v_add_f32 v122, v122, v124
    v_max_f32 v65, v65, v122
    ds_write_b32 v64, v122 offset:3584
    v_mfma_f32_16x16x32_bf16 v[96:99], a[124:127], v[92:95], v[96:99]
    v_add_u32 v64, 3840, v64
    s_mov_b32 s97, 8
    s_mov_b32 s86, 32
    s_and_b32 s36, s32, 3
    s_sub_u32 s80, s36, 2
    s_cmp_ge_u32 s36, 2
    s_cselect_b32 s80, s80, 8
    s_cselect_b32 s81, 27, 25
    s_cmp_eq_u32 s80, s33
    s_cselect_b32 s36, 2, 0
    s_sub_u32 s86, s86, s36
    s_lshr_b32 s36, s36, 1
    s_sub_u32 s97, s97, s36
    s_add_u32 s80, s80, 35
    s_sub_u32 s92, s81, 1
    s_mov_b32 s66, 134217728
    s_mov_b32 s67, 0x20000
    s_mov_b64 s[64:65], s[52:53]
    v_mov_b32 v62, v76
    v_mov_b32 v63, v77
    s_branch L_bloop
L_ql:
    v_lshrrev_b32 v4, 2, v3
    v_and_b32 v5, 3, v3
    v_lshlrev_b32 v19, 6, v2
    v_lshl_add_u32 v19, v5, 4, v19
    v_lshl_add_u32 v14, v4, 18, v19
    s_and_b32 s61, s32, 28
    s_add_u32 s61, s61, s34
    s_and_b32 s60, s32, 3
    s_lshl_b32 s38, s60, 20
    s_add_u32 s63, s38, 0
    s_lshl_b32 s38, s61, 8
    s_add_u32 s63, s38, s63
    s_mov_b32 s74, 4194304
    s_mov_b32 s75, 0x20000
    s_waitcnt lgkmcnt(0)
    s_mov_b64 s[72:73], s[10:11]
    buffer_load_dwordx4 a[128:131], v14, s[72:75], s63 offen nt
    s_add_u32 s63, s63, 8192
    buffer_load_dwordx4 a[132:135], v14, s[72:75], s63 offen nt
    s_add_u32 s63, s63, 8192
    buffer_load_dwordx4 a[136:139], v14, s[72:75], s63 offen nt
    s_add_u32 s63, s63, 8192
    buffer_load_dwordx4 a[140:143], v14, s[72:75], s63 offen nt
    s_add_u32 s63, s63, 8192
    buffer_load_dwordx4 a[144:147], v14, s[72:75], s63 offen nt
    s_add_u32 s63, s63, 8192
    buffer_load_dwordx4 a[148:151], v14, s[72:75], s63 offen nt
    s_add_u32 s63, s63, 8192
    buffer_load_dwordx4 a[152:155], v14, s[72:75], s63 offen nt
    s_add_u32 s63, s63, 8192
    buffer_load_dwordx4 a[156:159], v14, s[72:75], s63 offen nt
    s_add_u32 s63, s63, 8192
    v_lshlrev_b32 v15, 1, v19
    v_lshl_add_u32 v15, v4, 9, v15
    v_lshl_add_u32 v19, v4, 15, v19
    s_load_dword s35, s[30:31], 0
    s_mov_b32 s48, s30
    s_and_b32 s49, s31, 0xffff
    s_mov_b32 s50, 8388608
    s_mov_b32 s51, 0x20000
    s_mov_b32 s82, 0xffffff00
    s_mov_b32 s83, 0x3e0293ee
    s_mov_b32 s84, 2097152
    s_lshl_b32 s38, s61, 12
    s_add_u32 s95, s38, 264192
    s_lshl_b32 s38, s61, 10
    s_add_u32 s94, s38, 393216
    s_lshl_b32 s38, s60, 8
    s_add_u32 s94, s38, s94
    s_waitcnt vmcnt(7)
    buffer_load_dwordx4 a[160:163], v14, s[72:75], s63 offen nt
    s_add_u32 s63, s63, 8192
    s_waitcnt vmcnt(7)
    buffer_load_dwordx4 a[164:167], v14, s[72:75], s63 offen nt
    s_add_u32 s63, s63, 8192
    s_waitcnt vmcnt(7)
    buffer_load_dwordx4 a[168:171], v14, s[72:75], s63 offen nt
    s_add_u32 s63, s63, 8192
    s_waitcnt vmcnt(7)
    buffer_load_dwordx4 a[172:175], v14, s[72:75], s63 offen nt
    s_add_u32 s63, s63, 8192
    s_waitcnt vmcnt(7)
    buffer_load_dwordx4 a[176:179], v14, s[72:75], s63 offen nt
    s_add_u32 s63, s63, 8192
    v_and_b32 v4, 1, v1
    v_lshlrev_b32 v4, 4, v4
    v_mov_b32 v5, 0xffff
    v_lshlrev_b32 v4, v4, v5
    v_bfe_u32 v5, v1, 1, 2
    v_cmp_eq_u32 vcc, 0, v5
    s_nop 1
    v_cndmask_b32 v10, 0, v4, vcc
    v_cmp_eq_u32 vcc, 1, v5
    s_nop 1
    v_cndmask_b32 v11, 0, v4, vcc
    v_cmp_eq_u32 vcc, 2, v5
    s_nop 1
    v_cndmask_b32 v12, 0, v4, vcc
    v_cmp_eq_u32 vcc, 3, v5
    s_nop 1
    v_cndmask_b32 v13, 0, v4, vcc
    s_waitcnt vmcnt(7)
    buffer_load_dwordx4 a[180:183], v14, s[72:75], s63 offen nt
    s_add_u32 s63, s63, 8192
    s_waitcnt vmcnt(7)
    buffer_load_dwordx4 a[184:187], v14, s[72:75], s63 offen nt
    s_add_u32 s63, s63, 8192
    s_waitcnt vmcnt(7)
    buffer_load_dwordx4 a[188:191], v14, s[72:75], s63 offen nt
    s_add_u32 s63, s63, 8192
    s_waitcnt vmcnt(7)
    buffer_load_dwordx4 a[192:195], v14, s[72:75], s63 offen nt
    s_add_u32 s63, s63, 8192
    v_lshrrev_b32 v4, 2, v3
    v_and_b32 v5, 3, v3
    v_lshlrev_b32 v76, 8, v4
    v_lshlrev_b32 v126, 8, v2
    v_lshl_add_u32 v76, v2, 6, v76
    v_lshl_add_u32 v76, v5, 4, v76
    v_lshl_add_u32 v126, v3, 4, v126
    v_xor_b32 v77, 32768, v76
    v_xor_b32 v127, 32768, v126
    s_add_u32 s3, s34, s33
    s_and_b32 s3, s3, 3
    s_lshl_b32 s89, s3, 5
    s_add_u32 s89, s89, s32
    s_lshl_b32 s89, s89, 20
    s_mul_i32 s88, s32, 8
    s_add_u32 s88, s88, s3
    s_lshl_b32 s87, s33, 0
    s_waitcnt vmcnt(7)
    buffer_load_dwordx4 a[196:199], v14, s[72:75], s63 offen nt
    s_add_u32 s63, s63, 8192
    s_waitcnt vmcnt(7)
    buffer_load_dwordx4 a[200:203], v14, s[72:75], s63 offen nt
    s_add_u32 s63, s63, 8192
    s_waitcnt vmcnt(7)
    buffer_load_dwordx4 a[204:207], v14, s[72:75], s63 offen nt
    s_add_u32 s63, s63, 8192
    s_waitcnt vmcnt(7)
    buffer_load_dwordx4 a[208:211], v14, s[72:75], s63 offen nt
    s_add_u32 s63, s63, 8192
    s_mov_b32 s52, s18
    s_and_b32 s53, s19, 0xffff
    s_mov_b32 s54, 134217728
    s_mov_b32 s55, 0x20000
    s_mov_b32 s56, s20
    s_and_b32 s57, s21, 0xffff
    s_mov_b32 s58, 134217728
    s_mov_b32 s59, 0x20000
    s_waitcnt vmcnt(7)
    buffer_load_dwordx4 a[212:215], v14, s[72:75], s63 offen nt
    s_add_u32 s63, s63, 8192
    s_waitcnt vmcnt(7)
    buffer_load_dwordx4 a[216:219], v14, s[72:75], s63 offen nt
    s_add_u32 s63, s63, 8192
    s_waitcnt vmcnt(7)
    buffer_load_dwordx4 a[220:223], v14, s[72:75], s63 offen nt
    s_add_u32 s63, s63, 8192
    s_waitcnt vmcnt(7)
    buffer_load_dwordx4 a[224:227], v14, s[72:75], s63 offen nt
    s_add_u32 s63, s63, 8192
    v_mov_b32 v120, 0xff7f0000
    v_mov_b32 v121, 0
    v_mov_b32 v18, 1
    v_mov_b32 v116, 0
    v_mov_b32 v117, 0
    v_mov_b32 v118, 0
    v_mov_b32 v119, 0
    s_lshl_b32 s38, s32, 10
    s_add_u32 s96, s38, 65536
    s_lshl_b32 s38, s3, 8
    s_add_u32 s96, s38, s96
    v_mov_b32 v9, s96
    s_lshl_b32 s38, s32, 15
    s_add_u32 s96, s38, 1048576
    s_lshl_b32 s38, s3, 13
    s_add_u32 s96, s38, s96
    s_lshl_b32 s38, s33, 10
    s_add_u32 s96, s38, s96
    v_and_b32 v5, 3, v3
    v_lshlrev_b32 v78, 7, v2
    v_lshl_add_u32 v78, v5, 5, v78
    s_lshl_b32 s38, s32, 12
    s_add_u32 s91, s38, 262144
    s_lshl_b32 s38, s3, 9
    s_add_u32 s91, s38, s91
    v_lshlrev_b32 v4, 7, v2
    v_lshl_add_u32 v4, v3, 4, v4
    v_mov_b32 v5, 512
    v_cmp_gt_u32 vcc, 8, v3
    s_nop 1
    v_cndmask_b32 v79, v5, v4, vcc
    s_waitcnt vmcnt(7)
    buffer_load_dwordx4 a[228:231], v14, s[72:75], s63 offen nt
    s_add_u32 s63, s63, 8192
    s_waitcnt vmcnt(7)
    buffer_load_dwordx4 a[232:235], v14, s[72:75], s63 offen nt
    s_add_u32 s63, s63, 8192
    s_waitcnt vmcnt(7)
    buffer_load_dwordx4 a[236:239], v14, s[72:75], s63 offen nt
    s_add_u32 s63, s63, 8192
    s_waitcnt vmcnt(7)
    buffer_load_dwordx4 a[240:243], v14, s[72:75], s63 offen nt
    s_add_u32 s63, s63, 8192
    s_waitcnt vmcnt(7)
    buffer_load_dwordx4 a[244:247], v14, s[72:75], s63 offen nt
    s_add_u32 s63, s63, 8192
    s_waitcnt vmcnt(7)
    buffer_load_dwordx4 a[248:251], v14, s[72:75], s63 offen nt
    s_add_u32 s63, s63, 8192
    s_waitcnt vmcnt(7)
    buffer_load_dwordx4 a[252:255], v14, s[72:75], s63 offen nt
    s_add_u32 s63, s63, 8192
    s_waitcnt lgkmcnt(0)
    s_add_u32 s35, s35, 0x5b
    s_and_b32 s35, s35, 0xff
    v_mov_b32 v8, s35
    s_or_b32 s68, s35, 0x6b3ac500
    s_waitcnt vmcnt(6)
    s_add_u32 s39, s87, s88
    s_bfe_u32 s37, s39, 0x30000
    s_lshl_b32 s37, s37, 12
    s_add_u32 s85, s37, s89
    s_bfe_u32 s37, s39, 0x10003
    s_lshl_b32 s37, s37, 11
    s_add_u32 s85, s37, s85
    s_bfe_u32 s37, s39, 0x40004
    s_lshl_b32 s37, s37, 16
    s_add_u32 s85, s37, s85
    buffer_load_dwordx4 v[128:131], v76, s[52:55], s85 offen offset:0 nt
    s_waitcnt vmcnt(6)
    buffer_load_dwordx4 v[132:135], v77, s[52:55], s85 offen offset:0 nt
    s_waitcnt vmcnt(6)
    buffer_load_dwordx4 v[136:139], v76, s[52:55], s85 offen offset:1024 nt
    s_waitcnt vmcnt(6)
    buffer_load_dwordx4 v[140:143], v77, s[52:55], s85 offen offset:1024 nt
    s_add_u32 s87, s87, 7
    s_add_u32 s39, s87, s88
    s_bfe_u32 s37, s39, 0x30000
    s_lshl_b32 s37, s37, 12
    s_add_u32 s85, s37, s89
    s_bfe_u32 s37, s39, 0x10003
    s_lshl_b32 s37, s37, 11
    s_add_u32 s85, s37, s85
    s_bfe_u32 s37, s39, 0x40004
    s_lshl_b32 s37, s37, 16
    s_add_u32 s85, s37, s85
    s_waitcnt vmcnt(6)
    buffer_load_dwordx4 v[144:147], v76, s[52:55], s85 offen offset:0 nt
    s_waitcnt vmcnt(6)
    buffer_load_dwordx4 v[148:151], v77, s[52:55], s85 offen offset:0 nt
    s_waitcnt vmcnt(6)
    buffer_load_dwordx4 v[152:155], v76, s[52:55], s85 offen offset:1024 nt
    s_waitcnt vmcnt(6)
    buffer_load_dwordx4 v[156:159], v77, s[52:55], s85 offen offset:1024 nt
    s_add_u32 s87, s87, 7
    s_add_u32 s39, s87, s88
    s_bfe_u32 s37, s39, 0x30000
    s_lshl_b32 s37, s37, 12
    s_add_u32 s85, s37, s89
    s_bfe_u32 s37, s39, 0x10003
    s_lshl_b32 s37, s37, 11
    s_add_u32 s85, s37, s85
    s_bfe_u32 s37, s39, 0x40004
    s_lshl_b32 s37, s37, 16
    s_add_u32 s85, s37, s85
    s_waitcnt vmcnt(6)
    buffer_load_dwordx4 v[160:163], v76, s[52:55], s85 offen offset:0 nt
    s_waitcnt vmcnt(6)
    buffer_load_dwordx4 v[164:167], v77, s[52:55], s85 offen offset:0 nt
    s_waitcnt vmcnt(6)
    buffer_load_dwordx4 v[168:171], v76, s[52:55], s85 offen offset:1024 nt
    s_waitcnt vmcnt(6)
    buffer_load_dwordx4 v[172:175], v77, s[52:55], s85 offen offset:1024 nt
    s_add_u32 s87, s87, 7
    s_add_u32 s39, s87, s88
    s_bfe_u32 s37, s39, 0x30000
    s_lshl_b32 s37, s37, 12
    s_add_u32 s85, s37, s89
    s_bfe_u32 s37, s39, 0x10003
    s_lshl_b32 s37, s37, 11
    s_add_u32 s85, s37, s85
    s_bfe_u32 s37, s39, 0x40004
    s_lshl_b32 s37, s37, 16
    s_add_u32 s85, s37, s85
    s_waitcnt vmcnt(6)
    buffer_load_dwordx4 v[176:179], v76, s[52:55], s85 offen offset:0 nt
    s_waitcnt vmcnt(6)
    buffer_load_dwordx4 v[180:183], v77, s[52:55], s85 offen offset:0 nt
    s_waitcnt vmcnt(6)
    buffer_load_dwordx4 v[184:187], v76, s[52:55], s85 offen offset:1024 nt
    s_waitcnt vmcnt(6)
    buffer_load_dwordx4 v[188:191], v77, s[52:55], s85 offen offset:1024 nt
    s_add_u32 s87, s87, 7
    s_add_u32 s39, s87, s88
    s_bfe_u32 s37, s39, 0x30000
    s_lshl_b32 s37, s37, 12
    s_add_u32 s85, s37, s89
    s_bfe_u32 s37, s39, 0x10003
    s_lshl_b32 s37, s37, 11
    s_add_u32 s85, s37, s85
    s_bfe_u32 s37, s39, 0x40004
    s_lshl_b32 s37, s37, 16
    s_add_u32 s85, s37, s85
    s_waitcnt vmcnt(6)
    buffer_load_dwordx4 v[192:195], v76, s[52:55], s85 offen offset:0 nt
    s_waitcnt vmcnt(6)
    buffer_load_dwordx4 v[196:199], v77, s[52:55], s85 offen offset:0 nt
    s_waitcnt vmcnt(6)
    buffer_load_dwordx4 v[200:203], v76, s[52:55], s85 offen offset:1024 nt
    s_waitcnt vmcnt(6)
    buffer_load_dwordx4 v[204:207], v77, s[52:55], s85 offen offset:1024 nt
    s_add_u32 s87, s87, 7
    s_add_u32 s39, s87, s88
    s_bfe_u32 s37, s39, 0x30000
    s_lshl_b32 s37, s37, 12
    s_add_u32 s85, s37, s89
    s_bfe_u32 s37, s39, 0x10003
    s_lshl_b32 s37, s37, 11
    s_add_u32 s85, s37, s85
    s_bfe_u32 s37, s39, 0x40004
    s_lshl_b32 s37, s37, 16
    s_add_u32 s85, s37, s85
    s_waitcnt vmcnt(6)
    buffer_load_dwordx4 v[208:211], v76, s[52:55], s85 offen offset:0 nt
    s_waitcnt vmcnt(6)
    buffer_load_dwordx4 v[212:215], v77, s[52:55], s85 offen offset:0 nt
    s_waitcnt vmcnt(6)
    buffer_load_dwordx4 v[216:219], v76, s[52:55], s85 offen offset:1024 nt
    s_waitcnt vmcnt(6)
    buffer_load_dwordx4 v[220:223], v77, s[52:55], s85 offen offset:1024 nt
    s_add_u32 s87, s87, 7
    s_add_u32 s39, s87, s88
    s_bfe_u32 s37, s39, 0x30000
    s_lshl_b32 s37, s37, 12
    s_add_u32 s85, s37, s89
    s_bfe_u32 s37, s39, 0x10003
    s_lshl_b32 s37, s37, 11
    s_add_u32 s85, s37, s85
    s_bfe_u32 s37, s39, 0x40004
    s_lshl_b32 s37, s37, 16
    s_add_u32 s85, s37, s85
    s_waitcnt vmcnt(6)
    buffer_load_dwordx4 v[224:227], v76, s[52:55], s85 offen offset:0 nt
    s_waitcnt vmcnt(6)
    buffer_load_dwordx4 v[228:231], v77, s[52:55], s85 offen offset:0 nt
    s_waitcnt vmcnt(6)
    buffer_load_dwordx4 v[232:235], v76, s[52:55], s85 offen offset:1024 nt
    s_waitcnt vmcnt(6)
    buffer_load_dwordx4 v[236:239], v77, s[52:55], s85 offen offset:1024 nt
    s_add_u32 s87, s87, 7
    s_add_u32 s39, s87, s88
    s_bfe_u32 s37, s39, 0x30000
    s_lshl_b32 s37, s37, 12
    s_add_u32 s85, s37, s89
    s_bfe_u32 s37, s39, 0x10003
    s_lshl_b32 s37, s37, 11
    s_add_u32 s85, s37, s85
    s_bfe_u32 s37, s39, 0x40004
    s_lshl_b32 s37, s37, 16
    s_add_u32 s85, s37, s85
    s_waitcnt vmcnt(6)
    buffer_load_dwordx4 v[240:243], v76, s[52:55], s85 offen offset:0 nt
    s_waitcnt vmcnt(6)
    buffer_load_dwordx4 v[244:247], v77, s[52:55], s85 offen offset:0 nt
    buffer_load_dwordx4 v[20:23], v15, s[48:51], s95 offen offset:0 sc1
    buffer_load_dwordx4 v[24:27], v15, s[48:51], s95 offen offset:16 sc1
    s_waitcnt vmcnt(8)
    buffer_load_dwordx4 v[248:251], v76, s[52:55], s85 offen offset:1024 nt
    s_waitcnt vmcnt(8)
    buffer_load_dwordx4 v[252:255], v77, s[52:55], s85 offen offset:1024 nt
    s_add_u32 s87, s87, 7
    s_add_u32 s39, s87, s88
    s_bfe_u32 s37, s39, 0x30000
    s_lshl_b32 s37, s37, 12
    s_add_u32 s85, s37, s89
    s_bfe_u32 s37, s39, 0x10003
    s_lshl_b32 s37, s37, 11
    s_add_u32 s85, s37, s85
    s_bfe_u32 s37, s39, 0x40004
    s_lshl_b32 s37, s37, 16
    s_add_u32 s85, s37, s85
    s_waitcnt vmcnt(8)
    buffer_load_dwordx4 a[0:3], v76, s[52:55], s85 offen offset:0 nt
    s_waitcnt vmcnt(8)
    buffer_load_dwordx4 a[4:7], v77, s[52:55], s85 offen offset:0 nt
    s_waitcnt vmcnt(8)
    buffer_load_dwordx4 a[8:11], v76, s[52:55], s85 offen offset:1024 nt
    s_waitcnt vmcnt(8)
    buffer_load_dwordx4 a[12:15], v77, s[52:55], s85 offen offset:1024 nt
    s_add_u32 s87, s87, 7
    s_add_u32 s39, s87, s88
    s_bfe_u32 s37, s39, 0x30000
    s_lshl_b32 s37, s37, 12
    s_add_u32 s85, s37, s89
    s_bfe_u32 s37, s39, 0x10003
    s_lshl_b32 s37, s37, 11
    s_add_u32 s85, s37, s85
    s_bfe_u32 s37, s39, 0x40004
    s_lshl_b32 s37, s37, 16
    s_add_u32 s85, s37, s85
    s_waitcnt vmcnt(6)
L_qacheck_14:
    v_xor_b32 v20, s35, v20
    v_xor_b32 v21, s35, v21
    v_xor_b32 v22, s35, v22
    v_xor_b32 v23, s35, v23
    v_xor_b32 v24, s35, v24
    v_xor_b32 v25, s35, v25
    v_xor_b32 v26, s35, v26
    v_xor_b32 v27, s35, v27
    v_or_b32 v4, v20, v21
    v_or3_b32 v4, v4, v22, v23
    v_or3_b32 v4, v4, v24, v25
    v_or3_b32 v4, v4, v26, v27
    v_and_b32 v4, 0xff, v4
    v_cmp_ne_u32 vcc, 0, v4
    s_cbranch_vccz L_qaok_15
    buffer_load_dwordx4 v[20:23], v15, s[48:51], s95 offen offset:0 sc1
    buffer_load_dwordx4 v[24:27], v15, s[48:51], s95 offen offset:16 sc1
    s_waitcnt vmcnt(0)
    s_sub_u32 s84, s84, 1
    s_cmp_lg_u32 s84, 0
    s_cbranch_scc1 L_qacheck_14
    s_branch L_end
L_qaok_15:
    buffer_load_dwordx4 v[68:71], v78, s[48:51], s91 offen offset:0 sc1
    buffer_load_dwordx4 v[72:75], v78, s[48:51], s91 offen offset:16 sc1
    v_cvt_pk_bf16_f32 v20, v20, v21
    v_cvt_pk_bf16_f32 v21, v22, v23
    v_cvt_pk_bf16_f32 v22, v24, v25
    v_cvt_pk_bf16_f32 v23, v26, v27
    s_nop 1
    v_mfma_f32_16x16x32_bf16 v[28:31], a[128:131], v[20:23], 0
    v_mfma_f32_16x16x32_bf16 v[32:35], a[132:135], v[20:23], 0
    v_mfma_f32_16x16x32_bf16 v[36:39], a[136:139], v[20:23], 0
    s_nop 5
    v_mov_b32_dpp v60, v28 quad_perm:[0,0,0,0] row_mask:0xf bank_mask:0xf
    v_mov_b32_dpp v4, v30 quad_perm:[2,2,2,2] row_mask:0xf bank_mask:0xf
    s_nop 0
    v_add_f32_dpp v60, v29, v60 quad_perm:[1,1,1,1] row_mask:0xf bank_mask:0xf
    v_add_f32_dpp v4, v31, v4 quad_perm:[3,3,3,3] row_mask:0xf bank_mask:0xf
    v_add_f32 v60, v60, v4
    v_mfma_f32_16x16x32_bf16 v[40:43], a[140:143], v[20:23], 0
    v_mov_b32_dpp v61, v32 quad_perm:[0,0,0,0] row_mask:0xf bank_mask:0xf
    v_mov_b32_dpp v4, v34 quad_perm:[2,2,2,2] row_mask:0xf bank_mask:0xf
    s_nop 0
    v_add_f32_dpp v61, v33, v61 quad_perm:[1,1,1,1] row_mask:0xf bank_mask:0xf
    v_add_f32_dpp v4, v35, v4 quad_perm:[3,3,3,3] row_mask:0xf bank_mask:0xf
    v_add_f32 v61, v61, v4
    v_cvt_pk_bf16_f32 v44, v60, v61
    v_mfma_f32_16x16x32_bf16 v[28:31], a[144:147], v[20:23], 0
    v_mov_b32_dpp v60, v36 quad_perm:[0,0,0,0] row_mask:0xf bank_mask:0xf
    v_mov_b32_dpp v4, v38 quad_perm:[2,2,2,2] row_mask:0xf bank_mask:0xf
    s_nop 0
    v_add_f32_dpp v60, v37, v60 quad_perm:[1,1,1,1] row_mask:0xf bank_mask:0xf
    v_add_f32_dpp v4, v39, v4 quad_perm:[3,3,3,3] row_mask:0xf bank_mask:0xf
    v_add_f32 v60, v60, v4
    buffer_load_dwordx4 a[16:19], v76, s[52:55], s85 offen offset:0 nt
    v_mfma_f32_16x16x32_bf16 v[32:35], a[148:151], v[20:23], 0
    v_mov_b32_dpp v61, v40 quad_perm:[0,0,0,0] row_mask:0xf bank_mask:0xf
    v_mov_b32_dpp v4, v42 quad_perm:[2,2,2,2] row_mask:0xf bank_mask:0xf
    s_nop 0
    v_add_f32_dpp v61, v41, v61 quad_perm:[1,1,1,1] row_mask:0xf bank_mask:0xf
    v_add_f32_dpp v4, v43, v4 quad_perm:[3,3,3,3] row_mask:0xf bank_mask:0xf
    v_add_f32 v61, v61, v4
    v_cvt_pk_bf16_f32 v45, v60, v61
    v_mfma_f32_16x16x32_bf16 v[36:39], a[152:155], v[20:23], 0
    v_mov_b32_dpp v60, v28 quad_perm:[0,0,0,0] row_mask:0xf bank_mask:0xf
    v_mov_b32_dpp v4, v30 quad_perm:[2,2,2,2] row_mask:0xf bank_mask:0xf
    s_nop 0
    v_add_f32_dpp v60, v29, v60 quad_perm:[1,1,1,1] row_mask:0xf bank_mask:0xf
    v_add_f32_dpp v4, v31, v4 quad_perm:[3,3,3,3] row_mask:0xf bank_mask:0xf
    v_add_f32 v60, v60, v4
    v_mfma_f32_16x16x32_bf16 v[40:43], a[156:159], v[20:23], 0
    v_mov_b32_dpp v61, v32 quad_perm:[0,0,0,0] row_mask:0xf bank_mask:0xf
    v_mov_b32_dpp v4, v34 quad_perm:[2,2,2,2] row_mask:0xf bank_mask:0xf
    s_nop 0
    v_add_f32_dpp v61, v33, v61 quad_perm:[1,1,1,1] row_mask:0xf bank_mask:0xf
    v_add_f32_dpp v4, v35, v4 quad_perm:[3,3,3,3] row_mask:0xf bank_mask:0xf
    v_add_f32 v61, v61, v4
    v_cvt_pk_bf16_f32 v46, v60, v61
    v_mfma_f32_16x16x32_bf16 v[28:31], a[160:163], v[20:23], 0
    v_mov_b32_dpp v60, v36 quad_perm:[0,0,0,0] row_mask:0xf bank_mask:0xf
    v_mov_b32_dpp v4, v38 quad_perm:[2,2,2,2] row_mask:0xf bank_mask:0xf
    s_nop 0
    v_add_f32_dpp v60, v37, v60 quad_perm:[1,1,1,1] row_mask:0xf bank_mask:0xf
    v_add_f32_dpp v4, v39, v4 quad_perm:[3,3,3,3] row_mask:0xf bank_mask:0xf
    v_add_f32 v60, v60, v4
    v_mfma_f32_16x16x32_bf16 v[32:35], a[164:167], v[20:23], 0
    v_mov_b32_dpp v61, v40 quad_perm:[0,0,0,0] row_mask:0xf bank_mask:0xf
    v_mov_b32_dpp v4, v42 quad_perm:[2,2,2,2] row_mask:0xf bank_mask:0xf
    s_nop 0
    v_add_f32_dpp v61, v41, v61 quad_perm:[1,1,1,1] row_mask:0xf bank_mask:0xf
    v_add_f32_dpp v4, v43, v4 quad_perm:[3,3,3,3] row_mask:0xf bank_mask:0xf
    v_add_f32 v61, v61, v4
    v_cvt_pk_bf16_f32 v47, v60, v61
    v_mfma_f32_16x16x32_bf16 v[36:39], a[168:171], v[20:23], 0
    v_mov_b32_dpp v60, v28 quad_perm:[0,0,0,0] row_mask:0xf bank_mask:0xf
    v_mov_b32_dpp v4, v30 quad_perm:[2,2,2,2] row_mask:0xf bank_mask:0xf
    s_nop 0
    v_add_f32_dpp v60, v29, v60 quad_perm:[1,1,1,1] row_mask:0xf bank_mask:0xf
    v_add_f32_dpp v4, v31, v4 quad_perm:[3,3,3,3] row_mask:0xf bank_mask:0xf
    v_add_f32 v60, v60, v4
    v_mfma_f32_16x16x32_bf16 v[40:43], a[172:175], v[20:23], 0
    v_mov_b32_dpp v61, v32 quad_perm:[0,0,0,0] row_mask:0xf bank_mask:0xf
    v_mov_b32_dpp v4, v34 quad_perm:[2,2,2,2] row_mask:0xf bank_mask:0xf
    s_nop 0
    v_add_f32_dpp v61, v33, v61 quad_perm:[1,1,1,1] row_mask:0xf bank_mask:0xf
    v_add_f32_dpp v4, v35, v4 quad_perm:[3,3,3,3] row_mask:0xf bank_mask:0xf
    v_add_f32 v61, v61, v4
    v_cvt_pk_bf16_f32 v48, v60, v61
    v_mfma_f32_16x16x32_bf16 v[28:31], a[176:179], v[20:23], 0
    v_mov_b32_dpp v60, v36 quad_perm:[0,0,0,0] row_mask:0xf bank_mask:0xf
    v_mov_b32_dpp v4, v38 quad_perm:[2,2,2,2] row_mask:0xf bank_mask:0xf
    s_nop 0
    v_add_f32_dpp v60, v37, v60 quad_perm:[1,1,1,1] row_mask:0xf bank_mask:0xf
    v_add_f32_dpp v4, v39, v4 quad_perm:[3,3,3,3] row_mask:0xf bank_mask:0xf
    v_add_f32 v60, v60, v4
    buffer_load_dwordx4 a[20:23], v77, s[52:55], s85 offen offset:0 nt
    v_mfma_f32_16x16x32_bf16 v[32:35], a[180:183], v[20:23], 0
    v_mov_b32_dpp v61, v40 quad_perm:[0,0,0,0] row_mask:0xf bank_mask:0xf
    v_mov_b32_dpp v4, v42 quad_perm:[2,2,2,2] row_mask:0xf bank_mask:0xf
    s_nop 0
    v_add_f32_dpp v61, v41, v61 quad_perm:[1,1,1,1] row_mask:0xf bank_mask:0xf
    v_add_f32_dpp v4, v43, v4 quad_perm:[3,3,3,3] row_mask:0xf bank_mask:0xf
    v_add_f32 v61, v61, v4
    v_cvt_pk_bf16_f32 v49, v60, v61
    v_mfma_f32_16x16x32_bf16 v[36:39], a[184:187], v[20:23], 0
    v_mov_b32_dpp v60, v28 quad_perm:[0,0,0,0] row_mask:0xf bank_mask:0xf
    v_mov_b32_dpp v4, v30 quad_perm:[2,2,2,2] row_mask:0xf bank_mask:0xf
    s_nop 0
    v_add_f32_dpp v60, v29, v60 quad_perm:[1,1,1,1] row_mask:0xf bank_mask:0xf
    v_add_f32_dpp v4, v31, v4 quad_perm:[3,3,3,3] row_mask:0xf bank_mask:0xf
    v_add_f32 v60, v60, v4
    v_mfma_f32_16x16x32_bf16 v[40:43], a[188:191], v[20:23], 0
    v_mov_b32_dpp v61, v32 quad_perm:[0,0,0,0] row_mask:0xf bank_mask:0xf
    v_mov_b32_dpp v4, v34 quad_perm:[2,2,2,2] row_mask:0xf bank_mask:0xf
    s_nop 0
    v_add_f32_dpp v61, v33, v61 quad_perm:[1,1,1,1] row_mask:0xf bank_mask:0xf
    v_add_f32_dpp v4, v35, v4 quad_perm:[3,3,3,3] row_mask:0xf bank_mask:0xf
    v_add_f32 v61, v61, v4
    v_cvt_pk_bf16_f32 v50, v60, v61
    v_mfma_f32_16x16x32_bf16 v[28:31], a[192:195], v[20:23], 0
    v_mov_b32_dpp v60, v36 quad_perm:[0,0,0,0] row_mask:0xf bank_mask:0xf
    v_mov_b32_dpp v4, v38 quad_perm:[2,2,2,2] row_mask:0xf bank_mask:0xf
    s_nop 0
    v_add_f32_dpp v60, v37, v60 quad_perm:[1,1,1,1] row_mask:0xf bank_mask:0xf
    v_add_f32_dpp v4, v39, v4 quad_perm:[3,3,3,3] row_mask:0xf bank_mask:0xf
    v_add_f32 v60, v60, v4
    v_mfma_f32_16x16x32_bf16 v[32:35], a[196:199], v[20:23], 0
    v_mov_b32_dpp v61, v40 quad_perm:[0,0,0,0] row_mask:0xf bank_mask:0xf
    v_mov_b32_dpp v4, v42 quad_perm:[2,2,2,2] row_mask:0xf bank_mask:0xf
    s_nop 0
    v_add_f32_dpp v61, v41, v61 quad_perm:[1,1,1,1] row_mask:0xf bank_mask:0xf
    v_add_f32_dpp v4, v43, v4 quad_perm:[3,3,3,3] row_mask:0xf bank_mask:0xf
    v_add_f32 v61, v61, v4
    v_cvt_pk_bf16_f32 v51, v60, v61
    v_mfma_f32_16x16x32_bf16 v[36:39], a[200:203], v[20:23], 0
    v_mov_b32_dpp v60, v28 quad_perm:[0,0,0,0] row_mask:0xf bank_mask:0xf
    v_mov_b32_dpp v4, v30 quad_perm:[2,2,2,2] row_mask:0xf bank_mask:0xf
    s_nop 0
    v_add_f32_dpp v60, v29, v60 quad_perm:[1,1,1,1] row_mask:0xf bank_mask:0xf
    v_add_f32_dpp v4, v31, v4 quad_perm:[3,3,3,3] row_mask:0xf bank_mask:0xf
    v_add_f32 v60, v60, v4
    v_mfma_f32_16x16x32_bf16 v[40:43], a[204:207], v[20:23], 0
    v_mov_b32_dpp v61, v32 quad_perm:[0,0,0,0] row_mask:0xf bank_mask:0xf
    v_mov_b32_dpp v4, v34 quad_perm:[2,2,2,2] row_mask:0xf bank_mask:0xf
    s_nop 0
    v_add_f32_dpp v61, v33, v61 quad_perm:[1,1,1,1] row_mask:0xf bank_mask:0xf
    v_add_f32_dpp v4, v35, v4 quad_perm:[3,3,3,3] row_mask:0xf bank_mask:0xf
    v_add_f32 v61, v61, v4
    v_cvt_pk_bf16_f32 v52, v60, v61
    v_mfma_f32_16x16x32_bf16 v[28:31], a[208:211], v[20:23], 0
    v_mov_b32_dpp v60, v36 quad_perm:[0,0,0,0] row_mask:0xf bank_mask:0xf
    v_mov_b32_dpp v4, v38 quad_perm:[2,2,2,2] row_mask:0xf bank_mask:0xf
    s_nop 0
    v_add_f32_dpp v60, v37, v60 quad_perm:[1,1,1,1] row_mask:0xf bank_mask:0xf
    v_add_f32_dpp v4, v39, v4 quad_perm:[3,3,3,3] row_mask:0xf bank_mask:0xf
    v_add_f32 v60, v60, v4
    buffer_load_dwordx4 a[24:27], v76, s[52:55], s85 offen offset:1024 nt
    v_mfma_f32_16x16x32_bf16 v[32:35], a[212:215], v[20:23], 0
    v_mov_b32_dpp v61, v40 quad_perm:[0,0,0,0] row_mask:0xf bank_mask:0xf
    v_mov_b32_dpp v4, v42 quad_perm:[2,2,2,2] row_mask:0xf bank_mask:0xf
    s_nop 0
    v_add_f32_dpp v61, v41, v61 quad_perm:[1,1,1,1] row_mask:0xf bank_mask:0xf
    v_add_f32_dpp v4, v43, v4 quad_perm:[3,3,3,3] row_mask:0xf bank_mask:0xf
    v_add_f32 v61, v61, v4
    v_cvt_pk_bf16_f32 v53, v60, v61
    v_mfma_f32_16x16x32_bf16 v[36:39], a[216:219], v[20:23], 0
    v_mov_b32_dpp v60, v28 quad_perm:[0,0,0,0] row_mask:0xf bank_mask:0xf
    v_mov_b32_dpp v4, v30 quad_perm:[2,2,2,2] row_mask:0xf bank_mask:0xf
    s_nop 0
    v_add_f32_dpp v60, v29, v60 quad_perm:[1,1,1,1] row_mask:0xf bank_mask:0xf
    v_add_f32_dpp v4, v31, v4 quad_perm:[3,3,3,3] row_mask:0xf bank_mask:0xf
    v_add_f32 v60, v60, v4
    v_mfma_f32_16x16x32_bf16 v[40:43], a[220:223], v[20:23], 0
    v_mov_b32_dpp v61, v32 quad_perm:[0,0,0,0] row_mask:0xf bank_mask:0xf
    v_mov_b32_dpp v4, v34 quad_perm:[2,2,2,2] row_mask:0xf bank_mask:0xf
    s_nop 0
    v_add_f32_dpp v61, v33, v61 quad_perm:[1,1,1,1] row_mask:0xf bank_mask:0xf
    v_add_f32_dpp v4, v35, v4 quad_perm:[3,3,3,3] row_mask:0xf bank_mask:0xf
    v_add_f32 v61, v61, v4
    v_cvt_pk_bf16_f32 v54, v60, v61
    v_mfma_f32_16x16x32_bf16 v[28:31], a[224:227], v[20:23], 0
    v_mov_b32_dpp v60, v36 quad_perm:[0,0,0,0] row_mask:0xf bank_mask:0xf
    v_mov_b32_dpp v4, v38 quad_perm:[2,2,2,2] row_mask:0xf bank_mask:0xf
    s_nop 0
    v_add_f32_dpp v60, v37, v60 quad_perm:[1,1,1,1] row_mask:0xf bank_mask:0xf
    v_add_f32_dpp v4, v39, v4 quad_perm:[3,3,3,3] row_mask:0xf bank_mask:0xf
    v_add_f32 v60, v60, v4
    v_mfma_f32_16x16x32_bf16 v[32:35], a[228:231], v[20:23], 0
    v_mov_b32_dpp v61, v40 quad_perm:[0,0,0,0] row_mask:0xf bank_mask:0xf
    v_mov_b32_dpp v4, v42 quad_perm:[2,2,2,2] row_mask:0xf bank_mask:0xf
    s_nop 0
    v_add_f32_dpp v61, v41, v61 quad_perm:[1,1,1,1] row_mask:0xf bank_mask:0xf
    v_add_f32_dpp v4, v43, v4 quad_perm:[3,3,3,3] row_mask:0xf bank_mask:0xf
    v_add_f32 v61, v61, v4
    v_cvt_pk_bf16_f32 v55, v60, v61
    v_mfma_f32_16x16x32_bf16 v[36:39], a[232:235], v[20:23], 0
    v_mov_b32_dpp v60, v28 quad_perm:[0,0,0,0] row_mask:0xf bank_mask:0xf
    v_mov_b32_dpp v4, v30 quad_perm:[2,2,2,2] row_mask:0xf bank_mask:0xf
    s_nop 0
    v_add_f32_dpp v60, v29, v60 quad_perm:[1,1,1,1] row_mask:0xf bank_mask:0xf
    v_add_f32_dpp v4, v31, v4 quad_perm:[3,3,3,3] row_mask:0xf bank_mask:0xf
    v_add_f32 v60, v60, v4
    v_mfma_f32_16x16x32_bf16 v[40:43], a[236:239], v[20:23], 0
    v_mov_b32_dpp v61, v32 quad_perm:[0,0,0,0] row_mask:0xf bank_mask:0xf
    v_mov_b32_dpp v4, v34 quad_perm:[2,2,2,2] row_mask:0xf bank_mask:0xf
    s_nop 0
    v_add_f32_dpp v61, v33, v61 quad_perm:[1,1,1,1] row_mask:0xf bank_mask:0xf
    v_add_f32_dpp v4, v35, v4 quad_perm:[3,3,3,3] row_mask:0xf bank_mask:0xf
    v_add_f32 v61, v61, v4
    v_cvt_pk_bf16_f32 v56, v60, v61
    v_mfma_f32_16x16x32_bf16 v[28:31], a[240:243], v[20:23], 0
    v_mov_b32_dpp v60, v36 quad_perm:[0,0,0,0] row_mask:0xf bank_mask:0xf
    v_mov_b32_dpp v4, v38 quad_perm:[2,2,2,2] row_mask:0xf bank_mask:0xf
    s_nop 0
    v_add_f32_dpp v60, v37, v60 quad_perm:[1,1,1,1] row_mask:0xf bank_mask:0xf
    v_add_f32_dpp v4, v39, v4 quad_perm:[3,3,3,3] row_mask:0xf bank_mask:0xf
    v_add_f32 v60, v60, v4
    buffer_load_dwordx4 a[28:31], v77, s[52:55], s85 offen offset:1024 nt
    s_add_u32 s87, s87, 7
    s_add_u32 s39, s87, s88
    s_bfe_u32 s37, s39, 0x30000
    s_lshl_b32 s37, s37, 12
    s_add_u32 s85, s37, s89
    s_bfe_u32 s37, s39, 0x10003
    s_lshl_b32 s37, s37, 11
    s_add_u32 s85, s37, s85
    s_bfe_u32 s37, s39, 0x40004
    s_lshl_b32 s37, s37, 16
    s_add_u32 s85, s37, s85
    v_mfma_f32_16x16x32_bf16 v[32:35], a[244:247], v[20:23], 0
    v_mov_b32_dpp v61, v40 quad_perm:[0,0,0,0] row_mask:0xf bank_mask:0xf
    v_mov_b32_dpp v4, v42 quad_perm:[2,2,2,2] row_mask:0xf bank_mask:0xf
    s_nop 0
    v_add_f32_dpp v61, v41, v61 quad_perm:[1,1,1,1] row_mask:0xf bank_mask:0xf
    v_add_f32_dpp v4, v43, v4 quad_perm:[3,3,3,3] row_mask:0xf bank_mask:0xf
    v_add_f32 v61, v61, v4
    v_cvt_pk_bf16_f32 v57, v60, v61
    v_mfma_f32_16x16x32_bf16 v[36:39], a[248:251], v[20:23], 0
    v_mov_b32_dpp v60, v28 quad_perm:[0,0,0,0] row_mask:0xf bank_mask:0xf
    v_mov_b32_dpp v4, v30 quad_perm:[2,2,2,2] row_mask:0xf bank_mask:0xf
    s_nop 0
    v_add_f32_dpp v60, v29, v60 quad_perm:[1,1,1,1] row_mask:0xf bank_mask:0xf
    v_add_f32_dpp v4, v31, v4 quad_perm:[3,3,3,3] row_mask:0xf bank_mask:0xf
    v_add_f32 v60, v60, v4
    v_mfma_f32_16x16x32_bf16 v[40:43], a[252:255], v[20:23], 0
    v_mov_b32_dpp v61, v32 quad_perm:[0,0,0,0] row_mask:0xf bank_mask:0xf
    v_mov_b32_dpp v4, v34 quad_perm:[2,2,2,2] row_mask:0xf bank_mask:0xf
    s_nop 0
    v_add_f32_dpp v61, v33, v61 quad_perm:[1,1,1,1] row_mask:0xf bank_mask:0xf
    v_add_f32_dpp v4, v35, v4 quad_perm:[3,3,3,3] row_mask:0xf bank_mask:0xf
    v_add_f32 v61, v61, v4
    v_cvt_pk_bf16_f32 v58, v60, v61
    v_mov_b32_dpp v60, v36 quad_perm:[0,0,0,0] row_mask:0xf bank_mask:0xf
    v_mov_b32_dpp v4, v38 quad_perm:[2,2,2,2] row_mask:0xf bank_mask:0xf
    s_nop 0
    v_add_f32_dpp v60, v37, v60 quad_perm:[1,1,1,1] row_mask:0xf bank_mask:0xf
    v_add_f32_dpp v4, v39, v4 quad_perm:[3,3,3,3] row_mask:0xf bank_mask:0xf
    v_add_f32 v60, v60, v4
    v_mov_b32_dpp v61, v40 quad_perm:[0,0,0,0] row_mask:0xf bank_mask:0xf
    v_mov_b32_dpp v4, v42 quad_perm:[2,2,2,2] row_mask:0xf bank_mask:0xf
    s_nop 0
    v_add_f32_dpp v61, v41, v61 quad_perm:[1,1,1,1] row_mask:0xf bank_mask:0xf
    v_add_f32_dpp v4, v43, v4 quad_perm:[3,3,3,3] row_mask:0xf bank_mask:0xf
    v_add_f32 v61, v61, v4
    v_cvt_pk_bf16_f32 v59, v60, v61
    s_mov_b32 exec_lo, 0x22222222
    s_mov_b32 exec_hi, 0x22222222
    v_mov_b32 v44, v48
    v_mov_b32 v45, v49
    v_mov_b32 v46, v50
    v_mov_b32 v47, v51
    s_mov_b32 exec_lo, 0x44444444
    s_mov_b32 exec_hi, 0x44444444
    v_mov_b32 v44, v52
    v_mov_b32 v45, v53
    v_mov_b32 v46, v54
    v_mov_b32 v47, v55
    s_mov_b32 exec_lo, 0x88888888
    s_mov_b32 exec_hi, 0x88888888
    v_mov_b32 v44, v56
    v_mov_b32 v45, v57
    v_mov_b32 v46, v58
    v_mov_b32 v47, v59
    s_mov_b64 exec, -1
    buffer_store_dwordx4 v[44:47], v19, s[48:51], s94 offen sc1
    s_waitcnt vmcnt(5)
L_qcheck_16:
    v_xor_b32 v68, s35, v68
    v_xor_b32 v69, s35, v69
    v_xor_b32 v70, s35, v70
    v_xor_b32 v71, s35, v71
    v_xor_b32 v72, s35, v72
    v_xor_b32 v73, s35, v73
    v_xor_b32 v74, s35, v74
    v_xor_b32 v75, s35, v75
    v_or_b32 v4, v68, v69
    v_or3_b32 v4, v4, v70, v71
    v_or3_b32 v4, v4, v72, v73
    v_or3_b32 v4, v4, v74, v75
    v_and_b32 v4, 0xff, v4
    v_cmp_ne_u32 vcc, 0, v4
    s_cbranch_vccz L_qok_17
    buffer_load_dwordx4 v[68:71], v78, s[48:51], s91 offen offset:0 sc1
    buffer_load_dwordx4 v[72:75], v78, s[48:51], s91 offen offset:16 sc1
    s_waitcnt vmcnt(0)
    s_sub_u32 s84, s84, 1
    s_cmp_lg_u32 s84, 0
    s_cbranch_scc1 L_qcheck_16
    s_branch L_end
L_qok_17:
    v_cvt_pk_bf16_f32 v68, v68, v69
    v_cvt_pk_bf16_f32 v69, v70, v71
    v_cvt_pk_bf16_f32 v70, v72, v73
    v_cvt_pk_bf16_f32 v71, v74, v75
    s_mov_b32 vcc_lo, 0xf000f
    s_mov_b32 vcc_hi, 0xf000f
    v_cndmask_b32 v80, 0, v68, vcc
    v_cndmask_b32 v81, 0, v69, vcc
    v_cndmask_b32 v82, 0, v70, vcc
    v_cndmask_b32 v83, 0, v71, vcc
    s_mov_b32 vcc_lo, 0xf000f0
    s_mov_b32 vcc_hi, 0xf000f0
    v_cndmask_b32 v84, 0, v68, vcc
    v_cndmask_b32 v85, 0, v69, vcc
    v_cndmask_b32 v86, 0, v70, vcc
    v_cndmask_b32 v87, 0, v71, vcc
    s_mov_b32 vcc_lo, 0xf000f00
    s_mov_b32 vcc_hi, 0xf000f00
    v_cndmask_b32 v88, 0, v68, vcc
    v_cndmask_b32 v89, 0, v69, vcc
    v_cndmask_b32 v90, 0, v70, vcc
    v_cndmask_b32 v91, 0, v71, vcc
    s_mov_b32 vcc_lo, 0xf000f000
    s_mov_b32 vcc_hi, 0xf000f000
    v_cndmask_b32 v92, 0, v68, vcc
    v_cndmask_b32 v93, 0, v69, vcc
    v_cndmask_b32 v94, 0, v70, vcc
    v_cndmask_b32 v95, 0, v71, vcc
    s_getreg_b32 s70, hwreg(HW_REG_XCC_ID, 0, 4)
    s_lshl_b32 s70, s70, 8
    s_or_b32 s70, s70, s35
    s_or_b32 s70, s70, 0x5e9d0000
    s_bfe_u32 s38, s2, 0x30000
    s_lshl_b32 s38, s38, 8
    s_add_u32 s69, s38, 32768
    s_lshl_b32 s38, s32, 2
    s_add_u32 s69, s38, s69
    s_lshl_b32 s38, s34, 24
    s_add_u32 s69, s38, s69
    v_mov_b32 v72, s69
    v_mov_b32 v73, s70
    s_mov_b64 exec, 1
    buffer_store_dword v73, v72, s[48:51], 0 offen sc1
    s_mov_b64 exec, -1
    v_mov_b32 v65, 0xff7f0000
    s_lshl_b32 s38, s34, 14
    s_add_u32 s38, s38, 16384
    v_lshl_add_u32 v64, v1, 2, s38
    buffer_load_dwordx4 a[32:35], v76, s[52:55], s85 offen offset:0 nt
    v_mfma_f32_16x16x32_bf16 v[112:115], v[128:131], v[80:83], 0
    v_mfma_f32_16x16x32_bf16 v[112:115], v[132:135], v[84:87], v[112:115]
    buffer_load_dwordx4 a[36:39], v77, s[52:55], s85 offen offset:0 nt
    v_mfma_f32_16x16x32_bf16 v[112:115], v[136:139], v[88:91], v[112:115]
    v_mfma_f32_16x16x32_bf16 v[112:115], v[140:143], v[92:95], v[112:115]
    buffer_load_dwordx4 a[40:43], v76, s[52:55], s85 offen offset:1024 nt
    v_mfma_f32_16x16x32_bf16 v[96:99], v[144:147], v[80:83], 0
    v_mfma_f32_16x16x32_bf16 v[96:99], v[148:151], v[84:87], v[96:99]
    s_waitcnt vmcnt(8)
    buffer_load_dwordx4 a[44:47], v77, s[52:55], s85 offen offset:1024 nt
    s_add_u32 s87, s87, 7
    s_add_u32 s39, s87, s88
    s_bfe_u32 s37, s39, 0x30000
    s_lshl_b32 s37, s37, 12
    s_add_u32 s85, s37, s89
    s_bfe_u32 s37, s39, 0x10003
    s_lshl_b32 s37, s37, 11
    s_add_u32 s85, s37, s85
    s_bfe_u32 s37, s39, 0x40004
    s_lshl_b32 s37, s37, 16
    s_add_u32 s85, s37, s85
    v_mfma_f32_16x16x32_bf16 v[96:99], v[152:155], v[88:91], v[96:99]
    v_mov_b32_dpp v122, v112 quad_perm:[0,0,0,0] row_mask:0xf bank_mask:0xf
    v_mov_b32_dpp v124, v114 quad_perm:[2,2,2,2] row_mask:0xf bank_mask:0xf
    s_nop 0
    v_add_f32_dpp v122, v113, v122 quad_perm:[1,1,1,1] row_mask:0xf bank_mask:0xf
    v_add_f32_dpp v124, v115, v124 quad_perm:[3,3,3,3] row_mask:0xf bank_mask:0xf
    v_add_f32 v122, v122, v124
    v_max_f32 v65, v65, v122
    ds_write_b32 v64, v122 offset:0
    v_mfma_f32_16x16x32_bf16 v[96:99], v[156:159], v[92:95], v[96:99]
    s_waitcnt vmcnt(8)
    buffer_load_dwordx4 a[48:51], v76, s[52:55], s85 offen offset:0 nt
    v_mfma_f32_16x16x32_bf16 v[112:115], v[160:163], v[80:83], 0
    v_mfma_f32_16x16x32_bf16 v[112:115], v[164:167], v[84:87], v[112:115]
    s_waitcnt vmcnt(8)
    buffer_load_dwordx4 a[52:55], v77, s[52:55], s85 offen offset:0 nt
    v_mfma_f32_16x16x32_bf16 v[112:115], v[168:171], v[88:91], v[112:115]
    s_nop 0
    v_mov_b32_dpp v122, v96 quad_perm:[0,0,0,0] row_mask:0xf bank_mask:0xf
    v_mov_b32_dpp v124, v98 quad_perm:[2,2,2,2] row_mask:0xf bank_mask:0xf
    s_nop 0
    v_add_f32_dpp v122, v97, v122 quad_perm:[1,1,1,1] row_mask:0xf bank_mask:0xf
    v_add_f32_dpp v124, v99, v124 quad_perm:[3,3,3,3] row_mask:0xf bank_mask:0xf
    v_add_f32 v122, v122, v124
    v_max_f32 v65, v65, v122
    ds_write_b32 v64, v122 offset:256
    v_mfma_f32_16x16x32_bf16 v[112:115], v[172:175], v[92:95], v[112:115]
    s_waitcnt vmcnt(8)
    buffer_load_dwordx4 a[56:59], v76, s[52:55], s85 offen offset:1024 nt
    v_mfma_f32_16x16x32_bf16 v[96:99], v[176:179], v[80:83], 0
    v_mfma_f32_16x16x32_bf16 v[96:99], v[180:183], v[84:87], v[96:99]
    s_waitcnt vmcnt(6)
    buffer_load_dwordx4 a[60:63], v77, s[52:55], s85 offen offset:1024 nt
    s_add_u32 s87, s87, 7
    s_add_u32 s39, s87, s88
    s_bfe_u32 s37, s39, 0x30000
    s_lshl_b32 s37, s37, 12
    s_add_u32 s85, s37, s89
    s_bfe_u32 s37, s39, 0x10003
    s_lshl_b32 s37, s37, 11
    s_add_u32 s85, s37, s85
    s_bfe_u32 s37, s39, 0x40004
    s_lshl_b32 s37, s37, 16
    s_add_u32 s85, s37, s85
    v_mfma_f32_16x16x32_bf16 v[96:99], v[184:187], v[88:91], v[96:99]
    v_mov_b32_dpp v122, v112 quad_perm:[0,0,0,0] row_mask:0xf bank_mask:0xf
    v_mov_b32_dpp v124, v114 quad_perm:[2,2,2,2] row_mask:0xf bank_mask:0xf
    s_nop 0
    v_add_f32_dpp v122, v113, v122 quad_perm:[1,1,1,1] row_mask:0xf bank_mask:0xf
    v_add_f32_dpp v124, v115, v124 quad_perm:[3,3,3,3] row_mask:0xf bank_mask:0xf
    v_add_f32 v122, v122, v124
    v_max_f32 v65, v65, v122
    ds_write_b32 v64, v122 offset:512
    s_lshl_b32 s38, s32, 8
    s_add_u32 s69, s38, 98304
    s_lshl_b32 s38, s34, 23
    s_add_u32 s69, s38, s69
    v_mov_b32 v48, s69
    v_mov_b32 v49, s68
    s_barrier
    s_mov_b64 exec, 1
    buffer_store_dword v49, v48, s[48:51], 0 offen sc1
    s_mov_b64 exec, -1
    v_mfma_f32_16x16x32_bf16 v[96:99], v[188:191], v[92:95], v[96:99]
    v_mfma_f32_16x16x32_bf16 v[112:115], v[192:195], v[80:83], 0
    s_waitcnt vmcnt(7)
    buffer_load_dwordx4 a[64:67], v76, s[52:55], s85 offen offset:0 nt
    v_mfma_f32_16x16x32_bf16 v[112:115], v[196:199], v[84:87], v[112:115]
    v_mfma_f32_16x16x32_bf16 v[112:115], v[200:203], v[88:91], v[112:115]
    s_nop 2
    v_mov_b32_dpp v122, v96 quad_perm:[0,0,0,0] row_mask:0xf bank_mask:0xf
    v_mov_b32_dpp v124, v98 quad_perm:[2,2,2,2] row_mask:0xf bank_mask:0xf
    s_nop 0
    v_add_f32_dpp v122, v97, v122 quad_perm:[1,1,1,1] row_mask:0xf bank_mask:0xf
    v_add_f32_dpp v124, v99, v124 quad_perm:[3,3,3,3] row_mask:0xf bank_mask:0xf
    v_add_f32 v122, v122, v124
    v_max_f32 v65, v65, v122
    ds_write_b32 v64, v122 offset:768
    s_waitcnt vmcnt(7)
    buffer_load_dwordx4 a[68:71], v77, s[52:55], s85 offen offset:0 nt
    v_mfma_f32_16x16x32_bf16 v[112:115], v[204:207], v[92:95], v[112:115]
    v_mfma_f32_16x16x32_bf16 v[96:99], v[208:211], v[80:83], 0
    s_waitcnt vmcnt(7)
    buffer_load_dwordx4 a[72:75], v76, s[52:55], s85 offen offset:1024 nt
    v_mfma_f32_16x16x32_bf16 v[96:99], v[212:215], v[84:87], v[96:99]
    v_mfma_f32_16x16x32_bf16 v[96:99], v[216:219], v[88:91], v[96:99]
    s_nop 2
    v_mov_b32_dpp v122, v112 quad_perm:[0,0,0,0] row_mask:0xf bank_mask:0xf
    v_mov_b32_dpp v124, v114 quad_perm:[2,2,2,2] row_mask:0xf bank_mask:0xf
    s_nop 0
    v_add_f32_dpp v122, v113, v122 quad_perm:[1,1,1,1] row_mask:0xf bank_mask:0xf
    v_add_f32_dpp v124, v115, v124 quad_perm:[3,3,3,3] row_mask:0xf bank_mask:0xf
    v_add_f32 v122, v122, v124
    v_max_f32 v65, v65, v122
    ds_write_b32 v64, v122 offset:1024
    s_waitcnt vmcnt(7)
    buffer_load_dwordx4 a[76:79], v77, s[52:55], s85 offen offset:1024 nt
    s_add_u32 s87, s87, 7
    s_add_u32 s39, s87, s88
    s_bfe_u32 s37, s39, 0x30000
    s_lshl_b32 s37, s37, 12
    s_add_u32 s85, s37, s89
    s_bfe_u32 s37, s39, 0x10003
    s_lshl_b32 s37, s37, 11
    s_add_u32 s85, s37, s85
    s_bfe_u32 s37, s39, 0x40004
    s_lshl_b32 s37, s37, 16
    s_add_u32 s85, s37, s85
    v_mfma_f32_16x16x32_bf16 v[96:99], v[220:223], v[92:95], v[96:99]
    v_mfma_f32_16x16x32_bf16 v[112:115], v[224:227], v[80:83], 0
    s_waitcnt vmcnt(7)
    buffer_load_dwordx4 a[80:83], v76, s[52:55], s85 offen offset:0 nt
    v_mfma_f32_16x16x32_bf16 v[112:115], v[228:231], v[84:87], v[112:115]
    v_mfma_f32_16x16x32_bf16 v[112:115], v[232:235], v[88:91], v[112:115]
    s_nop 2
    v_mov_b32_dpp v122, v96 quad_perm:[0,0,0,0] row_mask:0xf bank_mask:0xf
    v_mov_b32_dpp v124, v98 quad_perm:[2,2,2,2] row_mask:0xf bank_mask:0xf
    s_nop 0
    v_add_f32_dpp v122, v97, v122 quad_perm:[1,1,1,1] row_mask:0xf bank_mask:0xf
    v_add_f32_dpp v124, v99, v124 quad_perm:[3,3,3,3] row_mask:0xf bank_mask:0xf
    v_add_f32 v122, v122, v124
    v_max_f32 v65, v65, v122
    ds_write_b32 v64, v122 offset:1280
    s_waitcnt vmcnt(7)
    buffer_load_dwordx4 a[84:87], v77, s[52:55], s85 offen offset:0 nt
    v_mfma_f32_16x16x32_bf16 v[112:115], v[236:239], v[92:95], v[112:115]
    v_mfma_f32_16x16x32_bf16 v[96:99], v[240:243], v[80:83], 0
    s_waitcnt vmcnt(7)
    buffer_load_dwordx4 a[88:91], v76, s[52:55], s85 offen offset:1024 nt
    v_mfma_f32_16x16x32_bf16 v[96:99], v[244:247], v[84:87], v[96:99]
    v_mfma_f32_16x16x32_bf16 v[96:99], v[248:251], v[88:91], v[96:99]
    s_nop 2
    v_mov_b32_dpp v122, v112 quad_perm:[0,0,0,0] row_mask:0xf bank_mask:0xf
    v_mov_b32_dpp v124, v114 quad_perm:[2,2,2,2] row_mask:0xf bank_mask:0xf
    s_nop 0
    v_add_f32_dpp v122, v113, v122 quad_perm:[1,1,1,1] row_mask:0xf bank_mask:0xf
    v_add_f32_dpp v124, v115, v124 quad_perm:[3,3,3,3] row_mask:0xf bank_mask:0xf
    v_add_f32 v122, v122, v124
    v_max_f32 v65, v65, v122
    ds_write_b32 v64, v122 offset:1536
    v_mfma_f32_16x16x32_bf16 v[96:99], v[252:255], v[92:95], v[96:99]
    s_waitcnt vmcnt(6)
    buffer_load_dwordx4 a[92:95], v77, s[52:55], s85 offen offset:1024 nt
    s_add_u32 s87, s87, 7
    s_add_u32 s39, s87, s88
    s_bfe_u32 s37, s39, 0x30000
    s_lshl_b32 s37, s37, 12
    s_add_u32 s85, s37, s89
    s_bfe_u32 s37, s39, 0x10003
    s_lshl_b32 s37, s37, 11
    s_add_u32 s85, s37, s85
    s_bfe_u32 s37, s39, 0x40004
    s_lshl_b32 s37, s37, 16
    s_add_u32 s85, s37, s85
    v_mfma_f32_16x16x32_bf16 v[112:115], a[0:3], v[80:83], 0
    v_mfma_f32_16x16x32_bf16 v[112:115], a[4:7], v[84:87], v[112:115]
    s_waitcnt vmcnt(6)
    buffer_load_dwordx4 a[96:99], v76, s[52:55], s85 offen offset:0 nt
    v_mfma_f32_16x16x32_bf16 v[112:115], a[8:11], v[88:91], v[112:115]
    v_mov_b32_dpp v122, v96 quad_perm:[0,0,0,0] row_mask:0xf bank_mask:0xf
    v_mov_b32_dpp v124, v98 quad_perm:[2,2,2,2] row_mask:0xf bank_mask:0xf
    s_nop 0
    v_add_f32_dpp v122, v97, v122 quad_perm:[1,1,1,1] row_mask:0xf bank_mask:0xf
    v_add_f32_dpp v124, v99, v124 quad_perm:[3,3,3,3] row_mask:0xf bank_mask:0xf
    v_add_f32 v122, v122, v124
    v_max_f32 v65, v65, v122
    ds_write_b32 v64, v122 offset:1792
    v_mfma_f32_16x16x32_bf16 v[112:115], a[12:15], v[92:95], v[112:115]
    s_waitcnt vmcnt(6)
    buffer_load_dwordx4 a[100:103], v77, s[52:55], s85 offen offset:0 nt
    v_mfma_f32_16x16x32_bf16 v[96:99], a[16:19], v[80:83], 0
    v_mfma_f32_16x16x32_bf16 v[96:99], a[20:23], v[84:87], v[96:99]
    s_waitcnt vmcnt(6)
    buffer_load_dwordx4 a[104:107], v76, s[52:55], s85 offen offset:1024 nt
    v_mfma_f32_16x16x32_bf16 v[96:99], a[24:27], v[88:91], v[96:99]
    s_nop 0
    v_mov_b32_dpp v122, v112 quad_perm:[0,0,0,0] row_mask:0xf bank_mask:0xf
    v_mov_b32_dpp v124, v114 quad_perm:[2,2,2,2] row_mask:0xf bank_mask:0xf
    s_nop 0
    v_add_f32_dpp v122, v113, v122 quad_perm:[1,1,1,1] row_mask:0xf bank_mask:0xf
    v_add_f32_dpp v124, v115, v124 quad_perm:[3,3,3,3] row_mask:0xf bank_mask:0xf
    v_add_f32 v122, v122, v124
    v_max_f32 v65, v65, v122
    ds_write_b32 v64, v122 offset:2048
    v_mfma_f32_16x16x32_bf16 v[96:99], a[28:31], v[92:95], v[96:99]
    s_waitcnt vmcnt(6)
    buffer_load_dwordx4 a[108:111], v77, s[52:55], s85 offen offset:1024 nt
    s_add_u32 s87, s87, 7
    s_add_u32 s39, s87, s88
    s_bfe_u32 s37, s39, 0x30000
    s_lshl_b32 s37, s37, 12
    s_add_u32 s85, s37, s89
    s_bfe_u32 s37, s39, 0x10003
    s_lshl_b32 s37, s37, 11
    s_add_u32 s85, s37, s85
    s_bfe_u32 s37, s39, 0x40004
    s_lshl_b32 s37, s37, 16
    s_add_u32 s85, s37, s85
    v_mfma_f32_16x16x32_bf16 v[112:115], a[32:35], v[80:83], 0
    s_bfe_u32 s38, s2, 0x20001
    s_lshl_b32 s38, s38, 0
    s_add_u32 s90, s38, 0
    s_bfe_u32 s38, s2, 0x10000
    s_lshl_b32 s38, s38, 2
    s_add_u32 s90, s38, s90
    s_and_b32 s36, s90, 3
    s_bitcmp0_b32 s90, 2
    s_cselect_b64 s[40:41], s[24:25], s[14:15]
    s_cselect_b32 s45, 262144, 0
    s_add_u32 s45, s45, 524288
    s_lshl_b32 s38, s36, 16
    s_add_u32 s71, s38, s45
    s_lshr_b32 s38, s32, 2
    s_lshl_b32 s38, s38, 13
    s_add_u32 s71, s38, s71
    s_bfe_u32 s38, s32, 0x20000
    s_lshl_b32 s38, s38, 6
    s_add_u32 s71, s38, s71
    s_mov_b32 s42, 4194304
    s_mov_b32 s43, 0x20000
    s_lshl_b32 s38, s32, 17
    s_add_u32 s44, s38, 0
    s_lshl_b32 s38, s34, 15
    s_add_u32 s44, s38, s44
    s_lshl_b32 s38, s36, 8
    s_add_u32 s44, s38, s44
    s_lshl_b32 s38, s36, 16
    s_add_u32 s45, s38, s45
    s_lshr_b32 s38, s34, 1
    s_lshl_b32 s38, s38, 15
    s_add_u32 s45, s38, s45
    s_lshl_b32 s38, s32, 8
    s_add_u32 s45, s38, s45
    s_bfe_u32 s38, s34, 0x10000
    s_lshl_b32 s38, s38, 7
    s_add_u32 s45, s38, s45
    s_lshl_b32 s38, s32, 11
    s_add_u32 s46, s38, 196608
    s_lshl_b32 s38, s34, 9
    s_add_u32 s46, s38, s46
    s_mov_b32 s72, s26
    s_and_b32 s73, s27, 0xffff
    s_mov_b32 s74, 8192
    s_mov_b32 s75, 0x20000
    v_mfma_f32_16x16x32_bf16 v[112:115], a[36:39], v[84:87], v[112:115]
    s_waitcnt vmcnt(6)
    buffer_load_dwordx4 a[112:115], v76, s[52:55], s85 offen offset:0 nt
    v_mfma_f32_16x16x32_bf16 v[112:115], a[40:43], v[88:91], v[112:115]
    v_mov_b32_dpp v122, v96 quad_perm:[0,0,0,0] row_mask:0xf bank_mask:0xf
    v_mov_b32_dpp v124, v98 quad_perm:[2,2,2,2] row_mask:0xf bank_mask:0xf
    s_nop 0
    v_add_f32_dpp v122, v97, v122 quad_perm:[1,1,1,1] row_mask:0xf bank_mask:0xf
    v_add_f32_dpp v124, v99, v124 quad_perm:[3,3,3,3] row_mask:0xf bank_mask:0xf
    v_add_f32 v122, v122, v124
    v_max_f32 v65, v65, v122
    ds_write_b32 v64, v122 offset:2304
    v_mfma_f32_16x16x32_bf16 v[112:115], a[44:47], v[92:95], v[112:115]
    s_waitcnt vmcnt(6)
    buffer_load_dwordx4 a[116:119], v77, s[52:55], s85 offen offset:0 nt
    v_mfma_f32_16x16x32_bf16 v[96:99], a[48:51], v[80:83], 0
    v_mfma_f32_16x16x32_bf16 v[96:99], a[52:55], v[84:87], v[96:99]
    s_waitcnt vmcnt(6)
    buffer_load_dwordx4 a[120:123], v76, s[52:55], s85 offen offset:1024 nt
    v_mfma_f32_16x16x32_bf16 v[96:99], a[56:59], v[88:91], v[96:99]
    s_nop 0
    v_mov_b32_dpp v122, v112 quad_perm:[0,0,0,0] row_mask:0xf bank_mask:0xf
    v_mov_b32_dpp v124, v114 quad_perm:[2,2,2,2] row_mask:0xf bank_mask:0xf
    s_nop 0
    v_add_f32_dpp v122, v113, v122 quad_perm:[1,1,1,1] row_mask:0xf bank_mask:0xf
    v_add_f32_dpp v124, v115, v124 quad_perm:[3,3,3,3] row_mask:0xf bank_mask:0xf
    v_add_f32 v122, v122, v124
    v_max_f32 v65, v65, v122
    ds_write_b32 v64, v122 offset:2560
    v_lshlrev_b32 v4, 2, v2
    v_xor_b32 v4, v4, v3
    v_xor_b32 v5, 0, v4
    v_lshlrev_b32 v5, 4, v5
    v_lshl_add_u32 v20, v2, 10, v5
    v_xor_b32 v5, 1, v4
    v_lshlrev_b32 v5, 4, v5
    v_lshl_add_u32 v21, v2, 10, v5
    v_add_u32 v21, 3072, v21
    v_xor_b32 v5, 2, v4
    v_lshlrev_b32 v5, 4, v5
    v_lshl_add_u32 v22, v2, 10, v5
    v_add_u32 v22, 6144, v22
    v_xor_b32 v5, 3, v4
    v_lshlrev_b32 v5, 4, v5
    v_lshl_add_u32 v23, v2, 10, v5
    v_add_u32 v23, 9216, v23
    s_lshl_b32 s38, s32, 15
    s_add_u32 s47, s38, 1048576
    s_lshl_b32 s38, s3, 13
    s_add_u32 s47, s38, s47
    v_lshlrev_b32 v6, 7, v2
    v_bfe_u32 v5, v3, 0, 3
    v_lshl_add_u32 v6, v5, 4, v6
    v_lshrrev_b32 v4, 3, v3
    v_and_b32 v7, 3, v3
    v_min_u32 v7, 2, v7
    v_lshl_add_u32 v7, v7, 1, v4
    v_add_u32 v5, 0, v4
    v_cmp_le_u32 vcc, s33, v5
    s_nop 1
    v_addc_co_u32 v5, vcc, 0, v5, vcc
    v_lshl_add_u32 v50, v5, 10, v6
    v_add_u32 v5, 2, v4
    v_cmp_le_u32 vcc, s33, v5
    s_nop 1
    v_addc_co_u32 v5, vcc, 0, v5, vcc
    v_lshl_add_u32 v51, v5, 10, v6
    v_add_u32 v5, 4, v4
    v_cmp_le_u32 vcc, s33, v5
    s_nop 1
    v_addc_co_u32 v5, vcc, 0, v5, vcc
    v_lshl_add_u32 v52, v5, 10, v6
    v_mov_b32 v5, v7
    v_mov_b32 v6, 512
    v_cmp_le_u32 vcc, s33, v5
    s_nop 1
    v_addc_co_u32 v5, vcc, 0, v5, vcc
    v_lshl_add_u32 v53, v5, 10, v6
    s_mul_i32 s38, s3, 320
    s_add_u32 s38, s38, 135168
    v_lshlrev_b32 v4, 6, v2
    v_lshl_add_u32 v4, v3, 1, v4
    v_add_u32 v31, s38, v4
    v_mfma_f32_16x16x32_bf16 v[96:99], a[60:63], v[92:95], v[96:99]
    v_mfma_f32_16x16x32_bf16 v[112:115], a[64:67], v[80:83], 0
    s_waitcnt vmcnt(6)
    buffer_load_dwordx4 a[124:127], v77, s[52:55], s85 offen offset:1024 nt
    s_add_u32 s87, s87, 7
    s_add_u32 s39, s87, s88
    s_bfe_u32 s37, s39, 0x30000
    s_lshl_b32 s37, s37, 12
    s_add_u32 s85, s37, s89
    s_bfe_u32 s37, s39, 0x10003
    s_lshl_b32 s37, s37, 11
    s_add_u32 s85, s37, s85
    s_bfe_u32 s37, s39, 0x40004
    s_lshl_b32 s37, s37, 16
    s_add_u32 s85, s37, s85
    v_mfma_f32_16x16x32_bf16 v[112:115], a[68:71], v[84:87], v[112:115]
    v_mfma_f32_16x16x32_bf16 v[112:115], a[72:75], v[88:91], v[112:115]
    v_mov_b32_dpp v122, v96 quad_perm:[0,0,0,0] row_mask:0xf bank_mask:0xf
    v_mov_b32_dpp v124, v98 quad_perm:[2,2,2,2] row_mask:0xf bank_mask:0xf
    s_nop 0
    v_add_f32_dpp v122, v97, v122 quad_perm:[1,1,1,1] row_mask:0xf bank_mask:0xf
    v_add_f32_dpp v124, v99, v124 quad_perm:[3,3,3,3] row_mask:0xf bank_mask:0xf
    v_add_f32 v122, v122, v124
    v_max_f32 v65, v65, v122
    ds_write_b32 v64, v122 offset:2816
    s_waitcnt vmcnt(5)
    buffer_load_dwordx4 v[128:131], v76, s[52:55], s85 offen offset:0 nt
    v_mfma_f32_16x16x32_bf16 v[112:115], a[76:79], v[92:95], v[112:115]
    v_mfma_f32_16x16x32_bf16 v[96:99], a[80:83], v[80:83], 0
    v_lshlrev_b32 v4, 11, v2
    v_bfe_u32 v5, v1, 2, 2
    v_lshl_add_u32 v4, v5, 8, v4
    v_bfe_u32 v5, v1, 2, 2
    v_lshl_add_u32 v4, v5, 6, v4
    v_bfe_u32 v5, v1, 4, 1
    v_lshl_add_u32 v4, v5, 5, v4
    v_bfe_u32 v5, v1, 1, 1
    v_lshl_add_u32 v4, v5, 4, v4
    v_bfe_u32 v5, v1, 0, 1
    v_lshl_add_u32 v4, v5, 3, v4
    s_lshl_b32 s38, s34, 6
    s_add_u32 s38, s38, 98304
    v_xor_b32 v24, s38, v4
    v_xor_b32 v25, 16, v24
    v_xor_b32 v26, 32, v24
    v_xor_b32 v27, 48, v24
    v_and_b32 v4, 3, v3
    v_lshrrev_b32 v5, 2, v3
    v_lshlrev_b32 v6, 4, v2
    v_add_u32 v6, 135168, v6
    s_movk_i32 s36, 320
    v_cmp_eq_u32 vcc, 0, v5
    s_nop 1
    v_cndmask_b32 v28, 4, v4, vcc
    v_mad_u32_u24 v28, v28, s36, v6
    v_cmp_eq_u32 vcc, 1, v5
    s_nop 1
    v_cndmask_b32 v29, 4, v4, vcc
    v_mad_u32_u24 v29, v29, s36, v6
    v_lshlrev_b32 v5, 2, v1
    v_add_u32 v5, 136448, v5
    v_mov_b32 v6, 0
    ds_write_b32 v5, v6
    s_waitcnt vmcnt(5)
    buffer_load_dwordx4 v[132:135], v77, s[52:55], s85 offen offset:0 nt
    v_mfma_f32_16x16x32_bf16 v[96:99], a[84:87], v[84:87], v[96:99]
    v_mfma_f32_16x16x32_bf16 v[96:99], a[88:91], v[88:91], v[96:99]
    v_mov_b32_dpp v122, v112 quad_perm:[0,0,0,0] row_mask:0xf bank_mask:0xf
    v_mov_b32_dpp v124, v114 quad_perm:[2,2,2,2] row_mask:0xf bank_mask:0xf
    s_nop 0
    v_add_f32_dpp v122, v113, v122 quad_perm:[1,1,1,1] row_mask:0xf bank_mask:0xf
    v_add_f32_dpp v124, v115, v124 quad_perm:[3,3,3,3] row_mask:0xf bank_mask:0xf
    v_add_f32 v122, v122, v124
    v_max_f32 v65, v65, v122
    ds_write_b32 v64, v122 offset:3072
    s_waitcnt vmcnt(5)
    buffer_load_dwordx4 v[136:139], v76, s[52:55], s85 offen offset:1024 nt
    v_mfma_f32_16x16x32_bf16 v[96:99], a[92:95], v[92:95], v[96:99]
    v_mfma_f32_16x16x32_bf16 v[112:115], a[96:99], v[80:83], 0
    s_waitcnt vmcnt(5)
    buffer_load_dwordx4 v[140:143], v77, s[52:55], s85 offen offset:1024 nt
    s_add_u32 s87, s87, 7
    s_add_u32 s39, s87, s88
    s_bfe_u32 s37, s39, 0x30000
    s_lshl_b32 s37, s37, 12
    s_add_u32 s85, s37, s89
    s_bfe_u32 s37, s39, 0x10003
    s_lshl_b32 s37, s37, 11
    s_add_u32 s85, s37, s85
    s_bfe_u32 s37, s39, 0x40004
    s_lshl_b32 s37, s37, 16
    s_add_u32 s85, s37, s85
    v_mfma_f32_16x16x32_bf16 v[112:115], a[100:103], v[84:87], v[112:115]
    v_mfma_f32_16x16x32_bf16 v[112:115], a[104:107], v[88:91], v[112:115]
    v_mov_b32_dpp v122, v96 quad_perm:[0,0,0,0] row_mask:0xf bank_mask:0xf
    v_mov_b32_dpp v124, v98 quad_perm:[2,2,2,2] row_mask:0xf bank_mask:0xf
    s_nop 0
    v_add_f32_dpp v122, v97, v122 quad_perm:[1,1,1,1] row_mask:0xf bank_mask:0xf
    v_add_f32_dpp v124, v99, v124 quad_perm:[3,3,3,3] row_mask:0xf bank_mask:0xf
    v_add_f32 v122, v122, v124
    v_max_f32 v65, v65, v122
    ds_write_b32 v64, v122 offset:3328
    v_lshlrev_b32 v30, 4, v3
    v_lshl_add_u32 v30, v2, 13, v30
    v_lshrrev_b32 v5, 2, v1
    v_lshlrev_b32 v32, 8, v5
    v_bfe_u32 v5, v1, 0, 2
    v_lshl_add_u32 v32, v5, 4, v32
    s_xor_b32 s37, s90, 4
    s_bfe_u32 s38, s37, 0x30000
    s_lshl_b32 s38, s38, 8
    s_add_u32 s36, s38, 0
    s_lshr_b32 s38, s32, 4
    s_lshl_b32 s38, s38, 7
    s_add_u32 s36, s38, s36
    s_bfe_u32 s38, s32, 0x20000
    s_lshl_b32 s38, s38, 5
    s_add_u32 s36, s38, s36
    s_bfe_u32 s38, s32, 0x20002
    s_lshl_b32 s38, s38, 3
    s_add_u32 s36, s38, s36
    v_bfe_u32 v5, v1, 0, 2
    v_lshlrev_b32 v33, 11, v5
    v_lshl_add_u32 v33, v2, 1, v33
    v_add_u32 v33, s36, v33
    v_and_b32 v5, 31, v1
    v_lshlrev_b32 v34, 4, v5
    s_mul_i32 s38, s34, 320
    s_add_u32 s38, s38, 135168
    v_lshl_add_u32 v35, v5, 3, s38
    s_bfe_u32 s38, s34, 0x10000
    s_lshl_b32 s38, s38, 12
    s_add_u32 s36, s38, s71
    s_lshr_b32 s38, s34, 1
    s_lshl_b32 s38, s38, 24
    s_add_u32 s36, s38, s36
    s_bitcmp1_b32 s90, 2
    s_cselect_b32 s46, s46, s36
    s_cselect_b64 vcc, -1, 0
    v_cndmask_b32 v54, v32, v34, vcc
    s_waitcnt vmcnt(5)
    buffer_load_dwordx4 v[144:147], v76, s[52:55], s85 offen offset:0 nt
    v_mfma_f32_16x16x32_bf16 v[112:115], a[108:111], v[92:95], v[112:115]
    v_mfma_f32_16x16x32_bf16 v[96:99], a[112:115], v[80:83], 0
    s_waitcnt vmcnt(5)
    buffer_load_dwordx4 v[148:151], v77, s[52:55], s85 offen offset:0 nt
    v_mfma_f32_16x16x32_bf16 v[96:99], a[116:119], v[84:87], v[96:99]
    v_mfma_f32_16x16x32_bf16 v[96:99], a[120:123], v[88:91], v[96:99]
    s_nop 2
    v_mov_b32_dpp v122, v112 quad_perm:[0,0,0,0] row_mask:0xf bank_mask:0xf
    v_mov_b32_dpp v124, v114 quad_perm:[2,2,2,2] row_mask:0xf bank_mask:0xf
    s_nop 0
    v_add_f32_dpp v122, v113, v122 quad_perm:[1,1,1,1] row_mask:0xf bank_mask:0xf
    v_add_f32_dpp v124, v115, v124 quad_perm:[3,3,3,3] row_mask:0xf bank_mask:0xf
    v_add_f32 v122, v122, v124
    v_max_f32 v65, v65, v122
    ds_write_b32 v64, v122 offset:3584
    v_mfma_f32_16x16x32_bf16 v[96:99], a[124:127], v[92:95], v[96:99]
    v_add_u32 v64, 3840, v64
    s_mov_b32 s97, 8
    s_mov_b32 s86, 32
    s_and_b32 s36, s32, 3
    s_sub_u32 s80, s36, 2
    s_cmp_ge_u32 s36, 2
    s_cselect_b32 s80, s80, 8
    s_cselect_b32 s81, 27, 25
    s_cmp_eq_u32 s80, s33
    s_cselect_b32 s36, 2, 0
    s_sub_u32 s86, s86, s36
    s_lshr_b32 s36, s36, 1
    s_sub_u32 s97, s97, s36
    s_add_u32 s80, s80, 35
    s_sub_u32 s92, s81, 1
    s_mov_b32 s66, 134217728
    s_mov_b32 s67, 0x20000
    s_mov_b64 s[64:65], s[52:53]
    v_mov_b32 v62, v76
    v_mov_b32 v63, v77
    s_branch L_bloop
L_aux:
    v_lshlrev_b32 v4, 2, v2
    v_xor_b32 v4, v4, v3
    v_xor_b32 v96, 0, v4
    v_lshlrev_b32 v96, 4, v96
    v_lshl_add_u32 v10, v2, 13, v96
    v_xor_b32 v97, 1, v4
    v_lshlrev_b32 v97, 4, v97
    v_lshl_add_u32 v11, v2, 13, v97
    v_add_u32 v11, 31744, v11
    v_xor_b32 v98, 2, v4
    v_lshlrev_b32 v98, 4, v98
    v_lshl_add_u32 v12, v2, 13, v98
    v_add_u32 v12, 63488, v12
    v_xor_b32 v99, 3, v4
    v_lshlrev_b32 v99, 4, v99
    v_lshl_add_u32 v13, v2, 13, v99
    v_add_u32 v13, 95232, v13
    s_lshl_b32 s56, s34, 15
    s_mov_b32 s62, 0
    s_lshl_b32 s38, s34, 20
    s_add_u32 s95, s38, 0
    s_lshl_b32 s38, s32, 8
    s_add_u32 s95, s38, s95
    s_waitcnt lgkmcnt(0)
    s_mov_b32 s52, s12
    s_and_b32 s53, s13, 0xffff
    s_mov_b32 s54, 4194304
    s_mov_b32 s55, 0x20000
    s_add_u32 s39, s56, s62
    s_mov_b32 m0, s39
    s_add_u32 s62, s62, 4096
    s_and_b32 s62, s62, 0x7fff
    buffer_load_dwordx4 v10, s[52:55], s95 offen offset:0 nt lds
    buffer_load_dwordx4 v11, s[52:55], s95 offen offset:1024 nt lds
    buffer_load_dwordx4 v12, s[52:55], s95 offen offset:2048 nt lds
    buffer_load_dwordx4 v13, s[52:55], s95 offen offset:3072 nt lds
    s_add_u32 s95, s95, 131072
    s_add_u32 s39, s56, s62
    s_mov_b32 m0, s39
    s_add_u32 s62, s62, 4096
    s_and_b32 s62, s62, 0x7fff
    buffer_load_dwordx4 v10, s[52:55], s95 offen offset:0 nt lds
    buffer_load_dwordx4 v11, s[52:55], s95 offen offset:1024 nt lds
    buffer_load_dwordx4 v12, s[52:55], s95 offen offset:2048 nt lds
    buffer_load_dwordx4 v13, s[52:55], s95 offen offset:3072 nt lds
    s_add_u32 s95, s95, 131072
    s_load_dword s35, s[30:31], 0
    s_mov_b32 s48, s30
    s_and_b32 s49, s31, 0xffff
    s_mov_b32 s50, 8388608
    s_mov_b32 s51, 0x20000
    s_mov_b32 s82, 0xffffff00
    s_mov_b32 s83, 0x3e0293ee
    s_mov_b32 s84, 2097152
    v_lshl_add_u32 v76, v2, 10, v96
    v_lshl_add_u32 v96, v2, 8, v96
    v_lshl_add_u32 v77, v2, 10, v97
    v_lshl_add_u32 v97, v2, 8, v97
    v_add_u32 v77, 3072, v77
    v_lshl_add_u32 v78, v2, 10, v98
    v_lshl_add_u32 v98, v2, 8, v98
    v_add_u32 v78, 6144, v78
    v_lshl_add_u32 v79, v2, 10, v99
    v_lshl_add_u32 v99, v2, 8, v99
    v_add_u32 v79, 9216, v79
    v_bfe_u32 v100, v1, 0, 5
    v_lshlrev_b32 v101, 8, v100
    v_lshlrev_b32 v9, 4, v3
    v_lshl_add_u32 v9, v2, 10, v9
    v_xor_b32 v5, v3, v2
    v_bfe_u32 v4, v3, 2, 1
    v_lshlrev_b32 v6, 11, v4
    v_bfe_u32 v4, v3, 3, 1
    v_lshl_add_u32 v6, v4, 10, v6
    v_bfe_u32 v4, v3, 0, 2
    v_lshl_add_u32 v6, v4, 8, v6
    v_bfe_u32 v4, v5, 0, 2
    v_lshl_add_u32 v6, v4, 6, v6
    v_bfe_u32 v4, v3, 2, 1
    v_lshl_add_u32 v6, v4, 5, v6
    v_bfe_u32 v4, v3, 3, 1
    v_lshl_add_u32 v6, v4, 4, v6
    v_add_u32 v60, s56, v6
    v_xor_b32 v61, 16, v60
    v_xor_b32 v62, 32, v60
    v_xor_b32 v63, 48, v60
    v_lshrrev_b32 v5, 4, v1
    v_xor_b32 v5, v5, v1
    v_bfe_u32 v4, v1, 4, 1
    v_lshlrev_b32 v6, 11, v4
    v_bfe_u32 v4, v1, 5, 1
    v_lshl_add_u32 v6, v4, 10, v6
    v_bfe_u32 v4, v1, 2, 2
    v_lshl_add_u32 v6, v4, 8, v6
    v_bfe_u32 v4, v1, 2, 2
    v_lshl_add_u32 v6, v4, 6, v6
    v_bfe_u32 v4, v1, 4, 1
    v_lshl_add_u32 v6, v4, 5, v6
    v_bfe_u32 v4, v5, 1, 1
    v_lshl_add_u32 v6, v4, 4, v6
    v_bfe_u32 v4, v1, 0, 1
    v_lshl_add_u32 v6, v4, 3, v6
    v_add_u32 v82, s56, v6
    v_xor_b32 v83, 32, v82
    v_xor_b32 v84, 64, v82
    v_xor_b32 v85, 96, v82
    v_xor_b32 v86, 128, v82
    v_xor_b32 v87, 160, v82
    v_xor_b32 v88, 192, v82
    v_xor_b32 v89, 224, v82
    v_lshlrev_b32 v6, 11, v2
    v_bfe_u32 v4, v1, 2, 2
    v_lshl_add_u32 v6, v4, 8, v6
    v_bfe_u32 v4, v1, 2, 2
    v_lshl_add_u32 v6, v4, 6, v6
    v_bfe_u32 v4, v1, 4, 1
    v_lshl_add_u32 v6, v4, 5, v6
    v_bfe_u32 v4, v1, 1, 1
    v_lshl_add_u32 v6, v4, 4, v6
    v_bfe_u32 v4, v1, 0, 1
    v_lshl_add_u32 v6, v4, 3, v6
    v_add_u32 v136, s56, v6
    v_xor_b32 v137, 16, v136
    v_xor_b32 v138, 32, v136
    v_xor_b32 v139, 48, v136
    v_xor_b32 v140, 64, v136
    v_xor_b32 v141, 80, v136
    v_xor_b32 v142, 96, v136
    v_xor_b32 v143, 112, v136
    v_xor_b32 v144, 128, v136
    v_xor_b32 v145, 144, v136
    v_xor_b32 v146, 160, v136
    v_xor_b32 v147, 176, v136
    v_xor_b32 v148, 192, v136
    v_xor_b32 v149, 208, v136
    v_xor_b32 v150, 224, v136
    v_xor_b32 v151, 240, v136
    s_lshl_b32 s85, s34, 13
    s_add_u32 s85, s85, 131072
    v_lshl_add_u32 v94, v1, 4, s85
    v_add_u32 v96, s85, v96
    v_add_u32 v97, s85, v97
    v_add_u32 v98, s85, v98
    v_add_u32 v99, s85, v99
    s_add_u32 s39, s56, s62
    s_mov_b32 m0, s39
    s_add_u32 s62, s62, 4096
    s_and_b32 s62, s62, 0x7fff
    buffer_load_dwordx4 v10, s[52:55], s95 offen offset:0 nt lds
    buffer_load_dwordx4 v11, s[52:55], s95 offen offset:1024 nt lds
    buffer_load_dwordx4 v12, s[52:55], s95 offen offset:2048 nt lds
    buffer_load_dwordx4 v13, s[52:55], s95 offen offset:3072 nt lds
    s_add_u32 s95, s95, 131072
    s_add_u32 s39, s56, s62
    s_mov_b32 m0, s39
    s_add_u32 s62, s62, 4096
    s_and_b32 s62, s62, 0x7fff
    buffer_load_dwordx4 v10, s[52:55], s95 offen offset:0 nt lds
    buffer_load_dwordx4 v11, s[52:55], s95 offen offset:1024 nt lds
    buffer_load_dwordx4 v12, s[52:55], s95 offen offset:2048 nt lds
    buffer_load_dwordx4 v13, s[52:55], s95 offen offset:3072 nt lds
    s_add_u32 s95, s95, 131072
    s_add_u32 s39, s56, s62
    s_mov_b32 m0, s39
    s_add_u32 s62, s62, 4096
    s_and_b32 s62, s62, 0x7fff
    buffer_load_dwordx4 v10, s[52:55], s95 offen offset:0 nt lds
    buffer_load_dwordx4 v11, s[52:55], s95 offen offset:1024 nt lds
    buffer_load_dwordx4 v12, s[52:55], s95 offen offset:2048 nt lds
    buffer_load_dwordx4 v13, s[52:55], s95 offen offset:3072 nt lds
    s_add_u32 s95, s95, 131072
    s_add_u32 s39, s56, s62
    s_mov_b32 m0, s39
    s_add_u32 s62, s62, 4096
    s_and_b32 s62, s62, 0x7fff
    buffer_load_dwordx4 v10, s[52:55], s95 offen offset:0 nt lds
    buffer_load_dwordx4 v11, s[52:55], s95 offen offset:1024 nt lds
    buffer_load_dwordx4 v12, s[52:55], s95 offen offset:2048 nt lds
    buffer_load_dwordx4 v13, s[52:55], s95 offen offset:3072 nt lds
    s_add_u32 s95, s95, 131072
    s_add_u32 s39, s56, s62
    s_mov_b32 m0, s39
    s_add_u32 s62, s62, 4096
    s_and_b32 s62, s62, 0x7fff
    buffer_load_dwordx4 v10, s[52:55], s95 offen offset:0 nt lds
    buffer_load_dwordx4 v11, s[52:55], s95 offen offset:1024 nt lds
    buffer_load_dwordx4 v12, s[52:55], s95 offen offset:2048 nt lds
    buffer_load_dwordx4 v13, s[52:55], s95 offen offset:3072 nt lds
    s_add_u32 s95, s95, 131072
    s_add_u32 s39, s56, s62
    s_mov_b32 m0, s39
    s_add_u32 s62, s62, 4096
    s_and_b32 s62, s62, 0x7fff
    buffer_load_dwordx4 v10, s[52:55], s95 offen offset:0 nt lds
    buffer_load_dwordx4 v11, s[52:55], s95 offen offset:1024 nt lds
    buffer_load_dwordx4 v12, s[52:55], s95 offen offset:2048 nt lds
    buffer_load_dwordx4 v13, s[52:55], s95 offen offset:3072 nt lds
    s_add_u32 s95, s95, 131072
    s_waitcnt lgkmcnt(0)
    s_add_u32 s35, s35, 0x5b
    s_and_b32 s35, s35, 0xff
    v_mov_b32 v8, s35
    s_or_b32 s68, s35, 0x6b3ac500
    s_getreg_b32 s70, hwreg(HW_REG_XCC_ID, 0, 4)
    s_lshl_b32 s70, s70, 8
    s_or_b32 s70, s70, s35
    s_or_b32 s70, s70, 0x5e9d0000
    s_bfe_u32 s38, s2, 0x30000
    s_lshl_b32 s38, s38, 8
    s_add_u32 s69, s38, 32768
    s_lshl_b32 s38, s32, 2
    s_add_u32 s69, s38, s69
    s_lshl_b32 s38, s34, 24
    s_add_u32 s69, s38, s69
    v_mov_b32 v4, s69
    v_mov_b32 v5, s70
    s_mov_b64 exec, 1
    buffer_store_dword v5, v4, s[48:51], 0 offen sc1
    s_mov_b64 exec, -1
    s_mov_b32 s52, s6
    s_and_b32 s53, s7, 0xffff
    s_mov_b32 s54, 16777216
    s_mov_b32 s55, 0x20000
    s_bfe_u32 s38, s32, 0x30000
    s_lshl_b32 s38, s38, 1
    s_add_u32 s3, s38, 0
    s_lshr_b32 s38, s32, 4
    s_lshl_b32 s38, s38, 0
    s_add_u32 s3, s38, s3
    s_bfe_u32 s94, s32, 0x10003
    s_lshl_b32 s38, s3, 20
    s_add_u32 s95, s38, 0
    s_lshl_b32 s38, s34, 8
    s_add_u32 s95, s38, s95
    s_waitcnt vmcnt(25)
    ds_read_b64_tr_b16 a[128:129], v136 offset:0
    ds_read_b64_tr_b16 a[130:131], v137 offset:1024
    ds_read_b64_tr_b16 a[144:145], v138 offset:0
    ds_read_b64_tr_b16 a[146:147], v139 offset:1024
    ds_read_b64_tr_b16 a[160:161], v140 offset:0
    ds_read_b64_tr_b16 a[162:163], v141 offset:1024
    ds_read_b64_tr_b16 a[176:177], v142 offset:0
    ds_read_b64_tr_b16 a[178:179], v143 offset:1024
    ds_read_b64_tr_b16 a[192:193], v144 offset:0
    ds_read_b64_tr_b16 a[194:195], v145 offset:1024
    ds_read_b64_tr_b16 a[208:209], v146 offset:0
    ds_read_b64_tr_b16 a[210:211], v147 offset:1024
    ds_read_b64_tr_b16 a[224:225], v148 offset:0
    ds_read_b64_tr_b16 a[226:227], v149 offset:1024
    ds_read_b64_tr_b16 a[240:241], v150 offset:0
    ds_read_b64_tr_b16 a[242:243], v151 offset:1024
    s_waitcnt lgkmcnt(0)
    s_add_u32 s39, s56, s62
    s_mov_b32 m0, s39
    s_add_u32 s62, s62, 4096
    s_and_b32 s62, s62, 0x7fff
    buffer_load_dwordx4 v76, s[52:55], s95 offen offset:0 nt lds
    buffer_load_dwordx4 v77, s[52:55], s95 offen offset:1024 nt lds
    buffer_load_dwordx4 v78, s[52:55], s95 offen offset:2048 nt lds
    buffer_load_dwordx4 v79, s[52:55], s95 offen offset:3072 nt lds
    s_add_u32 s95, s95, 16384
    s_add_u32 s39, s56, s62
    s_mov_b32 m0, s39
    s_add_u32 s62, s62, 4096
    s_and_b32 s62, s62, 0x7fff
    buffer_load_dwordx4 v76, s[52:55], s95 offen offset:0 nt lds
    buffer_load_dwordx4 v77, s[52:55], s95 offen offset:1024 nt lds
    buffer_load_dwordx4 v78, s[52:55], s95 offen offset:2048 nt lds
    buffer_load_dwordx4 v79, s[52:55], s95 offen offset:3072 nt lds
    s_add_u32 s95, s95, 16384
    s_waitcnt vmcnt(25)
    ds_read_b64_tr_b16 a[132:133], v136 offset:8192
    ds_read_b64_tr_b16 a[134:135], v137 offset:9216
    ds_read_b64_tr_b16 a[148:149], v138 offset:8192
    ds_read_b64_tr_b16 a[150:151], v139 offset:9216
    ds_read_b64_tr_b16 a[164:165], v140 offset:8192
    ds_read_b64_tr_b16 a[166:167], v141 offset:9216
    ds_read_b64_tr_b16 a[180:181], v142 offset:8192
    ds_read_b64_tr_b16 a[182:183], v143 offset:9216
    ds_read_b64_tr_b16 a[196:197], v144 offset:8192
    ds_read_b64_tr_b16 a[198:199], v145 offset:9216
    ds_read_b64_tr_b16 a[212:213], v146 offset:8192
    ds_read_b64_tr_b16 a[214:215], v147 offset:9216
    ds_read_b64_tr_b16 a[228:229], v148 offset:8192
    ds_read_b64_tr_b16 a[230:231], v149 offset:9216
    ds_read_b64_tr_b16 a[244:245], v150 offset:8192
    ds_read_b64_tr_b16 a[246:247], v151 offset:9216
    s_waitcnt lgkmcnt(0)
    s_add_u32 s39, s56, s62
    s_mov_b32 m0, s39
    s_add_u32 s62, s62, 4096
    s_and_b32 s62, s62, 0x7fff
    buffer_load_dwordx4 v76, s[52:55], s95 offen offset:0 nt lds
    buffer_load_dwordx4 v77, s[52:55], s95 offen offset:1024 nt lds
    buffer_load_dwordx4 v78, s[52:55], s95 offen offset:2048 nt lds
    buffer_load_dwordx4 v79, s[52:55], s95 offen offset:3072 nt lds
    s_add_u32 s95, s95, 16384
    s_add_u32 s39, s56, s62
    s_mov_b32 m0, s39
    s_add_u32 s62, s62, 4096
    s_and_b32 s62, s62, 0x7fff
    buffer_load_dwordx4 v76, s[52:55], s95 offen offset:0 nt lds
    buffer_load_dwordx4 v77, s[52:55], s95 offen offset:1024 nt lds
    buffer_load_dwordx4 v78, s[52:55], s95 offen offset:2048 nt lds
    buffer_load_dwordx4 v79, s[52:55], s95 offen offset:3072 nt lds
    s_add_u32 s95, s95, 16384
    s_waitcnt vmcnt(25)
    ds_read_b64_tr_b16 a[136:137], v136 offset:16384
    ds_read_b64_tr_b16 a[138:139], v137 offset:17408
    ds_read_b64_tr_b16 a[152:153], v138 offset:16384
    ds_read_b64_tr_b16 a[154:155], v139 offset:17408
    ds_read_b64_tr_b16 a[168:169], v140 offset:16384
    ds_read_b64_tr_b16 a[170:171], v141 offset:17408
    ds_read_b64_tr_b16 a[184:185], v142 offset:16384
    ds_read_b64_tr_b16 a[186:187], v143 offset:17408
    ds_read_b64_tr_b16 a[200:201], v144 offset:16384
    ds_read_b64_tr_b16 a[202:203], v145 offset:17408
    ds_read_b64_tr_b16 a[216:217], v146 offset:16384
    ds_read_b64_tr_b16 a[218:219], v147 offset:17408
    ds_read_b64_tr_b16 a[232:233], v148 offset:16384
    ds_read_b64_tr_b16 a[234:235], v149 offset:17408
    ds_read_b64_tr_b16 a[248:249], v150 offset:16384
    ds_read_b64_tr_b16 a[250:251], v151 offset:17408
    s_waitcnt lgkmcnt(0)
    s_add_u32 s39, s56, s62
    s_mov_b32 m0, s39
    s_add_u32 s62, s62, 4096
    s_and_b32 s62, s62, 0x7fff
    buffer_load_dwordx4 v76, s[52:55], s95 offen offset:0 nt lds
    buffer_load_dwordx4 v77, s[52:55], s95 offen offset:1024 nt lds
    buffer_load_dwordx4 v78, s[52:55], s95 offen offset:2048 nt lds
    buffer_load_dwordx4 v79, s[52:55], s95 offen offset:3072 nt lds
    s_add_u32 s95, s95, 16384
    s_add_u32 s39, s56, s62
    s_mov_b32 m0, s39
    s_add_u32 s62, s62, 4096
    s_and_b32 s62, s62, 0x7fff
    buffer_load_dwordx4 v76, s[52:55], s95 offen offset:0 nt lds
    buffer_load_dwordx4 v77, s[52:55], s95 offen offset:1024 nt lds
    buffer_load_dwordx4 v78, s[52:55], s95 offen offset:2048 nt lds
    buffer_load_dwordx4 v79, s[52:55], s95 offen offset:3072 nt lds
    s_add_u32 s95, s95, 16384
    s_waitcnt vmcnt(25)
    ds_read_b64_tr_b16 a[140:141], v136 offset:24576
    ds_read_b64_tr_b16 a[142:143], v137 offset:25600
    ds_read_b64_tr_b16 a[156:157], v138 offset:24576
    ds_read_b64_tr_b16 a[158:159], v139 offset:25600
    ds_read_b64_tr_b16 a[172:173], v140 offset:24576
    ds_read_b64_tr_b16 a[174:175], v141 offset:25600
    ds_read_b64_tr_b16 a[188:189], v142 offset:24576
    ds_read_b64_tr_b16 a[190:191], v143 offset:25600
    ds_read_b64_tr_b16 a[204:205], v144 offset:24576
    ds_read_b64_tr_b16 a[206:207], v145 offset:25600
    ds_read_b64_tr_b16 a[220:221], v146 offset:24576
    ds_read_b64_tr_b16 a[222:223], v147 offset:25600
    ds_read_b64_tr_b16 a[236:237], v148 offset:24576
    ds_read_b64_tr_b16 a[238:239], v149 offset:25600
    ds_read_b64_tr_b16 a[252:253], v150 offset:24576
    ds_read_b64_tr_b16 a[254:255], v151 offset:25600
    s_waitcnt lgkmcnt(0)
    s_add_u32 s39, s56, s62
    s_mov_b32 m0, s39
    s_add_u32 s62, s62, 4096
    s_and_b32 s62, s62, 0x7fff
    buffer_load_dwordx4 v76, s[52:55], s95 offen offset:0 nt lds
    buffer_load_dwordx4 v77, s[52:55], s95 offen offset:1024 nt lds
    s_mov_b32 s86, 98304
    buffer_load_dword v7, v101, s[48:51], s86 offen sc1
    v_mov_b32 v104, 0
    v_mov_b32 v105, 0
    v_mov_b32 v106, 0
    v_mov_b32 v107, 0
    v_mov_b32 v108, 0
    v_mov_b32 v109, 0
    v_mov_b32 v110, 0
    v_mov_b32 v111, 0
    v_mov_b32 v112, 0
    v_mov_b32 v113, 0
    v_mov_b32 v114, 0
    v_mov_b32 v115, 0
    v_mov_b32 v116, 0
    v_mov_b32 v117, 0
    v_mov_b32 v118, 0
    v_mov_b32 v119, 0
    v_mov_b32 v120, 0
    v_mov_b32 v121, 0
    v_mov_b32 v122, 0
    v_mov_b32 v123, 0
    v_mov_b32 v124, 0
    v_mov_b32 v125, 0
    v_mov_b32 v126, 0
    v_mov_b32 v127, 0
    v_mov_b32 v128, 0
    v_mov_b32 v129, 0
    v_mov_b32 v130, 0
    v_mov_b32 v131, 0
    v_mov_b32 v132, 0
    v_mov_b32 v133, 0
    v_mov_b32 v134, 0
    v_mov_b32 v135, 0
    v_mov_b32 v90, 0xff7f0000
    s_mov_b32 s93, 0
    v_mov_b32 v102, 0
    v_mov_b32 v103, 0
    s_mov_b32 s60, s83
    s_mov_b32 s61, s83
    v_xor_b32 v5, v3, v2
    v_lshlrev_b32 v6, 8, v3
    v_bfe_u32 v4, v5, 0, 2
    v_lshl_add_u32 v6, v4, 6, v6
    v_lshrrev_b32 v4, 2, v3
    v_lshl_add_u32 v6, v4, 4, v6
    v_add_u32 v52, s85, v6
    v_xor_b32 v53, 16, v52
    v_xor_b32 v54, 32, v52
    v_xor_b32 v55, 48, v52
    s_lshr_b32 s38, s3, 2
    s_lshl_b32 s38, s38, 15
    s_add_u32 s36, s38, 393216
    s_lshl_b32 s38, s94, 14
    s_add_u32 s36, s38, s36
    s_lshl_b32 s38, s34, 8
    s_add_u32 s36, s38, s36
    s_waitcnt vmcnt(0)
L_fcheck_18:
    v_cmp_ne_u32 vcc, s68, v7
    s_cbranch_vccz L_fok_19
    s_sleep 2
    s_mov_b32 s86, 98304
    buffer_load_dword v7, v101, s[48:51], s86 offen sc1
    s_waitcnt vmcnt(0)
    s_sub_u32 s84, s84, 1
    s_cmp_lg_u32 s84, 0
    s_cbranch_scc1 L_fcheck_18
    s_branch L_end
L_fok_19:
    buffer_load_dwordx4 v[200:203], v9, s[48:51], s36 offen sc1
    s_add_u32 s36, s36, 4096
    buffer_load_dwordx4 v[204:207], v9, s[48:51], s36 offen sc1
    s_add_u32 s36, s36, 4096
    buffer_load_dwordx4 v[208:211], v9, s[48:51], s36 offen sc1
    s_add_u32 s36, s36, 4096
    buffer_load_dwordx4 v[212:215], v9, s[48:51], s36 offen sc1
    ds_read_b128 v[136:139], v60 offset:0
    ds_read_b128 v[140:143], v61 offset:0
    ds_read_b128 v[144:147], v62 offset:0
    ds_read_b128 v[148:151], v63 offset:0
    ds_read_b128 v[152:155], v60 offset:4096
    ds_read_b128 v[156:159], v61 offset:4096
    ds_read_b128 v[160:163], v62 offset:4096
    ds_read_b128 v[164:167], v63 offset:4096
    ds_read_b128 v[168:171], v60 offset:8192
    ds_read_b128 v[172:175], v61 offset:8192
    ds_read_b128 v[176:179], v62 offset:8192
    ds_read_b128 v[180:183], v63 offset:8192
    ds_read_b128 v[184:187], v60 offset:12288
    ds_read_b128 v[188:191], v61 offset:12288
    ds_read_b128 v[192:195], v62 offset:12288
    ds_read_b128 v[196:199], v63 offset:12288
    s_waitcnt vmcnt(3)
    ds_write_b128 v96, v[200:203] offset:0
    s_waitcnt vmcnt(2)
    ds_write_b128 v97, v[204:207] offset:1024
    s_waitcnt vmcnt(1)
    ds_write_b128 v98, v[208:211] offset:2048
    s_waitcnt vmcnt(0)
    ds_write_b128 v99, v[212:215] offset:3072
    s_waitcnt lgkmcnt(0)
    ds_read_b128 v[36:39], v52
    ds_read_b128 v[40:43], v53
    ds_read_b128 v[44:47], v54
    ds_read_b128 v[48:51], v55
L_att:
    s_waitcnt lgkmcnt(0)
    v_mfma_f32_16x16x32_bf16 v[200:203], v[136:139], v[36:39], 0
    ds_read_b64_tr_b16 a[0:1], v82 offset:0
    ds_read_b64_tr_b16 a[2:3], v82 offset:4096
    buffer_load_dwordx4 v78, s[52:55], s95 offen offset:2048 nt lds
    v_mfma_f32_16x16x32_bf16 v[200:203], v[140:143], v[40:43], v[200:203]
    ds_read_b64_tr_b16 a[4:5], v83 offset:0
    ds_read_b64_tr_b16 a[6:7], v83 offset:4096
    v_mfma_f32_16x16x32_bf16 v[200:203], v[144:147], v[44:47], v[200:203]
    ds_read_b64_tr_b16 a[8:9], v84 offset:0
    ds_read_b64_tr_b16 a[10:11], v84 offset:4096
    v_mfma_f32_16x16x32_bf16 v[200:203], v[148:151], v[48:51], v[200:203]
    ds_read_b64_tr_b16 a[12:13], v85 offset:0
    ds_read_b64_tr_b16 a[14:15], v85 offset:4096
    buffer_load_dwordx4 v79, s[52:55], s95 offen offset:3072 nt lds
    s_add_u32 s95, s95, 16384
    v_mfma_f32_16x16x32_bf16 v[204:207], v[152:155], v[36:39], 0
    ds_read_b64_tr_b16 a[16:17], v86 offset:0
    ds_read_b64_tr_b16 a[18:19], v86 offset:4096
    v_mfma_f32_16x16x32_bf16 v[204:207], v[156:159], v[40:43], v[204:207]
    ds_read_b64_tr_b16 a[20:21], v87 offset:0
    ds_read_b64_tr_b16 a[22:23], v87 offset:4096
    v_mfma_f32_16x16x32_bf16 v[204:207], v[160:163], v[44:47], v[204:207]
    ds_read_b64_tr_b16 a[24:25], v88 offset:0
    ds_read_b64_tr_b16 a[26:27], v88 offset:4096
    s_add_u32 s39, s56, s62
    s_mov_b32 m0, s39
    s_add_u32 s62, s62, 4096
    s_and_b32 s62, s62, 0x7fff
    buffer_load_dwordx4 v76, s[52:55], s95 offen offset:0 nt lds
    v_mfma_f32_16x16x32_bf16 v[204:207], v[164:167], v[48:51], v[204:207]
    ds_read_b64_tr_b16 a[28:29], v89 offset:0
    ds_read_b64_tr_b16 a[30:31], v89 offset:4096
    ds_write_b128 v94, v[200:203] offset:0
    v_mfma_f32_16x16x32_bf16 v[208:211], v[168:171], v[36:39], 0
    ds_read_b64_tr_b16 a[32:33], v82 offset:8192
    ds_read_b64_tr_b16 a[34:35], v82 offset:12288
    v_mfma_f32_16x16x32_bf16 v[208:211], v[172:175], v[40:43], v[208:211]
    ds_read_b64_tr_b16 a[36:37], v83 offset:8192
    ds_read_b64_tr_b16 a[38:39], v83 offset:12288
    buffer_load_dwordx4 v77, s[52:55], s95 offen offset:1024 nt lds
    v_mfma_f32_16x16x32_bf16 v[208:211], v[176:179], v[44:47], v[208:211]
    ds_read_b64_tr_b16 a[40:41], v84 offset:8192
    ds_read_b64_tr_b16 a[42:43], v84 offset:12288
    v_mfma_f32_16x16x32_bf16 v[208:211], v[180:183], v[48:51], v[208:211]
    ds_read_b64_tr_b16 a[44:45], v85 offset:8192
    ds_read_b64_tr_b16 a[46:47], v85 offset:12288
    ds_write_b128 v94, v[204:207] offset:1024
    v_mfma_f32_16x16x32_bf16 v[212:215], v[184:187], v[36:39], 0
    ds_read_b64_tr_b16 a[48:49], v86 offset:8192
    ds_read_b64_tr_b16 a[50:51], v86 offset:12288
    buffer_load_dwordx4 v78, s[52:55], s95 offen offset:2048 nt lds
    v_mfma_f32_16x16x32_bf16 v[212:215], v[188:191], v[40:43], v[212:215]
    ds_read_b64_tr_b16 a[52:53], v87 offset:8192
    ds_read_b64_tr_b16 a[54:55], v87 offset:12288
    v_mfma_f32_16x16x32_bf16 v[212:215], v[192:195], v[44:47], v[212:215]
    ds_read_b64_tr_b16 a[56:57], v88 offset:8192
    ds_read_b64_tr_b16 a[58:59], v88 offset:12288
    v_mfma_f32_16x16x32_bf16 v[212:215], v[196:199], v[48:51], v[212:215]
    ds_read_b64_tr_b16 a[60:61], v89 offset:8192
    ds_read_b64_tr_b16 a[62:63], v89 offset:12288
    buffer_load_dwordx4 v79, s[52:55], s95 offen offset:3072 nt lds
    s_add_u32 s95, s95, 16384
    ds_write_b128 v94, v[208:211] offset:2048
    v_xor_b32 v5, 0x2000, v94
    v_xor_b32 v6, 0x4000, v94
    v_xor_b32 v7, 0x6000, v94
    s_cmp_eq_u32 s93, 14
    s_cselect_b32 s95, 16777216, s95
    ds_write_b128 v94, v[212:215] offset:3072
    v_xor_b32 v82, 0x4000, v82
    v_xor_b32 v83, 0x4000, v83
    v_xor_b32 v84, 0x4000, v84
    v_xor_b32 v85, 0x4000, v85
    v_xor_b32 v86, 0x4000, v86
    v_xor_b32 v87, 0x4000, v87
    v_xor_b32 v88, 0x4000, v88
    v_xor_b32 v89, 0x4000, v89
    v_xor_b32 v60, 0x4000, v60
    v_xor_b32 v61, 0x4000, v61
    v_xor_b32 v62, 0x4000, v62
    v_xor_b32 v63, 0x4000, v63
    s_waitcnt lgkmcnt(0)
    s_barrier
    ds_read_b128 v[136:139], v5 offset:0
    ds_read_b128 v[152:155], v6 offset:0
    ds_read_b128 v[168:171], v7 offset:0
    ds_read_b128 v[140:143], v5 offset:1024
    ds_read_b128 v[156:159], v6 offset:1024
    ds_read_b128 v[172:175], v7 offset:1024
    ds_read_b128 v[144:147], v5 offset:2048
    ds_read_b128 v[160:163], v6 offset:2048
    ds_read_b128 v[176:179], v7 offset:2048
    ds_read_b128 v[148:151], v5 offset:3072
    ds_read_b128 v[164:167], v6 offset:3072
    ds_read_b128 v[180:183], v7 offset:3072
    v_xor_b32 v94, 0x1000, v94
    s_add_u32 s39, s56, s62
    s_mov_b32 m0, s39
    s_add_u32 s62, s62, 4096
    s_and_b32 s62, s62, 0x7fff
    buffer_load_dwordx4 v76, s[52:55], s95 offen offset:0 nt lds
    buffer_load_dwordx4 v77, s[52:55], s95 offen offset:1024 nt lds
    buffer_load_dwordx4 v78, s[52:55], s95 offen offset:2048 nt lds
    s_waitcnt lgkmcnt(9)
    v_pk_add_f32 v[200:201], v[200:201], v[136:137]
    v_pk_add_f32 v[152:153], v[152:153], v[168:169]
    v_pk_add_f32 v[202:203], v[202:203], v[138:139]
    v_pk_add_f32 v[154:155], v[154:155], v[170:171]
    v_pk_add_f32 v[200:201], v[200:201], v[152:153]
    v_pk_add_f32 v[202:203], v[202:203], v[154:155]
    s_waitcnt lgkmcnt(6)
    v_pk_add_f32 v[204:205], v[204:205], v[140:141]
    v_pk_add_f32 v[156:157], v[156:157], v[172:173]
    v_pk_add_f32 v[206:207], v[206:207], v[142:143]
    v_pk_add_f32 v[158:159], v[158:159], v[174:175]
    v_pk_add_f32 v[204:205], v[204:205], v[156:157]
    v_pk_add_f32 v[206:207], v[206:207], v[158:159]
    s_waitcnt lgkmcnt(3)
    v_pk_add_f32 v[208:209], v[208:209], v[144:145]
    v_pk_add_f32 v[160:161], v[160:161], v[176:177]
    v_pk_add_f32 v[210:211], v[210:211], v[146:147]
    v_pk_add_f32 v[162:163], v[162:163], v[178:179]
    v_pk_add_f32 v[208:209], v[208:209], v[160:161]
    v_pk_add_f32 v[210:211], v[210:211], v[162:163]
    s_waitcnt lgkmcnt(0)
    v_pk_add_f32 v[212:213], v[212:213], v[148:149]
    v_pk_add_f32 v[164:165], v[164:165], v[180:181]
    v_pk_add_f32 v[214:215], v[214:215], v[150:151]
    v_pk_add_f32 v[166:167], v[166:167], v[182:183]
    v_pk_add_f32 v[212:213], v[212:213], v[164:165]
    v_pk_add_f32 v[214:215], v[214:215], v[166:167]
    buffer_load_dwordx4 v79, s[52:55], s95 offen offset:3072 nt lds
    s_add_u32 s95, s95, 16384
    s_waitcnt vmcnt(4)
    v_max_f32 v4, v200, v201
    v_max3_f32 v4, v4, v202, v203
    v_max3_f32 v4, v4, v204, v205
    v_max3_f32 v4, v4, v206, v207
    v_max3_f32 v4, v4, v208, v209
    v_max3_f32 v4, v4, v210, v211
    v_max3_f32 v4, v4, v212, v213
    v_max3_f32 v4, v4, v214, v215
    v_mov_b32 v5, v4
    ds_read_b128 v[136:139], v60 offset:0
    ds_read_b128 v[140:143], v61 offset:0
    v_permlane16_swap_b32 v4, v5
    v_max_f32 v4, v4, v5
    v_mov_b32 v5, v4
    ds_read_b128 v[144:147], v62 offset:0
    ds_read_b128 v[148:151], v63 offset:0
    v_permlane32_swap_b32 v4, v5
    v_max_f32 v4, v4, v5
    v_mul_f32 v4, s83, v4
    v_max_f32 v4, v4, v90
    v_sub_f32 v92, v90, v4
    v_exp_f32 v92, v92
    v_mov_b32 v90, v4
    s_add_u32 s39, s56, s62
    s_mov_b32 m0, s39
    s_add_u32 s62, s62, 4096
    s_and_b32 s62, s62, 0x7fff
    buffer_load_dwordx4 v76, s[52:55], s95 offen offset:0 nt lds
    v_pk_fma_f32 v[200:201], v[200:201], s[60:61], v[90:91] op_sel_hi:[1,1,0] neg_lo:[0,0,1] neg_hi:[0,0,1]
    v_pk_fma_f32 v[202:203], v[202:203], s[60:61], v[90:91] op_sel_hi:[1,1,0] neg_lo:[0,0,1] neg_hi:[0,0,1]
    v_pk_fma_f32 v[204:205], v[204:205], s[60:61], v[90:91] op_sel_hi:[1,1,0] neg_lo:[0,0,1] neg_hi:[0,0,1]
    v_pk_fma_f32 v[206:207], v[206:207], s[60:61], v[90:91] op_sel_hi:[1,1,0] neg_lo:[0,0,1] neg_hi:[0,0,1]
    v_pk_fma_f32 v[208:209], v[208:209], s[60:61], v[90:91] op_sel_hi:[1,1,0] neg_lo:[0,0,1] neg_hi:[0,0,1]
    v_pk_fma_f32 v[210:211], v[210:211], s[60:61], v[90:91] op_sel_hi:[1,1,0] neg_lo:[0,0,1] neg_hi:[0,0,1]
    v_pk_fma_f32 v[212:213], v[212:213], s[60:61], v[90:91] op_sel_hi:[1,1,0] neg_lo:[0,0,1] neg_hi:[0,0,1]
    v_pk_fma_f32 v[214:215], v[214:215], s[60:61], v[90:91] op_sel_hi:[1,1,0] neg_lo:[0,0,1] neg_hi:[0,0,1]
    v_exp_f32 v200, v200
    v_exp_f32 v201, v201
    ds_read_b128 v[152:155], v60 offset:4096
    v_exp_f32 v202, v202
    v_exp_f32 v203, v203
    v_exp_f32 v204, v204
    v_exp_f32 v205, v205
    ds_read_b128 v[156:159], v61 offset:4096
    v_exp_f32 v206, v206
    v_exp_f32 v207, v207
    buffer_load_dwordx4 v77, s[52:55], s95 offen offset:1024 nt lds
    v_exp_f32 v208, v208
    v_exp_f32 v209, v209
    ds_read_b128 v[160:163], v62 offset:4096
    v_exp_f32 v210, v210
    v_exp_f32 v211, v211
    v_exp_f32 v212, v212
    v_exp_f32 v213, v213
    ds_read_b128 v[164:167], v63 offset:4096
    v_exp_f32 v214, v214
    v_exp_f32 v215, v215
    buffer_load_dwordx4 v78, s[52:55], s95 offen offset:2048 nt lds
    v_pk_mul_f32 v[102:103], v[102:103], v[92:93] op_sel_hi:[1,0]
    v_pk_mul_f32 v[104:105], v[104:105], v[92:93] op_sel_hi:[1,0]
    v_pk_mul_f32 v[106:107], v[106:107], v[92:93] op_sel_hi:[1,0]
    v_pk_mul_f32 v[108:109], v[108:109], v[92:93] op_sel_hi:[1,0]
    v_pk_mul_f32 v[110:111], v[110:111], v[92:93] op_sel_hi:[1,0]
    v_pk_mul_f32 v[112:113], v[112:113], v[92:93] op_sel_hi:[1,0]
    v_pk_mul_f32 v[114:115], v[114:115], v[92:93] op_sel_hi:[1,0]
    v_pk_mul_f32 v[116:117], v[116:117], v[92:93] op_sel_hi:[1,0]
    v_pk_mul_f32 v[118:119], v[118:119], v[92:93] op_sel_hi:[1,0]
    v_pk_mul_f32 v[120:121], v[120:121], v[92:93] op_sel_hi:[1,0]
    v_pk_mul_f32 v[122:123], v[122:123], v[92:93] op_sel_hi:[1,0]
    v_pk_mul_f32 v[124:125], v[124:125], v[92:93] op_sel_hi:[1,0]
    v_pk_mul_f32 v[126:127], v[126:127], v[92:93] op_sel_hi:[1,0]
    v_pk_mul_f32 v[128:129], v[128:129], v[92:93] op_sel_hi:[1,0]
    v_pk_mul_f32 v[130:131], v[130:131], v[92:93] op_sel_hi:[1,0]
    v_pk_mul_f32 v[132:133], v[132:133], v[92:93] op_sel_hi:[1,0]
    v_pk_mul_f32 v[134:135], v[134:135], v[92:93] op_sel_hi:[1,0]
    buffer_load_dwordx4 v79, s[52:55], s95 offen offset:3072 nt lds
    s_add_u32 s95, s95, 16384
    v_cvt_pk_bf16_f32 v52, v200, v201
    v_pk_add_f32 v[102:103], v[102:103], v[200:201]
    v_cvt_pk_bf16_f32 v53, v202, v203
    v_pk_add_f32 v[102:103], v[102:103], v[202:203]
    v_cvt_pk_bf16_f32 v54, v204, v205
    v_pk_add_f32 v[102:103], v[102:103], v[204:205]
    v_cvt_pk_bf16_f32 v55, v206, v207
    v_pk_add_f32 v[102:103], v[102:103], v[206:207]
    v_cvt_pk_bf16_f32 v56, v208, v209
    v_pk_add_f32 v[102:103], v[102:103], v[208:209]
    v_cvt_pk_bf16_f32 v57, v210, v211
    v_pk_add_f32 v[102:103], v[102:103], v[210:211]
    v_cvt_pk_bf16_f32 v58, v212, v213
    v_pk_add_f32 v[102:103], v[102:103], v[212:213]
    v_cvt_pk_bf16_f32 v59, v214, v215
    v_pk_add_f32 v[102:103], v[102:103], v[214:215]
    v_mfma_f32_16x16x32_bf16 v[104:107], a[0:3], v[52:55], v[104:107]
    ds_read_b128 v[168:171], v60 offset:8192
    v_mfma_f32_16x16x32_bf16 v[108:111], a[4:7], v[52:55], v[108:111]
    ds_read_b128 v[172:175], v61 offset:8192
    v_mfma_f32_16x16x32_bf16 v[112:115], a[8:11], v[52:55], v[112:115]
    ds_read_b128 v[176:179], v62 offset:8192
    v_mfma_f32_16x16x32_bf16 v[116:119], a[12:15], v[52:55], v[116:119]
    ds_read_b128 v[180:183], v63 offset:8192
    v_mfma_f32_16x16x32_bf16 v[120:123], a[16:19], v[52:55], v[120:123]
    ds_read_b128 v[184:187], v60 offset:12288
    v_mfma_f32_16x16x32_bf16 v[124:127], a[20:23], v[52:55], v[124:127]
    ds_read_b128 v[188:191], v61 offset:12288
    v_mfma_f32_16x16x32_bf16 v[128:131], a[24:27], v[52:55], v[128:131]
    ds_read_b128 v[192:195], v62 offset:12288
    v_mfma_f32_16x16x32_bf16 v[132:135], a[28:31], v[52:55], v[132:135]
    ds_read_b128 v[196:199], v63 offset:12288
    v_mfma_f32_16x16x32_bf16 v[104:107], a[32:35], v[56:59], v[104:107]
    v_mfma_f32_16x16x32_bf16 v[108:111], a[36:39], v[56:59], v[108:111]
    s_add_u32 s39, s56, s62
    s_mov_b32 m0, s39
    s_add_u32 s62, s62, 4096
    s_and_b32 s62, s62, 0x7fff
    buffer_load_dwordx4 v76, s[52:55], s95 offen offset:0 nt lds
    v_mfma_f32_16x16x32_bf16 v[112:115], a[40:43], v[56:59], v[112:115]
    v_mfma_f32_16x16x32_bf16 v[116:119], a[44:47], v[56:59], v[116:119]
    v_mfma_f32_16x16x32_bf16 v[120:123], a[48:51], v[56:59], v[120:123]
    v_mfma_f32_16x16x32_bf16 v[124:127], a[52:55], v[56:59], v[124:127]
    buffer_load_dwordx4 v77, s[52:55], s95 offen offset:1024 nt lds
    v_mfma_f32_16x16x32_bf16 v[128:131], a[56:59], v[56:59], v[128:131]
    v_mfma_f32_16x16x32_bf16 v[132:135], a[60:63], v[56:59], v[132:135]
    s_add_u32 s93, s93, 1
    s_cmp_lt_u32 s93, 16
    s_cbranch_scc1 L_att
    v_add_f32 v91, v102, v103
    v_mov_b32 v5, v91
    s_nop 1
    v_permlane16_swap_b32 v91, v5
    v_add_f32 v91, v91, v5
    v_mov_b32 v5, v91
    s_nop 1
    v_permlane32_swap_b32 v91, v5
    v_add_f32 v91, v91, v5
    v_lshrrev_b32 v6, 1, v2
    v_xor_b32 v6, v6, v3
    v_lshlrev_b32 v5, 8, v3
    v_lshl_add_u32 v5, v6, 4, v5
    v_bfe_u32 v4, v2, 0, 1
    v_lshl_add_u32 v5, v4, 3, v5
    v_add_u32 v5, s85, v5
    s_waitcnt vmcnt(0) lgkmcnt(0)
    s_barrier
    v_cvt_pk_bf16_f32 v216, v104, v105
    v_cvt_pk_bf16_f32 v217, v106, v107
    v_xor_b32 v82, 0, v5
    ds_write_b64 v82, v[216:217]
    v_cvt_pk_bf16_f32 v218, v108, v109
    v_cvt_pk_bf16_f32 v219, v110, v111
    v_xor_b32 v83, 32, v5
    ds_write_b64 v83, v[218:219]
    v_cvt_pk_bf16_f32 v220, v112, v113
    v_cvt_pk_bf16_f32 v221, v114, v115
    v_xor_b32 v84, 64, v5
    ds_write_b64 v84, v[220:221]
    v_cvt_pk_bf16_f32 v222, v116, v117
    v_cvt_pk_bf16_f32 v223, v118, v119
    v_xor_b32 v85, 96, v5
    ds_write_b64 v85, v[222:223]
    v_cvt_pk_bf16_f32 v224, v120, v121
    v_cvt_pk_bf16_f32 v225, v122, v123
    v_xor_b32 v86, 128, v5
    ds_write_b64 v86, v[224:225]
    v_cvt_pk_bf16_f32 v226, v124, v125
    v_cvt_pk_bf16_f32 v227, v126, v127
    v_xor_b32 v87, 160, v5
    ds_write_b64 v87, v[226:227]
    v_cvt_pk_bf16_f32 v228, v128, v129
    v_cvt_pk_bf16_f32 v229, v130, v131
    v_xor_b32 v88, 192, v5
    ds_write_b64 v88, v[228:229]
    v_cvt_pk_bf16_f32 v230, v132, v133
    v_cvt_pk_bf16_f32 v231, v134, v135
    v_xor_b32 v89, 224, v5
    ds_write_b64 v89, v[230:231]
    v_xor_b32 v6, v3, v2
    v_lshlrev_b32 v6, 4, v6
    v_lshl_add_u32 v4, v2, 8, v6
    v_add_u32 v4, s85, v4
    v_xor_b32 v60, 0, v4
    v_xor_b32 v61, 64, v4
    v_xor_b32 v62, 128, v4
    v_xor_b32 v63, 192, v4
    v_lshlrev_b32 v7, 4, v3
    v_lshl_add_u32 v7, v2, 14, v7
    s_lshl_b32 s38, s94, 18
    s_add_u32 s36, s38, 2097152
    s_lshl_b32 s38, s3, 10
    s_add_u32 s36, s38, s36
    s_lshl_b32 s38, s34, 8
    s_add_u32 s36, s38, s36
    s_waitcnt lgkmcnt(0)
    ds_read_b128 v[200:203], v60 offset:0
    ds_read_b128 v[204:207], v61 offset:1024
    ds_read_b128 v[208:211], v62 offset:2048
    ds_read_b128 v[212:215], v63 offset:3072
    v_lshlrev_b32 v4, 3, v3
    s_lshl_b32 s38, s3, 8
    s_add_u32 s37, s38, 163840
    s_lshl_b32 s38, s94, 7
    s_add_u32 s37, s38, s37
    s_lshl_b32 s38, s34, 23
    s_add_u32 s37, s38, s37
    s_mov_b32 exec_lo, 0xffff
    s_mov_b32 exec_hi, 0x0
    buffer_store_dwordx2 v[90:91], v4, s[48:51], s37 offen sc1
    s_mov_b64 exec, -1
    s_waitcnt lgkmcnt(3)
    buffer_store_dwordx4 v[200:203], v7, s[48:51], s36 offen sc1
    s_add_u32 s36, s36, 65536
    s_waitcnt lgkmcnt(2)
    buffer_store_dwordx4 v[204:207], v7, s[48:51], s36 offen sc1
    s_add_u32 s36, s36, 65536
    s_waitcnt lgkmcnt(1)
    buffer_store_dwordx4 v[208:211], v7, s[48:51], s36 offen sc1
    s_add_u32 s36, s36, 65536
    s_waitcnt lgkmcnt(0)
    buffer_store_dwordx4 v[212:215], v7, s[48:51], s36 offen sc1
    s_bfe_u32 s38, s2, 0x20001
    s_lshl_b32 s38, s38, 0
    s_add_u32 s90, s38, 0
    s_bfe_u32 s38, s2, 0x10000
    s_lshl_b32 s38, s38, 2
    s_add_u32 s90, s38, s90
    s_and_b32 s36, s90, 3
    s_bitcmp0_b32 s90, 2
    s_cselect_b64 s[40:41], s[24:25], s[14:15]
    s_cselect_b32 s45, 262144, 0
    s_add_u32 s45, s45, 524288
    s_lshl_b32 s38, s36, 16
    s_add_u32 s71, s38, s45
    s_lshr_b32 s38, s32, 2
    s_lshl_b32 s38, s38, 13
    s_add_u32 s71, s38, s71
    s_bfe_u32 s38, s32, 0x20000
    s_lshl_b32 s38, s38, 6
    s_add_u32 s71, s38, s71
    s_mov_b32 s42, 4194304
    s_mov_b32 s43, 0x20000
    s_lshl_b32 s38, s32, 17
    s_add_u32 s44, s38, 0
    s_lshl_b32 s38, s34, 15
    s_add_u32 s44, s38, s44
    s_lshl_b32 s38, s36, 8
    s_add_u32 s44, s38, s44
    s_lshl_b32 s38, s36, 16
    s_add_u32 s45, s38, s45
    s_lshr_b32 s38, s34, 1
    s_lshl_b32 s38, s38, 15
    s_add_u32 s45, s38, s45
    s_lshl_b32 s38, s32, 8
    s_add_u32 s45, s38, s45
    s_bfe_u32 s38, s34, 0x10000
    s_lshl_b32 s38, s38, 7
    s_add_u32 s45, s38, s45
    s_lshl_b32 s38, s32, 11
    s_add_u32 s46, s38, 196608
    s_lshl_b32 s38, s34, 9
    s_add_u32 s46, s38, s46
    s_mov_b32 s72, s26
    s_and_b32 s73, s27, 0xffff
    s_mov_b32 s74, 8192
    s_mov_b32 s75, 0x20000
    s_lshl_b32 s39, s34, 13
    s_add_u32 s39, s39, 98304
    s_mov_b32 m0, s39
    s_nop 0
    buffer_load_dwordx4 v76, s[40:43], s44 offen offset:0 nt lds
    buffer_load_dwordx4 v77, s[40:43], s44 offen offset:1024 nt lds
    buffer_load_dwordx4 v78, s[40:43], s44 offen offset:2048 nt lds
    buffer_load_dwordx4 v79, s[40:43], s44 offen offset:3072 nt lds
    s_lshl_b32 s39, s34, 13
    s_add_u32 s39, s39, 102400
    s_mov_b32 m0, s39
    s_add_u32 s44, s44, 16384
    buffer_load_dwordx4 v76, s[40:43], s44 offen offset:0 nt lds
    buffer_load_dwordx4 v77, s[40:43], s44 offen offset:1024 nt lds
    buffer_load_dwordx4 v78, s[40:43], s44 offen offset:2048 nt lds
    buffer_load_dwordx4 v79, s[40:43], s44 offen offset:3072 nt lds
    v_lshlrev_b32 v30, 4, v3
    v_lshl_add_u32 v30, v2, 13, v30
    v_lshrrev_b32 v5, 2, v1
    v_lshlrev_b32 v32, 8, v5
    v_bfe_u32 v5, v1, 0, 2
    v_lshl_add_u32 v32, v5, 4, v32
    s_xor_b32 s37, s90, 4
    s_bfe_u32 s38, s37, 0x30000
    s_lshl_b32 s38, s38, 8
    s_add_u32 s36, s38, 0
    s_lshr_b32 s38, s32, 4
    s_lshl_b32 s38, s38, 7
    s_add_u32 s36, s38, s36
    s_bfe_u32 s38, s32, 0x20000
    s_lshl_b32 s38, s38, 5
    s_add_u32 s36, s38, s36
    s_bfe_u32 s38, s32, 0x20002
    s_lshl_b32 s38, s38, 3
    s_add_u32 s36, s38, s36
    v_bfe_u32 v5, v1, 0, 2
    v_lshlrev_b32 v33, 11, v5
    v_lshl_add_u32 v33, v2, 1, v33
    v_add_u32 v33, s36, v33
    v_and_b32 v5, 31, v1
    v_lshlrev_b32 v34, 4, v5
    s_mul_i32 s38, s34, 320
    s_add_u32 s38, s38, 135168
    v_lshl_add_u32 v35, v5, 3, s38
    s_bfe_u32 s38, s34, 0x10000
    s_lshl_b32 s38, s38, 12
    s_add_u32 s36, s38, s71
    s_lshr_b32 s38, s34, 1
    s_lshl_b32 s38, s38, 24
    s_add_u32 s36, s38, s36
    s_bitcmp1_b32 s90, 2
    s_cselect_b32 s46, s46, s36
    s_cselect_b64 vcc, -1, 0
    v_cndmask_b32 v54, v32, v34, vcc
    s_bfe_u32 s38, s2, 0x30000
    s_lshl_b32 s38, s38, 8
    s_add_u32 s69, s38, 32768
    v_lshrrev_b32 v64, 2, v34
    buffer_load_dword v64, v64, s[48:51], s69 offen sc1
    v_bfe_u32 v5, v3, 0, 2
    v_lshlrev_b32 v81, 10, v5
    v_lshrrev_b32 v5, 2, v3
    v_lshl_add_u32 v81, v5, 8, v81
    v_add3_u32 v82, v81, v6, s85
    v_xor_b32 v83, 64, v82
    v_xor_b32 v84, 128, v82
    v_xor_b32 v85, 192, v82
    v_bfe_u32 v5, v3, 0, 2
    v_lshlrev_b32 v94, 9, v5
    v_lshl_add_u32 v94, v2, 4, v94
    v_add_u32 v94, s85, v94
    s_lshl_b32 s38, s34, 9
    s_add_u32 s38, s38, 131072
    v_add_u32 v102, s38, v34
    s_lshl_b32 s38, s32, 14
    s_add_u32 s36, s38, 2097152
    s_lshl_b32 s38, s34, 8
    s_add_u32 s36, s38, s36
    s_lshl_b32 s38, s32, 3
    s_add_u32 s37, s38, 163840
    s_lshl_b32 s38, s32, 8
    s_add_u32 s69, s38, 131072
    s_lshl_b32 s38, s34, 23
    s_add_u32 s69, s38, s69
    v_mov_b32 v4, s69
    v_mov_b32 v5, s68
    s_waitcnt vmcnt(9)
    s_barrier
    s_mov_b64 exec, 1
    buffer_store_dword v5, v4, s[48:51], 0 offen sc1
    s_mov_b64 exec, -1
    s_mov_b32 s86, 131072
    buffer_load_dword v7, v101, s[48:51], s86 offen sc1
    s_waitcnt vmcnt(0)
L_fcheck_20:
    v_cmp_ne_u32 vcc, s68, v7
    s_cbranch_vccz L_fok_21
    s_sleep 2
    s_mov_b32 s86, 131072
    buffer_load_dword v7, v101, s[48:51], s86 offen sc1
    s_waitcnt vmcnt(0)
    s_sub_u32 s84, s84, 1
    s_cmp_lg_u32 s84, 0
    s_cbranch_scc1 L_fcheck_20
    s_branch L_end
L_fok_21:
    buffer_load_dwordx2 v[52:53], v81, s[48:51], s37 offen sc1
    buffer_load_dwordx4 v[200:203], v9, s[48:51], s36 offen sc1
    s_add_u32 s36, s36, 4096
    buffer_load_dwordx4 v[204:207], v9, s[48:51], s36 offen sc1
    s_add_u32 s36, s36, 4096
    buffer_load_dwordx4 v[208:211], v9, s[48:51], s36 offen sc1
    s_add_u32 s36, s36, 4096
    buffer_load_dwordx4 v[212:215], v9, s[48:51], s36 offen sc1
    s_waitcnt vmcnt(4)
    v_max_f32_dpp v4, v52, v52 row_ror:8 row_mask:0xf bank_mask:0xf
    s_nop 1
    v_max_f32_dpp v4, v4, v4 row_ror:4 row_mask:0xf bank_mask:0xf
    v_sub_f32 v52, v52, v4
    v_exp_f32 v52, v52
    s_nop 0
    v_mul_f32 v5, v52, v53
    s_nop 1
    v_add_f32_dpp v5, v5, v5 row_ror:8 row_mask:0xf bank_mask:0xf
    s_nop 1
    v_add_f32_dpp v5, v5, v5 row_ror:4 row_mask:0xf bank_mask:0xf
    v_rcp_f32 v5, v5
    s_nop 0
    v_mul_f32 v52, v52, v5
    s_waitcnt vmcnt(3)
    ds_write_b128 v96, v[200:203] offset:0
    s_waitcnt vmcnt(2)
    ds_write_b128 v97, v[204:207] offset:1024
    s_waitcnt vmcnt(1)
    ds_write_b128 v98, v[208:211] offset:2048
    s_waitcnt vmcnt(0)
    ds_write_b128 v99, v[212:215] offset:3072
    s_waitcnt lgkmcnt(0)
    ds_read_b128 v[136:139], v82
    ds_read_b128 v[140:143], v83
    ds_read_b128 v[144:147], v84
    ds_read_b128 v[148:151], v85
    s_waitcnt lgkmcnt(0)
    v_mfma_f32_16x16x32_bf16 v[104:107], a[128:131], v[136:139], 0
    v_mfma_f32_16x16x32_bf16 v[104:107], a[132:135], v[140:143], v[104:107]
    v_mfma_f32_16x16x32_bf16 v[104:107], a[136:139], v[144:147], v[104:107]
    v_mfma_f32_16x16x32_bf16 v[104:107], a[140:143], v[148:151], v[104:107]
    v_mfma_f32_16x16x32_bf16 v[108:111], a[144:147], v[136:139], 0
    v_mfma_f32_16x16x32_bf16 v[108:111], a[148:151], v[140:143], v[108:111]
    v_mfma_f32_16x16x32_bf16 v[108:111], a[152:155], v[144:147], v[108:111]
    v_mfma_f32_16x16x32_bf16 v[108:111], a[156:159], v[148:151], v[108:111]
    v_mfma_f32_16x16x32_bf16 v[112:115], a[160:163], v[136:139], 0
    v_mfma_f32_16x16x32_bf16 v[112:115], a[164:167], v[140:143], v[112:115]
    v_mfma_f32_16x16x32_bf16 v[112:115], a[168:171], v[144:147], v[112:115]
    v_mfma_f32_16x16x32_bf16 v[112:115], a[172:175], v[148:151], v[112:115]
    v_mul_f32 v104, v104, v52
    v_mul_f32 v105, v105, v52
    v_mul_f32 v106, v106, v52
    v_mul_f32 v107, v107, v52
    v_add_f32_dpp v104, v104, v104 row_ror:8 row_mask:0xf bank_mask:0xf
    v_add_f32_dpp v105, v105, v105 row_ror:8 row_mask:0xf bank_mask:0xf
    v_add_f32_dpp v106, v106, v106 row_ror:8 row_mask:0xf bank_mask:0xf
    v_add_f32_dpp v107, v107, v107 row_ror:8 row_mask:0xf bank_mask:0xf
    v_add_f32_dpp v104, v104, v104 row_ror:4 row_mask:0xf bank_mask:0xf
    v_add_f32_dpp v105, v105, v105 row_ror:4 row_mask:0xf bank_mask:0xf
    v_add_f32_dpp v106, v106, v106 row_ror:4 row_mask:0xf bank_mask:0xf
    v_add_f32_dpp v107, v107, v107 row_ror:4 row_mask:0xf bank_mask:0xf
    ds_write_b128 v94, v[104:107] offset:0
    v_mfma_f32_16x16x32_bf16 v[116:119], a[176:179], v[136:139], 0
    v_mfma_f32_16x16x32_bf16 v[116:119], a[180:183], v[140:143], v[116:119]
    v_mfma_f32_16x16x32_bf16 v[116:119], a[184:187], v[144:147], v[116:119]
    v_mfma_f32_16x16x32_bf16 v[116:119], a[188:191], v[148:151], v[116:119]
    v_mul_f32 v108, v108, v52
    v_mul_f32 v109, v109, v52
    v_mul_f32 v110, v110, v52
    v_mul_f32 v111, v111, v52
    v_add_f32_dpp v108, v108, v108 row_ror:8 row_mask:0xf bank_mask:0xf
    v_add_f32_dpp v109, v109, v109 row_ror:8 row_mask:0xf bank_mask:0xf
    v_add_f32_dpp v110, v110, v110 row_ror:8 row_mask:0xf bank_mask:0xf
    v_add_f32_dpp v111, v111, v111 row_ror:8 row_mask:0xf bank_mask:0xf
    v_add_f32_dpp v108, v108, v108 row_ror:4 row_mask:0xf bank_mask:0xf
    v_add_f32_dpp v109, v109, v109 row_ror:4 row_mask:0xf bank_mask:0xf
    v_add_f32_dpp v110, v110, v110 row_ror:4 row_mask:0xf bank_mask:0xf
    v_add_f32_dpp v111, v111, v111 row_ror:4 row_mask:0xf bank_mask:0xf
    ds_write_b128 v94, v[108:111] offset:64
    v_mfma_f32_16x16x32_bf16 v[120:123], a[192:195], v[136:139], 0
    v_mfma_f32_16x16x32_bf16 v[120:123], a[196:199], v[140:143], v[120:123]
    v_mfma_f32_16x16x32_bf16 v[120:123], a[200:203], v[144:147], v[120:123]
    v_mfma_f32_16x16x32_bf16 v[120:123], a[204:207], v[148:151], v[120:123]
    v_mul_f32 v112, v112, v52
    v_mul_f32 v113, v113, v52
    v_mul_f32 v114, v114, v52
    v_mul_f32 v115, v115, v52
    v_add_f32_dpp v112, v112, v112 row_ror:8 row_mask:0xf bank_mask:0xf
    v_add_f32_dpp v113, v113, v113 row_ror:8 row_mask:0xf bank_mask:0xf
    v_add_f32_dpp v114, v114, v114 row_ror:8 row_mask:0xf bank_mask:0xf
    v_add_f32_dpp v115, v115, v115 row_ror:8 row_mask:0xf bank_mask:0xf
    v_add_f32_dpp v112, v112, v112 row_ror:4 row_mask:0xf bank_mask:0xf
    v_add_f32_dpp v113, v113, v113 row_ror:4 row_mask:0xf bank_mask:0xf
    v_add_f32_dpp v114, v114, v114 row_ror:4 row_mask:0xf bank_mask:0xf
    v_add_f32_dpp v115, v115, v115 row_ror:4 row_mask:0xf bank_mask:0xf
    ds_write_b128 v94, v[112:115] offset:128
    v_mfma_f32_16x16x32_bf16 v[124:127], a[208:211], v[136:139], 0
    v_mfma_f32_16x16x32_bf16 v[124:127], a[212:215], v[140:143], v[124:127]
    v_mfma_f32_16x16x32_bf16 v[124:127], a[216:219], v[144:147], v[124:127]
    v_mfma_f32_16x16x32_bf16 v[124:127], a[220:223], v[148:151], v[124:127]
    v_mul_f32 v116, v116, v52
    v_mul_f32 v117, v117, v52
    v_mul_f32 v118, v118, v52
    v_mul_f32 v119, v119, v52
    v_add_f32_dpp v116, v116, v116 row_ror:8 row_mask:0xf bank_mask:0xf
    v_add_f32_dpp v117, v117, v117 row_ror:8 row_mask:0xf bank_mask:0xf
    v_add_f32_dpp v118, v118, v118 row_ror:8 row_mask:0xf bank_mask:0xf
    v_add_f32_dpp v119, v119, v119 row_ror:8 row_mask:0xf bank_mask:0xf
    v_add_f32_dpp v116, v116, v116 row_ror:4 row_mask:0xf bank_mask:0xf
    v_add_f32_dpp v117, v117, v117 row_ror:4 row_mask:0xf bank_mask:0xf
    v_add_f32_dpp v118, v118, v118 row_ror:4 row_mask:0xf bank_mask:0xf
    v_add_f32_dpp v119, v119, v119 row_ror:4 row_mask:0xf bank_mask:0xf
    ds_write_b128 v94, v[116:119] offset:192
    v_mfma_f32_16x16x32_bf16 v[128:131], a[224:227], v[136:139], 0
    v_mfma_f32_16x16x32_bf16 v[128:131], a[228:231], v[140:143], v[128:131]
    v_mfma_f32_16x16x32_bf16 v[128:131], a[232:235], v[144:147], v[128:131]
    v_mfma_f32_16x16x32_bf16 v[128:131], a[236:239], v[148:151], v[128:131]
    v_mul_f32 v120, v120, v52
    v_mul_f32 v121, v121, v52
    v_mul_f32 v122, v122, v52
    v_mul_f32 v123, v123, v52
    v_add_f32_dpp v120, v120, v120 row_ror:8 row_mask:0xf bank_mask:0xf
    v_add_f32_dpp v121, v121, v121 row_ror:8 row_mask:0xf bank_mask:0xf
    v_add_f32_dpp v122, v122, v122 row_ror:8 row_mask:0xf bank_mask:0xf
    v_add_f32_dpp v123, v123, v123 row_ror:8 row_mask:0xf bank_mask:0xf
    v_add_f32_dpp v120, v120, v120 row_ror:4 row_mask:0xf bank_mask:0xf
    v_add_f32_dpp v121, v121, v121 row_ror:4 row_mask:0xf bank_mask:0xf
    v_add_f32_dpp v122, v122, v122 row_ror:4 row_mask:0xf bank_mask:0xf
    v_add_f32_dpp v123, v123, v123 row_ror:4 row_mask:0xf bank_mask:0xf
    ds_write_b128 v94, v[120:123] offset:256
    v_mfma_f32_16x16x32_bf16 v[132:135], a[240:243], v[136:139], 0
    v_mfma_f32_16x16x32_bf16 v[132:135], a[244:247], v[140:143], v[132:135]
    v_mfma_f32_16x16x32_bf16 v[132:135], a[248:251], v[144:147], v[132:135]
    v_mfma_f32_16x16x32_bf16 v[132:135], a[252:255], v[148:151], v[132:135]
    v_mul_f32 v124, v124, v52
    v_mul_f32 v125, v125, v52
    v_mul_f32 v126, v126, v52
    v_mul_f32 v127, v127, v52
    v_add_f32_dpp v124, v124, v124 row_ror:8 row_mask:0xf bank_mask:0xf
    v_add_f32_dpp v125, v125, v125 row_ror:8 row_mask:0xf bank_mask:0xf
    v_add_f32_dpp v126, v126, v126 row_ror:8 row_mask:0xf bank_mask:0xf
    v_add_f32_dpp v127, v127, v127 row_ror:8 row_mask:0xf bank_mask:0xf
    v_add_f32_dpp v124, v124, v124 row_ror:4 row_mask:0xf bank_mask:0xf
    v_add_f32_dpp v125, v125, v125 row_ror:4 row_mask:0xf bank_mask:0xf
    v_add_f32_dpp v126, v126, v126 row_ror:4 row_mask:0xf bank_mask:0xf
    v_add_f32_dpp v127, v127, v127 row_ror:4 row_mask:0xf bank_mask:0xf
    ds_write_b128 v94, v[124:127] offset:320
    v_mul_f32 v128, v128, v52
    v_mul_f32 v129, v129, v52
    v_mul_f32 v130, v130, v52
    v_mul_f32 v131, v131, v52
    v_add_f32_dpp v128, v128, v128 row_ror:8 row_mask:0xf bank_mask:0xf
    v_add_f32_dpp v129, v129, v129 row_ror:8 row_mask:0xf bank_mask:0xf
    v_add_f32_dpp v130, v130, v130 row_ror:8 row_mask:0xf bank_mask:0xf
    v_add_f32_dpp v131, v131, v131 row_ror:8 row_mask:0xf bank_mask:0xf
    v_add_f32_dpp v128, v128, v128 row_ror:4 row_mask:0xf bank_mask:0xf
    v_add_f32_dpp v129, v129, v129 row_ror:4 row_mask:0xf bank_mask:0xf
    v_add_f32_dpp v130, v130, v130 row_ror:4 row_mask:0xf bank_mask:0xf
    v_add_f32_dpp v131, v131, v131 row_ror:4 row_mask:0xf bank_mask:0xf
    ds_write_b128 v94, v[128:131] offset:384
    v_mul_f32 v132, v132, v52
    v_mul_f32 v133, v133, v52
    v_mul_f32 v134, v134, v52
    v_mul_f32 v135, v135, v52
    v_add_f32_dpp v132, v132, v132 row_ror:8 row_mask:0xf bank_mask:0xf
    v_add_f32_dpp v133, v133, v133 row_ror:8 row_mask:0xf bank_mask:0xf
    v_add_f32_dpp v134, v134, v134 row_ror:8 row_mask:0xf bank_mask:0xf
    v_add_f32_dpp v135, v135, v135 row_ror:8 row_mask:0xf bank_mask:0xf
    v_add_f32_dpp v132, v132, v132 row_ror:4 row_mask:0xf bank_mask:0xf
    v_add_f32_dpp v133, v133, v133 row_ror:4 row_mask:0xf bank_mask:0xf
    v_add_f32_dpp v134, v134, v134 row_ror:4 row_mask:0xf bank_mask:0xf
    v_add_f32_dpp v135, v135, v135 row_ror:4 row_mask:0xf bank_mask:0xf
    ds_write_b128 v94, v[132:135] offset:448
    s_waitcnt lgkmcnt(0)
    s_barrier
    ds_read_b128 v[136:139], v102 offset:0
    ds_read_b128 v[140:143], v102 offset:8192
    ds_read_b128 v[144:147], v102 offset:16384
    ds_read_b128 v[148:151], v102 offset:24576
    s_waitcnt lgkmcnt(0)
    v_add_f32 v136, v136, v140
    v_add_f32 v144, v144, v148
    v_add_f32 v137, v137, v141
    v_add_f32 v145, v145, v149
    v_add_f32 v138, v138, v142
    v_add_f32 v146, v146, v150
    v_add_f32 v139, v139, v143
    v_add_f32 v147, v147, v151
    v_add_f32 v136, v136, v144
    v_add_f32 v137, v137, v145
    v_add_f32 v138, v138, v146
    v_add_f32 v139, v139, v147
    s_mov_b32 s38, 0xffff0000
    v_cvt_pk_bf16_f32 v136, v136, v136
    v_cvt_pk_bf16_f32 v137, v137, v137
    v_cvt_pk_bf16_f32 v138, v138, v138
    v_cvt_pk_bf16_f32 v139, v139, v139
    v_and_or_b32 v136, v136, s38, v8
    v_and_or_b32 v137, v137, s38, v8
    v_and_or_b32 v138, v138, s38, v8
    v_and_or_b32 v139, v139, s38, v8
    s_lshl_b32 s38, s32, 11
    s_add_u32 s36, s38, 196608
    s_lshl_b32 s38, s34, 9
    s_add_u32 s36, s38, s36
    s_mov_b32 exec_lo, 0xffffffff
    s_mov_b32 exec_hi, 0x0
    buffer_store_dwordx4 v[136:139], v34, s[48:51], s36 offen sc1
    s_mov_b64 exec, -1
    v_xor_b32 v224, s35, v136
    v_xor_b32 v225, s35, v137
    v_xor_b32 v226, s35, v138
    v_xor_b32 v227, s35, v139
    v_lshlrev_b32 v4, 11, v2
    v_bfe_u32 v5, v1, 2, 2
    v_lshl_add_u32 v4, v5, 8, v4
    v_bfe_u32 v5, v1, 2, 2
    v_lshl_add_u32 v4, v5, 6, v4
    v_bfe_u32 v5, v1, 4, 1
    v_lshl_add_u32 v4, v5, 5, v4
    v_bfe_u32 v5, v1, 1, 1
    v_lshl_add_u32 v4, v5, 4, v4
    v_bfe_u32 v5, v1, 0, 1
    v_lshl_add_u32 v4, v5, 3, v4
    s_lshl_b32 s38, s34, 6
    s_add_u32 s38, s38, 98304
    v_xor_b32 v24, s38, v4
    v_xor_b32 v25, 16, v24
    v_xor_b32 v26, 32, v24
    v_xor_b32 v27, 48, v24
    v_and_b32 v4, 3, v3
    v_lshrrev_b32 v5, 2, v3
    v_lshlrev_b32 v6, 4, v2
    v_add_u32 v6, 135168, v6
    s_movk_i32 s36, 320
    v_cmp_eq_u32 vcc, 0, v5
    s_nop 1
    v_cndmask_b32 v28, 4, v4, vcc
    v_mad_u32_u24 v28, v28, s36, v6
    v_cmp_eq_u32 vcc, 1, v5
    s_nop 1
    v_cndmask_b32 v29, 4, v4, vcc
    v_mad_u32_u24 v29, v29, s36, v6
    v_lshlrev_b32 v5, 2, v1
    v_add_u32 v5, 136448, v5
    v_mov_b32 v6, 0
    ds_write_b32 v5, v6
    v_cmp_ne_u32 vcc, s70, v64
    s_nop 0
    s_cmp_eq_u64 vcc, 0
    s_cselect_b32 s70, 1, 0
    s_bitcmp1_b32 s90, 2
    s_cbranch_scc1 L_ctxok
    s_mov_b32 s3, s34
    buffer_load_dwordx4 v[224:227], v54, s[48:51], s46 offen sc1
    v_lshlrev_b32 v4, 2, v2
    v_xor_b32 v4, v4, v3
    v_xor_b32 v5, 0, v4
    v_lshlrev_b32 v5, 4, v5
    v_lshl_add_u32 v20, v2, 10, v5
    v_xor_b32 v5, 1, v4
    v_lshlrev_b32 v5, 4, v5
    v_lshl_add_u32 v21, v2, 10, v5
    v_add_u32 v21, 3072, v21
    v_xor_b32 v5, 2, v4
    v_lshlrev_b32 v5, 4, v5
    v_lshl_add_u32 v22, v2, 10, v5
    v_add_u32 v22, 6144, v22
    v_xor_b32 v5, 3, v4
    v_lshlrev_b32 v5, 4, v5
    v_lshl_add_u32 v23, v2, 10, v5
    v_add_u32 v23, 9216, v23
    s_lshl_b32 s38, s32, 15
    s_add_u32 s47, s38, 1048576
    s_lshl_b32 s38, s3, 13
    s_add_u32 s47, s38, s47
    v_lshlrev_b32 v6, 7, v2
    v_bfe_u32 v5, v3, 0, 3
    v_lshl_add_u32 v6, v5, 4, v6
    v_lshrrev_b32 v4, 3, v3
    v_and_b32 v7, 3, v3
    v_min_u32 v7, 2, v7
    v_lshl_add_u32 v7, v7, 1, v4
    v_add_u32 v5, 0, v4
    v_cmp_le_u32 vcc, s33, v5
    s_nop 1
    v_addc_co_u32 v5, vcc, 0, v5, vcc
    v_lshl_add_u32 v50, v5, 10, v6
    v_add_u32 v5, 2, v4
    v_cmp_le_u32 vcc, s33, v5
    s_nop 1
    v_addc_co_u32 v5, vcc, 0, v5, vcc
    v_lshl_add_u32 v51, v5, 10, v6
    v_add_u32 v5, 4, v4
    v_cmp_le_u32 vcc, s33, v5
    s_nop 1
    v_addc_co_u32 v5, vcc, 0, v5, vcc
    v_lshl_add_u32 v52, v5, 10, v6
    v_mov_b32 v5, v7
    v_mov_b32 v6, 512
    v_cmp_le_u32 vcc, s33, v5
    s_nop 1
    v_addc_co_u32 v5, vcc, 0, v5, vcc
    v_lshl_add_u32 v53, v5, 10, v6
    s_mul_i32 s38, s3, 320
    s_add_u32 s38, s38, 135168
    v_lshlrev_b32 v4, 6, v2
    v_lshl_add_u32 v4, v3, 1, v4
    v_add_u32 v31, s38, v4
    v_lshlrev_b32 v4, 7, v2
    v_lshl_add_u32 v4, v3, 4, v4
    v_mov_b32 v5, 512
    v_cmp_gt_u32 vcc, 8, v3
    s_nop 1
    v_cndmask_b32 v79, v5, v4, vcc
    s_add_u32 s37, s47, 6144
    s_mov_b32 s86, 0x88888888
    s_mov_b32 s87, 0x88888888
    v_mov_b32 v120, 0xff7f0000
L_auxpoll:
    buffer_load_dwordx4 v[204:207], v53, s[48:51], s47 offen sc1
    buffer_load_dwordx4 v[192:195], v50, s[48:51], s47 offen sc1
    buffer_load_dwordx4 v[196:199], v51, s[48:51], s47 offen sc1
    buffer_load_dwordx4 v[200:203], v52, s[48:51], s47 offen sc1
    buffer_load_dwordx4 v[104:107], v79, s[48:51], s37 offen sc1
    s_waitcnt vmcnt(0)
    v_xor_b32 v104, s35, v104
    v_xor_b32 v105, s35, v105
    v_xor_b32 v106, s35, v106
    v_xor_b32 v107, s35, v107
    v_xor_b32 v192, s35, v192
    v_xor_b32 v193, s35, v193
    v_xor_b32 v194, s35, v194
    v_xor_b32 v195, s35, v195
    v_xor_b32 v196, s35, v196
    v_xor_b32 v197, s35, v197
    v_xor_b32 v198, s35, v198
    v_xor_b32 v199, s35, v199
    v_xor_b32 v200, s35, v200
    v_xor_b32 v201, s35, v201
    v_xor_b32 v202, s35, v202
    v_xor_b32 v203, s35, v203
    v_xor_b32 v204, s35, v204
    v_xor_b32 v205, s35, v205
    v_xor_b32 v206, s35, v206
    v_xor_b32 v207, s35, v207
    v_or_b32 v4, v104, v105
    v_or3_b32 v4, v4, v106, v107
    v_or3_b32 v4, v4, v192, v193
    v_or3_b32 v4, v4, v194, v195
    v_or3_b32 v4, v4, v196, v197
    v_or3_b32 v4, v4, v198, v199
    v_or3_b32 v4, v4, v200, v201
    v_or3_b32 v4, v4, v202, v203
    v_or3_b32 v4, v4, v204, v205
    v_or3_b32 v4, v4, v206, v207
    v_and_b32 v4, 0xff, v4
    v_cmp_ne_u32 vcc, 0, v4
    v_add_f32 v123, v104, v106
    v_add_f32 v122, v204, v206
    v_mov_b32_dpp v121, v105 row_newbcast:8 row_mask:0xf bank_mask:0xf
    v_mov_b32_dpp v120, v123 row_newbcast:8 row_mask:0xf bank_mask:0x3
    s_cbranch_vccz L_hop1ok
    s_sub_u32 s84, s84, 1
    s_cmp_lg_u32 s84, 0
    s_cbranch_scc1 L_auxpoll
    s_branch L_end
.section .rodata,"a"
.p2align 6
.amdhsa_kernel concat_heads__compressed_kv_cla__mha_block_cached__decode_kernel
  .amdhsa_next_free_vgpr 512
  .amdhsa_next_free_sgpr 102
  .amdhsa_accum_offset 256
  .amdhsa_group_segment_fixed_size 0
  .amdhsa_kernarg_size 112
  .amdhsa_user_sgpr_count 2
  .amdhsa_user_sgpr_kernarg_segment_ptr 1
  .amdhsa_system_sgpr_workgroup_id_x 1
.end_amdhsa_kernel
```

```asm
; @launch grid=(256,1,1) block=(256,1,1) lds=163840
    .amdgcn_target "amdgcn-amd-amdhsa--gfx950"
    .text
    .globl concat_heads__compressed_kv_cla__mha_block_cached__decode_kernel
    .p2align 8
    .type concat_heads__compressed_kv_cla__mha_block_cached__decode_kernel,@function
concat_heads__compressed_kv_cla__mha_block_cached__decode_kernel:
    s_cmp_ge_u32 s2, 256
    s_cbranch_scc1 L_end
    s_load_dwordx16 s[4:19], s[0:1], 0
    s_load_dwordx8 s[20:27], s[0:1], 64
    s_load_dwordx4 s[28:31], s[0:1], 96
    v_lshrrev_b32 v4, 6, v0
    v_and_b32 v1, 63, v0
    v_readfirstlane_b32 s34, v4
    s_lshr_b32 s32, s2, 3
    s_sub_u32 s33, s2, s32
    s_sub_u32 s33, s33, 1
    s_and_b32 s33, s33, 7
    v_lshrrev_b32 v2, 4, v1
    v_and_b32 v3, 15, v1
    s_cmp_lt_u32 s33, 2
    s_cbranch_scc1 L_qp
    s_cmp_eq_u32 s33, 2
    s_cbranch_scc1 L_ql
    s_cmp_eq_u32 s33, 7
    s_cbranch_scc1 L_aux
    s_bfe_u32 s38, s2, 0x30000
    s_lshl_b32 s38, s38, 21
    s_add_u32 s36, s38, -393216
    s_lshr_b32 s38, s32, 3
    s_lshl_b32 s38, s38, 19
    s_add_u32 s36, s38, s36
    s_lshl_b32 s38, s33, 17
    s_add_u32 s36, s38, s36
    s_lshl_b32 s38, s34, 12
    s_add_u32 s36, s38, s36
    v_bfe_u32 v5, v1, 0, 5
    v_lshlrev_b32 v4, 7, v5
    v_lshrrev_b32 v5, 5, v1
    v_lshl_add_u32 v4, v5, 15, v4
    s_mov_b32 s42, 16777216
    s_mov_b32 s43, 0x20000
    s_waitcnt lgkmcnt(0)
    s_mov_b64 s[40:41], s[6:7]
    buffer_load_dword v20, v4, s[40:43], s36 offen
    s_add_u32 s36, s36, 16384
    buffer_load_dword v21, v4, s[40:43], s36 offen
    s_add_u32 s36, s36, 49152
    buffer_load_dword v22, v4, s[40:43], s36 offen
    s_add_u32 s36, s36, 16384
    buffer_load_dword v23, v4, s[40:43], s36 offen
    s_load_dword s35, s[30:31], 0
    s_mov_b32 s48, s30
    s_and_b32 s49, s31, 0xffff
    s_mov_b32 s50, 8388608
    s_mov_b32 s51, 0x20000
    s_mov_b32 s82, 0xffffff00
    s_mov_b32 s83, 0x3e0293ee
    s_mov_b32 s84, 2097152
    v_lshrrev_b32 v4, 2, v3
    v_and_b32 v5, 3, v3
    v_lshlrev_b32 v76, 8, v4
    v_lshlrev_b32 v126, 8, v2
    v_lshl_add_u32 v76, v2, 6, v76
    v_lshl_add_u32 v76, v5, 4, v76
    v_lshl_add_u32 v126, v3, 4, v126
    v_xor_b32 v77, 32768, v76
    v_xor_b32 v127, 32768, v126
    s_add_u32 s3, s34, s33
    s_and_b32 s3, s3, 3
    s_lshl_b32 s89, s3, 5
    s_add_u32 s89, s89, s32
    s_lshl_b32 s89, s89, 20
    s_mul_i32 s88, s32, 8
    s_add_u32 s88, s88, s3
    s_lshl_b32 s87, s33, 0
    s_mov_b32 s52, s18
    s_and_b32 s53, s19, 0xffff
    s_mov_b32 s54, 134217728
    s_mov_b32 s55, 0x20000
    s_mov_b32 s56, s20
    s_and_b32 s57, s21, 0xffff
    s_mov_b32 s58, 134217728
    s_mov_b32 s59, 0x20000
    v_and_b32 v4, 1, v1
    v_lshlrev_b32 v4, 4, v4
    v_mov_b32 v5, 0xffff
    v_lshlrev_b32 v4, v4, v5
    v_bfe_u32 v5, v1, 1, 2
    v_cmp_eq_u32 vcc, 0, v5
    s_nop 1
    v_cndmask_b32 v10, 0, v4, vcc
    v_cmp_eq_u32 vcc, 1, v5
    s_nop 1
    v_cndmask_b32 v11, 0, v4, vcc
    v_cmp_eq_u32 vcc, 2, v5
    s_nop 1
    v_cndmask_b32 v12, 0, v4, vcc
    v_cmp_eq_u32 vcc, 3, v5
    s_nop 1
    v_cndmask_b32 v13, 0, v4, vcc
    v_mov_b32 v120, 0xff7f0000
    v_mov_b32 v121, 0
    v_mov_b32 v18, 1
    v_mov_b32 v116, 0
    v_mov_b32 v117, 0
    v_mov_b32 v118, 0
    v_mov_b32 v119, 0
    v_lshlrev_b32 v0, 3, v1
    ds_write_b64 v0, v[116:117] offset:8192
    v_mov_b32 v0, 8192
    s_lshl_b32 s38, s32, 10
    s_add_u32 s96, s38, 65536
    s_lshr_b32 s38, s32, 3
    s_lshl_b32 s38, s38, 8
    s_add_u32 s96, s38, s96
    v_mov_b32 v9, s96
    s_lshl_b32 s38, s32, 15
    s_add_u32 s96, s38, 1048576
    s_lshl_b32 s38, s3, 13
    s_add_u32 s96, s38, s96
    s_lshl_b32 s38, s33, 10
    s_add_u32 s96, s38, s96
    v_and_b32 v5, 3, v3
    v_lshlrev_b32 v78, 7, v2
    v_lshl_add_u32 v78, v5, 5, v78
    s_lshl_b32 s38, s32, 12
    s_add_u32 s91, s38, 262144
    s_lshl_b32 s38, s3, 9
    s_add_u32 s91, s38, s91
    v_lshlrev_b32 v4, 7, v2
    v_lshl_add_u32 v4, v3, 4, v4
    v_mov_b32 v5, 512
    v_cmp_gt_u32 vcc, 8, v3
    s_nop 1
    v_cndmask_b32 v79, v5, v4, vcc
    s_add_u32 s39, s87, s88
    s_bfe_u32 s37, s39, 0x30000
    s_lshl_b32 s37, s37, 12
    s_add_u32 s85, s37, s89
    s_bfe_u32 s37, s39, 0x10003
    s_lshl_b32 s37, s37, 11
    s_add_u32 s85, s37, s85
    s_bfe_u32 s37, s39, 0x40004
    s_lshl_b32 s37, s37, 16
    s_add_u32 s85, s37, s85
    buffer_load_dwordx4 v[128:131], v76, s[52:55], s85 offen offset:0 nt
    buffer_load_dwordx4 v[132:135], v77, s[52:55], s85 offen offset:0 nt
    buffer_load_dwordx4 v[136:139], v76, s[52:55], s85 offen offset:1024 nt
    buffer_load_dwordx4 v[140:143], v77, s[52:55], s85 offen offset:1024 nt
    s_add_u32 s87, s87, 7
    s_add_u32 s39, s87, s88
    s_bfe_u32 s37, s39, 0x30000
    s_lshl_b32 s37, s37, 12
    s_add_u32 s85, s37, s89
    s_bfe_u32 s37, s39, 0x10003
    s_lshl_b32 s37, s37, 11
    s_add_u32 s85, s37, s85
    s_bfe_u32 s37, s39, 0x40004
    s_lshl_b32 s37, s37, 16
    s_add_u32 s85, s37, s85
    buffer_load_dwordx4 v[144:147], v76, s[52:55], s85 offen offset:0 nt
    buffer_load_dwordx4 v[148:151], v77, s[52:55], s85 offen offset:0 nt
    buffer_load_dwordx4 v[152:155], v76, s[52:55], s85 offen offset:1024 nt
    s_waitcnt lgkmcnt(0)
    s_add_u32 s35, s35, 0x5b
    s_and_b32 s35, s35, 0xff
    v_mov_b32 v8, s35
    s_barrier
    s_waitcnt vmcnt(6)
    buffer_load_dwordx4 v[156:159], v77, s[52:55], s85 offen offset:1024 nt
    s_add_u32 s87, s87, 7
    s_add_u32 s39, s87, s88
    s_bfe_u32 s37, s39, 0x30000
    s_lshl_b32 s37, s37, 12
    s_add_u32 s85, s37, s89
    s_bfe_u32 s37, s39, 0x10003
    s_lshl_b32 s37, s37, 11
    s_add_u32 s85, s37, s85
    s_bfe_u32 s37, s39, 0x40004
    s_lshl_b32 s37, s37, 16
    s_add_u32 s85, s37, s85
    s_waitcnt vmcnt(6)
    buffer_load_dwordx4 v[160:163], v76, s[52:55], s85 offen offset:0 nt
    s_waitcnt vmcnt(6)
    buffer_load_dwordx4 v[164:167], v77, s[52:55], s85 offen offset:0 nt
    s_waitcnt vmcnt(6)
    buffer_load_dwordx4 v[168:171], v76, s[52:55], s85 offen offset:1024 nt
    s_waitcnt vmcnt(6)
    buffer_load_dwordx4 v[172:175], v77, s[52:55], s85 offen offset:1024 nt
    s_add_u32 s87, s87, 7
    s_add_u32 s39, s87, s88
    s_bfe_u32 s37, s39, 0x30000
    s_lshl_b32 s37, s37, 12
    s_add_u32 s85, s37, s89
    s_bfe_u32 s37, s39, 0x10003
    s_lshl_b32 s37, s37, 11
    s_add_u32 s85, s37, s85
    s_bfe_u32 s37, s39, 0x40004
    s_lshl_b32 s37, s37, 16
    s_add_u32 s85, s37, s85
    s_waitcnt vmcnt(6)
    buffer_load_dwordx4 v[176:179], v76, s[52:55], s85 offen offset:0 nt
    s_waitcnt vmcnt(6)
    buffer_load_dwordx4 v[180:183], v77, s[52:55], s85 offen offset:0 nt
    s_waitcnt vmcnt(6)
    buffer_load_dwordx4 v[184:187], v76, s[52:55], s85 offen offset:1024 nt
    s_waitcnt vmcnt(6)
    buffer_load_dwordx4 v[188:191], v77, s[52:55], s85 offen offset:1024 nt
    s_add_u32 s87, s87, 7
    s_add_u32 s39, s87, s88
    s_bfe_u32 s37, s39, 0x30000
    s_lshl_b32 s37, s37, 12
    s_add_u32 s85, s37, s89
    s_bfe_u32 s37, s39, 0x10003
    s_lshl_b32 s37, s37, 11
    s_add_u32 s85, s37, s85
    s_bfe_u32 s37, s39, 0x40004
    s_lshl_b32 s37, s37, 16
    s_add_u32 s85, s37, s85
    s_waitcnt vmcnt(6)
    buffer_load_dwordx4 v[192:195], v76, s[52:55], s85 offen offset:0 nt
    s_waitcnt vmcnt(6)
    buffer_load_dwordx4 v[196:199], v77, s[52:55], s85 offen offset:0 nt
    s_waitcnt vmcnt(6)
    buffer_load_dwordx4 v[200:203], v76, s[52:55], s85 offen offset:1024 nt
    s_waitcnt vmcnt(6)
    buffer_load_dwordx4 v[204:207], v77, s[52:55], s85 offen offset:1024 nt
    s_add_u32 s87, s87, 7
    s_add_u32 s39, s87, s88
    s_bfe_u32 s37, s39, 0x30000
    s_lshl_b32 s37, s37, 12
    s_add_u32 s85, s37, s89
    s_bfe_u32 s37, s39, 0x10003
    s_lshl_b32 s37, s37, 11
    s_add_u32 s85, s37, s85
    s_bfe_u32 s37, s39, 0x40004
    s_lshl_b32 s37, s37, 16
    s_add_u32 s85, s37, s85
    s_waitcnt vmcnt(6)
    buffer_load_dwordx4 v[208:211], v76, s[52:55], s85 offen offset:0 nt
    s_waitcnt vmcnt(6)
    buffer_load_dwordx4 v[212:215], v77, s[52:55], s85 offen offset:0 nt
    s_waitcnt vmcnt(6)
    buffer_load_dwordx4 v[216:219], v76, s[52:55], s85 offen offset:1024 nt
    s_waitcnt vmcnt(6)
    buffer_load_dwordx4 v[220:223], v77, s[52:55], s85 offen offset:1024 nt
    s_add_u32 s87, s87, 7
    s_add_u32 s39, s87, s88
    s_bfe_u32 s37, s39, 0x30000
    s_lshl_b32 s37, s37, 12
    s_add_u32 s85, s37, s89
    s_bfe_u32 s37, s39, 0x10003
    s_lshl_b32 s37, s37, 11
    s_add_u32 s85, s37, s85
    s_bfe_u32 s37, s39, 0x40004
    s_lshl_b32 s37, s37, 16
    s_add_u32 s85, s37, s85
    s_waitcnt vmcnt(6)
    buffer_load_dwordx4 v[224:227], v76, s[52:55], s85 offen offset:0 nt
    s_waitcnt vmcnt(6)
    buffer_load_dwordx4 v[228:231], v77, s[52:55], s85 offen offset:0 nt
    s_waitcnt vmcnt(6)
    buffer_load_dwordx4 v[232:235], v76, s[52:55], s85 offen offset:1024 nt
    s_waitcnt vmcnt(6)
    buffer_load_dwordx4 v[236:239], v77, s[52:55], s85 offen offset:1024 nt
    s_add_u32 s87, s87, 7
    s_add_u32 s39, s87, s88
    s_bfe_u32 s37, s39, 0x30000
    s_lshl_b32 s37, s37, 12
    s_add_u32 s85, s37, s89
    s_bfe_u32 s37, s39, 0x10003
    s_lshl_b32 s37, s37, 11
    s_add_u32 s85, s37, s85
    s_bfe_u32 s37, s39, 0x40004
    s_lshl_b32 s37, s37, 16
    s_add_u32 s85, s37, s85
    s_waitcnt vmcnt(6)
    buffer_load_dwordx4 v[240:243], v76, s[52:55], s85 offen offset:0 nt
    s_waitcnt vmcnt(6)
    buffer_load_dwordx4 v[244:247], v77, s[52:55], s85 offen offset:0 nt
    s_waitcnt vmcnt(6)
    buffer_load_dwordx4 v[248:251], v76, s[52:55], s85 offen offset:1024 nt
    s_waitcnt vmcnt(6)
    buffer_load_dwordx4 v[252:255], v77, s[52:55], s85 offen offset:1024 nt
    s_add_u32 s87, s87, 7
    s_add_u32 s39, s87, s88
    s_bfe_u32 s37, s39, 0x30000
    s_lshl_b32 s37, s37, 12
    s_add_u32 s85, s37, s89
    s_bfe_u32 s37, s39, 0x10003
    s_lshl_b32 s37, s37, 11
    s_add_u32 s85, s37, s85
    s_bfe_u32 s37, s39, 0x40004
    s_lshl_b32 s37, s37, 16
    s_add_u32 s85, s37, s85
    s_waitcnt vmcnt(6)
    buffer_load_dwordx4 a[0:3], v76, s[52:55], s85 offen offset:0 nt
    s_waitcnt vmcnt(6)
    buffer_load_dwordx4 a[4:7], v77, s[52:55], s85 offen offset:0 nt
    s_waitcnt vmcnt(6)
    buffer_load_dwordx4 a[8:11], v76, s[52:55], s85 offen offset:1024 nt
    s_waitcnt vmcnt(6)
    buffer_load_dwordx4 a[12:15], v77, s[52:55], s85 offen offset:1024 nt
    s_add_u32 s87, s87, 7
    s_add_u32 s39, s87, s88
    s_bfe_u32 s37, s39, 0x30000
    s_lshl_b32 s37, s37, 12
    s_add_u32 s85, s37, s89
    s_bfe_u32 s37, s39, 0x10003
    s_lshl_b32 s37, s37, 11
    s_add_u32 s85, s37, s85
    s_bfe_u32 s37, s39, 0x40004
    s_lshl_b32 s37, s37, 16
    s_add_u32 s85, s37, s85
    s_waitcnt vmcnt(6)
    buffer_load_dwordx4 a[16:19], v76, s[52:55], s85 offen offset:0 nt
    s_waitcnt vmcnt(6)
    buffer_load_dwordx4 a[20:23], v77, s[52:55], s85 offen offset:0 nt
    s_waitcnt vmcnt(6)
    buffer_load_dwordx4 a[24:27], v76, s[52:55], s85 offen offset:1024 nt
    s_waitcnt vmcnt(6)
    buffer_load_dwordx4 a[28:31], v77, s[52:55], s85 offen offset:1024 nt
    s_add_u32 s87, s87, 7
    s_add_u32 s39, s87, s88
    s_bfe_u32 s37, s39, 0x30000
    s_lshl_b32 s37, s37, 12
    s_add_u32 s85, s37, s89
    s_bfe_u32 s37, s39, 0x10003
    s_lshl_b32 s37, s37, 11
    s_add_u32 s85, s37, s85
    s_bfe_u32 s37, s39, 0x40004
    s_lshl_b32 s37, s37, 16
    s_add_u32 s85, s37, s85
    s_waitcnt vmcnt(6)
    buffer_load_dwordx4 a[32:35], v76, s[52:55], s85 offen offset:0 nt
    s_waitcnt vmcnt(6)
    buffer_load_dwordx4 a[36:39], v77, s[52:55], s85 offen offset:0 nt
    s_waitcnt vmcnt(6)
    buffer_load_dwordx4 a[40:43], v76, s[52:55], s85 offen offset:1024 nt
    s_waitcnt vmcnt(6)
    buffer_load_dwordx4 a[44:47], v77, s[52:55], s85 offen offset:1024 nt
    s_add_u32 s87, s87, 7
    s_add_u32 s39, s87, s88
    s_bfe_u32 s37, s39, 0x30000
    s_lshl_b32 s37, s37, 12
    s_add_u32 s85, s37, s89
    s_bfe_u32 s37, s39, 0x10003
    s_lshl_b32 s37, s37, 11
    s_add_u32 s85, s37, s85
    s_bfe_u32 s37, s39, 0x40004
    s_lshl_b32 s37, s37, 16
    s_add_u32 s85, s37, s85
    s_waitcnt vmcnt(6)
    buffer_load_dwordx4 a[48:51], v76, s[52:55], s85 offen offset:0 nt
    s_waitcnt vmcnt(6)
    buffer_load_dwordx4 a[52:55], v77, s[52:55], s85 offen offset:0 nt
    buffer_load_dwordx4 v[68:71], v78, s[48:51], s91 offen offset:0 sc1
    buffer_load_dwordx4 v[72:75], v78, s[48:51], s91 offen offset:16 sc1
    s_waitcnt vmcnt(8)
    buffer_load_dwordx4 a[56:59], v76, s[52:55], s85 offen offset:1024 nt
    s_waitcnt vmcnt(8)
    buffer_load_dwordx4 a[60:63], v77, s[52:55], s85 offen offset:1024 nt
    s_add_u32 s87, s87, 7
    s_add_u32 s39, s87, s88
    s_bfe_u32 s37, s39, 0x30000
    s_lshl_b32 s37, s37, 12
    s_add_u32 s85, s37, s89
    s_bfe_u32 s37, s39, 0x10003
    s_lshl_b32 s37, s37, 11
    s_add_u32 s85, s37, s85
    s_bfe_u32 s37, s39, 0x40004
    s_lshl_b32 s37, s37, 16
    s_add_u32 s85, s37, s85
    s_waitcnt vmcnt(8)
    buffer_load_dwordx4 a[64:67], v76, s[52:55], s85 offen offset:0 nt
    s_waitcnt vmcnt(8)
    buffer_load_dwordx4 a[68:71], v77, s[52:55], s85 offen offset:0 nt
    s_waitcnt vmcnt(8)
    buffer_load_dwordx4 a[72:75], v76, s[52:55], s85 offen offset:1024 nt
    s_waitcnt vmcnt(8)
    buffer_load_dwordx4 a[76:79], v77, s[52:55], s85 offen offset:1024 nt
    s_add_u32 s87, s87, 7
    s_add_u32 s39, s87, s88
    s_bfe_u32 s37, s39, 0x30000
    s_lshl_b32 s37, s37, 12
    s_add_u32 s85, s37, s89
    s_bfe_u32 s37, s39, 0x10003
    s_lshl_b32 s37, s37, 11
    s_add_u32 s85, s37, s85
    s_bfe_u32 s37, s39, 0x40004
    s_lshl_b32 s37, s37, 16
    s_add_u32 s85, s37, s85
    s_waitcnt vmcnt(6)
L_qcheck_1:
    v_xor_b32 v68, s35, v68
    v_xor_b32 v69, s35, v69
    v_xor_b32 v70, s35, v70
    v_xor_b32 v71, s35, v71
    v_xor_b32 v72, s35, v72
    v_xor_b32 v73, s35, v73
    v_xor_b32 v74, s35, v74
    v_xor_b32 v75, s35, v75
    v_or_b32 v4, v68, v69
    v_or3_b32 v4, v4, v70, v71
    v_or3_b32 v4, v4, v72, v73
    v_or3_b32 v4, v4, v74, v75
    v_and_b32 v4, 0xff, v4
    v_cmp_ne_u32 vcc, 0, v4
    s_cbranch_vccz L_qok_2
    buffer_load_dwordx4 v[68:71], v78, s[48:51], s91 offen offset:0 sc1
    buffer_load_dwordx4 v[72:75], v78, s[48:51], s91 offen offset:16 sc1
    s_waitcnt vmcnt(0)
    s_sub_u32 s84, s84, 1
    s_cmp_lg_u32 s84, 0
    s_cbranch_scc1 L_qcheck_1
    s_branch L_end
L_qok_2:
    v_cvt_pk_bf16_f32 v68, v68, v69
    v_cvt_pk_bf16_f32 v69, v70, v71
    v_cvt_pk_bf16_f32 v70, v72, v73
    v_cvt_pk_bf16_f32 v71, v74, v75
    s_mov_b32 vcc_lo, 0xf000f
    s_mov_b32 vcc_hi, 0xf000f
    v_cndmask_b32 v80, 0, v68, vcc
    v_cndmask_b32 v81, 0, v69, vcc
    v_cndmask_b32 v82, 0, v70, vcc
    v_cndmask_b32 v83, 0, v71, vcc
    s_mov_b32 vcc_lo, 0xf000f0
    s_mov_b32 vcc_hi, 0xf000f0
    v_cndmask_b32 v84, 0, v68, vcc
    v_cndmask_b32 v85, 0, v69, vcc
    v_cndmask_b32 v86, 0, v70, vcc
    v_cndmask_b32 v87, 0, v71, vcc
    s_mov_b32 vcc_lo, 0xf000f00
    s_mov_b32 vcc_hi, 0xf000f00
    v_cndmask_b32 v88, 0, v68, vcc
    v_cndmask_b32 v89, 0, v69, vcc
    v_cndmask_b32 v90, 0, v70, vcc
    v_cndmask_b32 v91, 0, v71, vcc
    s_mov_b32 vcc_lo, 0xf000f000
    s_mov_b32 vcc_hi, 0xf000f000
    v_cndmask_b32 v92, 0, v68, vcc
    v_cndmask_b32 v93, 0, v69, vcc
    v_cndmask_b32 v94, 0, v70, vcc
    v_cndmask_b32 v95, 0, v71, vcc
    s_getreg_b32 s70, hwreg(HW_REG_XCC_ID, 0, 4)
    s_lshl_b32 s70, s70, 8
    s_or_b32 s70, s70, s35
    s_or_b32 s70, s70, 0x5e9d0000
    s_bfe_u32 s38, s2, 0x30000
    s_lshl_b32 s38, s38, 8
    s_add_u32 s69, s38, 32768
    s_lshl_b32 s38, s32, 2
    s_add_u32 s69, s38, s69
    s_lshl_b32 s38, s34, 24
    s_add_u32 s69, s38, s69
    v_mov_b32 v72, s69
    v_mov_b32 v73, s70
    s_mov_b64 exec, 1
    buffer_store_dword v73, v72, s[48:51], 0 offen sc1
    s_mov_b64 exec, -1
    v_mov_b32 v65, 0xff7f0000
    s_lshl_b32 s38, s34, 14
    s_add_u32 s38, s38, 16384
    v_lshl_add_u32 v64, v1, 2, s38
    buffer_load_dwordx4 a[80:83], v76, s[52:55], s85 offen offset:0 nt
    v_mfma_f32_16x16x32_bf16 v[112:115], v[128:131], v[80:83], 0
    v_mfma_f32_16x16x32_bf16 v[112:115], v[132:135], v[84:87], v[112:115]
    v_mfma_f32_16x16x32_bf16 v[112:115], v[136:139], v[88:91], v[112:115]
    s_waitcnt vmcnt(7)
    buffer_load_dwordx4 a[84:87], v77, s[52:55], s85 offen offset:0 nt
    v_mfma_f32_16x16x32_bf16 v[112:115], v[140:143], v[92:95], v[112:115]
    v_mfma_f32_16x16x32_bf16 v[96:99], v[144:147], v[80:83], 0
    v_mfma_f32_16x16x32_bf16 v[96:99], v[148:151], v[84:87], v[96:99]
    v_mfma_f32_16x16x32_bf16 v[96:99], v[152:155], v[88:91], v[96:99]
    s_nop 4
    v_mov_b32_dpp v122, v112 quad_perm:[0,0,0,0] row_mask:0xf bank_mask:0xf
    v_mov_b32_dpp v124, v114 quad_perm:[2,2,2,2] row_mask:0xf bank_mask:0xf
    s_nop 0
    v_add_f32_dpp v122, v113, v122 quad_perm:[1,1,1,1] row_mask:0xf bank_mask:0xf
    v_add_f32_dpp v124, v115, v124 quad_perm:[3,3,3,3] row_mask:0xf bank_mask:0xf
    v_add_f32 v122, v122, v124
    v_max_f32 v65, v65, v122
    ds_write_b32 v64, v122 offset:0
    s_waitcnt vmcnt(7)
    buffer_load_dwordx4 a[88:91], v76, s[52:55], s85 offen offset:1024 nt
    v_mfma_f32_16x16x32_bf16 v[96:99], v[156:159], v[92:95], v[96:99]
    v_mfma_f32_16x16x32_bf16 v[112:115], v[160:163], v[80:83], 0
    v_mfma_f32_16x16x32_bf16 v[112:115], v[164:167], v[84:87], v[112:115]
    s_waitcnt vmcnt(7)
    buffer_load_dwordx4 a[92:95], v77, s[52:55], s85 offen offset:1024 nt
    s_add_u32 s87, s87, 7
    s_add_u32 s39, s87, s88
    s_bfe_u32 s37, s39, 0x30000
    s_lshl_b32 s37, s37, 12
    s_add_u32 s85, s37, s89
    s_bfe_u32 s37, s39, 0x10003
    s_lshl_b32 s37, s37, 11
    s_add_u32 s85, s37, s85
    s_bfe_u32 s37, s39, 0x40004
    s_lshl_b32 s37, s37, 16
    s_add_u32 s85, s37, s85
    v_mfma_f32_16x16x32_bf16 v[112:115], v[168:171], v[88:91], v[112:115]
    v_mov_b32_dpp v122, v96 quad_perm:[0,0,0,0] row_mask:0xf bank_mask:0xf
    v_mov_b32_dpp v124, v98 quad_perm:[2,2,2,2] row_mask:0xf bank_mask:0xf
    s_nop 0
    v_add_f32_dpp v122, v97, v122 quad_perm:[1,1,1,1] row_mask:0xf bank_mask:0xf
    v_add_f32_dpp v124, v99, v124 quad_perm:[3,3,3,3] row_mask:0xf bank_mask:0xf
    v_add_f32 v122, v122, v124
    v_max_f32 v65, v65, v122
    ds_write_b32 v64, v122 offset:256
    v_mfma_f32_16x16x32_bf16 v[112:115], v[172:175], v[92:95], v[112:115]
    v_mfma_f32_16x16x32_bf16 v[96:99], v[176:179], v[80:83], 0
    v_mfma_f32_16x16x32_bf16 v[96:99], v[180:183], v[84:87], v[96:99]
    s_waitcnt vmcnt(7)
    buffer_load_dwordx4 a[96:99], v76, s[52:55], s85 offen offset:0 nt
    v_mfma_f32_16x16x32_bf16 v[96:99], v[184:187], v[88:91], v[96:99]
    s_nop 2
    v_mov_b32_dpp v122, v112 quad_perm:[0,0,0,0] row_mask:0xf bank_mask:0xf
    v_mov_b32_dpp v124, v114 quad_perm:[2,2,2,2] row_mask:0xf bank_mask:0xf
    s_nop 0
    v_add_f32_dpp v122, v113, v122 quad_perm:[1,1,1,1] row_mask:0xf bank_mask:0xf
    v_add_f32_dpp v124, v115, v124 quad_perm:[3,3,3,3] row_mask:0xf bank_mask:0xf
    v_add_f32 v122, v122, v124
    v_max_f32 v65, v65, v122
    ds_write_b32 v64, v122 offset:512
    v_mfma_f32_16x16x32_bf16 v[96:99], v[188:191], v[92:95], v[96:99]
    v_mfma_f32_16x16x32_bf16 v[112:115], v[192:195], v[80:83], 0
    s_waitcnt vmcnt(7)
    buffer_load_dwordx4 a[100:103], v77, s[52:55], s85 offen offset:0 nt
    v_mfma_f32_16x16x32_bf16 v[112:115], v[196:199], v[84:87], v[112:115]
    v_mfma_f32_16x16x32_bf16 v[112:115], v[200:203], v[88:91], v[112:115]
    s_nop 2
    v_mov_b32_dpp v122, v96 quad_perm:[0,0,0,0] row_mask:0xf bank_mask:0xf
    v_mov_b32_dpp v124, v98 quad_perm:[2,2,2,2] row_mask:0xf bank_mask:0xf
    s_nop 0
    v_add_f32_dpp v122, v97, v122 quad_perm:[1,1,1,1] row_mask:0xf bank_mask:0xf
    v_add_f32_dpp v124, v99, v124 quad_perm:[3,3,3,3] row_mask:0xf bank_mask:0xf
    v_add_f32 v122, v122, v124
    v_max_f32 v65, v65, v122
    ds_write_b32 v64, v122 offset:768
    v_mfma_f32_16x16x32_bf16 v[112:115], v[204:207], v[92:95], v[112:115]
    v_mfma_f32_16x16x32_bf16 v[96:99], v[208:211], v[80:83], 0
    s_waitcnt vmcnt(7)
    buffer_load_dwordx4 a[104:107], v76, s[52:55], s85 offen offset:1024 nt
    v_mfma_f32_16x16x32_bf16 v[96:99], v[212:215], v[84:87], v[96:99]
    v_mfma_f32_16x16x32_bf16 v[96:99], v[216:219], v[88:91], v[96:99]
    s_nop 2
    v_mov_b32_dpp v122, v112 quad_perm:[0,0,0,0] row_mask:0xf bank_mask:0xf
    v_mov_b32_dpp v124, v114 quad_perm:[2,2,2,2] row_mask:0xf bank_mask:0xf
    s_nop 0
    v_add_f32_dpp v122, v113, v122 quad_perm:[1,1,1,1] row_mask:0xf bank_mask:0xf
    v_add_f32_dpp v124, v115, v124 quad_perm:[3,3,3,3] row_mask:0xf bank_mask:0xf
    v_add_f32 v122, v122, v124
    v_max_f32 v65, v65, v122
    ds_write_b32 v64, v122 offset:1024
    v_mfma_f32_16x16x32_bf16 v[96:99], v[220:223], v[92:95], v[96:99]
    s_waitcnt vmcnt(6)
    buffer_load_dwordx4 a[108:111], v77, s[52:55], s85 offen offset:1024 nt
    s_add_u32 s87, s87, 7
    s_add_u32 s39, s87, s88
    s_bfe_u32 s37, s39, 0x30000
    s_lshl_b32 s37, s37, 12
    s_add_u32 s85, s37, s89
    s_bfe_u32 s37, s39, 0x10003
    s_lshl_b32 s37, s37, 11
    s_add_u32 s85, s37, s85
    s_bfe_u32 s37, s39, 0x40004
    s_lshl_b32 s37, s37, 16
    s_add_u32 s85, s37, s85
    v_mfma_f32_16x16x32_bf16 v[112:115], v[224:227], v[80:83], 0
    v_mfma_f32_16x16x32_bf16 v[112:115], v[228:231], v[84:87], v[112:115]
    v_mfma_f32_16x16x32_bf16 v[112:115], v[232:235], v[88:91], v[112:115]
    v_mov_b32_dpp v122, v96 quad_perm:[0,0,0,0] row_mask:0xf bank_mask:0xf
    v_mov_b32_dpp v124, v98 quad_perm:[2,2,2,2] row_mask:0xf bank_mask:0xf
    s_nop 0
    v_add_f32_dpp v122, v97, v122 quad_perm:[1,1,1,1] row_mask:0xf bank_mask:0xf
    v_add_f32_dpp v124, v99, v124 quad_perm:[3,3,3,3] row_mask:0xf bank_mask:0xf
    v_add_f32 v122, v122, v124
    v_max_f32 v65, v65, v122
    ds_write_b32 v64, v122 offset:1280
    v_mfma_f32_16x16x32_bf16 v[112:115], v[236:239], v[92:95], v[112:115]
    s_waitcnt vmcnt(6)
    buffer_load_dwordx4 a[112:115], v76, s[52:55], s85 offen offset:0 nt
    v_mfma_f32_16x16x32_bf16 v[96:99], v[240:243], v[80:83], 0
    v_mfma_f32_16x16x32_bf16 v[96:99], v[244:247], v[84:87], v[96:99]
    v_mfma_f32_16x16x32_bf16 v[96:99], v[248:251], v[88:91], v[96:99]
    s_nop 2
    v_mov_b32_dpp v122, v112 quad_perm:[0,0,0,0] row_mask:0xf bank_mask:0xf
    v_mov_b32_dpp v124, v114 quad_perm:[2,2,2,2] row_mask:0xf bank_mask:0xf
    s_nop 0
    v_add_f32_dpp v122, v113, v122 quad_perm:[1,1,1,1] row_mask:0xf bank_mask:0xf
    v_add_f32_dpp v124, v115, v124 quad_perm:[3,3,3,3] row_mask:0xf bank_mask:0xf
    v_add_f32 v122, v122, v124
    v_max_f32 v65, v65, v122
    ds_write_b32 v64, v122 offset:1536
    v_mfma_f32_16x16x32_bf16 v[96:99], v[252:255], v[92:95], v[96:99]
    s_waitcnt vmcnt(6)
    buffer_load_dwordx4 a[116:119], v77, s[52:55], s85 offen offset:0 nt
    v_mfma_f32_16x16x32_bf16 v[112:115], a[0:3], v[80:83], 0
    v_mfma_f32_16x16x32_bf16 v[112:115], a[4:7], v[84:87], v[112:115]
    v_mfma_f32_16x16x32_bf16 v[112:115], a[8:11], v[88:91], v[112:115]
    s_nop 2
    v_mov_b32_dpp v122, v96 quad_perm:[0,0,0,0] row_mask:0xf bank_mask:0xf
    v_mov_b32_dpp v124, v98 quad_perm:[2,2,2,2] row_mask:0xf bank_mask:0xf
    s_nop 0
    v_add_f32_dpp v122, v97, v122 quad_perm:[1,1,1,1] row_mask:0xf bank_mask:0xf
    v_add_f32_dpp v124, v99, v124 quad_perm:[3,3,3,3] row_mask:0xf bank_mask:0xf
    v_add_f32 v122, v122, v124
    v_max_f32 v65, v65, v122
    ds_write_b32 v64, v122 offset:1792
    s_waitcnt vmcnt(6)
    buffer_load_dwordx4 a[120:123], v76, s[52:55], s85 offen offset:1024 nt
    v_mfma_f32_16x16x32_bf16 v[112:115], a[12:15], v[92:95], v[112:115]
    v_mfma_f32_16x16x32_bf16 v[96:99], a[16:19], v[80:83], 0
    v_mfma_f32_16x16x32_bf16 v[96:99], a[20:23], v[84:87], v[96:99]
    v_mfma_f32_16x16x32_bf16 v[96:99], a[24:27], v[88:91], v[96:99]
    s_nop 4
    v_mov_b32_dpp v122, v112 quad_perm:[0,0,0,0] row_mask:0xf bank_mask:0xf
    v_mov_b32_dpp v124, v114 quad_perm:[2,2,2,2] row_mask:0xf bank_mask:0xf
    s_nop 0
    v_add_f32_dpp v122, v113, v122 quad_perm:[1,1,1,1] row_mask:0xf bank_mask:0xf
    v_add_f32_dpp v124, v115, v124 quad_perm:[3,3,3,3] row_mask:0xf bank_mask:0xf
    v_add_f32 v122, v122, v124
    v_max_f32 v65, v65, v122
    ds_write_b32 v64, v122 offset:2048
    s_waitcnt vmcnt(6)
    buffer_load_dwordx4 a[124:127], v77, s[52:55], s85 offen offset:1024 nt
    s_add_u32 s87, s87, 7
    s_add_u32 s39, s87, s88
    s_bfe_u32 s37, s39, 0x30000
    s_lshl_b32 s37, s37, 12
    s_add_u32 s85, s37, s89
    s_bfe_u32 s37, s39, 0x10003
    s_lshl_b32 s37, s37, 11
    s_add_u32 s85, s37, s85
    s_bfe_u32 s37, s39, 0x40004
    s_lshl_b32 s37, s37, 16
    s_add_u32 s85, s37, s85
    v_mfma_f32_16x16x32_bf16 v[96:99], a[28:31], v[92:95], v[96:99]
    v_mfma_f32_16x16x32_bf16 v[112:115], a[32:35], v[80:83], 0
    s_bfe_u32 s38, s2, 0x20001
    s_lshl_b32 s38, s38, 0
    s_add_u32 s90, s38, 0
    s_bfe_u32 s38, s2, 0x10000
    s_lshl_b32 s38, s38, 2
    s_add_u32 s90, s38, s90
    s_and_b32 s36, s90, 3
    s_bitcmp0_b32 s90, 2
    s_cselect_b64 s[40:41], s[24:25], s[14:15]
    s_cselect_b32 s45, 262144, 0
    s_add_u32 s45, s45, 524288
    s_lshl_b32 s38, s36, 16
    s_add_u32 s71, s38, s45
    s_lshr_b32 s38, s32, 2
    s_lshl_b32 s38, s38, 13
    s_add_u32 s71, s38, s71
    s_bfe_u32 s38, s32, 0x20000
    s_lshl_b32 s38, s38, 6
    s_add_u32 s71, s38, s71
    s_mov_b32 s42, 4194304
    s_mov_b32 s43, 0x20000
    s_lshl_b32 s38, s32, 17
    s_add_u32 s44, s38, 0
    s_lshl_b32 s38, s34, 15
    s_add_u32 s44, s38, s44
    s_lshl_b32 s38, s36, 8
    s_add_u32 s44, s38, s44
    s_lshl_b32 s38, s36, 16
    s_add_u32 s45, s38, s45
    s_lshr_b32 s38, s34, 1
    s_lshl_b32 s38, s38, 15
    s_add_u32 s45, s38, s45
    s_lshl_b32 s38, s32, 8
    s_add_u32 s45, s38, s45
    s_bfe_u32 s38, s34, 0x10000
    s_lshl_b32 s38, s38, 7
    s_add_u32 s45, s38, s45
    s_lshl_b32 s38, s32, 11
    s_add_u32 s46, s38, 196608
    s_lshl_b32 s38, s34, 9
    s_add_u32 s46, s38, s46
    s_mov_b32 s72, s26
    s_and_b32 s73, s27, 0xffff
    s_mov_b32 s74, 8192
    s_mov_b32 s75, 0x20000
    v_mfma_f32_16x16x32_bf16 v[112:115], a[36:39], v[84:87], v[112:115]
    s_waitcnt vmcnt(5)
    buffer_load_dwordx4 v[128:131], v76, s[52:55], s85 offen offset:0 nt
    v_mfma_f32_16x16x32_bf16 v[112:115], a[40:43], v[88:91], v[112:115]
    v_mov_b32_dpp v122, v96 quad_perm:[0,0,0,0] row_mask:0xf bank_mask:0xf
    v_mov_b32_dpp v124, v98 quad_perm:[2,2,2,2] row_mask:0xf bank_mask:0xf
    s_nop 0
    v_add_f32_dpp v122, v97, v122 quad_perm:[1,1,1,1] row_mask:0xf bank_mask:0xf
    v_add_f32_dpp v124, v99, v124 quad_perm:[3,3,3,3] row_mask:0xf bank_mask:0xf
    v_add_f32 v122, v122, v124
    v_max_f32 v65, v65, v122
    ds_write_b32 v64, v122 offset:2304
    v_mfma_f32_16x16x32_bf16 v[112:115], a[44:47], v[92:95], v[112:115]
    v_mfma_f32_16x16x32_bf16 v[96:99], a[48:51], v[80:83], 0
    v_mfma_f32_16x16x32_bf16 v[96:99], a[52:55], v[84:87], v[96:99]
    s_waitcnt vmcnt(5)
    buffer_load_dwordx4 v[132:135], v77, s[52:55], s85 offen offset:0 nt
    v_mfma_f32_16x16x32_bf16 v[96:99], a[56:59], v[88:91], v[96:99]
    s_nop 2
    v_mov_b32_dpp v122, v112 quad_perm:[0,0,0,0] row_mask:0xf bank_mask:0xf
    v_mov_b32_dpp v124, v114 quad_perm:[2,2,2,2] row_mask:0xf bank_mask:0xf
    s_nop 0
    v_add_f32_dpp v122, v113, v122 quad_perm:[1,1,1,1] row_mask:0xf bank_mask:0xf
    v_add_f32_dpp v124, v115, v124 quad_perm:[3,3,3,3] row_mask:0xf bank_mask:0xf
    v_add_f32 v122, v122, v124
    v_max_f32 v65, v65, v122
    ds_write_b32 v64, v122 offset:2560
    v_lshlrev_b32 v4, 2, v2
    v_xor_b32 v4, v4, v3
    v_xor_b32 v5, 0, v4
    v_lshlrev_b32 v5, 4, v5
    v_lshl_add_u32 v20, v2, 10, v5
    v_xor_b32 v5, 1, v4
    v_lshlrev_b32 v5, 4, v5
    v_lshl_add_u32 v21, v2, 10, v5
    v_add_u32 v21, 3072, v21
    v_xor_b32 v5, 2, v4
    v_lshlrev_b32 v5, 4, v5
    v_lshl_add_u32 v22, v2, 10, v5
    v_add_u32 v22, 6144, v22
    v_xor_b32 v5, 3, v4
    v_lshlrev_b32 v5, 4, v5
    v_lshl_add_u32 v23, v2, 10, v5
    v_add_u32 v23, 9216, v23
    s_lshl_b32 s38, s32, 15
    s_add_u32 s47, s38, 1048576
    s_lshl_b32 s38, s3, 13
    s_add_u32 s47, s38, s47
    v_lshlrev_b32 v6, 7, v2
    v_bfe_u32 v5, v3, 0, 3
    v_lshl_add_u32 v6, v5, 4, v6
    v_lshrrev_b32 v4, 3, v3
    v_and_b32 v7, 3, v3
    v_min_u32 v7, 2, v7
    v_lshl_add_u32 v7, v7, 1, v4
    v_add_u32 v5, 0, v4
    v_cmp_le_u32 vcc, s33, v5
    s_nop 1
    v_addc_co_u32 v5, vcc, 0, v5, vcc
    v_lshl_add_u32 v50, v5, 10, v6
    v_add_u32 v5, 2, v4
    v_cmp_le_u32 vcc, s33, v5
    s_nop 1
    v_addc_co_u32 v5, vcc, 0, v5, vcc
    v_lshl_add_u32 v51, v5, 10, v6
    v_add_u32 v5, 4, v4
    v_cmp_le_u32 vcc, s33, v5
    s_nop 1
    v_addc_co_u32 v5, vcc, 0, v5, vcc
    v_lshl_add_u32 v52, v5, 10, v6
    v_mov_b32 v5, v7
    v_mov_b32 v6, 512
    v_cmp_le_u32 vcc, s33, v5
    s_nop 1
    v_addc_co_u32 v5, vcc, 0, v5, vcc
    v_lshl_add_u32 v53, v5, 10, v6
    s_mul_i32 s38, s3, 320
    s_add_u32 s38, s38, 135168
    v_lshlrev_b32 v4, 6, v2
    v_lshl_add_u32 v4, v3, 1, v4
    v_add_u32 v31, s38, v4
    v_mfma_f32_16x16x32_bf16 v[96:99], a[60:63], v[92:95], v[96:99]
    v_mfma_f32_16x16x32_bf16 v[112:115], a[64:67], v[80:83], 0
    s_waitcnt vmcnt(5)
    buffer_load_dwordx4 v[136:139], v76, s[52:55], s85 offen offset:1024 nt
    v_mfma_f32_16x16x32_bf16 v[112:115], a[68:71], v[84:87], v[112:115]
    v_mfma_f32_16x16x32_bf16 v[112:115], a[72:75], v[88:91], v[112:115]
    s_nop 2
    v_mov_b32_dpp v122, v96 quad_perm:[0,0,0,0] row_mask:0xf bank_mask:0xf
    v_mov_b32_dpp v124, v98 quad_perm:[2,2,2,2] row_mask:0xf bank_mask:0xf
    s_nop 0
    v_add_f32_dpp v122, v97, v122 quad_perm:[1,1,1,1] row_mask:0xf bank_mask:0xf
    v_add_f32_dpp v124, v99, v124 quad_perm:[3,3,3,3] row_mask:0xf bank_mask:0xf
    v_add_f32 v122, v122, v124
    v_max_f32 v65, v65, v122
    ds_write_b32 v64, v122 offset:2816
    v_mfma_f32_16x16x32_bf16 v[112:115], a[76:79], v[92:95], v[112:115]
    v_mfma_f32_16x16x32_bf16 v[96:99], a[80:83], v[80:83], 0
    v_lshlrev_b32 v4, 11, v2
    v_bfe_u32 v5, v1, 2, 2
    v_lshl_add_u32 v4, v5, 8, v4
    v_bfe_u32 v5, v1, 2, 2
    v_lshl_add_u32 v4, v5, 6, v4
    v_bfe_u32 v5, v1, 4, 1
    v_lshl_add_u32 v4, v5, 5, v4
    v_bfe_u32 v5, v1, 1, 1
    v_lshl_add_u32 v4, v5, 4, v4
    v_bfe_u32 v5, v1, 0, 1
    v_lshl_add_u32 v4, v5, 3, v4
    s_lshl_b32 s38, s34, 6
    s_add_u32 s38, s38, 98304
    v_xor_b32 v24, s38, v4
    v_xor_b32 v25, 16, v24
    v_xor_b32 v26, 32, v24
    v_xor_b32 v27, 48, v24
    v_and_b32 v4, 3, v3
    v_lshrrev_b32 v5, 2, v3
    v_lshlrev_b32 v6, 4, v2
    v_add_u32 v6, 135168, v6
    s_movk_i32 s36, 320
    v_cmp_eq_u32 vcc, 0, v5
    s_nop 1
    v_cndmask_b32 v28, 4, v4, vcc
    v_mad_u32_u24 v28, v28, s36, v6
    v_cmp_eq_u32 vcc, 1, v5
    s_nop 1
    v_cndmask_b32 v29, 4, v4, vcc
    v_mad_u32_u24 v29, v29, s36, v6
    v_lshlrev_b32 v5, 2, v1
    v_add_u32 v5, 136448, v5
    v_mov_b32 v6, 0
    ds_write_b32 v5, v6
    s_waitcnt vmcnt(5)
    buffer_load_dwordx4 v[140:143], v77, s[52:55], s85 offen offset:1024 nt
    s_add_u32 s87, s87, 7
    s_add_u32 s39, s87, s88
    s_bfe_u32 s37, s39, 0x30000
    s_lshl_b32 s37, s37, 12
    s_add_u32 s85, s37, s89
    s_bfe_u32 s37, s39, 0x10003
    s_lshl_b32 s37, s37, 11
    s_add_u32 s85, s37, s85
    s_bfe_u32 s37, s39, 0x40004
    s_lshl_b32 s37, s37, 16
    s_add_u32 s85, s37, s85
    v_mfma_f32_16x16x32_bf16 v[96:99], a[84:87], v[84:87], v[96:99]
    v_mfma_f32_16x16x32_bf16 v[96:99], a[88:91], v[88:91], v[96:99]
    v_mov_b32_dpp v122, v112 quad_perm:[0,0,0,0] row_mask:0xf bank_mask:0xf
    v_mov_b32_dpp v124, v114 quad_perm:[2,2,2,2] row_mask:0xf bank_mask:0xf
    s_nop 0
    v_add_f32_dpp v122, v113, v122 quad_perm:[1,1,1,1] row_mask:0xf bank_mask:0xf
    v_add_f32_dpp v124, v115, v124 quad_perm:[3,3,3,3] row_mask:0xf bank_mask:0xf
    v_add_f32 v122, v122, v124
    v_max_f32 v65, v65, v122
    ds_write_b32 v64, v122 offset:3072
    v_mfma_f32_16x16x32_bf16 v[96:99], a[92:95], v[92:95], v[96:99]
    s_waitcnt vmcnt(5)
    buffer_load_dwordx4 v[144:147], v76, s[52:55], s85 offen offset:0 nt
    v_mfma_f32_16x16x32_bf16 v[112:115], a[96:99], v[80:83], 0
    v_mfma_f32_16x16x32_bf16 v[112:115], a[100:103], v[84:87], v[112:115]
    v_mfma_f32_16x16x32_bf16 v[112:115], a[104:107], v[88:91], v[112:115]
    s_nop 2
    v_mov_b32_dpp v122, v96 quad_perm:[0,0,0,0] row_mask:0xf bank_mask:0xf
    v_mov_b32_dpp v124, v98 quad_perm:[2,2,2,2] row_mask:0xf bank_mask:0xf
    s_nop 0
    v_add_f32_dpp v122, v97, v122 quad_perm:[1,1,1,1] row_mask:0xf bank_mask:0xf
    v_add_f32_dpp v124, v99, v124 quad_perm:[3,3,3,3] row_mask:0xf bank_mask:0xf
    v_add_f32 v122, v122, v124
    v_max_f32 v65, v65, v122
    ds_write_b32 v64, v122 offset:3328
    v_lshlrev_b32 v30, 4, v3
    v_lshl_add_u32 v30, v2, 13, v30
    v_lshrrev_b32 v5, 2, v1
    v_lshlrev_b32 v32, 8, v5
    v_bfe_u32 v5, v1, 0, 2
    v_lshl_add_u32 v32, v5, 4, v32
    s_xor_b32 s37, s90, 4
    s_bfe_u32 s38, s37, 0x30000
    s_lshl_b32 s38, s38, 8
    s_add_u32 s36, s38, 0
    s_lshr_b32 s38, s32, 4
    s_lshl_b32 s38, s38, 7
    s_add_u32 s36, s38, s36
    s_bfe_u32 s38, s32, 0x20000
    s_lshl_b32 s38, s38, 5
    s_add_u32 s36, s38, s36
    s_bfe_u32 s38, s32, 0x20002
    s_lshl_b32 s38, s38, 3
    s_add_u32 s36, s38, s36
    v_bfe_u32 v5, v1, 0, 2
    v_lshlrev_b32 v33, 11, v5
    v_lshl_add_u32 v33, v2, 1, v33
    v_add_u32 v33, s36, v33
    v_and_b32 v5, 31, v1
    v_lshlrev_b32 v34, 4, v5
    s_mul_i32 s38, s34, 320
    s_add_u32 s38, s38, 135168
    v_lshl_add_u32 v35, v5, 3, s38
    s_bfe_u32 s38, s34, 0x10000
    s_lshl_b32 s38, s38, 12
    s_add_u32 s36, s38, s71
    s_lshr_b32 s38, s34, 1
    s_lshl_b32 s38, s38, 24
    s_add_u32 s36, s38, s36
    s_bitcmp1_b32 s90, 2
    s_cselect_b32 s46, s46, s36
    s_cselect_b64 vcc, -1, 0
    v_cndmask_b32 v54, v32, v34, vcc
    v_mfma_f32_16x16x32_bf16 v[112:115], a[108:111], v[92:95], v[112:115]
    s_waitcnt vmcnt(5)
    buffer_load_dwordx4 v[148:151], v77, s[52:55], s85 offen offset:0 nt
    v_mfma_f32_16x16x32_bf16 v[96:99], a[112:115], v[80:83], 0
    v_mfma_f32_16x16x32_bf16 v[96:99], a[116:119], v[84:87], v[96:99]
    v_mfma_f32_16x16x32_bf16 v[96:99], a[120:123], v[88:91], v[96:99]
    s_nop 2
    v_mov_b32_dpp v122, v112 quad_perm:[0,0,0,0] row_mask:0xf bank_mask:0xf
    v_mov_b32_dpp v124, v114 quad_perm:[2,2,2,2] row_mask:0xf bank_mask:0xf
    s_nop 0
    v_add_f32_dpp v122, v113, v122 quad_perm:[1,1,1,1] row_mask:0xf bank_mask:0xf
    v_add_f32_dpp v124, v115, v124 quad_perm:[3,3,3,3] row_mask:0xf bank_mask:0xf
    v_add_f32 v122, v122, v124
    v_max_f32 v65, v65, v122
    ds_write_b32 v64, v122 offset:3584
    v_mfma_f32_16x16x32_bf16 v[96:99], a[124:127], v[92:95], v[96:99]
    v_add_u32 v64, 3840, v64
    s_mov_b32 s97, 8
    s_mov_b32 s92, 7
    s_lshl_b32 s38, s32, 13
    s_add_u32 s80, s38, 3145728
    s_lshl_b32 s38, s3, 11
    s_add_u32 s80, s38, s80
    v_lshrrev_b32 v4, 2, v1
    v_lshlrev_b32 v55, 3, v4
    s_mov_b32 s66, 134217728
    s_mov_b32 s67, 0x20000
    s_mov_b64 s[64:65], s[52:53]
    v_mov_b32 v62, v76
    v_mov_b32 v63, v77
L_bloop:
    s_waitcnt vmcnt(5)
    buffer_load_dwordx4 v[152:155], v62, s[64:67], s85 offen offset:1024 nt
    v_mfma_f32_16x16x32_bf16 v[112:115], v[128:131], v[80:83], 0
    s_waitcnt vmcnt(5)
    buffer_load_dwordx4 v[156:159], v63, s[64:67], s85 offen offset:1024 nt
    v_mfma_f32_16x16x32_bf16 v[112:115], v[132:135], v[84:87], v[112:115]
    s_cmp_le_u32 s97, 2
    s_cbranch_scc1 L_rare_3
L_back_4:
    s_add_u32 s87, s87, 7
L_done_5:
    s_add_u32 s39, s87, s88
    s_bfe_u32 s37, s39, 0x30000
    s_lshl_b32 s37, s37, 12
    s_add_u32 s85, s37, s89
    s_bfe_u32 s37, s39, 0x10003
    s_lshl_b32 s37, s37, 11
    s_add_u32 s85, s37, s85
    s_bfe_u32 s37, s39, 0x40004
    s_lshl_b32 s37, s37, 16
    s_add_u32 s85, s37, s85
    v_mov_b32_dpp v122, v96 quad_perm:[0,0,0,0] row_mask:0xf bank_mask:0xf
    v_mov_b32_dpp v124, v98 quad_perm:[2,2,2,2] row_mask:0xf bank_mask:0xf
    s_nop 0
    v_add_f32_dpp v122, v97, v122 quad_perm:[1,1,1,1] row_mask:0xf bank_mask:0xf
    v_add_f32_dpp v124, v99, v124 quad_perm:[3,3,3,3] row_mask:0xf bank_mask:0xf
    v_add_f32 v122, v122, v124
    v_max_f32 v65, v65, v122
    ds_write_b32 v64, v122 offset:0
    s_waitcnt vmcnt(5)
    buffer_load_dwordx4 v[128:131], v62, s[64:67], s85 offen offset:0 nt
    v_mfma_f32_16x16x32_bf16 v[112:115], v[136:139], v[88:91], v[112:115]
    s_waitcnt vmcnt(5)
    buffer_load_dwordx4 v[132:135], v63, s[64:67], s85 offen offset:0 nt
    v_mfma_f32_16x16x32_bf16 v[112:115], v[140:143], v[92:95], v[112:115]
    s_waitcnt vmcnt(5)
    buffer_load_dwordx4 v[136:139], v62, s[64:67], s85 offen offset:1024 nt
    v_mfma_f32_16x16x32_bf16 v[96:99], v[144:147], v[80:83], 0
    s_waitcnt vmcnt(5)
    buffer_load_dwordx4 v[140:143], v63, s[64:67], s85 offen offset:1024 nt
    v_mfma_f32_16x16x32_bf16 v[96:99], v[148:151], v[84:87], v[96:99]
    s_add_u32 s87, s87, s92
    s_add_u32 s39, s87, s88
    s_bfe_u32 s37, s39, 0x30000
    s_lshl_b32 s37, s37, 12
    s_add_u32 s85, s37, s89
    s_bfe_u32 s37, s39, 0x10003
    s_lshl_b32 s37, s37, 11
    s_add_u32 s85, s37, s85
    s_bfe_u32 s37, s39, 0x40004
    s_lshl_b32 s37, s37, 16
    s_add_u32 s85, s37, s85
    v_mov_b32_dpp v122, v112 quad_perm:[0,0,0,0] row_mask:0xf bank_mask:0xf
    v_mov_b32_dpp v124, v114 quad_perm:[2,2,2,2] row_mask:0xf bank_mask:0xf
    s_nop 0
    v_add_f32_dpp v122, v113, v122 quad_perm:[1,1,1,1] row_mask:0xf bank_mask:0xf
    v_add_f32_dpp v124, v115, v124 quad_perm:[3,3,3,3] row_mask:0xf bank_mask:0xf
    v_add_f32 v122, v122, v124
    v_max_f32 v65, v65, v122
    ds_write_b32 v64, v122 offset:256
    s_waitcnt vmcnt(5)
    buffer_load_dwordx4 v[144:147], v62, s[64:67], s85 offen offset:0 nt
    v_mfma_f32_16x16x32_bf16 v[96:99], v[152:155], v[88:91], v[96:99]
    s_waitcnt vmcnt(5)
    buffer_load_dwordx4 v[148:151], v63, s[64:67], s85 offen offset:0 nt
    v_mfma_f32_16x16x32_bf16 v[96:99], v[156:159], v[92:95], v[96:99]
    v_add_u32 v64, 512, v64
    s_sub_u32 s97, s97, 1
    s_cmp_lg_u32 s97, 0
    s_cbranch_scc1 L_bloop
    s_bfe_u32 s38, s2, 0x30000
    s_lshl_b32 s38, s38, 8
    s_add_u32 s69, s38, 32768
    v_lshrrev_b32 v68, 2, v34
    buffer_load_dword v68, v68, s[48:51], s69 offen sc1
    v_mov_b32_dpp v122, v96 quad_perm:[0,0,0,0] row_mask:0xf bank_mask:0xf
    v_mov_b32_dpp v124, v98 quad_perm:[2,2,2,2] row_mask:0xf bank_mask:0xf
    s_nop 0
    v_add_f32_dpp v122, v97, v122 quad_perm:[1,1,1,1] row_mask:0xf bank_mask:0xf
    v_add_f32_dpp v124, v99, v124 quad_perm:[3,3,3,3] row_mask:0xf bank_mask:0xf
    v_add_f32 v122, v122, v124
    v_max_f32 v65, v65, v122
    ds_write_b32 v64, v122 offset:0
    v_mov_b32 v123, 0xff7f0000
    ds_write_b32 v64, v123 offset:256
    s_lshl_b32 s38, s34, 14
    s_add_u32 s38, s38, 16384
    v_lshl_add_u32 v64, v1, 2, s38
    ds_read_b32 v66, v64
    ds_read_b32 v67, v64 offset:256
    v_mul_f32 v65, s83, v65
    s_nop 1
    v_max_f32_dpp v124, v65, v65 row_ror:4 row_mask:0xf bank_mask:0xf
    s_nop 1
    v_max_f32_dpp v124, v124, v124 row_ror:8 row_mask:0xf bank_mask:0xf
    v_mov_b32 v125, v124
    s_nop 1
    v_permlane16_swap_b32 v124, v125
    v_max_f32 v124, v124, v125
    v_mov_b32 v125, v124
    s_nop 1
    v_permlane32_swap_b32 v124, v125
    v_max_f32 v124, v124, v125
    v_mov_b32 v120, v124
    s_mov_b32 s97, 16
    s_waitcnt lgkmcnt(1)
    v_fma_f32 v123, v66, s83, -v120
    v_exp_f32 v123, v123
    ds_read_b32 v66, v64 offset:512
    v_cvt_pk_bf16_f32 v100, v123, v123
    v_add_f32 v121, v121, v123
    v_and_b32 v65, 1, v1
    v_lshl_add_u32 v65, v65, 2, v55
    s_mov_b32 vcc_lo, 0xaaaaaaaa
    s_mov_b32 vcc_hi, 0xaaaaaaaa
    s_cmp_ge_u32 s93, 16
    s_cbranch_scc1 L_kdone
L_kdyn:
    s_lshl_b32 s81, s93, 7
    s_add_u32 s81, s81, s80
    s_waitcnt vmcnt(5)
    buffer_load_dwordx4 v[152:155], v62, s[64:67], s85 offen offset:1024 nt
    v_mfma_f32_16x16x32_bf16 v[112:115], v[128:131], v[80:83], 0
    s_waitcnt vmcnt(5)
    buffer_load_dwordx4 v[156:159], v63, s[64:67], s85 offen offset:1024 nt
    v_mfma_f32_16x16x32_bf16 v[112:115], v[132:135], v[84:87], v[112:115]
    s_cmp_lg_u32 s62, 0
    s_cbranch_scc1 L_nopost_11
    v_add_u32 v19, 1, v19
    s_mov_b64 exec, 1
    ds_write_b32 v0, v19 offset:4
L_nopost_11:
    s_mov_b64 exec, 1
    ds_add_rtn_u32 v5, v0, v18 offset:8
    s_mov_b64 exec, -1
L_again_12:
    ds_read_b32 v4, v0 offset:4
    s_waitcnt lgkmcnt(0)
    v_readfirstlane_b32 s93, v4
    s_nop 0
    s_sub_u32 s93, s93, 1
    s_cbranch_scc1 L_retry_13
    v_add_u32 v0, 8, v0
    s_cmp_ge_u32 s93, 16
    s_cbranch_scc1 L_gone_10
    s_lshl_b32 s87, s93, 1
    s_add_u32 s87, s87, 224
    s_mov_b32 s92, 1
    v_mov_b32 v19, 64
    s_mov_b32 s62, 0
    s_cmp_ge_u32 s93, 15
    s_cbranch_scc1 L_lastone_14
    v_readfirstlane_b32 s62, v5
    s_nop 0
    s_cmp_lg_u32 s62, 0
    s_cbranch_scc1 L_nodraw_15
    s_mov_b64 exec, 1
    global_atomic_add v19, v9, v18, s[30:31] offset:0 sc0 sc1
    s_mov_b64 exec, -1
L_nodraw_15:
L_lastone_14:
L_done_9:
    s_add_u32 s39, s87, s88
    s_bfe_u32 s37, s39, 0x30000
    s_lshl_b32 s37, s37, 12
    s_add_u32 s85, s37, s89
    s_bfe_u32 s37, s39, 0x10003
    s_lshl_b32 s37, s37, 11
    s_add_u32 s85, s37, s85
    s_bfe_u32 s37, s39, 0x40004
    s_lshl_b32 s37, s37, 16
    s_add_u32 s85, s37, s85
    s_waitcnt vmcnt(5)
    buffer_load_dwordx4 v[128:131], v62, s[64:67], s85 offen offset:0 nt
    v_mfma_f32_16x16x32_bf16 v[112:115], v[136:139], v[88:91], v[112:115]
    s_waitcnt vmcnt(5)
    buffer_load_dwordx4 v[132:135], v63, s[64:67], s85 offen offset:0 nt
    v_mfma_f32_16x16x32_bf16 v[112:115], v[140:143], v[92:95], v[112:115]
    s_waitcnt vmcnt(5)
    buffer_load_dwordx4 v[136:139], v62, s[64:67], s85 offen offset:1024 nt
    v_mfma_f32_16x16x32_bf16 v[96:99], v[144:147], v[80:83], 0
    s_waitcnt vmcnt(5)
    buffer_load_dwordx4 v[140:143], v63, s[64:67], s85 offen offset:1024 nt
    v_mfma_f32_16x16x32_bf16 v[96:99], v[148:151], v[84:87], v[96:99]
    s_add_u32 s87, s87, s92
    s_add_u32 s39, s87, s88
    s_bfe_u32 s37, s39, 0x30000
    s_lshl_b32 s37, s37, 12
    s_add_u32 s85, s37, s89
    s_bfe_u32 s37, s39, 0x10003
    s_lshl_b32 s37, s37, 11
    s_add_u32 s85, s37, s85
    s_bfe_u32 s37, s39, 0x40004
    s_lshl_b32 s37, s37, 16
    s_add_u32 s85, s37, s85
    v_mov_b32_dpp v123, v112 quad_perm:[0,0,0,0] row_mask:0xf bank_mask:0xf
    v_mov_b32_dpp v124, v114 quad_perm:[2,2,2,2] row_mask:0xf bank_mask:0xf
    s_nop 0
    v_add_f32_dpp v123, v113, v123 quad_perm:[1,1,1,1] row_mask:0xf bank_mask:0xf
    v_add_f32_dpp v124, v115, v124 quad_perm:[3,3,3,3] row_mask:0xf bank_mask:0xf
    v_add_f32 v123, v123, v124
    s_waitcnt vmcnt(5)
    buffer_load_dwordx4 v[144:147], v62, s[64:67], s85 offen offset:0 nt
    v_mfma_f32_16x16x32_bf16 v[96:99], v[152:155], v[88:91], v[96:99]
    s_waitcnt vmcnt(5)
    buffer_load_dwordx4 v[148:151], v63, s[64:67], s85 offen offset:0 nt
    v_mfma_f32_16x16x32_bf16 v[96:99], v[156:159], v[92:95], v[96:99]
    s_nop 7
    v_mov_b32_dpp v122, v96 quad_perm:[0,0,0,0] row_mask:0xf bank_mask:0xf
    v_mov_b32_dpp v124, v98 quad_perm:[2,2,2,2] row_mask:0xf bank_mask:0xf
    s_nop 0
    v_add_f32_dpp v122, v97, v122 quad_perm:[1,1,1,1] row_mask:0xf bank_mask:0xf
    v_add_f32_dpp v124, v99, v124 quad_perm:[3,3,3,3] row_mask:0xf bank_mask:0xf
    v_add_f32 v122, v122, v124
    v_cndmask_b32 v123, v123, v122, vcc
    v_and_or_b32 v123, v123, s82, v8
    s_mov_b32 exec_lo, 0x33333333
    s_mov_b32 exec_hi, 0x33333333
    buffer_store_dword v123, v65, s[48:51], s81 offen sc1
    s_mov_b64 exec, -1
    s_cmp_lt_u32 s93, 16
    s_cbranch_scc1 L_kdyn
L_kdone:
L_vloop:
    v_and_b32_dpp v104, v100, v10 row_newbcast:0 row_mask:0xf bank_mask:0xf
    v_and_b32_dpp v105, v100, v11 row_newbcast:0 row_mask:0xf bank_mask:0xf
    v_and_b32_dpp v106, v100, v12 row_newbcast:0 row_mask:0xf bank_mask:0xf
    v_and_b32_dpp v107, v100, v13 row_newbcast:0 row_mask:0xf bank_mask:0xf
    s_waitcnt vmcnt(5)
    buffer_load_dwordx4 v[152:155], v62, s[64:67], s85 offen offset:1024 nt
    v_mfma_f32_16x16x32_bf16 v[116:119], v[128:131], v[104:107], v[116:119]
    v_and_b32_dpp v108, v100, v10 row_newbcast:4 row_mask:0xf bank_mask:0xf
    v_and_b32_dpp v109, v100, v11 row_newbcast:4 row_mask:0xf bank_mask:0xf
    v_and_b32_dpp v110, v100, v12 row_newbcast:4 row_mask:0xf bank_mask:0xf
    v_and_b32_dpp v111, v100, v13 row_newbcast:4 row_mask:0xf bank_mask:0xf
    s_waitcnt vmcnt(5)
    buffer_load_dwordx4 v[156:159], v63, s[64:67], s85 offen offset:1024 nt
    v_mfma_f32_16x16x32_bf16 v[116:119], v[132:135], v[108:111], v[116:119]
    s_cmp_le_u32 s97, 2
    s_cbranch_scc1 L_rare_16
L_back_17:
    s_add_u32 s87, s87, 7
L_done_18:
    s_add_u32 s39, s87, s88
    s_bfe_u32 s37, s39, 0x30000
    s_lshl_b32 s37, s37, 12
    s_add_u32 s85, s37, s89
    s_bfe_u32 s37, s39, 0x10003
    s_lshl_b32 s37, s37, 11
    s_add_u32 s85, s37, s85
    s_bfe_u32 s37, s39, 0x40004
    s_lshl_b32 s37, s37, 16
    s_add_u32 s85, s37, s85
    s_waitcnt lgkmcnt(1)
    v_fma_f32 v123, v67, s83, -v120
    v_exp_f32 v123, v123
    ds_read_b32 v67, v64 offset:768
    v_cvt_pk_bf16_f32 v101, v123, v123
    v_add_f32 v121, v121, v123
    v_and_b32_dpp v104, v100, v10 row_newbcast:8 row_mask:0xf bank_mask:0xf
    v_and_b32_dpp v105, v100, v11 row_newbcast:8 row_mask:0xf bank_mask:0xf
    v_and_b32_dpp v106, v100, v12 row_newbcast:8 row_mask:0xf bank_mask:0xf
    v_and_b32_dpp v107, v100, v13 row_newbcast:8 row_mask:0xf bank_mask:0xf
    s_waitcnt vmcnt(5)
    buffer_load_dwordx4 v[128:131], v62, s[64:67], s85 offen offset:0 nt
    v_mfma_f32_16x16x32_bf16 v[116:119], v[136:139], v[104:107], v[116:119]
    v_and_b32_dpp v108, v100, v10 row_newbcast:12 row_mask:0xf bank_mask:0xf
    v_and_b32_dpp v109, v100, v11 row_newbcast:12 row_mask:0xf bank_mask:0xf
    v_and_b32_dpp v110, v100, v12 row_newbcast:12 row_mask:0xf bank_mask:0xf
    v_and_b32_dpp v111, v100, v13 row_newbcast:12 row_mask:0xf bank_mask:0xf
    s_waitcnt vmcnt(5)
    buffer_load_dwordx4 v[132:135], v63, s[64:67], s85 offen offset:0 nt
    v_mfma_f32_16x16x32_bf16 v[116:119], v[140:143], v[108:111], v[116:119]
    v_and_b32_dpp v104, v101, v10 row_newbcast:0 row_mask:0xf bank_mask:0xf
    v_and_b32_dpp v105, v101, v11 row_newbcast:0 row_mask:0xf bank_mask:0xf
    v_and_b32_dpp v106, v101, v12 row_newbcast:0 row_mask:0xf bank_mask:0xf
    v_and_b32_dpp v107, v101, v13 row_newbcast:0 row_mask:0xf bank_mask:0xf
    s_waitcnt vmcnt(5)
    buffer_load_dwordx4 v[136:139], v62, s[64:67], s85 offen offset:1024 nt
    v_mfma_f32_16x16x32_bf16 v[116:119], v[144:147], v[104:107], v[116:119]
    v_and_b32_dpp v108, v101, v10 row_newbcast:4 row_mask:0xf bank_mask:0xf
    v_and_b32_dpp v109, v101, v11 row_newbcast:4 row_mask:0xf bank_mask:0xf
    v_and_b32_dpp v110, v101, v12 row_newbcast:4 row_mask:0xf bank_mask:0xf
    v_and_b32_dpp v111, v101, v13 row_newbcast:4 row_mask:0xf bank_mask:0xf
    s_waitcnt vmcnt(5)
    buffer_load_dwordx4 v[140:143], v63, s[64:67], s85 offen offset:1024 nt
    v_mfma_f32_16x16x32_bf16 v[116:119], v[148:151], v[108:111], v[116:119]
    s_add_u32 s87, s87, s92
    s_add_u32 s39, s87, s88
    s_bfe_u32 s37, s39, 0x30000
    s_lshl_b32 s37, s37, 12
    s_add_u32 s85, s37, s89
    s_bfe_u32 s37, s39, 0x10003
    s_lshl_b32 s37, s37, 11
    s_add_u32 s85, s37, s85
    s_bfe_u32 s37, s39, 0x40004
    s_lshl_b32 s37, s37, 16
    s_add_u32 s85, s37, s85
    v_add_u32 v64, 512, v64
    s_waitcnt lgkmcnt(1)
    v_fma_f32 v123, v66, s83, -v120
    v_exp_f32 v123, v123
    ds_read_b32 v66, v64 offset:512
    v_cvt_pk_bf16_f32 v100, v123, v123
    v_add_f32 v121, v121, v123
    v_and_b32_dpp v104, v101, v10 row_newbcast:8 row_mask:0xf bank_mask:0xf
    v_and_b32_dpp v105, v101, v11 row_newbcast:8 row_mask:0xf bank_mask:0xf
    v_and_b32_dpp v106, v101, v12 row_newbcast:8 row_mask:0xf bank_mask:0xf
    v_and_b32_dpp v107, v101, v13 row_newbcast:8 row_mask:0xf bank_mask:0xf
    s_waitcnt vmcnt(5)
    buffer_load_dwordx4 v[144:147], v62, s[64:67], s85 offen offset:0 nt
    v_mfma_f32_16x16x32_bf16 v[116:119], v[152:155], v[104:107], v[116:119]
    v_and_b32_dpp v108, v101, v10 row_newbcast:12 row_mask:0xf bank_mask:0xf
    v_and_b32_dpp v109, v101, v11 row_newbcast:12 row_mask:0xf bank_mask:0xf
    v_and_b32_dpp v110, v101, v12 row_newbcast:12 row_mask:0xf bank_mask:0xf
    v_and_b32_dpp v111, v101, v13 row_newbcast:12 row_mask:0xf bank_mask:0xf
    s_waitcnt vmcnt(5)
    buffer_load_dwordx4 v[148:151], v63, s[64:67], s85 offen offset:0 nt
    v_mfma_f32_16x16x32_bf16 v[116:119], v[156:159], v[108:111], v[116:119]
    s_sub_u32 s97, s97, 1
    s_cmp_lg_u32 s97, 0
    s_cbranch_scc1 L_vloop
    buffer_load_dwordx4 v[152:155], v62, s[64:67], s85 offen offset:1024 nt
    v_cmp_ne_u32 vcc, s70, v68
    s_nop 0
    s_cmp_eq_u64 vcc, 0
    s_cselect_b32 s70, 1, 0
    s_cmp_ge_u32 s93, 16
    s_cbranch_scc1 L_none
L_vdyn:
    s_waitcnt vmcnt(6)
    buffer_load_dwordx4 v[156:159], v63, s[64:67], s85 offen offset:1024 nt
L_sccheck:
    v_xor_b32 v102, s35, v102
    v_xor_b32 v103, s35, v103
    v_or_b32 v4, v102, v103
    v_and_b32 v4, 0xff, v4
    v_cmp_ne_u32 vcc, 0, v4
    v_fma_f32 v123, v102, s83, -v120
    v_fma_f32 v122, v103, s83, -v120
    s_cbranch_vccnz L_scretry
    v_max_f32 v124, v123, v122
    v_cmp_lt_f32 vcc, 0, v124
    s_cbranch_vccnz L_newmax
L_oldmax:
    v_exp_f32 v123, v123
    v_exp_f32 v122, v122
    v_cvt_pk_bf16_f32 v100, v123, v123
    v_add_f32 v121, v121, v123
    v_cvt_pk_bf16_f32 v101, v122, v122
    v_add_f32 v121, v121, v122
    s_cmp_lg_u32 s62, 0
    s_cbranch_scc1 L_nopost_20
    v_add_u32 v19, 1, v19
    s_mov_b64 exec, 1
    ds_write_b32 v0, v19 offset:4
L_nopost_20:
    s_mov_b64 exec, 1
    ds_add_rtn_u32 v5, v0, v18 offset:8
    s_mov_b64 exec, -1
L_again_21:
    ds_read_b32 v4, v0 offset:4
    s_waitcnt lgkmcnt(0)
    v_readfirstlane_b32 s93, v4
    s_nop 0
    s_sub_u32 s93, s93, 1
    s_cbranch_scc1 L_retry_22
    v_add_u32 v0, 8, v0
    s_cmp_ge_u32 s93, 16
    s_cbranch_scc1 L_last
    s_lshl_b32 s81, s93, 7
    s_add_u32 s81, s81, s80
    buffer_load_dwordx2 v[102:103], v55, s[48:51], s81 offen sc1
    s_lshl_b32 s87, s93, 1
    s_add_u32 s87, s87, 224
    s_mov_b32 s92, 1
    v_mov_b32 v19, 64
    s_mov_b32 s62, 0
    s_cmp_ge_u32 s93, 15
    s_cbranch_scc1 L_lastone_23
    v_readfirstlane_b32 s62, v5
    s_nop 0
    s_cmp_lg_u32 s62, 0
    s_cbranch_scc1 L_nodraw_24
    s_mov_b64 exec, 1
    global_atomic_add v19, v9, v18, s[30:31] offset:4 sc0 sc1
    s_mov_b64 exec, -1
L_nodraw_24:
L_lastone_23:
    s_add_u32 s39, s87, s88
    s_bfe_u32 s37, s39, 0x30000
    s_lshl_b32 s37, s37, 12
    s_add_u32 s85, s37, s89
    s_bfe_u32 s37, s39, 0x10003
    s_lshl_b32 s37, s37, 11
    s_add_u32 s85, s37, s85
    s_bfe_u32 s37, s39, 0x40004
    s_lshl_b32 s37, s37, 16
    s_add_u32 s85, s37, s85
    v_and_b32_dpp v104, v100, v10 row_newbcast:0 row_mask:0xf bank_mask:0xf
    v_and_b32_dpp v105, v100, v11 row_newbcast:0 row_mask:0xf bank_mask:0xf
    v_and_b32_dpp v106, v100, v12 row_newbcast:0 row_mask:0xf bank_mask:0xf
    v_and_b32_dpp v107, v100, v13 row_newbcast:0 row_mask:0xf bank_mask:0xf
    s_nop 1
    v_mfma_f32_16x16x32_bf16 v[116:119], v[128:131], v[104:107], v[116:119]
    v_and_b32_dpp v108, v100, v10 row_newbcast:4 row_mask:0xf bank_mask:0xf
    v_and_b32_dpp v109, v100, v11 row_newbcast:4 row_mask:0xf bank_mask:0xf
    v_and_b32_dpp v110, v100, v12 row_newbcast:4 row_mask:0xf bank_mask:0xf
    v_and_b32_dpp v111, v100, v13 row_newbcast:4 row_mask:0xf bank_mask:0xf
    s_waitcnt vmcnt(7)
    buffer_load_dwordx4 v[128:131], v62, s[64:67], s85 offen offset:0 nt
    v_mfma_f32_16x16x32_bf16 v[116:119], v[132:135], v[108:111], v[116:119]
    v_and_b32_dpp v104, v100, v10 row_newbcast:8 row_mask:0xf bank_mask:0xf
    v_and_b32_dpp v105, v100, v11 row_newbcast:8 row_mask:0xf bank_mask:0xf
    v_and_b32_dpp v106, v100, v12 row_newbcast:8 row_mask:0xf bank_mask:0xf
    v_and_b32_dpp v107, v100, v13 row_newbcast:8 row_mask:0xf bank_mask:0xf
    s_waitcnt vmcnt(7)
    buffer_load_dwordx4 v[132:135], v63, s[64:67], s85 offen offset:0 nt
    v_mfma_f32_16x16x32_bf16 v[116:119], v[136:139], v[104:107], v[116:119]
    v_and_b32_dpp v108, v100, v10 row_newbcast:12 row_mask:0xf bank_mask:0xf
    v_and_b32_dpp v109, v100, v11 row_newbcast:12 row_mask:0xf bank_mask:0xf
    v_and_b32_dpp v110, v100, v12 row_newbcast:12 row_mask:0xf bank_mask:0xf
    v_and_b32_dpp v111, v100, v13 row_newbcast:12 row_mask:0xf bank_mask:0xf
    s_waitcnt vmcnt(7)
    buffer_load_dwordx4 v[136:139], v62, s[64:67], s85 offen offset:1024 nt
    v_mfma_f32_16x16x32_bf16 v[116:119], v[140:143], v[108:111], v[116:119]
    v_and_b32_dpp v104, v101, v10 row_newbcast:0 row_mask:0xf bank_mask:0xf
    v_and_b32_dpp v105, v101, v11 row_newbcast:0 row_mask:0xf bank_mask:0xf
    v_and_b32_dpp v106, v101, v12 row_newbcast:0 row_mask:0xf bank_mask:0xf
    v_and_b32_dpp v107, v101, v13 row_newbcast:0 row_mask:0xf bank_mask:0xf
    s_waitcnt vmcnt(7)
    buffer_load_dwordx4 v[140:143], v63, s[64:67], s85 offen offset:1024 nt
    v_mfma_f32_16x16x32_bf16 v[116:119], v[144:147], v[104:107], v[116:119]
    s_add_u32 s87, s87, s92
    s_add_u32 s39, s87, s88
    s_bfe_u32 s37, s39, 0x30000
    s_lshl_b32 s37, s37, 12
    s_add_u32 s85, s37, s89
    s_bfe_u32 s37, s39, 0x10003
    s_lshl_b32 s37, s37, 11
    s_add_u32 s85, s37, s85
    s_bfe_u32 s37, s39, 0x40004
    s_lshl_b32 s37, s37, 16
    s_add_u32 s85, s37, s85
    v_and_b32_dpp v108, v101, v10 row_newbcast:4 row_mask:0xf bank_mask:0xf
    v_and_b32_dpp v109, v101, v11 row_newbcast:4 row_mask:0xf bank_mask:0xf
    v_and_b32_dpp v110, v101, v12 row_newbcast:4 row_mask:0xf bank_mask:0xf
    v_and_b32_dpp v111, v101, v13 row_newbcast:4 row_mask:0xf bank_mask:0xf
    s_waitcnt vmcnt(7)
    buffer_load_dwordx4 v[144:147], v62, s[64:67], s85 offen offset:0 nt
    v_mfma_f32_16x16x32_bf16 v[116:119], v[148:151], v[108:111], v[116:119]
    v_and_b32_dpp v104, v101, v10 row_newbcast:8 row_mask:0xf bank_mask:0xf
    v_and_b32_dpp v105, v101, v11 row_newbcast:8 row_mask:0xf bank_mask:0xf
    v_and_b32_dpp v106, v101, v12 row_newbcast:8 row_mask:0xf bank_mask:0xf
    v_and_b32_dpp v107, v101, v13 row_newbcast:8 row_mask:0xf bank_mask:0xf
    s_waitcnt vmcnt(7)
    buffer_load_dwordx4 v[148:151], v63, s[64:67], s85 offen offset:0 nt
    v_mfma_f32_16x16x32_bf16 v[116:119], v[152:155], v[104:107], v[116:119]
    v_and_b32_dpp v108, v101, v10 row_newbcast:12 row_mask:0xf bank_mask:0xf
    v_and_b32_dpp v109, v101, v11 row_newbcast:12 row_mask:0xf bank_mask:0xf
    v_and_b32_dpp v110, v101, v12 row_newbcast:12 row_mask:0xf bank_mask:0xf
    v_and_b32_dpp v111, v101, v13 row_newbcast:12 row_mask:0xf bank_mask:0xf
    s_waitcnt vmcnt(7)
    buffer_load_dwordx4 v[152:155], v62, s[64:67], s85 offen offset:1024 nt
    v_mfma_f32_16x16x32_bf16 v[116:119], v[156:159], v[108:111], v[116:119]
    s_branch L_vdyn
L_scretry:
    buffer_load_dwordx2 v[102:103], v55, s[48:51], s81 offen sc1
    s_waitcnt vmcnt(0)
    s_sub_u32 s84, s84, 1
    s_cmp_lg_u32 s84, 0
    s_cbranch_scc1 L_sccheck
    s_branch L_end
L_newmax:
    v_max_f32 v123, v102, v103
    v_mul_f32 v123, s83, v123
    s_nop 1
    v_max_f32_dpp v124, v123, v123 row_ror:4 row_mask:0xf bank_mask:0xf
    s_nop 1
    v_max_f32_dpp v124, v124, v124 row_ror:8 row_mask:0xf bank_mask:0xf
    v_mov_b32 v125, v124
    s_nop 1
    v_permlane16_swap_b32 v124, v125
    v_max_f32 v124, v124, v125
    v_mov_b32 v125, v124
    s_nop 1
    v_permlane32_swap_b32 v124, v125
    v_max_f32 v124, v124, v125
    v_max_f32 v124, v124, v120
    v_sub_f32 v125, v120, v124
    v_exp_f32 v125, v125
    v_mov_b32 v120, v124
    v_fma_f32 v123, v102, s83, -v120
    v_fma_f32 v122, v103, s83, -v120
    v_mul_f32 v121, v121, v125
    v_mul_f32 v116, v116, v125
    v_mul_f32 v117, v117, v125
    v_mul_f32 v118, v118, v125
    v_mul_f32 v119, v119, v125
    s_branch L_oldmax
L_rare_3:
    s_cmp_eq_u32 s97, 1
    s_cbranch_scc1 L_last_25
    s_mov_b64 exec, 1
    ds_add_rtn_u32 v5, v0, v18 offset:0
    s_mov_b64 exec, -1
    s_waitcnt lgkmcnt(0)
    v_readfirstlane_b32 s62, v5
    s_nop 0
    s_cmp_lg_u32 s62, 0
    s_cbranch_scc1 L_nodraw_26
    s_mov_b64 exec, 1
    global_atomic_add v19, v9, v18, s[30:31] offset:0 sc0 sc1
    s_mov_b64 exec, -1
L_nodraw_26:
    s_branch L_back_4
L_last_25:
    s_cmp_lg_u32 s62, 0
    s_cbranch_scc1 L_nopost_27
    v_add_u32 v19, 1, v19
    s_mov_b64 exec, 1
    ds_write_b32 v0, v19 offset:4
L_nopost_27:
    s_mov_b64 exec, 1
    ds_add_rtn_u32 v5, v0, v18 offset:8
    s_mov_b64 exec, -1
L_again_28:
    ds_read_b32 v4, v0 offset:4
    s_waitcnt lgkmcnt(0)
    v_readfirstlane_b32 s93, v4
    s_nop 0
    s_sub_u32 s93, s93, 1
    s_cbranch_scc1 L_retry_29
    v_add_u32 v0, 8, v0
    s_cmp_ge_u32 s93, 16
    s_cbranch_scc1 L_gone_6
    s_lshl_b32 s87, s93, 1
    s_add_u32 s87, s87, 224
    s_mov_b32 s92, 1
    v_mov_b32 v19, 64
    s_mov_b32 s62, 0
    s_cmp_ge_u32 s93, 15
    s_cbranch_scc1 L_lastone_30
    v_readfirstlane_b32 s62, v5
    s_nop 0
    s_cmp_lg_u32 s62, 0
    s_cbranch_scc1 L_nodraw_31
    s_mov_b64 exec, 1
    global_atomic_add v19, v9, v18, s[30:31] offset:0 sc0 sc1
    s_mov_b64 exec, -1
L_nodraw_31:
L_lastone_30:
    s_branch L_done_5
L_gone_6:
    s_mov_b64 s[64:65], s[56:57]
    v_mov_b32 v62, v126
    v_mov_b32 v63, v127
    s_lshl_b32 s87, s33, 0
    s_mov_b32 s92, 7
    v_add_u32 v0, 8, v0
    s_branch L_done_5
L_retry_13:
    s_sub_u32 s84, s84, 1
    s_cmp_lg_u32 s84, 0
    s_cbranch_scc1 L_again_12
    s_branch L_end
L_gone_10:
    s_mov_b64 s[64:65], s[56:57]
    v_mov_b32 v62, v126
    v_mov_b32 v63, v127
    s_lshl_b32 s87, s33, 0
    s_mov_b32 s92, 7
    v_add_u32 v0, 8, v0
    s_branch L_done_9
L_rare_16:
    s_cmp_eq_u32 s97, 1
    s_cbranch_scc1 L_last_32
    s_mov_b64 exec, 1
    ds_add_rtn_u32 v5, v0, v18 offset:0
    s_mov_b64 exec, -1
    s_waitcnt lgkmcnt(0)
    v_readfirstlane_b32 s62, v5
    s_nop 0
    s_cmp_lg_u32 s62, 0
    s_cbranch_scc1 L_nodraw_33
    s_mov_b64 exec, 1
    global_atomic_add v19, v9, v18, s[30:31] offset:4 sc0 sc1
    s_mov_b64 exec, -1
L_nodraw_33:
    s_branch L_back_17
L_last_32:
    s_cmp_lg_u32 s62, 0
    s_cbranch_scc1 L_nopost_34
    v_add_u32 v19, 1, v19
    s_mov_b64 exec, 1
    ds_write_b32 v0, v19 offset:4
L_nopost_34:
    s_mov_b64 exec, 1
    ds_add_rtn_u32 v5, v0, v18 offset:8
    s_mov_b64 exec, -1
L_again_35:
    ds_read_b32 v4, v0 offset:4
    s_waitcnt lgkmcnt(0)
    v_readfirstlane_b32 s93, v4
    s_nop 0
    s_sub_u32 s93, s93, 1
    s_cbranch_scc1 L_retry_36
    v_add_u32 v0, 8, v0
    s_cmp_ge_u32 s93, 16
    s_cbranch_scc1 L_gone_19
    s_lshl_b32 s81, s93, 7
    s_add_u32 s81, s81, s80
    buffer_load_dwordx2 v[102:103], v55, s[48:51], s81 offen sc1
    s_lshl_b32 s87, s93, 1
    s_add_u32 s87, s87, 224
    s_mov_b32 s92, 1
    v_mov_b32 v19, 64
    s_mov_b32 s62, 0
    s_cmp_ge_u32 s93, 15
    s_cbranch_scc1 L_lastone_37
    v_readfirstlane_b32 s62, v5
    s_nop 0
    s_cmp_lg_u32 s62, 0
    s_cbranch_scc1 L_nodraw_38
    s_mov_b64 exec, 1
    global_atomic_add v19, v9, v18, s[30:31] offset:4 sc0 sc1
    s_mov_b64 exec, -1
L_nodraw_38:
L_lastone_37:
    s_branch L_done_18
L_gone_19:
    s_mov_b32 s89, 134217728
    s_branch L_done_18
L_retry_22:
    s_sub_u32 s84, s84, 1
    s_cmp_lg_u32 s84, 0
    s_cbranch_scc1 L_again_21
    s_branch L_end
L_retry_29:
    s_sub_u32 s84, s84, 1
    s_cmp_lg_u32 s84, 0
    s_cbranch_scc1 L_again_28
    s_branch L_end
L_retry_36:
    s_sub_u32 s84, s84, 1
    s_cmp_lg_u32 s84, 0
    s_cbranch_scc1 L_again_35
    s_branch L_end
L_none:
    buffer_load_dwordx4 v[224:227], v54, s[48:51], s46 offen sc1
    s_mov_b32 s86, s44
    s_bitcmp1_b32 s90, 2
    s_cselect_b32 s44, 4194304, s44
    s_lshl_b32 s39, s34, 13
    s_add_u32 s39, s39, 98304
    s_mov_b32 m0, s39
    s_nop 0
    buffer_load_dwordx4 v20, s[40:43], s44 offen offset:0 nt lds
    buffer_load_dwordx4 v21, s[40:43], s44 offen offset:1024 nt lds
    buffer_load_dwordx4 v22, s[40:43], s44 offen offset:2048 nt lds
    buffer_load_dwordx4 v23, s[40:43], s44 offen offset:3072 nt lds
    s_lshl_b32 s39, s34, 13
    s_add_u32 s39, s39, 102400
    s_mov_b32 m0, s39
    s_add_u32 s44, s44, 16384
    buffer_load_dwordx4 v20, s[40:43], s44 offen offset:0 nt lds
    buffer_load_dwordx4 v21, s[40:43], s44 offen offset:1024 nt lds
    buffer_load_dwordx4 v22, s[40:43], s44 offen offset:2048 nt lds
    buffer_load_dwordx4 v23, s[40:43], s44 offen offset:3072 nt lds
    v_add_f32_dpp v121, v121, v121 row_ror:8 row_mask:0xf bank_mask:0xf
    s_nop 1
    v_add_f32_dpp v121, v121, v121 row_ror:4 row_mask:0xf bank_mask:0xf
    v_mov_b32 v125, v121
    s_nop 1
    v_permlane16_swap_b32 v121, v125
    v_add_f32 v121, v121, v125
    v_mov_b32 v125, v121
    s_nop 1
    v_permlane32_swap_b32 v121, v125
    v_add_f32 v121, v121, v125
    v_and_b32 v125, s82, v120
    v_sub_f32 v125, v120, v125
    s_mov_b32 vcc_lo, 0xff00ff00
    s_mov_b32 vcc_hi, 0xff00ff00
    s_branch L_bdone
L_last:
    buffer_load_dwordx4 v[224:227], v54, s[48:51], s46 offen sc1
    s_mov_b32 s86, s44
    s_bitcmp1_b32 s90, 2
    s_cselect_b32 s44, 4194304, s44
    v_and_b32_dpp v104, v100, v10 row_newbcast:0 row_mask:0xf bank_mask:0xf
    v_and_b32_dpp v105, v100, v11 row_newbcast:0 row_mask:0xf bank_mask:0xf
    v_and_b32_dpp v106, v100, v12 row_newbcast:0 row_mask:0xf bank_mask:0xf
    v_and_b32_dpp v107, v100, v13 row_newbcast:0 row_mask:0xf bank_mask:0xf
    s_lshl_b32 s39, s34, 13
    s_add_u32 s39, s39, 98304
    s_mov_b32 m0, s39
    s_nop 0
    buffer_load_dwordx4 v20, s[40:43], s44 offen offset:0 nt lds
    v_mfma_f32_16x16x32_bf16 v[116:119], v[128:131], v[104:107], v[116:119]
    v_and_b32_dpp v108, v100, v10 row_newbcast:4 row_mask:0xf bank_mask:0xf
    v_and_b32_dpp v109, v100, v11 row_newbcast:4 row_mask:0xf bank_mask:0xf
    v_and_b32_dpp v110, v100, v12 row_newbcast:4 row_mask:0xf bank_mask:0xf
    v_and_b32_dpp v111, v100, v13 row_newbcast:4 row_mask:0xf bank_mask:0xf
    s_waitcnt vmcnt(8)
    buffer_load_dwordx4 v21, s[40:43], s44 offen offset:1024 nt lds
    v_mfma_f32_16x16x32_bf16 v[116:119], v[132:135], v[108:111], v[116:119]
    v_add_f32_dpp v121, v121, v121 row_ror:8 row_mask:0xf bank_mask:0xf
    s_nop 1
    v_add_f32_dpp v121, v121, v121 row_ror:4 row_mask:0xf bank_mask:0xf
    v_mov_b32 v125, v121
    s_nop 1
    v_permlane16_swap_b32 v121, v125
    v_add_f32 v121, v121, v125
    v_mov_b32 v125, v121
    s_nop 1
    v_permlane32_swap_b32 v121, v125
    v_add_f32 v121, v121, v125
    v_and_b32 v125, s82, v120
    v_sub_f32 v125, v120, v125
    s_mov_b32 vcc_lo, 0xff00ff00
    s_mov_b32 vcc_hi, 0xff00ff00
    v_and_b32_dpp v104, v100, v10 row_newbcast:8 row_mask:0xf bank_mask:0xf
    v_and_b32_dpp v105, v100, v11 row_newbcast:8 row_mask:0xf bank_mask:0xf
    v_and_b32_dpp v106, v100, v12 row_newbcast:8 row_mask:0xf bank_mask:0xf
    v_and_b32_dpp v107, v100, v13 row_newbcast:8 row_mask:0xf bank_mask:0xf
    s_waitcnt vmcnt(8)
    buffer_load_dwordx4 v22, s[40:43], s44 offen offset:2048 nt lds
    v_mfma_f32_16x16x32_bf16 v[116:119], v[136:139], v[104:107], v[116:119]
    v_and_b32_dpp v108, v100, v10 row_newbcast:12 row_mask:0xf bank_mask:0xf
    v_and_b32_dpp v109, v100, v11 row_newbcast:12 row_mask:0xf bank_mask:0xf
    v_and_b32_dpp v110, v100, v12 row_newbcast:12 row_mask:0xf bank_mask:0xf
    v_and_b32_dpp v111, v100, v13 row_newbcast:12 row_mask:0xf bank_mask:0xf
    s_waitcnt vmcnt(8)
    buffer_load_dwordx4 v23, s[40:43], s44 offen offset:3072 nt lds
    v_mfma_f32_16x16x32_bf16 v[116:119], v[140:143], v[108:111], v[116:119]
    v_and_b32_dpp v104, v101, v10 row_newbcast:0 row_mask:0xf bank_mask:0xf
    v_and_b32_dpp v105, v101, v11 row_newbcast:0 row_mask:0xf bank_mask:0xf
    v_and_b32_dpp v106, v101, v12 row_newbcast:0 row_mask:0xf bank_mask:0xf
    v_and_b32_dpp v107, v101, v13 row_newbcast:0 row_mask:0xf bank_mask:0xf
    s_waitcnt vmcnt(8)
    s_lshl_b32 s39, s34, 13
    s_add_u32 s39, s39, 102400
    s_mov_b32 m0, s39
    s_add_u32 s44, s44, 16384
    buffer_load_dwordx4 v20, s[40:43], s44 offen offset:0 nt lds
    v_mfma_f32_16x16x32_bf16 v[116:119], v[144:147], v[104:107], v[116:119]
    v_and_b32_dpp v108, v101, v10 row_newbcast:4 row_mask:0xf bank_mask:0xf
    v_and_b32_dpp v109, v101, v11 row_newbcast:4 row_mask:0xf bank_mask:0xf
    v_and_b32_dpp v110, v101, v12 row_newbcast:4 row_mask:0xf bank_mask:0xf
    v_and_b32_dpp v111, v101, v13 row_newbcast:4 row_mask:0xf bank_mask:0xf
    s_waitcnt vmcnt(8)
    buffer_load_dwordx4 v21, s[40:43], s44 offen offset:1024 nt lds
    v_mfma_f32_16x16x32_bf16 v[116:119], v[148:151], v[108:111], v[116:119]
    v_and_b32_dpp v104, v101, v10 row_newbcast:8 row_mask:0xf bank_mask:0xf
    v_and_b32_dpp v105, v101, v11 row_newbcast:8 row_mask:0xf bank_mask:0xf
    v_and_b32_dpp v106, v101, v12 row_newbcast:8 row_mask:0xf bank_mask:0xf
    v_and_b32_dpp v107, v101, v13 row_newbcast:8 row_mask:0xf bank_mask:0xf
    s_waitcnt vmcnt(8)
    buffer_load_dwordx4 v22, s[40:43], s44 offen offset:2048 nt lds
    v_mfma_f32_16x16x32_bf16 v[116:119], v[152:155], v[104:107], v[116:119]
    v_and_b32_dpp v108, v101, v10 row_newbcast:12 row_mask:0xf bank_mask:0xf
    v_and_b32_dpp v109, v101, v11 row_newbcast:12 row_mask:0xf bank_mask:0xf
    v_and_b32_dpp v110, v101, v12 row_newbcast:12 row_mask:0xf bank_mask:0xf
    v_and_b32_dpp v111, v101, v13 row_newbcast:12 row_mask:0xf bank_mask:0xf
    s_waitcnt vmcnt(8)
    buffer_load_dwordx4 v23, s[40:43], s44 offen offset:3072 nt lds
    v_mfma_f32_16x16x32_bf16 v[116:119], v[156:159], v[108:111], v[116:119]
L_bdone:
    s_nop 7
    v_cndmask_b32 v116, v116, v120, vcc
    v_cndmask_b32 v117, v117, v121, vcc
    v_cndmask_b32 v118, v118, v125, vcc
    v_and_or_b32 v119, v119, s82, v8
    v_and_or_b32 v116, v116, s82, v8
    v_and_or_b32 v117, v117, s82, v8
    v_and_or_b32 v118, v118, s82, v8
    s_mov_b32 exec_lo, 0xff01ff
    s_mov_b32 exec_hi, 0xff00ff
    buffer_store_dwordx4 v[116:119], v79, s[48:51], s96 offen sc1
    s_mov_b64 exec, -1
    s_bitcmp1_b32 s90, 2
    s_cbranch_scc1 L_ctx
    buffer_load_dwordx4 v[204:207], v53, s[48:51], s47 offen sc1
    buffer_load_dwordx4 v[192:195], v50, s[48:51], s47 offen sc1
    buffer_load_dwordx4 v[196:199], v51, s[48:51], s47 offen sc1
    buffer_load_dwordx4 v[200:203], v52, s[48:51], s47 offen sc1
    v_xor_b32 v104, s35, v116
    v_xor_b32 v105, s35, v117
    v_xor_b32 v106, s35, v118
    v_xor_b32 v107, s35, v119
    v_mov_b32 v5, 0xff7f0000
    v_cndmask_b32 v120, v120, v5, vcc
    v_and_b32 v121, s82, v121
    s_mov_b32 s86, 0x88888888
    s_mov_b32 s87, 0x88888888
    s_waitcnt vmcnt(0)
L_hop1poll:
    v_xor_b32 v192, s35, v192
    v_xor_b32 v193, s35, v193
    v_xor_b32 v194, s35, v194
    v_xor_b32 v195, s35, v195
    v_xor_b32 v196, s35, v196
    v_xor_b32 v197, s35, v197
    v_xor_b32 v198, s35, v198
    v_xor_b32 v199, s35, v199
    v_xor_b32 v200, s35, v200
    v_xor_b32 v201, s35, v201
    v_xor_b32 v202, s35, v202
    v_xor_b32 v203, s35, v203
    v_xor_b32 v204, s35, v204
    v_xor_b32 v205, s35, v205
    v_xor_b32 v206, s35, v206
    v_xor_b32 v207, s35, v207
    v_or_b32 v4, v192, v193
    v_or3_b32 v4, v4, v194, v195
    v_or3_b32 v4, v4, v196, v197
    v_or3_b32 v4, v4, v198, v199
    v_or3_b32 v4, v4, v200, v201
    v_or3_b32 v4, v4, v202, v203
    v_or3_b32 v4, v4, v204, v205
    v_or3_b32 v4, v4, v206, v207
    v_and_b32 v4, 0xff, v4
    v_cmp_ne_u32 vcc, 0, v4
    v_add_f32 v122, v204, v206
    s_cbranch_vccz L_hop1ok
    buffer_load_dwordx4 v[204:207], v53, s[48:51], s47 offen sc1
    buffer_load_dwordx4 v[192:195], v50, s[48:51], s47 offen sc1
    buffer_load_dwordx4 v[196:199], v51, s[48:51], s47 offen sc1
    buffer_load_dwordx4 v[200:203], v52, s[48:51], s47 offen sc1
    s_waitcnt vmcnt(0)
    s_sub_u32 s84, s84, 1
    s_cmp_lg_u32 s84, 0
    s_cbranch_scc1 L_hop1poll
    s_branch L_end
L_ctx:
    s_mov_b32 s44, s86
    s_lshl_b32 s39, s34, 13
    s_add_u32 s39, s39, 98304
    s_mov_b32 m0, s39
    s_nop 0
    buffer_load_dwordx4 v20, s[40:43], s44 offen offset:0 nt lds
    buffer_load_dwordx4 v21, s[40:43], s44 offen offset:1024 nt lds
    buffer_load_dwordx4 v22, s[40:43], s44 offen offset:2048 nt lds
    buffer_load_dwordx4 v23, s[40:43], s44 offen offset:3072 nt lds
    s_lshl_b32 s39, s34, 13
    s_add_u32 s39, s39, 102400
    s_mov_b32 m0, s39
    s_add_u32 s44, s44, 16384
    buffer_load_dwordx4 v20, s[40:43], s44 offen offset:0 nt lds
    buffer_load_dwordx4 v21, s[40:43], s44 offen offset:1024 nt lds
    buffer_load_dwordx4 v22, s[40:43], s44 offen offset:2048 nt lds
    buffer_load_dwordx4 v23, s[40:43], s44 offen offset:3072 nt lds
    s_waitcnt vmcnt(9)
L_ctxcheck:
    v_xor_b32 v224, s35, v224
    v_xor_b32 v225, s35, v225
    v_xor_b32 v226, s35, v226
    v_xor_b32 v227, s35, v227
    v_or_b32 v4, v224, v225
    v_or3_b32 v4, v4, v226, v227
    v_and_b32 v4, 0xff, v4
    v_cmp_ne_u32 vcc, 0, v4
    s_cbranch_vccz L_ctxok
    buffer_load_dwordx4 v[224:227], v54, s[48:51], s46 offen sc1
    s_waitcnt vmcnt(0)
    s_sub_u32 s84, s84, 1
    s_cmp_lg_u32 s84, 0
    s_cbranch_scc1 L_ctxcheck
    s_branch L_end
L_ctxok:
    v_cvt_pk_bf16_f32 v224, v224, v225
    v_cvt_pk_bf16_f32 v225, v226, v227
    ds_write_b64 v35, v[224:225]
    s_branch L_final
L_hop1ok:
    v_cndmask_b32 v122, v122, v120, s[86:87]
    v_cndmask_b32 v123, v205, v121, s[86:87]
    s_nop 0
    v_max_f32_dpp v5, v122, v122 quad_perm:[1,0,3,2] row_mask:0xf bank_mask:0xf
    s_nop 1
    v_max_f32_dpp v5, v5, v5 quad_perm:[2,3,0,1] row_mask:0xf bank_mask:0xf
    s_nop 1
    v_max_f32_dpp v5, v5, v5 row_ror:8 row_mask:0xf bank_mask:0xf
    v_sub_f32 v122, v122, v5
    v_exp_f32 v122, v122
    s_nop 0
    v_mul_f32 v123, v123, v122
    v_mul_f32_dpp v104, v122, v104 quad_perm:[3,3,3,3] row_mask:0xf bank_mask:0xf
    v_mul_f32_dpp v105, v122, v105 quad_perm:[3,3,3,3] row_mask:0xf bank_mask:0xf
    v_mul_f32_dpp v106, v122, v106 quad_perm:[3,3,3,3] row_mask:0xf bank_mask:0xf
    v_mul_f32_dpp v107, v122, v107 quad_perm:[3,3,3,3] row_mask:0xf bank_mask:0xf
    v_add_f32_dpp v123, v123, v123 quad_perm:[1,0,3,2] row_mask:0xf bank_mask:0xf
    v_fmac_f32_dpp v104, v122, v192 quad_perm:[0,0,0,0] row_mask:0xf bank_mask:0xf
    v_fmac_f32_dpp v105, v122, v193 quad_perm:[0,0,0,0] row_mask:0xf bank_mask:0xf
    v_fmac_f32_dpp v106, v122, v194 quad_perm:[0,0,0,0] row_mask:0xf bank_mask:0xf
    v_fmac_f32_dpp v107, v122, v195 quad_perm:[0,0,0,0] row_mask:0xf bank_mask:0xf
    v_add_f32_dpp v123, v123, v123 quad_perm:[2,3,0,1] row_mask:0xf bank_mask:0xf
    v_fmac_f32_dpp v104, v122, v196 quad_perm:[1,1,1,1] row_mask:0xf bank_mask:0xf
    v_fmac_f32_dpp v105, v122, v197 quad_perm:[1,1,1,1] row_mask:0xf bank_mask:0xf
    v_fmac_f32_dpp v106, v122, v198 quad_perm:[1,1,1,1] row_mask:0xf bank_mask:0xf
    v_fmac_f32_dpp v107, v122, v199 quad_perm:[1,1,1,1] row_mask:0xf bank_mask:0xf
    v_add_f32_dpp v123, v123, v123 row_ror:8 row_mask:0xf bank_mask:0xf
    v_fmac_f32_dpp v104, v122, v200 quad_perm:[2,2,2,2] row_mask:0xf bank_mask:0xf
    v_fmac_f32_dpp v105, v122, v201 quad_perm:[2,2,2,2] row_mask:0xf bank_mask:0xf
    v_fmac_f32_dpp v106, v122, v202 quad_perm:[2,2,2,2] row_mask:0xf bank_mask:0xf
    v_fmac_f32_dpp v107, v122, v203 quad_perm:[2,2,2,2] row_mask:0xf bank_mask:0xf
    v_rcp_f32 v123, v123
    v_add_f32_dpp v104, v104, v104 row_ror:8 row_mask:0xf bank_mask:0xf
    v_add_f32_dpp v105, v105, v105 row_ror:8 row_mask:0xf bank_mask:0xf
    v_add_f32_dpp v106, v106, v106 row_ror:8 row_mask:0xf bank_mask:0xf
    v_add_f32_dpp v107, v107, v107 row_ror:8 row_mask:0xf bank_mask:0xf
    v_mul_f32 v104, v104, v123
    v_mul_f32 v105, v105, v123
    v_mul_f32 v106, v106, v123
    v_mul_f32 v107, v107, v123
    v_cvt_pk_bf16_f32 v104, v104, v105
    v_cvt_pk_bf16_f32 v106, v106, v107
    s_mov_b32 exec_lo, 0xff00ff
    s_mov_b32 exec_hi, 0xff00ff
    ds_write_b16 v31, v104
    ds_write_b16_d16_hi v31, v104 offset:16
    ds_write_b16 v31, v106 offset:32
    ds_write_b16_d16_hi v31, v106 offset:48
    s_mov_b64 exec, -1
L_final:
    s_waitcnt vmcnt(0) lgkmcnt(0)
    s_barrier
    ds_read_b64_tr_b16 v[128:129], v24 offset:0
    ds_read_b64_tr_b16 v[130:131], v25 offset:1024
    ds_read_b128 v[160:163], v28 offset:0
    ds_read_b64_tr_b16 v[132:133], v24 offset:8192
    ds_read_b64_tr_b16 v[134:135], v25 offset:9216
    ds_read_b128 v[164:167], v28 offset:64
    ds_read_b64_tr_b16 v[136:137], v24 offset:16384
    ds_read_b64_tr_b16 v[138:139], v25 offset:17408
    ds_read_b128 v[168:171], v28 offset:128
    ds_read_b64_tr_b16 v[140:141], v24 offset:24576
    ds_read_b64_tr_b16 v[142:143], v25 offset:25600
    ds_read_b128 v[172:175], v28 offset:192
    ds_read_b64_tr_b16 v[144:145], v26 offset:0
    ds_read_b64_tr_b16 v[146:147], v27 offset:1024
    ds_read_b128 v[176:179], v29 offset:0
    s_waitcnt lgkmcnt(12)
    v_mfma_f32_16x16x32_bf16 v[112:115], v[128:131], v[160:163], 0
    ds_read_b64_tr_b16 v[148:149], v26 offset:8192
    ds_read_b64_tr_b16 v[150:151], v27 offset:9216
    ds_read_b128 v[180:183], v29 offset:64
    s_waitcnt lgkmcnt(12)
    v_mfma_f32_16x16x32_bf16 v[112:115], v[132:135], v[164:167], v[112:115]
    ds_read_b64_tr_b16 v[152:153], v26 offset:16384
    ds_read_b64_tr_b16 v[154:155], v27 offset:17408
    ds_read_b128 v[184:187], v29 offset:128
    s_waitcnt lgkmcnt(12)
    v_mfma_f32_16x16x32_bf16 v[112:115], v[136:139], v[168:171], v[112:115]
    ds_read_b64_tr_b16 v[156:157], v26 offset:24576
    ds_read_b64_tr_b16 v[158:159], v27 offset:25600
    ds_read_b128 v[188:191], v29 offset:192
    s_waitcnt lgkmcnt(12)
    v_mfma_f32_16x16x32_bf16 v[112:115], v[140:143], v[172:175], v[112:115]
    s_waitcnt lgkmcnt(9)
    v_mfma_f32_16x16x32_bf16 v[112:115], v[144:147], v[176:179], v[112:115]
    s_waitcnt lgkmcnt(6)
    v_mfma_f32_16x16x32_bf16 v[112:115], v[148:151], v[180:183], v[112:115]
    s_waitcnt lgkmcnt(3)
    v_mfma_f32_16x16x32_bf16 v[112:115], v[152:155], v[184:187], v[112:115]
    s_waitcnt lgkmcnt(0)
    v_mfma_f32_16x16x32_bf16 v[112:115], v[156:159], v[188:191], v[112:115]
    s_add_u32 s37, s71, 4096
    s_cmp_eq_u32 s70, 1
    s_mov_b32 exec_lo, 0xff00ff
    s_mov_b32 exec_hi, 0xff00ff
    s_nop 3
    v_and_or_b32 v112, v112, s82, v8
    v_and_or_b32 v113, v113, s82, v8
    v_and_or_b32 v114, v114, s82, v8
    v_and_or_b32 v115, v115, s82, v8
    s_cbranch_scc1 L_ylocal
    buffer_store_dwordx4 v[112:115], v30, s[48:51], s45 offen sc1
    s_branch L_ydone
L_ylocal:
    buffer_store_dwordx4 v[112:115], v30, s[48:51], s45 offen
L_ydone:
    s_mov_b64 exec, -1
    s_cmp_lg_u32 s34, 0
    s_cbranch_scc1 L_done
L_hop2:
    buffer_load_dwordx4 v[224:227], v32, s[48:51], s71 offen sc1
    buffer_load_dwordx4 v[228:231], v32, s[48:51], s37 offen sc1
    s_waitcnt vmcnt(0)
    v_xor_b32 v224, s35, v224
    v_xor_b32 v225, s35, v225
    v_xor_b32 v226, s35, v226
    v_xor_b32 v227, s35, v227
    v_xor_b32 v228, s35, v228
    v_xor_b32 v229, s35, v229
    v_xor_b32 v230, s35, v230
    v_xor_b32 v231, s35, v231
    v_or_b32 v4, v224, v225
    v_or3_b32 v4, v4, v226, v227
    v_or3_b32 v4, v4, v228, v229
    v_or3_b32 v4, v4, v230, v231
    v_and_b32 v4, 0xff, v4
    v_cmp_ne_u32 vcc, 0, v4
    v_add_f32 v232, v224, v228
    v_add_f32 v233, v225, v229
    v_add_f32 v234, v226, v230
    v_add_f32 v235, v227, v231
    s_cbranch_vccz L_hop2ok
    s_sub_u32 s84, s84, 1
    s_cmp_lg_u32 s84, 0
    s_cbranch_scc1 L_hop2
    s_branch L_end
L_hop2ok:
    v_permlane16_swap_b32 v232, v233
    v_permlane16_swap_b32 v234, v235
    v_add_f32 v232, v232, v233
    v_add_f32 v234, v234, v235
    s_nop 1
    v_permlane32_swap_b32 v232, v234
    v_add_f32 v232, v232, v234
    s_nop 1
    v_add_f32_dpp v232, v232, v232 row_ror:8 row_mask:0xf bank_mask:0xf
    s_nop 1
    v_add_f32_dpp v232, v232, v232 row_ror:4 row_mask:0xf bank_mask:0xf
    v_cvt_pk_bf16_f32 v232, v232, v232
    s_mov_b32 exec_lo, 0xf000f
    s_mov_b32 exec_hi, 0xf000f
    buffer_store_short v232, v33, s[72:75], 0 offen
    s_cmp_lg_u32 s2, 0
    s_cbranch_scc1 L_done
    v_mov_b32 v4, 0
    s_mov_b64 exec, 1
    buffer_store_dword v8, v4, s[48:51], 0 offen
L_done:
L_end:
    s_endpgm
L_qp:
    v_lshlrev_b32 v4, 18, v2
    v_lshl_add_u32 v14, v3, 4, v4
    v_lshrrev_b32 v5, 3, v3
    v_lshlrev_b32 v5, 10, v5
    v_lshl_add_u32 v15, v2, 6, v5
    s_cmp_eq_u32 s33, 0
    s_cselect_b32 s61, 3, 2
    s_xor_b32 s61, s61, s32
    s_lshl_b32 s86, s34, 8
    s_lshl_b32 s63, s34, 20
    s_lshl_b32 s38, s61, 8
    s_add_u32 s63, s63, s38
    s_mov_b32 s42, 4194304
    s_mov_b32 s43, 0x20000
    s_mov_b32 s46, 4096
    s_mov_b32 s47, 0x20000
    s_cmp_eq_u32 s33, 0
    s_waitcnt lgkmcnt(0)
    s_cselect_b64 s[40:41], s[22:23], s[8:9]
    s_cselect_b64 s[44:45], s[16:17], s[4:5]
    buffer_load_dwordx4 a[128:131], v14, s[40:43], s63 offen nt
    s_add_u32 s63, s63, 8192
    buffer_load_dwordx4 a[132:135], v14, s[40:43], s63 offen nt
    s_add_u32 s63, s63, 8192
    buffer_load_dwordx4 v[20:23], v15, s[44:47], s86 offen offset:0
    buffer_load_dwordx4 v[36:39], v15, s[44:47], s86 offen offset:2048
    buffer_load_dwordx4 a[136:139], v14, s[40:43], s63 offen nt
    s_add_u32 s63, s63, 8192
    buffer_load_dwordx4 a[140:143], v14, s[40:43], s63 offen nt
    s_add_u32 s63, s63, 8192
    buffer_load_dwordx4 a[144:147], v14, s[40:43], s63 offen nt
    s_add_u32 s63, s63, 8192
    buffer_load_dwordx4 a[148:151], v14, s[40:43], s63 offen nt
    s_add_u32 s63, s63, 8192
    buffer_load_dwordx4 a[152:155], v14, s[40:43], s63 offen nt
    s_add_u32 s63, s63, 8192
    buffer_load_dwordx4 a[156:159], v14, s[40:43], s63 offen nt
    s_add_u32 s63, s63, 8192
    s_load_dword s35, s[30:31], 0
    s_mov_b32 s48, s30
    s_and_b32 s49, s31, 0xffff
    s_mov_b32 s50, 8388608
    s_mov_b32 s51, 0x20000
    s_mov_b32 s82, 0xffffff00
    s_mov_b32 s83, 0x3e0293ee
    s_mov_b32 s84, 2097152
    v_and_b32 v4, 1, v1
    v_lshlrev_b32 v4, 4, v4
    v_mov_b32 v5, 0xffff
    v_lshlrev_b32 v4, v4, v5
    v_bfe_u32 v5, v1, 1, 2
    v_cmp_eq_u32 vcc, 0, v5
    s_nop 1
    v_cndmask_b32 v10, 0, v4, vcc
    v_cmp_eq_u32 vcc, 1, v5
    s_nop 1
    v_cndmask_b32 v11, 0, v4, vcc
    v_cmp_eq_u32 vcc, 2, v5
    s_nop 1
    v_cndmask_b32 v12, 0, v4, vcc
    v_cmp_eq_u32 vcc, 3, v5
    s_nop 1
    v_cndmask_b32 v13, 0, v4, vcc
    buffer_load_dwordx4 v[24:27], v15, s[44:47], s86 offen offset:16
    buffer_load_dwordx4 v[40:43], v15, s[44:47], s86 offen offset:2064
    buffer_load_dwordx4 v[28:31], v15, s[44:47], s86 offen offset:32
    buffer_load_dwordx4 v[44:47], v15, s[44:47], s86 offen offset:2080
    buffer_load_dwordx4 v[32:35], v15, s[44:47], s86 offen offset:48
    buffer_load_dwordx4 v[48:51], v15, s[44:47], s86 offen offset:2096
    s_lshl_b32 s38, s61, 10
    s_add_u32 s36, s38, 65536
    s_lshr_b32 s38, s61, 3
    s_lshl_b32 s38, s38, 8
    s_add_u32 s36, s38, s36
    s_lshl_b32 s38, s34, 23
    s_add_u32 s36, s38, s36
    v_mov_b32 v18, 0
    v_mov_b32 v19, 0
    s_cmp_eq_u32 s33, 0
    s_cselect_b32 s38, s36, 8388608
    s_mov_b64 exec, 1
    buffer_store_dwordx2 v[18:19], v19, s[48:51], s38 offen sc1
    s_mov_b64 exec, -1
    s_mov_b32 s80, 0x01000100
    s_mov_b32 s81, 0x03020302
    s_waitcnt vmcnt(13)
    buffer_load_dwordx4 a[160:163], v14, s[40:43], s63 offen nt
    s_add_u32 s63, s63, 8192
    v_perm_b32 v4, v20, v20, s80
    v_perm_b32 v5, v36, v36, s80
    v_and_b32 v52, v4, v10
    v_and_b32 v53, v4, v11
    v_and_b32 v54, v4, v12
    v_and_b32 v55, v4, v13
    v_and_b32 v56, v5, v10
    v_and_b32 v57, v5, v11
    v_and_b32 v58, v5, v12
    v_and_b32 v59, v5, v13
    v_mfma_f32_16x16x32_bf16 v[60:63], a[128:131], v[52:55], 0
    s_nop 0
    v_mfma_f32_16x16x32_bf16 v[64:67], a[128:131], v[56:59], 0
    buffer_load_dwordx4 a[164:167], v14, s[40:43], s63 offen nt
    s_add_u32 s63, s63, 8192
    v_perm_b32 v4, v20, v20, s81
    v_perm_b32 v5, v36, v36, s81
    v_and_b32 v52, v4, v10
    v_and_b32 v53, v4, v11
    v_and_b32 v54, v4, v12
    v_and_b32 v55, v4, v13
    v_and_b32 v56, v5, v10
    v_and_b32 v57, v5, v11
    v_and_b32 v58, v5, v12
    v_and_b32 v59, v5, v13
    v_mfma_f32_16x16x32_bf16 v[60:63], a[132:135], v[52:55], v[60:63]
    s_nop 0
    v_mfma_f32_16x16x32_bf16 v[64:67], a[132:135], v[56:59], v[64:67]
    s_waitcnt vmcnt(14)
    buffer_load_dwordx4 a[168:171], v14, s[40:43], s63 offen nt
    s_add_u32 s63, s63, 8192
    v_perm_b32 v4, v21, v21, s80
    v_perm_b32 v5, v37, v37, s80
    v_and_b32 v52, v4, v10
    v_and_b32 v53, v4, v11
    v_and_b32 v54, v4, v12
    v_and_b32 v55, v4, v13
    v_and_b32 v56, v5, v10
    v_and_b32 v57, v5, v11
    v_and_b32 v58, v5, v12
    v_and_b32 v59, v5, v13
    v_mfma_f32_16x16x32_bf16 v[60:63], a[136:139], v[52:55], v[60:63]
    s_nop 0
    v_mfma_f32_16x16x32_bf16 v[64:67], a[136:139], v[56:59], v[64:67]
    s_waitcnt vmcnt(14)
    buffer_load_dwordx4 a[172:175], v14, s[40:43], s63 offen nt
    s_add_u32 s63, s63, 8192
    v_perm_b32 v4, v21, v21, s81
    v_perm_b32 v5, v37, v37, s81
    v_and_b32 v52, v4, v10
    v_and_b32 v53, v4, v11
    v_and_b32 v54, v4, v12
    v_and_b32 v55, v4, v13
    v_and_b32 v56, v5, v10
    v_and_b32 v57, v5, v11
    v_and_b32 v58, v5, v12
    v_and_b32 v59, v5, v13
    v_mfma_f32_16x16x32_bf16 v[60:63], a[140:143], v[52:55], v[60:63]
    s_nop 0
    v_mfma_f32_16x16x32_bf16 v[64:67], a[140:143], v[56:59], v[64:67]
    s_waitcnt vmcnt(14)
    buffer_load_dwordx4 a[176:179], v14, s[40:43], s63 offen nt
    s_add_u32 s63, s63, 8192
    v_lshrrev_b32 v4, 2, v3
    v_and_b32 v5, 3, v3
    v_lshlrev_b32 v76, 8, v4
    v_lshlrev_b32 v126, 8, v2
    v_lshl_add_u32 v76, v2, 6, v76
    v_lshl_add_u32 v76, v5, 4, v76
    v_lshl_add_u32 v126, v3, 4, v126
    v_xor_b32 v77, 32768, v76
    v_xor_b32 v127, 32768, v126
    s_add_u32 s3, s34, s33
    s_and_b32 s3, s3, 3
    s_lshl_b32 s89, s3, 5
    s_add_u32 s89, s89, s32
    s_lshl_b32 s89, s89, 20
    s_mul_i32 s88, s32, 8
    s_add_u32 s88, s88, s3
    s_lshl_b32 s87, s33, 0
    v_perm_b32 v4, v22, v22, s80
    v_perm_b32 v5, v38, v38, s80
    v_and_b32 v52, v4, v10
    v_and_b32 v53, v4, v11
    v_and_b32 v54, v4, v12
    v_and_b32 v55, v4, v13
    v_and_b32 v56, v5, v10
    v_and_b32 v57, v5, v11
    v_and_b32 v58, v5, v12
    v_and_b32 v59, v5, v13
    v_mfma_f32_16x16x32_bf16 v[60:63], a[144:147], v[52:55], v[60:63]
    s_nop 0
    v_mfma_f32_16x16x32_bf16 v[64:67], a[144:147], v[56:59], v[64:67]
    s_waitcnt vmcnt(14)
    buffer_load_dwordx4 a[180:183], v14, s[40:43], s63 offen nt
    s_add_u32 s63, s63, 8192
    v_perm_b32 v4, v22, v22, s81
    v_perm_b32 v5, v38, v38, s81
    v_and_b32 v52, v4, v10
    v_and_b32 v53, v4, v11
    v_and_b32 v54, v4, v12
    v_and_b32 v55, v4, v13
    v_and_b32 v56, v5, v10
    v_and_b32 v57, v5, v11
    v_and_b32 v58, v5, v12
    v_and_b32 v59, v5, v13
    v_mfma_f32_16x16x32_bf16 v[60:63], a[148:151], v[52:55], v[60:63]
    s_nop 0
    v_mfma_f32_16x16x32_bf16 v[64:67], a[148:151], v[56:59], v[64:67]
    s_waitcnt vmcnt(14)
    buffer_load_dwordx4 a[184:187], v14, s[40:43], s63 offen nt
    s_add_u32 s63, s63, 8192
    v_perm_b32 v4, v23, v23, s80
    v_perm_b32 v5, v39, v39, s80
    v_and_b32 v52, v4, v10
    v_and_b32 v53, v4, v11
    v_and_b32 v54, v4, v12
    v_and_b32 v55, v4, v13
    v_and_b32 v56, v5, v10
    v_and_b32 v57, v5, v11
    v_and_b32 v58, v5, v12
    v_and_b32 v59, v5, v13
    v_mfma_f32_16x16x32_bf16 v[60:63], a[152:155], v[52:55], v[60:63]
    s_nop 0
    v_mfma_f32_16x16x32_bf16 v[64:67], a[152:155], v[56:59], v[64:67]
    s_waitcnt vmcnt(14)
    buffer_load_dwordx4 a[188:191], v14, s[40:43], s63 offen nt
    s_add_u32 s63, s63, 8192
    v_perm_b32 v4, v23, v23, s81
    v_perm_b32 v5, v39, v39, s81
    v_and_b32 v52, v4, v10
    v_and_b32 v53, v4, v11
    v_and_b32 v54, v4, v12
    v_and_b32 v55, v4, v13
    v_and_b32 v56, v5, v10
    v_and_b32 v57, v5, v11
    v_and_b32 v58, v5, v12
    v_and_b32 v59, v5, v13
    v_mfma_f32_16x16x32_bf16 v[60:63], a[156:159], v[52:55], v[60:63]
    s_nop 0
    v_mfma_f32_16x16x32_bf16 v[64:67], a[156:159], v[56:59], v[64:67]
    s_waitcnt vmcnt(13)
    s_waitcnt vmcnt(7)
    buffer_load_dwordx4 a[192:195], v14, s[40:43], s63 offen nt
    s_add_u32 s63, s63, 8192
    s_mov_b32 s52, s18
    s_and_b32 s53, s19, 0xffff
    s_mov_b32 s54, 134217728
    s_mov_b32 s55, 0x20000
    s_mov_b32 s56, s20
    s_and_b32 s57, s21, 0xffff
    s_mov_b32 s58, 134217728
    s_mov_b32 s59, 0x20000
    v_perm_b32 v4, v24, v24, s80
    v_perm_b32 v5, v40, v40, s80
    v_and_b32 v52, v4, v10
    v_and_b32 v53, v4, v11
    v_and_b32 v54, v4, v12
    v_and_b32 v55, v4, v13
    v_and_b32 v56, v5, v10
    v_and_b32 v57, v5, v11
    v_and_b32 v58, v5, v12
    v_and_b32 v59, v5, v13
    v_mfma_f32_16x16x32_bf16 v[60:63], a[160:163], v[52:55], v[60:63]
    s_nop 0
    v_mfma_f32_16x16x32_bf16 v[64:67], a[160:163], v[56:59], v[64:67]
    s_waitcnt vmcnt(7)
    buffer_load_dwordx4 a[196:199], v14, s[40:43], s63 offen nt
    s_add_u32 s63, s63, 8192
    v_perm_b32 v4, v24, v24, s81
    v_perm_b32 v5, v40, v40, s81
    v_and_b32 v52, v4, v10
    v_and_b32 v53, v4, v11
    v_and_b32 v54, v4, v12
    v_and_b32 v55, v4, v13
    v_and_b32 v56, v5, v10
    v_and_b32 v57, v5, v11
    v_and_b32 v58, v5, v12
    v_and_b32 v59, v5, v13
    v_mfma_f32_16x16x32_bf16 v[60:63], a[164:167], v[52:55], v[60:63]
    s_nop 0
    v_mfma_f32_16x16x32_bf16 v[64:67], a[164:167], v[56:59], v[64:67]
    s_waitcnt vmcnt(7)
    buffer_load_dwordx4 a[200:203], v14, s[40:43], s63 offen nt
    s_add_u32 s63, s63, 8192
    v_perm_b32 v4, v25, v25, s80
    v_perm_b32 v5, v41, v41, s80
    v_and_b32 v52, v4, v10
    v_and_b32 v53, v4, v11
    v_and_b32 v54, v4, v12
    v_and_b32 v55, v4, v13
    v_and_b32 v56, v5, v10
    v_and_b32 v57, v5, v11
    v_and_b32 v58, v5, v12
    v_and_b32 v59, v5, v13
    v_mfma_f32_16x16x32_bf16 v[60:63], a[168:171], v[52:55], v[60:63]
    s_nop 0
    v_mfma_f32_16x16x32_bf16 v[64:67], a[168:171], v[56:59], v[64:67]
    s_waitcnt vmcnt(7)
    buffer_load_dwordx4 a[204:207], v14, s[40:43], s63 offen nt
    s_add_u32 s63, s63, 8192
    v_perm_b32 v4, v25, v25, s81
    v_perm_b32 v5, v41, v41, s81
    v_and_b32 v52, v4, v10
    v_and_b32 v53, v4, v11
    v_and_b32 v54, v4, v12
    v_and_b32 v55, v4, v13
    v_and_b32 v56, v5, v10
    v_and_b32 v57, v5, v11
    v_and_b32 v58, v5, v12
    v_and_b32 v59, v5, v13
    v_mfma_f32_16x16x32_bf16 v[60:63], a[172:175], v[52:55], v[60:63]
    s_nop 0
    v_mfma_f32_16x16x32_bf16 v[64:67], a[172:175], v[56:59], v[64:67]
    s_waitcnt vmcnt(7)
    buffer_load_dwordx4 a[208:211], v14, s[40:43], s63 offen nt
    s_add_u32 s63, s63, 8192
    v_mov_b32 v120, 0xff7f0000
    v_mov_b32 v121, 0
    v_mov_b32 v18, 1
    v_mov_b32 v116, 0
    v_mov_b32 v117, 0
    v_mov_b32 v118, 0
    v_mov_b32 v119, 0
    v_lshlrev_b32 v0, 3, v1
    ds_write_b64 v0, v[116:117] offset:8192
    v_mov_b32 v0, 8192
    s_lshl_b32 s38, s32, 10
    s_add_u32 s96, s38, 65536
    s_lshr_b32 s38, s32, 3
    s_lshl_b32 s38, s38, 8
    s_add_u32 s96, s38, s96
    v_mov_b32 v9, s96
    s_lshl_b32 s38, s32, 15
    s_add_u32 s96, s38, 1048576
    s_lshl_b32 s38, s3, 13
    s_add_u32 s96, s38, s96
    s_lshl_b32 s38, s33, 10
    s_add_u32 s96, s38, s96
    v_and_b32 v5, 3, v3
    v_lshlrev_b32 v78, 7, v2
    v_lshl_add_u32 v78, v5, 5, v78
    s_lshl_b32 s38, s32, 12
    s_add_u32 s91, s38, 262144
    s_lshl_b32 s38, s3, 9
    s_add_u32 s91, s38, s91
    v_lshlrev_b32 v4, 7, v2
    v_lshl_add_u32 v4, v3, 4, v4
    v_mov_b32 v5, 512
    v_cmp_gt_u32 vcc, 8, v3
    s_nop 1
    v_cndmask_b32 v79, v5, v4, vcc
    v_perm_b32 v4, v26, v26, s80
    v_perm_b32 v5, v42, v42, s80
    v_and_b32 v52, v4, v10
    v_and_b32 v53, v4, v11
    v_and_b32 v54, v4, v12
    v_and_b32 v55, v4, v13
    v_and_b32 v56, v5, v10
    v_and_b32 v57, v5, v11
    v_and_b32 v58, v5, v12
    v_and_b32 v59, v5, v13
    v_mfma_f32_16x16x32_bf16 v[60:63], a[176:179], v[52:55], v[60:63]
    s_nop 0
    v_mfma_f32_16x16x32_bf16 v[64:67], a[176:179], v[56:59], v[64:67]
    s_waitcnt vmcnt(7)
    buffer_load_dwordx4 a[212:215], v14, s[40:43], s63 offen nt
    s_add_u32 s63, s63, 8192
    v_perm_b32 v4, v26, v26, s81
    v_perm_b32 v5, v42, v42, s81
    v_and_b32 v52, v4, v10
    v_and_b32 v53, v4, v11
    v_and_b32 v54, v4, v12
    v_and_b32 v55, v4, v13
    v_and_b32 v56, v5, v10
    v_and_b32 v57, v5, v11
    v_and_b32 v58, v5, v12
    v_and_b32 v59, v5, v13
    v_mfma_f32_16x16x32_bf16 v[60:63], a[180:183], v[52:55], v[60:63]
    s_nop 0
    v_mfma_f32_16x16x32_bf16 v[64:67], a[180:183], v[56:59], v[64:67]
    s_waitcnt vmcnt(7)
    buffer_load_dwordx4 a[216:219], v14, s[40:43], s63 offen nt
    s_add_u32 s63, s63, 8192
    v_perm_b32 v4, v27, v27, s80
    v_perm_b32 v5, v43, v43, s80
    v_and_b32 v52, v4, v10
    v_and_b32 v53, v4, v11
    v_and_b32 v54, v4, v12
    v_and_b32 v55, v4, v13
    v_and_b32 v56, v5, v10
    v_and_b32 v57, v5, v11
    v_and_b32 v58, v5, v12
    v_and_b32 v59, v5, v13
    v_mfma_f32_16x16x32_bf16 v[60:63], a[184:187], v[52:55], v[60:63]
    s_nop 0
    v_mfma_f32_16x16x32_bf16 v[64:67], a[184:187], v[56:59], v[64:67]
    s_waitcnt vmcnt(7)
    buffer_load_dwordx4 a[220:223], v14, s[40:43], s63 offen nt
    s_add_u32 s63, s63, 8192
    v_perm_b32 v4, v27, v27, s81
    v_perm_b32 v5, v43, v43, s81
    v_and_b32 v52, v4, v10
    v_and_b32 v53, v4, v11
    v_and_b32 v54, v4, v12
    v_and_b32 v55, v4, v13
    v_and_b32 v56, v5, v10
    v_and_b32 v57, v5, v11
    v_and_b32 v58, v5, v12
    v_and_b32 v59, v5, v13
    v_mfma_f32_16x16x32_bf16 v[60:63], a[188:191], v[52:55], v[60:63]
    s_nop 0
    v_mfma_f32_16x16x32_bf16 v[64:67], a[188:191], v[56:59], v[64:67]
    s_waitcnt vmcnt(7)
    buffer_load_dwordx4 a[224:227], v14, s[40:43], s63 offen nt
    s_add_u32 s63, s63, 8192
    v_perm_b32 v4, v28, v28, s80
    v_perm_b32 v5, v44, v44, s80
    v_and_b32 v52, v4, v10
    v_and_b32 v53, v4, v11
    v_and_b32 v54, v4, v12
    v_and_b32 v55, v4, v13
    v_and_b32 v56, v5, v10
    v_and_b32 v57, v5, v11
    v_and_b32 v58, v5, v12
    v_and_b32 v59, v5, v13
    v_mfma_f32_16x16x32_bf16 v[60:63], a[192:195], v[52:55], v[60:63]
    s_nop 0
    v_mfma_f32_16x16x32_bf16 v[64:67], a[192:195], v[56:59], v[64:67]
    s_waitcnt vmcnt(7)
    buffer_load_dwordx4 a[228:231], v14, s[40:43], s63 offen nt
    s_add_u32 s63, s63, 8192
    v_perm_b32 v4, v28, v28, s81
    v_perm_b32 v5, v44, v44, s81
    v_and_b32 v52, v4, v10
    v_and_b32 v53, v4, v11
    v_and_b32 v54, v4, v12
    v_and_b32 v55, v4, v13
    v_and_b32 v56, v5, v10
    v_and_b32 v57, v5, v11
    v_and_b32 v58, v5, v12
    v_and_b32 v59, v5, v13
    v_mfma_f32_16x16x32_bf16 v[60:63], a[196:199], v[52:55], v[60:63]
    s_nop 0
    v_mfma_f32_16x16x32_bf16 v[64:67], a[196:199], v[56:59], v[64:67]
    s_waitcnt vmcnt(7)
    buffer_load_dwordx4 a[232:235], v14, s[40:43], s63 offen nt
    s_add_u32 s63, s63, 8192
    v_perm_b32 v4, v29, v29, s80
    v_perm_b32 v5, v45, v45, s80
    v_and_b32 v52, v4, v10
    v_and_b32 v53, v4, v11
    v_and_b32 v54, v4, v12
    v_and_b32 v55, v4, v13
    v_and_b32 v56, v5, v10
    v_and_b32 v57, v5, v11
    v_and_b32 v58, v5, v12
    v_and_b32 v59, v5, v13
    v_mfma_f32_16x16x32_bf16 v[60:63], a[200:203], v[52:55], v[60:63]
    s_nop 0
    v_mfma_f32_16x16x32_bf16 v[64:67], a[200:203], v[56:59], v[64:67]
    s_waitcnt vmcnt(7)
    buffer_load_dwordx4 a[236:239], v14, s[40:43], s63 offen nt
    s_add_u32 s63, s63, 8192
    v_perm_b32 v4, v29, v29, s81
    v_perm_b32 v5, v45, v45, s81
    v_and_b32 v52, v4, v10
    v_and_b32 v53, v4, v11
    v_and_b32 v54, v4, v12
    v_and_b32 v55, v4, v13
    v_and_b32 v56, v5, v10
    v_and_b32 v57, v5, v11
    v_and_b32 v58, v5, v12
    v_and_b32 v59, v5, v13
    v_mfma_f32_16x16x32_bf16 v[60:63], a[204:207], v[52:55], v[60:63]
    s_nop 0
    v_mfma_f32_16x16x32_bf16 v[64:67], a[204:207], v[56:59], v[64:67]
    s_waitcnt vmcnt(7)
    buffer_load_dwordx4 a[240:243], v14, s[40:43], s63 offen nt
    s_add_u32 s63, s63, 8192
    v_perm_b32 v4, v30, v30, s80
    v_perm_b32 v5, v46, v46, s80
    v_and_b32 v52, v4, v10
    v_and_b32 v53, v4, v11
    v_and_b32 v54, v4, v12
    v_and_b32 v55, v4, v13
    v_and_b32 v56, v5, v10
    v_and_b32 v57, v5, v11
    v_and_b32 v58, v5, v12
    v_and_b32 v59, v5, v13
    v_mfma_f32_16x16x32_bf16 v[60:63], a[208:211], v[52:55], v[60:63]
    s_nop 0
    v_mfma_f32_16x16x32_bf16 v[64:67], a[208:211], v[56:59], v[64:67]
    s_waitcnt vmcnt(7)
    buffer_load_dwordx4 a[244:247], v14, s[40:43], s63 offen nt
    s_add_u32 s63, s63, 8192
    v_perm_b32 v4, v30, v30, s81
    v_perm_b32 v5, v46, v46, s81
    v_and_b32 v52, v4, v10
    v_and_b32 v53, v4, v11
    v_and_b32 v54, v4, v12
    v_and_b32 v55, v4, v13
    v_and_b32 v56, v5, v10
    v_and_b32 v57, v5, v11
    v_and_b32 v58, v5, v12
    v_and_b32 v59, v5, v13
    v_mfma_f32_16x16x32_bf16 v[60:63], a[212:215], v[52:55], v[60:63]
    s_nop 0
    v_mfma_f32_16x16x32_bf16 v[64:67], a[212:215], v[56:59], v[64:67]
    s_waitcnt vmcnt(7)
    buffer_load_dwordx4 a[248:251], v14, s[40:43], s63 offen nt
    s_add_u32 s63, s63, 8192
    v_perm_b32 v4, v31, v31, s80
    v_perm_b32 v5, v47, v47, s80
    v_and_b32 v52, v4, v10
    v_and_b32 v53, v4, v11
    v_and_b32 v54, v4, v12
    v_and_b32 v55, v4, v13
    v_and_b32 v56, v5, v10
    v_and_b32 v57, v5, v11
    v_and_b32 v58, v5, v12
    v_and_b32 v59, v5, v13
    v_mfma_f32_16x16x32_bf16 v[60:63], a[216:219], v[52:55], v[60:63]
    s_nop 0
    v_mfma_f32_16x16x32_bf16 v[64:67], a[216:219], v[56:59], v[64:67]
    s_waitcnt vmcnt(7)
    buffer_load_dwordx4 a[252:255], v14, s[40:43], s63 offen nt
    s_add_u32 s63, s63, 8192
    v_perm_b32 v4, v31, v31, s81
    v_perm_b32 v5, v47, v47, s81
    v_and_b32 v52, v4, v10
    v_and_b32 v53, v4, v11
    v_and_b32 v54, v4, v12
    v_and_b32 v55, v4, v13
    v_and_b32 v56, v5, v10
    v_and_b32 v57, v5, v11
    v_and_b32 v58, v5, v12
    v_and_b32 v59, v5, v13
    v_mfma_f32_16x16x32_bf16 v[60:63], a[220:223], v[52:55], v[60:63]
    s_nop 0
    v_mfma_f32_16x16x32_bf16 v[64:67], a[220:223], v[56:59], v[64:67]
    s_waitcnt vmcnt(7)
    v_perm_b32 v4, v32, v32, s80
    v_perm_b32 v5, v48, v48, s80
    v_and_b32 v52, v4, v10
    v_and_b32 v53, v4, v11
    v_and_b32 v54, v4, v12
    v_and_b32 v55, v4, v13
    v_and_b32 v56, v5, v10
    v_and_b32 v57, v5, v11
    v_and_b32 v58, v5, v12
    v_and_b32 v59, v5, v13
    v_mfma_f32_16x16x32_bf16 v[60:63], a[224:227], v[52:55], v[60:63]
    s_nop 0
    v_mfma_f32_16x16x32_bf16 v[64:67], a[224:227], v[56:59], v[64:67]
    s_waitcnt vmcnt(6)
    s_add_u32 s39, s87, s88
    s_bfe_u32 s37, s39, 0x30000
    s_lshl_b32 s37, s37, 12
    s_add_u32 s85, s37, s89
    s_bfe_u32 s37, s39, 0x10003
    s_lshl_b32 s37, s37, 11
    s_add_u32 s85, s37, s85
    s_bfe_u32 s37, s39, 0x40004
    s_lshl_b32 s37, s37, 16
    s_add_u32 s85, s37, s85
    buffer_load_dwordx4 v[128:131], v76, s[52:55], s85 offen offset:0 nt
    v_perm_b32 v4, v32, v32, s81
    v_perm_b32 v5, v48, v48, s81
    v_and_b32 v52, v4, v10
    v_and_b32 v53, v4, v11
    v_and_b32 v54, v4, v12
    v_and_b32 v55, v4, v13
    v_and_b32 v56, v5, v10
    v_and_b32 v57, v5, v11
    v_and_b32 v58, v5, v12
    v_and_b32 v59, v5, v13
    v_mfma_f32_16x16x32_bf16 v[60:63], a[228:231], v[52:55], v[60:63]
    s_nop 0
    v_mfma_f32_16x16x32_bf16 v[64:67], a[228:231], v[56:59], v[64:67]
    s_waitcnt vmcnt(6)
    buffer_load_dwordx4 v[132:135], v77, s[52:55], s85 offen offset:0 nt
    v_perm_b32 v4, v33, v33, s80
    v_perm_b32 v5, v49, v49, s80
    v_and_b32 v52, v4, v10
    v_and_b32 v53, v4, v11
    v_and_b32 v54, v4, v12
    v_and_b32 v55, v4, v13
    v_and_b32 v56, v5, v10
    v_and_b32 v57, v5, v11
    v_and_b32 v58, v5, v12
    v_and_b32 v59, v5, v13
    v_mfma_f32_16x16x32_bf16 v[60:63], a[232:235], v[52:55], v[60:63]
    s_nop 0
    v_mfma_f32_16x16x32_bf16 v[64:67], a[232:235], v[56:59], v[64:67]
    s_waitcnt vmcnt(6)
    buffer_load_dwordx4 v[136:139], v76, s[52:55], s85 offen offset:1024 nt
    v_perm_b32 v4, v33, v33, s81
    v_perm_b32 v5, v49, v49, s81
    v_and_b32 v52, v4, v10
    v_and_b32 v53, v4, v11
    v_and_b32 v54, v4, v12
    v_and_b32 v55, v4, v13
    v_and_b32 v56, v5, v10
    v_and_b32 v57, v5, v11
    v_and_b32 v58, v5, v12
    v_and_b32 v59, v5, v13
    v_mfma_f32_16x16x32_bf16 v[60:63], a[236:239], v[52:55], v[60:63]
    s_nop 0
    v_mfma_f32_16x16x32_bf16 v[64:67], a[236:239], v[56:59], v[64:67]
    s_waitcnt vmcnt(6)
    buffer_load_dwordx4 v[140:143], v77, s[52:55], s85 offen offset:1024 nt
    s_add_u32 s87, s87, 7
    s_add_u32 s39, s87, s88
    s_bfe_u32 s37, s39, 0x30000
    s_lshl_b32 s37, s37, 12
    s_add_u32 s85, s37, s89
    s_bfe_u32 s37, s39, 0x10003
    s_lshl_b32 s37, s37, 11
    s_add_u32 s85, s37, s85
    s_bfe_u32 s37, s39, 0x40004
    s_lshl_b32 s37, s37, 16
    s_add_u32 s85, s37, s85
    v_perm_b32 v4, v34, v34, s80
    v_perm_b32 v5, v50, v50, s80
    v_and_b32 v52, v4, v10
    v_and_b32 v53, v4, v11
    v_and_b32 v54, v4, v12
    v_and_b32 v55, v4, v13
    v_and_b32 v56, v5, v10
    v_and_b32 v57, v5, v11
    v_and_b32 v58, v5, v12
    v_and_b32 v59, v5, v13
    v_mfma_f32_16x16x32_bf16 v[60:63], a[240:243], v[52:55], v[60:63]
    s_nop 0
    v_mfma_f32_16x16x32_bf16 v[64:67], a[240:243], v[56:59], v[64:67]
    s_waitcnt vmcnt(6)
    buffer_load_dwordx4 v[144:147], v76, s[52:55], s85 offen offset:0 nt
    v_perm_b32 v4, v34, v34, s81
    v_perm_b32 v5, v50, v50, s81
    v_and_b32 v52, v4, v10
    v_and_b32 v53, v4, v11
    v_and_b32 v54, v4, v12
    v_and_b32 v55, v4, v13
    v_and_b32 v56, v5, v10
    v_and_b32 v57, v5, v11
    v_and_b32 v58, v5, v12
    v_and_b32 v59, v5, v13
    v_mfma_f32_16x16x32_bf16 v[60:63], a[244:247], v[52:55], v[60:63]
    s_nop 0
    v_mfma_f32_16x16x32_bf16 v[64:67], a[244:247], v[56:59], v[64:67]
    s_waitcnt vmcnt(6)
    buffer_load_dwordx4 v[148:151], v77, s[52:55], s85 offen offset:0 nt
    v_perm_b32 v4, v35, v35, s80
    v_perm_b32 v5, v51, v51, s80
    v_and_b32 v52, v4, v10
    v_and_b32 v53, v4, v11
    v_and_b32 v54, v4, v12
    v_and_b32 v55, v4, v13
    v_and_b32 v56, v5, v10
    v_and_b32 v57, v5, v11
    v_and_b32 v58, v5, v12
    v_and_b32 v59, v5, v13
    v_mfma_f32_16x16x32_bf16 v[60:63], a[248:251], v[52:55], v[60:63]
    s_nop 0
    v_mfma_f32_16x16x32_bf16 v[64:67], a[248:251], v[56:59], v[64:67]
    s_waitcnt vmcnt(6)
    buffer_load_dwordx4 v[152:155], v76, s[52:55], s85 offen offset:1024 nt
    v_perm_b32 v4, v35, v35, s81
    v_perm_b32 v5, v51, v51, s81
    v_and_b32 v52, v4, v10
    v_and_b32 v53, v4, v11
    v_and_b32 v54, v4, v12
    v_and_b32 v55, v4, v13
    v_and_b32 v56, v5, v10
    v_and_b32 v57, v5, v11
    v_and_b32 v58, v5, v12
    v_and_b32 v59, v5, v13
    v_mfma_f32_16x16x32_bf16 v[60:63], a[252:255], v[52:55], v[60:63]
    s_nop 0
    v_mfma_f32_16x16x32_bf16 v[64:67], a[252:255], v[56:59], v[64:67]
    s_lshl_b32 s38, s34, 11
    v_lshrrev_b32 v4, 3, v3
    v_lshlrev_b32 v4, 9, v4
    v_lshl_add_u32 v4, v2, 7, v4
    v_and_b32 v5, 7, v3
    v_lshl_add_u32 v4, v5, 2, v4
    v_add_u32 v4, s38, v4
    ds_write_b32 v4, v60 offset:0
    ds_write_b32 v4, v61 offset:32
    ds_write_b32 v4, v62 offset:64
    ds_write_b32 v4, v63 offset:96
    ds_write_b32 v4, v64 offset:1024
    ds_write_b32 v4, v65 offset:1056
    ds_write_b32 v4, v66 offset:1088
    ds_write_b32 v4, v67 offset:1120
    s_lshl_b32 s38, s34, 9
    v_and_b32 v5, 31, v1
    v_lshl_add_u32 v5, v5, 4, s38
    s_waitcnt lgkmcnt(0)
    s_add_u32 s35, s35, 0x5b
    s_and_b32 s35, s35, 0xff
    v_mov_b32 v8, s35
    s_barrier
    ds_read_b128 v[20:23], v5 offset:0
    ds_read_b128 v[24:27], v5 offset:2048
    ds_read_b128 v[28:31], v5 offset:4096
    ds_read_b128 v[32:35], v5 offset:6144
    s_lshl_b32 s38, s61, 12
    s_add_u32 s36, s38, 262144
    s_lshl_b32 s38, s33, 11
    s_add_u32 s36, s38, s36
    s_waitcnt lgkmcnt(0)
    v_add_f32 v20, v20, v24
    v_add_f32 v28, v28, v32
    v_add_f32 v21, v21, v25
    v_add_f32 v29, v29, v33
    v_add_f32 v22, v22, v26
    v_add_f32 v30, v30, v34
    v_add_f32 v23, v23, v27
    v_add_f32 v31, v31, v35
    v_add_f32 v20, v20, v28
    v_add_f32 v21, v21, v29
    v_add_f32 v22, v22, v30
    v_add_f32 v23, v23, v31
    s_mov_b32 s38, 0xffff0000
    v_cvt_pk_bf16_f32 v20, v20, v20
    v_cvt_pk_bf16_f32 v21, v21, v21
    v_cvt_pk_bf16_f32 v22, v22, v22
    v_cvt_pk_bf16_f32 v23, v23, v23
    v_and_or_b32 v20, v20, s38, v8
    v_and_or_b32 v21, v21, s38, v8
    v_and_or_b32 v22, v22, s38, v8
    v_and_or_b32 v23, v23, s38, v8
    s_mov_b32 exec_lo, 0xffffffff
    s_mov_b32 exec_hi, 0x0
    buffer_store_dwordx4 v[20:23], v5, s[48:51], s36 offen sc1
    s_mov_b64 exec, -1
    s_waitcnt vmcnt(7)
    buffer_load_dwordx4 v[156:159], v77, s[52:55], s85 offen offset:1024 nt
    s_add_u32 s87, s87, 7
    s_add_u32 s39, s87, s88
    s_bfe_u32 s37, s39, 0x30000
    s_lshl_b32 s37, s37, 12
    s_add_u32 s85, s37, s89
    s_bfe_u32 s37, s39, 0x10003
    s_lshl_b32 s37, s37, 11
    s_add_u32 s85, s37, s85
    s_bfe_u32 s37, s39, 0x40004
    s_lshl_b32 s37, s37, 16
    s_add_u32 s85, s37, s85
    s_waitcnt vmcnt(7)
    buffer_load_dwordx4 v[160:163], v76, s[52:55], s85 offen offset:0 nt
    s_waitcnt vmcnt(7)
    buffer_load_dwordx4 v[164:167], v77, s[52:55], s85 offen offset:0 nt
    s_waitcnt vmcnt(7)
    buffer_load_dwordx4 v[168:171], v76, s[52:55], s85 offen offset:1024 nt
    s_waitcnt vmcnt(7)
    buffer_load_dwordx4 v[172:175], v77, s[52:55], s85 offen offset:1024 nt
    s_add_u32 s87, s87, 7
    s_add_u32 s39, s87, s88
    s_bfe_u32 s37, s39, 0x30000
    s_lshl_b32 s37, s37, 12
    s_add_u32 s85, s37, s89
    s_bfe_u32 s37, s39, 0x10003
    s_lshl_b32 s37, s37, 11
    s_add_u32 s85, s37, s85
    s_bfe_u32 s37, s39, 0x40004
    s_lshl_b32 s37, s37, 16
    s_add_u32 s85, s37, s85
    s_waitcnt vmcnt(7)
    buffer_load_dwordx4 v[176:179], v76, s[52:55], s85 offen offset:0 nt
    s_waitcnt vmcnt(7)
    buffer_load_dwordx4 v[180:183], v77, s[52:55], s85 offen offset:0 nt
    s_waitcnt vmcnt(6)
    buffer_load_dwordx4 v[184:187], v76, s[52:55], s85 offen offset:1024 nt
    s_waitcnt vmcnt(6)
    buffer_load_dwordx4 v[188:191], v77, s[52:55], s85 offen offset:1024 nt
    s_add_u32 s87, s87, 7
    s_add_u32 s39, s87, s88
    s_bfe_u32 s37, s39, 0x30000
    s_lshl_b32 s37, s37, 12
    s_add_u32 s85, s37, s89
    s_bfe_u32 s37, s39, 0x10003
    s_lshl_b32 s37, s37, 11
    s_add_u32 s85, s37, s85
    s_bfe_u32 s37, s39, 0x40004
    s_lshl_b32 s37, s37, 16
    s_add_u32 s85, s37, s85
    s_waitcnt vmcnt(6)
    buffer_load_dwordx4 v[192:195], v76, s[52:55], s85 offen offset:0 nt
    s_waitcnt vmcnt(6)
    buffer_load_dwordx4 v[196:199], v77, s[52:55], s85 offen offset:0 nt
    s_waitcnt vmcnt(6)
    buffer_load_dwordx4 v[200:203], v76, s[52:55], s85 offen offset:1024 nt
    s_waitcnt vmcnt(6)
    buffer_load_dwordx4 v[204:207], v77, s[52:55], s85 offen offset:1024 nt
    s_add_u32 s87, s87, 7
    s_add_u32 s39, s87, s88
    s_bfe_u32 s37, s39, 0x30000
    s_lshl_b32 s37, s37, 12
    s_add_u32 s85, s37, s89
    s_bfe_u32 s37, s39, 0x10003
    s_lshl_b32 s37, s37, 11
    s_add_u32 s85, s37, s85
    s_bfe_u32 s37, s39, 0x40004
    s_lshl_b32 s37, s37, 16
    s_add_u32 s85, s37, s85
    s_waitcnt vmcnt(6)
    buffer_load_dwordx4 v[208:211], v76, s[52:55], s85 offen offset:0 nt
    s_waitcnt vmcnt(6)
    buffer_load_dwordx4 v[212:215], v77, s[52:55], s85 offen offset:0 nt
    s_waitcnt vmcnt(6)
    buffer_load_dwordx4 v[216:219], v76, s[52:55], s85 offen offset:1024 nt
    s_waitcnt vmcnt(6)
    buffer_load_dwordx4 v[220:223], v77, s[52:55], s85 offen offset:1024 nt
    s_add_u32 s87, s87, 7
    s_add_u32 s39, s87, s88
    s_bfe_u32 s37, s39, 0x30000
    s_lshl_b32 s37, s37, 12
    s_add_u32 s85, s37, s89
    s_bfe_u32 s37, s39, 0x10003
    s_lshl_b32 s37, s37, 11
    s_add_u32 s85, s37, s85
    s_bfe_u32 s37, s39, 0x40004
    s_lshl_b32 s37, s37, 16
    s_add_u32 s85, s37, s85
    s_waitcnt vmcnt(6)
    buffer_load_dwordx4 v[224:227], v76, s[52:55], s85 offen offset:0 nt
    s_waitcnt vmcnt(6)
    buffer_load_dwordx4 v[228:231], v77, s[52:55], s85 offen offset:0 nt
    s_waitcnt vmcnt(6)
    buffer_load_dwordx4 v[232:235], v76, s[52:55], s85 offen offset:1024 nt
    s_waitcnt vmcnt(6)
    buffer_load_dwordx4 v[236:239], v77, s[52:55], s85 offen offset:1024 nt
    s_add_u32 s87, s87, 7
    s_add_u32 s39, s87, s88
    s_bfe_u32 s37, s39, 0x30000
    s_lshl_b32 s37, s37, 12
    s_add_u32 s85, s37, s89
    s_bfe_u32 s37, s39, 0x10003
    s_lshl_b32 s37, s37, 11
    s_add_u32 s85, s37, s85
    s_bfe_u32 s37, s39, 0x40004
    s_lshl_b32 s37, s37, 16
    s_add_u32 s85, s37, s85
    s_waitcnt vmcnt(6)
    buffer_load_dwordx4 v[240:243], v76, s[52:55], s85 offen offset:0 nt
    s_waitcnt vmcnt(6)
    buffer_load_dwordx4 v[244:247], v77, s[52:55], s85 offen offset:0 nt
    s_waitcnt vmcnt(6)
    buffer_load_dwordx4 v[248:251], v76, s[52:55], s85 offen offset:1024 nt
    s_waitcnt vmcnt(6)
    buffer_load_dwordx4 v[252:255], v77, s[52:55], s85 offen offset:1024 nt
    s_add_u32 s87, s87, 7
    s_add_u32 s39, s87, s88
    s_bfe_u32 s37, s39, 0x30000
    s_lshl_b32 s37, s37, 12
    s_add_u32 s85, s37, s89
    s_bfe_u32 s37, s39, 0x10003
    s_lshl_b32 s37, s37, 11
    s_add_u32 s85, s37, s85
    s_bfe_u32 s37, s39, 0x40004
    s_lshl_b32 s37, s37, 16
    s_add_u32 s85, s37, s85
    s_waitcnt vmcnt(6)
    buffer_load_dwordx4 a[0:3], v76, s[52:55], s85 offen offset:0 nt
    s_waitcnt vmcnt(6)
    buffer_load_dwordx4 a[4:7], v77, s[52:55], s85 offen offset:0 nt
    s_waitcnt vmcnt(6)
    buffer_load_dwordx4 a[8:11], v76, s[52:55], s85 offen offset:1024 nt
    s_waitcnt vmcnt(6)
    buffer_load_dwordx4 a[12:15], v77, s[52:55], s85 offen offset:1024 nt
    s_add_u32 s87, s87, 7
    s_add_u32 s39, s87, s88
    s_bfe_u32 s37, s39, 0x30000
    s_lshl_b32 s37, s37, 12
    s_add_u32 s85, s37, s89
    s_bfe_u32 s37, s39, 0x10003
    s_lshl_b32 s37, s37, 11
    s_add_u32 s85, s37, s85
    s_bfe_u32 s37, s39, 0x40004
    s_lshl_b32 s37, s37, 16
    s_add_u32 s85, s37, s85
    s_waitcnt vmcnt(6)
    buffer_load_dwordx4 a[16:19], v76, s[52:55], s85 offen offset:0 nt
    s_waitcnt vmcnt(6)
    buffer_load_dwordx4 a[20:23], v77, s[52:55], s85 offen offset:0 nt
    s_waitcnt vmcnt(6)
    buffer_load_dwordx4 a[24:27], v76, s[52:55], s85 offen offset:1024 nt
    s_waitcnt vmcnt(6)
    buffer_load_dwordx4 a[28:31], v77, s[52:55], s85 offen offset:1024 nt
    s_add_u32 s87, s87, 7
    s_add_u32 s39, s87, s88
    s_bfe_u32 s37, s39, 0x30000
    s_lshl_b32 s37, s37, 12
    s_add_u32 s85, s37, s89
    s_bfe_u32 s37, s39, 0x10003
    s_lshl_b32 s37, s37, 11
    s_add_u32 s85, s37, s85
    s_bfe_u32 s37, s39, 0x40004
    s_lshl_b32 s37, s37, 16
    s_add_u32 s85, s37, s85
    s_waitcnt vmcnt(6)
    buffer_load_dwordx4 a[32:35], v76, s[52:55], s85 offen offset:0 nt
    s_waitcnt vmcnt(6)
    buffer_load_dwordx4 a[36:39], v77, s[52:55], s85 offen offset:0 nt
    s_waitcnt vmcnt(6)
    buffer_load_dwordx4 a[40:43], v76, s[52:55], s85 offen offset:1024 nt
    s_waitcnt vmcnt(6)
    buffer_load_dwordx4 a[44:47], v77, s[52:55], s85 offen offset:1024 nt
    s_add_u32 s87, s87, 7
    s_add_u32 s39, s87, s88
    s_bfe_u32 s37, s39, 0x30000
    s_lshl_b32 s37, s37, 12
    s_add_u32 s85, s37, s89
    s_bfe_u32 s37, s39, 0x10003
    s_lshl_b32 s37, s37, 11
    s_add_u32 s85, s37, s85
    s_bfe_u32 s37, s39, 0x40004
    s_lshl_b32 s37, s37, 16
    s_add_u32 s85, s37, s85
    s_waitcnt vmcnt(6)
    buffer_load_dwordx4 a[48:51], v76, s[52:55], s85 offen offset:0 nt
    s_waitcnt vmcnt(6)
    buffer_load_dwordx4 a[52:55], v77, s[52:55], s85 offen offset:0 nt
    buffer_load_dwordx4 v[68:71], v78, s[48:51], s91 offen offset:0 sc1
    buffer_load_dwordx4 v[72:75], v78, s[48:51], s91 offen offset:16 sc1
    s_waitcnt vmcnt(8)
    buffer_load_dwordx4 a[56:59], v76, s[52:55], s85 offen offset:1024 nt
    s_waitcnt vmcnt(8)
    buffer_load_dwordx4 a[60:63], v77, s[52:55], s85 offen offset:1024 nt
    s_add_u32 s87, s87, 7
    s_add_u32 s39, s87, s88
    s_bfe_u32 s37, s39, 0x30000
    s_lshl_b32 s37, s37, 12
    s_add_u32 s85, s37, s89
    s_bfe_u32 s37, s39, 0x10003
    s_lshl_b32 s37, s37, 11
    s_add_u32 s85, s37, s85
    s_bfe_u32 s37, s39, 0x40004
    s_lshl_b32 s37, s37, 16
    s_add_u32 s85, s37, s85
    s_waitcnt vmcnt(8)
    buffer_load_dwordx4 a[64:67], v76, s[52:55], s85 offen offset:0 nt
    s_waitcnt vmcnt(8)
    buffer_load_dwordx4 a[68:71], v77, s[52:55], s85 offen offset:0 nt
    s_waitcnt vmcnt(8)
    buffer_load_dwordx4 a[72:75], v76, s[52:55], s85 offen offset:1024 nt
    s_waitcnt vmcnt(8)
    buffer_load_dwordx4 a[76:79], v77, s[52:55], s85 offen offset:1024 nt
    s_add_u32 s87, s87, 7
    s_add_u32 s39, s87, s88
    s_bfe_u32 s37, s39, 0x30000
    s_lshl_b32 s37, s37, 12
    s_add_u32 s85, s37, s89
    s_bfe_u32 s37, s39, 0x10003
    s_lshl_b32 s37, s37, 11
    s_add_u32 s85, s37, s85
    s_bfe_u32 s37, s39, 0x40004
    s_lshl_b32 s37, s37, 16
    s_add_u32 s85, s37, s85
    s_waitcnt vmcnt(6)
L_qcheck_39:
    v_xor_b32 v68, s35, v68
    v_xor_b32 v69, s35, v69
    v_xor_b32 v70, s35, v70
    v_xor_b32 v71, s35, v71
    v_xor_b32 v72, s35, v72
    v_xor_b32 v73, s35, v73
    v_xor_b32 v74, s35, v74
    v_xor_b32 v75, s35, v75
    v_or_b32 v4, v68, v69
    v_or3_b32 v4, v4, v70, v71
    v_or3_b32 v4, v4, v72, v73
    v_or3_b32 v4, v4, v74, v75
    v_and_b32 v4, 0xff, v4
    v_cmp_ne_u32 vcc, 0, v4
    s_cbranch_vccz L_qok_40
    buffer_load_dwordx4 v[68:71], v78, s[48:51], s91 offen offset:0 sc1
    buffer_load_dwordx4 v[72:75], v78, s[48:51], s91 offen offset:16 sc1
    s_waitcnt vmcnt(0)
    s_sub_u32 s84, s84, 1
    s_cmp_lg_u32 s84, 0
    s_cbranch_scc1 L_qcheck_39
    s_branch L_end
L_qok_40:
    v_cvt_pk_bf16_f32 v68, v68, v69
    v_cvt_pk_bf16_f32 v69, v70, v71
    v_cvt_pk_bf16_f32 v70, v72, v73
    v_cvt_pk_bf16_f32 v71, v74, v75
    s_mov_b32 vcc_lo, 0xf000f
    s_mov_b32 vcc_hi, 0xf000f
    v_cndmask_b32 v80, 0, v68, vcc
    v_cndmask_b32 v81, 0, v69, vcc
    v_cndmask_b32 v82, 0, v70, vcc
    v_cndmask_b32 v83, 0, v71, vcc
    s_mov_b32 vcc_lo, 0xf000f0
    s_mov_b32 vcc_hi, 0xf000f0
    v_cndmask_b32 v84, 0, v68, vcc
    v_cndmask_b32 v85, 0, v69, vcc
    v_cndmask_b32 v86, 0, v70, vcc
    v_cndmask_b32 v87, 0, v71, vcc
    s_mov_b32 vcc_lo, 0xf000f00
    s_mov_b32 vcc_hi, 0xf000f00
    v_cndmask_b32 v88, 0, v68, vcc
    v_cndmask_b32 v89, 0, v69, vcc
    v_cndmask_b32 v90, 0, v70, vcc
    v_cndmask_b32 v91, 0, v71, vcc
    s_mov_b32 vcc_lo, 0xf000f000
    s_mov_b32 vcc_hi, 0xf000f000
    v_cndmask_b32 v92, 0, v68, vcc
    v_cndmask_b32 v93, 0, v69, vcc
    v_cndmask_b32 v94, 0, v70, vcc
    v_cndmask_b32 v95, 0, v71, vcc
    s_getreg_b32 s70, hwreg(HW_REG_XCC_ID, 0, 4)
    s_lshl_b32 s70, s70, 8
    s_or_b32 s70, s70, s35
    s_or_b32 s70, s70, 0x5e9d0000
    s_bfe_u32 s38, s2, 0x30000
    s_lshl_b32 s38, s38, 8
    s_add_u32 s69, s38, 32768
    s_lshl_b32 s38, s32, 2
    s_add_u32 s69, s38, s69
    s_lshl_b32 s38, s34, 24
    s_add_u32 s69, s38, s69
    v_mov_b32 v72, s69
    v_mov_b32 v73, s70
    s_mov_b64 exec, 1
    buffer_store_dword v73, v72, s[48:51], 0 offen sc1
    s_mov_b64 exec, -1
    v_mov_b32 v65, 0xff7f0000
    s_lshl_b32 s38, s34, 14
    s_add_u32 s38, s38, 16384
    v_lshl_add_u32 v64, v1, 2, s38
    buffer_load_dwordx4 a[80:83], v76, s[52:55], s85 offen offset:0 nt
    v_mfma_f32_16x16x32_bf16 v[112:115], v[128:131], v[80:83], 0
    v_mfma_f32_16x16x32_bf16 v[112:115], v[132:135], v[84:87], v[112:115]
    v_mfma_f32_16x16x32_bf16 v[112:115], v[136:139], v[88:91], v[112:115]
    s_waitcnt vmcnt(7)
    buffer_load_dwordx4 a[84:87], v77, s[52:55], s85 offen offset:0 nt
    v_mfma_f32_16x16x32_bf16 v[112:115], v[140:143], v[92:95], v[112:115]
    v_mfma_f32_16x16x32_bf16 v[96:99], v[144:147], v[80:83], 0
    v_mfma_f32_16x16x32_bf16 v[96:99], v[148:151], v[84:87], v[96:99]
    v_mfma_f32_16x16x32_bf16 v[96:99], v[152:155], v[88:91], v[96:99]
    s_nop 4
    v_mov_b32_dpp v122, v112 quad_perm:[0,0,0,0] row_mask:0xf bank_mask:0xf
    v_mov_b32_dpp v124, v114 quad_perm:[2,2,2,2] row_mask:0xf bank_mask:0xf
    s_nop 0
    v_add_f32_dpp v122, v113, v122 quad_perm:[1,1,1,1] row_mask:0xf bank_mask:0xf
    v_add_f32_dpp v124, v115, v124 quad_perm:[3,3,3,3] row_mask:0xf bank_mask:0xf
    v_add_f32 v122, v122, v124
    v_max_f32 v65, v65, v122
    ds_write_b32 v64, v122 offset:0
    s_waitcnt vmcnt(7)
    buffer_load_dwordx4 a[88:91], v76, s[52:55], s85 offen offset:1024 nt
    v_mfma_f32_16x16x32_bf16 v[96:99], v[156:159], v[92:95], v[96:99]
    v_mfma_f32_16x16x32_bf16 v[112:115], v[160:163], v[80:83], 0
    v_mfma_f32_16x16x32_bf16 v[112:115], v[164:167], v[84:87], v[112:115]
    s_waitcnt vmcnt(7)
    buffer_load_dwordx4 a[92:95], v77, s[52:55], s85 offen offset:1024 nt
    s_add_u32 s87, s87, 7
    s_add_u32 s39, s87, s88
    s_bfe_u32 s37, s39, 0x30000
    s_lshl_b32 s37, s37, 12
    s_add_u32 s85, s37, s89
    s_bfe_u32 s37, s39, 0x10003
    s_lshl_b32 s37, s37, 11
    s_add_u32 s85, s37, s85
    s_bfe_u32 s37, s39, 0x40004
    s_lshl_b32 s37, s37, 16
    s_add_u32 s85, s37, s85
    v_mfma_f32_16x16x32_bf16 v[112:115], v[168:171], v[88:91], v[112:115]
    v_mov_b32_dpp v122, v96 quad_perm:[0,0,0,0] row_mask:0xf bank_mask:0xf
    v_mov_b32_dpp v124, v98 quad_perm:[2,2,2,2] row_mask:0xf bank_mask:0xf
    s_nop 0
    v_add_f32_dpp v122, v97, v122 quad_perm:[1,1,1,1] row_mask:0xf bank_mask:0xf
    v_add_f32_dpp v124, v99, v124 quad_perm:[3,3,3,3] row_mask:0xf bank_mask:0xf
    v_add_f32 v122, v122, v124
    v_max_f32 v65, v65, v122
    ds_write_b32 v64, v122 offset:256
    v_mfma_f32_16x16x32_bf16 v[112:115], v[172:175], v[92:95], v[112:115]
    v_mfma_f32_16x16x32_bf16 v[96:99], v[176:179], v[80:83], 0
    v_mfma_f32_16x16x32_bf16 v[96:99], v[180:183], v[84:87], v[96:99]
    s_waitcnt vmcnt(7)
    buffer_load_dwordx4 a[96:99], v76, s[52:55], s85 offen offset:0 nt
    v_mfma_f32_16x16x32_bf16 v[96:99], v[184:187], v[88:91], v[96:99]
    s_nop 2
    v_mov_b32_dpp v122, v112 quad_perm:[0,0,0,0] row_mask:0xf bank_mask:0xf
    v_mov_b32_dpp v124, v114 quad_perm:[2,2,2,2] row_mask:0xf bank_mask:0xf
    s_nop 0
    v_add_f32_dpp v122, v113, v122 quad_perm:[1,1,1,1] row_mask:0xf bank_mask:0xf
    v_add_f32_dpp v124, v115, v124 quad_perm:[3,3,3,3] row_mask:0xf bank_mask:0xf
    v_add_f32 v122, v122, v124
    v_max_f32 v65, v65, v122
    ds_write_b32 v64, v122 offset:512
    v_mfma_f32_16x16x32_bf16 v[96:99], v[188:191], v[92:95], v[96:99]
    v_mfma_f32_16x16x32_bf16 v[112:115], v[192:195], v[80:83], 0
    s_waitcnt vmcnt(7)
    buffer_load_dwordx4 a[100:103], v77, s[52:55], s85 offen offset:0 nt
    v_mfma_f32_16x16x32_bf16 v[112:115], v[196:199], v[84:87], v[112:115]
    v_mfma_f32_16x16x32_bf16 v[112:115], v[200:203], v[88:91], v[112:115]
    s_nop 2
    v_mov_b32_dpp v122, v96 quad_perm:[0,0,0,0] row_mask:0xf bank_mask:0xf
    v_mov_b32_dpp v124, v98 quad_perm:[2,2,2,2] row_mask:0xf bank_mask:0xf
    s_nop 0
    v_add_f32_dpp v122, v97, v122 quad_perm:[1,1,1,1] row_mask:0xf bank_mask:0xf
    v_add_f32_dpp v124, v99, v124 quad_perm:[3,3,3,3] row_mask:0xf bank_mask:0xf
    v_add_f32 v122, v122, v124
    v_max_f32 v65, v65, v122
    ds_write_b32 v64, v122 offset:768
    v_mfma_f32_16x16x32_bf16 v[112:115], v[204:207], v[92:95], v[112:115]
    v_mfma_f32_16x16x32_bf16 v[96:99], v[208:211], v[80:83], 0
    s_waitcnt vmcnt(7)
    buffer_load_dwordx4 a[104:107], v76, s[52:55], s85 offen offset:1024 nt
    v_mfma_f32_16x16x32_bf16 v[96:99], v[212:215], v[84:87], v[96:99]
    v_mfma_f32_16x16x32_bf16 v[96:99], v[216:219], v[88:91], v[96:99]
    s_nop 2
    v_mov_b32_dpp v122, v112 quad_perm:[0,0,0,0] row_mask:0xf bank_mask:0xf
    v_mov_b32_dpp v124, v114 quad_perm:[2,2,2,2] row_mask:0xf bank_mask:0xf
    s_nop 0
    v_add_f32_dpp v122, v113, v122 quad_perm:[1,1,1,1] row_mask:0xf bank_mask:0xf
    v_add_f32_dpp v124, v115, v124 quad_perm:[3,3,3,3] row_mask:0xf bank_mask:0xf
    v_add_f32 v122, v122, v124
    v_max_f32 v65, v65, v122
    ds_write_b32 v64, v122 offset:1024
    v_mfma_f32_16x16x32_bf16 v[96:99], v[220:223], v[92:95], v[96:99]
    s_waitcnt vmcnt(6)
    buffer_load_dwordx4 a[108:111], v77, s[52:55], s85 offen offset:1024 nt
    s_add_u32 s87, s87, 7
    s_add_u32 s39, s87, s88
    s_bfe_u32 s37, s39, 0x30000
    s_lshl_b32 s37, s37, 12
    s_add_u32 s85, s37, s89
    s_bfe_u32 s37, s39, 0x10003
    s_lshl_b32 s37, s37, 11
    s_add_u32 s85, s37, s85
    s_bfe_u32 s37, s39, 0x40004
    s_lshl_b32 s37, s37, 16
    s_add_u32 s85, s37, s85
    v_mfma_f32_16x16x32_bf16 v[112:115], v[224:227], v[80:83], 0
    v_mfma_f32_16x16x32_bf16 v[112:115], v[228:231], v[84:87], v[112:115]
    v_mfma_f32_16x16x32_bf16 v[112:115], v[232:235], v[88:91], v[112:115]
    v_mov_b32_dpp v122, v96 quad_perm:[0,0,0,0] row_mask:0xf bank_mask:0xf
    v_mov_b32_dpp v124, v98 quad_perm:[2,2,2,2] row_mask:0xf bank_mask:0xf
    s_nop 0
    v_add_f32_dpp v122, v97, v122 quad_perm:[1,1,1,1] row_mask:0xf bank_mask:0xf
    v_add_f32_dpp v124, v99, v124 quad_perm:[3,3,3,3] row_mask:0xf bank_mask:0xf
    v_add_f32 v122, v122, v124
    v_max_f32 v65, v65, v122
    ds_write_b32 v64, v122 offset:1280
    v_mfma_f32_16x16x32_bf16 v[112:115], v[236:239], v[92:95], v[112:115]
    s_waitcnt vmcnt(6)
    buffer_load_dwordx4 a[112:115], v76, s[52:55], s85 offen offset:0 nt
    v_mfma_f32_16x16x32_bf16 v[96:99], v[240:243], v[80:83], 0
    v_mfma_f32_16x16x32_bf16 v[96:99], v[244:247], v[84:87], v[96:99]
    v_mfma_f32_16x16x32_bf16 v[96:99], v[248:251], v[88:91], v[96:99]
    s_nop 2
    v_mov_b32_dpp v122, v112 quad_perm:[0,0,0,0] row_mask:0xf bank_mask:0xf
    v_mov_b32_dpp v124, v114 quad_perm:[2,2,2,2] row_mask:0xf bank_mask:0xf
    s_nop 0
    v_add_f32_dpp v122, v113, v122 quad_perm:[1,1,1,1] row_mask:0xf bank_mask:0xf
    v_add_f32_dpp v124, v115, v124 quad_perm:[3,3,3,3] row_mask:0xf bank_mask:0xf
    v_add_f32 v122, v122, v124
    v_max_f32 v65, v65, v122
    ds_write_b32 v64, v122 offset:1536
    v_mfma_f32_16x16x32_bf16 v[96:99], v[252:255], v[92:95], v[96:99]
    s_waitcnt vmcnt(6)
    buffer_load_dwordx4 a[116:119], v77, s[52:55], s85 offen offset:0 nt
    v_mfma_f32_16x16x32_bf16 v[112:115], a[0:3], v[80:83], 0
    v_mfma_f32_16x16x32_bf16 v[112:115], a[4:7], v[84:87], v[112:115]
    v_mfma_f32_16x16x32_bf16 v[112:115], a[8:11], v[88:91], v[112:115]
    s_nop 2
    v_mov_b32_dpp v122, v96 quad_perm:[0,0,0,0] row_mask:0xf bank_mask:0xf
    v_mov_b32_dpp v124, v98 quad_perm:[2,2,2,2] row_mask:0xf bank_mask:0xf
    s_nop 0
    v_add_f32_dpp v122, v97, v122 quad_perm:[1,1,1,1] row_mask:0xf bank_mask:0xf
    v_add_f32_dpp v124, v99, v124 quad_perm:[3,3,3,3] row_mask:0xf bank_mask:0xf
    v_add_f32 v122, v122, v124
    v_max_f32 v65, v65, v122
    ds_write_b32 v64, v122 offset:1792
    s_waitcnt vmcnt(6)
    buffer_load_dwordx4 a[120:123], v76, s[52:55], s85 offen offset:1024 nt
    v_mfma_f32_16x16x32_bf16 v[112:115], a[12:15], v[92:95], v[112:115]
    v_mfma_f32_16x16x32_bf16 v[96:99], a[16:19], v[80:83], 0
    v_mfma_f32_16x16x32_bf16 v[96:99], a[20:23], v[84:87], v[96:99]
    v_mfma_f32_16x16x32_bf16 v[96:99], a[24:27], v[88:91], v[96:99]
    s_nop 4
    v_mov_b32_dpp v122, v112 quad_perm:[0,0,0,0] row_mask:0xf bank_mask:0xf
    v_mov_b32_dpp v124, v114 quad_perm:[2,2,2,2] row_mask:0xf bank_mask:0xf
    s_nop 0
    v_add_f32_dpp v122, v113, v122 quad_perm:[1,1,1,1] row_mask:0xf bank_mask:0xf
    v_add_f32_dpp v124, v115, v124 quad_perm:[3,3,3,3] row_mask:0xf bank_mask:0xf
    v_add_f32 v122, v122, v124
    v_max_f32 v65, v65, v122
    ds_write_b32 v64, v122 offset:2048
    s_waitcnt vmcnt(6)
    buffer_load_dwordx4 a[124:127], v77, s[52:55], s85 offen offset:1024 nt
    s_add_u32 s87, s87, 7
    s_add_u32 s39, s87, s88
    s_bfe_u32 s37, s39, 0x30000
    s_lshl_b32 s37, s37, 12
    s_add_u32 s85, s37, s89
    s_bfe_u32 s37, s39, 0x10003
    s_lshl_b32 s37, s37, 11
    s_add_u32 s85, s37, s85
    s_bfe_u32 s37, s39, 0x40004
    s_lshl_b32 s37, s37, 16
    s_add_u32 s85, s37, s85
    v_mfma_f32_16x16x32_bf16 v[96:99], a[28:31], v[92:95], v[96:99]
    v_mfma_f32_16x16x32_bf16 v[112:115], a[32:35], v[80:83], 0
    s_bfe_u32 s38, s2, 0x20001
    s_lshl_b32 s38, s38, 0
    s_add_u32 s90, s38, 0
    s_bfe_u32 s38, s2, 0x10000
    s_lshl_b32 s38, s38, 2
    s_add_u32 s90, s38, s90
    s_and_b32 s36, s90, 3
    s_bitcmp0_b32 s90, 2
    s_cselect_b64 s[40:41], s[24:25], s[14:15]
    s_cselect_b32 s45, 262144, 0
    s_add_u32 s45, s45, 524288
    s_lshl_b32 s38, s36, 16
    s_add_u32 s71, s38, s45
    s_lshr_b32 s38, s32, 2
    s_lshl_b32 s38, s38, 13
    s_add_u32 s71, s38, s71
    s_bfe_u32 s38, s32, 0x20000
    s_lshl_b32 s38, s38, 6
    s_add_u32 s71, s38, s71
    s_mov_b32 s42, 4194304
    s_mov_b32 s43, 0x20000
    s_lshl_b32 s38, s32, 17
    s_add_u32 s44, s38, 0
    s_lshl_b32 s38, s34, 15
    s_add_u32 s44, s38, s44
    s_lshl_b32 s38, s36, 8
    s_add_u32 s44, s38, s44
    s_lshl_b32 s38, s36, 16
    s_add_u32 s45, s38, s45
    s_lshr_b32 s38, s34, 1
    s_lshl_b32 s38, s38, 15
    s_add_u32 s45, s38, s45
    s_lshl_b32 s38, s32, 8
    s_add_u32 s45, s38, s45
    s_bfe_u32 s38, s34, 0x10000
    s_lshl_b32 s38, s38, 7
    s_add_u32 s45, s38, s45
    s_lshl_b32 s38, s32, 11
    s_add_u32 s46, s38, 196608
    s_lshl_b32 s38, s34, 9
    s_add_u32 s46, s38, s46
    s_mov_b32 s72, s26
    s_and_b32 s73, s27, 0xffff
    s_mov_b32 s74, 8192
    s_mov_b32 s75, 0x20000
    v_mfma_f32_16x16x32_bf16 v[112:115], a[36:39], v[84:87], v[112:115]
    s_waitcnt vmcnt(5)
    buffer_load_dwordx4 v[128:131], v76, s[52:55], s85 offen offset:0 nt
    v_mfma_f32_16x16x32_bf16 v[112:115], a[40:43], v[88:91], v[112:115]
    v_mov_b32_dpp v122, v96 quad_perm:[0,0,0,0] row_mask:0xf bank_mask:0xf
    v_mov_b32_dpp v124, v98 quad_perm:[2,2,2,2] row_mask:0xf bank_mask:0xf
    s_nop 0
    v_add_f32_dpp v122, v97, v122 quad_perm:[1,1,1,1] row_mask:0xf bank_mask:0xf
    v_add_f32_dpp v124, v99, v124 quad_perm:[3,3,3,3] row_mask:0xf bank_mask:0xf
    v_add_f32 v122, v122, v124
    v_max_f32 v65, v65, v122
    ds_write_b32 v64, v122 offset:2304
    v_mfma_f32_16x16x32_bf16 v[112:115], a[44:47], v[92:95], v[112:115]
    v_mfma_f32_16x16x32_bf16 v[96:99], a[48:51], v[80:83], 0
    v_mfma_f32_16x16x32_bf16 v[96:99], a[52:55], v[84:87], v[96:99]
    s_waitcnt vmcnt(5)
    buffer_load_dwordx4 v[132:135], v77, s[52:55], s85 offen offset:0 nt
    v_mfma_f32_16x16x32_bf16 v[96:99], a[56:59], v[88:91], v[96:99]
    s_nop 2
    v_mov_b32_dpp v122, v112 quad_perm:[0,0,0,0] row_mask:0xf bank_mask:0xf
    v_mov_b32_dpp v124, v114 quad_perm:[2,2,2,2] row_mask:0xf bank_mask:0xf
    s_nop 0
    v_add_f32_dpp v122, v113, v122 quad_perm:[1,1,1,1] row_mask:0xf bank_mask:0xf
    v_add_f32_dpp v124, v115, v124 quad_perm:[3,3,3,3] row_mask:0xf bank_mask:0xf
    v_add_f32 v122, v122, v124
    v_max_f32 v65, v65, v122
    ds_write_b32 v64, v122 offset:2560
    v_lshlrev_b32 v4, 2, v2
    v_xor_b32 v4, v4, v3
    v_xor_b32 v5, 0, v4
    v_lshlrev_b32 v5, 4, v5
    v_lshl_add_u32 v20, v2, 10, v5
    v_xor_b32 v5, 1, v4
    v_lshlrev_b32 v5, 4, v5
    v_lshl_add_u32 v21, v2, 10, v5
    v_add_u32 v21, 3072, v21
    v_xor_b32 v5, 2, v4
    v_lshlrev_b32 v5, 4, v5
    v_lshl_add_u32 v22, v2, 10, v5
    v_add_u32 v22, 6144, v22
    v_xor_b32 v5, 3, v4
    v_lshlrev_b32 v5, 4, v5
    v_lshl_add_u32 v23, v2, 10, v5
    v_add_u32 v23, 9216, v23
    s_lshl_b32 s38, s32, 15
    s_add_u32 s47, s38, 1048576
    s_lshl_b32 s38, s3, 13
    s_add_u32 s47, s38, s47
    v_lshlrev_b32 v6, 7, v2
    v_bfe_u32 v5, v3, 0, 3
    v_lshl_add_u32 v6, v5, 4, v6
    v_lshrrev_b32 v4, 3, v3
    v_and_b32 v7, 3, v3
    v_min_u32 v7, 2, v7
    v_lshl_add_u32 v7, v7, 1, v4
    v_add_u32 v5, 0, v4
    v_cmp_le_u32 vcc, s33, v5
    s_nop 1
    v_addc_co_u32 v5, vcc, 0, v5, vcc
    v_lshl_add_u32 v50, v5, 10, v6
    v_add_u32 v5, 2, v4
    v_cmp_le_u32 vcc, s33, v5
    s_nop 1
    v_addc_co_u32 v5, vcc, 0, v5, vcc
    v_lshl_add_u32 v51, v5, 10, v6
    v_add_u32 v5, 4, v4
    v_cmp_le_u32 vcc, s33, v5
    s_nop 1
    v_addc_co_u32 v5, vcc, 0, v5, vcc
    v_lshl_add_u32 v52, v5, 10, v6
    v_mov_b32 v5, v7
    v_mov_b32 v6, 512
    v_cmp_le_u32 vcc, s33, v5
    s_nop 1
    v_addc_co_u32 v5, vcc, 0, v5, vcc
    v_lshl_add_u32 v53, v5, 10, v6
    s_mul_i32 s38, s3, 320
    s_add_u32 s38, s38, 135168
    v_lshlrev_b32 v4, 6, v2
    v_lshl_add_u32 v4, v3, 1, v4
    v_add_u32 v31, s38, v4
    v_mfma_f32_16x16x32_bf16 v[96:99], a[60:63], v[92:95], v[96:99]
    v_mfma_f32_16x16x32_bf16 v[112:115], a[64:67], v[80:83], 0
    s_waitcnt vmcnt(5)
    buffer_load_dwordx4 v[136:139], v76, s[52:55], s85 offen offset:1024 nt
    v_mfma_f32_16x16x32_bf16 v[112:115], a[68:71], v[84:87], v[112:115]
    v_mfma_f32_16x16x32_bf16 v[112:115], a[72:75], v[88:91], v[112:115]
    s_nop 2
    v_mov_b32_dpp v122, v96 quad_perm:[0,0,0,0] row_mask:0xf bank_mask:0xf
    v_mov_b32_dpp v124, v98 quad_perm:[2,2,2,2] row_mask:0xf bank_mask:0xf
    s_nop 0
    v_add_f32_dpp v122, v97, v122 quad_perm:[1,1,1,1] row_mask:0xf bank_mask:0xf
    v_add_f32_dpp v124, v99, v124 quad_perm:[3,3,3,3] row_mask:0xf bank_mask:0xf
    v_add_f32 v122, v122, v124
    v_max_f32 v65, v65, v122
    ds_write_b32 v64, v122 offset:2816
    v_mfma_f32_16x16x32_bf16 v[112:115], a[76:79], v[92:95], v[112:115]
    v_mfma_f32_16x16x32_bf16 v[96:99], a[80:83], v[80:83], 0
    v_lshlrev_b32 v4, 11, v2
    v_bfe_u32 v5, v1, 2, 2
    v_lshl_add_u32 v4, v5, 8, v4
    v_bfe_u32 v5, v1, 2, 2
    v_lshl_add_u32 v4, v5, 6, v4
    v_bfe_u32 v5, v1, 4, 1
    v_lshl_add_u32 v4, v5, 5, v4
    v_bfe_u32 v5, v1, 1, 1
    v_lshl_add_u32 v4, v5, 4, v4
    v_bfe_u32 v5, v1, 0, 1
    v_lshl_add_u32 v4, v5, 3, v4
    s_lshl_b32 s38, s34, 6
    s_add_u32 s38, s38, 98304
    v_xor_b32 v24, s38, v4
    v_xor_b32 v25, 16, v24
    v_xor_b32 v26, 32, v24
    v_xor_b32 v27, 48, v24
    v_and_b32 v4, 3, v3
    v_lshrrev_b32 v5, 2, v3
    v_lshlrev_b32 v6, 4, v2
    v_add_u32 v6, 135168, v6
    s_movk_i32 s36, 320
    v_cmp_eq_u32 vcc, 0, v5
    s_nop 1
    v_cndmask_b32 v28, 4, v4, vcc
    v_mad_u32_u24 v28, v28, s36, v6
    v_cmp_eq_u32 vcc, 1, v5
    s_nop 1
    v_cndmask_b32 v29, 4, v4, vcc
    v_mad_u32_u24 v29, v29, s36, v6
    v_lshlrev_b32 v5, 2, v1
    v_add_u32 v5, 136448, v5
    v_mov_b32 v6, 0
    ds_write_b32 v5, v6
    s_waitcnt vmcnt(5)
    buffer_load_dwordx4 v[140:143], v77, s[52:55], s85 offen offset:1024 nt
    s_add_u32 s87, s87, 7
    s_add_u32 s39, s87, s88
    s_bfe_u32 s37, s39, 0x30000
    s_lshl_b32 s37, s37, 12
    s_add_u32 s85, s37, s89
    s_bfe_u32 s37, s39, 0x10003
    s_lshl_b32 s37, s37, 11
    s_add_u32 s85, s37, s85
    s_bfe_u32 s37, s39, 0x40004
    s_lshl_b32 s37, s37, 16
    s_add_u32 s85, s37, s85
    v_mfma_f32_16x16x32_bf16 v[96:99], a[84:87], v[84:87], v[96:99]
    v_mfma_f32_16x16x32_bf16 v[96:99], a[88:91], v[88:91], v[96:99]
    v_mov_b32_dpp v122, v112 quad_perm:[0,0,0,0] row_mask:0xf bank_mask:0xf
    v_mov_b32_dpp v124, v114 quad_perm:[2,2,2,2] row_mask:0xf bank_mask:0xf
    s_nop 0
    v_add_f32_dpp v122, v113, v122 quad_perm:[1,1,1,1] row_mask:0xf bank_mask:0xf
    v_add_f32_dpp v124, v115, v124 quad_perm:[3,3,3,3] row_mask:0xf bank_mask:0xf
    v_add_f32 v122, v122, v124
    v_max_f32 v65, v65, v122
    ds_write_b32 v64, v122 offset:3072
    v_mfma_f32_16x16x32_bf16 v[96:99], a[92:95], v[92:95], v[96:99]
    s_waitcnt vmcnt(5)
    buffer_load_dwordx4 v[144:147], v76, s[52:55], s85 offen offset:0 nt
    v_mfma_f32_16x16x32_bf16 v[112:115], a[96:99], v[80:83], 0
    v_mfma_f32_16x16x32_bf16 v[112:115], a[100:103], v[84:87], v[112:115]
    v_mfma_f32_16x16x32_bf16 v[112:115], a[104:107], v[88:91], v[112:115]
    s_nop 2
    v_mov_b32_dpp v122, v96 quad_perm:[0,0,0,0] row_mask:0xf bank_mask:0xf
    v_mov_b32_dpp v124, v98 quad_perm:[2,2,2,2] row_mask:0xf bank_mask:0xf
    s_nop 0
    v_add_f32_dpp v122, v97, v122 quad_perm:[1,1,1,1] row_mask:0xf bank_mask:0xf
    v_add_f32_dpp v124, v99, v124 quad_perm:[3,3,3,3] row_mask:0xf bank_mask:0xf
    v_add_f32 v122, v122, v124
    v_max_f32 v65, v65, v122
    ds_write_b32 v64, v122 offset:3328
    v_lshlrev_b32 v30, 4, v3
    v_lshl_add_u32 v30, v2, 13, v30
    v_lshrrev_b32 v5, 2, v1
    v_lshlrev_b32 v32, 8, v5
    v_bfe_u32 v5, v1, 0, 2
    v_lshl_add_u32 v32, v5, 4, v32
    s_xor_b32 s37, s90, 4
    s_bfe_u32 s38, s37, 0x30000
    s_lshl_b32 s38, s38, 8
    s_add_u32 s36, s38, 0
    s_lshr_b32 s38, s32, 4
    s_lshl_b32 s38, s38, 7
    s_add_u32 s36, s38, s36
    s_bfe_u32 s38, s32, 0x20000
    s_lshl_b32 s38, s38, 5
    s_add_u32 s36, s38, s36
    s_bfe_u32 s38, s32, 0x20002
    s_lshl_b32 s38, s38, 3
    s_add_u32 s36, s38, s36
    v_bfe_u32 v5, v1, 0, 2
    v_lshlrev_b32 v33, 11, v5
    v_lshl_add_u32 v33, v2, 1, v33
    v_add_u32 v33, s36, v33
    v_and_b32 v5, 31, v1
    v_lshlrev_b32 v34, 4, v5
    s_mul_i32 s38, s34, 320
    s_add_u32 s38, s38, 135168
    v_lshl_add_u32 v35, v5, 3, s38
    s_bfe_u32 s38, s34, 0x10000
    s_lshl_b32 s38, s38, 12
    s_add_u32 s36, s38, s71
    s_lshr_b32 s38, s34, 1
    s_lshl_b32 s38, s38, 24
    s_add_u32 s36, s38, s36
    s_bitcmp1_b32 s90, 2
    s_cselect_b32 s46, s46, s36
    s_cselect_b64 vcc, -1, 0
    v_cndmask_b32 v54, v32, v34, vcc
    v_mfma_f32_16x16x32_bf16 v[112:115], a[108:111], v[92:95], v[112:115]
    s_waitcnt vmcnt(5)
    buffer_load_dwordx4 v[148:151], v77, s[52:55], s85 offen offset:0 nt
    v_mfma_f32_16x16x32_bf16 v[96:99], a[112:115], v[80:83], 0
    v_mfma_f32_16x16x32_bf16 v[96:99], a[116:119], v[84:87], v[96:99]
    v_mfma_f32_16x16x32_bf16 v[96:99], a[120:123], v[88:91], v[96:99]
    s_nop 2
    v_mov_b32_dpp v122, v112 quad_perm:[0,0,0,0] row_mask:0xf bank_mask:0xf
    v_mov_b32_dpp v124, v114 quad_perm:[2,2,2,2] row_mask:0xf bank_mask:0xf
    s_nop 0
    v_add_f32_dpp v122, v113, v122 quad_perm:[1,1,1,1] row_mask:0xf bank_mask:0xf
    v_add_f32_dpp v124, v115, v124 quad_perm:[3,3,3,3] row_mask:0xf bank_mask:0xf
    v_add_f32 v122, v122, v124
    v_max_f32 v65, v65, v122
    ds_write_b32 v64, v122 offset:3584
    v_mfma_f32_16x16x32_bf16 v[96:99], a[124:127], v[92:95], v[96:99]
    v_add_u32 v64, 3840, v64
    s_mov_b32 s97, 8
    s_mov_b32 s92, 7
    s_lshl_b32 s38, s32, 13
    s_add_u32 s80, s38, 3145728
    s_lshl_b32 s38, s3, 11
    s_add_u32 s80, s38, s80
    v_lshrrev_b32 v4, 2, v1
    v_lshlrev_b32 v55, 3, v4
    s_mov_b32 s66, 134217728
    s_mov_b32 s67, 0x20000
    s_mov_b64 s[64:65], s[52:53]
    v_mov_b32 v62, v76
    v_mov_b32 v63, v77
    s_branch L_bloop
L_ql:
    v_lshrrev_b32 v4, 2, v3
    v_and_b32 v5, 3, v3
    v_lshlrev_b32 v19, 6, v2
    v_lshl_add_u32 v19, v5, 4, v19
    v_lshl_add_u32 v14, v4, 18, v19
    s_and_b32 s61, s32, 28
    s_add_u32 s61, s61, s34
    s_and_b32 s60, s32, 3
    s_lshl_b32 s38, s60, 20
    s_add_u32 s63, s38, 0
    s_lshl_b32 s38, s61, 8
    s_add_u32 s63, s38, s63
    s_mov_b32 s74, 4194304
    s_mov_b32 s75, 0x20000
    s_waitcnt lgkmcnt(0)
    s_mov_b64 s[72:73], s[10:11]
    buffer_load_dwordx4 a[128:131], v14, s[72:75], s63 offen nt
    s_add_u32 s63, s63, 8192
    buffer_load_dwordx4 a[132:135], v14, s[72:75], s63 offen nt
    s_add_u32 s63, s63, 8192
    buffer_load_dwordx4 a[136:139], v14, s[72:75], s63 offen nt
    s_add_u32 s63, s63, 8192
    buffer_load_dwordx4 a[140:143], v14, s[72:75], s63 offen nt
    s_add_u32 s63, s63, 8192
    buffer_load_dwordx4 a[144:147], v14, s[72:75], s63 offen nt
    s_add_u32 s63, s63, 8192
    buffer_load_dwordx4 a[148:151], v14, s[72:75], s63 offen nt
    s_add_u32 s63, s63, 8192
    buffer_load_dwordx4 a[152:155], v14, s[72:75], s63 offen nt
    s_add_u32 s63, s63, 8192
    buffer_load_dwordx4 a[156:159], v14, s[72:75], s63 offen nt
    s_add_u32 s63, s63, 8192
    v_lshlrev_b32 v15, 1, v19
    v_lshl_add_u32 v15, v4, 9, v15
    v_lshl_add_u32 v19, v4, 15, v19
    s_load_dword s35, s[30:31], 0
    s_mov_b32 s48, s30
    s_and_b32 s49, s31, 0xffff
    s_mov_b32 s50, 8388608
    s_mov_b32 s51, 0x20000
    s_mov_b32 s82, 0xffffff00
    s_mov_b32 s83, 0x3e0293ee
    s_mov_b32 s84, 2097152
    s_lshl_b32 s38, s61, 12
    s_add_u32 s95, s38, 264192
    s_lshl_b32 s38, s61, 10
    s_add_u32 s94, s38, 393216
    s_lshl_b32 s38, s60, 8
    s_add_u32 s94, s38, s94
    s_waitcnt vmcnt(7)
    buffer_load_dwordx4 a[160:163], v14, s[72:75], s63 offen nt
    s_add_u32 s63, s63, 8192
    s_waitcnt vmcnt(7)
    buffer_load_dwordx4 a[164:167], v14, s[72:75], s63 offen nt
    s_add_u32 s63, s63, 8192
    s_waitcnt vmcnt(7)
    buffer_load_dwordx4 a[168:171], v14, s[72:75], s63 offen nt
    s_add_u32 s63, s63, 8192
    s_waitcnt vmcnt(7)
    buffer_load_dwordx4 a[172:175], v14, s[72:75], s63 offen nt
    s_add_u32 s63, s63, 8192
    s_waitcnt vmcnt(7)
    buffer_load_dwordx4 a[176:179], v14, s[72:75], s63 offen nt
    s_add_u32 s63, s63, 8192
    v_and_b32 v4, 1, v1
    v_lshlrev_b32 v4, 4, v4
    v_mov_b32 v5, 0xffff
    v_lshlrev_b32 v4, v4, v5
    v_bfe_u32 v5, v1, 1, 2
    v_cmp_eq_u32 vcc, 0, v5
    s_nop 1
    v_cndmask_b32 v10, 0, v4, vcc
    v_cmp_eq_u32 vcc, 1, v5
    s_nop 1
    v_cndmask_b32 v11, 0, v4, vcc
    v_cmp_eq_u32 vcc, 2, v5
    s_nop 1
    v_cndmask_b32 v12, 0, v4, vcc
    v_cmp_eq_u32 vcc, 3, v5
    s_nop 1
    v_cndmask_b32 v13, 0, v4, vcc
    s_waitcnt vmcnt(7)
    buffer_load_dwordx4 a[180:183], v14, s[72:75], s63 offen nt
    s_add_u32 s63, s63, 8192
    s_waitcnt vmcnt(7)
    buffer_load_dwordx4 a[184:187], v14, s[72:75], s63 offen nt
    s_add_u32 s63, s63, 8192
    s_waitcnt vmcnt(7)
    buffer_load_dwordx4 a[188:191], v14, s[72:75], s63 offen nt
    s_add_u32 s63, s63, 8192
    s_waitcnt vmcnt(7)
    buffer_load_dwordx4 a[192:195], v14, s[72:75], s63 offen nt
    s_add_u32 s63, s63, 8192
    v_lshrrev_b32 v4, 2, v3
    v_and_b32 v5, 3, v3
    v_lshlrev_b32 v76, 8, v4
    v_lshlrev_b32 v126, 8, v2
    v_lshl_add_u32 v76, v2, 6, v76
    v_lshl_add_u32 v76, v5, 4, v76
    v_lshl_add_u32 v126, v3, 4, v126
    v_xor_b32 v77, 32768, v76
    v_xor_b32 v127, 32768, v126
    s_add_u32 s3, s34, s33
    s_and_b32 s3, s3, 3
    s_lshl_b32 s89, s3, 5
    s_add_u32 s89, s89, s32
    s_lshl_b32 s89, s89, 20
    s_mul_i32 s88, s32, 8
    s_add_u32 s88, s88, s3
    s_lshl_b32 s87, s33, 0
    s_waitcnt vmcnt(7)
    buffer_load_dwordx4 a[196:199], v14, s[72:75], s63 offen nt
    s_add_u32 s63, s63, 8192
    s_waitcnt vmcnt(7)
    buffer_load_dwordx4 a[200:203], v14, s[72:75], s63 offen nt
    s_add_u32 s63, s63, 8192
    s_waitcnt vmcnt(7)
    buffer_load_dwordx4 a[204:207], v14, s[72:75], s63 offen nt
    s_add_u32 s63, s63, 8192
    s_waitcnt vmcnt(7)
    buffer_load_dwordx4 a[208:211], v14, s[72:75], s63 offen nt
    s_add_u32 s63, s63, 8192
    s_mov_b32 s52, s18
    s_and_b32 s53, s19, 0xffff
    s_mov_b32 s54, 134217728
    s_mov_b32 s55, 0x20000
    s_mov_b32 s56, s20
    s_and_b32 s57, s21, 0xffff
    s_mov_b32 s58, 134217728
    s_mov_b32 s59, 0x20000
    s_waitcnt vmcnt(7)
    buffer_load_dwordx4 a[212:215], v14, s[72:75], s63 offen nt
    s_add_u32 s63, s63, 8192
    s_waitcnt vmcnt(7)
    buffer_load_dwordx4 a[216:219], v14, s[72:75], s63 offen nt
    s_add_u32 s63, s63, 8192
    s_waitcnt vmcnt(7)
    buffer_load_dwordx4 a[220:223], v14, s[72:75], s63 offen nt
    s_add_u32 s63, s63, 8192
    s_waitcnt vmcnt(7)
    buffer_load_dwordx4 a[224:227], v14, s[72:75], s63 offen nt
    s_add_u32 s63, s63, 8192
    v_mov_b32 v120, 0xff7f0000
    v_mov_b32 v121, 0
    v_mov_b32 v18, 1
    v_mov_b32 v116, 0
    v_mov_b32 v117, 0
    v_mov_b32 v118, 0
    v_mov_b32 v119, 0
    v_lshlrev_b32 v0, 3, v1
    ds_write_b64 v0, v[116:117] offset:8192
    v_mov_b32 v0, 8192
    s_lshl_b32 s38, s32, 10
    s_add_u32 s96, s38, 65536
    s_lshr_b32 s38, s32, 3
    s_lshl_b32 s38, s38, 8
    s_add_u32 s96, s38, s96
    v_mov_b32 v9, s96
    s_lshl_b32 s38, s32, 15
    s_add_u32 s96, s38, 1048576
    s_lshl_b32 s38, s3, 13
    s_add_u32 s96, s38, s96
    s_lshl_b32 s38, s33, 10
    s_add_u32 s96, s38, s96
    v_and_b32 v5, 3, v3
    v_lshlrev_b32 v78, 7, v2
    v_lshl_add_u32 v78, v5, 5, v78
    s_lshl_b32 s38, s32, 12
    s_add_u32 s91, s38, 262144
    s_lshl_b32 s38, s3, 9
    s_add_u32 s91, s38, s91
    v_lshlrev_b32 v4, 7, v2
    v_lshl_add_u32 v4, v3, 4, v4
    v_mov_b32 v5, 512
    v_cmp_gt_u32 vcc, 8, v3
    s_nop 1
    v_cndmask_b32 v79, v5, v4, vcc
    s_waitcnt vmcnt(7)
    buffer_load_dwordx4 a[228:231], v14, s[72:75], s63 offen nt
    s_add_u32 s63, s63, 8192
    s_waitcnt vmcnt(7)
    buffer_load_dwordx4 a[232:235], v14, s[72:75], s63 offen nt
    s_add_u32 s63, s63, 8192
    s_waitcnt vmcnt(7)
    buffer_load_dwordx4 a[236:239], v14, s[72:75], s63 offen nt
    s_add_u32 s63, s63, 8192
    s_waitcnt vmcnt(7)
    buffer_load_dwordx4 a[240:243], v14, s[72:75], s63 offen nt
    s_add_u32 s63, s63, 8192
    s_waitcnt vmcnt(7)
    buffer_load_dwordx4 a[244:247], v14, s[72:75], s63 offen nt
    s_add_u32 s63, s63, 8192
    s_waitcnt vmcnt(7)
    buffer_load_dwordx4 a[248:251], v14, s[72:75], s63 offen nt
    s_add_u32 s63, s63, 8192
    s_waitcnt vmcnt(7)
    buffer_load_dwordx4 a[252:255], v14, s[72:75], s63 offen nt
    s_add_u32 s63, s63, 8192
    s_waitcnt lgkmcnt(0)
    s_add_u32 s35, s35, 0x5b
    s_and_b32 s35, s35, 0xff
    v_mov_b32 v8, s35
    s_or_b32 s68, s35, 0x6b3ac500
    s_waitcnt vmcnt(6)
    s_add_u32 s39, s87, s88
    s_bfe_u32 s37, s39, 0x30000
    s_lshl_b32 s37, s37, 12
    s_add_u32 s85, s37, s89
    s_bfe_u32 s37, s39, 0x10003
    s_lshl_b32 s37, s37, 11
    s_add_u32 s85, s37, s85
    s_bfe_u32 s37, s39, 0x40004
    s_lshl_b32 s37, s37, 16
    s_add_u32 s85, s37, s85
    buffer_load_dwordx4 v[128:131], v76, s[52:55], s85 offen offset:0 nt
    s_waitcnt vmcnt(6)
    buffer_load_dwordx4 v[132:135], v77, s[52:55], s85 offen offset:0 nt
    s_waitcnt vmcnt(6)
    buffer_load_dwordx4 v[136:139], v76, s[52:55], s85 offen offset:1024 nt
    s_waitcnt vmcnt(6)
    buffer_load_dwordx4 v[140:143], v77, s[52:55], s85 offen offset:1024 nt
    s_add_u32 s87, s87, 7
    s_add_u32 s39, s87, s88
    s_bfe_u32 s37, s39, 0x30000
    s_lshl_b32 s37, s37, 12
    s_add_u32 s85, s37, s89
    s_bfe_u32 s37, s39, 0x10003
    s_lshl_b32 s37, s37, 11
    s_add_u32 s85, s37, s85
    s_bfe_u32 s37, s39, 0x40004
    s_lshl_b32 s37, s37, 16
    s_add_u32 s85, s37, s85
    s_waitcnt vmcnt(6)
    buffer_load_dwordx4 v[144:147], v76, s[52:55], s85 offen offset:0 nt
    s_waitcnt vmcnt(6)
    buffer_load_dwordx4 v[148:151], v77, s[52:55], s85 offen offset:0 nt
    s_waitcnt vmcnt(6)
    buffer_load_dwordx4 v[152:155], v76, s[52:55], s85 offen offset:1024 nt
    s_waitcnt vmcnt(6)
    buffer_load_dwordx4 v[156:159], v77, s[52:55], s85 offen offset:1024 nt
    s_add_u32 s87, s87, 7
    s_add_u32 s39, s87, s88
    s_bfe_u32 s37, s39, 0x30000
    s_lshl_b32 s37, s37, 12
    s_add_u32 s85, s37, s89
    s_bfe_u32 s37, s39, 0x10003
    s_lshl_b32 s37, s37, 11
    s_add_u32 s85, s37, s85
    s_bfe_u32 s37, s39, 0x40004
    s_lshl_b32 s37, s37, 16
    s_add_u32 s85, s37, s85
    s_waitcnt vmcnt(6)
    buffer_load_dwordx4 v[160:163], v76, s[52:55], s85 offen offset:0 nt
    s_waitcnt vmcnt(6)
    buffer_load_dwordx4 v[164:167], v77, s[52:55], s85 offen offset:0 nt
    s_waitcnt vmcnt(6)
    buffer_load_dwordx4 v[168:171], v76, s[52:55], s85 offen offset:1024 nt
    s_waitcnt vmcnt(6)
    buffer_load_dwordx4 v[172:175], v77, s[52:55], s85 offen offset:1024 nt
    s_add_u32 s87, s87, 7
    s_add_u32 s39, s87, s88
    s_bfe_u32 s37, s39, 0x30000
    s_lshl_b32 s37, s37, 12
    s_add_u32 s85, s37, s89
    s_bfe_u32 s37, s39, 0x10003
    s_lshl_b32 s37, s37, 11
    s_add_u32 s85, s37, s85
    s_bfe_u32 s37, s39, 0x40004
    s_lshl_b32 s37, s37, 16
    s_add_u32 s85, s37, s85
    s_waitcnt vmcnt(6)
    buffer_load_dwordx4 v[176:179], v76, s[52:55], s85 offen offset:0 nt
    s_waitcnt vmcnt(6)
    buffer_load_dwordx4 v[180:183], v77, s[52:55], s85 offen offset:0 nt
    s_waitcnt vmcnt(6)
    buffer_load_dwordx4 v[184:187], v76, s[52:55], s85 offen offset:1024 nt
    s_waitcnt vmcnt(6)
    buffer_load_dwordx4 v[188:191], v77, s[52:55], s85 offen offset:1024 nt
    s_add_u32 s87, s87, 7
    s_add_u32 s39, s87, s88
    s_bfe_u32 s37, s39, 0x30000
    s_lshl_b32 s37, s37, 12
    s_add_u32 s85, s37, s89
    s_bfe_u32 s37, s39, 0x10003
    s_lshl_b32 s37, s37, 11
    s_add_u32 s85, s37, s85
    s_bfe_u32 s37, s39, 0x40004
    s_lshl_b32 s37, s37, 16
    s_add_u32 s85, s37, s85
    s_waitcnt vmcnt(6)
    buffer_load_dwordx4 v[192:195], v76, s[52:55], s85 offen offset:0 nt
    s_waitcnt vmcnt(6)
    buffer_load_dwordx4 v[196:199], v77, s[52:55], s85 offen offset:0 nt
    s_waitcnt vmcnt(6)
    buffer_load_dwordx4 v[200:203], v76, s[52:55], s85 offen offset:1024 nt
    s_waitcnt vmcnt(6)
    buffer_load_dwordx4 v[204:207], v77, s[52:55], s85 offen offset:1024 nt
    s_add_u32 s87, s87, 7
    s_add_u32 s39, s87, s88
    s_bfe_u32 s37, s39, 0x30000
    s_lshl_b32 s37, s37, 12
    s_add_u32 s85, s37, s89
    s_bfe_u32 s37, s39, 0x10003
    s_lshl_b32 s37, s37, 11
    s_add_u32 s85, s37, s85
    s_bfe_u32 s37, s39, 0x40004
    s_lshl_b32 s37, s37, 16
    s_add_u32 s85, s37, s85
    s_waitcnt vmcnt(6)
    buffer_load_dwordx4 v[208:211], v76, s[52:55], s85 offen offset:0 nt
    s_waitcnt vmcnt(6)
    buffer_load_dwordx4 v[212:215], v77, s[52:55], s85 offen offset:0 nt
    s_waitcnt vmcnt(6)
    buffer_load_dwordx4 v[216:219], v76, s[52:55], s85 offen offset:1024 nt
    s_waitcnt vmcnt(6)
    buffer_load_dwordx4 v[220:223], v77, s[52:55], s85 offen offset:1024 nt
    s_add_u32 s87, s87, 7
    s_add_u32 s39, s87, s88
    s_bfe_u32 s37, s39, 0x30000
    s_lshl_b32 s37, s37, 12
    s_add_u32 s85, s37, s89
    s_bfe_u32 s37, s39, 0x10003
    s_lshl_b32 s37, s37, 11
    s_add_u32 s85, s37, s85
    s_bfe_u32 s37, s39, 0x40004
    s_lshl_b32 s37, s37, 16
    s_add_u32 s85, s37, s85
    s_waitcnt vmcnt(6)
    buffer_load_dwordx4 v[224:227], v76, s[52:55], s85 offen offset:0 nt
    s_waitcnt vmcnt(6)
    buffer_load_dwordx4 v[228:231], v77, s[52:55], s85 offen offset:0 nt
    s_waitcnt vmcnt(6)
    buffer_load_dwordx4 v[232:235], v76, s[52:55], s85 offen offset:1024 nt
    s_waitcnt vmcnt(6)
    buffer_load_dwordx4 v[236:239], v77, s[52:55], s85 offen offset:1024 nt
    s_add_u32 s87, s87, 7
    s_add_u32 s39, s87, s88
    s_bfe_u32 s37, s39, 0x30000
    s_lshl_b32 s37, s37, 12
    s_add_u32 s85, s37, s89
    s_bfe_u32 s37, s39, 0x10003
    s_lshl_b32 s37, s37, 11
    s_add_u32 s85, s37, s85
    s_bfe_u32 s37, s39, 0x40004
    s_lshl_b32 s37, s37, 16
    s_add_u32 s85, s37, s85
    s_waitcnt vmcnt(6)
    buffer_load_dwordx4 v[240:243], v76, s[52:55], s85 offen offset:0 nt
    s_waitcnt vmcnt(6)
    buffer_load_dwordx4 v[244:247], v77, s[52:55], s85 offen offset:0 nt
    buffer_load_dwordx4 v[20:23], v15, s[48:51], s95 offen offset:0 sc1
    buffer_load_dwordx4 v[24:27], v15, s[48:51], s95 offen offset:16 sc1
    s_waitcnt vmcnt(8)
    buffer_load_dwordx4 v[248:251], v76, s[52:55], s85 offen offset:1024 nt
    s_waitcnt vmcnt(8)
    buffer_load_dwordx4 v[252:255], v77, s[52:55], s85 offen offset:1024 nt
    s_add_u32 s87, s87, 7
    s_add_u32 s39, s87, s88
    s_bfe_u32 s37, s39, 0x30000
    s_lshl_b32 s37, s37, 12
    s_add_u32 s85, s37, s89
    s_bfe_u32 s37, s39, 0x10003
    s_lshl_b32 s37, s37, 11
    s_add_u32 s85, s37, s85
    s_bfe_u32 s37, s39, 0x40004
    s_lshl_b32 s37, s37, 16
    s_add_u32 s85, s37, s85
    s_waitcnt vmcnt(8)
    buffer_load_dwordx4 a[0:3], v76, s[52:55], s85 offen offset:0 nt
    s_waitcnt vmcnt(8)
    buffer_load_dwordx4 a[4:7], v77, s[52:55], s85 offen offset:0 nt
    s_waitcnt vmcnt(8)
    buffer_load_dwordx4 a[8:11], v76, s[52:55], s85 offen offset:1024 nt
    s_waitcnt vmcnt(8)
    buffer_load_dwordx4 a[12:15], v77, s[52:55], s85 offen offset:1024 nt
    s_add_u32 s87, s87, 7
    s_add_u32 s39, s87, s88
    s_bfe_u32 s37, s39, 0x30000
    s_lshl_b32 s37, s37, 12
    s_add_u32 s85, s37, s89
    s_bfe_u32 s37, s39, 0x10003
    s_lshl_b32 s37, s37, 11
    s_add_u32 s85, s37, s85
    s_bfe_u32 s37, s39, 0x40004
    s_lshl_b32 s37, s37, 16
    s_add_u32 s85, s37, s85
    s_waitcnt vmcnt(6)
L_qacheck_41:
    v_xor_b32 v20, s35, v20
    v_xor_b32 v21, s35, v21
    v_xor_b32 v22, s35, v22
    v_xor_b32 v23, s35, v23
    v_xor_b32 v24, s35, v24
    v_xor_b32 v25, s35, v25
    v_xor_b32 v26, s35, v26
    v_xor_b32 v27, s35, v27
    v_or_b32 v4, v20, v21
    v_or3_b32 v4, v4, v22, v23
    v_or3_b32 v4, v4, v24, v25
    v_or3_b32 v4, v4, v26, v27
    v_and_b32 v4, 0xff, v4
    v_cmp_ne_u32 vcc, 0, v4
    s_cbranch_vccz L_qaok_42
    buffer_load_dwordx4 v[20:23], v15, s[48:51], s95 offen offset:0 sc1
    buffer_load_dwordx4 v[24:27], v15, s[48:51], s95 offen offset:16 sc1
    s_waitcnt vmcnt(0)
    s_sub_u32 s84, s84, 1
    s_cmp_lg_u32 s84, 0
    s_cbranch_scc1 L_qacheck_41
    s_branch L_end
L_qaok_42:
    buffer_load_dwordx4 v[68:71], v78, s[48:51], s91 offen offset:0 sc1
    buffer_load_dwordx4 v[72:75], v78, s[48:51], s91 offen offset:16 sc1
    v_cvt_pk_bf16_f32 v20, v20, v21
    v_cvt_pk_bf16_f32 v21, v22, v23
    v_cvt_pk_bf16_f32 v22, v24, v25
    v_cvt_pk_bf16_f32 v23, v26, v27
    s_nop 1
    v_mfma_f32_16x16x32_bf16 v[28:31], a[128:131], v[20:23], 0
    v_mfma_f32_16x16x32_bf16 v[32:35], a[132:135], v[20:23], 0
    v_mfma_f32_16x16x32_bf16 v[36:39], a[136:139], v[20:23], 0
    s_nop 5
    v_mov_b32_dpp v60, v28 quad_perm:[0,0,0,0] row_mask:0xf bank_mask:0xf
    v_mov_b32_dpp v4, v30 quad_perm:[2,2,2,2] row_mask:0xf bank_mask:0xf
    s_nop 0
    v_add_f32_dpp v60, v29, v60 quad_perm:[1,1,1,1] row_mask:0xf bank_mask:0xf
    v_add_f32_dpp v4, v31, v4 quad_perm:[3,3,3,3] row_mask:0xf bank_mask:0xf
    v_add_f32 v60, v60, v4
    v_mfma_f32_16x16x32_bf16 v[40:43], a[140:143], v[20:23], 0
    v_mov_b32_dpp v61, v32 quad_perm:[0,0,0,0] row_mask:0xf bank_mask:0xf
    v_mov_b32_dpp v4, v34 quad_perm:[2,2,2,2] row_mask:0xf bank_mask:0xf
    s_nop 0
    v_add_f32_dpp v61, v33, v61 quad_perm:[1,1,1,1] row_mask:0xf bank_mask:0xf
    v_add_f32_dpp v4, v35, v4 quad_perm:[3,3,3,3] row_mask:0xf bank_mask:0xf
    v_add_f32 v61, v61, v4
    v_cvt_pk_bf16_f32 v44, v60, v61
    v_mfma_f32_16x16x32_bf16 v[28:31], a[144:147], v[20:23], 0
    v_mov_b32_dpp v60, v36 quad_perm:[0,0,0,0] row_mask:0xf bank_mask:0xf
    v_mov_b32_dpp v4, v38 quad_perm:[2,2,2,2] row_mask:0xf bank_mask:0xf
    s_nop 0
    v_add_f32_dpp v60, v37, v60 quad_perm:[1,1,1,1] row_mask:0xf bank_mask:0xf
    v_add_f32_dpp v4, v39, v4 quad_perm:[3,3,3,3] row_mask:0xf bank_mask:0xf
    v_add_f32 v60, v60, v4
    buffer_load_dwordx4 a[16:19], v76, s[52:55], s85 offen offset:0 nt
    v_mfma_f32_16x16x32_bf16 v[32:35], a[148:151], v[20:23], 0
    v_mov_b32_dpp v61, v40 quad_perm:[0,0,0,0] row_mask:0xf bank_mask:0xf
    v_mov_b32_dpp v4, v42 quad_perm:[2,2,2,2] row_mask:0xf bank_mask:0xf
    s_nop 0
    v_add_f32_dpp v61, v41, v61 quad_perm:[1,1,1,1] row_mask:0xf bank_mask:0xf
    v_add_f32_dpp v4, v43, v4 quad_perm:[3,3,3,3] row_mask:0xf bank_mask:0xf
    v_add_f32 v61, v61, v4
    v_cvt_pk_bf16_f32 v45, v60, v61
    v_mfma_f32_16x16x32_bf16 v[36:39], a[152:155], v[20:23], 0
    v_mov_b32_dpp v60, v28 quad_perm:[0,0,0,0] row_mask:0xf bank_mask:0xf
    v_mov_b32_dpp v4, v30 quad_perm:[2,2,2,2] row_mask:0xf bank_mask:0xf
    s_nop 0
    v_add_f32_dpp v60, v29, v60 quad_perm:[1,1,1,1] row_mask:0xf bank_mask:0xf
    v_add_f32_dpp v4, v31, v4 quad_perm:[3,3,3,3] row_mask:0xf bank_mask:0xf
    v_add_f32 v60, v60, v4
    v_mfma_f32_16x16x32_bf16 v[40:43], a[156:159], v[20:23], 0
    v_mov_b32_dpp v61, v32 quad_perm:[0,0,0,0] row_mask:0xf bank_mask:0xf
    v_mov_b32_dpp v4, v34 quad_perm:[2,2,2,2] row_mask:0xf bank_mask:0xf
    s_nop 0
    v_add_f32_dpp v61, v33, v61 quad_perm:[1,1,1,1] row_mask:0xf bank_mask:0xf
    v_add_f32_dpp v4, v35, v4 quad_perm:[3,3,3,3] row_mask:0xf bank_mask:0xf
    v_add_f32 v61, v61, v4
    v_cvt_pk_bf16_f32 v46, v60, v61
    v_mfma_f32_16x16x32_bf16 v[28:31], a[160:163], v[20:23], 0
    v_mov_b32_dpp v60, v36 quad_perm:[0,0,0,0] row_mask:0xf bank_mask:0xf
    v_mov_b32_dpp v4, v38 quad_perm:[2,2,2,2] row_mask:0xf bank_mask:0xf
    s_nop 0
    v_add_f32_dpp v60, v37, v60 quad_perm:[1,1,1,1] row_mask:0xf bank_mask:0xf
    v_add_f32_dpp v4, v39, v4 quad_perm:[3,3,3,3] row_mask:0xf bank_mask:0xf
    v_add_f32 v60, v60, v4
    v_mfma_f32_16x16x32_bf16 v[32:35], a[164:167], v[20:23], 0
    v_mov_b32_dpp v61, v40 quad_perm:[0,0,0,0] row_mask:0xf bank_mask:0xf
    v_mov_b32_dpp v4, v42 quad_perm:[2,2,2,2] row_mask:0xf bank_mask:0xf
    s_nop 0
    v_add_f32_dpp v61, v41, v61 quad_perm:[1,1,1,1] row_mask:0xf bank_mask:0xf
    v_add_f32_dpp v4, v43, v4 quad_perm:[3,3,3,3] row_mask:0xf bank_mask:0xf
    v_add_f32 v61, v61, v4
    v_cvt_pk_bf16_f32 v47, v60, v61
    v_mfma_f32_16x16x32_bf16 v[36:39], a[168:171], v[20:23], 0
    v_mov_b32_dpp v60, v28 quad_perm:[0,0,0,0] row_mask:0xf bank_mask:0xf
    v_mov_b32_dpp v4, v30 quad_perm:[2,2,2,2] row_mask:0xf bank_mask:0xf
    s_nop 0
    v_add_f32_dpp v60, v29, v60 quad_perm:[1,1,1,1] row_mask:0xf bank_mask:0xf
    v_add_f32_dpp v4, v31, v4 quad_perm:[3,3,3,3] row_mask:0xf bank_mask:0xf
    v_add_f32 v60, v60, v4
    v_mfma_f32_16x16x32_bf16 v[40:43], a[172:175], v[20:23], 0
    v_mov_b32_dpp v61, v32 quad_perm:[0,0,0,0] row_mask:0xf bank_mask:0xf
    v_mov_b32_dpp v4, v34 quad_perm:[2,2,2,2] row_mask:0xf bank_mask:0xf
    s_nop 0
    v_add_f32_dpp v61, v33, v61 quad_perm:[1,1,1,1] row_mask:0xf bank_mask:0xf
    v_add_f32_dpp v4, v35, v4 quad_perm:[3,3,3,3] row_mask:0xf bank_mask:0xf
    v_add_f32 v61, v61, v4
    v_cvt_pk_bf16_f32 v48, v60, v61
    v_mfma_f32_16x16x32_bf16 v[28:31], a[176:179], v[20:23], 0
    v_mov_b32_dpp v60, v36 quad_perm:[0,0,0,0] row_mask:0xf bank_mask:0xf
    v_mov_b32_dpp v4, v38 quad_perm:[2,2,2,2] row_mask:0xf bank_mask:0xf
    s_nop 0
    v_add_f32_dpp v60, v37, v60 quad_perm:[1,1,1,1] row_mask:0xf bank_mask:0xf
    v_add_f32_dpp v4, v39, v4 quad_perm:[3,3,3,3] row_mask:0xf bank_mask:0xf
    v_add_f32 v60, v60, v4
    buffer_load_dwordx4 a[20:23], v77, s[52:55], s85 offen offset:0 nt
    v_mfma_f32_16x16x32_bf16 v[32:35], a[180:183], v[20:23], 0
    v_mov_b32_dpp v61, v40 quad_perm:[0,0,0,0] row_mask:0xf bank_mask:0xf
    v_mov_b32_dpp v4, v42 quad_perm:[2,2,2,2] row_mask:0xf bank_mask:0xf
    s_nop 0
    v_add_f32_dpp v61, v41, v61 quad_perm:[1,1,1,1] row_mask:0xf bank_mask:0xf
    v_add_f32_dpp v4, v43, v4 quad_perm:[3,3,3,3] row_mask:0xf bank_mask:0xf
    v_add_f32 v61, v61, v4
    v_cvt_pk_bf16_f32 v49, v60, v61
    v_mfma_f32_16x16x32_bf16 v[36:39], a[184:187], v[20:23], 0
    v_mov_b32_dpp v60, v28 quad_perm:[0,0,0,0] row_mask:0xf bank_mask:0xf
    v_mov_b32_dpp v4, v30 quad_perm:[2,2,2,2] row_mask:0xf bank_mask:0xf
    s_nop 0
    v_add_f32_dpp v60, v29, v60 quad_perm:[1,1,1,1] row_mask:0xf bank_mask:0xf
    v_add_f32_dpp v4, v31, v4 quad_perm:[3,3,3,3] row_mask:0xf bank_mask:0xf
    v_add_f32 v60, v60, v4
    v_mfma_f32_16x16x32_bf16 v[40:43], a[188:191], v[20:23], 0
    v_mov_b32_dpp v61, v32 quad_perm:[0,0,0,0] row_mask:0xf bank_mask:0xf
    v_mov_b32_dpp v4, v34 quad_perm:[2,2,2,2] row_mask:0xf bank_mask:0xf
    s_nop 0
    v_add_f32_dpp v61, v33, v61 quad_perm:[1,1,1,1] row_mask:0xf bank_mask:0xf
    v_add_f32_dpp v4, v35, v4 quad_perm:[3,3,3,3] row_mask:0xf bank_mask:0xf
    v_add_f32 v61, v61, v4
    v_cvt_pk_bf16_f32 v50, v60, v61
    v_mfma_f32_16x16x32_bf16 v[28:31], a[192:195], v[20:23], 0
    v_mov_b32_dpp v60, v36 quad_perm:[0,0,0,0] row_mask:0xf bank_mask:0xf
    v_mov_b32_dpp v4, v38 quad_perm:[2,2,2,2] row_mask:0xf bank_mask:0xf
    s_nop 0
    v_add_f32_dpp v60, v37, v60 quad_perm:[1,1,1,1] row_mask:0xf bank_mask:0xf
    v_add_f32_dpp v4, v39, v4 quad_perm:[3,3,3,3] row_mask:0xf bank_mask:0xf
    v_add_f32 v60, v60, v4
    v_mfma_f32_16x16x32_bf16 v[32:35], a[196:199], v[20:23], 0
    v_mov_b32_dpp v61, v40 quad_perm:[0,0,0,0] row_mask:0xf bank_mask:0xf
    v_mov_b32_dpp v4, v42 quad_perm:[2,2,2,2] row_mask:0xf bank_mask:0xf
    s_nop 0
    v_add_f32_dpp v61, v41, v61 quad_perm:[1,1,1,1] row_mask:0xf bank_mask:0xf
    v_add_f32_dpp v4, v43, v4 quad_perm:[3,3,3,3] row_mask:0xf bank_mask:0xf
    v_add_f32 v61, v61, v4
    v_cvt_pk_bf16_f32 v51, v60, v61
    v_mfma_f32_16x16x32_bf16 v[36:39], a[200:203], v[20:23], 0
    v_mov_b32_dpp v60, v28 quad_perm:[0,0,0,0] row_mask:0xf bank_mask:0xf
    v_mov_b32_dpp v4, v30 quad_perm:[2,2,2,2] row_mask:0xf bank_mask:0xf
    s_nop 0
    v_add_f32_dpp v60, v29, v60 quad_perm:[1,1,1,1] row_mask:0xf bank_mask:0xf
    v_add_f32_dpp v4, v31, v4 quad_perm:[3,3,3,3] row_mask:0xf bank_mask:0xf
    v_add_f32 v60, v60, v4
    v_mfma_f32_16x16x32_bf16 v[40:43], a[204:207], v[20:23], 0
    v_mov_b32_dpp v61, v32 quad_perm:[0,0,0,0] row_mask:0xf bank_mask:0xf
    v_mov_b32_dpp v4, v34 quad_perm:[2,2,2,2] row_mask:0xf bank_mask:0xf
    s_nop 0
    v_add_f32_dpp v61, v33, v61 quad_perm:[1,1,1,1] row_mask:0xf bank_mask:0xf
    v_add_f32_dpp v4, v35, v4 quad_perm:[3,3,3,3] row_mask:0xf bank_mask:0xf
    v_add_f32 v61, v61, v4
    v_cvt_pk_bf16_f32 v52, v60, v61
    v_mfma_f32_16x16x32_bf16 v[28:31], a[208:211], v[20:23], 0
    v_mov_b32_dpp v60, v36 quad_perm:[0,0,0,0] row_mask:0xf bank_mask:0xf
    v_mov_b32_dpp v4, v38 quad_perm:[2,2,2,2] row_mask:0xf bank_mask:0xf
    s_nop 0
    v_add_f32_dpp v60, v37, v60 quad_perm:[1,1,1,1] row_mask:0xf bank_mask:0xf
    v_add_f32_dpp v4, v39, v4 quad_perm:[3,3,3,3] row_mask:0xf bank_mask:0xf
    v_add_f32 v60, v60, v4
    buffer_load_dwordx4 a[24:27], v76, s[52:55], s85 offen offset:1024 nt
    v_mfma_f32_16x16x32_bf16 v[32:35], a[212:215], v[20:23], 0
    v_mov_b32_dpp v61, v40 quad_perm:[0,0,0,0] row_mask:0xf bank_mask:0xf
    v_mov_b32_dpp v4, v42 quad_perm:[2,2,2,2] row_mask:0xf bank_mask:0xf
    s_nop 0
    v_add_f32_dpp v61, v41, v61 quad_perm:[1,1,1,1] row_mask:0xf bank_mask:0xf
    v_add_f32_dpp v4, v43, v4 quad_perm:[3,3,3,3] row_mask:0xf bank_mask:0xf
    v_add_f32 v61, v61, v4
    v_cvt_pk_bf16_f32 v53, v60, v61
    v_mfma_f32_16x16x32_bf16 v[36:39], a[216:219], v[20:23], 0
    v_mov_b32_dpp v60, v28 quad_perm:[0,0,0,0] row_mask:0xf bank_mask:0xf
    v_mov_b32_dpp v4, v30 quad_perm:[2,2,2,2] row_mask:0xf bank_mask:0xf
    s_nop 0
    v_add_f32_dpp v60, v29, v60 quad_perm:[1,1,1,1] row_mask:0xf bank_mask:0xf
    v_add_f32_dpp v4, v31, v4 quad_perm:[3,3,3,3] row_mask:0xf bank_mask:0xf
    v_add_f32 v60, v60, v4
    v_mfma_f32_16x16x32_bf16 v[40:43], a[220:223], v[20:23], 0
    v_mov_b32_dpp v61, v32 quad_perm:[0,0,0,0] row_mask:0xf bank_mask:0xf
    v_mov_b32_dpp v4, v34 quad_perm:[2,2,2,2] row_mask:0xf bank_mask:0xf
    s_nop 0
    v_add_f32_dpp v61, v33, v61 quad_perm:[1,1,1,1] row_mask:0xf bank_mask:0xf
    v_add_f32_dpp v4, v35, v4 quad_perm:[3,3,3,3] row_mask:0xf bank_mask:0xf
    v_add_f32 v61, v61, v4
    v_cvt_pk_bf16_f32 v54, v60, v61
    v_mfma_f32_16x16x32_bf16 v[28:31], a[224:227], v[20:23], 0
    v_mov_b32_dpp v60, v36 quad_perm:[0,0,0,0] row_mask:0xf bank_mask:0xf
    v_mov_b32_dpp v4, v38 quad_perm:[2,2,2,2] row_mask:0xf bank_mask:0xf
    s_nop 0
    v_add_f32_dpp v60, v37, v60 quad_perm:[1,1,1,1] row_mask:0xf bank_mask:0xf
    v_add_f32_dpp v4, v39, v4 quad_perm:[3,3,3,3] row_mask:0xf bank_mask:0xf
    v_add_f32 v60, v60, v4
    v_mfma_f32_16x16x32_bf16 v[32:35], a[228:231], v[20:23], 0
    v_mov_b32_dpp v61, v40 quad_perm:[0,0,0,0] row_mask:0xf bank_mask:0xf
    v_mov_b32_dpp v4, v42 quad_perm:[2,2,2,2] row_mask:0xf bank_mask:0xf
    s_nop 0
    v_add_f32_dpp v61, v41, v61 quad_perm:[1,1,1,1] row_mask:0xf bank_mask:0xf
    v_add_f32_dpp v4, v43, v4 quad_perm:[3,3,3,3] row_mask:0xf bank_mask:0xf
    v_add_f32 v61, v61, v4
    v_cvt_pk_bf16_f32 v55, v60, v61
    v_mfma_f32_16x16x32_bf16 v[36:39], a[232:235], v[20:23], 0
    v_mov_b32_dpp v60, v28 quad_perm:[0,0,0,0] row_mask:0xf bank_mask:0xf
    v_mov_b32_dpp v4, v30 quad_perm:[2,2,2,2] row_mask:0xf bank_mask:0xf
    s_nop 0
    v_add_f32_dpp v60, v29, v60 quad_perm:[1,1,1,1] row_mask:0xf bank_mask:0xf
    v_add_f32_dpp v4, v31, v4 quad_perm:[3,3,3,3] row_mask:0xf bank_mask:0xf
    v_add_f32 v60, v60, v4
    v_mfma_f32_16x16x32_bf16 v[40:43], a[236:239], v[20:23], 0
    v_mov_b32_dpp v61, v32 quad_perm:[0,0,0,0] row_mask:0xf bank_mask:0xf
    v_mov_b32_dpp v4, v34 quad_perm:[2,2,2,2] row_mask:0xf bank_mask:0xf
    s_nop 0
    v_add_f32_dpp v61, v33, v61 quad_perm:[1,1,1,1] row_mask:0xf bank_mask:0xf
    v_add_f32_dpp v4, v35, v4 quad_perm:[3,3,3,3] row_mask:0xf bank_mask:0xf
    v_add_f32 v61, v61, v4
    v_cvt_pk_bf16_f32 v56, v60, v61
    v_mfma_f32_16x16x32_bf16 v[28:31], a[240:243], v[20:23], 0
    v_mov_b32_dpp v60, v36 quad_perm:[0,0,0,0] row_mask:0xf bank_mask:0xf
    v_mov_b32_dpp v4, v38 quad_perm:[2,2,2,2] row_mask:0xf bank_mask:0xf
    s_nop 0
    v_add_f32_dpp v60, v37, v60 quad_perm:[1,1,1,1] row_mask:0xf bank_mask:0xf
    v_add_f32_dpp v4, v39, v4 quad_perm:[3,3,3,3] row_mask:0xf bank_mask:0xf
    v_add_f32 v60, v60, v4
    buffer_load_dwordx4 a[28:31], v77, s[52:55], s85 offen offset:1024 nt
    s_add_u32 s87, s87, 7
    s_add_u32 s39, s87, s88
    s_bfe_u32 s37, s39, 0x30000
    s_lshl_b32 s37, s37, 12
    s_add_u32 s85, s37, s89
    s_bfe_u32 s37, s39, 0x10003
    s_lshl_b32 s37, s37, 11
    s_add_u32 s85, s37, s85
    s_bfe_u32 s37, s39, 0x40004
    s_lshl_b32 s37, s37, 16
    s_add_u32 s85, s37, s85
    v_mfma_f32_16x16x32_bf16 v[32:35], a[244:247], v[20:23], 0
    v_mov_b32_dpp v61, v40 quad_perm:[0,0,0,0] row_mask:0xf bank_mask:0xf
    v_mov_b32_dpp v4, v42 quad_perm:[2,2,2,2] row_mask:0xf bank_mask:0xf
    s_nop 0
    v_add_f32_dpp v61, v41, v61 quad_perm:[1,1,1,1] row_mask:0xf bank_mask:0xf
    v_add_f32_dpp v4, v43, v4 quad_perm:[3,3,3,3] row_mask:0xf bank_mask:0xf
    v_add_f32 v61, v61, v4
    v_cvt_pk_bf16_f32 v57, v60, v61
    v_mfma_f32_16x16x32_bf16 v[36:39], a[248:251], v[20:23], 0
    v_mov_b32_dpp v60, v28 quad_perm:[0,0,0,0] row_mask:0xf bank_mask:0xf
    v_mov_b32_dpp v4, v30 quad_perm:[2,2,2,2] row_mask:0xf bank_mask:0xf
    s_nop 0
    v_add_f32_dpp v60, v29, v60 quad_perm:[1,1,1,1] row_mask:0xf bank_mask:0xf
    v_add_f32_dpp v4, v31, v4 quad_perm:[3,3,3,3] row_mask:0xf bank_mask:0xf
    v_add_f32 v60, v60, v4
    v_mfma_f32_16x16x32_bf16 v[40:43], a[252:255], v[20:23], 0
    v_mov_b32_dpp v61, v32 quad_perm:[0,0,0,0] row_mask:0xf bank_mask:0xf
    v_mov_b32_dpp v4, v34 quad_perm:[2,2,2,2] row_mask:0xf bank_mask:0xf
    s_nop 0
    v_add_f32_dpp v61, v33, v61 quad_perm:[1,1,1,1] row_mask:0xf bank_mask:0xf
    v_add_f32_dpp v4, v35, v4 quad_perm:[3,3,3,3] row_mask:0xf bank_mask:0xf
    v_add_f32 v61, v61, v4
    v_cvt_pk_bf16_f32 v58, v60, v61
    v_mov_b32_dpp v60, v36 quad_perm:[0,0,0,0] row_mask:0xf bank_mask:0xf
    v_mov_b32_dpp v4, v38 quad_perm:[2,2,2,2] row_mask:0xf bank_mask:0xf
    s_nop 0
    v_add_f32_dpp v60, v37, v60 quad_perm:[1,1,1,1] row_mask:0xf bank_mask:0xf
    v_add_f32_dpp v4, v39, v4 quad_perm:[3,3,3,3] row_mask:0xf bank_mask:0xf
    v_add_f32 v60, v60, v4
    v_mov_b32_dpp v61, v40 quad_perm:[0,0,0,0] row_mask:0xf bank_mask:0xf
    v_mov_b32_dpp v4, v42 quad_perm:[2,2,2,2] row_mask:0xf bank_mask:0xf
    s_nop 0
    v_add_f32_dpp v61, v41, v61 quad_perm:[1,1,1,1] row_mask:0xf bank_mask:0xf
    v_add_f32_dpp v4, v43, v4 quad_perm:[3,3,3,3] row_mask:0xf bank_mask:0xf
    v_add_f32 v61, v61, v4
    v_cvt_pk_bf16_f32 v59, v60, v61
    s_mov_b32 exec_lo, 0x22222222
    s_mov_b32 exec_hi, 0x22222222
    v_mov_b32 v44, v48
    v_mov_b32 v45, v49
    v_mov_b32 v46, v50
    v_mov_b32 v47, v51
    s_mov_b32 exec_lo, 0x44444444
    s_mov_b32 exec_hi, 0x44444444
    v_mov_b32 v44, v52
    v_mov_b32 v45, v53
    v_mov_b32 v46, v54
    v_mov_b32 v47, v55
    s_mov_b32 exec_lo, 0x88888888
    s_mov_b32 exec_hi, 0x88888888
    v_mov_b32 v44, v56
    v_mov_b32 v45, v57
    v_mov_b32 v46, v58
    v_mov_b32 v47, v59
    s_mov_b64 exec, -1
    buffer_store_dwordx4 v[44:47], v19, s[48:51], s94 offen sc1
    s_waitcnt vmcnt(5)
L_qcheck_43:
    v_xor_b32 v68, s35, v68
    v_xor_b32 v69, s35, v69
    v_xor_b32 v70, s35, v70
    v_xor_b32 v71, s35, v71
    v_xor_b32 v72, s35, v72
    v_xor_b32 v73, s35, v73
    v_xor_b32 v74, s35, v74
    v_xor_b32 v75, s35, v75
    v_or_b32 v4, v68, v69
    v_or3_b32 v4, v4, v70, v71
    v_or3_b32 v4, v4, v72, v73
    v_or3_b32 v4, v4, v74, v75
    v_and_b32 v4, 0xff, v4
    v_cmp_ne_u32 vcc, 0, v4
    s_cbranch_vccz L_qok_44
    buffer_load_dwordx4 v[68:71], v78, s[48:51], s91 offen offset:0 sc1
    buffer_load_dwordx4 v[72:75], v78, s[48:51], s91 offen offset:16 sc1
    s_waitcnt vmcnt(0)
    s_sub_u32 s84, s84, 1
    s_cmp_lg_u32 s84, 0
    s_cbranch_scc1 L_qcheck_43
    s_branch L_end
L_qok_44:
    v_cvt_pk_bf16_f32 v68, v68, v69
    v_cvt_pk_bf16_f32 v69, v70, v71
    v_cvt_pk_bf16_f32 v70, v72, v73
    v_cvt_pk_bf16_f32 v71, v74, v75
    s_mov_b32 vcc_lo, 0xf000f
    s_mov_b32 vcc_hi, 0xf000f
    v_cndmask_b32 v80, 0, v68, vcc
    v_cndmask_b32 v81, 0, v69, vcc
    v_cndmask_b32 v82, 0, v70, vcc
    v_cndmask_b32 v83, 0, v71, vcc
    s_mov_b32 vcc_lo, 0xf000f0
    s_mov_b32 vcc_hi, 0xf000f0
    v_cndmask_b32 v84, 0, v68, vcc
    v_cndmask_b32 v85, 0, v69, vcc
    v_cndmask_b32 v86, 0, v70, vcc
    v_cndmask_b32 v87, 0, v71, vcc
    s_mov_b32 vcc_lo, 0xf000f00
    s_mov_b32 vcc_hi, 0xf000f00
    v_cndmask_b32 v88, 0, v68, vcc
    v_cndmask_b32 v89, 0, v69, vcc
    v_cndmask_b32 v90, 0, v70, vcc
    v_cndmask_b32 v91, 0, v71, vcc
    s_mov_b32 vcc_lo, 0xf000f000
    s_mov_b32 vcc_hi, 0xf000f000
    v_cndmask_b32 v92, 0, v68, vcc
    v_cndmask_b32 v93, 0, v69, vcc
    v_cndmask_b32 v94, 0, v70, vcc
    v_cndmask_b32 v95, 0, v71, vcc
    s_getreg_b32 s70, hwreg(HW_REG_XCC_ID, 0, 4)
    s_lshl_b32 s70, s70, 8
    s_or_b32 s70, s70, s35
    s_or_b32 s70, s70, 0x5e9d0000
    s_bfe_u32 s38, s2, 0x30000
    s_lshl_b32 s38, s38, 8
    s_add_u32 s69, s38, 32768
    s_lshl_b32 s38, s32, 2
    s_add_u32 s69, s38, s69
    s_lshl_b32 s38, s34, 24
    s_add_u32 s69, s38, s69
    v_mov_b32 v72, s69
    v_mov_b32 v73, s70
    s_mov_b64 exec, 1
    buffer_store_dword v73, v72, s[48:51], 0 offen sc1
    s_mov_b64 exec, -1
    v_mov_b32 v65, 0xff7f0000
    s_lshl_b32 s38, s34, 14
    s_add_u32 s38, s38, 16384
    v_lshl_add_u32 v64, v1, 2, s38
    buffer_load_dwordx4 a[32:35], v76, s[52:55], s85 offen offset:0 nt
    v_mfma_f32_16x16x32_bf16 v[112:115], v[128:131], v[80:83], 0
    v_mfma_f32_16x16x32_bf16 v[112:115], v[132:135], v[84:87], v[112:115]
    buffer_load_dwordx4 a[36:39], v77, s[52:55], s85 offen offset:0 nt
    v_mfma_f32_16x16x32_bf16 v[112:115], v[136:139], v[88:91], v[112:115]
    v_mfma_f32_16x16x32_bf16 v[112:115], v[140:143], v[92:95], v[112:115]
    buffer_load_dwordx4 a[40:43], v76, s[52:55], s85 offen offset:1024 nt
    v_mfma_f32_16x16x32_bf16 v[96:99], v[144:147], v[80:83], 0
    v_mfma_f32_16x16x32_bf16 v[96:99], v[148:151], v[84:87], v[96:99]
    s_waitcnt vmcnt(8)
    buffer_load_dwordx4 a[44:47], v77, s[52:55], s85 offen offset:1024 nt
    s_add_u32 s87, s87, 7
    s_add_u32 s39, s87, s88
    s_bfe_u32 s37, s39, 0x30000
    s_lshl_b32 s37, s37, 12
    s_add_u32 s85, s37, s89
    s_bfe_u32 s37, s39, 0x10003
    s_lshl_b32 s37, s37, 11
    s_add_u32 s85, s37, s85
    s_bfe_u32 s37, s39, 0x40004
    s_lshl_b32 s37, s37, 16
    s_add_u32 s85, s37, s85
    v_mfma_f32_16x16x32_bf16 v[96:99], v[152:155], v[88:91], v[96:99]
    v_mov_b32_dpp v122, v112 quad_perm:[0,0,0,0] row_mask:0xf bank_mask:0xf
    v_mov_b32_dpp v124, v114 quad_perm:[2,2,2,2] row_mask:0xf bank_mask:0xf
    s_nop 0
    v_add_f32_dpp v122, v113, v122 quad_perm:[1,1,1,1] row_mask:0xf bank_mask:0xf
    v_add_f32_dpp v124, v115, v124 quad_perm:[3,3,3,3] row_mask:0xf bank_mask:0xf
    v_add_f32 v122, v122, v124
    v_max_f32 v65, v65, v122
    ds_write_b32 v64, v122 offset:0
    v_mfma_f32_16x16x32_bf16 v[96:99], v[156:159], v[92:95], v[96:99]
    s_waitcnt vmcnt(8)
    buffer_load_dwordx4 a[48:51], v76, s[52:55], s85 offen offset:0 nt
    v_mfma_f32_16x16x32_bf16 v[112:115], v[160:163], v[80:83], 0
    v_mfma_f32_16x16x32_bf16 v[112:115], v[164:167], v[84:87], v[112:115]
    s_waitcnt vmcnt(8)
    buffer_load_dwordx4 a[52:55], v77, s[52:55], s85 offen offset:0 nt
    v_mfma_f32_16x16x32_bf16 v[112:115], v[168:171], v[88:91], v[112:115]
    s_nop 0
    v_mov_b32_dpp v122, v96 quad_perm:[0,0,0,0] row_mask:0xf bank_mask:0xf
    v_mov_b32_dpp v124, v98 quad_perm:[2,2,2,2] row_mask:0xf bank_mask:0xf
    s_nop 0
    v_add_f32_dpp v122, v97, v122 quad_perm:[1,1,1,1] row_mask:0xf bank_mask:0xf
    v_add_f32_dpp v124, v99, v124 quad_perm:[3,3,3,3] row_mask:0xf bank_mask:0xf
    v_add_f32 v122, v122, v124
    v_max_f32 v65, v65, v122
    ds_write_b32 v64, v122 offset:256
    v_mfma_f32_16x16x32_bf16 v[112:115], v[172:175], v[92:95], v[112:115]
    s_waitcnt vmcnt(8)
    buffer_load_dwordx4 a[56:59], v76, s[52:55], s85 offen offset:1024 nt
    v_mfma_f32_16x16x32_bf16 v[96:99], v[176:179], v[80:83], 0
    v_mfma_f32_16x16x32_bf16 v[96:99], v[180:183], v[84:87], v[96:99]
    s_waitcnt vmcnt(6)
    buffer_load_dwordx4 a[60:63], v77, s[52:55], s85 offen offset:1024 nt
    s_add_u32 s87, s87, 7
    s_add_u32 s39, s87, s88
    s_bfe_u32 s37, s39, 0x30000
    s_lshl_b32 s37, s37, 12
    s_add_u32 s85, s37, s89
    s_bfe_u32 s37, s39, 0x10003
    s_lshl_b32 s37, s37, 11
    s_add_u32 s85, s37, s85
    s_bfe_u32 s37, s39, 0x40004
    s_lshl_b32 s37, s37, 16
    s_add_u32 s85, s37, s85
    v_mfma_f32_16x16x32_bf16 v[96:99], v[184:187], v[88:91], v[96:99]
    v_mov_b32_dpp v122, v112 quad_perm:[0,0,0,0] row_mask:0xf bank_mask:0xf
    v_mov_b32_dpp v124, v114 quad_perm:[2,2,2,2] row_mask:0xf bank_mask:0xf
    s_nop 0
    v_add_f32_dpp v122, v113, v122 quad_perm:[1,1,1,1] row_mask:0xf bank_mask:0xf
    v_add_f32_dpp v124, v115, v124 quad_perm:[3,3,3,3] row_mask:0xf bank_mask:0xf
    v_add_f32 v122, v122, v124
    v_max_f32 v65, v65, v122
    ds_write_b32 v64, v122 offset:512
    s_lshl_b32 s38, s32, 8
    s_add_u32 s69, s38, 98304
    s_lshl_b32 s38, s34, 23
    s_add_u32 s69, s38, s69
    v_mov_b32 v48, s69
    v_mov_b32 v49, s68
    s_barrier
    s_mov_b64 exec, 1
    buffer_store_dword v49, v48, s[48:51], 0 offen sc1
    s_mov_b64 exec, -1
    v_mfma_f32_16x16x32_bf16 v[96:99], v[188:191], v[92:95], v[96:99]
    v_mfma_f32_16x16x32_bf16 v[112:115], v[192:195], v[80:83], 0
    s_waitcnt vmcnt(7)
    buffer_load_dwordx4 a[64:67], v76, s[52:55], s85 offen offset:0 nt
    v_mfma_f32_16x16x32_bf16 v[112:115], v[196:199], v[84:87], v[112:115]
    v_mfma_f32_16x16x32_bf16 v[112:115], v[200:203], v[88:91], v[112:115]
    s_nop 2
    v_mov_b32_dpp v122, v96 quad_perm:[0,0,0,0] row_mask:0xf bank_mask:0xf
    v_mov_b32_dpp v124, v98 quad_perm:[2,2,2,2] row_mask:0xf bank_mask:0xf
    s_nop 0
    v_add_f32_dpp v122, v97, v122 quad_perm:[1,1,1,1] row_mask:0xf bank_mask:0xf
    v_add_f32_dpp v124, v99, v124 quad_perm:[3,3,3,3] row_mask:0xf bank_mask:0xf
    v_add_f32 v122, v122, v124
    v_max_f32 v65, v65, v122
    ds_write_b32 v64, v122 offset:768
    s_waitcnt vmcnt(7)
    buffer_load_dwordx4 a[68:71], v77, s[52:55], s85 offen offset:0 nt
    v_mfma_f32_16x16x32_bf16 v[112:115], v[204:207], v[92:95], v[112:115]
    v_mfma_f32_16x16x32_bf16 v[96:99], v[208:211], v[80:83], 0
    s_waitcnt vmcnt(7)
    buffer_load_dwordx4 a[72:75], v76, s[52:55], s85 offen offset:1024 nt
    v_mfma_f32_16x16x32_bf16 v[96:99], v[212:215], v[84:87], v[96:99]
    v_mfma_f32_16x16x32_bf16 v[96:99], v[216:219], v[88:91], v[96:99]
    s_nop 2
    v_mov_b32_dpp v122, v112 quad_perm:[0,0,0,0] row_mask:0xf bank_mask:0xf
    v_mov_b32_dpp v124, v114 quad_perm:[2,2,2,2] row_mask:0xf bank_mask:0xf
    s_nop 0
    v_add_f32_dpp v122, v113, v122 quad_perm:[1,1,1,1] row_mask:0xf bank_mask:0xf
    v_add_f32_dpp v124, v115, v124 quad_perm:[3,3,3,3] row_mask:0xf bank_mask:0xf
    v_add_f32 v122, v122, v124
    v_max_f32 v65, v65, v122
    ds_write_b32 v64, v122 offset:1024
    s_waitcnt vmcnt(7)
    buffer_load_dwordx4 a[76:79], v77, s[52:55], s85 offen offset:1024 nt
    s_add_u32 s87, s87, 7
    s_add_u32 s39, s87, s88
    s_bfe_u32 s37, s39, 0x30000
    s_lshl_b32 s37, s37, 12
    s_add_u32 s85, s37, s89
    s_bfe_u32 s37, s39, 0x10003
    s_lshl_b32 s37, s37, 11
    s_add_u32 s85, s37, s85
    s_bfe_u32 s37, s39, 0x40004
    s_lshl_b32 s37, s37, 16
    s_add_u32 s85, s37, s85
    v_mfma_f32_16x16x32_bf16 v[96:99], v[220:223], v[92:95], v[96:99]
    v_mfma_f32_16x16x32_bf16 v[112:115], v[224:227], v[80:83], 0
    s_waitcnt vmcnt(7)
    buffer_load_dwordx4 a[80:83], v76, s[52:55], s85 offen offset:0 nt
    v_mfma_f32_16x16x32_bf16 v[112:115], v[228:231], v[84:87], v[112:115]
    v_mfma_f32_16x16x32_bf16 v[112:115], v[232:235], v[88:91], v[112:115]
    s_nop 2
    v_mov_b32_dpp v122, v96 quad_perm:[0,0,0,0] row_mask:0xf bank_mask:0xf
    v_mov_b32_dpp v124, v98 quad_perm:[2,2,2,2] row_mask:0xf bank_mask:0xf
    s_nop 0
    v_add_f32_dpp v122, v97, v122 quad_perm:[1,1,1,1] row_mask:0xf bank_mask:0xf
    v_add_f32_dpp v124, v99, v124 quad_perm:[3,3,3,3] row_mask:0xf bank_mask:0xf
    v_add_f32 v122, v122, v124
    v_max_f32 v65, v65, v122
    ds_write_b32 v64, v122 offset:1280
    s_waitcnt vmcnt(7)
    buffer_load_dwordx4 a[84:87], v77, s[52:55], s85 offen offset:0 nt
    v_mfma_f32_16x16x32_bf16 v[112:115], v[236:239], v[92:95], v[112:115]
    v_mfma_f32_16x16x32_bf16 v[96:99], v[240:243], v[80:83], 0
    s_waitcnt vmcnt(7)
    buffer_load_dwordx4 a[88:91], v76, s[52:55], s85 offen offset:1024 nt
    v_mfma_f32_16x16x32_bf16 v[96:99], v[244:247], v[84:87], v[96:99]
    v_mfma_f32_16x16x32_bf16 v[96:99], v[248:251], v[88:91], v[96:99]
    s_nop 2
    v_mov_b32_dpp v122, v112 quad_perm:[0,0,0,0] row_mask:0xf bank_mask:0xf
    v_mov_b32_dpp v124, v114 quad_perm:[2,2,2,2] row_mask:0xf bank_mask:0xf
    s_nop 0
    v_add_f32_dpp v122, v113, v122 quad_perm:[1,1,1,1] row_mask:0xf bank_mask:0xf
    v_add_f32_dpp v124, v115, v124 quad_perm:[3,3,3,3] row_mask:0xf bank_mask:0xf
    v_add_f32 v122, v122, v124
    v_max_f32 v65, v65, v122
    ds_write_b32 v64, v122 offset:1536
    v_mfma_f32_16x16x32_bf16 v[96:99], v[252:255], v[92:95], v[96:99]
    s_waitcnt vmcnt(6)
    buffer_load_dwordx4 a[92:95], v77, s[52:55], s85 offen offset:1024 nt
    s_add_u32 s87, s87, 7
    s_add_u32 s39, s87, s88
    s_bfe_u32 s37, s39, 0x30000
    s_lshl_b32 s37, s37, 12
    s_add_u32 s85, s37, s89
    s_bfe_u32 s37, s39, 0x10003
    s_lshl_b32 s37, s37, 11
    s_add_u32 s85, s37, s85
    s_bfe_u32 s37, s39, 0x40004
    s_lshl_b32 s37, s37, 16
    s_add_u32 s85, s37, s85
    v_mfma_f32_16x16x32_bf16 v[112:115], a[0:3], v[80:83], 0
    v_mfma_f32_16x16x32_bf16 v[112:115], a[4:7], v[84:87], v[112:115]
    s_waitcnt vmcnt(6)
    buffer_load_dwordx4 a[96:99], v76, s[52:55], s85 offen offset:0 nt
    v_mfma_f32_16x16x32_bf16 v[112:115], a[8:11], v[88:91], v[112:115]
    v_mov_b32_dpp v122, v96 quad_perm:[0,0,0,0] row_mask:0xf bank_mask:0xf
    v_mov_b32_dpp v124, v98 quad_perm:[2,2,2,2] row_mask:0xf bank_mask:0xf
    s_nop 0
    v_add_f32_dpp v122, v97, v122 quad_perm:[1,1,1,1] row_mask:0xf bank_mask:0xf
    v_add_f32_dpp v124, v99, v124 quad_perm:[3,3,3,3] row_mask:0xf bank_mask:0xf
    v_add_f32 v122, v122, v124
    v_max_f32 v65, v65, v122
    ds_write_b32 v64, v122 offset:1792
    v_mfma_f32_16x16x32_bf16 v[112:115], a[12:15], v[92:95], v[112:115]
    s_waitcnt vmcnt(6)
    buffer_load_dwordx4 a[100:103], v77, s[52:55], s85 offen offset:0 nt
    v_mfma_f32_16x16x32_bf16 v[96:99], a[16:19], v[80:83], 0
    v_mfma_f32_16x16x32_bf16 v[96:99], a[20:23], v[84:87], v[96:99]
    s_waitcnt vmcnt(6)
    buffer_load_dwordx4 a[104:107], v76, s[52:55], s85 offen offset:1024 nt
    v_mfma_f32_16x16x32_bf16 v[96:99], a[24:27], v[88:91], v[96:99]
    s_nop 0
    v_mov_b32_dpp v122, v112 quad_perm:[0,0,0,0] row_mask:0xf bank_mask:0xf
    v_mov_b32_dpp v124, v114 quad_perm:[2,2,2,2] row_mask:0xf bank_mask:0xf
    s_nop 0
    v_add_f32_dpp v122, v113, v122 quad_perm:[1,1,1,1] row_mask:0xf bank_mask:0xf
    v_add_f32_dpp v124, v115, v124 quad_perm:[3,3,3,3] row_mask:0xf bank_mask:0xf
    v_add_f32 v122, v122, v124
    v_max_f32 v65, v65, v122
    ds_write_b32 v64, v122 offset:2048
    v_mfma_f32_16x16x32_bf16 v[96:99], a[28:31], v[92:95], v[96:99]
    s_waitcnt vmcnt(6)
    buffer_load_dwordx4 a[108:111], v77, s[52:55], s85 offen offset:1024 nt
    s_add_u32 s87, s87, 7
    s_add_u32 s39, s87, s88
    s_bfe_u32 s37, s39, 0x30000
    s_lshl_b32 s37, s37, 12
    s_add_u32 s85, s37, s89
    s_bfe_u32 s37, s39, 0x10003
    s_lshl_b32 s37, s37, 11
    s_add_u32 s85, s37, s85
    s_bfe_u32 s37, s39, 0x40004
    s_lshl_b32 s37, s37, 16
    s_add_u32 s85, s37, s85
    v_mfma_f32_16x16x32_bf16 v[112:115], a[32:35], v[80:83], 0
    s_bfe_u32 s38, s2, 0x20001
    s_lshl_b32 s38, s38, 0
    s_add_u32 s90, s38, 0
    s_bfe_u32 s38, s2, 0x10000
    s_lshl_b32 s38, s38, 2
    s_add_u32 s90, s38, s90
    s_and_b32 s36, s90, 3
    s_bitcmp0_b32 s90, 2
    s_cselect_b64 s[40:41], s[24:25], s[14:15]
    s_cselect_b32 s45, 262144, 0
    s_add_u32 s45, s45, 524288
    s_lshl_b32 s38, s36, 16
    s_add_u32 s71, s38, s45
    s_lshr_b32 s38, s32, 2
    s_lshl_b32 s38, s38, 13
    s_add_u32 s71, s38, s71
    s_bfe_u32 s38, s32, 0x20000
    s_lshl_b32 s38, s38, 6
    s_add_u32 s71, s38, s71
    s_mov_b32 s42, 4194304
    s_mov_b32 s43, 0x20000
    s_lshl_b32 s38, s32, 17
    s_add_u32 s44, s38, 0
    s_lshl_b32 s38, s34, 15
    s_add_u32 s44, s38, s44
    s_lshl_b32 s38, s36, 8
    s_add_u32 s44, s38, s44
    s_lshl_b32 s38, s36, 16
    s_add_u32 s45, s38, s45
    s_lshr_b32 s38, s34, 1
    s_lshl_b32 s38, s38, 15
    s_add_u32 s45, s38, s45
    s_lshl_b32 s38, s32, 8
    s_add_u32 s45, s38, s45
    s_bfe_u32 s38, s34, 0x10000
    s_lshl_b32 s38, s38, 7
    s_add_u32 s45, s38, s45
    s_lshl_b32 s38, s32, 11
    s_add_u32 s46, s38, 196608
    s_lshl_b32 s38, s34, 9
    s_add_u32 s46, s38, s46
    s_mov_b32 s72, s26
    s_and_b32 s73, s27, 0xffff
    s_mov_b32 s74, 8192
    s_mov_b32 s75, 0x20000
    v_mfma_f32_16x16x32_bf16 v[112:115], a[36:39], v[84:87], v[112:115]
    s_waitcnt vmcnt(6)
    buffer_load_dwordx4 a[112:115], v76, s[52:55], s85 offen offset:0 nt
    v_mfma_f32_16x16x32_bf16 v[112:115], a[40:43], v[88:91], v[112:115]
    v_mov_b32_dpp v122, v96 quad_perm:[0,0,0,0] row_mask:0xf bank_mask:0xf
    v_mov_b32_dpp v124, v98 quad_perm:[2,2,2,2] row_mask:0xf bank_mask:0xf
    s_nop 0
    v_add_f32_dpp v122, v97, v122 quad_perm:[1,1,1,1] row_mask:0xf bank_mask:0xf
    v_add_f32_dpp v124, v99, v124 quad_perm:[3,3,3,3] row_mask:0xf bank_mask:0xf
    v_add_f32 v122, v122, v124
    v_max_f32 v65, v65, v122
    ds_write_b32 v64, v122 offset:2304
    v_mfma_f32_16x16x32_bf16 v[112:115], a[44:47], v[92:95], v[112:115]
    s_waitcnt vmcnt(6)
    buffer_load_dwordx4 a[116:119], v77, s[52:55], s85 offen offset:0 nt
    v_mfma_f32_16x16x32_bf16 v[96:99], a[48:51], v[80:83], 0
    v_mfma_f32_16x16x32_bf16 v[96:99], a[52:55], v[84:87], v[96:99]
    s_waitcnt vmcnt(6)
    buffer_load_dwordx4 a[120:123], v76, s[52:55], s85 offen offset:1024 nt
    v_mfma_f32_16x16x32_bf16 v[96:99], a[56:59], v[88:91], v[96:99]
    s_nop 0
    v_mov_b32_dpp v122, v112 quad_perm:[0,0,0,0] row_mask:0xf bank_mask:0xf
    v_mov_b32_dpp v124, v114 quad_perm:[2,2,2,2] row_mask:0xf bank_mask:0xf
    s_nop 0
    v_add_f32_dpp v122, v113, v122 quad_perm:[1,1,1,1] row_mask:0xf bank_mask:0xf
    v_add_f32_dpp v124, v115, v124 quad_perm:[3,3,3,3] row_mask:0xf bank_mask:0xf
    v_add_f32 v122, v122, v124
    v_max_f32 v65, v65, v122
    ds_write_b32 v64, v122 offset:2560
    v_lshlrev_b32 v4, 2, v2
    v_xor_b32 v4, v4, v3
    v_xor_b32 v5, 0, v4
    v_lshlrev_b32 v5, 4, v5
    v_lshl_add_u32 v20, v2, 10, v5
    v_xor_b32 v5, 1, v4
    v_lshlrev_b32 v5, 4, v5
    v_lshl_add_u32 v21, v2, 10, v5
    v_add_u32 v21, 3072, v21
    v_xor_b32 v5, 2, v4
    v_lshlrev_b32 v5, 4, v5
    v_lshl_add_u32 v22, v2, 10, v5
    v_add_u32 v22, 6144, v22
    v_xor_b32 v5, 3, v4
    v_lshlrev_b32 v5, 4, v5
    v_lshl_add_u32 v23, v2, 10, v5
    v_add_u32 v23, 9216, v23
    s_lshl_b32 s38, s32, 15
    s_add_u32 s47, s38, 1048576
    s_lshl_b32 s38, s3, 13
    s_add_u32 s47, s38, s47
    v_lshlrev_b32 v6, 7, v2
    v_bfe_u32 v5, v3, 0, 3
    v_lshl_add_u32 v6, v5, 4, v6
    v_lshrrev_b32 v4, 3, v3
    v_and_b32 v7, 3, v3
    v_min_u32 v7, 2, v7
    v_lshl_add_u32 v7, v7, 1, v4
    v_add_u32 v5, 0, v4
    v_cmp_le_u32 vcc, s33, v5
    s_nop 1
    v_addc_co_u32 v5, vcc, 0, v5, vcc
    v_lshl_add_u32 v50, v5, 10, v6
    v_add_u32 v5, 2, v4
    v_cmp_le_u32 vcc, s33, v5
    s_nop 1
    v_addc_co_u32 v5, vcc, 0, v5, vcc
    v_lshl_add_u32 v51, v5, 10, v6
    v_add_u32 v5, 4, v4
    v_cmp_le_u32 vcc, s33, v5
    s_nop 1
    v_addc_co_u32 v5, vcc, 0, v5, vcc
    v_lshl_add_u32 v52, v5, 10, v6
    v_mov_b32 v5, v7
    v_mov_b32 v6, 512
    v_cmp_le_u32 vcc, s33, v5
    s_nop 1
    v_addc_co_u32 v5, vcc, 0, v5, vcc
    v_lshl_add_u32 v53, v5, 10, v6
    s_mul_i32 s38, s3, 320
    s_add_u32 s38, s38, 135168
    v_lshlrev_b32 v4, 6, v2
    v_lshl_add_u32 v4, v3, 1, v4
    v_add_u32 v31, s38, v4
    v_mfma_f32_16x16x32_bf16 v[96:99], a[60:63], v[92:95], v[96:99]
    v_mfma_f32_16x16x32_bf16 v[112:115], a[64:67], v[80:83], 0
    s_waitcnt vmcnt(6)
    buffer_load_dwordx4 a[124:127], v77, s[52:55], s85 offen offset:1024 nt
    s_add_u32 s87, s87, 7
    s_add_u32 s39, s87, s88
    s_bfe_u32 s37, s39, 0x30000
    s_lshl_b32 s37, s37, 12
    s_add_u32 s85, s37, s89
    s_bfe_u32 s37, s39, 0x10003
    s_lshl_b32 s37, s37, 11
    s_add_u32 s85, s37, s85
    s_bfe_u32 s37, s39, 0x40004
    s_lshl_b32 s37, s37, 16
    s_add_u32 s85, s37, s85
    v_mfma_f32_16x16x32_bf16 v[112:115], a[68:71], v[84:87], v[112:115]
    v_mfma_f32_16x16x32_bf16 v[112:115], a[72:75], v[88:91], v[112:115]
    v_mov_b32_dpp v122, v96 quad_perm:[0,0,0,0] row_mask:0xf bank_mask:0xf
    v_mov_b32_dpp v124, v98 quad_perm:[2,2,2,2] row_mask:0xf bank_mask:0xf
    s_nop 0
    v_add_f32_dpp v122, v97, v122 quad_perm:[1,1,1,1] row_mask:0xf bank_mask:0xf
    v_add_f32_dpp v124, v99, v124 quad_perm:[3,3,3,3] row_mask:0xf bank_mask:0xf
    v_add_f32 v122, v122, v124
    v_max_f32 v65, v65, v122
    ds_write_b32 v64, v122 offset:2816
    s_waitcnt vmcnt(5)
    buffer_load_dwordx4 v[128:131], v76, s[52:55], s85 offen offset:0 nt
    v_mfma_f32_16x16x32_bf16 v[112:115], a[76:79], v[92:95], v[112:115]
    v_mfma_f32_16x16x32_bf16 v[96:99], a[80:83], v[80:83], 0
    v_lshlrev_b32 v4, 11, v2
    v_bfe_u32 v5, v1, 2, 2
    v_lshl_add_u32 v4, v5, 8, v4
    v_bfe_u32 v5, v1, 2, 2
    v_lshl_add_u32 v4, v5, 6, v4
    v_bfe_u32 v5, v1, 4, 1
    v_lshl_add_u32 v4, v5, 5, v4
    v_bfe_u32 v5, v1, 1, 1
    v_lshl_add_u32 v4, v5, 4, v4
    v_bfe_u32 v5, v1, 0, 1
    v_lshl_add_u32 v4, v5, 3, v4
    s_lshl_b32 s38, s34, 6
    s_add_u32 s38, s38, 98304
    v_xor_b32 v24, s38, v4
    v_xor_b32 v25, 16, v24
    v_xor_b32 v26, 32, v24
    v_xor_b32 v27, 48, v24
    v_and_b32 v4, 3, v3
    v_lshrrev_b32 v5, 2, v3
    v_lshlrev_b32 v6, 4, v2
    v_add_u32 v6, 135168, v6
    s_movk_i32 s36, 320
    v_cmp_eq_u32 vcc, 0, v5
    s_nop 1
    v_cndmask_b32 v28, 4, v4, vcc
    v_mad_u32_u24 v28, v28, s36, v6
    v_cmp_eq_u32 vcc, 1, v5
    s_nop 1
    v_cndmask_b32 v29, 4, v4, vcc
    v_mad_u32_u24 v29, v29, s36, v6
    v_lshlrev_b32 v5, 2, v1
    v_add_u32 v5, 136448, v5
    v_mov_b32 v6, 0
    ds_write_b32 v5, v6
    s_waitcnt vmcnt(5)
    buffer_load_dwordx4 v[132:135], v77, s[52:55], s85 offen offset:0 nt
    v_mfma_f32_16x16x32_bf16 v[96:99], a[84:87], v[84:87], v[96:99]
    v_mfma_f32_16x16x32_bf16 v[96:99], a[88:91], v[88:91], v[96:99]
    v_mov_b32_dpp v122, v112 quad_perm:[0,0,0,0] row_mask:0xf bank_mask:0xf
    v_mov_b32_dpp v124, v114 quad_perm:[2,2,2,2] row_mask:0xf bank_mask:0xf
    s_nop 0
    v_add_f32_dpp v122, v113, v122 quad_perm:[1,1,1,1] row_mask:0xf bank_mask:0xf
    v_add_f32_dpp v124, v115, v124 quad_perm:[3,3,3,3] row_mask:0xf bank_mask:0xf
    v_add_f32 v122, v122, v124
    v_max_f32 v65, v65, v122
    ds_write_b32 v64, v122 offset:3072
    s_waitcnt vmcnt(5)
    buffer_load_dwordx4 v[136:139], v76, s[52:55], s85 offen offset:1024 nt
    v_mfma_f32_16x16x32_bf16 v[96:99], a[92:95], v[92:95], v[96:99]
    v_mfma_f32_16x16x32_bf16 v[112:115], a[96:99], v[80:83], 0
    s_waitcnt vmcnt(5)
    buffer_load_dwordx4 v[140:143], v77, s[52:55], s85 offen offset:1024 nt
    s_add_u32 s87, s87, 7
    s_add_u32 s39, s87, s88
    s_bfe_u32 s37, s39, 0x30000
    s_lshl_b32 s37, s37, 12
    s_add_u32 s85, s37, s89
    s_bfe_u32 s37, s39, 0x10003
    s_lshl_b32 s37, s37, 11
    s_add_u32 s85, s37, s85
    s_bfe_u32 s37, s39, 0x40004
    s_lshl_b32 s37, s37, 16
    s_add_u32 s85, s37, s85
    v_mfma_f32_16x16x32_bf16 v[112:115], a[100:103], v[84:87], v[112:115]
    v_mfma_f32_16x16x32_bf16 v[112:115], a[104:107], v[88:91], v[112:115]
    v_mov_b32_dpp v122, v96 quad_perm:[0,0,0,0] row_mask:0xf bank_mask:0xf
    v_mov_b32_dpp v124, v98 quad_perm:[2,2,2,2] row_mask:0xf bank_mask:0xf
    s_nop 0
    v_add_f32_dpp v122, v97, v122 quad_perm:[1,1,1,1] row_mask:0xf bank_mask:0xf
    v_add_f32_dpp v124, v99, v124 quad_perm:[3,3,3,3] row_mask:0xf bank_mask:0xf
    v_add_f32 v122, v122, v124
    v_max_f32 v65, v65, v122
    ds_write_b32 v64, v122 offset:3328
    v_lshlrev_b32 v30, 4, v3
    v_lshl_add_u32 v30, v2, 13, v30
    v_lshrrev_b32 v5, 2, v1
    v_lshlrev_b32 v32, 8, v5
    v_bfe_u32 v5, v1, 0, 2
    v_lshl_add_u32 v32, v5, 4, v32
    s_xor_b32 s37, s90, 4
    s_bfe_u32 s38, s37, 0x30000
    s_lshl_b32 s38, s38, 8
    s_add_u32 s36, s38, 0
    s_lshr_b32 s38, s32, 4
    s_lshl_b32 s38, s38, 7
    s_add_u32 s36, s38, s36
    s_bfe_u32 s38, s32, 0x20000
    s_lshl_b32 s38, s38, 5
    s_add_u32 s36, s38, s36
    s_bfe_u32 s38, s32, 0x20002
    s_lshl_b32 s38, s38, 3
    s_add_u32 s36, s38, s36
    v_bfe_u32 v5, v1, 0, 2
    v_lshlrev_b32 v33, 11, v5
    v_lshl_add_u32 v33, v2, 1, v33
    v_add_u32 v33, s36, v33
    v_and_b32 v5, 31, v1
    v_lshlrev_b32 v34, 4, v5
    s_mul_i32 s38, s34, 320
    s_add_u32 s38, s38, 135168
    v_lshl_add_u32 v35, v5, 3, s38
    s_bfe_u32 s38, s34, 0x10000
    s_lshl_b32 s38, s38, 12
    s_add_u32 s36, s38, s71
    s_lshr_b32 s38, s34, 1
    s_lshl_b32 s38, s38, 24
    s_add_u32 s36, s38, s36
    s_bitcmp1_b32 s90, 2
    s_cselect_b32 s46, s46, s36
    s_cselect_b64 vcc, -1, 0
    v_cndmask_b32 v54, v32, v34, vcc
    s_waitcnt vmcnt(5)
    buffer_load_dwordx4 v[144:147], v76, s[52:55], s85 offen offset:0 nt
    v_mfma_f32_16x16x32_bf16 v[112:115], a[108:111], v[92:95], v[112:115]
    v_mfma_f32_16x16x32_bf16 v[96:99], a[112:115], v[80:83], 0
    s_waitcnt vmcnt(5)
    buffer_load_dwordx4 v[148:151], v77, s[52:55], s85 offen offset:0 nt
    v_mfma_f32_16x16x32_bf16 v[96:99], a[116:119], v[84:87], v[96:99]
    v_mfma_f32_16x16x32_bf16 v[96:99], a[120:123], v[88:91], v[96:99]
    s_nop 2
    v_mov_b32_dpp v122, v112 quad_perm:[0,0,0,0] row_mask:0xf bank_mask:0xf
    v_mov_b32_dpp v124, v114 quad_perm:[2,2,2,2] row_mask:0xf bank_mask:0xf
    s_nop 0
    v_add_f32_dpp v122, v113, v122 quad_perm:[1,1,1,1] row_mask:0xf bank_mask:0xf
    v_add_f32_dpp v124, v115, v124 quad_perm:[3,3,3,3] row_mask:0xf bank_mask:0xf
    v_add_f32 v122, v122, v124
    v_max_f32 v65, v65, v122
    ds_write_b32 v64, v122 offset:3584
    v_mfma_f32_16x16x32_bf16 v[96:99], a[124:127], v[92:95], v[96:99]
    v_add_u32 v64, 3840, v64
    s_mov_b32 s97, 8
    s_mov_b32 s92, 7
    s_lshl_b32 s38, s32, 13
    s_add_u32 s80, s38, 3145728
    s_lshl_b32 s38, s3, 11
    s_add_u32 s80, s38, s80
    v_lshrrev_b32 v4, 2, v1
    v_lshlrev_b32 v55, 3, v4
    s_mov_b32 s66, 134217728
    s_mov_b32 s67, 0x20000
    s_mov_b64 s[64:65], s[52:53]
    v_mov_b32 v62, v76
    v_mov_b32 v63, v77
    s_branch L_bloop
L_aux:
    v_lshlrev_b32 v4, 2, v2
    v_xor_b32 v4, v4, v3
    v_xor_b32 v96, 0, v4
    v_lshlrev_b32 v96, 4, v96
    v_lshl_add_u32 v10, v2, 13, v96
    v_xor_b32 v97, 1, v4
    v_lshlrev_b32 v97, 4, v97
    v_lshl_add_u32 v11, v2, 13, v97
    v_add_u32 v11, 31744, v11
    v_xor_b32 v98, 2, v4
    v_lshlrev_b32 v98, 4, v98
    v_lshl_add_u32 v12, v2, 13, v98
    v_add_u32 v12, 63488, v12
    v_xor_b32 v99, 3, v4
    v_lshlrev_b32 v99, 4, v99
    v_lshl_add_u32 v13, v2, 13, v99
    v_add_u32 v13, 95232, v13
    s_lshl_b32 s56, s34, 15
    s_mov_b32 s62, 0
    s_lshl_b32 s38, s34, 20
    s_add_u32 s95, s38, 0
    s_lshl_b32 s38, s32, 8
    s_add_u32 s95, s38, s95
    s_waitcnt lgkmcnt(0)
    s_mov_b32 s52, s12
    s_and_b32 s53, s13, 0xffff
    s_mov_b32 s54, 4194304
    s_mov_b32 s55, 0x20000
    s_add_u32 s39, s56, s62
    s_mov_b32 m0, s39
    s_add_u32 s62, s62, 4096
    s_and_b32 s62, s62, 0x7fff
    buffer_load_dwordx4 v10, s[52:55], s95 offen offset:0 nt lds
    buffer_load_dwordx4 v11, s[52:55], s95 offen offset:1024 nt lds
    buffer_load_dwordx4 v12, s[52:55], s95 offen offset:2048 nt lds
    buffer_load_dwordx4 v13, s[52:55], s95 offen offset:3072 nt lds
    s_add_u32 s95, s95, 131072
    s_add_u32 s39, s56, s62
    s_mov_b32 m0, s39
    s_add_u32 s62, s62, 4096
    s_and_b32 s62, s62, 0x7fff
    buffer_load_dwordx4 v10, s[52:55], s95 offen offset:0 nt lds
    buffer_load_dwordx4 v11, s[52:55], s95 offen offset:1024 nt lds
    buffer_load_dwordx4 v12, s[52:55], s95 offen offset:2048 nt lds
    buffer_load_dwordx4 v13, s[52:55], s95 offen offset:3072 nt lds
    s_add_u32 s95, s95, 131072
    s_load_dword s35, s[30:31], 0
    s_mov_b32 s48, s30
    s_and_b32 s49, s31, 0xffff
    s_mov_b32 s50, 8388608
    s_mov_b32 s51, 0x20000
    s_mov_b32 s82, 0xffffff00
    s_mov_b32 s83, 0x3e0293ee
    s_mov_b32 s84, 2097152
    v_lshl_add_u32 v76, v2, 10, v96
    v_lshl_add_u32 v96, v2, 8, v96
    v_lshl_add_u32 v77, v2, 10, v97
    v_lshl_add_u32 v97, v2, 8, v97
    v_add_u32 v77, 3072, v77
    v_lshl_add_u32 v78, v2, 10, v98
    v_lshl_add_u32 v98, v2, 8, v98
    v_add_u32 v78, 6144, v78
    v_lshl_add_u32 v79, v2, 10, v99
    v_lshl_add_u32 v99, v2, 8, v99
    v_add_u32 v79, 9216, v79
    v_bfe_u32 v100, v1, 0, 5
    v_lshlrev_b32 v101, 8, v100
    v_lshlrev_b32 v9, 4, v3
    v_lshl_add_u32 v9, v2, 10, v9
    v_xor_b32 v5, v3, v2
    v_bfe_u32 v4, v3, 2, 1
    v_lshlrev_b32 v6, 11, v4
    v_bfe_u32 v4, v3, 3, 1
    v_lshl_add_u32 v6, v4, 10, v6
    v_bfe_u32 v4, v3, 0, 2
    v_lshl_add_u32 v6, v4, 8, v6
    v_bfe_u32 v4, v5, 0, 2
    v_lshl_add_u32 v6, v4, 6, v6
    v_bfe_u32 v4, v3, 2, 1
    v_lshl_add_u32 v6, v4, 5, v6
    v_bfe_u32 v4, v3, 3, 1
    v_lshl_add_u32 v6, v4, 4, v6
    v_add_u32 v60, s56, v6
    v_xor_b32 v61, 16, v60
    v_xor_b32 v62, 32, v60
    v_xor_b32 v63, 48, v60
    v_lshrrev_b32 v5, 4, v1
    v_xor_b32 v5, v5, v1
    v_bfe_u32 v4, v1, 4, 1
    v_lshlrev_b32 v6, 11, v4
    v_bfe_u32 v4, v1, 5, 1
    v_lshl_add_u32 v6, v4, 10, v6
    v_bfe_u32 v4, v1, 2, 2
    v_lshl_add_u32 v6, v4, 8, v6
    v_bfe_u32 v4, v1, 2, 2
    v_lshl_add_u32 v6, v4, 6, v6
    v_bfe_u32 v4, v1, 4, 1
    v_lshl_add_u32 v6, v4, 5, v6
    v_bfe_u32 v4, v5, 1, 1
    v_lshl_add_u32 v6, v4, 4, v6
    v_bfe_u32 v4, v1, 0, 1
    v_lshl_add_u32 v6, v4, 3, v6
    v_add_u32 v82, s56, v6
    v_xor_b32 v83, 32, v82
    v_xor_b32 v84, 64, v82
    v_xor_b32 v85, 96, v82
    v_xor_b32 v86, 128, v82
    v_xor_b32 v87, 160, v82
    v_xor_b32 v88, 192, v82
    v_xor_b32 v89, 224, v82
    v_lshlrev_b32 v6, 11, v2
    v_bfe_u32 v4, v1, 2, 2
    v_lshl_add_u32 v6, v4, 8, v6
    v_bfe_u32 v4, v1, 2, 2
    v_lshl_add_u32 v6, v4, 6, v6
    v_bfe_u32 v4, v1, 4, 1
    v_lshl_add_u32 v6, v4, 5, v6
    v_bfe_u32 v4, v1, 1, 1
    v_lshl_add_u32 v6, v4, 4, v6
    v_bfe_u32 v4, v1, 0, 1
    v_lshl_add_u32 v6, v4, 3, v6
    v_add_u32 v136, s56, v6
    v_xor_b32 v137, 16, v136
    v_xor_b32 v138, 32, v136
    v_xor_b32 v139, 48, v136
    v_xor_b32 v140, 64, v136
    v_xor_b32 v141, 80, v136
    v_xor_b32 v142, 96, v136
    v_xor_b32 v143, 112, v136
    v_xor_b32 v144, 128, v136
    v_xor_b32 v145, 144, v136
    v_xor_b32 v146, 160, v136
    v_xor_b32 v147, 176, v136
    v_xor_b32 v148, 192, v136
    v_xor_b32 v149, 208, v136
    v_xor_b32 v150, 224, v136
    v_xor_b32 v151, 240, v136
    s_lshl_b32 s85, s34, 13
    s_add_u32 s85, s85, 131072
    v_lshl_add_u32 v94, v1, 4, s85
    v_add_u32 v96, s85, v96
    v_add_u32 v97, s85, v97
    v_add_u32 v98, s85, v98
    v_add_u32 v99, s85, v99
    s_add_u32 s39, s56, s62
    s_mov_b32 m0, s39
    s_add_u32 s62, s62, 4096
    s_and_b32 s62, s62, 0x7fff
    buffer_load_dwordx4 v10, s[52:55], s95 offen offset:0 nt lds
    buffer_load_dwordx4 v11, s[52:55], s95 offen offset:1024 nt lds
    buffer_load_dwordx4 v12, s[52:55], s95 offen offset:2048 nt lds
    buffer_load_dwordx4 v13, s[52:55], s95 offen offset:3072 nt lds
    s_add_u32 s95, s95, 131072
    s_add_u32 s39, s56, s62
    s_mov_b32 m0, s39
    s_add_u32 s62, s62, 4096
    s_and_b32 s62, s62, 0x7fff
    buffer_load_dwordx4 v10, s[52:55], s95 offen offset:0 nt lds
    buffer_load_dwordx4 v11, s[52:55], s95 offen offset:1024 nt lds
    buffer_load_dwordx4 v12, s[52:55], s95 offen offset:2048 nt lds
    buffer_load_dwordx4 v13, s[52:55], s95 offen offset:3072 nt lds
    s_add_u32 s95, s95, 131072
    s_add_u32 s39, s56, s62
    s_mov_b32 m0, s39
    s_add_u32 s62, s62, 4096
    s_and_b32 s62, s62, 0x7fff
    buffer_load_dwordx4 v10, s[52:55], s95 offen offset:0 nt lds
    buffer_load_dwordx4 v11, s[52:55], s95 offen offset:1024 nt lds
    buffer_load_dwordx4 v12, s[52:55], s95 offen offset:2048 nt lds
    buffer_load_dwordx4 v13, s[52:55], s95 offen offset:3072 nt lds
    s_add_u32 s95, s95, 131072
    s_add_u32 s39, s56, s62
    s_mov_b32 m0, s39
    s_add_u32 s62, s62, 4096
    s_and_b32 s62, s62, 0x7fff
    buffer_load_dwordx4 v10, s[52:55], s95 offen offset:0 nt lds
    buffer_load_dwordx4 v11, s[52:55], s95 offen offset:1024 nt lds
    buffer_load_dwordx4 v12, s[52:55], s95 offen offset:2048 nt lds
    buffer_load_dwordx4 v13, s[52:55], s95 offen offset:3072 nt lds
    s_add_u32 s95, s95, 131072
    s_add_u32 s39, s56, s62
    s_mov_b32 m0, s39
    s_add_u32 s62, s62, 4096
    s_and_b32 s62, s62, 0x7fff
    buffer_load_dwordx4 v10, s[52:55], s95 offen offset:0 nt lds
    buffer_load_dwordx4 v11, s[52:55], s95 offen offset:1024 nt lds
    buffer_load_dwordx4 v12, s[52:55], s95 offen offset:2048 nt lds
    buffer_load_dwordx4 v13, s[52:55], s95 offen offset:3072 nt lds
    s_add_u32 s95, s95, 131072
    s_add_u32 s39, s56, s62
    s_mov_b32 m0, s39
    s_add_u32 s62, s62, 4096
    s_and_b32 s62, s62, 0x7fff
    buffer_load_dwordx4 v10, s[52:55], s95 offen offset:0 nt lds
    buffer_load_dwordx4 v11, s[52:55], s95 offen offset:1024 nt lds
    buffer_load_dwordx4 v12, s[52:55], s95 offen offset:2048 nt lds
    buffer_load_dwordx4 v13, s[52:55], s95 offen offset:3072 nt lds
    s_add_u32 s95, s95, 131072
    s_waitcnt lgkmcnt(0)
    s_add_u32 s35, s35, 0x5b
    s_and_b32 s35, s35, 0xff
    v_mov_b32 v8, s35
    s_or_b32 s68, s35, 0x6b3ac500
    s_getreg_b32 s70, hwreg(HW_REG_XCC_ID, 0, 4)
    s_lshl_b32 s70, s70, 8
    s_or_b32 s70, s70, s35
    s_or_b32 s70, s70, 0x5e9d0000
    s_bfe_u32 s38, s2, 0x30000
    s_lshl_b32 s38, s38, 8
    s_add_u32 s69, s38, 32768
    s_lshl_b32 s38, s32, 2
    s_add_u32 s69, s38, s69
    s_lshl_b32 s38, s34, 24
    s_add_u32 s69, s38, s69
    v_mov_b32 v4, s69
    v_mov_b32 v5, s70
    s_mov_b64 exec, 1
    buffer_store_dword v5, v4, s[48:51], 0 offen sc1
    s_mov_b64 exec, -1
    s_mov_b32 s52, s6
    s_and_b32 s53, s7, 0xffff
    s_mov_b32 s54, 16777216
    s_mov_b32 s55, 0x20000
    s_bfe_u32 s38, s32, 0x30000
    s_lshl_b32 s38, s38, 1
    s_add_u32 s3, s38, 0
    s_lshr_b32 s38, s32, 4
    s_lshl_b32 s38, s38, 0
    s_add_u32 s3, s38, s3
    s_bfe_u32 s94, s32, 0x10003
    s_lshl_b32 s38, s3, 20
    s_add_u32 s95, s38, 0
    s_lshl_b32 s38, s34, 8
    s_add_u32 s95, s38, s95
    s_waitcnt vmcnt(25)
    ds_read_b64_tr_b16 a[128:129], v136 offset:0
    ds_read_b64_tr_b16 a[130:131], v137 offset:1024
    ds_read_b64_tr_b16 a[144:145], v138 offset:0
    ds_read_b64_tr_b16 a[146:147], v139 offset:1024
    ds_read_b64_tr_b16 a[160:161], v140 offset:0
    ds_read_b64_tr_b16 a[162:163], v141 offset:1024
    ds_read_b64_tr_b16 a[176:177], v142 offset:0
    ds_read_b64_tr_b16 a[178:179], v143 offset:1024
    ds_read_b64_tr_b16 a[192:193], v144 offset:0
    ds_read_b64_tr_b16 a[194:195], v145 offset:1024
    ds_read_b64_tr_b16 a[208:209], v146 offset:0
    ds_read_b64_tr_b16 a[210:211], v147 offset:1024
    ds_read_b64_tr_b16 a[224:225], v148 offset:0
    ds_read_b64_tr_b16 a[226:227], v149 offset:1024
    ds_read_b64_tr_b16 a[240:241], v150 offset:0
    ds_read_b64_tr_b16 a[242:243], v151 offset:1024
    s_waitcnt lgkmcnt(0)
    s_add_u32 s39, s56, s62
    s_mov_b32 m0, s39
    s_add_u32 s62, s62, 4096
    s_and_b32 s62, s62, 0x7fff
    buffer_load_dwordx4 v76, s[52:55], s95 offen offset:0 nt lds
    buffer_load_dwordx4 v77, s[52:55], s95 offen offset:1024 nt lds
    buffer_load_dwordx4 v78, s[52:55], s95 offen offset:2048 nt lds
    buffer_load_dwordx4 v79, s[52:55], s95 offen offset:3072 nt lds
    s_add_u32 s95, s95, 16384
    s_add_u32 s39, s56, s62
    s_mov_b32 m0, s39
    s_add_u32 s62, s62, 4096
    s_and_b32 s62, s62, 0x7fff
    buffer_load_dwordx4 v76, s[52:55], s95 offen offset:0 nt lds
    buffer_load_dwordx4 v77, s[52:55], s95 offen offset:1024 nt lds
    buffer_load_dwordx4 v78, s[52:55], s95 offen offset:2048 nt lds
    buffer_load_dwordx4 v79, s[52:55], s95 offen offset:3072 nt lds
    s_add_u32 s95, s95, 16384
    s_waitcnt vmcnt(25)
    ds_read_b64_tr_b16 a[132:133], v136 offset:8192
    ds_read_b64_tr_b16 a[134:135], v137 offset:9216
    ds_read_b64_tr_b16 a[148:149], v138 offset:8192
    ds_read_b64_tr_b16 a[150:151], v139 offset:9216
    ds_read_b64_tr_b16 a[164:165], v140 offset:8192
    ds_read_b64_tr_b16 a[166:167], v141 offset:9216
    ds_read_b64_tr_b16 a[180:181], v142 offset:8192
    ds_read_b64_tr_b16 a[182:183], v143 offset:9216
    ds_read_b64_tr_b16 a[196:197], v144 offset:8192
    ds_read_b64_tr_b16 a[198:199], v145 offset:9216
    ds_read_b64_tr_b16 a[212:213], v146 offset:8192
    ds_read_b64_tr_b16 a[214:215], v147 offset:9216
    ds_read_b64_tr_b16 a[228:229], v148 offset:8192
    ds_read_b64_tr_b16 a[230:231], v149 offset:9216
    ds_read_b64_tr_b16 a[244:245], v150 offset:8192
    ds_read_b64_tr_b16 a[246:247], v151 offset:9216
    s_waitcnt lgkmcnt(0)
    s_add_u32 s39, s56, s62
    s_mov_b32 m0, s39
    s_add_u32 s62, s62, 4096
    s_and_b32 s62, s62, 0x7fff
    buffer_load_dwordx4 v76, s[52:55], s95 offen offset:0 nt lds
    buffer_load_dwordx4 v77, s[52:55], s95 offen offset:1024 nt lds
    buffer_load_dwordx4 v78, s[52:55], s95 offen offset:2048 nt lds
    buffer_load_dwordx4 v79, s[52:55], s95 offen offset:3072 nt lds
    s_add_u32 s95, s95, 16384
    s_add_u32 s39, s56, s62
    s_mov_b32 m0, s39
    s_add_u32 s62, s62, 4096
    s_and_b32 s62, s62, 0x7fff
    buffer_load_dwordx4 v76, s[52:55], s95 offen offset:0 nt lds
    buffer_load_dwordx4 v77, s[52:55], s95 offen offset:1024 nt lds
    buffer_load_dwordx4 v78, s[52:55], s95 offen offset:2048 nt lds
    buffer_load_dwordx4 v79, s[52:55], s95 offen offset:3072 nt lds
    s_add_u32 s95, s95, 16384
    s_waitcnt vmcnt(25)
    ds_read_b64_tr_b16 a[136:137], v136 offset:16384
    ds_read_b64_tr_b16 a[138:139], v137 offset:17408
    ds_read_b64_tr_b16 a[152:153], v138 offset:16384
    ds_read_b64_tr_b16 a[154:155], v139 offset:17408
    ds_read_b64_tr_b16 a[168:169], v140 offset:16384
    ds_read_b64_tr_b16 a[170:171], v141 offset:17408
    ds_read_b64_tr_b16 a[184:185], v142 offset:16384
    ds_read_b64_tr_b16 a[186:187], v143 offset:17408
    ds_read_b64_tr_b16 a[200:201], v144 offset:16384
    ds_read_b64_tr_b16 a[202:203], v145 offset:17408
    ds_read_b64_tr_b16 a[216:217], v146 offset:16384
    ds_read_b64_tr_b16 a[218:219], v147 offset:17408
    ds_read_b64_tr_b16 a[232:233], v148 offset:16384
    ds_read_b64_tr_b16 a[234:235], v149 offset:17408
    ds_read_b64_tr_b16 a[248:249], v150 offset:16384
    ds_read_b64_tr_b16 a[250:251], v151 offset:17408
    s_waitcnt lgkmcnt(0)
    s_add_u32 s39, s56, s62
    s_mov_b32 m0, s39
    s_add_u32 s62, s62, 4096
    s_and_b32 s62, s62, 0x7fff
    buffer_load_dwordx4 v76, s[52:55], s95 offen offset:0 nt lds
    buffer_load_dwordx4 v77, s[52:55], s95 offen offset:1024 nt lds
    buffer_load_dwordx4 v78, s[52:55], s95 offen offset:2048 nt lds
    buffer_load_dwordx4 v79, s[52:55], s95 offen offset:3072 nt lds
    s_add_u32 s95, s95, 16384
    s_add_u32 s39, s56, s62
    s_mov_b32 m0, s39
    s_add_u32 s62, s62, 4096
    s_and_b32 s62, s62, 0x7fff
    buffer_load_dwordx4 v76, s[52:55], s95 offen offset:0 nt lds
    buffer_load_dwordx4 v77, s[52:55], s95 offen offset:1024 nt lds
    buffer_load_dwordx4 v78, s[52:55], s95 offen offset:2048 nt lds
    buffer_load_dwordx4 v79, s[52:55], s95 offen offset:3072 nt lds
    s_add_u32 s95, s95, 16384
    s_waitcnt vmcnt(25)
    ds_read_b64_tr_b16 a[140:141], v136 offset:24576
    ds_read_b64_tr_b16 a[142:143], v137 offset:25600
    ds_read_b64_tr_b16 a[156:157], v138 offset:24576
    ds_read_b64_tr_b16 a[158:159], v139 offset:25600
    ds_read_b64_tr_b16 a[172:173], v140 offset:24576
    ds_read_b64_tr_b16 a[174:175], v141 offset:25600
    ds_read_b64_tr_b16 a[188:189], v142 offset:24576
    ds_read_b64_tr_b16 a[190:191], v143 offset:25600
    ds_read_b64_tr_b16 a[204:205], v144 offset:24576
    ds_read_b64_tr_b16 a[206:207], v145 offset:25600
    ds_read_b64_tr_b16 a[220:221], v146 offset:24576
    ds_read_b64_tr_b16 a[222:223], v147 offset:25600
    ds_read_b64_tr_b16 a[236:237], v148 offset:24576
    ds_read_b64_tr_b16 a[238:239], v149 offset:25600
    ds_read_b64_tr_b16 a[252:253], v150 offset:24576
    ds_read_b64_tr_b16 a[254:255], v151 offset:25600
    s_waitcnt lgkmcnt(0)
    s_add_u32 s39, s56, s62
    s_mov_b32 m0, s39
    s_add_u32 s62, s62, 4096
    s_and_b32 s62, s62, 0x7fff
    buffer_load_dwordx4 v76, s[52:55], s95 offen offset:0 nt lds
    buffer_load_dwordx4 v77, s[52:55], s95 offen offset:1024 nt lds
    s_mov_b32 s86, 98304
    buffer_load_dword v7, v101, s[48:51], s86 offen sc1
    v_mov_b32 v104, 0
    v_mov_b32 v105, 0
    v_mov_b32 v106, 0
    v_mov_b32 v107, 0
    v_mov_b32 v108, 0
    v_mov_b32 v109, 0
    v_mov_b32 v110, 0
    v_mov_b32 v111, 0
    v_mov_b32 v112, 0
    v_mov_b32 v113, 0
    v_mov_b32 v114, 0
    v_mov_b32 v115, 0
    v_mov_b32 v116, 0
    v_mov_b32 v117, 0
    v_mov_b32 v118, 0
    v_mov_b32 v119, 0
    v_mov_b32 v120, 0
    v_mov_b32 v121, 0
    v_mov_b32 v122, 0
    v_mov_b32 v123, 0
    v_mov_b32 v124, 0
    v_mov_b32 v125, 0
    v_mov_b32 v126, 0
    v_mov_b32 v127, 0
    v_mov_b32 v128, 0
    v_mov_b32 v129, 0
    v_mov_b32 v130, 0
    v_mov_b32 v131, 0
    v_mov_b32 v132, 0
    v_mov_b32 v133, 0
    v_mov_b32 v134, 0
    v_mov_b32 v135, 0
    v_mov_b32 v90, 0xff7f0000
    s_mov_b32 s93, 0
    v_mov_b32 v102, 0
    v_mov_b32 v103, 0
    s_mov_b32 s60, s83
    s_mov_b32 s61, s83
    v_xor_b32 v5, v3, v2
    v_lshlrev_b32 v6, 8, v3
    v_bfe_u32 v4, v5, 0, 2
    v_lshl_add_u32 v6, v4, 6, v6
    v_lshrrev_b32 v4, 2, v3
    v_lshl_add_u32 v6, v4, 4, v6
    v_add_u32 v52, s85, v6
    v_xor_b32 v53, 16, v52
    v_xor_b32 v54, 32, v52
    v_xor_b32 v55, 48, v52
    s_lshr_b32 s38, s3, 2
    s_lshl_b32 s38, s38, 15
    s_add_u32 s36, s38, 393216
    s_lshl_b32 s38, s94, 14
    s_add_u32 s36, s38, s36
    s_lshl_b32 s38, s34, 8
    s_add_u32 s36, s38, s36
    s_waitcnt vmcnt(0)
L_fcheck_45:
    v_cmp_ne_u32 vcc, s68, v7
    s_cbranch_vccz L_fok_46
    s_sleep 2
    s_mov_b32 s86, 98304
    buffer_load_dword v7, v101, s[48:51], s86 offen sc1
    s_waitcnt vmcnt(0)
    s_sub_u32 s84, s84, 1
    s_cmp_lg_u32 s84, 0
    s_cbranch_scc1 L_fcheck_45
    s_branch L_end
L_fok_46:
    buffer_load_dwordx4 v[200:203], v9, s[48:51], s36 offen sc1
    s_add_u32 s36, s36, 4096
    buffer_load_dwordx4 v[204:207], v9, s[48:51], s36 offen sc1
    s_add_u32 s36, s36, 4096
    buffer_load_dwordx4 v[208:211], v9, s[48:51], s36 offen sc1
    s_add_u32 s36, s36, 4096
    buffer_load_dwordx4 v[212:215], v9, s[48:51], s36 offen sc1
    ds_read_b128 v[136:139], v60 offset:0
    ds_read_b128 v[140:143], v61 offset:0
    ds_read_b128 v[144:147], v62 offset:0
    ds_read_b128 v[148:151], v63 offset:0
    ds_read_b128 v[152:155], v60 offset:4096
    ds_read_b128 v[156:159], v61 offset:4096
    ds_read_b128 v[160:163], v62 offset:4096
    ds_read_b128 v[164:167], v63 offset:4096
    ds_read_b128 v[168:171], v60 offset:8192
    ds_read_b128 v[172:175], v61 offset:8192
    ds_read_b128 v[176:179], v62 offset:8192
    ds_read_b128 v[180:183], v63 offset:8192
    ds_read_b128 v[184:187], v60 offset:12288
    ds_read_b128 v[188:191], v61 offset:12288
    ds_read_b128 v[192:195], v62 offset:12288
    ds_read_b128 v[196:199], v63 offset:12288
    s_waitcnt vmcnt(3)
    ds_write_b128 v96, v[200:203] offset:0
    s_waitcnt vmcnt(2)
    ds_write_b128 v97, v[204:207] offset:1024
    s_waitcnt vmcnt(1)
    ds_write_b128 v98, v[208:211] offset:2048
    s_waitcnt vmcnt(0)
    ds_write_b128 v99, v[212:215] offset:3072
    s_waitcnt lgkmcnt(0)
    ds_read_b128 v[36:39], v52
    ds_read_b128 v[40:43], v53
    ds_read_b128 v[44:47], v54
    ds_read_b128 v[48:51], v55
L_att:
    s_waitcnt lgkmcnt(0)
    v_mfma_f32_16x16x32_bf16 v[200:203], v[136:139], v[36:39], 0
    ds_read_b64_tr_b16 a[0:1], v82 offset:0
    ds_read_b64_tr_b16 a[2:3], v82 offset:4096
    buffer_load_dwordx4 v78, s[52:55], s95 offen offset:2048 nt lds
    v_mfma_f32_16x16x32_bf16 v[200:203], v[140:143], v[40:43], v[200:203]
    ds_read_b64_tr_b16 a[4:5], v83 offset:0
    ds_read_b64_tr_b16 a[6:7], v83 offset:4096
    v_mfma_f32_16x16x32_bf16 v[200:203], v[144:147], v[44:47], v[200:203]
    ds_read_b64_tr_b16 a[8:9], v84 offset:0
    ds_read_b64_tr_b16 a[10:11], v84 offset:4096
    v_mfma_f32_16x16x32_bf16 v[200:203], v[148:151], v[48:51], v[200:203]
    ds_read_b64_tr_b16 a[12:13], v85 offset:0
    ds_read_b64_tr_b16 a[14:15], v85 offset:4096
    buffer_load_dwordx4 v79, s[52:55], s95 offen offset:3072 nt lds
    s_add_u32 s95, s95, 16384
    v_mfma_f32_16x16x32_bf16 v[204:207], v[152:155], v[36:39], 0
    ds_read_b64_tr_b16 a[16:17], v86 offset:0
    ds_read_b64_tr_b16 a[18:19], v86 offset:4096
    v_mfma_f32_16x16x32_bf16 v[204:207], v[156:159], v[40:43], v[204:207]
    ds_read_b64_tr_b16 a[20:21], v87 offset:0
    ds_read_b64_tr_b16 a[22:23], v87 offset:4096
    v_mfma_f32_16x16x32_bf16 v[204:207], v[160:163], v[44:47], v[204:207]
    ds_read_b64_tr_b16 a[24:25], v88 offset:0
    ds_read_b64_tr_b16 a[26:27], v88 offset:4096
    s_add_u32 s39, s56, s62
    s_mov_b32 m0, s39
    s_add_u32 s62, s62, 4096
    s_and_b32 s62, s62, 0x7fff
    buffer_load_dwordx4 v76, s[52:55], s95 offen offset:0 nt lds
    v_mfma_f32_16x16x32_bf16 v[204:207], v[164:167], v[48:51], v[204:207]
    ds_read_b64_tr_b16 a[28:29], v89 offset:0
    ds_read_b64_tr_b16 a[30:31], v89 offset:4096
    ds_write_b128 v94, v[200:203] offset:0
    v_mfma_f32_16x16x32_bf16 v[208:211], v[168:171], v[36:39], 0
    ds_read_b64_tr_b16 a[32:33], v82 offset:8192
    ds_read_b64_tr_b16 a[34:35], v82 offset:12288
    v_mfma_f32_16x16x32_bf16 v[208:211], v[172:175], v[40:43], v[208:211]
    ds_read_b64_tr_b16 a[36:37], v83 offset:8192
    ds_read_b64_tr_b16 a[38:39], v83 offset:12288
    buffer_load_dwordx4 v77, s[52:55], s95 offen offset:1024 nt lds
    v_mfma_f32_16x16x32_bf16 v[208:211], v[176:179], v[44:47], v[208:211]
    ds_read_b64_tr_b16 a[40:41], v84 offset:8192
    ds_read_b64_tr_b16 a[42:43], v84 offset:12288
    v_mfma_f32_16x16x32_bf16 v[208:211], v[180:183], v[48:51], v[208:211]
    ds_read_b64_tr_b16 a[44:45], v85 offset:8192
    ds_read_b64_tr_b16 a[46:47], v85 offset:12288
    ds_write_b128 v94, v[204:207] offset:1024
    v_mfma_f32_16x16x32_bf16 v[212:215], v[184:187], v[36:39], 0
    ds_read_b64_tr_b16 a[48:49], v86 offset:8192
    ds_read_b64_tr_b16 a[50:51], v86 offset:12288
    buffer_load_dwordx4 v78, s[52:55], s95 offen offset:2048 nt lds
    v_mfma_f32_16x16x32_bf16 v[212:215], v[188:191], v[40:43], v[212:215]
    ds_read_b64_tr_b16 a[52:53], v87 offset:8192
    ds_read_b64_tr_b16 a[54:55], v87 offset:12288
    v_mfma_f32_16x16x32_bf16 v[212:215], v[192:195], v[44:47], v[212:215]
    ds_read_b64_tr_b16 a[56:57], v88 offset:8192
    ds_read_b64_tr_b16 a[58:59], v88 offset:12288
    v_mfma_f32_16x16x32_bf16 v[212:215], v[196:199], v[48:51], v[212:215]
    ds_read_b64_tr_b16 a[60:61], v89 offset:8192
    ds_read_b64_tr_b16 a[62:63], v89 offset:12288
    buffer_load_dwordx4 v79, s[52:55], s95 offen offset:3072 nt lds
    s_add_u32 s95, s95, 16384
    ds_write_b128 v94, v[208:211] offset:2048
    v_xor_b32 v5, 0x2000, v94
    v_xor_b32 v6, 0x4000, v94
    v_xor_b32 v7, 0x6000, v94
    s_cmp_eq_u32 s93, 14
    s_cselect_b32 s95, 16777216, s95
    ds_write_b128 v94, v[212:215] offset:3072
    v_xor_b32 v82, 0x4000, v82
    v_xor_b32 v83, 0x4000, v83
    v_xor_b32 v84, 0x4000, v84
    v_xor_b32 v85, 0x4000, v85
    v_xor_b32 v86, 0x4000, v86
    v_xor_b32 v87, 0x4000, v87
    v_xor_b32 v88, 0x4000, v88
    v_xor_b32 v89, 0x4000, v89
    v_xor_b32 v60, 0x4000, v60
    v_xor_b32 v61, 0x4000, v61
    v_xor_b32 v62, 0x4000, v62
    v_xor_b32 v63, 0x4000, v63
    s_waitcnt lgkmcnt(0)
    s_barrier
    ds_read_b128 v[136:139], v5 offset:0
    ds_read_b128 v[152:155], v6 offset:0
    ds_read_b128 v[168:171], v7 offset:0
    ds_read_b128 v[140:143], v5 offset:1024
    ds_read_b128 v[156:159], v6 offset:1024
    ds_read_b128 v[172:175], v7 offset:1024
    ds_read_b128 v[144:147], v5 offset:2048
    ds_read_b128 v[160:163], v6 offset:2048
    ds_read_b128 v[176:179], v7 offset:2048
    ds_read_b128 v[148:151], v5 offset:3072
    ds_read_b128 v[164:167], v6 offset:3072
    ds_read_b128 v[180:183], v7 offset:3072
    v_xor_b32 v94, 0x1000, v94
    s_add_u32 s39, s56, s62
    s_mov_b32 m0, s39
    s_add_u32 s62, s62, 4096
    s_and_b32 s62, s62, 0x7fff
    buffer_load_dwordx4 v76, s[52:55], s95 offen offset:0 nt lds
    buffer_load_dwordx4 v77, s[52:55], s95 offen offset:1024 nt lds
    buffer_load_dwordx4 v78, s[52:55], s95 offen offset:2048 nt lds
    s_waitcnt lgkmcnt(9)
    v_pk_add_f32 v[200:201], v[200:201], v[136:137]
    v_pk_add_f32 v[152:153], v[152:153], v[168:169]
    v_pk_add_f32 v[202:203], v[202:203], v[138:139]
    v_pk_add_f32 v[154:155], v[154:155], v[170:171]
    v_pk_add_f32 v[200:201], v[200:201], v[152:153]
    v_pk_add_f32 v[202:203], v[202:203], v[154:155]
    s_waitcnt lgkmcnt(6)
    v_pk_add_f32 v[204:205], v[204:205], v[140:141]
    v_pk_add_f32 v[156:157], v[156:157], v[172:173]
    v_pk_add_f32 v[206:207], v[206:207], v[142:143]
    v_pk_add_f32 v[158:159], v[158:159], v[174:175]
    v_pk_add_f32 v[204:205], v[204:205], v[156:157]
    v_pk_add_f32 v[206:207], v[206:207], v[158:159]
    s_waitcnt lgkmcnt(3)
    v_pk_add_f32 v[208:209], v[208:209], v[144:145]
    v_pk_add_f32 v[160:161], v[160:161], v[176:177]
    v_pk_add_f32 v[210:211], v[210:211], v[146:147]
    v_pk_add_f32 v[162:163], v[162:163], v[178:179]
    v_pk_add_f32 v[208:209], v[208:209], v[160:161]
    v_pk_add_f32 v[210:211], v[210:211], v[162:163]
    s_waitcnt lgkmcnt(0)
    v_pk_add_f32 v[212:213], v[212:213], v[148:149]
    v_pk_add_f32 v[164:165], v[164:165], v[180:181]
    v_pk_add_f32 v[214:215], v[214:215], v[150:151]
    v_pk_add_f32 v[166:167], v[166:167], v[182:183]
    v_pk_add_f32 v[212:213], v[212:213], v[164:165]
    v_pk_add_f32 v[214:215], v[214:215], v[166:167]
    buffer_load_dwordx4 v79, s[52:55], s95 offen offset:3072 nt lds
    s_add_u32 s95, s95, 16384
    s_waitcnt vmcnt(4)
    v_max_f32 v4, v200, v201
    v_max3_f32 v4, v4, v202, v203
    v_max3_f32 v4, v4, v204, v205
    v_max3_f32 v4, v4, v206, v207
    v_max3_f32 v4, v4, v208, v209
    v_max3_f32 v4, v4, v210, v211
    v_max3_f32 v4, v4, v212, v213
    v_max3_f32 v4, v4, v214, v215
    v_mov_b32 v5, v4
    ds_read_b128 v[136:139], v60 offset:0
    ds_read_b128 v[140:143], v61 offset:0
    v_permlane16_swap_b32 v4, v5
    v_max_f32 v4, v4, v5
    v_mov_b32 v5, v4
    ds_read_b128 v[144:147], v62 offset:0
    ds_read_b128 v[148:151], v63 offset:0
    v_permlane32_swap_b32 v4, v5
    v_max_f32 v4, v4, v5
    v_mul_f32 v4, s83, v4
    v_max_f32 v4, v4, v90
    v_sub_f32 v92, v90, v4
    v_exp_f32 v92, v92
    v_mov_b32 v90, v4
    s_add_u32 s39, s56, s62
    s_mov_b32 m0, s39
    s_add_u32 s62, s62, 4096
    s_and_b32 s62, s62, 0x7fff
    buffer_load_dwordx4 v76, s[52:55], s95 offen offset:0 nt lds
    v_pk_fma_f32 v[200:201], v[200:201], s[60:61], v[90:91] op_sel_hi:[1,1,0] neg_lo:[0,0,1] neg_hi:[0,0,1]
    v_pk_fma_f32 v[202:203], v[202:203], s[60:61], v[90:91] op_sel_hi:[1,1,0] neg_lo:[0,0,1] neg_hi:[0,0,1]
    v_pk_fma_f32 v[204:205], v[204:205], s[60:61], v[90:91] op_sel_hi:[1,1,0] neg_lo:[0,0,1] neg_hi:[0,0,1]
    v_pk_fma_f32 v[206:207], v[206:207], s[60:61], v[90:91] op_sel_hi:[1,1,0] neg_lo:[0,0,1] neg_hi:[0,0,1]
    v_pk_fma_f32 v[208:209], v[208:209], s[60:61], v[90:91] op_sel_hi:[1,1,0] neg_lo:[0,0,1] neg_hi:[0,0,1]
    v_pk_fma_f32 v[210:211], v[210:211], s[60:61], v[90:91] op_sel_hi:[1,1,0] neg_lo:[0,0,1] neg_hi:[0,0,1]
    v_pk_fma_f32 v[212:213], v[212:213], s[60:61], v[90:91] op_sel_hi:[1,1,0] neg_lo:[0,0,1] neg_hi:[0,0,1]
    v_pk_fma_f32 v[214:215], v[214:215], s[60:61], v[90:91] op_sel_hi:[1,1,0] neg_lo:[0,0,1] neg_hi:[0,0,1]
    v_exp_f32 v200, v200
    v_exp_f32 v201, v201
    ds_read_b128 v[152:155], v60 offset:4096
    v_exp_f32 v202, v202
    v_exp_f32 v203, v203
    v_exp_f32 v204, v204
    v_exp_f32 v205, v205
    ds_read_b128 v[156:159], v61 offset:4096
    v_exp_f32 v206, v206
    v_exp_f32 v207, v207
    buffer_load_dwordx4 v77, s[52:55], s95 offen offset:1024 nt lds
    v_exp_f32 v208, v208
    v_exp_f32 v209, v209
    ds_read_b128 v[160:163], v62 offset:4096
    v_exp_f32 v210, v210
    v_exp_f32 v211, v211
    v_exp_f32 v212, v212
    v_exp_f32 v213, v213
    ds_read_b128 v[164:167], v63 offset:4096
    v_exp_f32 v214, v214
    v_exp_f32 v215, v215
    buffer_load_dwordx4 v78, s[52:55], s95 offen offset:2048 nt lds
    v_pk_mul_f32 v[102:103], v[102:103], v[92:93] op_sel_hi:[1,0]
    v_pk_mul_f32 v[104:105], v[104:105], v[92:93] op_sel_hi:[1,0]
    v_pk_mul_f32 v[106:107], v[106:107], v[92:93] op_sel_hi:[1,0]
    v_pk_mul_f32 v[108:109], v[108:109], v[92:93] op_sel_hi:[1,0]
    v_pk_mul_f32 v[110:111], v[110:111], v[92:93] op_sel_hi:[1,0]
    v_pk_mul_f32 v[112:113], v[112:113], v[92:93] op_sel_hi:[1,0]
    v_pk_mul_f32 v[114:115], v[114:115], v[92:93] op_sel_hi:[1,0]
    v_pk_mul_f32 v[116:117], v[116:117], v[92:93] op_sel_hi:[1,0]
    v_pk_mul_f32 v[118:119], v[118:119], v[92:93] op_sel_hi:[1,0]
    v_pk_mul_f32 v[120:121], v[120:121], v[92:93] op_sel_hi:[1,0]
    v_pk_mul_f32 v[122:123], v[122:123], v[92:93] op_sel_hi:[1,0]
    v_pk_mul_f32 v[124:125], v[124:125], v[92:93] op_sel_hi:[1,0]
    v_pk_mul_f32 v[126:127], v[126:127], v[92:93] op_sel_hi:[1,0]
    v_pk_mul_f32 v[128:129], v[128:129], v[92:93] op_sel_hi:[1,0]
    v_pk_mul_f32 v[130:131], v[130:131], v[92:93] op_sel_hi:[1,0]
    v_pk_mul_f32 v[132:133], v[132:133], v[92:93] op_sel_hi:[1,0]
    v_pk_mul_f32 v[134:135], v[134:135], v[92:93] op_sel_hi:[1,0]
    buffer_load_dwordx4 v79, s[52:55], s95 offen offset:3072 nt lds
    s_add_u32 s95, s95, 16384
    v_cvt_pk_bf16_f32 v52, v200, v201
    v_pk_add_f32 v[102:103], v[102:103], v[200:201]
    v_cvt_pk_bf16_f32 v53, v202, v203
    v_pk_add_f32 v[102:103], v[102:103], v[202:203]
    v_cvt_pk_bf16_f32 v54, v204, v205
    v_pk_add_f32 v[102:103], v[102:103], v[204:205]
    v_cvt_pk_bf16_f32 v55, v206, v207
    v_pk_add_f32 v[102:103], v[102:103], v[206:207]
    v_cvt_pk_bf16_f32 v56, v208, v209
    v_pk_add_f32 v[102:103], v[102:103], v[208:209]
    v_cvt_pk_bf16_f32 v57, v210, v211
    v_pk_add_f32 v[102:103], v[102:103], v[210:211]
    v_cvt_pk_bf16_f32 v58, v212, v213
    v_pk_add_f32 v[102:103], v[102:103], v[212:213]
    v_cvt_pk_bf16_f32 v59, v214, v215
    v_pk_add_f32 v[102:103], v[102:103], v[214:215]
    v_mfma_f32_16x16x32_bf16 v[104:107], a[0:3], v[52:55], v[104:107]
    ds_read_b128 v[168:171], v60 offset:8192
    v_mfma_f32_16x16x32_bf16 v[108:111], a[4:7], v[52:55], v[108:111]
    ds_read_b128 v[172:175], v61 offset:8192
    v_mfma_f32_16x16x32_bf16 v[112:115], a[8:11], v[52:55], v[112:115]
    ds_read_b128 v[176:179], v62 offset:8192
    v_mfma_f32_16x16x32_bf16 v[116:119], a[12:15], v[52:55], v[116:119]
    ds_read_b128 v[180:183], v63 offset:8192
    v_mfma_f32_16x16x32_bf16 v[120:123], a[16:19], v[52:55], v[120:123]
    ds_read_b128 v[184:187], v60 offset:12288
    v_mfma_f32_16x16x32_bf16 v[124:127], a[20:23], v[52:55], v[124:127]
    ds_read_b128 v[188:191], v61 offset:12288
    v_mfma_f32_16x16x32_bf16 v[128:131], a[24:27], v[52:55], v[128:131]
    ds_read_b128 v[192:195], v62 offset:12288
    v_mfma_f32_16x16x32_bf16 v[132:135], a[28:31], v[52:55], v[132:135]
    ds_read_b128 v[196:199], v63 offset:12288
    v_mfma_f32_16x16x32_bf16 v[104:107], a[32:35], v[56:59], v[104:107]
    v_mfma_f32_16x16x32_bf16 v[108:111], a[36:39], v[56:59], v[108:111]
    s_add_u32 s39, s56, s62
    s_mov_b32 m0, s39
    s_add_u32 s62, s62, 4096
    s_and_b32 s62, s62, 0x7fff
    buffer_load_dwordx4 v76, s[52:55], s95 offen offset:0 nt lds
    v_mfma_f32_16x16x32_bf16 v[112:115], a[40:43], v[56:59], v[112:115]
    v_mfma_f32_16x16x32_bf16 v[116:119], a[44:47], v[56:59], v[116:119]
    v_mfma_f32_16x16x32_bf16 v[120:123], a[48:51], v[56:59], v[120:123]
    v_mfma_f32_16x16x32_bf16 v[124:127], a[52:55], v[56:59], v[124:127]
    buffer_load_dwordx4 v77, s[52:55], s95 offen offset:1024 nt lds
    v_mfma_f32_16x16x32_bf16 v[128:131], a[56:59], v[56:59], v[128:131]
    v_mfma_f32_16x16x32_bf16 v[132:135], a[60:63], v[56:59], v[132:135]
    s_add_u32 s93, s93, 1
    s_cmp_lt_u32 s93, 16
    s_cbranch_scc1 L_att
    v_add_f32 v91, v102, v103
    v_mov_b32 v5, v91
    s_nop 1
    v_permlane16_swap_b32 v91, v5
    v_add_f32 v91, v91, v5
    v_mov_b32 v5, v91
    s_nop 1
    v_permlane32_swap_b32 v91, v5
    v_add_f32 v91, v91, v5
    v_lshrrev_b32 v6, 1, v2
    v_xor_b32 v6, v6, v3
    v_lshlrev_b32 v5, 8, v3
    v_lshl_add_u32 v5, v6, 4, v5
    v_bfe_u32 v4, v2, 0, 1
    v_lshl_add_u32 v5, v4, 3, v5
    v_add_u32 v5, s85, v5
    s_waitcnt vmcnt(0) lgkmcnt(0)
    s_barrier
    v_cvt_pk_bf16_f32 v216, v104, v105
    v_cvt_pk_bf16_f32 v217, v106, v107
    v_xor_b32 v82, 0, v5
    ds_write_b64 v82, v[216:217]
    v_cvt_pk_bf16_f32 v218, v108, v109
    v_cvt_pk_bf16_f32 v219, v110, v111
    v_xor_b32 v83, 32, v5
    ds_write_b64 v83, v[218:219]
    v_cvt_pk_bf16_f32 v220, v112, v113
    v_cvt_pk_bf16_f32 v221, v114, v115
    v_xor_b32 v84, 64, v5
    ds_write_b64 v84, v[220:221]
    v_cvt_pk_bf16_f32 v222, v116, v117
    v_cvt_pk_bf16_f32 v223, v118, v119
    v_xor_b32 v85, 96, v5
    ds_write_b64 v85, v[222:223]
    v_cvt_pk_bf16_f32 v224, v120, v121
    v_cvt_pk_bf16_f32 v225, v122, v123
    v_xor_b32 v86, 128, v5
    ds_write_b64 v86, v[224:225]
    v_cvt_pk_bf16_f32 v226, v124, v125
    v_cvt_pk_bf16_f32 v227, v126, v127
    v_xor_b32 v87, 160, v5
    ds_write_b64 v87, v[226:227]
    v_cvt_pk_bf16_f32 v228, v128, v129
    v_cvt_pk_bf16_f32 v229, v130, v131
    v_xor_b32 v88, 192, v5
    ds_write_b64 v88, v[228:229]
    v_cvt_pk_bf16_f32 v230, v132, v133
    v_cvt_pk_bf16_f32 v231, v134, v135
    v_xor_b32 v89, 224, v5
    ds_write_b64 v89, v[230:231]
    v_xor_b32 v6, v3, v2
    v_lshlrev_b32 v6, 4, v6
    v_lshl_add_u32 v4, v2, 8, v6
    v_add_u32 v4, s85, v4
    v_xor_b32 v60, 0, v4
    v_xor_b32 v61, 64, v4
    v_xor_b32 v62, 128, v4
    v_xor_b32 v63, 192, v4
    v_lshlrev_b32 v7, 4, v3
    v_lshl_add_u32 v7, v2, 14, v7
    s_lshl_b32 s38, s94, 18
    s_add_u32 s36, s38, 2097152
    s_lshl_b32 s38, s3, 10
    s_add_u32 s36, s38, s36
    s_lshl_b32 s38, s34, 8
    s_add_u32 s36, s38, s36
    s_waitcnt lgkmcnt(0)
    ds_read_b128 v[200:203], v60 offset:0
    ds_read_b128 v[204:207], v61 offset:1024
    ds_read_b128 v[208:211], v62 offset:2048
    ds_read_b128 v[212:215], v63 offset:3072
    v_lshlrev_b32 v4, 3, v3
    s_lshl_b32 s38, s3, 8
    s_add_u32 s37, s38, 163840
    s_lshl_b32 s38, s94, 7
    s_add_u32 s37, s38, s37
    s_lshl_b32 s38, s34, 23
    s_add_u32 s37, s38, s37
    s_mov_b32 exec_lo, 0xffff
    s_mov_b32 exec_hi, 0x0
    buffer_store_dwordx2 v[90:91], v4, s[48:51], s37 offen sc1
    s_mov_b64 exec, -1
    s_waitcnt lgkmcnt(3)
    buffer_store_dwordx4 v[200:203], v7, s[48:51], s36 offen sc1
    s_add_u32 s36, s36, 65536
    s_waitcnt lgkmcnt(2)
    buffer_store_dwordx4 v[204:207], v7, s[48:51], s36 offen sc1
    s_add_u32 s36, s36, 65536
    s_waitcnt lgkmcnt(1)
    buffer_store_dwordx4 v[208:211], v7, s[48:51], s36 offen sc1
    s_add_u32 s36, s36, 65536
    s_waitcnt lgkmcnt(0)
    buffer_store_dwordx4 v[212:215], v7, s[48:51], s36 offen sc1
    s_bfe_u32 s38, s2, 0x20001
    s_lshl_b32 s38, s38, 0
    s_add_u32 s90, s38, 0
    s_bfe_u32 s38, s2, 0x10000
    s_lshl_b32 s38, s38, 2
    s_add_u32 s90, s38, s90
    s_and_b32 s36, s90, 3
    s_bitcmp0_b32 s90, 2
    s_cselect_b64 s[40:41], s[24:25], s[14:15]
    s_cselect_b32 s45, 262144, 0
    s_add_u32 s45, s45, 524288
    s_lshl_b32 s38, s36, 16
    s_add_u32 s71, s38, s45
    s_lshr_b32 s38, s32, 2
    s_lshl_b32 s38, s38, 13
    s_add_u32 s71, s38, s71
    s_bfe_u32 s38, s32, 0x20000
    s_lshl_b32 s38, s38, 6
    s_add_u32 s71, s38, s71
    s_mov_b32 s42, 4194304
    s_mov_b32 s43, 0x20000
    s_lshl_b32 s38, s32, 17
    s_add_u32 s44, s38, 0
    s_lshl_b32 s38, s34, 15
    s_add_u32 s44, s38, s44
    s_lshl_b32 s38, s36, 8
    s_add_u32 s44, s38, s44
    s_lshl_b32 s38, s36, 16
    s_add_u32 s45, s38, s45
    s_lshr_b32 s38, s34, 1
    s_lshl_b32 s38, s38, 15
    s_add_u32 s45, s38, s45
    s_lshl_b32 s38, s32, 8
    s_add_u32 s45, s38, s45
    s_bfe_u32 s38, s34, 0x10000
    s_lshl_b32 s38, s38, 7
    s_add_u32 s45, s38, s45
    s_lshl_b32 s38, s32, 11
    s_add_u32 s46, s38, 196608
    s_lshl_b32 s38, s34, 9
    s_add_u32 s46, s38, s46
    s_mov_b32 s72, s26
    s_and_b32 s73, s27, 0xffff
    s_mov_b32 s74, 8192
    s_mov_b32 s75, 0x20000
    s_lshl_b32 s39, s34, 13
    s_add_u32 s39, s39, 98304
    s_mov_b32 m0, s39
    s_nop 0
    buffer_load_dwordx4 v76, s[40:43], s44 offen offset:0 nt lds
    buffer_load_dwordx4 v77, s[40:43], s44 offen offset:1024 nt lds
    buffer_load_dwordx4 v78, s[40:43], s44 offen offset:2048 nt lds
    buffer_load_dwordx4 v79, s[40:43], s44 offen offset:3072 nt lds
    s_lshl_b32 s39, s34, 13
    s_add_u32 s39, s39, 102400
    s_mov_b32 m0, s39
    s_add_u32 s44, s44, 16384
    buffer_load_dwordx4 v76, s[40:43], s44 offen offset:0 nt lds
    buffer_load_dwordx4 v77, s[40:43], s44 offen offset:1024 nt lds
    buffer_load_dwordx4 v78, s[40:43], s44 offen offset:2048 nt lds
    buffer_load_dwordx4 v79, s[40:43], s44 offen offset:3072 nt lds
    v_lshlrev_b32 v30, 4, v3
    v_lshl_add_u32 v30, v2, 13, v30
    v_lshrrev_b32 v5, 2, v1
    v_lshlrev_b32 v32, 8, v5
    v_bfe_u32 v5, v1, 0, 2
    v_lshl_add_u32 v32, v5, 4, v32
    s_xor_b32 s37, s90, 4
    s_bfe_u32 s38, s37, 0x30000
    s_lshl_b32 s38, s38, 8
    s_add_u32 s36, s38, 0
    s_lshr_b32 s38, s32, 4
    s_lshl_b32 s38, s38, 7
    s_add_u32 s36, s38, s36
    s_bfe_u32 s38, s32, 0x20000
    s_lshl_b32 s38, s38, 5
    s_add_u32 s36, s38, s36
    s_bfe_u32 s38, s32, 0x20002
    s_lshl_b32 s38, s38, 3
    s_add_u32 s36, s38, s36
    v_bfe_u32 v5, v1, 0, 2
    v_lshlrev_b32 v33, 11, v5
    v_lshl_add_u32 v33, v2, 1, v33
    v_add_u32 v33, s36, v33
    v_and_b32 v5, 31, v1
    v_lshlrev_b32 v34, 4, v5
    s_mul_i32 s38, s34, 320
    s_add_u32 s38, s38, 135168
    v_lshl_add_u32 v35, v5, 3, s38
    s_bfe_u32 s38, s34, 0x10000
    s_lshl_b32 s38, s38, 12
    s_add_u32 s36, s38, s71
    s_lshr_b32 s38, s34, 1
    s_lshl_b32 s38, s38, 24
    s_add_u32 s36, s38, s36
    s_bitcmp1_b32 s90, 2
    s_cselect_b32 s46, s46, s36
    s_cselect_b64 vcc, -1, 0
    v_cndmask_b32 v54, v32, v34, vcc
    s_bfe_u32 s38, s2, 0x30000
    s_lshl_b32 s38, s38, 8
    s_add_u32 s69, s38, 32768
    v_lshrrev_b32 v64, 2, v34
    buffer_load_dword v64, v64, s[48:51], s69 offen sc1
    v_bfe_u32 v5, v3, 0, 2
    v_lshlrev_b32 v81, 10, v5
    v_lshrrev_b32 v5, 2, v3
    v_lshl_add_u32 v81, v5, 8, v81
    v_add3_u32 v82, v81, v6, s85
    v_xor_b32 v83, 64, v82
    v_xor_b32 v84, 128, v82
    v_xor_b32 v85, 192, v82
    v_bfe_u32 v5, v3, 0, 2
    v_lshlrev_b32 v94, 9, v5
    v_lshl_add_u32 v94, v2, 4, v94
    v_add_u32 v94, s85, v94
    s_lshl_b32 s38, s34, 9
    s_add_u32 s38, s38, 131072
    v_add_u32 v102, s38, v34
    s_lshl_b32 s38, s32, 14
    s_add_u32 s36, s38, 2097152
    s_lshl_b32 s38, s34, 8
    s_add_u32 s36, s38, s36
    s_lshl_b32 s38, s32, 3
    s_add_u32 s37, s38, 163840
    s_lshl_b32 s38, s32, 8
    s_add_u32 s69, s38, 131072
    s_lshl_b32 s38, s34, 23
    s_add_u32 s69, s38, s69
    v_mov_b32 v4, s69
    v_mov_b32 v5, s68
    s_waitcnt vmcnt(9)
    s_barrier
    s_mov_b64 exec, 1
    buffer_store_dword v5, v4, s[48:51], 0 offen sc1
    s_mov_b64 exec, -1
    s_mov_b32 s86, 131072
    buffer_load_dword v7, v101, s[48:51], s86 offen sc1
    s_waitcnt vmcnt(0)
L_fcheck_47:
    v_cmp_ne_u32 vcc, s68, v7
    s_cbranch_vccz L_fok_48
    s_sleep 2
    s_mov_b32 s86, 131072
    buffer_load_dword v7, v101, s[48:51], s86 offen sc1
    s_waitcnt vmcnt(0)
    s_sub_u32 s84, s84, 1
    s_cmp_lg_u32 s84, 0
    s_cbranch_scc1 L_fcheck_47
    s_branch L_end
L_fok_48:
    buffer_load_dwordx2 v[52:53], v81, s[48:51], s37 offen sc1
    buffer_load_dwordx4 v[200:203], v9, s[48:51], s36 offen sc1
    s_add_u32 s36, s36, 4096
    buffer_load_dwordx4 v[204:207], v9, s[48:51], s36 offen sc1
    s_add_u32 s36, s36, 4096
    buffer_load_dwordx4 v[208:211], v9, s[48:51], s36 offen sc1
    s_add_u32 s36, s36, 4096
    buffer_load_dwordx4 v[212:215], v9, s[48:51], s36 offen sc1
    s_waitcnt vmcnt(4)
    v_max_f32_dpp v4, v52, v52 row_ror:8 row_mask:0xf bank_mask:0xf
    s_nop 1
    v_max_f32_dpp v4, v4, v4 row_ror:4 row_mask:0xf bank_mask:0xf
    v_sub_f32 v52, v52, v4
    v_exp_f32 v52, v52
    s_nop 0
    v_mul_f32 v5, v52, v53
    s_nop 1
    v_add_f32_dpp v5, v5, v5 row_ror:8 row_mask:0xf bank_mask:0xf
    s_nop 1
    v_add_f32_dpp v5, v5, v5 row_ror:4 row_mask:0xf bank_mask:0xf
    v_rcp_f32 v5, v5
    s_nop 0
    v_mul_f32 v52, v52, v5
    s_waitcnt vmcnt(3)
    ds_write_b128 v96, v[200:203] offset:0
    s_waitcnt vmcnt(2)
    ds_write_b128 v97, v[204:207] offset:1024
    s_waitcnt vmcnt(1)
    ds_write_b128 v98, v[208:211] offset:2048
    s_waitcnt vmcnt(0)
    ds_write_b128 v99, v[212:215] offset:3072
    s_waitcnt lgkmcnt(0)
    ds_read_b128 v[136:139], v82
    ds_read_b128 v[140:143], v83
    ds_read_b128 v[144:147], v84
    ds_read_b128 v[148:151], v85
    s_waitcnt lgkmcnt(0)
    v_mfma_f32_16x16x32_bf16 v[104:107], a[128:131], v[136:139], 0
    v_mfma_f32_16x16x32_bf16 v[104:107], a[132:135], v[140:143], v[104:107]
    v_mfma_f32_16x16x32_bf16 v[104:107], a[136:139], v[144:147], v[104:107]
    v_mfma_f32_16x16x32_bf16 v[104:107], a[140:143], v[148:151], v[104:107]
    v_mfma_f32_16x16x32_bf16 v[108:111], a[144:147], v[136:139], 0
    v_mfma_f32_16x16x32_bf16 v[108:111], a[148:151], v[140:143], v[108:111]
    v_mfma_f32_16x16x32_bf16 v[108:111], a[152:155], v[144:147], v[108:111]
    v_mfma_f32_16x16x32_bf16 v[108:111], a[156:159], v[148:151], v[108:111]
    v_mfma_f32_16x16x32_bf16 v[112:115], a[160:163], v[136:139], 0
    v_mfma_f32_16x16x32_bf16 v[112:115], a[164:167], v[140:143], v[112:115]
    v_mfma_f32_16x16x32_bf16 v[112:115], a[168:171], v[144:147], v[112:115]
    v_mfma_f32_16x16x32_bf16 v[112:115], a[172:175], v[148:151], v[112:115]
    v_mul_f32 v104, v104, v52
    v_mul_f32 v105, v105, v52
    v_mul_f32 v106, v106, v52
    v_mul_f32 v107, v107, v52
    v_add_f32_dpp v104, v104, v104 row_ror:8 row_mask:0xf bank_mask:0xf
    v_add_f32_dpp v105, v105, v105 row_ror:8 row_mask:0xf bank_mask:0xf
    v_add_f32_dpp v106, v106, v106 row_ror:8 row_mask:0xf bank_mask:0xf
    v_add_f32_dpp v107, v107, v107 row_ror:8 row_mask:0xf bank_mask:0xf
    v_add_f32_dpp v104, v104, v104 row_ror:4 row_mask:0xf bank_mask:0xf
    v_add_f32_dpp v105, v105, v105 row_ror:4 row_mask:0xf bank_mask:0xf
    v_add_f32_dpp v106, v106, v106 row_ror:4 row_mask:0xf bank_mask:0xf
    v_add_f32_dpp v107, v107, v107 row_ror:4 row_mask:0xf bank_mask:0xf
    ds_write_b128 v94, v[104:107] offset:0
    v_mfma_f32_16x16x32_bf16 v[116:119], a[176:179], v[136:139], 0
    v_mfma_f32_16x16x32_bf16 v[116:119], a[180:183], v[140:143], v[116:119]
    v_mfma_f32_16x16x32_bf16 v[116:119], a[184:187], v[144:147], v[116:119]
    v_mfma_f32_16x16x32_bf16 v[116:119], a[188:191], v[148:151], v[116:119]
    v_mul_f32 v108, v108, v52
    v_mul_f32 v109, v109, v52
    v_mul_f32 v110, v110, v52
    v_mul_f32 v111, v111, v52
    v_add_f32_dpp v108, v108, v108 row_ror:8 row_mask:0xf bank_mask:0xf
    v_add_f32_dpp v109, v109, v109 row_ror:8 row_mask:0xf bank_mask:0xf
    v_add_f32_dpp v110, v110, v110 row_ror:8 row_mask:0xf bank_mask:0xf
    v_add_f32_dpp v111, v111, v111 row_ror:8 row_mask:0xf bank_mask:0xf
    v_add_f32_dpp v108, v108, v108 row_ror:4 row_mask:0xf bank_mask:0xf
    v_add_f32_dpp v109, v109, v109 row_ror:4 row_mask:0xf bank_mask:0xf
    v_add_f32_dpp v110, v110, v110 row_ror:4 row_mask:0xf bank_mask:0xf
    v_add_f32_dpp v111, v111, v111 row_ror:4 row_mask:0xf bank_mask:0xf
    ds_write_b128 v94, v[108:111] offset:64
    v_mfma_f32_16x16x32_bf16 v[120:123], a[192:195], v[136:139], 0
    v_mfma_f32_16x16x32_bf16 v[120:123], a[196:199], v[140:143], v[120:123]
    v_mfma_f32_16x16x32_bf16 v[120:123], a[200:203], v[144:147], v[120:123]
    v_mfma_f32_16x16x32_bf16 v[120:123], a[204:207], v[148:151], v[120:123]
    v_mul_f32 v112, v112, v52
    v_mul_f32 v113, v113, v52
    v_mul_f32 v114, v114, v52
    v_mul_f32 v115, v115, v52
    v_add_f32_dpp v112, v112, v112 row_ror:8 row_mask:0xf bank_mask:0xf
    v_add_f32_dpp v113, v113, v113 row_ror:8 row_mask:0xf bank_mask:0xf
    v_add_f32_dpp v114, v114, v114 row_ror:8 row_mask:0xf bank_mask:0xf
    v_add_f32_dpp v115, v115, v115 row_ror:8 row_mask:0xf bank_mask:0xf
    v_add_f32_dpp v112, v112, v112 row_ror:4 row_mask:0xf bank_mask:0xf
    v_add_f32_dpp v113, v113, v113 row_ror:4 row_mask:0xf bank_mask:0xf
    v_add_f32_dpp v114, v114, v114 row_ror:4 row_mask:0xf bank_mask:0xf
    v_add_f32_dpp v115, v115, v115 row_ror:4 row_mask:0xf bank_mask:0xf
    ds_write_b128 v94, v[112:115] offset:128
    v_mfma_f32_16x16x32_bf16 v[124:127], a[208:211], v[136:139], 0
    v_mfma_f32_16x16x32_bf16 v[124:127], a[212:215], v[140:143], v[124:127]
    v_mfma_f32_16x16x32_bf16 v[124:127], a[216:219], v[144:147], v[124:127]
    v_mfma_f32_16x16x32_bf16 v[124:127], a[220:223], v[148:151], v[124:127]
    v_mul_f32 v116, v116, v52
    v_mul_f32 v117, v117, v52
    v_mul_f32 v118, v118, v52
    v_mul_f32 v119, v119, v52
    v_add_f32_dpp v116, v116, v116 row_ror:8 row_mask:0xf bank_mask:0xf
    v_add_f32_dpp v117, v117, v117 row_ror:8 row_mask:0xf bank_mask:0xf
    v_add_f32_dpp v118, v118, v118 row_ror:8 row_mask:0xf bank_mask:0xf
    v_add_f32_dpp v119, v119, v119 row_ror:8 row_mask:0xf bank_mask:0xf
    v_add_f32_dpp v116, v116, v116 row_ror:4 row_mask:0xf bank_mask:0xf
    v_add_f32_dpp v117, v117, v117 row_ror:4 row_mask:0xf bank_mask:0xf
    v_add_f32_dpp v118, v118, v118 row_ror:4 row_mask:0xf bank_mask:0xf
    v_add_f32_dpp v119, v119, v119 row_ror:4 row_mask:0xf bank_mask:0xf
    ds_write_b128 v94, v[116:119] offset:192
    v_mfma_f32_16x16x32_bf16 v[128:131], a[224:227], v[136:139], 0
    v_mfma_f32_16x16x32_bf16 v[128:131], a[228:231], v[140:143], v[128:131]
    v_mfma_f32_16x16x32_bf16 v[128:131], a[232:235], v[144:147], v[128:131]
    v_mfma_f32_16x16x32_bf16 v[128:131], a[236:239], v[148:151], v[128:131]
    v_mul_f32 v120, v120, v52
    v_mul_f32 v121, v121, v52
    v_mul_f32 v122, v122, v52
    v_mul_f32 v123, v123, v52
    v_add_f32_dpp v120, v120, v120 row_ror:8 row_mask:0xf bank_mask:0xf
    v_add_f32_dpp v121, v121, v121 row_ror:8 row_mask:0xf bank_mask:0xf
    v_add_f32_dpp v122, v122, v122 row_ror:8 row_mask:0xf bank_mask:0xf
    v_add_f32_dpp v123, v123, v123 row_ror:8 row_mask:0xf bank_mask:0xf
    v_add_f32_dpp v120, v120, v120 row_ror:4 row_mask:0xf bank_mask:0xf
    v_add_f32_dpp v121, v121, v121 row_ror:4 row_mask:0xf bank_mask:0xf
    v_add_f32_dpp v122, v122, v122 row_ror:4 row_mask:0xf bank_mask:0xf
    v_add_f32_dpp v123, v123, v123 row_ror:4 row_mask:0xf bank_mask:0xf
    ds_write_b128 v94, v[120:123] offset:256
    v_mfma_f32_16x16x32_bf16 v[132:135], a[240:243], v[136:139], 0
    v_mfma_f32_16x16x32_bf16 v[132:135], a[244:247], v[140:143], v[132:135]
    v_mfma_f32_16x16x32_bf16 v[132:135], a[248:251], v[144:147], v[132:135]
    v_mfma_f32_16x16x32_bf16 v[132:135], a[252:255], v[148:151], v[132:135]
    v_mul_f32 v124, v124, v52
    v_mul_f32 v125, v125, v52
    v_mul_f32 v126, v126, v52
    v_mul_f32 v127, v127, v52
    v_add_f32_dpp v124, v124, v124 row_ror:8 row_mask:0xf bank_mask:0xf
    v_add_f32_dpp v125, v125, v125 row_ror:8 row_mask:0xf bank_mask:0xf
    v_add_f32_dpp v126, v126, v126 row_ror:8 row_mask:0xf bank_mask:0xf
    v_add_f32_dpp v127, v127, v127 row_ror:8 row_mask:0xf bank_mask:0xf
    v_add_f32_dpp v124, v124, v124 row_ror:4 row_mask:0xf bank_mask:0xf
    v_add_f32_dpp v125, v125, v125 row_ror:4 row_mask:0xf bank_mask:0xf
    v_add_f32_dpp v126, v126, v126 row_ror:4 row_mask:0xf bank_mask:0xf
    v_add_f32_dpp v127, v127, v127 row_ror:4 row_mask:0xf bank_mask:0xf
    ds_write_b128 v94, v[124:127] offset:320
    v_mul_f32 v128, v128, v52
    v_mul_f32 v129, v129, v52
    v_mul_f32 v130, v130, v52
    v_mul_f32 v131, v131, v52
    v_add_f32_dpp v128, v128, v128 row_ror:8 row_mask:0xf bank_mask:0xf
    v_add_f32_dpp v129, v129, v129 row_ror:8 row_mask:0xf bank_mask:0xf
    v_add_f32_dpp v130, v130, v130 row_ror:8 row_mask:0xf bank_mask:0xf
    v_add_f32_dpp v131, v131, v131 row_ror:8 row_mask:0xf bank_mask:0xf
    v_add_f32_dpp v128, v128, v128 row_ror:4 row_mask:0xf bank_mask:0xf
    v_add_f32_dpp v129, v129, v129 row_ror:4 row_mask:0xf bank_mask:0xf
    v_add_f32_dpp v130, v130, v130 row_ror:4 row_mask:0xf bank_mask:0xf
    v_add_f32_dpp v131, v131, v131 row_ror:4 row_mask:0xf bank_mask:0xf
    ds_write_b128 v94, v[128:131] offset:384
    v_mul_f32 v132, v132, v52
    v_mul_f32 v133, v133, v52
    v_mul_f32 v134, v134, v52
    v_mul_f32 v135, v135, v52
    v_add_f32_dpp v132, v132, v132 row_ror:8 row_mask:0xf bank_mask:0xf
    v_add_f32_dpp v133, v133, v133 row_ror:8 row_mask:0xf bank_mask:0xf
    v_add_f32_dpp v134, v134, v134 row_ror:8 row_mask:0xf bank_mask:0xf
    v_add_f32_dpp v135, v135, v135 row_ror:8 row_mask:0xf bank_mask:0xf
    v_add_f32_dpp v132, v132, v132 row_ror:4 row_mask:0xf bank_mask:0xf
    v_add_f32_dpp v133, v133, v133 row_ror:4 row_mask:0xf bank_mask:0xf
    v_add_f32_dpp v134, v134, v134 row_ror:4 row_mask:0xf bank_mask:0xf
    v_add_f32_dpp v135, v135, v135 row_ror:4 row_mask:0xf bank_mask:0xf
    ds_write_b128 v94, v[132:135] offset:448
    s_waitcnt lgkmcnt(0)
    s_barrier
    ds_read_b128 v[136:139], v102 offset:0
    ds_read_b128 v[140:143], v102 offset:8192
    ds_read_b128 v[144:147], v102 offset:16384
    ds_read_b128 v[148:151], v102 offset:24576
    s_waitcnt lgkmcnt(0)
    v_add_f32 v136, v136, v140
    v_add_f32 v144, v144, v148
    v_add_f32 v137, v137, v141
    v_add_f32 v145, v145, v149
    v_add_f32 v138, v138, v142
    v_add_f32 v146, v146, v150
    v_add_f32 v139, v139, v143
    v_add_f32 v147, v147, v151
    v_add_f32 v136, v136, v144
    v_add_f32 v137, v137, v145
    v_add_f32 v138, v138, v146
    v_add_f32 v139, v139, v147
    s_mov_b32 s38, 0xffff0000
    v_cvt_pk_bf16_f32 v136, v136, v136
    v_cvt_pk_bf16_f32 v137, v137, v137
    v_cvt_pk_bf16_f32 v138, v138, v138
    v_cvt_pk_bf16_f32 v139, v139, v139
    v_and_or_b32 v136, v136, s38, v8
    v_and_or_b32 v137, v137, s38, v8
    v_and_or_b32 v138, v138, s38, v8
    v_and_or_b32 v139, v139, s38, v8
    s_lshl_b32 s38, s32, 11
    s_add_u32 s36, s38, 196608
    s_lshl_b32 s38, s34, 9
    s_add_u32 s36, s38, s36
    s_mov_b32 exec_lo, 0xffffffff
    s_mov_b32 exec_hi, 0x0
    buffer_store_dwordx4 v[136:139], v34, s[48:51], s36 offen sc1
    s_mov_b64 exec, -1
    v_xor_b32 v224, s35, v136
    v_xor_b32 v225, s35, v137
    v_xor_b32 v226, s35, v138
    v_xor_b32 v227, s35, v139
    v_lshlrev_b32 v4, 11, v2
    v_bfe_u32 v5, v1, 2, 2
    v_lshl_add_u32 v4, v5, 8, v4
    v_bfe_u32 v5, v1, 2, 2
    v_lshl_add_u32 v4, v5, 6, v4
    v_bfe_u32 v5, v1, 4, 1
    v_lshl_add_u32 v4, v5, 5, v4
    v_bfe_u32 v5, v1, 1, 1
    v_lshl_add_u32 v4, v5, 4, v4
    v_bfe_u32 v5, v1, 0, 1
    v_lshl_add_u32 v4, v5, 3, v4
    s_lshl_b32 s38, s34, 6
    s_add_u32 s38, s38, 98304
    v_xor_b32 v24, s38, v4
    v_xor_b32 v25, 16, v24
    v_xor_b32 v26, 32, v24
    v_xor_b32 v27, 48, v24
    v_and_b32 v4, 3, v3
    v_lshrrev_b32 v5, 2, v3
    v_lshlrev_b32 v6, 4, v2
    v_add_u32 v6, 135168, v6
    s_movk_i32 s36, 320
    v_cmp_eq_u32 vcc, 0, v5
    s_nop 1
    v_cndmask_b32 v28, 4, v4, vcc
    v_mad_u32_u24 v28, v28, s36, v6
    v_cmp_eq_u32 vcc, 1, v5
    s_nop 1
    v_cndmask_b32 v29, 4, v4, vcc
    v_mad_u32_u24 v29, v29, s36, v6
    v_lshlrev_b32 v5, 2, v1
    v_add_u32 v5, 136448, v5
    v_mov_b32 v6, 0
    ds_write_b32 v5, v6
    v_cmp_ne_u32 vcc, s70, v64
    s_nop 0
    s_cmp_eq_u64 vcc, 0
    s_cselect_b32 s70, 1, 0
    s_bitcmp1_b32 s90, 2
    s_cbranch_scc1 L_ctxok
    s_mov_b32 s3, s34
    buffer_load_dwordx4 v[224:227], v54, s[48:51], s46 offen sc1
    v_lshlrev_b32 v4, 2, v2
    v_xor_b32 v4, v4, v3
    v_xor_b32 v5, 0, v4
    v_lshlrev_b32 v5, 4, v5
    v_lshl_add_u32 v20, v2, 10, v5
    v_xor_b32 v5, 1, v4
    v_lshlrev_b32 v5, 4, v5
    v_lshl_add_u32 v21, v2, 10, v5
    v_add_u32 v21, 3072, v21
    v_xor_b32 v5, 2, v4
    v_lshlrev_b32 v5, 4, v5
    v_lshl_add_u32 v22, v2, 10, v5
    v_add_u32 v22, 6144, v22
    v_xor_b32 v5, 3, v4
    v_lshlrev_b32 v5, 4, v5
    v_lshl_add_u32 v23, v2, 10, v5
    v_add_u32 v23, 9216, v23
    s_lshl_b32 s38, s32, 15
    s_add_u32 s47, s38, 1048576
    s_lshl_b32 s38, s3, 13
    s_add_u32 s47, s38, s47
    v_lshlrev_b32 v6, 7, v2
    v_bfe_u32 v5, v3, 0, 3
    v_lshl_add_u32 v6, v5, 4, v6
    v_lshrrev_b32 v4, 3, v3
    v_and_b32 v7, 3, v3
    v_min_u32 v7, 2, v7
    v_lshl_add_u32 v7, v7, 1, v4
    v_add_u32 v5, 0, v4
    v_cmp_le_u32 vcc, s33, v5
    s_nop 1
    v_addc_co_u32 v5, vcc, 0, v5, vcc
    v_lshl_add_u32 v50, v5, 10, v6
    v_add_u32 v5, 2, v4
    v_cmp_le_u32 vcc, s33, v5
    s_nop 1
    v_addc_co_u32 v5, vcc, 0, v5, vcc
    v_lshl_add_u32 v51, v5, 10, v6
    v_add_u32 v5, 4, v4
    v_cmp_le_u32 vcc, s33, v5
    s_nop 1
    v_addc_co_u32 v5, vcc, 0, v5, vcc
    v_lshl_add_u32 v52, v5, 10, v6
    v_mov_b32 v5, v7
    v_mov_b32 v6, 512
    v_cmp_le_u32 vcc, s33, v5
    s_nop 1
    v_addc_co_u32 v5, vcc, 0, v5, vcc
    v_lshl_add_u32 v53, v5, 10, v6
    s_mul_i32 s38, s3, 320
    s_add_u32 s38, s38, 135168
    v_lshlrev_b32 v4, 6, v2
    v_lshl_add_u32 v4, v3, 1, v4
    v_add_u32 v31, s38, v4
    v_lshlrev_b32 v4, 7, v2
    v_lshl_add_u32 v4, v3, 4, v4
    v_mov_b32 v5, 512
    v_cmp_gt_u32 vcc, 8, v3
    s_nop 1
    v_cndmask_b32 v79, v5, v4, vcc
    s_add_u32 s37, s47, 6144
    s_mov_b32 s86, 0x88888888
    s_mov_b32 s87, 0x88888888
    v_mov_b32 v120, 0xff7f0000
L_auxpoll:
    buffer_load_dwordx4 v[204:207], v53, s[48:51], s47 offen sc1
    buffer_load_dwordx4 v[192:195], v50, s[48:51], s47 offen sc1
    buffer_load_dwordx4 v[196:199], v51, s[48:51], s47 offen sc1
    buffer_load_dwordx4 v[200:203], v52, s[48:51], s47 offen sc1
    buffer_load_dwordx4 v[104:107], v79, s[48:51], s37 offen sc1
    s_waitcnt vmcnt(0)
    v_xor_b32 v104, s35, v104
    v_xor_b32 v105, s35, v105
    v_xor_b32 v106, s35, v106
    v_xor_b32 v107, s35, v107
    v_xor_b32 v192, s35, v192
    v_xor_b32 v193, s35, v193
    v_xor_b32 v194, s35, v194
    v_xor_b32 v195, s35, v195
    v_xor_b32 v196, s35, v196
    v_xor_b32 v197, s35, v197
    v_xor_b32 v198, s35, v198
    v_xor_b32 v199, s35, v199
    v_xor_b32 v200, s35, v200
    v_xor_b32 v201, s35, v201
    v_xor_b32 v202, s35, v202
    v_xor_b32 v203, s35, v203
    v_xor_b32 v204, s35, v204
    v_xor_b32 v205, s35, v205
    v_xor_b32 v206, s35, v206
    v_xor_b32 v207, s35, v207
    v_or_b32 v4, v104, v105
    v_or3_b32 v4, v4, v106, v107
    v_or3_b32 v4, v4, v192, v193
    v_or3_b32 v4, v4, v194, v195
    v_or3_b32 v4, v4, v196, v197
    v_or3_b32 v4, v4, v198, v199
    v_or3_b32 v4, v4, v200, v201
    v_or3_b32 v4, v4, v202, v203
    v_or3_b32 v4, v4, v204, v205
    v_or3_b32 v4, v4, v206, v207
    v_and_b32 v4, 0xff, v4
    v_cmp_ne_u32 vcc, 0, v4
    v_add_f32 v123, v104, v106
    v_add_f32 v122, v204, v206
    v_mov_b32_dpp v121, v105 row_newbcast:8 row_mask:0xf bank_mask:0xf
    v_mov_b32_dpp v120, v123 row_newbcast:8 row_mask:0xf bank_mask:0x3
    s_cbranch_vccz L_hop1ok
    s_sub_u32 s84, s84, 1
    s_cmp_lg_u32 s84, 0
    s_cbranch_scc1 L_auxpoll
    s_branch L_end
.section .rodata,"a"
.p2align 6
.amdhsa_kernel concat_heads__compressed_kv_cla__mha_block_cached__decode_kernel
  .amdhsa_next_free_vgpr 512
  .amdhsa_next_free_sgpr 102
  .amdhsa_accum_offset 256
  .amdhsa_group_segment_fixed_size 0
  .amdhsa_kernarg_size 112
  .amdhsa_user_sgpr_count 2
  .amdhsa_user_sgpr_kernarg_segment_ptr 1
  .amdhsa_system_sgpr_workgroup_id_x 1
.end_amdhsa_kernel
```

```asm
; @launch grid=(256,1,1) block=(256,1,1) lds=163840
    .amdgcn_target "amdgcn-amd-amdhsa--gfx950"
    .text
    .globl concat_heads__compressed_kv_cla__mha_block_cached__decode_kernel
    .p2align 8
    .type concat_heads__compressed_kv_cla__mha_block_cached__decode_kernel,@function
concat_heads__compressed_kv_cla__mha_block_cached__decode_kernel:
    s_cmp_ge_u32 s2, 256
    s_cbranch_scc1 L_end
    s_load_dwordx16 s[4:19], s[0:1], 0
    s_load_dwordx8 s[20:27], s[0:1], 64
    s_load_dwordx4 s[28:31], s[0:1], 96
    v_lshrrev_b32 v4, 6, v0
    v_and_b32 v1, 63, v0
    v_readfirstlane_b32 s34, v4
    s_lshr_b32 s32, s2, 3
    s_sub_u32 s33, s2, s32
    s_sub_u32 s33, s33, 1
    s_and_b32 s33, s33, 7
    v_lshrrev_b32 v2, 4, v1
    v_and_b32 v3, 15, v1
    s_cmp_lt_u32 s33, 2
    s_cbranch_scc1 L_qp
    s_cmp_eq_u32 s33, 2
    s_cbranch_scc1 L_ql
    s_cmp_eq_u32 s33, 7
    s_cbranch_scc1 L_aux
    s_bfe_u32 s38, s2, 0x30000
    s_lshl_b32 s38, s38, 21
    s_add_u32 s36, s38, -393216
    s_lshr_b32 s38, s32, 3
    s_lshl_b32 s38, s38, 19
    s_add_u32 s36, s38, s36
    s_lshl_b32 s38, s33, 17
    s_add_u32 s36, s38, s36
    s_lshl_b32 s38, s34, 12
    s_add_u32 s36, s38, s36
    v_bfe_u32 v5, v1, 0, 5
    v_lshlrev_b32 v4, 7, v5
    v_lshrrev_b32 v5, 5, v1
    v_lshl_add_u32 v4, v5, 15, v4
    s_mov_b32 s42, 16777216
    s_mov_b32 s43, 0x20000
    s_waitcnt lgkmcnt(0)
    s_mov_b64 s[40:41], s[6:7]
    buffer_load_dword v20, v4, s[40:43], s36 offen
    s_add_u32 s36, s36, 16384
    buffer_load_dword v21, v4, s[40:43], s36 offen
    s_add_u32 s36, s36, 49152
    buffer_load_dword v22, v4, s[40:43], s36 offen
    s_add_u32 s36, s36, 16384
    buffer_load_dword v23, v4, s[40:43], s36 offen
    s_load_dword s35, s[30:31], 0
    s_mov_b32 s48, s30
    s_and_b32 s49, s31, 0xffff
    s_mov_b32 s50, 8388608
    s_mov_b32 s51, 0x20000
    s_mov_b32 s82, 0xffffff00
    s_mov_b32 s83, 0x3e0293ee
    s_mov_b32 s84, 2097152
    v_lshrrev_b32 v4, 2, v3
    v_and_b32 v5, 3, v3
    v_lshlrev_b32 v76, 8, v4
    v_lshlrev_b32 v126, 8, v2
    v_lshl_add_u32 v76, v2, 6, v76
    v_lshl_add_u32 v76, v5, 4, v76
    v_lshl_add_u32 v126, v3, 4, v126
    v_xor_b32 v77, 32768, v76
    v_xor_b32 v127, 32768, v126
    s_add_u32 s3, s34, s33
    s_and_b32 s3, s3, 3
    s_lshl_b32 s89, s3, 5
    s_add_u32 s89, s89, s32
    s_lshl_b32 s89, s89, 20
    s_mul_i32 s88, s32, 8
    s_add_u32 s88, s88, s3
    s_lshl_b32 s87, s33, 0
    s_mov_b32 s52, s18
    s_and_b32 s53, s19, 0xffff
    s_mov_b32 s54, 134217728
    s_mov_b32 s55, 0x20000
    s_mov_b32 s56, s20
    s_and_b32 s57, s21, 0xffff
    s_mov_b32 s58, 134217728
    s_mov_b32 s59, 0x20000
    v_and_b32 v4, 1, v1
    v_lshlrev_b32 v4, 4, v4
    v_mov_b32 v5, 0xffff
    v_lshlrev_b32 v4, v4, v5
    v_bfe_u32 v5, v1, 1, 2
    v_cmp_eq_u32 vcc, 0, v5
    s_nop 1
    v_cndmask_b32 v10, 0, v4, vcc
    v_cmp_eq_u32 vcc, 1, v5
    s_nop 1
    v_cndmask_b32 v11, 0, v4, vcc
    v_cmp_eq_u32 vcc, 2, v5
    s_nop 1
    v_cndmask_b32 v12, 0, v4, vcc
    v_cmp_eq_u32 vcc, 3, v5
    s_nop 1
    v_cndmask_b32 v13, 0, v4, vcc
    v_mov_b32 v120, 0xff7f0000
    v_mov_b32 v121, 0
    v_mov_b32 v18, 1
    v_mov_b32 v116, 0
    v_mov_b32 v117, 0
    v_mov_b32 v118, 0
    v_mov_b32 v119, 0
    v_lshlrev_b32 v0, 3, v1
    ds_write_b64 v0, v[116:117] offset:8192
    v_mov_b32 v0, 8192
    s_lshl_b32 s38, s32, 10
    s_add_u32 s96, s38, 65536
    s_lshr_b32 s38, s32, 3
    s_lshl_b32 s38, s38, 8
    s_add_u32 s96, s38, s96
    v_mov_b32 v9, s96
    s_lshl_b32 s38, s32, 15
    s_add_u32 s96, s38, 1048576
    s_lshl_b32 s38, s3, 13
    s_add_u32 s96, s38, s96
    s_lshl_b32 s38, s33, 10
    s_add_u32 s96, s38, s96
    v_and_b32 v5, 3, v3
    v_lshlrev_b32 v78, 7, v2
    v_lshl_add_u32 v78, v5, 5, v78
    s_lshl_b32 s38, s32, 12
    s_add_u32 s91, s38, 262144
    s_lshl_b32 s38, s3, 9
    s_add_u32 s91, s38, s91
    v_lshlrev_b32 v4, 7, v2
    v_lshl_add_u32 v4, v3, 4, v4
    v_mov_b32 v5, 512
    v_cmp_gt_u32 vcc, 8, v3
    s_nop 1
    v_cndmask_b32 v79, v5, v4, vcc
    s_add_u32 s39, s87, s88
    s_bfe_u32 s37, s39, 0x30000
    s_lshl_b32 s37, s37, 12
    s_add_u32 s85, s37, s89
    s_bfe_u32 s37, s39, 0x10003
    s_lshl_b32 s37, s37, 11
    s_add_u32 s85, s37, s85
    s_bfe_u32 s37, s39, 0x40004
    s_lshl_b32 s37, s37, 16
    s_add_u32 s85, s37, s85
    buffer_load_dwordx4 v[128:131], v76, s[52:55], s85 offen offset:0 nt
    buffer_load_dwordx4 v[132:135], v77, s[52:55], s85 offen offset:0 nt
    buffer_load_dwordx4 v[136:139], v76, s[52:55], s85 offen offset:1024 nt
    buffer_load_dwordx4 v[140:143], v77, s[52:55], s85 offen offset:1024 nt
    s_add_u32 s87, s87, 7
    s_add_u32 s39, s87, s88
    s_bfe_u32 s37, s39, 0x30000
    s_lshl_b32 s37, s37, 12
    s_add_u32 s85, s37, s89
    s_bfe_u32 s37, s39, 0x10003
    s_lshl_b32 s37, s37, 11
    s_add_u32 s85, s37, s85
    s_bfe_u32 s37, s39, 0x40004
    s_lshl_b32 s37, s37, 16
    s_add_u32 s85, s37, s85
    buffer_load_dwordx4 v[144:147], v76, s[52:55], s85 offen offset:0 nt
    buffer_load_dwordx4 v[148:151], v77, s[52:55], s85 offen offset:0 nt
    buffer_load_dwordx4 v[152:155], v76, s[52:55], s85 offen offset:1024 nt
    s_waitcnt lgkmcnt(0)
    s_add_u32 s35, s35, 0x5b
    s_and_b32 s35, s35, 0xff
    v_mov_b32 v8, s35
    s_barrier
    s_waitcnt vmcnt(6)
    buffer_load_dwordx4 v[156:159], v77, s[52:55], s85 offen offset:1024 nt
    s_add_u32 s87, s87, 7
    s_add_u32 s39, s87, s88
    s_bfe_u32 s37, s39, 0x30000
    s_lshl_b32 s37, s37, 12
    s_add_u32 s85, s37, s89
    s_bfe_u32 s37, s39, 0x10003
    s_lshl_b32 s37, s37, 11
    s_add_u32 s85, s37, s85
    s_bfe_u32 s37, s39, 0x40004
    s_lshl_b32 s37, s37, 16
    s_add_u32 s85, s37, s85
    s_waitcnt vmcnt(6)
    buffer_load_dwordx4 v[160:163], v76, s[52:55], s85 offen offset:0 nt
    s_waitcnt vmcnt(6)
    buffer_load_dwordx4 v[164:167], v77, s[52:55], s85 offen offset:0 nt
    s_waitcnt vmcnt(6)
    buffer_load_dwordx4 v[168:171], v76, s[52:55], s85 offen offset:1024 nt
    s_waitcnt vmcnt(6)
    buffer_load_dwordx4 v[172:175], v77, s[52:55], s85 offen offset:1024 nt
    s_add_u32 s87, s87, 7
    s_add_u32 s39, s87, s88
    s_bfe_u32 s37, s39, 0x30000
    s_lshl_b32 s37, s37, 12
    s_add_u32 s85, s37, s89
    s_bfe_u32 s37, s39, 0x10003
    s_lshl_b32 s37, s37, 11
    s_add_u32 s85, s37, s85
    s_bfe_u32 s37, s39, 0x40004
    s_lshl_b32 s37, s37, 16
    s_add_u32 s85, s37, s85
    s_waitcnt vmcnt(6)
    buffer_load_dwordx4 v[176:179], v76, s[52:55], s85 offen offset:0 nt
    s_waitcnt vmcnt(6)
    buffer_load_dwordx4 v[180:183], v77, s[52:55], s85 offen offset:0 nt
    s_waitcnt vmcnt(6)
    buffer_load_dwordx4 v[184:187], v76, s[52:55], s85 offen offset:1024 nt
    s_waitcnt vmcnt(6)
    buffer_load_dwordx4 v[188:191], v77, s[52:55], s85 offen offset:1024 nt
    s_add_u32 s87, s87, 7
    s_add_u32 s39, s87, s88
    s_bfe_u32 s37, s39, 0x30000
    s_lshl_b32 s37, s37, 12
    s_add_u32 s85, s37, s89
    s_bfe_u32 s37, s39, 0x10003
    s_lshl_b32 s37, s37, 11
    s_add_u32 s85, s37, s85
    s_bfe_u32 s37, s39, 0x40004
    s_lshl_b32 s37, s37, 16
    s_add_u32 s85, s37, s85
    s_waitcnt vmcnt(6)
    buffer_load_dwordx4 v[192:195], v76, s[52:55], s85 offen offset:0 nt
    s_waitcnt vmcnt(6)
    buffer_load_dwordx4 v[196:199], v77, s[52:55], s85 offen offset:0 nt
    s_waitcnt vmcnt(6)
    buffer_load_dwordx4 v[200:203], v76, s[52:55], s85 offen offset:1024 nt
    s_waitcnt vmcnt(6)
    buffer_load_dwordx4 v[204:207], v77, s[52:55], s85 offen offset:1024 nt
    s_add_u32 s87, s87, 7
    s_add_u32 s39, s87, s88
    s_bfe_u32 s37, s39, 0x30000
    s_lshl_b32 s37, s37, 12
    s_add_u32 s85, s37, s89
    s_bfe_u32 s37, s39, 0x10003
    s_lshl_b32 s37, s37, 11
    s_add_u32 s85, s37, s85
    s_bfe_u32 s37, s39, 0x40004
    s_lshl_b32 s37, s37, 16
    s_add_u32 s85, s37, s85
    s_waitcnt vmcnt(6)
    buffer_load_dwordx4 v[208:211], v76, s[52:55], s85 offen offset:0 nt
    s_waitcnt vmcnt(6)
    buffer_load_dwordx4 v[212:215], v77, s[52:55], s85 offen offset:0 nt
    s_waitcnt vmcnt(6)
    buffer_load_dwordx4 v[216:219], v76, s[52:55], s85 offen offset:1024 nt
    s_waitcnt vmcnt(6)
    buffer_load_dwordx4 v[220:223], v77, s[52:55], s85 offen offset:1024 nt
    s_add_u32 s87, s87, 7
    s_add_u32 s39, s87, s88
    s_bfe_u32 s37, s39, 0x30000
    s_lshl_b32 s37, s37, 12
    s_add_u32 s85, s37, s89
    s_bfe_u32 s37, s39, 0x10003
    s_lshl_b32 s37, s37, 11
    s_add_u32 s85, s37, s85
    s_bfe_u32 s37, s39, 0x40004
    s_lshl_b32 s37, s37, 16
    s_add_u32 s85, s37, s85
    s_waitcnt vmcnt(6)
    buffer_load_dwordx4 v[224:227], v76, s[52:55], s85 offen offset:0 nt
    s_waitcnt vmcnt(6)
    buffer_load_dwordx4 v[228:231], v77, s[52:55], s85 offen offset:0 nt
    s_waitcnt vmcnt(6)
    buffer_load_dwordx4 v[232:235], v76, s[52:55], s85 offen offset:1024 nt
    s_waitcnt vmcnt(6)
    buffer_load_dwordx4 v[236:239], v77, s[52:55], s85 offen offset:1024 nt
    s_add_u32 s87, s87, 7
    s_add_u32 s39, s87, s88
    s_bfe_u32 s37, s39, 0x30000
    s_lshl_b32 s37, s37, 12
    s_add_u32 s85, s37, s89
    s_bfe_u32 s37, s39, 0x10003
    s_lshl_b32 s37, s37, 11
    s_add_u32 s85, s37, s85
    s_bfe_u32 s37, s39, 0x40004
    s_lshl_b32 s37, s37, 16
    s_add_u32 s85, s37, s85
    s_waitcnt vmcnt(6)
    buffer_load_dwordx4 v[240:243], v76, s[52:55], s85 offen offset:0 nt
    s_waitcnt vmcnt(6)
    buffer_load_dwordx4 v[244:247], v77, s[52:55], s85 offen offset:0 nt
    s_waitcnt vmcnt(6)
    buffer_load_dwordx4 v[248:251], v76, s[52:55], s85 offen offset:1024 nt
    s_waitcnt vmcnt(6)
    buffer_load_dwordx4 v[252:255], v77, s[52:55], s85 offen offset:1024 nt
    s_add_u32 s87, s87, 7
    s_add_u32 s39, s87, s88
    s_bfe_u32 s37, s39, 0x30000
    s_lshl_b32 s37, s37, 12
    s_add_u32 s85, s37, s89
    s_bfe_u32 s37, s39, 0x10003
    s_lshl_b32 s37, s37, 11
    s_add_u32 s85, s37, s85
    s_bfe_u32 s37, s39, 0x40004
    s_lshl_b32 s37, s37, 16
    s_add_u32 s85, s37, s85
    s_waitcnt vmcnt(6)
    buffer_load_dwordx4 a[0:3], v76, s[52:55], s85 offen offset:0 nt
    s_waitcnt vmcnt(6)
    buffer_load_dwordx4 a[4:7], v77, s[52:55], s85 offen offset:0 nt
    s_waitcnt vmcnt(6)
    buffer_load_dwordx4 a[8:11], v76, s[52:55], s85 offen offset:1024 nt
    s_waitcnt vmcnt(6)
    buffer_load_dwordx4 a[12:15], v77, s[52:55], s85 offen offset:1024 nt
    s_add_u32 s87, s87, 7
    s_add_u32 s39, s87, s88
    s_bfe_u32 s37, s39, 0x30000
    s_lshl_b32 s37, s37, 12
    s_add_u32 s85, s37, s89
    s_bfe_u32 s37, s39, 0x10003
    s_lshl_b32 s37, s37, 11
    s_add_u32 s85, s37, s85
    s_bfe_u32 s37, s39, 0x40004
    s_lshl_b32 s37, s37, 16
    s_add_u32 s85, s37, s85
    s_waitcnt vmcnt(6)
    buffer_load_dwordx4 a[16:19], v76, s[52:55], s85 offen offset:0 nt
    s_waitcnt vmcnt(6)
    buffer_load_dwordx4 a[20:23], v77, s[52:55], s85 offen offset:0 nt
    s_waitcnt vmcnt(6)
    buffer_load_dwordx4 a[24:27], v76, s[52:55], s85 offen offset:1024 nt
    s_waitcnt vmcnt(6)
    buffer_load_dwordx4 a[28:31], v77, s[52:55], s85 offen offset:1024 nt
    s_add_u32 s87, s87, 7
    s_add_u32 s39, s87, s88
    s_bfe_u32 s37, s39, 0x30000
    s_lshl_b32 s37, s37, 12
    s_add_u32 s85, s37, s89
    s_bfe_u32 s37, s39, 0x10003
    s_lshl_b32 s37, s37, 11
    s_add_u32 s85, s37, s85
    s_bfe_u32 s37, s39, 0x40004
    s_lshl_b32 s37, s37, 16
    s_add_u32 s85, s37, s85
    s_waitcnt vmcnt(6)
    buffer_load_dwordx4 a[32:35], v76, s[52:55], s85 offen offset:0 nt
    s_waitcnt vmcnt(6)
    buffer_load_dwordx4 a[36:39], v77, s[52:55], s85 offen offset:0 nt
    s_waitcnt vmcnt(6)
    buffer_load_dwordx4 a[40:43], v76, s[52:55], s85 offen offset:1024 nt
    s_waitcnt vmcnt(6)
    buffer_load_dwordx4 a[44:47], v77, s[52:55], s85 offen offset:1024 nt
    s_add_u32 s87, s87, 7
    s_add_u32 s39, s87, s88
    s_bfe_u32 s37, s39, 0x30000
    s_lshl_b32 s37, s37, 12
    s_add_u32 s85, s37, s89
    s_bfe_u32 s37, s39, 0x10003
    s_lshl_b32 s37, s37, 11
    s_add_u32 s85, s37, s85
    s_bfe_u32 s37, s39, 0x40004
    s_lshl_b32 s37, s37, 16
    s_add_u32 s85, s37, s85
    s_waitcnt vmcnt(6)
    buffer_load_dwordx4 a[48:51], v76, s[52:55], s85 offen offset:0 nt
    s_waitcnt vmcnt(6)
    buffer_load_dwordx4 a[52:55], v77, s[52:55], s85 offen offset:0 nt
    buffer_load_dwordx4 v[68:71], v78, s[48:51], s91 offen offset:0 sc1
    buffer_load_dwordx4 v[72:75], v78, s[48:51], s91 offen offset:16 sc1
    s_waitcnt vmcnt(8)
    buffer_load_dwordx4 a[56:59], v76, s[52:55], s85 offen offset:1024 nt
    s_waitcnt vmcnt(8)
    buffer_load_dwordx4 a[60:63], v77, s[52:55], s85 offen offset:1024 nt
    s_add_u32 s87, s87, 7
    s_add_u32 s39, s87, s88
    s_bfe_u32 s37, s39, 0x30000
    s_lshl_b32 s37, s37, 12
    s_add_u32 s85, s37, s89
    s_bfe_u32 s37, s39, 0x10003
    s_lshl_b32 s37, s37, 11
    s_add_u32 s85, s37, s85
    s_bfe_u32 s37, s39, 0x40004
    s_lshl_b32 s37, s37, 16
    s_add_u32 s85, s37, s85
    s_waitcnt vmcnt(8)
    buffer_load_dwordx4 a[64:67], v76, s[52:55], s85 offen offset:0 nt
    s_waitcnt vmcnt(8)
    buffer_load_dwordx4 a[68:71], v77, s[52:55], s85 offen offset:0 nt
    s_waitcnt vmcnt(8)
    buffer_load_dwordx4 a[72:75], v76, s[52:55], s85 offen offset:1024 nt
    s_waitcnt vmcnt(8)
    buffer_load_dwordx4 a[76:79], v77, s[52:55], s85 offen offset:1024 nt
    s_add_u32 s87, s87, 7
    s_add_u32 s39, s87, s88
    s_bfe_u32 s37, s39, 0x30000
    s_lshl_b32 s37, s37, 12
    s_add_u32 s85, s37, s89
    s_bfe_u32 s37, s39, 0x10003
    s_lshl_b32 s37, s37, 11
    s_add_u32 s85, s37, s85
    s_bfe_u32 s37, s39, 0x40004
    s_lshl_b32 s37, s37, 16
    s_add_u32 s85, s37, s85
    s_waitcnt vmcnt(6)
L_qcheck_1:
    v_xor_b32 v68, s35, v68
    v_xor_b32 v69, s35, v69
    v_xor_b32 v70, s35, v70
    v_xor_b32 v71, s35, v71
    v_xor_b32 v72, s35, v72
    v_xor_b32 v73, s35, v73
    v_xor_b32 v74, s35, v74
    v_xor_b32 v75, s35, v75
    v_or_b32 v4, v68, v69
    v_or3_b32 v4, v4, v70, v71
    v_or3_b32 v4, v4, v72, v73
    v_or3_b32 v4, v4, v74, v75
    v_and_b32 v4, 0xff, v4
    v_cmp_ne_u32 vcc, 0, v4
    s_cbranch_vccz L_qok_2
    buffer_load_dwordx4 v[68:71], v78, s[48:51], s91 offen offset:0 sc1
    buffer_load_dwordx4 v[72:75], v78, s[48:51], s91 offen offset:16 sc1
    s_waitcnt vmcnt(0)
    s_sub_u32 s84, s84, 1
    s_cmp_lg_u32 s84, 0
    s_cbranch_scc1 L_qcheck_1
    s_branch L_end
L_qok_2:
    v_cvt_pk_bf16_f32 v68, v68, v69
    v_cvt_pk_bf16_f32 v69, v70, v71
    v_cvt_pk_bf16_f32 v70, v72, v73
    v_cvt_pk_bf16_f32 v71, v74, v75
    s_mov_b32 vcc_lo, 0xf000f
    s_mov_b32 vcc_hi, 0xf000f
    v_cndmask_b32 v80, 0, v68, vcc
    v_cndmask_b32 v81, 0, v69, vcc
    v_cndmask_b32 v82, 0, v70, vcc
    v_cndmask_b32 v83, 0, v71, vcc
    s_mov_b32 vcc_lo, 0xf000f0
    s_mov_b32 vcc_hi, 0xf000f0
    v_cndmask_b32 v84, 0, v68, vcc
    v_cndmask_b32 v85, 0, v69, vcc
    v_cndmask_b32 v86, 0, v70, vcc
    v_cndmask_b32 v87, 0, v71, vcc
    s_mov_b32 vcc_lo, 0xf000f00
    s_mov_b32 vcc_hi, 0xf000f00
    v_cndmask_b32 v88, 0, v68, vcc
    v_cndmask_b32 v89, 0, v69, vcc
    v_cndmask_b32 v90, 0, v70, vcc
    v_cndmask_b32 v91, 0, v71, vcc
    s_mov_b32 vcc_lo, 0xf000f000
    s_mov_b32 vcc_hi, 0xf000f000
    v_cndmask_b32 v92, 0, v68, vcc
    v_cndmask_b32 v93, 0, v69, vcc
    v_cndmask_b32 v94, 0, v70, vcc
    v_cndmask_b32 v95, 0, v71, vcc
    s_getreg_b32 s70, hwreg(HW_REG_XCC_ID, 0, 4)
    s_lshl_b32 s70, s70, 8
    s_or_b32 s70, s70, s35
    s_or_b32 s70, s70, 0x5e9d0000
    s_bfe_u32 s38, s2, 0x30000
    s_lshl_b32 s38, s38, 8
    s_add_u32 s69, s38, 32768
    s_lshl_b32 s38, s32, 2
    s_add_u32 s69, s38, s69
    s_lshl_b32 s38, s34, 24
    s_add_u32 s69, s38, s69
    v_mov_b32 v72, s69
    v_mov_b32 v73, s70
    s_mov_b64 exec, 1
    buffer_store_dword v73, v72, s[48:51], 0 offen sc1
    s_mov_b64 exec, -1
    v_mov_b32 v65, 0xff7f0000
    s_lshl_b32 s38, s34, 14
    s_add_u32 s38, s38, 16384
    v_lshl_add_u32 v64, v1, 2, s38
    buffer_load_dwordx4 a[80:83], v76, s[52:55], s85 offen offset:0 nt
    v_mfma_f32_16x16x32_bf16 v[112:115], v[128:131], v[80:83], 0
    v_mfma_f32_16x16x32_bf16 v[112:115], v[132:135], v[84:87], v[112:115]
    v_mfma_f32_16x16x32_bf16 v[112:115], v[136:139], v[88:91], v[112:115]
    s_waitcnt vmcnt(7)
    buffer_load_dwordx4 a[84:87], v77, s[52:55], s85 offen offset:0 nt
    v_mfma_f32_16x16x32_bf16 v[112:115], v[140:143], v[92:95], v[112:115]
    v_mfma_f32_16x16x32_bf16 v[96:99], v[144:147], v[80:83], 0
    v_mfma_f32_16x16x32_bf16 v[96:99], v[148:151], v[84:87], v[96:99]
    v_mfma_f32_16x16x32_bf16 v[96:99], v[152:155], v[88:91], v[96:99]
    s_nop 4
    v_mov_b32_dpp v122, v112 quad_perm:[0,0,0,0] row_mask:0xf bank_mask:0xf
    v_mov_b32_dpp v124, v114 quad_perm:[2,2,2,2] row_mask:0xf bank_mask:0xf
    s_nop 0
    v_add_f32_dpp v122, v113, v122 quad_perm:[1,1,1,1] row_mask:0xf bank_mask:0xf
    v_add_f32_dpp v124, v115, v124 quad_perm:[3,3,3,3] row_mask:0xf bank_mask:0xf
    v_add_f32 v122, v122, v124
    v_max_f32 v65, v65, v122
    ds_write_b32 v64, v122 offset:0
    s_waitcnt vmcnt(7)
    buffer_load_dwordx4 a[88:91], v76, s[52:55], s85 offen offset:1024 nt
    v_mfma_f32_16x16x32_bf16 v[96:99], v[156:159], v[92:95], v[96:99]
    v_mfma_f32_16x16x32_bf16 v[112:115], v[160:163], v[80:83], 0
    v_mfma_f32_16x16x32_bf16 v[112:115], v[164:167], v[84:87], v[112:115]
    s_waitcnt vmcnt(7)
    buffer_load_dwordx4 a[92:95], v77, s[52:55], s85 offen offset:1024 nt
    s_add_u32 s87, s87, 7
    s_add_u32 s39, s87, s88
    s_bfe_u32 s37, s39, 0x30000
    s_lshl_b32 s37, s37, 12
    s_add_u32 s85, s37, s89
    s_bfe_u32 s37, s39, 0x10003
    s_lshl_b32 s37, s37, 11
    s_add_u32 s85, s37, s85
    s_bfe_u32 s37, s39, 0x40004
    s_lshl_b32 s37, s37, 16
    s_add_u32 s85, s37, s85
    v_mfma_f32_16x16x32_bf16 v[112:115], v[168:171], v[88:91], v[112:115]
    v_mov_b32_dpp v122, v96 quad_perm:[0,0,0,0] row_mask:0xf bank_mask:0xf
    v_mov_b32_dpp v124, v98 quad_perm:[2,2,2,2] row_mask:0xf bank_mask:0xf
    s_nop 0
    v_add_f32_dpp v122, v97, v122 quad_perm:[1,1,1,1] row_mask:0xf bank_mask:0xf
    v_add_f32_dpp v124, v99, v124 quad_perm:[3,3,3,3] row_mask:0xf bank_mask:0xf
    v_add_f32 v122, v122, v124
    v_max_f32 v65, v65, v122
    ds_write_b32 v64, v122 offset:256
    v_mfma_f32_16x16x32_bf16 v[112:115], v[172:175], v[92:95], v[112:115]
    v_mfma_f32_16x16x32_bf16 v[96:99], v[176:179], v[80:83], 0
    v_mfma_f32_16x16x32_bf16 v[96:99], v[180:183], v[84:87], v[96:99]
    s_waitcnt vmcnt(7)
    buffer_load_dwordx4 a[96:99], v76, s[52:55], s85 offen offset:0 nt
    v_mfma_f32_16x16x32_bf16 v[96:99], v[184:187], v[88:91], v[96:99]
    s_nop 2
    v_mov_b32_dpp v122, v112 quad_perm:[0,0,0,0] row_mask:0xf bank_mask:0xf
    v_mov_b32_dpp v124, v114 quad_perm:[2,2,2,2] row_mask:0xf bank_mask:0xf
    s_nop 0
    v_add_f32_dpp v122, v113, v122 quad_perm:[1,1,1,1] row_mask:0xf bank_mask:0xf
    v_add_f32_dpp v124, v115, v124 quad_perm:[3,3,3,3] row_mask:0xf bank_mask:0xf
    v_add_f32 v122, v122, v124
    v_max_f32 v65, v65, v122
    ds_write_b32 v64, v122 offset:512
    v_mfma_f32_16x16x32_bf16 v[96:99], v[188:191], v[92:95], v[96:99]
    v_mfma_f32_16x16x32_bf16 v[112:115], v[192:195], v[80:83], 0
    s_waitcnt vmcnt(7)
    buffer_load_dwordx4 a[100:103], v77, s[52:55], s85 offen offset:0 nt
    v_mfma_f32_16x16x32_bf16 v[112:115], v[196:199], v[84:87], v[112:115]
    v_mfma_f32_16x16x32_bf16 v[112:115], v[200:203], v[88:91], v[112:115]
    s_nop 2
    v_mov_b32_dpp v122, v96 quad_perm:[0,0,0,0] row_mask:0xf bank_mask:0xf
    v_mov_b32_dpp v124, v98 quad_perm:[2,2,2,2] row_mask:0xf bank_mask:0xf
    s_nop 0
    v_add_f32_dpp v122, v97, v122 quad_perm:[1,1,1,1] row_mask:0xf bank_mask:0xf
    v_add_f32_dpp v124, v99, v124 quad_perm:[3,3,3,3] row_mask:0xf bank_mask:0xf
    v_add_f32 v122, v122, v124
    v_max_f32 v65, v65, v122
    ds_write_b32 v64, v122 offset:768
    v_mfma_f32_16x16x32_bf16 v[112:115], v[204:207], v[92:95], v[112:115]
    v_mfma_f32_16x16x32_bf16 v[96:99], v[208:211], v[80:83], 0
    s_waitcnt vmcnt(7)
    buffer_load_dwordx4 a[104:107], v76, s[52:55], s85 offen offset:1024 nt
    v_mfma_f32_16x16x32_bf16 v[96:99], v[212:215], v[84:87], v[96:99]
    v_mfma_f32_16x16x32_bf16 v[96:99], v[216:219], v[88:91], v[96:99]
    s_nop 2
    v_mov_b32_dpp v122, v112 quad_perm:[0,0,0,0] row_mask:0xf bank_mask:0xf
    v_mov_b32_dpp v124, v114 quad_perm:[2,2,2,2] row_mask:0xf bank_mask:0xf
    s_nop 0
    v_add_f32_dpp v122, v113, v122 quad_perm:[1,1,1,1] row_mask:0xf bank_mask:0xf
    v_add_f32_dpp v124, v115, v124 quad_perm:[3,3,3,3] row_mask:0xf bank_mask:0xf
    v_add_f32 v122, v122, v124
    v_max_f32 v65, v65, v122
    ds_write_b32 v64, v122 offset:1024
    v_mfma_f32_16x16x32_bf16 v[96:99], v[220:223], v[92:95], v[96:99]
    s_waitcnt vmcnt(6)
    buffer_load_dwordx4 a[108:111], v77, s[52:55], s85 offen offset:1024 nt
    s_add_u32 s87, s87, 7
    s_add_u32 s39, s87, s88
    s_bfe_u32 s37, s39, 0x30000
    s_lshl_b32 s37, s37, 12
    s_add_u32 s85, s37, s89
    s_bfe_u32 s37, s39, 0x10003
    s_lshl_b32 s37, s37, 11
    s_add_u32 s85, s37, s85
    s_bfe_u32 s37, s39, 0x40004
    s_lshl_b32 s37, s37, 16
    s_add_u32 s85, s37, s85
    v_mfma_f32_16x16x32_bf16 v[112:115], v[224:227], v[80:83], 0
    v_mfma_f32_16x16x32_bf16 v[112:115], v[228:231], v[84:87], v[112:115]
    v_mfma_f32_16x16x32_bf16 v[112:115], v[232:235], v[88:91], v[112:115]
    v_mov_b32_dpp v122, v96 quad_perm:[0,0,0,0] row_mask:0xf bank_mask:0xf
    v_mov_b32_dpp v124, v98 quad_perm:[2,2,2,2] row_mask:0xf bank_mask:0xf
    s_nop 0
    v_add_f32_dpp v122, v97, v122 quad_perm:[1,1,1,1] row_mask:0xf bank_mask:0xf
    v_add_f32_dpp v124, v99, v124 quad_perm:[3,3,3,3] row_mask:0xf bank_mask:0xf
    v_add_f32 v122, v122, v124
    v_max_f32 v65, v65, v122
    ds_write_b32 v64, v122 offset:1280
    v_mfma_f32_16x16x32_bf16 v[112:115], v[236:239], v[92:95], v[112:115]
    s_waitcnt vmcnt(6)
    buffer_load_dwordx4 a[112:115], v76, s[52:55], s85 offen offset:0 nt
    v_mfma_f32_16x16x32_bf16 v[96:99], v[240:243], v[80:83], 0
    v_mfma_f32_16x16x32_bf16 v[96:99], v[244:247], v[84:87], v[96:99]
    v_mfma_f32_16x16x32_bf16 v[96:99], v[248:251], v[88:91], v[96:99]
    s_nop 2
    v_mov_b32_dpp v122, v112 quad_perm:[0,0,0,0] row_mask:0xf bank_mask:0xf
    v_mov_b32_dpp v124, v114 quad_perm:[2,2,2,2] row_mask:0xf bank_mask:0xf
    s_nop 0
    v_add_f32_dpp v122, v113, v122 quad_perm:[1,1,1,1] row_mask:0xf bank_mask:0xf
    v_add_f32_dpp v124, v115, v124 quad_perm:[3,3,3,3] row_mask:0xf bank_mask:0xf
    v_add_f32 v122, v122, v124
    v_max_f32 v65, v65, v122
    ds_write_b32 v64, v122 offset:1536
    v_mfma_f32_16x16x32_bf16 v[96:99], v[252:255], v[92:95], v[96:99]
    s_waitcnt vmcnt(6)
    buffer_load_dwordx4 a[116:119], v77, s[52:55], s85 offen offset:0 nt
    v_mfma_f32_16x16x32_bf16 v[112:115], a[0:3], v[80:83], 0
    v_mfma_f32_16x16x32_bf16 v[112:115], a[4:7], v[84:87], v[112:115]
    v_mfma_f32_16x16x32_bf16 v[112:115], a[8:11], v[88:91], v[112:115]
    s_nop 2
    v_mov_b32_dpp v122, v96 quad_perm:[0,0,0,0] row_mask:0xf bank_mask:0xf
    v_mov_b32_dpp v124, v98 quad_perm:[2,2,2,2] row_mask:0xf bank_mask:0xf
    s_nop 0
    v_add_f32_dpp v122, v97, v122 quad_perm:[1,1,1,1] row_mask:0xf bank_mask:0xf
    v_add_f32_dpp v124, v99, v124 quad_perm:[3,3,3,3] row_mask:0xf bank_mask:0xf
    v_add_f32 v122, v122, v124
    v_max_f32 v65, v65, v122
    ds_write_b32 v64, v122 offset:1792
    s_waitcnt vmcnt(6)
    buffer_load_dwordx4 a[120:123], v76, s[52:55], s85 offen offset:1024 nt
    v_mfma_f32_16x16x32_bf16 v[112:115], a[12:15], v[92:95], v[112:115]
    v_mfma_f32_16x16x32_bf16 v[96:99], a[16:19], v[80:83], 0
    v_mfma_f32_16x16x32_bf16 v[96:99], a[20:23], v[84:87], v[96:99]
    v_mfma_f32_16x16x32_bf16 v[96:99], a[24:27], v[88:91], v[96:99]
    s_nop 4
    v_mov_b32_dpp v122, v112 quad_perm:[0,0,0,0] row_mask:0xf bank_mask:0xf
    v_mov_b32_dpp v124, v114 quad_perm:[2,2,2,2] row_mask:0xf bank_mask:0xf
    s_nop 0
    v_add_f32_dpp v122, v113, v122 quad_perm:[1,1,1,1] row_mask:0xf bank_mask:0xf
    v_add_f32_dpp v124, v115, v124 quad_perm:[3,3,3,3] row_mask:0xf bank_mask:0xf
    v_add_f32 v122, v122, v124
    v_max_f32 v65, v65, v122
    ds_write_b32 v64, v122 offset:2048
    s_waitcnt vmcnt(6)
    buffer_load_dwordx4 a[124:127], v77, s[52:55], s85 offen offset:1024 nt
    s_add_u32 s87, s87, 7
    s_add_u32 s39, s87, s88
    s_bfe_u32 s37, s39, 0x30000
    s_lshl_b32 s37, s37, 12
    s_add_u32 s85, s37, s89
    s_bfe_u32 s37, s39, 0x10003
    s_lshl_b32 s37, s37, 11
    s_add_u32 s85, s37, s85
    s_bfe_u32 s37, s39, 0x40004
    s_lshl_b32 s37, s37, 16
    s_add_u32 s85, s37, s85
    v_mfma_f32_16x16x32_bf16 v[96:99], a[28:31], v[92:95], v[96:99]
    v_mfma_f32_16x16x32_bf16 v[112:115], a[32:35], v[80:83], 0
    s_bfe_u32 s38, s2, 0x20001
    s_lshl_b32 s38, s38, 0
    s_add_u32 s90, s38, 0
    s_bfe_u32 s38, s2, 0x10000
    s_lshl_b32 s38, s38, 2
    s_add_u32 s90, s38, s90
    s_and_b32 s36, s90, 3
    s_bitcmp0_b32 s90, 2
    s_cselect_b64 s[40:41], s[24:25], s[14:15]
    s_cselect_b32 s45, 262144, 0
    s_add_u32 s45, s45, 524288
    s_lshl_b32 s38, s36, 16
    s_add_u32 s71, s38, s45
    s_lshr_b32 s38, s32, 2
    s_lshl_b32 s38, s38, 13
    s_add_u32 s71, s38, s71
    s_bfe_u32 s38, s32, 0x20000
    s_lshl_b32 s38, s38, 6
    s_add_u32 s71, s38, s71
    s_mov_b32 s42, 4194304
    s_mov_b32 s43, 0x20000
    s_lshl_b32 s38, s32, 17
    s_add_u32 s44, s38, 0
    s_lshl_b32 s38, s34, 15
    s_add_u32 s44, s38, s44
    s_lshl_b32 s38, s36, 8
    s_add_u32 s44, s38, s44
    s_lshl_b32 s38, s36, 16
    s_add_u32 s45, s38, s45
    s_lshr_b32 s38, s34, 1
    s_lshl_b32 s38, s38, 15
    s_add_u32 s45, s38, s45
    s_lshl_b32 s38, s32, 8
    s_add_u32 s45, s38, s45
    s_bfe_u32 s38, s34, 0x10000
    s_lshl_b32 s38, s38, 7
    s_add_u32 s45, s38, s45
    s_lshl_b32 s38, s32, 11
    s_add_u32 s46, s38, 196608
    s_lshl_b32 s38, s34, 9
    s_add_u32 s46, s38, s46
    s_mov_b32 s72, s26
    s_and_b32 s73, s27, 0xffff
    s_mov_b32 s74, 8192
    s_mov_b32 s75, 0x20000
    v_mfma_f32_16x16x32_bf16 v[112:115], a[36:39], v[84:87], v[112:115]
    s_waitcnt vmcnt(5)
    buffer_load_dwordx4 v[128:131], v76, s[52:55], s85 offen offset:0 nt
    v_mfma_f32_16x16x32_bf16 v[112:115], a[40:43], v[88:91], v[112:115]
    v_mov_b32_dpp v122, v96 quad_perm:[0,0,0,0] row_mask:0xf bank_mask:0xf
    v_mov_b32_dpp v124, v98 quad_perm:[2,2,2,2] row_mask:0xf bank_mask:0xf
    s_nop 0
    v_add_f32_dpp v122, v97, v122 quad_perm:[1,1,1,1] row_mask:0xf bank_mask:0xf
    v_add_f32_dpp v124, v99, v124 quad_perm:[3,3,3,3] row_mask:0xf bank_mask:0xf
    v_add_f32 v122, v122, v124
    v_max_f32 v65, v65, v122
    ds_write_b32 v64, v122 offset:2304
    v_mfma_f32_16x16x32_bf16 v[112:115], a[44:47], v[92:95], v[112:115]
    v_mfma_f32_16x16x32_bf16 v[96:99], a[48:51], v[80:83], 0
    v_mfma_f32_16x16x32_bf16 v[96:99], a[52:55], v[84:87], v[96:99]
    s_waitcnt vmcnt(5)
    buffer_load_dwordx4 v[132:135], v77, s[52:55], s85 offen offset:0 nt
    v_mfma_f32_16x16x32_bf16 v[96:99], a[56:59], v[88:91], v[96:99]
    s_nop 2
    v_mov_b32_dpp v122, v112 quad_perm:[0,0,0,0] row_mask:0xf bank_mask:0xf
    v_mov_b32_dpp v124, v114 quad_perm:[2,2,2,2] row_mask:0xf bank_mask:0xf
    s_nop 0
    v_add_f32_dpp v122, v113, v122 quad_perm:[1,1,1,1] row_mask:0xf bank_mask:0xf
    v_add_f32_dpp v124, v115, v124 quad_perm:[3,3,3,3] row_mask:0xf bank_mask:0xf
    v_add_f32 v122, v122, v124
    v_max_f32 v65, v65, v122
    ds_write_b32 v64, v122 offset:2560
    v_lshlrev_b32 v4, 2, v2
    v_xor_b32 v4, v4, v3
    v_xor_b32 v5, 0, v4
    v_lshlrev_b32 v5, 4, v5
    v_lshl_add_u32 v20, v2, 10, v5
    v_xor_b32 v5, 1, v4
    v_lshlrev_b32 v5, 4, v5
    v_lshl_add_u32 v21, v2, 10, v5
    v_add_u32 v21, 3072, v21
    v_xor_b32 v5, 2, v4
    v_lshlrev_b32 v5, 4, v5
    v_lshl_add_u32 v22, v2, 10, v5
    v_add_u32 v22, 6144, v22
    v_xor_b32 v5, 3, v4
    v_lshlrev_b32 v5, 4, v5
    v_lshl_add_u32 v23, v2, 10, v5
    v_add_u32 v23, 9216, v23
    s_lshl_b32 s38, s32, 15
    s_add_u32 s47, s38, 1048576
    s_lshl_b32 s38, s3, 13
    s_add_u32 s47, s38, s47
    v_lshlrev_b32 v6, 7, v2
    v_bfe_u32 v5, v3, 0, 3
    v_lshl_add_u32 v6, v5, 4, v6
    v_lshrrev_b32 v4, 3, v3
    v_and_b32 v7, 3, v3
    v_min_u32 v7, 2, v7
    v_lshl_add_u32 v7, v7, 1, v4
    v_add_u32 v5, 0, v4
    v_cmp_le_u32 vcc, s33, v5
    s_nop 1
    v_addc_co_u32 v5, vcc, 0, v5, vcc
    v_lshl_add_u32 v50, v5, 10, v6
    v_add_u32 v5, 2, v4
    v_cmp_le_u32 vcc, s33, v5
    s_nop 1
    v_addc_co_u32 v5, vcc, 0, v5, vcc
    v_lshl_add_u32 v51, v5, 10, v6
    v_add_u32 v5, 4, v4
    v_cmp_le_u32 vcc, s33, v5
    s_nop 1
    v_addc_co_u32 v5, vcc, 0, v5, vcc
    v_lshl_add_u32 v52, v5, 10, v6
    v_mov_b32 v5, v7
    v_mov_b32 v6, 512
    v_cmp_le_u32 vcc, s33, v5
    s_nop 1
    v_addc_co_u32 v5, vcc, 0, v5, vcc
    v_lshl_add_u32 v53, v5, 10, v6
    s_mul_i32 s38, s3, 320
    s_add_u32 s38, s38, 135168
    v_lshlrev_b32 v4, 6, v2
    v_lshl_add_u32 v4, v3, 1, v4
    v_add_u32 v31, s38, v4
    v_mfma_f32_16x16x32_bf16 v[96:99], a[60:63], v[92:95], v[96:99]
    v_mfma_f32_16x16x32_bf16 v[112:115], a[64:67], v[80:83], 0
    s_waitcnt vmcnt(5)
    buffer_load_dwordx4 v[136:139], v76, s[52:55], s85 offen offset:1024 nt
    v_mfma_f32_16x16x32_bf16 v[112:115], a[68:71], v[84:87], v[112:115]
    v_mfma_f32_16x16x32_bf16 v[112:115], a[72:75], v[88:91], v[112:115]
    s_nop 2
    v_mov_b32_dpp v122, v96 quad_perm:[0,0,0,0] row_mask:0xf bank_mask:0xf
    v_mov_b32_dpp v124, v98 quad_perm:[2,2,2,2] row_mask:0xf bank_mask:0xf
    s_nop 0
    v_add_f32_dpp v122, v97, v122 quad_perm:[1,1,1,1] row_mask:0xf bank_mask:0xf
    v_add_f32_dpp v124, v99, v124 quad_perm:[3,3,3,3] row_mask:0xf bank_mask:0xf
    v_add_f32 v122, v122, v124
    v_max_f32 v65, v65, v122
    ds_write_b32 v64, v122 offset:2816
    v_mfma_f32_16x16x32_bf16 v[112:115], a[76:79], v[92:95], v[112:115]
    v_mfma_f32_16x16x32_bf16 v[96:99], a[80:83], v[80:83], 0
    v_lshlrev_b32 v4, 11, v2
    v_bfe_u32 v5, v1, 2, 2
    v_lshl_add_u32 v4, v5, 8, v4
    v_bfe_u32 v5, v1, 2, 2
    v_lshl_add_u32 v4, v5, 6, v4
    v_bfe_u32 v5, v1, 4, 1
    v_lshl_add_u32 v4, v5, 5, v4
    v_bfe_u32 v5, v1, 1, 1
    v_lshl_add_u32 v4, v5, 4, v4
    v_bfe_u32 v5, v1, 0, 1
    v_lshl_add_u32 v4, v5, 3, v4
    s_lshl_b32 s38, s34, 6
    s_add_u32 s38, s38, 98304
    v_xor_b32 v24, s38, v4
    v_xor_b32 v25, 16, v24
    v_xor_b32 v26, 32, v24
    v_xor_b32 v27, 48, v24
    v_and_b32 v4, 3, v3
    v_lshrrev_b32 v5, 2, v3
    v_lshlrev_b32 v6, 4, v2
    v_add_u32 v6, 135168, v6
    s_movk_i32 s36, 320
    v_cmp_eq_u32 vcc, 0, v5
    s_nop 1
    v_cndmask_b32 v28, 4, v4, vcc
    v_mad_u32_u24 v28, v28, s36, v6
    v_cmp_eq_u32 vcc, 1, v5
    s_nop 1
    v_cndmask_b32 v29, 4, v4, vcc
    v_mad_u32_u24 v29, v29, s36, v6
    v_lshlrev_b32 v5, 2, v1
    v_add_u32 v5, 136448, v5
    v_mov_b32 v6, 0
    ds_write_b32 v5, v6
    s_waitcnt vmcnt(5)
    buffer_load_dwordx4 v[140:143], v77, s[52:55], s85 offen offset:1024 nt
    s_add_u32 s87, s87, 7
    s_add_u32 s39, s87, s88
    s_bfe_u32 s37, s39, 0x30000
    s_lshl_b32 s37, s37, 12
    s_add_u32 s85, s37, s89
    s_bfe_u32 s37, s39, 0x10003
    s_lshl_b32 s37, s37, 11
    s_add_u32 s85, s37, s85
    s_bfe_u32 s37, s39, 0x40004
    s_lshl_b32 s37, s37, 16
    s_add_u32 s85, s37, s85
    v_mfma_f32_16x16x32_bf16 v[96:99], a[84:87], v[84:87], v[96:99]
    v_mfma_f32_16x16x32_bf16 v[96:99], a[88:91], v[88:91], v[96:99]
    v_mov_b32_dpp v122, v112 quad_perm:[0,0,0,0] row_mask:0xf bank_mask:0xf
    v_mov_b32_dpp v124, v114 quad_perm:[2,2,2,2] row_mask:0xf bank_mask:0xf
    s_nop 0
    v_add_f32_dpp v122, v113, v122 quad_perm:[1,1,1,1] row_mask:0xf bank_mask:0xf
    v_add_f32_dpp v124, v115, v124 quad_perm:[3,3,3,3] row_mask:0xf bank_mask:0xf
    v_add_f32 v122, v122, v124
    v_max_f32 v65, v65, v122
    ds_write_b32 v64, v122 offset:3072
    v_mfma_f32_16x16x32_bf16 v[96:99], a[92:95], v[92:95], v[96:99]
    s_waitcnt vmcnt(5)
    buffer_load_dwordx4 v[144:147], v76, s[52:55], s85 offen offset:0 nt
    v_mfma_f32_16x16x32_bf16 v[112:115], a[96:99], v[80:83], 0
    v_mfma_f32_16x16x32_bf16 v[112:115], a[100:103], v[84:87], v[112:115]
    v_mfma_f32_16x16x32_bf16 v[112:115], a[104:107], v[88:91], v[112:115]
    s_nop 2
    v_mov_b32_dpp v122, v96 quad_perm:[0,0,0,0] row_mask:0xf bank_mask:0xf
    v_mov_b32_dpp v124, v98 quad_perm:[2,2,2,2] row_mask:0xf bank_mask:0xf
    s_nop 0
    v_add_f32_dpp v122, v97, v122 quad_perm:[1,1,1,1] row_mask:0xf bank_mask:0xf
    v_add_f32_dpp v124, v99, v124 quad_perm:[3,3,3,3] row_mask:0xf bank_mask:0xf
    v_add_f32 v122, v122, v124
    v_max_f32 v65, v65, v122
    ds_write_b32 v64, v122 offset:3328
    v_lshlrev_b32 v30, 4, v3
    v_lshl_add_u32 v30, v2, 13, v30
    v_lshrrev_b32 v5, 2, v1
    v_lshlrev_b32 v32, 8, v5
    v_bfe_u32 v5, v1, 0, 2
    v_lshl_add_u32 v32, v5, 4, v32
    s_xor_b32 s37, s90, 4
    s_bfe_u32 s38, s37, 0x30000
    s_lshl_b32 s38, s38, 8
    s_add_u32 s36, s38, 0
    s_lshr_b32 s38, s32, 4
    s_lshl_b32 s38, s38, 7
    s_add_u32 s36, s38, s36
    s_bfe_u32 s38, s32, 0x20000
    s_lshl_b32 s38, s38, 5
    s_add_u32 s36, s38, s36
    s_bfe_u32 s38, s32, 0x20002
    s_lshl_b32 s38, s38, 3
    s_add_u32 s36, s38, s36
    v_bfe_u32 v5, v1, 0, 2
    v_lshlrev_b32 v33, 11, v5
    v_lshl_add_u32 v33, v2, 1, v33
    v_add_u32 v33, s36, v33
    v_and_b32 v5, 31, v1
    v_lshlrev_b32 v34, 4, v5
    s_mul_i32 s38, s34, 320
    s_add_u32 s38, s38, 135168
    v_lshl_add_u32 v35, v5, 3, s38
    s_bfe_u32 s38, s34, 0x10000
    s_lshl_b32 s38, s38, 12
    s_add_u32 s36, s38, s71
    s_lshr_b32 s38, s34, 1
    s_lshl_b32 s38, s38, 24
    s_add_u32 s36, s38, s36
    s_bitcmp1_b32 s90, 2
    s_cselect_b32 s46, s46, s36
    s_cselect_b64 vcc, -1, 0
    v_cndmask_b32 v54, v32, v34, vcc
    v_mfma_f32_16x16x32_bf16 v[112:115], a[108:111], v[92:95], v[112:115]
    s_waitcnt vmcnt(5)
    buffer_load_dwordx4 v[148:151], v77, s[52:55], s85 offen offset:0 nt
    v_mfma_f32_16x16x32_bf16 v[96:99], a[112:115], v[80:83], 0
    v_mfma_f32_16x16x32_bf16 v[96:99], a[116:119], v[84:87], v[96:99]
    v_mfma_f32_16x16x32_bf16 v[96:99], a[120:123], v[88:91], v[96:99]
    s_nop 2
    v_mov_b32_dpp v122, v112 quad_perm:[0,0,0,0] row_mask:0xf bank_mask:0xf
    v_mov_b32_dpp v124, v114 quad_perm:[2,2,2,2] row_mask:0xf bank_mask:0xf
    s_nop 0
    v_add_f32_dpp v122, v113, v122 quad_perm:[1,1,1,1] row_mask:0xf bank_mask:0xf
    v_add_f32_dpp v124, v115, v124 quad_perm:[3,3,3,3] row_mask:0xf bank_mask:0xf
    v_add_f32 v122, v122, v124
    v_max_f32 v65, v65, v122
    ds_write_b32 v64, v122 offset:3584
    v_mfma_f32_16x16x32_bf16 v[96:99], a[124:127], v[92:95], v[96:99]
    v_add_u32 v64, 3840, v64
    s_mov_b32 s97, 8
    s_mov_b32 s92, 7
    s_lshl_b32 s38, s32, 13
    s_add_u32 s80, s38, 3145728
    s_lshl_b32 s38, s3, 11
    s_add_u32 s80, s38, s80
    v_lshrrev_b32 v4, 2, v1
    v_lshlrev_b32 v55, 3, v4
    s_mov_b32 s66, 134217728
    s_mov_b32 s67, 0x20000
    s_mov_b64 s[64:65], s[52:53]
    v_mov_b32 v62, v76
    v_mov_b32 v63, v77
L_bloop:
    s_waitcnt vmcnt(5)
    buffer_load_dwordx4 v[152:155], v62, s[64:67], s85 offen offset:1024 nt
    v_mfma_f32_16x16x32_bf16 v[112:115], v[128:131], v[80:83], 0
    s_waitcnt vmcnt(5)
    buffer_load_dwordx4 v[156:159], v63, s[64:67], s85 offen offset:1024 nt
    v_mfma_f32_16x16x32_bf16 v[112:115], v[132:135], v[84:87], v[112:115]
    s_cmp_le_u32 s97, 2
    s_cbranch_scc1 L_rare_3
L_back_4:
    s_add_u32 s87, s87, 7
L_done_5:
    s_add_u32 s39, s87, s88
    s_bfe_u32 s37, s39, 0x30000
    s_lshl_b32 s37, s37, 12
    s_add_u32 s85, s37, s89
    s_bfe_u32 s37, s39, 0x10003
    s_lshl_b32 s37, s37, 11
    s_add_u32 s85, s37, s85
    s_bfe_u32 s37, s39, 0x40004
    s_lshl_b32 s37, s37, 16
    s_add_u32 s85, s37, s85
    v_mov_b32_dpp v122, v96 quad_perm:[0,0,0,0] row_mask:0xf bank_mask:0xf
    v_mov_b32_dpp v124, v98 quad_perm:[2,2,2,2] row_mask:0xf bank_mask:0xf
    s_nop 0
    v_add_f32_dpp v122, v97, v122 quad_perm:[1,1,1,1] row_mask:0xf bank_mask:0xf
    v_add_f32_dpp v124, v99, v124 quad_perm:[3,3,3,3] row_mask:0xf bank_mask:0xf
    v_add_f32 v122, v122, v124
    v_max_f32 v65, v65, v122
    ds_write_b32 v64, v122 offset:0
    s_waitcnt vmcnt(5)
    buffer_load_dwordx4 v[128:131], v62, s[64:67], s85 offen offset:0 nt
    v_mfma_f32_16x16x32_bf16 v[112:115], v[136:139], v[88:91], v[112:115]
    s_waitcnt vmcnt(5)
    buffer_load_dwordx4 v[132:135], v63, s[64:67], s85 offen offset:0 nt
    v_mfma_f32_16x16x32_bf16 v[112:115], v[140:143], v[92:95], v[112:115]
    s_waitcnt vmcnt(5)
    buffer_load_dwordx4 v[136:139], v62, s[64:67], s85 offen offset:1024 nt
    v_mfma_f32_16x16x32_bf16 v[96:99], v[144:147], v[80:83], 0
    s_waitcnt vmcnt(5)
    buffer_load_dwordx4 v[140:143], v63, s[64:67], s85 offen offset:1024 nt
    v_mfma_f32_16x16x32_bf16 v[96:99], v[148:151], v[84:87], v[96:99]
    s_add_u32 s87, s87, s92
    s_add_u32 s39, s87, s88
    s_bfe_u32 s37, s39, 0x30000
    s_lshl_b32 s37, s37, 12
    s_add_u32 s85, s37, s89
    s_bfe_u32 s37, s39, 0x10003
    s_lshl_b32 s37, s37, 11
    s_add_u32 s85, s37, s85
    s_bfe_u32 s37, s39, 0x40004
    s_lshl_b32 s37, s37, 16
    s_add_u32 s85, s37, s85
    v_mov_b32_dpp v122, v112 quad_perm:[0,0,0,0] row_mask:0xf bank_mask:0xf
    v_mov_b32_dpp v124, v114 quad_perm:[2,2,2,2] row_mask:0xf bank_mask:0xf
    s_nop 0
    v_add_f32_dpp v122, v113, v122 quad_perm:[1,1,1,1] row_mask:0xf bank_mask:0xf
    v_add_f32_dpp v124, v115, v124 quad_perm:[3,3,3,3] row_mask:0xf bank_mask:0xf
    v_add_f32 v122, v122, v124
    v_max_f32 v65, v65, v122
    ds_write_b32 v64, v122 offset:256
    s_waitcnt vmcnt(5)
    buffer_load_dwordx4 v[144:147], v62, s[64:67], s85 offen offset:0 nt
    v_mfma_f32_16x16x32_bf16 v[96:99], v[152:155], v[88:91], v[96:99]
    s_waitcnt vmcnt(5)
    buffer_load_dwordx4 v[148:151], v63, s[64:67], s85 offen offset:0 nt
    v_mfma_f32_16x16x32_bf16 v[96:99], v[156:159], v[92:95], v[96:99]
    v_add_u32 v64, 512, v64
    s_sub_u32 s97, s97, 1
    s_cmp_lg_u32 s97, 0
    s_cbranch_scc1 L_bloop
    s_bfe_u32 s38, s2, 0x30000
    s_lshl_b32 s38, s38, 8
    s_add_u32 s69, s38, 32768
    v_lshrrev_b32 v68, 2, v34
    buffer_load_dword v68, v68, s[48:51], s69 offen sc1
    v_mov_b32_dpp v122, v96 quad_perm:[0,0,0,0] row_mask:0xf bank_mask:0xf
    v_mov_b32_dpp v124, v98 quad_perm:[2,2,2,2] row_mask:0xf bank_mask:0xf
    s_nop 0
    v_add_f32_dpp v122, v97, v122 quad_perm:[1,1,1,1] row_mask:0xf bank_mask:0xf
    v_add_f32_dpp v124, v99, v124 quad_perm:[3,3,3,3] row_mask:0xf bank_mask:0xf
    v_add_f32 v122, v122, v124
    v_max_f32 v65, v65, v122
    ds_write_b32 v64, v122 offset:0
    v_mov_b32 v123, 0xff7f0000
    ds_write_b32 v64, v123 offset:256
    s_lshl_b32 s38, s34, 14
    s_add_u32 s38, s38, 16384
    v_lshl_add_u32 v64, v1, 2, s38
    ds_read_b32 v66, v64
    ds_read_b32 v67, v64 offset:256
    v_mul_f32 v65, s83, v65
    s_nop 1
    v_max_f32_dpp v124, v65, v65 row_ror:4 row_mask:0xf bank_mask:0xf
    s_nop 1
    v_max_f32_dpp v124, v124, v124 row_ror:8 row_mask:0xf bank_mask:0xf
    v_mov_b32 v125, v124
    s_nop 1
    v_permlane16_swap_b32 v124, v125
    v_max_f32 v124, v124, v125
    v_mov_b32 v125, v124
    s_nop 1
    v_permlane32_swap_b32 v124, v125
    v_max_f32 v124, v124, v125
    v_mov_b32 v120, v124
    s_mov_b32 s97, 16
    s_waitcnt lgkmcnt(1)
    v_fma_f32 v123, v66, s83, -v120
    v_exp_f32 v123, v123
    ds_read_b32 v66, v64 offset:512
    v_cvt_pk_bf16_f32 v100, v123, v123
    v_add_f32 v121, v121, v123
    v_and_b32 v65, 1, v1
    v_lshl_add_u32 v65, v65, 2, v55
    s_mov_b32 vcc_lo, 0xaaaaaaaa
    s_mov_b32 vcc_hi, 0xaaaaaaaa
    s_cmp_ge_u32 s93, 16
    s_cbranch_scc1 L_kdone
L_kdyn:
    s_lshl_b32 s81, s93, 7
    s_add_u32 s81, s81, s80
    s_waitcnt vmcnt(5)
    buffer_load_dwordx4 v[152:155], v62, s[64:67], s85 offen offset:1024 nt
    v_mfma_f32_16x16x32_bf16 v[112:115], v[128:131], v[80:83], 0
    s_waitcnt vmcnt(5)
    buffer_load_dwordx4 v[156:159], v63, s[64:67], s85 offen offset:1024 nt
    v_mfma_f32_16x16x32_bf16 v[112:115], v[132:135], v[84:87], v[112:115]
    s_cmp_lg_u32 s62, 0
    s_cbranch_scc1 L_nopost_11
    v_add_u32 v19, 1, v19
    s_mov_b64 exec, 1
    ds_write_b32 v0, v19 offset:4
L_nopost_11:
    s_mov_b64 exec, 1
    ds_add_rtn_u32 v5, v0, v18 offset:8
    s_mov_b64 exec, -1
L_again_12:
    ds_read_b32 v4, v0 offset:4
    s_waitcnt lgkmcnt(0)
    v_readfirstlane_b32 s93, v4
    s_nop 0
    s_sub_u32 s93, s93, 1
    s_cbranch_scc1 L_retry_13
    v_add_u32 v0, 8, v0
    s_cmp_ge_u32 s93, 16
    s_cbranch_scc1 L_gone_10
    s_lshl_b32 s87, s93, 1
    s_add_u32 s87, s87, 224
    s_mov_b32 s92, 1
    v_mov_b32 v19, 64
    s_mov_b32 s62, 0
    s_cmp_ge_u32 s93, 15
    s_cbranch_scc1 L_lastone_14
    v_readfirstlane_b32 s62, v5
    s_nop 0
    s_cmp_lg_u32 s62, 0
    s_cbranch_scc1 L_nodraw_15
    s_mov_b64 exec, 1
    global_atomic_add v19, v9, v18, s[30:31] offset:0 sc0 sc1
    s_mov_b64 exec, -1
L_nodraw_15:
L_lastone_14:
L_done_9:
    s_add_u32 s39, s87, s88
    s_bfe_u32 s37, s39, 0x30000
    s_lshl_b32 s37, s37, 12
    s_add_u32 s85, s37, s89
    s_bfe_u32 s37, s39, 0x10003
    s_lshl_b32 s37, s37, 11
    s_add_u32 s85, s37, s85
    s_bfe_u32 s37, s39, 0x40004
    s_lshl_b32 s37, s37, 16
    s_add_u32 s85, s37, s85
    s_waitcnt vmcnt(5)
    buffer_load_dwordx4 v[128:131], v62, s[64:67], s85 offen offset:0 nt
    v_mfma_f32_16x16x32_bf16 v[112:115], v[136:139], v[88:91], v[112:115]
    s_waitcnt vmcnt(5)
    buffer_load_dwordx4 v[132:135], v63, s[64:67], s85 offen offset:0 nt
    v_mfma_f32_16x16x32_bf16 v[112:115], v[140:143], v[92:95], v[112:115]
    s_waitcnt vmcnt(5)
    buffer_load_dwordx4 v[136:139], v62, s[64:67], s85 offen offset:1024 nt
    v_mfma_f32_16x16x32_bf16 v[96:99], v[144:147], v[80:83], 0
    s_waitcnt vmcnt(5)
    buffer_load_dwordx4 v[140:143], v63, s[64:67], s85 offen offset:1024 nt
    v_mfma_f32_16x16x32_bf16 v[96:99], v[148:151], v[84:87], v[96:99]
    s_add_u32 s87, s87, s92
    s_add_u32 s39, s87, s88
    s_bfe_u32 s37, s39, 0x30000
    s_lshl_b32 s37, s37, 12
    s_add_u32 s85, s37, s89
    s_bfe_u32 s37, s39, 0x10003
    s_lshl_b32 s37, s37, 11
    s_add_u32 s85, s37, s85
    s_bfe_u32 s37, s39, 0x40004
    s_lshl_b32 s37, s37, 16
    s_add_u32 s85, s37, s85
    v_mov_b32_dpp v123, v112 quad_perm:[0,0,0,0] row_mask:0xf bank_mask:0xf
    v_mov_b32_dpp v124, v114 quad_perm:[2,2,2,2] row_mask:0xf bank_mask:0xf
    s_nop 0
    v_add_f32_dpp v123, v113, v123 quad_perm:[1,1,1,1] row_mask:0xf bank_mask:0xf
    v_add_f32_dpp v124, v115, v124 quad_perm:[3,3,3,3] row_mask:0xf bank_mask:0xf
    v_add_f32 v123, v123, v124
    s_waitcnt vmcnt(5)
    buffer_load_dwordx4 v[144:147], v62, s[64:67], s85 offen offset:0 nt
    v_mfma_f32_16x16x32_bf16 v[96:99], v[152:155], v[88:91], v[96:99]
    s_waitcnt vmcnt(5)
    buffer_load_dwordx4 v[148:151], v63, s[64:67], s85 offen offset:0 nt
    v_mfma_f32_16x16x32_bf16 v[96:99], v[156:159], v[92:95], v[96:99]
    s_nop 7
    v_mov_b32_dpp v122, v96 quad_perm:[0,0,0,0] row_mask:0xf bank_mask:0xf
    v_mov_b32_dpp v124, v98 quad_perm:[2,2,2,2] row_mask:0xf bank_mask:0xf
    s_nop 0
    v_add_f32_dpp v122, v97, v122 quad_perm:[1,1,1,1] row_mask:0xf bank_mask:0xf
    v_add_f32_dpp v124, v99, v124 quad_perm:[3,3,3,3] row_mask:0xf bank_mask:0xf
    v_add_f32 v122, v122, v124
    v_cndmask_b32 v123, v123, v122, vcc
    v_and_or_b32 v123, v123, s82, v8
    s_mov_b32 exec_lo, 0x33333333
    s_mov_b32 exec_hi, 0x33333333
    buffer_store_dword v123, v65, s[48:51], s81 offen sc1
    s_mov_b64 exec, -1
    s_cmp_lt_u32 s93, 16
    s_cbranch_scc1 L_kdyn
L_kdone:
L_vloop:
    v_and_b32_dpp v104, v100, v10 row_newbcast:0 row_mask:0xf bank_mask:0xf
    v_and_b32_dpp v105, v100, v11 row_newbcast:0 row_mask:0xf bank_mask:0xf
    v_and_b32_dpp v106, v100, v12 row_newbcast:0 row_mask:0xf bank_mask:0xf
    v_and_b32_dpp v107, v100, v13 row_newbcast:0 row_mask:0xf bank_mask:0xf
    s_waitcnt vmcnt(5)
    buffer_load_dwordx4 v[152:155], v62, s[64:67], s85 offen offset:1024 nt
    v_mfma_f32_16x16x32_bf16 v[116:119], v[128:131], v[104:107], v[116:119]
    v_and_b32_dpp v108, v100, v10 row_newbcast:4 row_mask:0xf bank_mask:0xf
    v_and_b32_dpp v109, v100, v11 row_newbcast:4 row_mask:0xf bank_mask:0xf
    v_and_b32_dpp v110, v100, v12 row_newbcast:4 row_mask:0xf bank_mask:0xf
    v_and_b32_dpp v111, v100, v13 row_newbcast:4 row_mask:0xf bank_mask:0xf
    s_waitcnt vmcnt(5)
    buffer_load_dwordx4 v[156:159], v63, s[64:67], s85 offen offset:1024 nt
    v_mfma_f32_16x16x32_bf16 v[116:119], v[132:135], v[108:111], v[116:119]
    s_cmp_le_u32 s97, 2
    s_cbranch_scc1 L_rare_16
L_back_17:
    s_add_u32 s87, s87, 7
L_done_18:
    s_add_u32 s39, s87, s88
    s_bfe_u32 s37, s39, 0x30000
    s_lshl_b32 s37, s37, 12
    s_add_u32 s85, s37, s89
    s_bfe_u32 s37, s39, 0x10003
    s_lshl_b32 s37, s37, 11
    s_add_u32 s85, s37, s85
    s_bfe_u32 s37, s39, 0x40004
    s_lshl_b32 s37, s37, 16
    s_add_u32 s85, s37, s85
    s_waitcnt lgkmcnt(1)
    v_fma_f32 v123, v67, s83, -v120
    v_exp_f32 v123, v123
    ds_read_b32 v67, v64 offset:768
    v_cvt_pk_bf16_f32 v101, v123, v123
    v_add_f32 v121, v121, v123
    v_and_b32_dpp v104, v100, v10 row_newbcast:8 row_mask:0xf bank_mask:0xf
    v_and_b32_dpp v105, v100, v11 row_newbcast:8 row_mask:0xf bank_mask:0xf
    v_and_b32_dpp v106, v100, v12 row_newbcast:8 row_mask:0xf bank_mask:0xf
    v_and_b32_dpp v107, v100, v13 row_newbcast:8 row_mask:0xf bank_mask:0xf
    s_waitcnt vmcnt(5)
    buffer_load_dwordx4 v[128:131], v62, s[64:67], s85 offen offset:0 nt
    v_mfma_f32_16x16x32_bf16 v[116:119], v[136:139], v[104:107], v[116:119]
    v_and_b32_dpp v108, v100, v10 row_newbcast:12 row_mask:0xf bank_mask:0xf
    v_and_b32_dpp v109, v100, v11 row_newbcast:12 row_mask:0xf bank_mask:0xf
    v_and_b32_dpp v110, v100, v12 row_newbcast:12 row_mask:0xf bank_mask:0xf
    v_and_b32_dpp v111, v100, v13 row_newbcast:12 row_mask:0xf bank_mask:0xf
    s_waitcnt vmcnt(5)
    buffer_load_dwordx4 v[132:135], v63, s[64:67], s85 offen offset:0 nt
    v_mfma_f32_16x16x32_bf16 v[116:119], v[140:143], v[108:111], v[116:119]
    v_and_b32_dpp v104, v101, v10 row_newbcast:0 row_mask:0xf bank_mask:0xf
    v_and_b32_dpp v105, v101, v11 row_newbcast:0 row_mask:0xf bank_mask:0xf
    v_and_b32_dpp v106, v101, v12 row_newbcast:0 row_mask:0xf bank_mask:0xf
    v_and_b32_dpp v107, v101, v13 row_newbcast:0 row_mask:0xf bank_mask:0xf
    s_waitcnt vmcnt(5)
    buffer_load_dwordx4 v[136:139], v62, s[64:67], s85 offen offset:1024 nt
    v_mfma_f32_16x16x32_bf16 v[116:119], v[144:147], v[104:107], v[116:119]
    v_and_b32_dpp v108, v101, v10 row_newbcast:4 row_mask:0xf bank_mask:0xf
    v_and_b32_dpp v109, v101, v11 row_newbcast:4 row_mask:0xf bank_mask:0xf
    v_and_b32_dpp v110, v101, v12 row_newbcast:4 row_mask:0xf bank_mask:0xf
    v_and_b32_dpp v111, v101, v13 row_newbcast:4 row_mask:0xf bank_mask:0xf
    s_waitcnt vmcnt(5)
    buffer_load_dwordx4 v[140:143], v63, s[64:67], s85 offen offset:1024 nt
    v_mfma_f32_16x16x32_bf16 v[116:119], v[148:151], v[108:111], v[116:119]
    s_add_u32 s87, s87, s92
    s_add_u32 s39, s87, s88
    s_bfe_u32 s37, s39, 0x30000
    s_lshl_b32 s37, s37, 12
    s_add_u32 s85, s37, s89
    s_bfe_u32 s37, s39, 0x10003
    s_lshl_b32 s37, s37, 11
    s_add_u32 s85, s37, s85
    s_bfe_u32 s37, s39, 0x40004
    s_lshl_b32 s37, s37, 16
    s_add_u32 s85, s37, s85
    v_add_u32 v64, 512, v64
    s_waitcnt lgkmcnt(1)
    v_fma_f32 v123, v66, s83, -v120
    v_exp_f32 v123, v123
    ds_read_b32 v66, v64 offset:512
    v_cvt_pk_bf16_f32 v100, v123, v123
    v_add_f32 v121, v121, v123
    v_and_b32_dpp v104, v101, v10 row_newbcast:8 row_mask:0xf bank_mask:0xf
    v_and_b32_dpp v105, v101, v11 row_newbcast:8 row_mask:0xf bank_mask:0xf
    v_and_b32_dpp v106, v101, v12 row_newbcast:8 row_mask:0xf bank_mask:0xf
    v_and_b32_dpp v107, v101, v13 row_newbcast:8 row_mask:0xf bank_mask:0xf
    s_waitcnt vmcnt(5)
    buffer_load_dwordx4 v[144:147], v62, s[64:67], s85 offen offset:0 nt
    v_mfma_f32_16x16x32_bf16 v[116:119], v[152:155], v[104:107], v[116:119]
    v_and_b32_dpp v108, v101, v10 row_newbcast:12 row_mask:0xf bank_mask:0xf
    v_and_b32_dpp v109, v101, v11 row_newbcast:12 row_mask:0xf bank_mask:0xf
    v_and_b32_dpp v110, v101, v12 row_newbcast:12 row_mask:0xf bank_mask:0xf
    v_and_b32_dpp v111, v101, v13 row_newbcast:12 row_mask:0xf bank_mask:0xf
    s_waitcnt vmcnt(5)
    buffer_load_dwordx4 v[148:151], v63, s[64:67], s85 offen offset:0 nt
    v_mfma_f32_16x16x32_bf16 v[116:119], v[156:159], v[108:111], v[116:119]
    s_sub_u32 s97, s97, 1
    s_cmp_lg_u32 s97, 0
    s_cbranch_scc1 L_vloop
    buffer_load_dwordx4 v[152:155], v62, s[64:67], s85 offen offset:1024 nt
    v_cmp_ne_u32 vcc, s70, v68
    s_nop 0
    s_cmp_eq_u64 vcc, 0
    s_cselect_b32 s70, 1, 0
    s_cmp_ge_u32 s93, 16
    s_cbranch_scc1 L_none
L_vdyn:
    s_waitcnt vmcnt(6)
    buffer_load_dwordx4 v[156:159], v63, s[64:67], s85 offen offset:1024 nt
L_sccheck:
    v_xor_b32 v102, s35, v102
    v_xor_b32 v103, s35, v103
    v_or_b32 v4, v102, v103
    v_and_b32 v4, 0xff, v4
    v_cmp_ne_u32 vcc, 0, v4
    v_fma_f32 v123, v102, s83, -v120
    v_fma_f32 v122, v103, s83, -v120
    s_cbranch_vccnz L_scretry
    v_max_f32 v124, v123, v122
    v_cmp_lt_f32 vcc, 0, v124
    s_cbranch_vccnz L_newmax
L_oldmax:
    v_exp_f32 v123, v123
    v_exp_f32 v122, v122
    v_cvt_pk_bf16_f32 v100, v123, v123
    v_add_f32 v121, v121, v123
    v_cvt_pk_bf16_f32 v101, v122, v122
    v_add_f32 v121, v121, v122
    s_cmp_lg_u32 s62, 0
    s_cbranch_scc1 L_nopost_20
    v_add_u32 v19, 1, v19
    s_mov_b64 exec, 1
    ds_write_b32 v0, v19 offset:4
L_nopost_20:
    s_mov_b64 exec, 1
    ds_add_rtn_u32 v5, v0, v18 offset:8
    s_mov_b64 exec, -1
L_again_21:
    ds_read_b32 v4, v0 offset:4
    s_waitcnt lgkmcnt(0)
    v_readfirstlane_b32 s93, v4
    s_nop 0
    s_sub_u32 s93, s93, 1
    s_cbranch_scc1 L_retry_22
    v_add_u32 v0, 8, v0
    s_cmp_ge_u32 s93, 16
    s_cbranch_scc1 L_last
    s_lshl_b32 s81, s93, 7
    s_add_u32 s81, s81, s80
    buffer_load_dwordx2 v[102:103], v55, s[48:51], s81 offen sc1
    s_lshl_b32 s87, s93, 1
    s_add_u32 s87, s87, 224
    s_mov_b32 s92, 1
    v_mov_b32 v19, 64
    s_mov_b32 s62, 0
    s_cmp_ge_u32 s93, 15
    s_cbranch_scc1 L_lastone_23
    v_readfirstlane_b32 s62, v5
    s_nop 0
    s_cmp_lg_u32 s62, 0
    s_cbranch_scc1 L_nodraw_24
    s_mov_b64 exec, 1
    global_atomic_add v19, v9, v18, s[30:31] offset:4 sc0 sc1
    s_mov_b64 exec, -1
L_nodraw_24:
L_lastone_23:
    s_add_u32 s39, s87, s88
    s_bfe_u32 s37, s39, 0x30000
    s_lshl_b32 s37, s37, 12
    s_add_u32 s85, s37, s89
    s_bfe_u32 s37, s39, 0x10003
    s_lshl_b32 s37, s37, 11
    s_add_u32 s85, s37, s85
    s_bfe_u32 s37, s39, 0x40004
    s_lshl_b32 s37, s37, 16
    s_add_u32 s85, s37, s85
    v_and_b32_dpp v104, v100, v10 row_newbcast:0 row_mask:0xf bank_mask:0xf
    v_and_b32_dpp v105, v100, v11 row_newbcast:0 row_mask:0xf bank_mask:0xf
    v_and_b32_dpp v106, v100, v12 row_newbcast:0 row_mask:0xf bank_mask:0xf
    v_and_b32_dpp v107, v100, v13 row_newbcast:0 row_mask:0xf bank_mask:0xf
    s_nop 1
    v_mfma_f32_16x16x32_bf16 v[116:119], v[128:131], v[104:107], v[116:119]
    v_and_b32_dpp v108, v100, v10 row_newbcast:4 row_mask:0xf bank_mask:0xf
    v_and_b32_dpp v109, v100, v11 row_newbcast:4 row_mask:0xf bank_mask:0xf
    v_and_b32_dpp v110, v100, v12 row_newbcast:4 row_mask:0xf bank_mask:0xf
    v_and_b32_dpp v111, v100, v13 row_newbcast:4 row_mask:0xf bank_mask:0xf
    s_waitcnt vmcnt(7)
    buffer_load_dwordx4 v[128:131], v62, s[64:67], s85 offen offset:0 nt
    v_mfma_f32_16x16x32_bf16 v[116:119], v[132:135], v[108:111], v[116:119]
    v_and_b32_dpp v104, v100, v10 row_newbcast:8 row_mask:0xf bank_mask:0xf
    v_and_b32_dpp v105, v100, v11 row_newbcast:8 row_mask:0xf bank_mask:0xf
    v_and_b32_dpp v106, v100, v12 row_newbcast:8 row_mask:0xf bank_mask:0xf
    v_and_b32_dpp v107, v100, v13 row_newbcast:8 row_mask:0xf bank_mask:0xf
    s_waitcnt vmcnt(7)
    buffer_load_dwordx4 v[132:135], v63, s[64:67], s85 offen offset:0 nt
    v_mfma_f32_16x16x32_bf16 v[116:119], v[136:139], v[104:107], v[116:119]
    v_and_b32_dpp v108, v100, v10 row_newbcast:12 row_mask:0xf bank_mask:0xf
    v_and_b32_dpp v109, v100, v11 row_newbcast:12 row_mask:0xf bank_mask:0xf
    v_and_b32_dpp v110, v100, v12 row_newbcast:12 row_mask:0xf bank_mask:0xf
    v_and_b32_dpp v111, v100, v13 row_newbcast:12 row_mask:0xf bank_mask:0xf
    s_waitcnt vmcnt(7)
    buffer_load_dwordx4 v[136:139], v62, s[64:67], s85 offen offset:1024 nt
    v_mfma_f32_16x16x32_bf16 v[116:119], v[140:143], v[108:111], v[116:119]
    v_and_b32_dpp v104, v101, v10 row_newbcast:0 row_mask:0xf bank_mask:0xf
    v_and_b32_dpp v105, v101, v11 row_newbcast:0 row_mask:0xf bank_mask:0xf
    v_and_b32_dpp v106, v101, v12 row_newbcast:0 row_mask:0xf bank_mask:0xf
    v_and_b32_dpp v107, v101, v13 row_newbcast:0 row_mask:0xf bank_mask:0xf
    s_waitcnt vmcnt(7)
    buffer_load_dwordx4 v[140:143], v63, s[64:67], s85 offen offset:1024 nt
    v_mfma_f32_16x16x32_bf16 v[116:119], v[144:147], v[104:107], v[116:119]
    s_add_u32 s87, s87, s92
    s_add_u32 s39, s87, s88
    s_bfe_u32 s37, s39, 0x30000
    s_lshl_b32 s37, s37, 12
    s_add_u32 s85, s37, s89
    s_bfe_u32 s37, s39, 0x10003
    s_lshl_b32 s37, s37, 11
    s_add_u32 s85, s37, s85
    s_bfe_u32 s37, s39, 0x40004
    s_lshl_b32 s37, s37, 16
    s_add_u32 s85, s37, s85
    v_and_b32_dpp v108, v101, v10 row_newbcast:4 row_mask:0xf bank_mask:0xf
    v_and_b32_dpp v109, v101, v11 row_newbcast:4 row_mask:0xf bank_mask:0xf
    v_and_b32_dpp v110, v101, v12 row_newbcast:4 row_mask:0xf bank_mask:0xf
    v_and_b32_dpp v111, v101, v13 row_newbcast:4 row_mask:0xf bank_mask:0xf
    s_waitcnt vmcnt(7)
    buffer_load_dwordx4 v[144:147], v62, s[64:67], s85 offen offset:0 nt
    v_mfma_f32_16x16x32_bf16 v[116:119], v[148:151], v[108:111], v[116:119]
    v_and_b32_dpp v104, v101, v10 row_newbcast:8 row_mask:0xf bank_mask:0xf
    v_and_b32_dpp v105, v101, v11 row_newbcast:8 row_mask:0xf bank_mask:0xf
    v_and_b32_dpp v106, v101, v12 row_newbcast:8 row_mask:0xf bank_mask:0xf
    v_and_b32_dpp v107, v101, v13 row_newbcast:8 row_mask:0xf bank_mask:0xf
    s_waitcnt vmcnt(7)
    buffer_load_dwordx4 v[148:151], v63, s[64:67], s85 offen offset:0 nt
    v_mfma_f32_16x16x32_bf16 v[116:119], v[152:155], v[104:107], v[116:119]
    v_and_b32_dpp v108, v101, v10 row_newbcast:12 row_mask:0xf bank_mask:0xf
    v_and_b32_dpp v109, v101, v11 row_newbcast:12 row_mask:0xf bank_mask:0xf
    v_and_b32_dpp v110, v101, v12 row_newbcast:12 row_mask:0xf bank_mask:0xf
    v_and_b32_dpp v111, v101, v13 row_newbcast:12 row_mask:0xf bank_mask:0xf
    s_waitcnt vmcnt(7)
    buffer_load_dwordx4 v[152:155], v62, s[64:67], s85 offen offset:1024 nt
    v_mfma_f32_16x16x32_bf16 v[116:119], v[156:159], v[108:111], v[116:119]
    s_branch L_vdyn
L_scretry:
    buffer_load_dwordx2 v[102:103], v55, s[48:51], s81 offen sc1
    s_waitcnt vmcnt(0)
    s_sub_u32 s84, s84, 1
    s_cmp_lg_u32 s84, 0
    s_cbranch_scc1 L_sccheck
    s_branch L_end
L_newmax:
    v_max_f32 v123, v102, v103
    v_mul_f32 v123, s83, v123
    s_nop 1
    v_max_f32_dpp v124, v123, v123 row_ror:4 row_mask:0xf bank_mask:0xf
    s_nop 1
    v_max_f32_dpp v124, v124, v124 row_ror:8 row_mask:0xf bank_mask:0xf
    v_mov_b32 v125, v124
    s_nop 1
    v_permlane16_swap_b32 v124, v125
    v_max_f32 v124, v124, v125
    v_mov_b32 v125, v124
    s_nop 1
    v_permlane32_swap_b32 v124, v125
    v_max_f32 v124, v124, v125
    v_max_f32 v124, v124, v120
    v_sub_f32 v125, v120, v124
    v_exp_f32 v125, v125
    v_mov_b32 v120, v124
    v_fma_f32 v123, v102, s83, -v120
    v_fma_f32 v122, v103, s83, -v120
    v_mul_f32 v121, v121, v125
    v_mul_f32 v116, v116, v125
    v_mul_f32 v117, v117, v125
    v_mul_f32 v118, v118, v125
    v_mul_f32 v119, v119, v125
    s_branch L_oldmax
L_rare_3:
    s_cmp_eq_u32 s97, 1
    s_cbranch_scc1 L_last_25
    s_mov_b64 exec, 1
    ds_add_rtn_u32 v5, v0, v18 offset:0
    s_mov_b64 exec, -1
    s_waitcnt lgkmcnt(0)
    v_readfirstlane_b32 s62, v5
    s_nop 0
    s_cmp_lg_u32 s62, 0
    s_cbranch_scc1 L_nodraw_26
    s_mov_b64 exec, 1
    global_atomic_add v19, v9, v18, s[30:31] offset:0 sc0 sc1
    s_mov_b64 exec, -1
L_nodraw_26:
    s_branch L_back_4
L_last_25:
    s_cmp_lg_u32 s62, 0
    s_cbranch_scc1 L_nopost_27
    v_add_u32 v19, 1, v19
    s_mov_b64 exec, 1
    ds_write_b32 v0, v19 offset:4
L_nopost_27:
    s_mov_b64 exec, 1
    ds_add_rtn_u32 v5, v0, v18 offset:8
    s_mov_b64 exec, -1
L_again_28:
    ds_read_b32 v4, v0 offset:4
    s_waitcnt lgkmcnt(0)
    v_readfirstlane_b32 s93, v4
    s_nop 0
    s_sub_u32 s93, s93, 1
    s_cbranch_scc1 L_retry_29
    v_add_u32 v0, 8, v0
    s_cmp_ge_u32 s93, 16
    s_cbranch_scc1 L_gone_6
    s_lshl_b32 s87, s93, 1
    s_add_u32 s87, s87, 224
    s_mov_b32 s92, 1
    v_mov_b32 v19, 64
    s_mov_b32 s62, 0
    s_cmp_ge_u32 s93, 15
    s_cbranch_scc1 L_lastone_30
    v_readfirstlane_b32 s62, v5
    s_nop 0
    s_cmp_lg_u32 s62, 0
    s_cbranch_scc1 L_nodraw_31
    s_mov_b64 exec, 1
    global_atomic_add v19, v9, v18, s[30:31] offset:0 sc0 sc1
    s_mov_b64 exec, -1
L_nodraw_31:
L_lastone_30:
    s_branch L_done_5
L_gone_6:
    s_mov_b64 s[64:65], s[56:57]
    v_mov_b32 v62, v126
    v_mov_b32 v63, v127
    s_lshl_b32 s87, s33, 0
    s_mov_b32 s92, 7
    v_add_u32 v0, 8, v0
    s_branch L_done_5
L_retry_13:
    s_sub_u32 s84, s84, 1
    s_cmp_lg_u32 s84, 0
    s_cbranch_scc1 L_again_12
    s_branch L_end
L_gone_10:
    s_mov_b64 s[64:65], s[56:57]
    v_mov_b32 v62, v126
    v_mov_b32 v63, v127
    s_lshl_b32 s87, s33, 0
    s_mov_b32 s92, 7
    v_add_u32 v0, 8, v0
    s_branch L_done_9
L_rare_16:
    s_cmp_eq_u32 s97, 1
    s_cbranch_scc1 L_last_32
    s_mov_b64 exec, 1
    ds_add_rtn_u32 v5, v0, v18 offset:0
    s_mov_b64 exec, -1
    s_waitcnt lgkmcnt(0)
    v_readfirstlane_b32 s62, v5
    s_nop 0
    s_cmp_lg_u32 s62, 0
    s_cbranch_scc1 L_nodraw_33
    s_mov_b64 exec, 1
    global_atomic_add v19, v9, v18, s[30:31] offset:4 sc0 sc1
    s_mov_b64 exec, -1
L_nodraw_33:
    s_branch L_back_17
L_last_32:
    s_cmp_lg_u32 s62, 0
    s_cbranch_scc1 L_nopost_34
    v_add_u32 v19, 1, v19
    s_mov_b64 exec, 1
    ds_write_b32 v0, v19 offset:4
L_nopost_34:
    s_mov_b64 exec, 1
    ds_add_rtn_u32 v5, v0, v18 offset:8
    s_mov_b64 exec, -1
L_again_35:
    ds_read_b32 v4, v0 offset:4
    s_waitcnt lgkmcnt(0)
    v_readfirstlane_b32 s93, v4
    s_nop 0
    s_sub_u32 s93, s93, 1
    s_cbranch_scc1 L_retry_36
    v_add_u32 v0, 8, v0
    s_cmp_ge_u32 s93, 16
    s_cbranch_scc1 L_gone_19
    s_lshl_b32 s81, s93, 7
    s_add_u32 s81, s81, s80
    buffer_load_dwordx2 v[102:103], v55, s[48:51], s81 offen sc1
    s_lshl_b32 s87, s93, 1
    s_add_u32 s87, s87, 224
    s_mov_b32 s92, 1
    v_mov_b32 v19, 64
    s_mov_b32 s62, 0
    s_cmp_ge_u32 s93, 15
    s_cbranch_scc1 L_lastone_37
    v_readfirstlane_b32 s62, v5
    s_nop 0
    s_cmp_lg_u32 s62, 0
    s_cbranch_scc1 L_nodraw_38
    s_mov_b64 exec, 1
    global_atomic_add v19, v9, v18, s[30:31] offset:4 sc0 sc1
    s_mov_b64 exec, -1
L_nodraw_38:
L_lastone_37:
    s_branch L_done_18
L_gone_19:
    s_mov_b32 s89, 134217728
    s_branch L_done_18
L_retry_22:
    s_sub_u32 s84, s84, 1
    s_cmp_lg_u32 s84, 0
    s_cbranch_scc1 L_again_21
    s_branch L_end
L_retry_29:
    s_sub_u32 s84, s84, 1
    s_cmp_lg_u32 s84, 0
    s_cbranch_scc1 L_again_28
    s_branch L_end
L_retry_36:
    s_sub_u32 s84, s84, 1
    s_cmp_lg_u32 s84, 0
    s_cbranch_scc1 L_again_35
    s_branch L_end
L_none:
    buffer_load_dwordx4 v[224:227], v54, s[48:51], s46 offen sc1
    s_mov_b32 s86, s44
    s_bitcmp1_b32 s90, 2
    s_cselect_b32 s44, 4194304, s44
    s_lshl_b32 s39, s34, 13
    s_add_u32 s39, s39, 98304
    s_mov_b32 m0, s39
    s_nop 0
    buffer_load_dwordx4 v20, s[40:43], s44 offen offset:0 nt lds
    buffer_load_dwordx4 v21, s[40:43], s44 offen offset:1024 nt lds
    buffer_load_dwordx4 v22, s[40:43], s44 offen offset:2048 nt lds
    buffer_load_dwordx4 v23, s[40:43], s44 offen offset:3072 nt lds
    s_lshl_b32 s39, s34, 13
    s_add_u32 s39, s39, 102400
    s_mov_b32 m0, s39
    s_add_u32 s44, s44, 16384
    buffer_load_dwordx4 v20, s[40:43], s44 offen offset:0 nt lds
    buffer_load_dwordx4 v21, s[40:43], s44 offen offset:1024 nt lds
    buffer_load_dwordx4 v22, s[40:43], s44 offen offset:2048 nt lds
    buffer_load_dwordx4 v23, s[40:43], s44 offen offset:3072 nt lds
    v_add_f32_dpp v121, v121, v121 row_ror:8 row_mask:0xf bank_mask:0xf
    s_nop 1
    v_add_f32_dpp v121, v121, v121 row_ror:4 row_mask:0xf bank_mask:0xf
    v_mov_b32 v125, v121
    s_nop 1
    v_permlane16_swap_b32 v121, v125
    v_add_f32 v121, v121, v125
    v_mov_b32 v125, v121
    s_nop 1
    v_permlane32_swap_b32 v121, v125
    v_add_f32 v121, v121, v125
    v_and_b32 v125, s82, v120
    v_sub_f32 v125, v120, v125
    s_mov_b32 vcc_lo, 0xff00ff00
    s_mov_b32 vcc_hi, 0xff00ff00
    s_branch L_bdone
L_last:
    buffer_load_dwordx4 v[224:227], v54, s[48:51], s46 offen sc1
    s_mov_b32 s86, s44
    s_bitcmp1_b32 s90, 2
    s_cselect_b32 s44, 4194304, s44
    v_and_b32_dpp v104, v100, v10 row_newbcast:0 row_mask:0xf bank_mask:0xf
    v_and_b32_dpp v105, v100, v11 row_newbcast:0 row_mask:0xf bank_mask:0xf
    v_and_b32_dpp v106, v100, v12 row_newbcast:0 row_mask:0xf bank_mask:0xf
    v_and_b32_dpp v107, v100, v13 row_newbcast:0 row_mask:0xf bank_mask:0xf
    s_lshl_b32 s39, s34, 13
    s_add_u32 s39, s39, 98304
    s_mov_b32 m0, s39
    s_nop 0
    buffer_load_dwordx4 v20, s[40:43], s44 offen offset:0 nt lds
    v_mfma_f32_16x16x32_bf16 v[116:119], v[128:131], v[104:107], v[116:119]
    v_and_b32_dpp v108, v100, v10 row_newbcast:4 row_mask:0xf bank_mask:0xf
    v_and_b32_dpp v109, v100, v11 row_newbcast:4 row_mask:0xf bank_mask:0xf
    v_and_b32_dpp v110, v100, v12 row_newbcast:4 row_mask:0xf bank_mask:0xf
    v_and_b32_dpp v111, v100, v13 row_newbcast:4 row_mask:0xf bank_mask:0xf
    s_waitcnt vmcnt(8)
    buffer_load_dwordx4 v21, s[40:43], s44 offen offset:1024 nt lds
    v_mfma_f32_16x16x32_bf16 v[116:119], v[132:135], v[108:111], v[116:119]
    v_add_f32_dpp v121, v121, v121 row_ror:8 row_mask:0xf bank_mask:0xf
    s_nop 1
    v_add_f32_dpp v121, v121, v121 row_ror:4 row_mask:0xf bank_mask:0xf
    v_mov_b32 v125, v121
    s_nop 1
    v_permlane16_swap_b32 v121, v125
    v_add_f32 v121, v121, v125
    v_mov_b32 v125, v121
    s_nop 1
    v_permlane32_swap_b32 v121, v125
    v_add_f32 v121, v121, v125
    v_and_b32 v125, s82, v120
    v_sub_f32 v125, v120, v125
    s_mov_b32 vcc_lo, 0xff00ff00
    s_mov_b32 vcc_hi, 0xff00ff00
    v_and_b32_dpp v104, v100, v10 row_newbcast:8 row_mask:0xf bank_mask:0xf
    v_and_b32_dpp v105, v100, v11 row_newbcast:8 row_mask:0xf bank_mask:0xf
    v_and_b32_dpp v106, v100, v12 row_newbcast:8 row_mask:0xf bank_mask:0xf
    v_and_b32_dpp v107, v100, v13 row_newbcast:8 row_mask:0xf bank_mask:0xf
    s_waitcnt vmcnt(8)
    buffer_load_dwordx4 v22, s[40:43], s44 offen offset:2048 nt lds
    v_mfma_f32_16x16x32_bf16 v[116:119], v[136:139], v[104:107], v[116:119]
    v_and_b32_dpp v108, v100, v10 row_newbcast:12 row_mask:0xf bank_mask:0xf
    v_and_b32_dpp v109, v100, v11 row_newbcast:12 row_mask:0xf bank_mask:0xf
    v_and_b32_dpp v110, v100, v12 row_newbcast:12 row_mask:0xf bank_mask:0xf
    v_and_b32_dpp v111, v100, v13 row_newbcast:12 row_mask:0xf bank_mask:0xf
    s_waitcnt vmcnt(8)
    buffer_load_dwordx4 v23, s[40:43], s44 offen offset:3072 nt lds
    v_mfma_f32_16x16x32_bf16 v[116:119], v[140:143], v[108:111], v[116:119]
    v_and_b32_dpp v104, v101, v10 row_newbcast:0 row_mask:0xf bank_mask:0xf
    v_and_b32_dpp v105, v101, v11 row_newbcast:0 row_mask:0xf bank_mask:0xf
    v_and_b32_dpp v106, v101, v12 row_newbcast:0 row_mask:0xf bank_mask:0xf
    v_and_b32_dpp v107, v101, v13 row_newbcast:0 row_mask:0xf bank_mask:0xf
    s_waitcnt vmcnt(8)
    s_lshl_b32 s39, s34, 13
    s_add_u32 s39, s39, 102400
    s_mov_b32 m0, s39
    s_add_u32 s44, s44, 16384
    buffer_load_dwordx4 v20, s[40:43], s44 offen offset:0 nt lds
    v_mfma_f32_16x16x32_bf16 v[116:119], v[144:147], v[104:107], v[116:119]
    v_and_b32_dpp v108, v101, v10 row_newbcast:4 row_mask:0xf bank_mask:0xf
    v_and_b32_dpp v109, v101, v11 row_newbcast:4 row_mask:0xf bank_mask:0xf
    v_and_b32_dpp v110, v101, v12 row_newbcast:4 row_mask:0xf bank_mask:0xf
    v_and_b32_dpp v111, v101, v13 row_newbcast:4 row_mask:0xf bank_mask:0xf
    s_waitcnt vmcnt(8)
    buffer_load_dwordx4 v21, s[40:43], s44 offen offset:1024 nt lds
    v_mfma_f32_16x16x32_bf16 v[116:119], v[148:151], v[108:111], v[116:119]
    v_and_b32_dpp v104, v101, v10 row_newbcast:8 row_mask:0xf bank_mask:0xf
    v_and_b32_dpp v105, v101, v11 row_newbcast:8 row_mask:0xf bank_mask:0xf
    v_and_b32_dpp v106, v101, v12 row_newbcast:8 row_mask:0xf bank_mask:0xf
    v_and_b32_dpp v107, v101, v13 row_newbcast:8 row_mask:0xf bank_mask:0xf
    s_waitcnt vmcnt(8)
    buffer_load_dwordx4 v22, s[40:43], s44 offen offset:2048 nt lds
    v_mfma_f32_16x16x32_bf16 v[116:119], v[152:155], v[104:107], v[116:119]
    v_and_b32_dpp v108, v101, v10 row_newbcast:12 row_mask:0xf bank_mask:0xf
    v_and_b32_dpp v109, v101, v11 row_newbcast:12 row_mask:0xf bank_mask:0xf
    v_and_b32_dpp v110, v101, v12 row_newbcast:12 row_mask:0xf bank_mask:0xf
    v_and_b32_dpp v111, v101, v13 row_newbcast:12 row_mask:0xf bank_mask:0xf
    s_waitcnt vmcnt(8)
    buffer_load_dwordx4 v23, s[40:43], s44 offen offset:3072 nt lds
    v_mfma_f32_16x16x32_bf16 v[116:119], v[156:159], v[108:111], v[116:119]
L_bdone:
    s_nop 7
    v_cndmask_b32 v116, v116, v120, vcc
    v_cndmask_b32 v117, v117, v121, vcc
    v_cndmask_b32 v118, v118, v125, vcc
    v_and_or_b32 v119, v119, s82, v8
    v_and_or_b32 v116, v116, s82, v8
    v_and_or_b32 v117, v117, s82, v8
    v_and_or_b32 v118, v118, s82, v8
    s_mov_b32 exec_lo, 0xff01ff
    s_mov_b32 exec_hi, 0xff00ff
    buffer_store_dwordx4 v[116:119], v79, s[48:51], s96 offen sc1
    s_mov_b64 exec, -1
    s_bitcmp1_b32 s90, 2
    s_cbranch_scc1 L_ctx
    buffer_load_dwordx4 v[204:207], v53, s[48:51], s47 offen sc1
    buffer_load_dwordx4 v[192:195], v50, s[48:51], s47 offen sc1
    buffer_load_dwordx4 v[196:199], v51, s[48:51], s47 offen sc1
    buffer_load_dwordx4 v[200:203], v52, s[48:51], s47 offen sc1
    v_xor_b32 v104, s35, v116
    v_xor_b32 v105, s35, v117
    v_xor_b32 v106, s35, v118
    v_xor_b32 v107, s35, v119
    v_mov_b32 v5, 0xff7f0000
    v_cndmask_b32 v120, v120, v5, vcc
    v_and_b32 v121, s82, v121
    s_mov_b32 s86, 0x88888888
    s_mov_b32 s87, 0x88888888
    s_waitcnt vmcnt(0)
L_hop1poll:
    v_xor_b32 v192, s35, v192
    v_xor_b32 v193, s35, v193
    v_xor_b32 v194, s35, v194
    v_xor_b32 v195, s35, v195
    v_xor_b32 v196, s35, v196
    v_xor_b32 v197, s35, v197
    v_xor_b32 v198, s35, v198
    v_xor_b32 v199, s35, v199
    v_xor_b32 v200, s35, v200
    v_xor_b32 v201, s35, v201
    v_xor_b32 v202, s35, v202
    v_xor_b32 v203, s35, v203
    v_xor_b32 v204, s35, v204
    v_xor_b32 v205, s35, v205
    v_xor_b32 v206, s35, v206
    v_xor_b32 v207, s35, v207
    v_or_b32 v4, v192, v193
    v_or3_b32 v4, v4, v194, v195
    v_or3_b32 v4, v4, v196, v197
    v_or3_b32 v4, v4, v198, v199
    v_or3_b32 v4, v4, v200, v201
    v_or3_b32 v4, v4, v202, v203
    v_or3_b32 v4, v4, v204, v205
    v_or3_b32 v4, v4, v206, v207
    v_and_b32 v4, 0xff, v4
    v_cmp_ne_u32 vcc, 0, v4
    v_add_f32 v122, v204, v206
    s_cbranch_vccz L_hop1ok
    buffer_load_dwordx4 v[204:207], v53, s[48:51], s47 offen sc1
    buffer_load_dwordx4 v[192:195], v50, s[48:51], s47 offen sc1
    buffer_load_dwordx4 v[196:199], v51, s[48:51], s47 offen sc1
    buffer_load_dwordx4 v[200:203], v52, s[48:51], s47 offen sc1
    s_waitcnt vmcnt(0)
    s_sub_u32 s84, s84, 1
    s_cmp_lg_u32 s84, 0
    s_cbranch_scc1 L_hop1poll
    s_branch L_end
L_ctx:
    s_mov_b32 s44, s86
    s_lshl_b32 s39, s34, 13
    s_add_u32 s39, s39, 98304
    s_mov_b32 m0, s39
    s_nop 0
    buffer_load_dwordx4 v20, s[40:43], s44 offen offset:0 nt lds
    buffer_load_dwordx4 v21, s[40:43], s44 offen offset:1024 nt lds
    buffer_load_dwordx4 v22, s[40:43], s44 offen offset:2048 nt lds
    buffer_load_dwordx4 v23, s[40:43], s44 offen offset:3072 nt lds
    s_lshl_b32 s39, s34, 13
    s_add_u32 s39, s39, 102400
    s_mov_b32 m0, s39
    s_add_u32 s44, s44, 16384
    buffer_load_dwordx4 v20, s[40:43], s44 offen offset:0 nt lds
    buffer_load_dwordx4 v21, s[40:43], s44 offen offset:1024 nt lds
    buffer_load_dwordx4 v22, s[40:43], s44 offen offset:2048 nt lds
    buffer_load_dwordx4 v23, s[40:43], s44 offen offset:3072 nt lds
    s_waitcnt vmcnt(9)
L_ctxcheck:
    v_xor_b32 v224, s35, v224
    v_xor_b32 v225, s35, v225
    v_xor_b32 v226, s35, v226
    v_xor_b32 v227, s35, v227
    v_or_b32 v4, v224, v225
    v_or3_b32 v4, v4, v226, v227
    v_and_b32 v4, 0xff, v4
    v_cmp_ne_u32 vcc, 0, v4
    s_cbranch_vccz L_ctxok
    buffer_load_dwordx4 v[224:227], v54, s[48:51], s46 offen sc1
    s_waitcnt vmcnt(0)
    s_sub_u32 s84, s84, 1
    s_cmp_lg_u32 s84, 0
    s_cbranch_scc1 L_ctxcheck
    s_branch L_end
L_ctxok:
    v_cvt_pk_bf16_f32 v224, v224, v225
    v_cvt_pk_bf16_f32 v225, v226, v227
    ds_write_b64 v35, v[224:225]
    s_branch L_final
L_hop1ok:
    v_cndmask_b32 v122, v122, v120, s[86:87]
    v_cndmask_b32 v123, v205, v121, s[86:87]
    s_nop 0
    v_max_f32_dpp v5, v122, v122 quad_perm:[1,0,3,2] row_mask:0xf bank_mask:0xf
    s_nop 1
    v_max_f32_dpp v5, v5, v5 quad_perm:[2,3,0,1] row_mask:0xf bank_mask:0xf
    s_nop 1
    v_max_f32_dpp v5, v5, v5 row_ror:8 row_mask:0xf bank_mask:0xf
    v_sub_f32 v122, v122, v5
    v_exp_f32 v122, v122
    s_nop 0
    v_mul_f32 v123, v123, v122
    v_mul_f32_dpp v104, v122, v104 quad_perm:[3,3,3,3] row_mask:0xf bank_mask:0xf
    v_mul_f32_dpp v105, v122, v105 quad_perm:[3,3,3,3] row_mask:0xf bank_mask:0xf
    v_mul_f32_dpp v106, v122, v106 quad_perm:[3,3,3,3] row_mask:0xf bank_mask:0xf
    v_mul_f32_dpp v107, v122, v107 quad_perm:[3,3,3,3] row_mask:0xf bank_mask:0xf
    v_add_f32_dpp v123, v123, v123 quad_perm:[1,0,3,2] row_mask:0xf bank_mask:0xf
    v_fmac_f32_dpp v104, v122, v192 quad_perm:[0,0,0,0] row_mask:0xf bank_mask:0xf
    v_fmac_f32_dpp v105, v122, v193 quad_perm:[0,0,0,0] row_mask:0xf bank_mask:0xf
    v_fmac_f32_dpp v106, v122, v194 quad_perm:[0,0,0,0] row_mask:0xf bank_mask:0xf
    v_fmac_f32_dpp v107, v122, v195 quad_perm:[0,0,0,0] row_mask:0xf bank_mask:0xf
    v_add_f32_dpp v123, v123, v123 quad_perm:[2,3,0,1] row_mask:0xf bank_mask:0xf
    v_fmac_f32_dpp v104, v122, v196 quad_perm:[1,1,1,1] row_mask:0xf bank_mask:0xf
    v_fmac_f32_dpp v105, v122, v197 quad_perm:[1,1,1,1] row_mask:0xf bank_mask:0xf
    v_fmac_f32_dpp v106, v122, v198 quad_perm:[1,1,1,1] row_mask:0xf bank_mask:0xf
    v_fmac_f32_dpp v107, v122, v199 quad_perm:[1,1,1,1] row_mask:0xf bank_mask:0xf
    v_add_f32_dpp v123, v123, v123 row_ror:8 row_mask:0xf bank_mask:0xf
    v_fmac_f32_dpp v104, v122, v200 quad_perm:[2,2,2,2] row_mask:0xf bank_mask:0xf
    v_fmac_f32_dpp v105, v122, v201 quad_perm:[2,2,2,2] row_mask:0xf bank_mask:0xf
    v_fmac_f32_dpp v106, v122, v202 quad_perm:[2,2,2,2] row_mask:0xf bank_mask:0xf
    v_fmac_f32_dpp v107, v122, v203 quad_perm:[2,2,2,2] row_mask:0xf bank_mask:0xf
    v_rcp_f32 v123, v123
    v_add_f32_dpp v104, v104, v104 row_ror:8 row_mask:0xf bank_mask:0xf
    v_add_f32_dpp v105, v105, v105 row_ror:8 row_mask:0xf bank_mask:0xf
    v_add_f32_dpp v106, v106, v106 row_ror:8 row_mask:0xf bank_mask:0xf
    v_add_f32_dpp v107, v107, v107 row_ror:8 row_mask:0xf bank_mask:0xf
    v_mul_f32 v104, v104, v123
    v_mul_f32 v105, v105, v123
    v_mul_f32 v106, v106, v123
    v_mul_f32 v107, v107, v123
    v_cvt_pk_bf16_f32 v104, v104, v105
    v_cvt_pk_bf16_f32 v106, v106, v107
    s_mov_b32 exec_lo, 0xff00ff
    s_mov_b32 exec_hi, 0xff00ff
    ds_write_b16 v31, v104
    ds_write_b16_d16_hi v31, v104 offset:16
    ds_write_b16 v31, v106 offset:32
    ds_write_b16_d16_hi v31, v106 offset:48
    s_mov_b64 exec, -1
L_final:
    s_waitcnt vmcnt(0) lgkmcnt(0)
    s_barrier
    ds_read_b64_tr_b16 v[128:129], v24 offset:0
    ds_read_b64_tr_b16 v[130:131], v25 offset:1024
    ds_read_b128 v[160:163], v28 offset:0
    ds_read_b64_tr_b16 v[132:133], v24 offset:8192
    ds_read_b64_tr_b16 v[134:135], v25 offset:9216
    ds_read_b128 v[164:167], v28 offset:64
    ds_read_b64_tr_b16 v[136:137], v24 offset:16384
    ds_read_b64_tr_b16 v[138:139], v25 offset:17408
    ds_read_b128 v[168:171], v28 offset:128
    ds_read_b64_tr_b16 v[140:141], v24 offset:24576
    ds_read_b64_tr_b16 v[142:143], v25 offset:25600
    ds_read_b128 v[172:175], v28 offset:192
    ds_read_b64_tr_b16 v[144:145], v26 offset:0
    ds_read_b64_tr_b16 v[146:147], v27 offset:1024
    ds_read_b128 v[176:179], v29 offset:0
    s_waitcnt lgkmcnt(12)
    v_mfma_f32_16x16x32_bf16 v[112:115], v[128:131], v[160:163], 0
    ds_read_b64_tr_b16 v[148:149], v26 offset:8192
    ds_read_b64_tr_b16 v[150:151], v27 offset:9216
    ds_read_b128 v[180:183], v29 offset:64
    s_waitcnt lgkmcnt(12)
    v_mfma_f32_16x16x32_bf16 v[112:115], v[132:135], v[164:167], v[112:115]
    ds_read_b64_tr_b16 v[152:153], v26 offset:16384
    ds_read_b64_tr_b16 v[154:155], v27 offset:17408
    ds_read_b128 v[184:187], v29 offset:128
    s_waitcnt lgkmcnt(12)
    v_mfma_f32_16x16x32_bf16 v[112:115], v[136:139], v[168:171], v[112:115]
    ds_read_b64_tr_b16 v[156:157], v26 offset:24576
    ds_read_b64_tr_b16 v[158:159], v27 offset:25600
    ds_read_b128 v[188:191], v29 offset:192
    s_waitcnt lgkmcnt(12)
    v_mfma_f32_16x16x32_bf16 v[112:115], v[140:143], v[172:175], v[112:115]
    s_waitcnt lgkmcnt(9)
    v_mfma_f32_16x16x32_bf16 v[112:115], v[144:147], v[176:179], v[112:115]
    s_waitcnt lgkmcnt(6)
    v_mfma_f32_16x16x32_bf16 v[112:115], v[148:151], v[180:183], v[112:115]
    s_waitcnt lgkmcnt(3)
    v_mfma_f32_16x16x32_bf16 v[112:115], v[152:155], v[184:187], v[112:115]
    s_waitcnt lgkmcnt(0)
    v_mfma_f32_16x16x32_bf16 v[112:115], v[156:159], v[188:191], v[112:115]
    s_add_u32 s37, s71, 4096
    s_cmp_eq_u32 s70, 1
    s_mov_b32 exec_lo, 0xff00ff
    s_mov_b32 exec_hi, 0xff00ff
    s_nop 3
    v_and_or_b32 v112, v112, s82, v8
    v_and_or_b32 v113, v113, s82, v8
    v_and_or_b32 v114, v114, s82, v8
    v_and_or_b32 v115, v115, s82, v8
    s_cbranch_scc1 L_ylocal
    buffer_store_dwordx4 v[112:115], v30, s[48:51], s45 offen sc1
    s_branch L_ydone
L_ylocal:
    buffer_store_dwordx4 v[112:115], v30, s[48:51], s45 offen
L_ydone:
    s_mov_b64 exec, -1
    s_cmp_lg_u32 s34, 0
    s_cbranch_scc1 L_done
L_hop2:
    buffer_load_dwordx4 v[224:227], v32, s[48:51], s71 offen sc1
    buffer_load_dwordx4 v[228:231], v32, s[48:51], s37 offen sc1
    s_waitcnt vmcnt(0)
    v_xor_b32 v224, s35, v224
    v_xor_b32 v225, s35, v225
    v_xor_b32 v226, s35, v226
    v_xor_b32 v227, s35, v227
    v_xor_b32 v228, s35, v228
    v_xor_b32 v229, s35, v229
    v_xor_b32 v230, s35, v230
    v_xor_b32 v231, s35, v231
    v_or_b32 v4, v224, v225
    v_or3_b32 v4, v4, v226, v227
    v_or3_b32 v4, v4, v228, v229
    v_or3_b32 v4, v4, v230, v231
    v_and_b32 v4, 0xff, v4
    v_cmp_ne_u32 vcc, 0, v4
    v_add_f32 v232, v224, v228
    v_add_f32 v233, v225, v229
    v_add_f32 v234, v226, v230
    v_add_f32 v235, v227, v231
    s_cbranch_vccz L_hop2ok
    s_sub_u32 s84, s84, 1
    s_cmp_lg_u32 s84, 0
    s_cbranch_scc1 L_hop2
    s_branch L_end
L_hop2ok:
    v_permlane16_swap_b32 v232, v233
    v_permlane16_swap_b32 v234, v235
    v_add_f32 v232, v232, v233
    v_add_f32 v234, v234, v235
    s_nop 1
    v_permlane32_swap_b32 v232, v234
    v_add_f32 v232, v232, v234
    s_nop 1
    v_add_f32_dpp v232, v232, v232 row_ror:8 row_mask:0xf bank_mask:0xf
    s_nop 1
    v_add_f32_dpp v232, v232, v232 row_ror:4 row_mask:0xf bank_mask:0xf
    v_cvt_pk_bf16_f32 v232, v232, v232
    s_mov_b32 exec_lo, 0xf000f
    s_mov_b32 exec_hi, 0xf000f
    buffer_store_short v232, v33, s[72:75], 0 offen
    s_cmp_lg_u32 s2, 0
    s_cbranch_scc1 L_done
    v_mov_b32 v4, 0
    s_mov_b64 exec, 1
    buffer_store_dword v8, v4, s[48:51], 0 offen
L_done:
L_end:
    s_endpgm
L_qp:
    v_lshlrev_b32 v4, 18, v2
    v_lshl_add_u32 v14, v3, 4, v4
    v_lshrrev_b32 v5, 3, v3
    v_lshlrev_b32 v5, 10, v5
    v_lshl_add_u32 v15, v2, 6, v5
    s_cmp_eq_u32 s33, 0
    s_cselect_b32 s61, 3, 2
    s_xor_b32 s61, s61, s32
    s_lshl_b32 s86, s34, 8
    s_lshl_b32 s63, s34, 20
    s_lshl_b32 s38, s61, 8
    s_add_u32 s63, s63, s38
    s_mov_b32 s42, 4194304
    s_mov_b32 s43, 0x20000
    s_mov_b32 s46, 4096
    s_mov_b32 s47, 0x20000
    s_cmp_eq_u32 s33, 0
    s_waitcnt lgkmcnt(0)
    s_cselect_b64 s[40:41], s[22:23], s[8:9]
    s_cselect_b64 s[44:45], s[16:17], s[4:5]
    buffer_load_dwordx4 a[128:131], v14, s[40:43], s63 offen nt
    s_add_u32 s63, s63, 8192
    buffer_load_dwordx4 a[132:135], v14, s[40:43], s63 offen nt
    s_add_u32 s63, s63, 8192
    buffer_load_dwordx4 v[20:23], v15, s[44:47], s86 offen offset:0
    buffer_load_dwordx4 v[36:39], v15, s[44:47], s86 offen offset:2048
    buffer_load_dwordx4 a[136:139], v14, s[40:43], s63 offen nt
    s_add_u32 s63, s63, 8192
    buffer_load_dwordx4 a[140:143], v14, s[40:43], s63 offen nt
    s_add_u32 s63, s63, 8192
    buffer_load_dwordx4 a[144:147], v14, s[40:43], s63 offen nt
    s_add_u32 s63, s63, 8192
    buffer_load_dwordx4 a[148:151], v14, s[40:43], s63 offen nt
    s_add_u32 s63, s63, 8192
    buffer_load_dwordx4 a[152:155], v14, s[40:43], s63 offen nt
    s_add_u32 s63, s63, 8192
    buffer_load_dwordx4 a[156:159], v14, s[40:43], s63 offen nt
    s_add_u32 s63, s63, 8192
    s_load_dword s35, s[30:31], 0
    s_mov_b32 s48, s30
    s_and_b32 s49, s31, 0xffff
    s_mov_b32 s50, 8388608
    s_mov_b32 s51, 0x20000
    s_mov_b32 s82, 0xffffff00
    s_mov_b32 s83, 0x3e0293ee
    s_mov_b32 s84, 2097152
    v_and_b32 v4, 1, v1
    v_lshlrev_b32 v4, 4, v4
    v_mov_b32 v5, 0xffff
    v_lshlrev_b32 v4, v4, v5
    v_bfe_u32 v5, v1, 1, 2
    v_cmp_eq_u32 vcc, 0, v5
    s_nop 1
    v_cndmask_b32 v10, 0, v4, vcc
    v_cmp_eq_u32 vcc, 1, v5
    s_nop 1
    v_cndmask_b32 v11, 0, v4, vcc
    v_cmp_eq_u32 vcc, 2, v5
    s_nop 1
    v_cndmask_b32 v12, 0, v4, vcc
    v_cmp_eq_u32 vcc, 3, v5
    s_nop 1
    v_cndmask_b32 v13, 0, v4, vcc
    buffer_load_dwordx4 v[24:27], v15, s[44:47], s86 offen offset:16
    buffer_load_dwordx4 v[40:43], v15, s[44:47], s86 offen offset:2064
    buffer_load_dwordx4 v[28:31], v15, s[44:47], s86 offen offset:32
    buffer_load_dwordx4 v[44:47], v15, s[44:47], s86 offen offset:2080
    buffer_load_dwordx4 v[32:35], v15, s[44:47], s86 offen offset:48
    buffer_load_dwordx4 v[48:51], v15, s[44:47], s86 offen offset:2096
    s_lshl_b32 s38, s61, 10
    s_add_u32 s36, s38, 65536
    s_lshr_b32 s38, s61, 3
    s_lshl_b32 s38, s38, 8
    s_add_u32 s36, s38, s36
    s_lshl_b32 s38, s34, 23
    s_add_u32 s36, s38, s36
    v_mov_b32 v18, 0
    v_mov_b32 v19, 0
    s_cmp_eq_u32 s33, 0
    s_cselect_b32 s38, s36, 8388608
    s_mov_b64 exec, 1
    buffer_store_dwordx2 v[18:19], v19, s[48:51], s38 offen sc1
    s_mov_b64 exec, -1
    buffer_load_dwordx4 a[160:163], v14, s[40:43], s63 offen nt
    s_add_u32 s63, s63, 8192
    buffer_load_dwordx4 a[164:167], v14, s[40:43], s63 offen nt
    s_add_u32 s63, s63, 8192
    buffer_load_dwordx4 a[168:171], v14, s[40:43], s63 offen nt
    s_add_u32 s63, s63, 8192
    buffer_load_dwordx4 a[172:175], v14, s[40:43], s63 offen nt
    s_add_u32 s63, s63, 8192
    s_mov_b32 s80, 0x01000100
    s_mov_b32 s81, 0x03020302
    s_waitcnt vmcnt(17)
    buffer_load_dwordx4 a[176:179], v14, s[40:43], s63 offen nt
    s_add_u32 s63, s63, 8192
    v_perm_b32 v4, v20, v20, s80
    v_perm_b32 v5, v36, v36, s80
    v_and_b32 v52, v4, v10
    v_and_b32 v53, v4, v11
    v_and_b32 v54, v4, v12
    v_and_b32 v55, v4, v13
    v_and_b32 v56, v5, v10
    v_and_b32 v57, v5, v11
    v_and_b32 v58, v5, v12
    v_and_b32 v59, v5, v13
    v_mfma_f32_16x16x32_bf16 v[60:63], a[128:131], v[52:55], 0
    s_nop 0
    v_mfma_f32_16x16x32_bf16 v[64:67], a[128:131], v[56:59], 0
    buffer_load_dwordx4 a[180:183], v14, s[40:43], s63 offen nt
    s_add_u32 s63, s63, 8192
    v_perm_b32 v4, v20, v20, s81
    v_perm_b32 v5, v36, v36, s81
    v_and_b32 v52, v4, v10
    v_and_b32 v53, v4, v11
    v_and_b32 v54, v4, v12
    v_and_b32 v55, v4, v13
    v_and_b32 v56, v5, v10
    v_and_b32 v57, v5, v11
    v_and_b32 v58, v5, v12
    v_and_b32 v59, v5, v13
    v_mfma_f32_16x16x32_bf16 v[60:63], a[132:135], v[52:55], v[60:63]
    s_nop 0
    v_mfma_f32_16x16x32_bf16 v[64:67], a[132:135], v[56:59], v[64:67]
    s_waitcnt vmcnt(18)
    buffer_load_dwordx4 a[184:187], v14, s[40:43], s63 offen nt
    s_add_u32 s63, s63, 8192
    v_perm_b32 v4, v21, v21, s80
    v_perm_b32 v5, v37, v37, s80
    v_and_b32 v52, v4, v10
    v_and_b32 v53, v4, v11
    v_and_b32 v54, v4, v12
    v_and_b32 v55, v4, v13
    v_and_b32 v56, v5, v10
    v_and_b32 v57, v5, v11
    v_and_b32 v58, v5, v12
    v_and_b32 v59, v5, v13
    v_mfma_f32_16x16x32_bf16 v[60:63], a[136:139], v[52:55], v[60:63]
    s_nop 0
    v_mfma_f32_16x16x32_bf16 v[64:67], a[136:139], v[56:59], v[64:67]
    s_waitcnt vmcnt(18)
    buffer_load_dwordx4 a[188:191], v14, s[40:43], s63 offen nt
    s_add_u32 s63, s63, 8192
    v_perm_b32 v4, v21, v21, s81
    v_perm_b32 v5, v37, v37, s81
    v_and_b32 v52, v4, v10
    v_and_b32 v53, v4, v11
    v_and_b32 v54, v4, v12
    v_and_b32 v55, v4, v13
    v_and_b32 v56, v5, v10
    v_and_b32 v57, v5, v11
    v_and_b32 v58, v5, v12
    v_and_b32 v59, v5, v13
    v_mfma_f32_16x16x32_bf16 v[60:63], a[140:143], v[52:55], v[60:63]
    s_nop 0
    v_mfma_f32_16x16x32_bf16 v[64:67], a[140:143], v[56:59], v[64:67]
    s_waitcnt vmcnt(18)
    buffer_load_dwordx4 a[192:195], v14, s[40:43], s63 offen nt
    s_add_u32 s63, s63, 8192
    v_lshrrev_b32 v4, 2, v3
    v_and_b32 v5, 3, v3
    v_lshlrev_b32 v76, 8, v4
    v_lshlrev_b32 v126, 8, v2
    v_lshl_add_u32 v76, v2, 6, v76
    v_lshl_add_u32 v76, v5, 4, v76
    v_lshl_add_u32 v126, v3, 4, v126
    v_xor_b32 v77, 32768, v76
    v_xor_b32 v127, 32768, v126
    s_add_u32 s3, s34, s33
    s_and_b32 s3, s3, 3
    s_lshl_b32 s89, s3, 5
    s_add_u32 s89, s89, s32
    s_lshl_b32 s89, s89, 20
    s_mul_i32 s88, s32, 8
    s_add_u32 s88, s88, s3
    s_lshl_b32 s87, s33, 0
    v_perm_b32 v4, v22, v22, s80
    v_perm_b32 v5, v38, v38, s80
    v_and_b32 v52, v4, v10
    v_and_b32 v53, v4, v11
    v_and_b32 v54, v4, v12
    v_and_b32 v55, v4, v13
    v_and_b32 v56, v5, v10
    v_and_b32 v57, v5, v11
    v_and_b32 v58, v5, v12
    v_and_b32 v59, v5, v13
    v_mfma_f32_16x16x32_bf16 v[60:63], a[144:147], v[52:55], v[60:63]
    s_nop 0
    v_mfma_f32_16x16x32_bf16 v[64:67], a[144:147], v[56:59], v[64:67]
    s_waitcnt vmcnt(18)
    buffer_load_dwordx4 a[196:199], v14, s[40:43], s63 offen nt
    s_add_u32 s63, s63, 8192
    v_perm_b32 v4, v22, v22, s81
    v_perm_b32 v5, v38, v38, s81
    v_and_b32 v52, v4, v10
    v_and_b32 v53, v4, v11
    v_and_b32 v54, v4, v12
    v_and_b32 v55, v4, v13
    v_and_b32 v56, v5, v10
    v_and_b32 v57, v5, v11
    v_and_b32 v58, v5, v12
    v_and_b32 v59, v5, v13
    v_mfma_f32_16x16x32_bf16 v[60:63], a[148:151], v[52:55], v[60:63]
    s_nop 0
    v_mfma_f32_16x16x32_bf16 v[64:67], a[148:151], v[56:59], v[64:67]
    s_waitcnt vmcnt(18)
    buffer_load_dwordx4 a[200:203], v14, s[40:43], s63 offen nt
    s_add_u32 s63, s63, 8192
    v_perm_b32 v4, v23, v23, s80
    v_perm_b32 v5, v39, v39, s80
    v_and_b32 v52, v4, v10
    v_and_b32 v53, v4, v11
    v_and_b32 v54, v4, v12
    v_and_b32 v55, v4, v13
    v_and_b32 v56, v5, v10
    v_and_b32 v57, v5, v11
    v_and_b32 v58, v5, v12
    v_and_b32 v59, v5, v13
    v_mfma_f32_16x16x32_bf16 v[60:63], a[152:155], v[52:55], v[60:63]
    s_nop 0
    v_mfma_f32_16x16x32_bf16 v[64:67], a[152:155], v[56:59], v[64:67]
    s_waitcnt vmcnt(18)
    buffer_load_dwordx4 a[204:207], v14, s[40:43], s63 offen nt
    s_add_u32 s63, s63, 8192
    v_perm_b32 v4, v23, v23, s81
    v_perm_b32 v5, v39, v39, s81
    v_and_b32 v52, v4, v10
    v_and_b32 v53, v4, v11
    v_and_b32 v54, v4, v12
    v_and_b32 v55, v4, v13
    v_and_b32 v56, v5, v10
    v_and_b32 v57, v5, v11
    v_and_b32 v58, v5, v12
    v_and_b32 v59, v5, v13
    v_mfma_f32_16x16x32_bf16 v[60:63], a[156:159], v[52:55], v[60:63]
    s_nop 0
    v_mfma_f32_16x16x32_bf16 v[64:67], a[156:159], v[56:59], v[64:67]
    s_waitcnt vmcnt(17)
    s_waitcnt vmcnt(11)
    buffer_load_dwordx4 a[208:211], v14, s[40:43], s63 offen nt
    s_add_u32 s63, s63, 8192
    s_mov_b32 s52, s18
    s_and_b32 s53, s19, 0xffff
    s_mov_b32 s54, 134217728
    s_mov_b32 s55, 0x20000
    s_mov_b32 s56, s20
    s_and_b32 s57, s21, 0xffff
    s_mov_b32 s58, 134217728
    s_mov_b32 s59, 0x20000
    v_perm_b32 v4, v24, v24, s80
    v_perm_b32 v5, v40, v40, s80
    v_and_b32 v52, v4, v10
    v_and_b32 v53, v4, v11
    v_and_b32 v54, v4, v12
    v_and_b32 v55, v4, v13
    v_and_b32 v56, v5, v10
    v_and_b32 v57, v5, v11
    v_and_b32 v58, v5, v12
    v_and_b32 v59, v5, v13
    v_mfma_f32_16x16x32_bf16 v[60:63], a[160:163], v[52:55], v[60:63]
    s_nop 0
    v_mfma_f32_16x16x32_bf16 v[64:67], a[160:163], v[56:59], v[64:67]
    s_waitcnt vmcnt(11)
    buffer_load_dwordx4 a[212:215], v14, s[40:43], s63 offen nt
    s_add_u32 s63, s63, 8192
    v_perm_b32 v4, v24, v24, s81
    v_perm_b32 v5, v40, v40, s81
    v_and_b32 v52, v4, v10
    v_and_b32 v53, v4, v11
    v_and_b32 v54, v4, v12
    v_and_b32 v55, v4, v13
    v_and_b32 v56, v5, v10
    v_and_b32 v57, v5, v11
    v_and_b32 v58, v5, v12
    v_and_b32 v59, v5, v13
    v_mfma_f32_16x16x32_bf16 v[60:63], a[164:167], v[52:55], v[60:63]
    s_nop 0
    v_mfma_f32_16x16x32_bf16 v[64:67], a[164:167], v[56:59], v[64:67]
    s_waitcnt vmcnt(11)
    buffer_load_dwordx4 a[216:219], v14, s[40:43], s63 offen nt
    s_add_u32 s63, s63, 8192
    v_perm_b32 v4, v25, v25, s80
    v_perm_b32 v5, v41, v41, s80
    v_and_b32 v52, v4, v10
    v_and_b32 v53, v4, v11
    v_and_b32 v54, v4, v12
    v_and_b32 v55, v4, v13
    v_and_b32 v56, v5, v10
    v_and_b32 v57, v5, v11
    v_and_b32 v58, v5, v12
    v_and_b32 v59, v5, v13
    v_mfma_f32_16x16x32_bf16 v[60:63], a[168:171], v[52:55], v[60:63]
    s_nop 0
    v_mfma_f32_16x16x32_bf16 v[64:67], a[168:171], v[56:59], v[64:67]
    s_waitcnt vmcnt(11)
    buffer_load_dwordx4 a[220:223], v14, s[40:43], s63 offen nt
    s_add_u32 s63, s63, 8192
    v_perm_b32 v4, v25, v25, s81
    v_perm_b32 v5, v41, v41, s81
    v_and_b32 v52, v4, v10
    v_and_b32 v53, v4, v11
    v_and_b32 v54, v4, v12
    v_and_b32 v55, v4, v13
    v_and_b32 v56, v5, v10
    v_and_b32 v57, v5, v11
    v_and_b32 v58, v5, v12
    v_and_b32 v59, v5, v13
    v_mfma_f32_16x16x32_bf16 v[60:63], a[172:175], v[52:55], v[60:63]
    s_nop 0
    v_mfma_f32_16x16x32_bf16 v[64:67], a[172:175], v[56:59], v[64:67]
    s_waitcnt vmcnt(11)
    buffer_load_dwordx4 a[224:227], v14, s[40:43], s63 offen nt
    s_add_u32 s63, s63, 8192
    v_mov_b32 v120, 0xff7f0000
    v_mov_b32 v121, 0
    v_mov_b32 v18, 1
    v_mov_b32 v116, 0
    v_mov_b32 v117, 0
    v_mov_b32 v118, 0
    v_mov_b32 v119, 0
    v_lshlrev_b32 v0, 3, v1
    ds_write_b64 v0, v[116:117] offset:8192
    v_mov_b32 v0, 8192
    s_lshl_b32 s38, s32, 10
    s_add_u32 s96, s38, 65536
    s_lshr_b32 s38, s32, 3
    s_lshl_b32 s38, s38, 8
    s_add_u32 s96, s38, s96
    v_mov_b32 v9, s96
    s_lshl_b32 s38, s32, 15
    s_add_u32 s96, s38, 1048576
    s_lshl_b32 s38, s3, 13
    s_add_u32 s96, s38, s96
    s_lshl_b32 s38, s33, 10
    s_add_u32 s96, s38, s96
    v_and_b32 v5, 3, v3
    v_lshlrev_b32 v78, 7, v2
    v_lshl_add_u32 v78, v5, 5, v78
    s_lshl_b32 s38, s32, 12
    s_add_u32 s91, s38, 262144
    s_lshl_b32 s38, s3, 9
    s_add_u32 s91, s38, s91
    v_lshlrev_b32 v4, 7, v2
    v_lshl_add_u32 v4, v3, 4, v4
    v_mov_b32 v5, 512
    v_cmp_gt_u32 vcc, 8, v3
    s_nop 1
    v_cndmask_b32 v79, v5, v4, vcc
    v_perm_b32 v4, v26, v26, s80
    v_perm_b32 v5, v42, v42, s80
    v_and_b32 v52, v4, v10
    v_and_b32 v53, v4, v11
    v_and_b32 v54, v4, v12
    v_and_b32 v55, v4, v13
    v_and_b32 v56, v5, v10
    v_and_b32 v57, v5, v11
    v_and_b32 v58, v5, v12
    v_and_b32 v59, v5, v13
    v_mfma_f32_16x16x32_bf16 v[60:63], a[176:179], v[52:55], v[60:63]
    s_nop 0
    v_mfma_f32_16x16x32_bf16 v[64:67], a[176:179], v[56:59], v[64:67]
    s_waitcnt vmcnt(11)
    buffer_load_dwordx4 a[228:231], v14, s[40:43], s63 offen nt
    s_add_u32 s63, s63, 8192
    v_perm_b32 v4, v26, v26, s81
    v_perm_b32 v5, v42, v42, s81
    v_and_b32 v52, v4, v10
    v_and_b32 v53, v4, v11
    v_and_b32 v54, v4, v12
    v_and_b32 v55, v4, v13
    v_and_b32 v56, v5, v10
    v_and_b32 v57, v5, v11
    v_and_b32 v58, v5, v12
    v_and_b32 v59, v5, v13
    v_mfma_f32_16x16x32_bf16 v[60:63], a[180:183], v[52:55], v[60:63]
    s_nop 0
    v_mfma_f32_16x16x32_bf16 v[64:67], a[180:183], v[56:59], v[64:67]
    s_waitcnt vmcnt(11)
    buffer_load_dwordx4 a[232:235], v14, s[40:43], s63 offen nt
    s_add_u32 s63, s63, 8192
    v_perm_b32 v4, v27, v27, s80
    v_perm_b32 v5, v43, v43, s80
    v_and_b32 v52, v4, v10
    v_and_b32 v53, v4, v11
    v_and_b32 v54, v4, v12
    v_and_b32 v55, v4, v13
    v_and_b32 v56, v5, v10
    v_and_b32 v57, v5, v11
    v_and_b32 v58, v5, v12
    v_and_b32 v59, v5, v13
    v_mfma_f32_16x16x32_bf16 v[60:63], a[184:187], v[52:55], v[60:63]
    s_nop 0
    v_mfma_f32_16x16x32_bf16 v[64:67], a[184:187], v[56:59], v[64:67]
    s_waitcnt vmcnt(11)
    buffer_load_dwordx4 a[236:239], v14, s[40:43], s63 offen nt
    s_add_u32 s63, s63, 8192
    v_perm_b32 v4, v27, v27, s81
    v_perm_b32 v5, v43, v43, s81
    v_and_b32 v52, v4, v10
    v_and_b32 v53, v4, v11
    v_and_b32 v54, v4, v12
    v_and_b32 v55, v4, v13
    v_and_b32 v56, v5, v10
    v_and_b32 v57, v5, v11
    v_and_b32 v58, v5, v12
    v_and_b32 v59, v5, v13
    v_mfma_f32_16x16x32_bf16 v[60:63], a[188:191], v[52:55], v[60:63]
    s_nop 0
    v_mfma_f32_16x16x32_bf16 v[64:67], a[188:191], v[56:59], v[64:67]
    s_waitcnt vmcnt(11)
    buffer_load_dwordx4 a[240:243], v14, s[40:43], s63 offen nt
    s_add_u32 s63, s63, 8192
    v_perm_b32 v4, v28, v28, s80
    v_perm_b32 v5, v44, v44, s80
    v_and_b32 v52, v4, v10
    v_and_b32 v53, v4, v11
    v_and_b32 v54, v4, v12
    v_and_b32 v55, v4, v13
    v_and_b32 v56, v5, v10
    v_and_b32 v57, v5, v11
    v_and_b32 v58, v5, v12
    v_and_b32 v59, v5, v13
    v_mfma_f32_16x16x32_bf16 v[60:63], a[192:195], v[52:55], v[60:63]
    s_nop 0
    v_mfma_f32_16x16x32_bf16 v[64:67], a[192:195], v[56:59], v[64:67]
    s_waitcnt vmcnt(11)
    buffer_load_dwordx4 a[244:247], v14, s[40:43], s63 offen nt
    s_add_u32 s63, s63, 8192
    v_perm_b32 v4, v28, v28, s81
    v_perm_b32 v5, v44, v44, s81
    v_and_b32 v52, v4, v10
    v_and_b32 v53, v4, v11
    v_and_b32 v54, v4, v12
    v_and_b32 v55, v4, v13
    v_and_b32 v56, v5, v10
    v_and_b32 v57, v5, v11
    v_and_b32 v58, v5, v12
    v_and_b32 v59, v5, v13
    v_mfma_f32_16x16x32_bf16 v[60:63], a[196:199], v[52:55], v[60:63]
    s_nop 0
    v_mfma_f32_16x16x32_bf16 v[64:67], a[196:199], v[56:59], v[64:67]
    s_waitcnt vmcnt(11)
    buffer_load_dwordx4 a[248:251], v14, s[40:43], s63 offen nt
    s_add_u32 s63, s63, 8192
    v_perm_b32 v4, v29, v29, s80
    v_perm_b32 v5, v45, v45, s80
    v_and_b32 v52, v4, v10
    v_and_b32 v53, v4, v11
    v_and_b32 v54, v4, v12
    v_and_b32 v55, v4, v13
    v_and_b32 v56, v5, v10
    v_and_b32 v57, v5, v11
    v_and_b32 v58, v5, v12
    v_and_b32 v59, v5, v13
    v_mfma_f32_16x16x32_bf16 v[60:63], a[200:203], v[52:55], v[60:63]
    s_nop 0
    v_mfma_f32_16x16x32_bf16 v[64:67], a[200:203], v[56:59], v[64:67]
    s_waitcnt vmcnt(11)
    buffer_load_dwordx4 a[252:255], v14, s[40:43], s63 offen nt
    s_add_u32 s63, s63, 8192
    v_perm_b32 v4, v29, v29, s81
    v_perm_b32 v5, v45, v45, s81
    v_and_b32 v52, v4, v10
    v_and_b32 v53, v4, v11
    v_and_b32 v54, v4, v12
    v_and_b32 v55, v4, v13
    v_and_b32 v56, v5, v10
    v_and_b32 v57, v5, v11
    v_and_b32 v58, v5, v12
    v_and_b32 v59, v5, v13
    v_mfma_f32_16x16x32_bf16 v[60:63], a[204:207], v[52:55], v[60:63]
    s_nop 0
    v_mfma_f32_16x16x32_bf16 v[64:67], a[204:207], v[56:59], v[64:67]
    s_waitcnt vmcnt(11)
    v_perm_b32 v4, v30, v30, s80
    v_perm_b32 v5, v46, v46, s80
    v_and_b32 v52, v4, v10
    v_and_b32 v53, v4, v11
    v_and_b32 v54, v4, v12
    v_and_b32 v55, v4, v13
    v_and_b32 v56, v5, v10
    v_and_b32 v57, v5, v11
    v_and_b32 v58, v5, v12
    v_and_b32 v59, v5, v13
    v_mfma_f32_16x16x32_bf16 v[60:63], a[208:211], v[52:55], v[60:63]
    s_nop 0
    v_mfma_f32_16x16x32_bf16 v[64:67], a[208:211], v[56:59], v[64:67]
    s_waitcnt vmcnt(10)
    v_perm_b32 v4, v30, v30, s81
    v_perm_b32 v5, v46, v46, s81
    v_and_b32 v52, v4, v10
    v_and_b32 v53, v4, v11
    v_and_b32 v54, v4, v12
    v_and_b32 v55, v4, v13
    v_and_b32 v56, v5, v10
    v_and_b32 v57, v5, v11
    v_and_b32 v58, v5, v12
    v_and_b32 v59, v5, v13
    v_mfma_f32_16x16x32_bf16 v[60:63], a[212:215], v[52:55], v[60:63]
    s_nop 0
    v_mfma_f32_16x16x32_bf16 v[64:67], a[212:215], v[56:59], v[64:67]
    s_waitcnt vmcnt(9)
    v_perm_b32 v4, v31, v31, s80
    v_perm_b32 v5, v47, v47, s80
    v_and_b32 v52, v4, v10
    v_and_b32 v53, v4, v11
    v_and_b32 v54, v4, v12
    v_and_b32 v55, v4, v13
    v_and_b32 v56, v5, v10
    v_and_b32 v57, v5, v11
    v_and_b32 v58, v5, v12
    v_and_b32 v59, v5, v13
    v_mfma_f32_16x16x32_bf16 v[60:63], a[216:219], v[52:55], v[60:63]
    s_nop 0
    v_mfma_f32_16x16x32_bf16 v[64:67], a[216:219], v[56:59], v[64:67]
    s_waitcnt vmcnt(8)
    v_perm_b32 v4, v31, v31, s81
    v_perm_b32 v5, v47, v47, s81
    v_and_b32 v52, v4, v10
    v_and_b32 v53, v4, v11
    v_and_b32 v54, v4, v12
    v_and_b32 v55, v4, v13
    v_and_b32 v56, v5, v10
    v_and_b32 v57, v5, v11
    v_and_b32 v58, v5, v12
    v_and_b32 v59, v5, v13
    v_mfma_f32_16x16x32_bf16 v[60:63], a[220:223], v[52:55], v[60:63]
    s_nop 0
    v_mfma_f32_16x16x32_bf16 v[64:67], a[220:223], v[56:59], v[64:67]
    s_waitcnt vmcnt(7)
    v_perm_b32 v4, v32, v32, s80
    v_perm_b32 v5, v48, v48, s80
    v_and_b32 v52, v4, v10
    v_and_b32 v53, v4, v11
    v_and_b32 v54, v4, v12
    v_and_b32 v55, v4, v13
    v_and_b32 v56, v5, v10
    v_and_b32 v57, v5, v11
    v_and_b32 v58, v5, v12
    v_and_b32 v59, v5, v13
    v_mfma_f32_16x16x32_bf16 v[60:63], a[224:227], v[52:55], v[60:63]
    s_nop 0
    v_mfma_f32_16x16x32_bf16 v[64:67], a[224:227], v[56:59], v[64:67]
    s_waitcnt vmcnt(6)
    s_add_u32 s39, s87, s88
    s_bfe_u32 s37, s39, 0x30000
    s_lshl_b32 s37, s37, 12
    s_add_u32 s85, s37, s89
    s_bfe_u32 s37, s39, 0x10003
    s_lshl_b32 s37, s37, 11
    s_add_u32 s85, s37, s85
    s_bfe_u32 s37, s39, 0x40004
    s_lshl_b32 s37, s37, 16
    s_add_u32 s85, s37, s85
    buffer_load_dwordx4 v[128:131], v76, s[52:55], s85 offen offset:0 nt
    v_perm_b32 v4, v32, v32, s81
    v_perm_b32 v5, v48, v48, s81
    v_and_b32 v52, v4, v10
    v_and_b32 v53, v4, v11
    v_and_b32 v54, v4, v12
    v_and_b32 v55, v4, v13
    v_and_b32 v56, v5, v10
    v_and_b32 v57, v5, v11
    v_and_b32 v58, v5, v12
    v_and_b32 v59, v5, v13
    v_mfma_f32_16x16x32_bf16 v[60:63], a[228:231], v[52:55], v[60:63]
    s_nop 0
    v_mfma_f32_16x16x32_bf16 v[64:67], a[228:231], v[56:59], v[64:67]
    s_waitcnt vmcnt(6)
    buffer_load_dwordx4 v[132:135], v77, s[52:55], s85 offen offset:0 nt
    v_perm_b32 v4, v33, v33, s80
    v_perm_b32 v5, v49, v49, s80
    v_and_b32 v52, v4, v10
    v_and_b32 v53, v4, v11
    v_and_b32 v54, v4, v12
    v_and_b32 v55, v4, v13
    v_and_b32 v56, v5, v10
    v_and_b32 v57, v5, v11
    v_and_b32 v58, v5, v12
    v_and_b32 v59, v5, v13
    v_mfma_f32_16x16x32_bf16 v[60:63], a[232:235], v[52:55], v[60:63]
    s_nop 0
    v_mfma_f32_16x16x32_bf16 v[64:67], a[232:235], v[56:59], v[64:67]
    s_waitcnt vmcnt(6)
    buffer_load_dwordx4 v[136:139], v76, s[52:55], s85 offen offset:1024 nt
    v_perm_b32 v4, v33, v33, s81
    v_perm_b32 v5, v49, v49, s81
    v_and_b32 v52, v4, v10
    v_and_b32 v53, v4, v11
    v_and_b32 v54, v4, v12
    v_and_b32 v55, v4, v13
    v_and_b32 v56, v5, v10
    v_and_b32 v57, v5, v11
    v_and_b32 v58, v5, v12
    v_and_b32 v59, v5, v13
    v_mfma_f32_16x16x32_bf16 v[60:63], a[236:239], v[52:55], v[60:63]
    s_nop 0
    v_mfma_f32_16x16x32_bf16 v[64:67], a[236:239], v[56:59], v[64:67]
    s_waitcnt vmcnt(6)
    buffer_load_dwordx4 v[140:143], v77, s[52:55], s85 offen offset:1024 nt
    s_add_u32 s87, s87, 7
    s_add_u32 s39, s87, s88
    s_bfe_u32 s37, s39, 0x30000
    s_lshl_b32 s37, s37, 12
    s_add_u32 s85, s37, s89
    s_bfe_u32 s37, s39, 0x10003
    s_lshl_b32 s37, s37, 11
    s_add_u32 s85, s37, s85
    s_bfe_u32 s37, s39, 0x40004
    s_lshl_b32 s37, s37, 16
    s_add_u32 s85, s37, s85
    v_perm_b32 v4, v34, v34, s80
    v_perm_b32 v5, v50, v50, s80
    v_and_b32 v52, v4, v10
    v_and_b32 v53, v4, v11
    v_and_b32 v54, v4, v12
    v_and_b32 v55, v4, v13
    v_and_b32 v56, v5, v10
    v_and_b32 v57, v5, v11
    v_and_b32 v58, v5, v12
    v_and_b32 v59, v5, v13
    v_mfma_f32_16x16x32_bf16 v[60:63], a[240:243], v[52:55], v[60:63]
    s_nop 0
    v_mfma_f32_16x16x32_bf16 v[64:67], a[240:243], v[56:59], v[64:67]
    s_waitcnt vmcnt(6)
    buffer_load_dwordx4 v[144:147], v76, s[52:55], s85 offen offset:0 nt
    v_perm_b32 v4, v34, v34, s81
    v_perm_b32 v5, v50, v50, s81
    v_and_b32 v52, v4, v10
    v_and_b32 v53, v4, v11
    v_and_b32 v54, v4, v12
    v_and_b32 v55, v4, v13
    v_and_b32 v56, v5, v10
    v_and_b32 v57, v5, v11
    v_and_b32 v58, v5, v12
    v_and_b32 v59, v5, v13
    v_mfma_f32_16x16x32_bf16 v[60:63], a[244:247], v[52:55], v[60:63]
    s_nop 0
    v_mfma_f32_16x16x32_bf16 v[64:67], a[244:247], v[56:59], v[64:67]
    s_waitcnt vmcnt(6)
    buffer_load_dwordx4 v[148:151], v77, s[52:55], s85 offen offset:0 nt
    v_perm_b32 v4, v35, v35, s80
    v_perm_b32 v5, v51, v51, s80
    v_and_b32 v52, v4, v10
    v_and_b32 v53, v4, v11
    v_and_b32 v54, v4, v12
    v_and_b32 v55, v4, v13
    v_and_b32 v56, v5, v10
    v_and_b32 v57, v5, v11
    v_and_b32 v58, v5, v12
    v_and_b32 v59, v5, v13
    v_mfma_f32_16x16x32_bf16 v[60:63], a[248:251], v[52:55], v[60:63]
    s_nop 0
    v_mfma_f32_16x16x32_bf16 v[64:67], a[248:251], v[56:59], v[64:67]
    s_waitcnt vmcnt(6)
    buffer_load_dwordx4 v[152:155], v76, s[52:55], s85 offen offset:1024 nt
    v_perm_b32 v4, v35, v35, s81
    v_perm_b32 v5, v51, v51, s81
    v_and_b32 v52, v4, v10
    v_and_b32 v53, v4, v11
    v_and_b32 v54, v4, v12
    v_and_b32 v55, v4, v13
    v_and_b32 v56, v5, v10
    v_and_b32 v57, v5, v11
    v_and_b32 v58, v5, v12
    v_and_b32 v59, v5, v13
    v_mfma_f32_16x16x32_bf16 v[60:63], a[252:255], v[52:55], v[60:63]
    s_nop 0
    v_mfma_f32_16x16x32_bf16 v[64:67], a[252:255], v[56:59], v[64:67]
    s_lshl_b32 s38, s34, 11
    v_lshrrev_b32 v4, 3, v3
    v_lshlrev_b32 v4, 9, v4
    v_lshl_add_u32 v4, v2, 7, v4
    v_and_b32 v5, 7, v3
    v_lshl_add_u32 v4, v5, 2, v4
    v_add_u32 v4, s38, v4
    ds_write_b32 v4, v60 offset:0
    ds_write_b32 v4, v61 offset:32
    ds_write_b32 v4, v62 offset:64
    ds_write_b32 v4, v63 offset:96
    ds_write_b32 v4, v64 offset:1024
    ds_write_b32 v4, v65 offset:1056
    ds_write_b32 v4, v66 offset:1088
    ds_write_b32 v4, v67 offset:1120
    s_lshl_b32 s38, s34, 9
    v_and_b32 v5, 31, v1
    v_lshl_add_u32 v5, v5, 4, s38
    s_waitcnt lgkmcnt(0)
    s_add_u32 s35, s35, 0x5b
    s_and_b32 s35, s35, 0xff
    v_mov_b32 v8, s35
    s_barrier
    ds_read_b128 v[20:23], v5 offset:0
    ds_read_b128 v[24:27], v5 offset:2048
    ds_read_b128 v[28:31], v5 offset:4096
    ds_read_b128 v[32:35], v5 offset:6144
    s_lshl_b32 s38, s61, 12
    s_add_u32 s36, s38, 262144
    s_lshl_b32 s38, s33, 11
    s_add_u32 s36, s38, s36
    s_waitcnt lgkmcnt(0)
    v_add_f32 v20, v20, v24
    v_add_f32 v28, v28, v32
    v_add_f32 v21, v21, v25
    v_add_f32 v29, v29, v33
    v_add_f32 v22, v22, v26
    v_add_f32 v30, v30, v34
    v_add_f32 v23, v23, v27
    v_add_f32 v31, v31, v35
    v_add_f32 v20, v20, v28
    v_add_f32 v21, v21, v29
    v_add_f32 v22, v22, v30
    v_add_f32 v23, v23, v31
    s_mov_b32 s38, 0xffff0000
    v_cvt_pk_bf16_f32 v20, v20, v20
    v_cvt_pk_bf16_f32 v21, v21, v21
    v_cvt_pk_bf16_f32 v22, v22, v22
    v_cvt_pk_bf16_f32 v23, v23, v23
    v_and_or_b32 v20, v20, s38, v8
    v_and_or_b32 v21, v21, s38, v8
    v_and_or_b32 v22, v22, s38, v8
    v_and_or_b32 v23, v23, s38, v8
    s_mov_b32 exec_lo, 0xffffffff
    s_mov_b32 exec_hi, 0x0
    buffer_store_dwordx4 v[20:23], v5, s[48:51], s36 offen sc1
    s_mov_b64 exec, -1
    s_waitcnt vmcnt(7)
    buffer_load_dwordx4 v[156:159], v77, s[52:55], s85 offen offset:1024 nt
    s_add_u32 s87, s87, 7
    s_add_u32 s39, s87, s88
    s_bfe_u32 s37, s39, 0x30000
    s_lshl_b32 s37, s37, 12
    s_add_u32 s85, s37, s89
    s_bfe_u32 s37, s39, 0x10003
    s_lshl_b32 s37, s37, 11
    s_add_u32 s85, s37, s85
    s_bfe_u32 s37, s39, 0x40004
    s_lshl_b32 s37, s37, 16
    s_add_u32 s85, s37, s85
    s_waitcnt vmcnt(7)
    buffer_load_dwordx4 v[160:163], v76, s[52:55], s85 offen offset:0 nt
    s_waitcnt vmcnt(7)
    buffer_load_dwordx4 v[164:167], v77, s[52:55], s85 offen offset:0 nt
    s_waitcnt vmcnt(7)
    buffer_load_dwordx4 v[168:171], v76, s[52:55], s85 offen offset:1024 nt
    s_waitcnt vmcnt(7)
    buffer_load_dwordx4 v[172:175], v77, s[52:55], s85 offen offset:1024 nt
    s_add_u32 s87, s87, 7
    s_add_u32 s39, s87, s88
    s_bfe_u32 s37, s39, 0x30000
    s_lshl_b32 s37, s37, 12
    s_add_u32 s85, s37, s89
    s_bfe_u32 s37, s39, 0x10003
    s_lshl_b32 s37, s37, 11
    s_add_u32 s85, s37, s85
    s_bfe_u32 s37, s39, 0x40004
    s_lshl_b32 s37, s37, 16
    s_add_u32 s85, s37, s85
    s_waitcnt vmcnt(7)
    buffer_load_dwordx4 v[176:179], v76, s[52:55], s85 offen offset:0 nt
    s_waitcnt vmcnt(7)
    buffer_load_dwordx4 v[180:183], v77, s[52:55], s85 offen offset:0 nt
    s_waitcnt vmcnt(6)
    buffer_load_dwordx4 v[184:187], v76, s[52:55], s85 offen offset:1024 nt
    s_waitcnt vmcnt(6)
    buffer_load_dwordx4 v[188:191], v77, s[52:55], s85 offen offset:1024 nt
    s_add_u32 s87, s87, 7
    s_add_u32 s39, s87, s88
    s_bfe_u32 s37, s39, 0x30000
    s_lshl_b32 s37, s37, 12
    s_add_u32 s85, s37, s89
    s_bfe_u32 s37, s39, 0x10003
    s_lshl_b32 s37, s37, 11
    s_add_u32 s85, s37, s85
    s_bfe_u32 s37, s39, 0x40004
    s_lshl_b32 s37, s37, 16
    s_add_u32 s85, s37, s85
    s_waitcnt vmcnt(6)
    buffer_load_dwordx4 v[192:195], v76, s[52:55], s85 offen offset:0 nt
    s_waitcnt vmcnt(6)
    buffer_load_dwordx4 v[196:199], v77, s[52:55], s85 offen offset:0 nt
    s_waitcnt vmcnt(6)
    buffer_load_dwordx4 v[200:203], v76, s[52:55], s85 offen offset:1024 nt
    s_waitcnt vmcnt(6)
    buffer_load_dwordx4 v[204:207], v77, s[52:55], s85 offen offset:1024 nt
    s_add_u32 s87, s87, 7
    s_add_u32 s39, s87, s88
    s_bfe_u32 s37, s39, 0x30000
    s_lshl_b32 s37, s37, 12
    s_add_u32 s85, s37, s89
    s_bfe_u32 s37, s39, 0x10003
    s_lshl_b32 s37, s37, 11
    s_add_u32 s85, s37, s85
    s_bfe_u32 s37, s39, 0x40004
    s_lshl_b32 s37, s37, 16
    s_add_u32 s85, s37, s85
    s_waitcnt vmcnt(6)
    buffer_load_dwordx4 v[208:211], v76, s[52:55], s85 offen offset:0 nt
    s_waitcnt vmcnt(6)
    buffer_load_dwordx4 v[212:215], v77, s[52:55], s85 offen offset:0 nt
    s_waitcnt vmcnt(6)
    buffer_load_dwordx4 v[216:219], v76, s[52:55], s85 offen offset:1024 nt
    s_waitcnt vmcnt(6)
    buffer_load_dwordx4 v[220:223], v77, s[52:55], s85 offen offset:1024 nt
    s_add_u32 s87, s87, 7
    s_add_u32 s39, s87, s88
    s_bfe_u32 s37, s39, 0x30000
    s_lshl_b32 s37, s37, 12
    s_add_u32 s85, s37, s89
    s_bfe_u32 s37, s39, 0x10003
    s_lshl_b32 s37, s37, 11
    s_add_u32 s85, s37, s85
    s_bfe_u32 s37, s39, 0x40004
    s_lshl_b32 s37, s37, 16
    s_add_u32 s85, s37, s85
    s_waitcnt vmcnt(6)
    buffer_load_dwordx4 v[224:227], v76, s[52:55], s85 offen offset:0 nt
    s_waitcnt vmcnt(6)
    buffer_load_dwordx4 v[228:231], v77, s[52:55], s85 offen offset:0 nt
    s_waitcnt vmcnt(6)
    buffer_load_dwordx4 v[232:235], v76, s[52:55], s85 offen offset:1024 nt
    s_waitcnt vmcnt(6)
    buffer_load_dwordx4 v[236:239], v77, s[52:55], s85 offen offset:1024 nt
    s_add_u32 s87, s87, 7
    s_add_u32 s39, s87, s88
    s_bfe_u32 s37, s39, 0x30000
    s_lshl_b32 s37, s37, 12
    s_add_u32 s85, s37, s89
    s_bfe_u32 s37, s39, 0x10003
    s_lshl_b32 s37, s37, 11
    s_add_u32 s85, s37, s85
    s_bfe_u32 s37, s39, 0x40004
    s_lshl_b32 s37, s37, 16
    s_add_u32 s85, s37, s85
    s_waitcnt vmcnt(6)
    buffer_load_dwordx4 v[240:243], v76, s[52:55], s85 offen offset:0 nt
    s_waitcnt vmcnt(6)
    buffer_load_dwordx4 v[244:247], v77, s[52:55], s85 offen offset:0 nt
    s_waitcnt vmcnt(6)
    buffer_load_dwordx4 v[248:251], v76, s[52:55], s85 offen offset:1024 nt
    s_waitcnt vmcnt(6)
    buffer_load_dwordx4 v[252:255], v77, s[52:55], s85 offen offset:1024 nt
    s_add_u32 s87, s87, 7
    s_add_u32 s39, s87, s88
    s_bfe_u32 s37, s39, 0x30000
    s_lshl_b32 s37, s37, 12
    s_add_u32 s85, s37, s89
    s_bfe_u32 s37, s39, 0x10003
    s_lshl_b32 s37, s37, 11
    s_add_u32 s85, s37, s85
    s_bfe_u32 s37, s39, 0x40004
    s_lshl_b32 s37, s37, 16
    s_add_u32 s85, s37, s85
    s_waitcnt vmcnt(6)
    buffer_load_dwordx4 a[0:3], v76, s[52:55], s85 offen offset:0 nt
    s_waitcnt vmcnt(6)
    buffer_load_dwordx4 a[4:7], v77, s[52:55], s85 offen offset:0 nt
    s_waitcnt vmcnt(6)
    buffer_load_dwordx4 a[8:11], v76, s[52:55], s85 offen offset:1024 nt
    s_waitcnt vmcnt(6)
    buffer_load_dwordx4 a[12:15], v77, s[52:55], s85 offen offset:1024 nt
    s_add_u32 s87, s87, 7
    s_add_u32 s39, s87, s88
    s_bfe_u32 s37, s39, 0x30000
    s_lshl_b32 s37, s37, 12
    s_add_u32 s85, s37, s89
    s_bfe_u32 s37, s39, 0x10003
    s_lshl_b32 s37, s37, 11
    s_add_u32 s85, s37, s85
    s_bfe_u32 s37, s39, 0x40004
    s_lshl_b32 s37, s37, 16
    s_add_u32 s85, s37, s85
    s_waitcnt vmcnt(6)
    buffer_load_dwordx4 a[16:19], v76, s[52:55], s85 offen offset:0 nt
    s_waitcnt vmcnt(6)
    buffer_load_dwordx4 a[20:23], v77, s[52:55], s85 offen offset:0 nt
    s_waitcnt vmcnt(6)
    buffer_load_dwordx4 a[24:27], v76, s[52:55], s85 offen offset:1024 nt
    s_waitcnt vmcnt(6)
    buffer_load_dwordx4 a[28:31], v77, s[52:55], s85 offen offset:1024 nt
    s_add_u32 s87, s87, 7
    s_add_u32 s39, s87, s88
    s_bfe_u32 s37, s39, 0x30000
    s_lshl_b32 s37, s37, 12
    s_add_u32 s85, s37, s89
    s_bfe_u32 s37, s39, 0x10003
    s_lshl_b32 s37, s37, 11
    s_add_u32 s85, s37, s85
    s_bfe_u32 s37, s39, 0x40004
    s_lshl_b32 s37, s37, 16
    s_add_u32 s85, s37, s85
    s_waitcnt vmcnt(6)
    buffer_load_dwordx4 a[32:35], v76, s[52:55], s85 offen offset:0 nt
    s_waitcnt vmcnt(6)
    buffer_load_dwordx4 a[36:39], v77, s[52:55], s85 offen offset:0 nt
    s_waitcnt vmcnt(6)
    buffer_load_dwordx4 a[40:43], v76, s[52:55], s85 offen offset:1024 nt
    s_waitcnt vmcnt(6)
    buffer_load_dwordx4 a[44:47], v77, s[52:55], s85 offen offset:1024 nt
    s_add_u32 s87, s87, 7
    s_add_u32 s39, s87, s88
    s_bfe_u32 s37, s39, 0x30000
    s_lshl_b32 s37, s37, 12
    s_add_u32 s85, s37, s89
    s_bfe_u32 s37, s39, 0x10003
    s_lshl_b32 s37, s37, 11
    s_add_u32 s85, s37, s85
    s_bfe_u32 s37, s39, 0x40004
    s_lshl_b32 s37, s37, 16
    s_add_u32 s85, s37, s85
    s_waitcnt vmcnt(6)
    buffer_load_dwordx4 a[48:51], v76, s[52:55], s85 offen offset:0 nt
    s_waitcnt vmcnt(6)
    buffer_load_dwordx4 a[52:55], v77, s[52:55], s85 offen offset:0 nt
    buffer_load_dwordx4 v[68:71], v78, s[48:51], s91 offen offset:0 sc1
    buffer_load_dwordx4 v[72:75], v78, s[48:51], s91 offen offset:16 sc1
    s_waitcnt vmcnt(8)
    buffer_load_dwordx4 a[56:59], v76, s[52:55], s85 offen offset:1024 nt
    s_waitcnt vmcnt(8)
    buffer_load_dwordx4 a[60:63], v77, s[52:55], s85 offen offset:1024 nt
    s_add_u32 s87, s87, 7
    s_add_u32 s39, s87, s88
    s_bfe_u32 s37, s39, 0x30000
    s_lshl_b32 s37, s37, 12
    s_add_u32 s85, s37, s89
    s_bfe_u32 s37, s39, 0x10003
    s_lshl_b32 s37, s37, 11
    s_add_u32 s85, s37, s85
    s_bfe_u32 s37, s39, 0x40004
    s_lshl_b32 s37, s37, 16
    s_add_u32 s85, s37, s85
    s_waitcnt vmcnt(8)
    buffer_load_dwordx4 a[64:67], v76, s[52:55], s85 offen offset:0 nt
    s_waitcnt vmcnt(8)
    buffer_load_dwordx4 a[68:71], v77, s[52:55], s85 offen offset:0 nt
    s_waitcnt vmcnt(8)
    buffer_load_dwordx4 a[72:75], v76, s[52:55], s85 offen offset:1024 nt
    s_waitcnt vmcnt(8)
    buffer_load_dwordx4 a[76:79], v77, s[52:55], s85 offen offset:1024 nt
    s_add_u32 s87, s87, 7
    s_add_u32 s39, s87, s88
    s_bfe_u32 s37, s39, 0x30000
    s_lshl_b32 s37, s37, 12
    s_add_u32 s85, s37, s89
    s_bfe_u32 s37, s39, 0x10003
    s_lshl_b32 s37, s37, 11
    s_add_u32 s85, s37, s85
    s_bfe_u32 s37, s39, 0x40004
    s_lshl_b32 s37, s37, 16
    s_add_u32 s85, s37, s85
    s_waitcnt vmcnt(6)
L_qcheck_39:
    v_xor_b32 v68, s35, v68
    v_xor_b32 v69, s35, v69
    v_xor_b32 v70, s35, v70
    v_xor_b32 v71, s35, v71
    v_xor_b32 v72, s35, v72
    v_xor_b32 v73, s35, v73
    v_xor_b32 v74, s35, v74
    v_xor_b32 v75, s35, v75
    v_or_b32 v4, v68, v69
    v_or3_b32 v4, v4, v70, v71
    v_or3_b32 v4, v4, v72, v73
    v_or3_b32 v4, v4, v74, v75
    v_and_b32 v4, 0xff, v4
    v_cmp_ne_u32 vcc, 0, v4
    s_cbranch_vccz L_qok_40
    buffer_load_dwordx4 v[68:71], v78, s[48:51], s91 offen offset:0 sc1
    buffer_load_dwordx4 v[72:75], v78, s[48:51], s91 offen offset:16 sc1
    s_waitcnt vmcnt(0)
    s_sub_u32 s84, s84, 1
    s_cmp_lg_u32 s84, 0
    s_cbranch_scc1 L_qcheck_39
    s_branch L_end
L_qok_40:
    v_cvt_pk_bf16_f32 v68, v68, v69
    v_cvt_pk_bf16_f32 v69, v70, v71
    v_cvt_pk_bf16_f32 v70, v72, v73
    v_cvt_pk_bf16_f32 v71, v74, v75
    s_mov_b32 vcc_lo, 0xf000f
    s_mov_b32 vcc_hi, 0xf000f
    v_cndmask_b32 v80, 0, v68, vcc
    v_cndmask_b32 v81, 0, v69, vcc
    v_cndmask_b32 v82, 0, v70, vcc
    v_cndmask_b32 v83, 0, v71, vcc
    s_mov_b32 vcc_lo, 0xf000f0
    s_mov_b32 vcc_hi, 0xf000f0
    v_cndmask_b32 v84, 0, v68, vcc
    v_cndmask_b32 v85, 0, v69, vcc
    v_cndmask_b32 v86, 0, v70, vcc
    v_cndmask_b32 v87, 0, v71, vcc
    s_mov_b32 vcc_lo, 0xf000f00
    s_mov_b32 vcc_hi, 0xf000f00
    v_cndmask_b32 v88, 0, v68, vcc
    v_cndmask_b32 v89, 0, v69, vcc
    v_cndmask_b32 v90, 0, v70, vcc
    v_cndmask_b32 v91, 0, v71, vcc
    s_mov_b32 vcc_lo, 0xf000f000
    s_mov_b32 vcc_hi, 0xf000f000
    v_cndmask_b32 v92, 0, v68, vcc
    v_cndmask_b32 v93, 0, v69, vcc
    v_cndmask_b32 v94, 0, v70, vcc
    v_cndmask_b32 v95, 0, v71, vcc
    s_getreg_b32 s70, hwreg(HW_REG_XCC_ID, 0, 4)
    s_lshl_b32 s70, s70, 8
    s_or_b32 s70, s70, s35
    s_or_b32 s70, s70, 0x5e9d0000
    s_bfe_u32 s38, s2, 0x30000
    s_lshl_b32 s38, s38, 8
    s_add_u32 s69, s38, 32768
    s_lshl_b32 s38, s32, 2
    s_add_u32 s69, s38, s69
    s_lshl_b32 s38, s34, 24
    s_add_u32 s69, s38, s69
    v_mov_b32 v72, s69
    v_mov_b32 v73, s70
    s_mov_b64 exec, 1
    buffer_store_dword v73, v72, s[48:51], 0 offen sc1
    s_mov_b64 exec, -1
    v_mov_b32 v65, 0xff7f0000
    s_lshl_b32 s38, s34, 14
    s_add_u32 s38, s38, 16384
    v_lshl_add_u32 v64, v1, 2, s38
    buffer_load_dwordx4 a[80:83], v76, s[52:55], s85 offen offset:0 nt
    v_mfma_f32_16x16x32_bf16 v[112:115], v[128:131], v[80:83], 0
    v_mfma_f32_16x16x32_bf16 v[112:115], v[132:135], v[84:87], v[112:115]
    v_mfma_f32_16x16x32_bf16 v[112:115], v[136:139], v[88:91], v[112:115]
    s_waitcnt vmcnt(7)
    buffer_load_dwordx4 a[84:87], v77, s[52:55], s85 offen offset:0 nt
    v_mfma_f32_16x16x32_bf16 v[112:115], v[140:143], v[92:95], v[112:115]
    v_mfma_f32_16x16x32_bf16 v[96:99], v[144:147], v[80:83], 0
    v_mfma_f32_16x16x32_bf16 v[96:99], v[148:151], v[84:87], v[96:99]
    v_mfma_f32_16x16x32_bf16 v[96:99], v[152:155], v[88:91], v[96:99]
    s_nop 4
    v_mov_b32_dpp v122, v112 quad_perm:[0,0,0,0] row_mask:0xf bank_mask:0xf
    v_mov_b32_dpp v124, v114 quad_perm:[2,2,2,2] row_mask:0xf bank_mask:0xf
    s_nop 0
    v_add_f32_dpp v122, v113, v122 quad_perm:[1,1,1,1] row_mask:0xf bank_mask:0xf
    v_add_f32_dpp v124, v115, v124 quad_perm:[3,3,3,3] row_mask:0xf bank_mask:0xf
    v_add_f32 v122, v122, v124
    v_max_f32 v65, v65, v122
    ds_write_b32 v64, v122 offset:0
    s_waitcnt vmcnt(7)
    buffer_load_dwordx4 a[88:91], v76, s[52:55], s85 offen offset:1024 nt
    v_mfma_f32_16x16x32_bf16 v[96:99], v[156:159], v[92:95], v[96:99]
    v_mfma_f32_16x16x32_bf16 v[112:115], v[160:163], v[80:83], 0
    v_mfma_f32_16x16x32_bf16 v[112:115], v[164:167], v[84:87], v[112:115]
    s_waitcnt vmcnt(7)
    buffer_load_dwordx4 a[92:95], v77, s[52:55], s85 offen offset:1024 nt
    s_add_u32 s87, s87, 7
    s_add_u32 s39, s87, s88
    s_bfe_u32 s37, s39, 0x30000
    s_lshl_b32 s37, s37, 12
    s_add_u32 s85, s37, s89
    s_bfe_u32 s37, s39, 0x10003
    s_lshl_b32 s37, s37, 11
    s_add_u32 s85, s37, s85
    s_bfe_u32 s37, s39, 0x40004
    s_lshl_b32 s37, s37, 16
    s_add_u32 s85, s37, s85
    v_mfma_f32_16x16x32_bf16 v[112:115], v[168:171], v[88:91], v[112:115]
    v_mov_b32_dpp v122, v96 quad_perm:[0,0,0,0] row_mask:0xf bank_mask:0xf
    v_mov_b32_dpp v124, v98 quad_perm:[2,2,2,2] row_mask:0xf bank_mask:0xf
    s_nop 0
    v_add_f32_dpp v122, v97, v122 quad_perm:[1,1,1,1] row_mask:0xf bank_mask:0xf
    v_add_f32_dpp v124, v99, v124 quad_perm:[3,3,3,3] row_mask:0xf bank_mask:0xf
    v_add_f32 v122, v122, v124
    v_max_f32 v65, v65, v122
    ds_write_b32 v64, v122 offset:256
    v_mfma_f32_16x16x32_bf16 v[112:115], v[172:175], v[92:95], v[112:115]
    v_mfma_f32_16x16x32_bf16 v[96:99], v[176:179], v[80:83], 0
    v_mfma_f32_16x16x32_bf16 v[96:99], v[180:183], v[84:87], v[96:99]
    s_waitcnt vmcnt(7)
    buffer_load_dwordx4 a[96:99], v76, s[52:55], s85 offen offset:0 nt
    v_mfma_f32_16x16x32_bf16 v[96:99], v[184:187], v[88:91], v[96:99]
    s_nop 2
    v_mov_b32_dpp v122, v112 quad_perm:[0,0,0,0] row_mask:0xf bank_mask:0xf
    v_mov_b32_dpp v124, v114 quad_perm:[2,2,2,2] row_mask:0xf bank_mask:0xf
    s_nop 0
    v_add_f32_dpp v122, v113, v122 quad_perm:[1,1,1,1] row_mask:0xf bank_mask:0xf
    v_add_f32_dpp v124, v115, v124 quad_perm:[3,3,3,3] row_mask:0xf bank_mask:0xf
    v_add_f32 v122, v122, v124
    v_max_f32 v65, v65, v122
    ds_write_b32 v64, v122 offset:512
    v_mfma_f32_16x16x32_bf16 v[96:99], v[188:191], v[92:95], v[96:99]
    v_mfma_f32_16x16x32_bf16 v[112:115], v[192:195], v[80:83], 0
    s_waitcnt vmcnt(7)
    buffer_load_dwordx4 a[100:103], v77, s[52:55], s85 offen offset:0 nt
    v_mfma_f32_16x16x32_bf16 v[112:115], v[196:199], v[84:87], v[112:115]
    v_mfma_f32_16x16x32_bf16 v[112:115], v[200:203], v[88:91], v[112:115]
    s_nop 2
    v_mov_b32_dpp v122, v96 quad_perm:[0,0,0,0] row_mask:0xf bank_mask:0xf
    v_mov_b32_dpp v124, v98 quad_perm:[2,2,2,2] row_mask:0xf bank_mask:0xf
    s_nop 0
    v_add_f32_dpp v122, v97, v122 quad_perm:[1,1,1,1] row_mask:0xf bank_mask:0xf
    v_add_f32_dpp v124, v99, v124 quad_perm:[3,3,3,3] row_mask:0xf bank_mask:0xf
    v_add_f32 v122, v122, v124
    v_max_f32 v65, v65, v122
    ds_write_b32 v64, v122 offset:768
    v_mfma_f32_16x16x32_bf16 v[112:115], v[204:207], v[92:95], v[112:115]
    v_mfma_f32_16x16x32_bf16 v[96:99], v[208:211], v[80:83], 0
    s_waitcnt vmcnt(7)
    buffer_load_dwordx4 a[104:107], v76, s[52:55], s85 offen offset:1024 nt
    v_mfma_f32_16x16x32_bf16 v[96:99], v[212:215], v[84:87], v[96:99]
    v_mfma_f32_16x16x32_bf16 v[96:99], v[216:219], v[88:91], v[96:99]
    s_nop 2
    v_mov_b32_dpp v122, v112 quad_perm:[0,0,0,0] row_mask:0xf bank_mask:0xf
    v_mov_b32_dpp v124, v114 quad_perm:[2,2,2,2] row_mask:0xf bank_mask:0xf
    s_nop 0
    v_add_f32_dpp v122, v113, v122 quad_perm:[1,1,1,1] row_mask:0xf bank_mask:0xf
    v_add_f32_dpp v124, v115, v124 quad_perm:[3,3,3,3] row_mask:0xf bank_mask:0xf
    v_add_f32 v122, v122, v124
    v_max_f32 v65, v65, v122
    ds_write_b32 v64, v122 offset:1024
    v_mfma_f32_16x16x32_bf16 v[96:99], v[220:223], v[92:95], v[96:99]
    s_waitcnt vmcnt(6)
    buffer_load_dwordx4 a[108:111], v77, s[52:55], s85 offen offset:1024 nt
    s_add_u32 s87, s87, 7
    s_add_u32 s39, s87, s88
    s_bfe_u32 s37, s39, 0x30000
    s_lshl_b32 s37, s37, 12
    s_add_u32 s85, s37, s89
    s_bfe_u32 s37, s39, 0x10003
    s_lshl_b32 s37, s37, 11
    s_add_u32 s85, s37, s85
    s_bfe_u32 s37, s39, 0x40004
    s_lshl_b32 s37, s37, 16
    s_add_u32 s85, s37, s85
    v_mfma_f32_16x16x32_bf16 v[112:115], v[224:227], v[80:83], 0
    v_mfma_f32_16x16x32_bf16 v[112:115], v[228:231], v[84:87], v[112:115]
    v_mfma_f32_16x16x32_bf16 v[112:115], v[232:235], v[88:91], v[112:115]
    v_mov_b32_dpp v122, v96 quad_perm:[0,0,0,0] row_mask:0xf bank_mask:0xf
    v_mov_b32_dpp v124, v98 quad_perm:[2,2,2,2] row_mask:0xf bank_mask:0xf
    s_nop 0
    v_add_f32_dpp v122, v97, v122 quad_perm:[1,1,1,1] row_mask:0xf bank_mask:0xf
    v_add_f32_dpp v124, v99, v124 quad_perm:[3,3,3,3] row_mask:0xf bank_mask:0xf
    v_add_f32 v122, v122, v124
    v_max_f32 v65, v65, v122
    ds_write_b32 v64, v122 offset:1280
    v_mfma_f32_16x16x32_bf16 v[112:115], v[236:239], v[92:95], v[112:115]
    s_waitcnt vmcnt(6)
    buffer_load_dwordx4 a[112:115], v76, s[52:55], s85 offen offset:0 nt
    v_mfma_f32_16x16x32_bf16 v[96:99], v[240:243], v[80:83], 0
    v_mfma_f32_16x16x32_bf16 v[96:99], v[244:247], v[84:87], v[96:99]
    v_mfma_f32_16x16x32_bf16 v[96:99], v[248:251], v[88:91], v[96:99]
    s_nop 2
    v_mov_b32_dpp v122, v112 quad_perm:[0,0,0,0] row_mask:0xf bank_mask:0xf
    v_mov_b32_dpp v124, v114 quad_perm:[2,2,2,2] row_mask:0xf bank_mask:0xf
    s_nop 0
    v_add_f32_dpp v122, v113, v122 quad_perm:[1,1,1,1] row_mask:0xf bank_mask:0xf
    v_add_f32_dpp v124, v115, v124 quad_perm:[3,3,3,3] row_mask:0xf bank_mask:0xf
    v_add_f32 v122, v122, v124
    v_max_f32 v65, v65, v122
    ds_write_b32 v64, v122 offset:1536
    v_mfma_f32_16x16x32_bf16 v[96:99], v[252:255], v[92:95], v[96:99]
    s_waitcnt vmcnt(6)
    buffer_load_dwordx4 a[116:119], v77, s[52:55], s85 offen offset:0 nt
    v_mfma_f32_16x16x32_bf16 v[112:115], a[0:3], v[80:83], 0
    v_mfma_f32_16x16x32_bf16 v[112:115], a[4:7], v[84:87], v[112:115]
    v_mfma_f32_16x16x32_bf16 v[112:115], a[8:11], v[88:91], v[112:115]
    s_nop 2
    v_mov_b32_dpp v122, v96 quad_perm:[0,0,0,0] row_mask:0xf bank_mask:0xf
    v_mov_b32_dpp v124, v98 quad_perm:[2,2,2,2] row_mask:0xf bank_mask:0xf
    s_nop 0
    v_add_f32_dpp v122, v97, v122 quad_perm:[1,1,1,1] row_mask:0xf bank_mask:0xf
    v_add_f32_dpp v124, v99, v124 quad_perm:[3,3,3,3] row_mask:0xf bank_mask:0xf
    v_add_f32 v122, v122, v124
    v_max_f32 v65, v65, v122
    ds_write_b32 v64, v122 offset:1792
    s_waitcnt vmcnt(6)
    buffer_load_dwordx4 a[120:123], v76, s[52:55], s85 offen offset:1024 nt
    v_mfma_f32_16x16x32_bf16 v[112:115], a[12:15], v[92:95], v[112:115]
    v_mfma_f32_16x16x32_bf16 v[96:99], a[16:19], v[80:83], 0
    v_mfma_f32_16x16x32_bf16 v[96:99], a[20:23], v[84:87], v[96:99]
    v_mfma_f32_16x16x32_bf16 v[96:99], a[24:27], v[88:91], v[96:99]
    s_nop 4
    v_mov_b32_dpp v122, v112 quad_perm:[0,0,0,0] row_mask:0xf bank_mask:0xf
    v_mov_b32_dpp v124, v114 quad_perm:[2,2,2,2] row_mask:0xf bank_mask:0xf
    s_nop 0
    v_add_f32_dpp v122, v113, v122 quad_perm:[1,1,1,1] row_mask:0xf bank_mask:0xf
    v_add_f32_dpp v124, v115, v124 quad_perm:[3,3,3,3] row_mask:0xf bank_mask:0xf
    v_add_f32 v122, v122, v124
    v_max_f32 v65, v65, v122
    ds_write_b32 v64, v122 offset:2048
    s_waitcnt vmcnt(6)
    buffer_load_dwordx4 a[124:127], v77, s[52:55], s85 offen offset:1024 nt
    s_add_u32 s87, s87, 7
    s_add_u32 s39, s87, s88
    s_bfe_u32 s37, s39, 0x30000
    s_lshl_b32 s37, s37, 12
    s_add_u32 s85, s37, s89
    s_bfe_u32 s37, s39, 0x10003
    s_lshl_b32 s37, s37, 11
    s_add_u32 s85, s37, s85
    s_bfe_u32 s37, s39, 0x40004
    s_lshl_b32 s37, s37, 16
    s_add_u32 s85, s37, s85
    v_mfma_f32_16x16x32_bf16 v[96:99], a[28:31], v[92:95], v[96:99]
    v_mfma_f32_16x16x32_bf16 v[112:115], a[32:35], v[80:83], 0
    s_bfe_u32 s38, s2, 0x20001
    s_lshl_b32 s38, s38, 0
    s_add_u32 s90, s38, 0
    s_bfe_u32 s38, s2, 0x10000
    s_lshl_b32 s38, s38, 2
    s_add_u32 s90, s38, s90
    s_and_b32 s36, s90, 3
    s_bitcmp0_b32 s90, 2
    s_cselect_b64 s[40:41], s[24:25], s[14:15]
    s_cselect_b32 s45, 262144, 0
    s_add_u32 s45, s45, 524288
    s_lshl_b32 s38, s36, 16
    s_add_u32 s71, s38, s45
    s_lshr_b32 s38, s32, 2
    s_lshl_b32 s38, s38, 13
    s_add_u32 s71, s38, s71
    s_bfe_u32 s38, s32, 0x20000
    s_lshl_b32 s38, s38, 6
    s_add_u32 s71, s38, s71
    s_mov_b32 s42, 4194304
    s_mov_b32 s43, 0x20000
    s_lshl_b32 s38, s32, 17
    s_add_u32 s44, s38, 0
    s_lshl_b32 s38, s34, 15
    s_add_u32 s44, s38, s44
    s_lshl_b32 s38, s36, 8
    s_add_u32 s44, s38, s44
    s_lshl_b32 s38, s36, 16
    s_add_u32 s45, s38, s45
    s_lshr_b32 s38, s34, 1
    s_lshl_b32 s38, s38, 15
    s_add_u32 s45, s38, s45
    s_lshl_b32 s38, s32, 8
    s_add_u32 s45, s38, s45
    s_bfe_u32 s38, s34, 0x10000
    s_lshl_b32 s38, s38, 7
    s_add_u32 s45, s38, s45
    s_lshl_b32 s38, s32, 11
    s_add_u32 s46, s38, 196608
    s_lshl_b32 s38, s34, 9
    s_add_u32 s46, s38, s46
    s_mov_b32 s72, s26
    s_and_b32 s73, s27, 0xffff
    s_mov_b32 s74, 8192
    s_mov_b32 s75, 0x20000
    v_mfma_f32_16x16x32_bf16 v[112:115], a[36:39], v[84:87], v[112:115]
    s_waitcnt vmcnt(5)
    buffer_load_dwordx4 v[128:131], v76, s[52:55], s85 offen offset:0 nt
    v_mfma_f32_16x16x32_bf16 v[112:115], a[40:43], v[88:91], v[112:115]
    v_mov_b32_dpp v122, v96 quad_perm:[0,0,0,0] row_mask:0xf bank_mask:0xf
    v_mov_b32_dpp v124, v98 quad_perm:[2,2,2,2] row_mask:0xf bank_mask:0xf
    s_nop 0
    v_add_f32_dpp v122, v97, v122 quad_perm:[1,1,1,1] row_mask:0xf bank_mask:0xf
    v_add_f32_dpp v124, v99, v124 quad_perm:[3,3,3,3] row_mask:0xf bank_mask:0xf
    v_add_f32 v122, v122, v124
    v_max_f32 v65, v65, v122
    ds_write_b32 v64, v122 offset:2304
    v_mfma_f32_16x16x32_bf16 v[112:115], a[44:47], v[92:95], v[112:115]
    v_mfma_f32_16x16x32_bf16 v[96:99], a[48:51], v[80:83], 0
    v_mfma_f32_16x16x32_bf16 v[96:99], a[52:55], v[84:87], v[96:99]
    s_waitcnt vmcnt(5)
    buffer_load_dwordx4 v[132:135], v77, s[52:55], s85 offen offset:0 nt
    v_mfma_f32_16x16x32_bf16 v[96:99], a[56:59], v[88:91], v[96:99]
    s_nop 2
    v_mov_b32_dpp v122, v112 quad_perm:[0,0,0,0] row_mask:0xf bank_mask:0xf
    v_mov_b32_dpp v124, v114 quad_perm:[2,2,2,2] row_mask:0xf bank_mask:0xf
    s_nop 0
    v_add_f32_dpp v122, v113, v122 quad_perm:[1,1,1,1] row_mask:0xf bank_mask:0xf
    v_add_f32_dpp v124, v115, v124 quad_perm:[3,3,3,3] row_mask:0xf bank_mask:0xf
    v_add_f32 v122, v122, v124
    v_max_f32 v65, v65, v122
    ds_write_b32 v64, v122 offset:2560
    v_lshlrev_b32 v4, 2, v2
    v_xor_b32 v4, v4, v3
    v_xor_b32 v5, 0, v4
    v_lshlrev_b32 v5, 4, v5
    v_lshl_add_u32 v20, v2, 10, v5
    v_xor_b32 v5, 1, v4
    v_lshlrev_b32 v5, 4, v5
    v_lshl_add_u32 v21, v2, 10, v5
    v_add_u32 v21, 3072, v21
    v_xor_b32 v5, 2, v4
    v_lshlrev_b32 v5, 4, v5
    v_lshl_add_u32 v22, v2, 10, v5
    v_add_u32 v22, 6144, v22
    v_xor_b32 v5, 3, v4
    v_lshlrev_b32 v5, 4, v5
    v_lshl_add_u32 v23, v2, 10, v5
    v_add_u32 v23, 9216, v23
    s_lshl_b32 s38, s32, 15
    s_add_u32 s47, s38, 1048576
    s_lshl_b32 s38, s3, 13
    s_add_u32 s47, s38, s47
    v_lshlrev_b32 v6, 7, v2
    v_bfe_u32 v5, v3, 0, 3
    v_lshl_add_u32 v6, v5, 4, v6
    v_lshrrev_b32 v4, 3, v3
    v_and_b32 v7, 3, v3
    v_min_u32 v7, 2, v7
    v_lshl_add_u32 v7, v7, 1, v4
    v_add_u32 v5, 0, v4
    v_cmp_le_u32 vcc, s33, v5
    s_nop 1
    v_addc_co_u32 v5, vcc, 0, v5, vcc
    v_lshl_add_u32 v50, v5, 10, v6
    v_add_u32 v5, 2, v4
    v_cmp_le_u32 vcc, s33, v5
    s_nop 1
    v_addc_co_u32 v5, vcc, 0, v5, vcc
    v_lshl_add_u32 v51, v5, 10, v6
    v_add_u32 v5, 4, v4
    v_cmp_le_u32 vcc, s33, v5
    s_nop 1
    v_addc_co_u32 v5, vcc, 0, v5, vcc
    v_lshl_add_u32 v52, v5, 10, v6
    v_mov_b32 v5, v7
    v_mov_b32 v6, 512
    v_cmp_le_u32 vcc, s33, v5
    s_nop 1
    v_addc_co_u32 v5, vcc, 0, v5, vcc
    v_lshl_add_u32 v53, v5, 10, v6
    s_mul_i32 s38, s3, 320
    s_add_u32 s38, s38, 135168
    v_lshlrev_b32 v4, 6, v2
    v_lshl_add_u32 v4, v3, 1, v4
    v_add_u32 v31, s38, v4
    v_mfma_f32_16x16x32_bf16 v[96:99], a[60:63], v[92:95], v[96:99]
    v_mfma_f32_16x16x32_bf16 v[112:115], a[64:67], v[80:83], 0
    s_waitcnt vmcnt(5)
    buffer_load_dwordx4 v[136:139], v76, s[52:55], s85 offen offset:1024 nt
    v_mfma_f32_16x16x32_bf16 v[112:115], a[68:71], v[84:87], v[112:115]
    v_mfma_f32_16x16x32_bf16 v[112:115], a[72:75], v[88:91], v[112:115]
    s_nop 2
    v_mov_b32_dpp v122, v96 quad_perm:[0,0,0,0] row_mask:0xf bank_mask:0xf
    v_mov_b32_dpp v124, v98 quad_perm:[2,2,2,2] row_mask:0xf bank_mask:0xf
    s_nop 0
    v_add_f32_dpp v122, v97, v122 quad_perm:[1,1,1,1] row_mask:0xf bank_mask:0xf
    v_add_f32_dpp v124, v99, v124 quad_perm:[3,3,3,3] row_mask:0xf bank_mask:0xf
    v_add_f32 v122, v122, v124
    v_max_f32 v65, v65, v122
    ds_write_b32 v64, v122 offset:2816
    v_mfma_f32_16x16x32_bf16 v[112:115], a[76:79], v[92:95], v[112:115]
    v_mfma_f32_16x16x32_bf16 v[96:99], a[80:83], v[80:83], 0
    v_lshlrev_b32 v4, 11, v2
    v_bfe_u32 v5, v1, 2, 2
    v_lshl_add_u32 v4, v5, 8, v4
    v_bfe_u32 v5, v1, 2, 2
    v_lshl_add_u32 v4, v5, 6, v4
    v_bfe_u32 v5, v1, 4, 1
    v_lshl_add_u32 v4, v5, 5, v4
    v_bfe_u32 v5, v1, 1, 1
    v_lshl_add_u32 v4, v5, 4, v4
    v_bfe_u32 v5, v1, 0, 1
    v_lshl_add_u32 v4, v5, 3, v4
    s_lshl_b32 s38, s34, 6
    s_add_u32 s38, s38, 98304
    v_xor_b32 v24, s38, v4
    v_xor_b32 v25, 16, v24
    v_xor_b32 v26, 32, v24
    v_xor_b32 v27, 48, v24
    v_and_b32 v4, 3, v3
    v_lshrrev_b32 v5, 2, v3
    v_lshlrev_b32 v6, 4, v2
    v_add_u32 v6, 135168, v6
    s_movk_i32 s36, 320
    v_cmp_eq_u32 vcc, 0, v5
    s_nop 1
    v_cndmask_b32 v28, 4, v4, vcc
    v_mad_u32_u24 v28, v28, s36, v6
    v_cmp_eq_u32 vcc, 1, v5
    s_nop 1
    v_cndmask_b32 v29, 4, v4, vcc
    v_mad_u32_u24 v29, v29, s36, v6
    v_lshlrev_b32 v5, 2, v1
    v_add_u32 v5, 136448, v5
    v_mov_b32 v6, 0
    ds_write_b32 v5, v6
    s_waitcnt vmcnt(5)
    buffer_load_dwordx4 v[140:143], v77, s[52:55], s85 offen offset:1024 nt
    s_add_u32 s87, s87, 7
    s_add_u32 s39, s87, s88
    s_bfe_u32 s37, s39, 0x30000
    s_lshl_b32 s37, s37, 12
    s_add_u32 s85, s37, s89
    s_bfe_u32 s37, s39, 0x10003
    s_lshl_b32 s37, s37, 11
    s_add_u32 s85, s37, s85
    s_bfe_u32 s37, s39, 0x40004
    s_lshl_b32 s37, s37, 16
    s_add_u32 s85, s37, s85
    v_mfma_f32_16x16x32_bf16 v[96:99], a[84:87], v[84:87], v[96:99]
    v_mfma_f32_16x16x32_bf16 v[96:99], a[88:91], v[88:91], v[96:99]
    v_mov_b32_dpp v122, v112 quad_perm:[0,0,0,0] row_mask:0xf bank_mask:0xf
    v_mov_b32_dpp v124, v114 quad_perm:[2,2,2,2] row_mask:0xf bank_mask:0xf
    s_nop 0
    v_add_f32_dpp v122, v113, v122 quad_perm:[1,1,1,1] row_mask:0xf bank_mask:0xf
    v_add_f32_dpp v124, v115, v124 quad_perm:[3,3,3,3] row_mask:0xf bank_mask:0xf
    v_add_f32 v122, v122, v124
    v_max_f32 v65, v65, v122
    ds_write_b32 v64, v122 offset:3072
    v_mfma_f32_16x16x32_bf16 v[96:99], a[92:95], v[92:95], v[96:99]
    s_waitcnt vmcnt(5)
    buffer_load_dwordx4 v[144:147], v76, s[52:55], s85 offen offset:0 nt
    v_mfma_f32_16x16x32_bf16 v[112:115], a[96:99], v[80:83], 0
    v_mfma_f32_16x16x32_bf16 v[112:115], a[100:103], v[84:87], v[112:115]
    v_mfma_f32_16x16x32_bf16 v[112:115], a[104:107], v[88:91], v[112:115]
    s_nop 2
    v_mov_b32_dpp v122, v96 quad_perm:[0,0,0,0] row_mask:0xf bank_mask:0xf
    v_mov_b32_dpp v124, v98 quad_perm:[2,2,2,2] row_mask:0xf bank_mask:0xf
    s_nop 0
    v_add_f32_dpp v122, v97, v122 quad_perm:[1,1,1,1] row_mask:0xf bank_mask:0xf
    v_add_f32_dpp v124, v99, v124 quad_perm:[3,3,3,3] row_mask:0xf bank_mask:0xf
    v_add_f32 v122, v122, v124
    v_max_f32 v65, v65, v122
    ds_write_b32 v64, v122 offset:3328
    v_lshlrev_b32 v30, 4, v3
    v_lshl_add_u32 v30, v2, 13, v30
    v_lshrrev_b32 v5, 2, v1
    v_lshlrev_b32 v32, 8, v5
    v_bfe_u32 v5, v1, 0, 2
    v_lshl_add_u32 v32, v5, 4, v32
    s_xor_b32 s37, s90, 4
    s_bfe_u32 s38, s37, 0x30000
    s_lshl_b32 s38, s38, 8
    s_add_u32 s36, s38, 0
    s_lshr_b32 s38, s32, 4
    s_lshl_b32 s38, s38, 7
    s_add_u32 s36, s38, s36
    s_bfe_u32 s38, s32, 0x20000
    s_lshl_b32 s38, s38, 5
    s_add_u32 s36, s38, s36
    s_bfe_u32 s38, s32, 0x20002
    s_lshl_b32 s38, s38, 3
    s_add_u32 s36, s38, s36
    v_bfe_u32 v5, v1, 0, 2
    v_lshlrev_b32 v33, 11, v5
    v_lshl_add_u32 v33, v2, 1, v33
    v_add_u32 v33, s36, v33
    v_and_b32 v5, 31, v1
    v_lshlrev_b32 v34, 4, v5
    s_mul_i32 s38, s34, 320
    s_add_u32 s38, s38, 135168
    v_lshl_add_u32 v35, v5, 3, s38
    s_bfe_u32 s38, s34, 0x10000
    s_lshl_b32 s38, s38, 12
    s_add_u32 s36, s38, s71
    s_lshr_b32 s38, s34, 1
    s_lshl_b32 s38, s38, 24
    s_add_u32 s36, s38, s36
    s_bitcmp1_b32 s90, 2
    s_cselect_b32 s46, s46, s36
    s_cselect_b64 vcc, -1, 0
    v_cndmask_b32 v54, v32, v34, vcc
    v_mfma_f32_16x16x32_bf16 v[112:115], a[108:111], v[92:95], v[112:115]
    s_waitcnt vmcnt(5)
    buffer_load_dwordx4 v[148:151], v77, s[52:55], s85 offen offset:0 nt
    v_mfma_f32_16x16x32_bf16 v[96:99], a[112:115], v[80:83], 0
    v_mfma_f32_16x16x32_bf16 v[96:99], a[116:119], v[84:87], v[96:99]
    v_mfma_f32_16x16x32_bf16 v[96:99], a[120:123], v[88:91], v[96:99]
    s_nop 2
    v_mov_b32_dpp v122, v112 quad_perm:[0,0,0,0] row_mask:0xf bank_mask:0xf
    v_mov_b32_dpp v124, v114 quad_perm:[2,2,2,2] row_mask:0xf bank_mask:0xf
    s_nop 0
    v_add_f32_dpp v122, v113, v122 quad_perm:[1,1,1,1] row_mask:0xf bank_mask:0xf
    v_add_f32_dpp v124, v115, v124 quad_perm:[3,3,3,3] row_mask:0xf bank_mask:0xf
    v_add_f32 v122, v122, v124
    v_max_f32 v65, v65, v122
    ds_write_b32 v64, v122 offset:3584
    v_mfma_f32_16x16x32_bf16 v[96:99], a[124:127], v[92:95], v[96:99]
    v_add_u32 v64, 3840, v64
    s_mov_b32 s97, 8
    s_mov_b32 s92, 7
    s_lshl_b32 s38, s32, 13
    s_add_u32 s80, s38, 3145728
    s_lshl_b32 s38, s3, 11
    s_add_u32 s80, s38, s80
    v_lshrrev_b32 v4, 2, v1
    v_lshlrev_b32 v55, 3, v4
    s_mov_b32 s66, 134217728
    s_mov_b32 s67, 0x20000
    s_mov_b64 s[64:65], s[52:53]
    v_mov_b32 v62, v76
    v_mov_b32 v63, v77
    s_branch L_bloop
L_ql:
    v_lshrrev_b32 v4, 2, v3
    v_and_b32 v5, 3, v3
    v_lshlrev_b32 v19, 6, v2
    v_lshl_add_u32 v19, v5, 4, v19
    v_lshl_add_u32 v14, v4, 18, v19
    s_and_b32 s61, s32, 28
    s_add_u32 s61, s61, s34
    s_and_b32 s60, s32, 3
    s_lshl_b32 s38, s60, 20
    s_add_u32 s63, s38, 0
    s_lshl_b32 s38, s61, 8
    s_add_u32 s63, s38, s63
    s_mov_b32 s74, 4194304
    s_mov_b32 s75, 0x20000
    s_waitcnt lgkmcnt(0)
    s_mov_b64 s[72:73], s[10:11]
    buffer_load_dwordx4 a[128:131], v14, s[72:75], s63 offen nt
    s_add_u32 s63, s63, 8192
    buffer_load_dwordx4 a[132:135], v14, s[72:75], s63 offen nt
    s_add_u32 s63, s63, 8192
    buffer_load_dwordx4 a[136:139], v14, s[72:75], s63 offen nt
    s_add_u32 s63, s63, 8192
    buffer_load_dwordx4 a[140:143], v14, s[72:75], s63 offen nt
    s_add_u32 s63, s63, 8192
    buffer_load_dwordx4 a[144:147], v14, s[72:75], s63 offen nt
    s_add_u32 s63, s63, 8192
    buffer_load_dwordx4 a[148:151], v14, s[72:75], s63 offen nt
    s_add_u32 s63, s63, 8192
    buffer_load_dwordx4 a[152:155], v14, s[72:75], s63 offen nt
    s_add_u32 s63, s63, 8192
    buffer_load_dwordx4 a[156:159], v14, s[72:75], s63 offen nt
    s_add_u32 s63, s63, 8192
    v_lshlrev_b32 v15, 1, v19
    v_lshl_add_u32 v15, v4, 9, v15
    v_lshl_add_u32 v19, v4, 15, v19
    s_load_dword s35, s[30:31], 0
    s_mov_b32 s48, s30
    s_and_b32 s49, s31, 0xffff
    s_mov_b32 s50, 8388608
    s_mov_b32 s51, 0x20000
    s_mov_b32 s82, 0xffffff00
    s_mov_b32 s83, 0x3e0293ee
    s_mov_b32 s84, 2097152
    s_lshl_b32 s38, s61, 12
    s_add_u32 s95, s38, 264192
    s_lshl_b32 s38, s61, 10
    s_add_u32 s94, s38, 393216
    s_lshl_b32 s38, s60, 8
    s_add_u32 s94, s38, s94
    buffer_load_dwordx4 a[160:163], v14, s[72:75], s63 offen nt
    s_add_u32 s63, s63, 8192
    buffer_load_dwordx4 a[164:167], v14, s[72:75], s63 offen nt
    s_add_u32 s63, s63, 8192
    buffer_load_dwordx4 a[168:171], v14, s[72:75], s63 offen nt
    s_add_u32 s63, s63, 8192
    buffer_load_dwordx4 a[172:175], v14, s[72:75], s63 offen nt
    s_add_u32 s63, s63, 8192
    s_waitcnt vmcnt(11)
    buffer_load_dwordx4 a[176:179], v14, s[72:75], s63 offen nt
    s_add_u32 s63, s63, 8192
    v_and_b32 v4, 1, v1
    v_lshlrev_b32 v4, 4, v4
    v_mov_b32 v5, 0xffff
    v_lshlrev_b32 v4, v4, v5
    v_bfe_u32 v5, v1, 1, 2
    v_cmp_eq_u32 vcc, 0, v5
    s_nop 1
    v_cndmask_b32 v10, 0, v4, vcc
    v_cmp_eq_u32 vcc, 1, v5
    s_nop 1
    v_cndmask_b32 v11, 0, v4, vcc
    v_cmp_eq_u32 vcc, 2, v5
    s_nop 1
    v_cndmask_b32 v12, 0, v4, vcc
    v_cmp_eq_u32 vcc, 3, v5
    s_nop 1
    v_cndmask_b32 v13, 0, v4, vcc
    s_waitcnt vmcnt(11)
    buffer_load_dwordx4 a[180:183], v14, s[72:75], s63 offen nt
    s_add_u32 s63, s63, 8192
    s_waitcnt vmcnt(11)
    buffer_load_dwordx4 a[184:187], v14, s[72:75], s63 offen nt
    s_add_u32 s63, s63, 8192
    s_waitcnt vmcnt(11)
    buffer_load_dwordx4 a[188:191], v14, s[72:75], s63 offen nt
    s_add_u32 s63, s63, 8192
    s_waitcnt vmcnt(11)
    buffer_load_dwordx4 a[192:195], v14, s[72:75], s63 offen nt
    s_add_u32 s63, s63, 8192
    v_lshrrev_b32 v4, 2, v3
    v_and_b32 v5, 3, v3
    v_lshlrev_b32 v76, 8, v4
    v_lshlrev_b32 v126, 8, v2
    v_lshl_add_u32 v76, v2, 6, v76
    v_lshl_add_u32 v76, v5, 4, v76
    v_lshl_add_u32 v126, v3, 4, v126
    v_xor_b32 v77, 32768, v76
    v_xor_b32 v127, 32768, v126
    s_add_u32 s3, s34, s33
    s_and_b32 s3, s3, 3
    s_lshl_b32 s89, s3, 5
    s_add_u32 s89, s89, s32
    s_lshl_b32 s89, s89, 20
    s_mul_i32 s88, s32, 8
    s_add_u32 s88, s88, s3
    s_lshl_b32 s87, s33, 0
    s_waitcnt vmcnt(11)
    buffer_load_dwordx4 a[196:199], v14, s[72:75], s63 offen nt
    s_add_u32 s63, s63, 8192
    s_waitcnt vmcnt(11)
    buffer_load_dwordx4 a[200:203], v14, s[72:75], s63 offen nt
    s_add_u32 s63, s63, 8192
    s_waitcnt vmcnt(11)
    buffer_load_dwordx4 a[204:207], v14, s[72:75], s63 offen nt
    s_add_u32 s63, s63, 8192
    s_waitcnt vmcnt(11)
    buffer_load_dwordx4 a[208:211], v14, s[72:75], s63 offen nt
    s_add_u32 s63, s63, 8192
    s_mov_b32 s52, s18
    s_and_b32 s53, s19, 0xffff
    s_mov_b32 s54, 134217728
    s_mov_b32 s55, 0x20000
    s_mov_b32 s56, s20
    s_and_b32 s57, s21, 0xffff
    s_mov_b32 s58, 134217728
    s_mov_b32 s59, 0x20000
    s_waitcnt vmcnt(11)
    buffer_load_dwordx4 a[212:215], v14, s[72:75], s63 offen nt
    s_add_u32 s63, s63, 8192
    s_waitcnt vmcnt(11)
    buffer_load_dwordx4 a[216:219], v14, s[72:75], s63 offen nt
    s_add_u32 s63, s63, 8192
    s_waitcnt vmcnt(11)
    buffer_load_dwordx4 a[220:223], v14, s[72:75], s63 offen nt
    s_add_u32 s63, s63, 8192
    s_waitcnt vmcnt(11)
    buffer_load_dwordx4 a[224:227], v14, s[72:75], s63 offen nt
    s_add_u32 s63, s63, 8192
    v_mov_b32 v120, 0xff7f0000
    v_mov_b32 v121, 0
    v_mov_b32 v18, 1
    v_mov_b32 v116, 0
    v_mov_b32 v117, 0
    v_mov_b32 v118, 0
    v_mov_b32 v119, 0
    v_lshlrev_b32 v0, 3, v1
    ds_write_b64 v0, v[116:117] offset:8192
    v_mov_b32 v0, 8192
    s_lshl_b32 s38, s32, 10
    s_add_u32 s96, s38, 65536
    s_lshr_b32 s38, s32, 3
    s_lshl_b32 s38, s38, 8
    s_add_u32 s96, s38, s96
    v_mov_b32 v9, s96
    s_lshl_b32 s38, s32, 15
    s_add_u32 s96, s38, 1048576
    s_lshl_b32 s38, s3, 13
    s_add_u32 s96, s38, s96
    s_lshl_b32 s38, s33, 10
    s_add_u32 s96, s38, s96
    v_and_b32 v5, 3, v3
    v_lshlrev_b32 v78, 7, v2
    v_lshl_add_u32 v78, v5, 5, v78
    s_lshl_b32 s38, s32, 12
    s_add_u32 s91, s38, 262144
    s_lshl_b32 s38, s3, 9
    s_add_u32 s91, s38, s91
    v_lshlrev_b32 v4, 7, v2
    v_lshl_add_u32 v4, v3, 4, v4
    v_mov_b32 v5, 512
    v_cmp_gt_u32 vcc, 8, v3
    s_nop 1
    v_cndmask_b32 v79, v5, v4, vcc
    s_waitcnt vmcnt(11)
    buffer_load_dwordx4 a[228:231], v14, s[72:75], s63 offen nt
    s_add_u32 s63, s63, 8192
    s_waitcnt vmcnt(11)
    buffer_load_dwordx4 a[232:235], v14, s[72:75], s63 offen nt
    s_add_u32 s63, s63, 8192
    s_waitcnt vmcnt(11)
    buffer_load_dwordx4 a[236:239], v14, s[72:75], s63 offen nt
    s_add_u32 s63, s63, 8192
    s_waitcnt vmcnt(11)
    buffer_load_dwordx4 a[240:243], v14, s[72:75], s63 offen nt
    s_add_u32 s63, s63, 8192
    s_waitcnt vmcnt(11)
    buffer_load_dwordx4 a[244:247], v14, s[72:75], s63 offen nt
    s_add_u32 s63, s63, 8192
    s_waitcnt vmcnt(11)
    buffer_load_dwordx4 a[248:251], v14, s[72:75], s63 offen nt
    s_add_u32 s63, s63, 8192
    s_waitcnt vmcnt(11)
    buffer_load_dwordx4 a[252:255], v14, s[72:75], s63 offen nt
    s_add_u32 s63, s63, 8192
    s_waitcnt lgkmcnt(0)
    s_add_u32 s35, s35, 0x5b
    s_and_b32 s35, s35, 0xff
    v_mov_b32 v8, s35
    s_or_b32 s68, s35, 0x6b3ac500
    s_waitcnt vmcnt(6)
    s_add_u32 s39, s87, s88
    s_bfe_u32 s37, s39, 0x30000
    s_lshl_b32 s37, s37, 12
    s_add_u32 s85, s37, s89
    s_bfe_u32 s37, s39, 0x10003
    s_lshl_b32 s37, s37, 11
    s_add_u32 s85, s37, s85
    s_bfe_u32 s37, s39, 0x40004
    s_lshl_b32 s37, s37, 16
    s_add_u32 s85, s37, s85
    buffer_load_dwordx4 v[128:131], v76, s[52:55], s85 offen offset:0 nt
    s_waitcnt vmcnt(6)
    buffer_load_dwordx4 v[132:135], v77, s[52:55], s85 offen offset:0 nt
    s_waitcnt vmcnt(6)
    buffer_load_dwordx4 v[136:139], v76, s[52:55], s85 offen offset:1024 nt
    s_waitcnt vmcnt(6)
    buffer_load_dwordx4 v[140:143], v77, s[52:55], s85 offen offset:1024 nt
    s_add_u32 s87, s87, 7
    s_add_u32 s39, s87, s88
    s_bfe_u32 s37, s39, 0x30000
    s_lshl_b32 s37, s37, 12
    s_add_u32 s85, s37, s89
    s_bfe_u32 s37, s39, 0x10003
    s_lshl_b32 s37, s37, 11
    s_add_u32 s85, s37, s85
    s_bfe_u32 s37, s39, 0x40004
    s_lshl_b32 s37, s37, 16
    s_add_u32 s85, s37, s85
    s_waitcnt vmcnt(6)
    buffer_load_dwordx4 v[144:147], v76, s[52:55], s85 offen offset:0 nt
    s_waitcnt vmcnt(6)
    buffer_load_dwordx4 v[148:151], v77, s[52:55], s85 offen offset:0 nt
    s_waitcnt vmcnt(6)
    buffer_load_dwordx4 v[152:155], v76, s[52:55], s85 offen offset:1024 nt
    s_waitcnt vmcnt(6)
    buffer_load_dwordx4 v[156:159], v77, s[52:55], s85 offen offset:1024 nt
    s_add_u32 s87, s87, 7
    s_add_u32 s39, s87, s88
    s_bfe_u32 s37, s39, 0x30000
    s_lshl_b32 s37, s37, 12
    s_add_u32 s85, s37, s89
    s_bfe_u32 s37, s39, 0x10003
    s_lshl_b32 s37, s37, 11
    s_add_u32 s85, s37, s85
    s_bfe_u32 s37, s39, 0x40004
    s_lshl_b32 s37, s37, 16
    s_add_u32 s85, s37, s85
    s_waitcnt vmcnt(6)
    buffer_load_dwordx4 v[160:163], v76, s[52:55], s85 offen offset:0 nt
    s_waitcnt vmcnt(6)
    buffer_load_dwordx4 v[164:167], v77, s[52:55], s85 offen offset:0 nt
    s_waitcnt vmcnt(6)
    buffer_load_dwordx4 v[168:171], v76, s[52:55], s85 offen offset:1024 nt
    s_waitcnt vmcnt(6)
    buffer_load_dwordx4 v[172:175], v77, s[52:55], s85 offen offset:1024 nt
    s_add_u32 s87, s87, 7
    s_add_u32 s39, s87, s88
    s_bfe_u32 s37, s39, 0x30000
    s_lshl_b32 s37, s37, 12
    s_add_u32 s85, s37, s89
    s_bfe_u32 s37, s39, 0x10003
    s_lshl_b32 s37, s37, 11
    s_add_u32 s85, s37, s85
    s_bfe_u32 s37, s39, 0x40004
    s_lshl_b32 s37, s37, 16
    s_add_u32 s85, s37, s85
    s_waitcnt vmcnt(6)
    buffer_load_dwordx4 v[176:179], v76, s[52:55], s85 offen offset:0 nt
    s_waitcnt vmcnt(6)
    buffer_load_dwordx4 v[180:183], v77, s[52:55], s85 offen offset:0 nt
    s_waitcnt vmcnt(6)
    buffer_load_dwordx4 v[184:187], v76, s[52:55], s85 offen offset:1024 nt
    s_waitcnt vmcnt(6)
    buffer_load_dwordx4 v[188:191], v77, s[52:55], s85 offen offset:1024 nt
    s_add_u32 s87, s87, 7
    s_add_u32 s39, s87, s88
    s_bfe_u32 s37, s39, 0x30000
    s_lshl_b32 s37, s37, 12
    s_add_u32 s85, s37, s89
    s_bfe_u32 s37, s39, 0x10003
    s_lshl_b32 s37, s37, 11
    s_add_u32 s85, s37, s85
    s_bfe_u32 s37, s39, 0x40004
    s_lshl_b32 s37, s37, 16
    s_add_u32 s85, s37, s85
    s_waitcnt vmcnt(6)
    buffer_load_dwordx4 v[192:195], v76, s[52:55], s85 offen offset:0 nt
    s_waitcnt vmcnt(6)
    buffer_load_dwordx4 v[196:199], v77, s[52:55], s85 offen offset:0 nt
    s_waitcnt vmcnt(6)
    buffer_load_dwordx4 v[200:203], v76, s[52:55], s85 offen offset:1024 nt
    s_waitcnt vmcnt(6)
    buffer_load_dwordx4 v[204:207], v77, s[52:55], s85 offen offset:1024 nt
    s_add_u32 s87, s87, 7
    s_add_u32 s39, s87, s88
    s_bfe_u32 s37, s39, 0x30000
    s_lshl_b32 s37, s37, 12
    s_add_u32 s85, s37, s89
    s_bfe_u32 s37, s39, 0x10003
    s_lshl_b32 s37, s37, 11
    s_add_u32 s85, s37, s85
    s_bfe_u32 s37, s39, 0x40004
    s_lshl_b32 s37, s37, 16
    s_add_u32 s85, s37, s85
    s_waitcnt vmcnt(6)
    buffer_load_dwordx4 v[208:211], v76, s[52:55], s85 offen offset:0 nt
    s_waitcnt vmcnt(6)
    buffer_load_dwordx4 v[212:215], v77, s[52:55], s85 offen offset:0 nt
    s_waitcnt vmcnt(6)
    buffer_load_dwordx4 v[216:219], v76, s[52:55], s85 offen offset:1024 nt
    s_waitcnt vmcnt(6)
    buffer_load_dwordx4 v[220:223], v77, s[52:55], s85 offen offset:1024 nt
    s_add_u32 s87, s87, 7
    s_add_u32 s39, s87, s88
    s_bfe_u32 s37, s39, 0x30000
    s_lshl_b32 s37, s37, 12
    s_add_u32 s85, s37, s89
    s_bfe_u32 s37, s39, 0x10003
    s_lshl_b32 s37, s37, 11
    s_add_u32 s85, s37, s85
    s_bfe_u32 s37, s39, 0x40004
    s_lshl_b32 s37, s37, 16
    s_add_u32 s85, s37, s85
    s_waitcnt vmcnt(6)
    buffer_load_dwordx4 v[224:227], v76, s[52:55], s85 offen offset:0 nt
    s_waitcnt vmcnt(6)
    buffer_load_dwordx4 v[228:231], v77, s[52:55], s85 offen offset:0 nt
    s_waitcnt vmcnt(6)
    buffer_load_dwordx4 v[232:235], v76, s[52:55], s85 offen offset:1024 nt
    s_waitcnt vmcnt(6)
    buffer_load_dwordx4 v[236:239], v77, s[52:55], s85 offen offset:1024 nt
    s_add_u32 s87, s87, 7
    s_add_u32 s39, s87, s88
    s_bfe_u32 s37, s39, 0x30000
    s_lshl_b32 s37, s37, 12
    s_add_u32 s85, s37, s89
    s_bfe_u32 s37, s39, 0x10003
    s_lshl_b32 s37, s37, 11
    s_add_u32 s85, s37, s85
    s_bfe_u32 s37, s39, 0x40004
    s_lshl_b32 s37, s37, 16
    s_add_u32 s85, s37, s85
    s_waitcnt vmcnt(6)
    buffer_load_dwordx4 v[240:243], v76, s[52:55], s85 offen offset:0 nt
    s_waitcnt vmcnt(6)
    buffer_load_dwordx4 v[244:247], v77, s[52:55], s85 offen offset:0 nt
    buffer_load_dwordx4 v[20:23], v15, s[48:51], s95 offen offset:0 sc1
    buffer_load_dwordx4 v[24:27], v15, s[48:51], s95 offen offset:16 sc1
    s_waitcnt vmcnt(8)
    buffer_load_dwordx4 v[248:251], v76, s[52:55], s85 offen offset:1024 nt
    s_waitcnt vmcnt(8)
    buffer_load_dwordx4 v[252:255], v77, s[52:55], s85 offen offset:1024 nt
    s_add_u32 s87, s87, 7
    s_add_u32 s39, s87, s88
    s_bfe_u32 s37, s39, 0x30000
    s_lshl_b32 s37, s37, 12
    s_add_u32 s85, s37, s89
    s_bfe_u32 s37, s39, 0x10003
    s_lshl_b32 s37, s37, 11
    s_add_u32 s85, s37, s85
    s_bfe_u32 s37, s39, 0x40004
    s_lshl_b32 s37, s37, 16
    s_add_u32 s85, s37, s85
    s_waitcnt vmcnt(8)
    buffer_load_dwordx4 a[0:3], v76, s[52:55], s85 offen offset:0 nt
    s_waitcnt vmcnt(8)
    buffer_load_dwordx4 a[4:7], v77, s[52:55], s85 offen offset:0 nt
    s_waitcnt vmcnt(8)
    buffer_load_dwordx4 a[8:11], v76, s[52:55], s85 offen offset:1024 nt
    s_waitcnt vmcnt(8)
    buffer_load_dwordx4 a[12:15], v77, s[52:55], s85 offen offset:1024 nt
    s_add_u32 s87, s87, 7
    s_add_u32 s39, s87, s88
    s_bfe_u32 s37, s39, 0x30000
    s_lshl_b32 s37, s37, 12
    s_add_u32 s85, s37, s89
    s_bfe_u32 s37, s39, 0x10003
    s_lshl_b32 s37, s37, 11
    s_add_u32 s85, s37, s85
    s_bfe_u32 s37, s39, 0x40004
    s_lshl_b32 s37, s37, 16
    s_add_u32 s85, s37, s85
    s_waitcnt vmcnt(6)
L_qacheck_41:
    v_xor_b32 v20, s35, v20
    v_xor_b32 v21, s35, v21
    v_xor_b32 v22, s35, v22
    v_xor_b32 v23, s35, v23
    v_xor_b32 v24, s35, v24
    v_xor_b32 v25, s35, v25
    v_xor_b32 v26, s35, v26
    v_xor_b32 v27, s35, v27
    v_or_b32 v4, v20, v21
    v_or3_b32 v4, v4, v22, v23
    v_or3_b32 v4, v4, v24, v25
    v_or3_b32 v4, v4, v26, v27
    v_and_b32 v4, 0xff, v4
    v_cmp_ne_u32 vcc, 0, v4
    s_cbranch_vccz L_qaok_42
    buffer_load_dwordx4 v[20:23], v15, s[48:51], s95 offen offset:0 sc1
    buffer_load_dwordx4 v[24:27], v15, s[48:51], s95 offen offset:16 sc1
    s_waitcnt vmcnt(0)
    s_sub_u32 s84, s84, 1
    s_cmp_lg_u32 s84, 0
    s_cbranch_scc1 L_qacheck_41
    s_branch L_end
L_qaok_42:
    buffer_load_dwordx4 v[68:71], v78, s[48:51], s91 offen offset:0 sc1
    buffer_load_dwordx4 v[72:75], v78, s[48:51], s91 offen offset:16 sc1
    v_cvt_pk_bf16_f32 v20, v20, v21
    v_cvt_pk_bf16_f32 v21, v22, v23
    v_cvt_pk_bf16_f32 v22, v24, v25
    v_cvt_pk_bf16_f32 v23, v26, v27
    s_nop 1
    v_mfma_f32_16x16x32_bf16 v[28:31], a[128:131], v[20:23], 0
    v_mfma_f32_16x16x32_bf16 v[32:35], a[132:135], v[20:23], 0
    v_mfma_f32_16x16x32_bf16 v[36:39], a[136:139], v[20:23], 0
    s_nop 5
    v_mov_b32_dpp v60, v28 quad_perm:[0,0,0,0] row_mask:0xf bank_mask:0xf
    v_mov_b32_dpp v4, v30 quad_perm:[2,2,2,2] row_mask:0xf bank_mask:0xf
    s_nop 0
    v_add_f32_dpp v60, v29, v60 quad_perm:[1,1,1,1] row_mask:0xf bank_mask:0xf
    v_add_f32_dpp v4, v31, v4 quad_perm:[3,3,3,3] row_mask:0xf bank_mask:0xf
    v_add_f32 v60, v60, v4
    v_mfma_f32_16x16x32_bf16 v[40:43], a[140:143], v[20:23], 0
    v_mov_b32_dpp v61, v32 quad_perm:[0,0,0,0] row_mask:0xf bank_mask:0xf
    v_mov_b32_dpp v4, v34 quad_perm:[2,2,2,2] row_mask:0xf bank_mask:0xf
    s_nop 0
    v_add_f32_dpp v61, v33, v61 quad_perm:[1,1,1,1] row_mask:0xf bank_mask:0xf
    v_add_f32_dpp v4, v35, v4 quad_perm:[3,3,3,3] row_mask:0xf bank_mask:0xf
    v_add_f32 v61, v61, v4
    v_cvt_pk_bf16_f32 v44, v60, v61
    v_mfma_f32_16x16x32_bf16 v[28:31], a[144:147], v[20:23], 0
    v_mov_b32_dpp v60, v36 quad_perm:[0,0,0,0] row_mask:0xf bank_mask:0xf
    v_mov_b32_dpp v4, v38 quad_perm:[2,2,2,2] row_mask:0xf bank_mask:0xf
    s_nop 0
    v_add_f32_dpp v60, v37, v60 quad_perm:[1,1,1,1] row_mask:0xf bank_mask:0xf
    v_add_f32_dpp v4, v39, v4 quad_perm:[3,3,3,3] row_mask:0xf bank_mask:0xf
    v_add_f32 v60, v60, v4
    buffer_load_dwordx4 a[16:19], v76, s[52:55], s85 offen offset:0 nt
    v_mfma_f32_16x16x32_bf16 v[32:35], a[148:151], v[20:23], 0
    v_mov_b32_dpp v61, v40 quad_perm:[0,0,0,0] row_mask:0xf bank_mask:0xf
    v_mov_b32_dpp v4, v42 quad_perm:[2,2,2,2] row_mask:0xf bank_mask:0xf
    s_nop 0
    v_add_f32_dpp v61, v41, v61 quad_perm:[1,1,1,1] row_mask:0xf bank_mask:0xf
    v_add_f32_dpp v4, v43, v4 quad_perm:[3,3,3,3] row_mask:0xf bank_mask:0xf
    v_add_f32 v61, v61, v4
    v_cvt_pk_bf16_f32 v45, v60, v61
    v_mfma_f32_16x16x32_bf16 v[36:39], a[152:155], v[20:23], 0
    v_mov_b32_dpp v60, v28 quad_perm:[0,0,0,0] row_mask:0xf bank_mask:0xf
    v_mov_b32_dpp v4, v30 quad_perm:[2,2,2,2] row_mask:0xf bank_mask:0xf
    s_nop 0
    v_add_f32_dpp v60, v29, v60 quad_perm:[1,1,1,1] row_mask:0xf bank_mask:0xf
    v_add_f32_dpp v4, v31, v4 quad_perm:[3,3,3,3] row_mask:0xf bank_mask:0xf
    v_add_f32 v60, v60, v4
    v_mfma_f32_16x16x32_bf16 v[40:43], a[156:159], v[20:23], 0
    v_mov_b32_dpp v61, v32 quad_perm:[0,0,0,0] row_mask:0xf bank_mask:0xf
    v_mov_b32_dpp v4, v34 quad_perm:[2,2,2,2] row_mask:0xf bank_mask:0xf
    s_nop 0
    v_add_f32_dpp v61, v33, v61 quad_perm:[1,1,1,1] row_mask:0xf bank_mask:0xf
    v_add_f32_dpp v4, v35, v4 quad_perm:[3,3,3,3] row_mask:0xf bank_mask:0xf
    v_add_f32 v61, v61, v4
    v_cvt_pk_bf16_f32 v46, v60, v61
    v_mfma_f32_16x16x32_bf16 v[28:31], a[160:163], v[20:23], 0
    v_mov_b32_dpp v60, v36 quad_perm:[0,0,0,0] row_mask:0xf bank_mask:0xf
    v_mov_b32_dpp v4, v38 quad_perm:[2,2,2,2] row_mask:0xf bank_mask:0xf
    s_nop 0
    v_add_f32_dpp v60, v37, v60 quad_perm:[1,1,1,1] row_mask:0xf bank_mask:0xf
    v_add_f32_dpp v4, v39, v4 quad_perm:[3,3,3,3] row_mask:0xf bank_mask:0xf
    v_add_f32 v60, v60, v4
    v_mfma_f32_16x16x32_bf16 v[32:35], a[164:167], v[20:23], 0
    v_mov_b32_dpp v61, v40 quad_perm:[0,0,0,0] row_mask:0xf bank_mask:0xf
    v_mov_b32_dpp v4, v42 quad_perm:[2,2,2,2] row_mask:0xf bank_mask:0xf
    s_nop 0
    v_add_f32_dpp v61, v41, v61 quad_perm:[1,1,1,1] row_mask:0xf bank_mask:0xf
    v_add_f32_dpp v4, v43, v4 quad_perm:[3,3,3,3] row_mask:0xf bank_mask:0xf
    v_add_f32 v61, v61, v4
    v_cvt_pk_bf16_f32 v47, v60, v61
    v_mfma_f32_16x16x32_bf16 v[36:39], a[168:171], v[20:23], 0
    v_mov_b32_dpp v60, v28 quad_perm:[0,0,0,0] row_mask:0xf bank_mask:0xf
    v_mov_b32_dpp v4, v30 quad_perm:[2,2,2,2] row_mask:0xf bank_mask:0xf
    s_nop 0
    v_add_f32_dpp v60, v29, v60 quad_perm:[1,1,1,1] row_mask:0xf bank_mask:0xf
    v_add_f32_dpp v4, v31, v4 quad_perm:[3,3,3,3] row_mask:0xf bank_mask:0xf
    v_add_f32 v60, v60, v4
    v_mfma_f32_16x16x32_bf16 v[40:43], a[172:175], v[20:23], 0
    v_mov_b32_dpp v61, v32 quad_perm:[0,0,0,0] row_mask:0xf bank_mask:0xf
    v_mov_b32_dpp v4, v34 quad_perm:[2,2,2,2] row_mask:0xf bank_mask:0xf
    s_nop 0
    v_add_f32_dpp v61, v33, v61 quad_perm:[1,1,1,1] row_mask:0xf bank_mask:0xf
    v_add_f32_dpp v4, v35, v4 quad_perm:[3,3,3,3] row_mask:0xf bank_mask:0xf
    v_add_f32 v61, v61, v4
    v_cvt_pk_bf16_f32 v48, v60, v61
    v_mfma_f32_16x16x32_bf16 v[28:31], a[176:179], v[20:23], 0
    v_mov_b32_dpp v60, v36 quad_perm:[0,0,0,0] row_mask:0xf bank_mask:0xf
    v_mov_b32_dpp v4, v38 quad_perm:[2,2,2,2] row_mask:0xf bank_mask:0xf
    s_nop 0
    v_add_f32_dpp v60, v37, v60 quad_perm:[1,1,1,1] row_mask:0xf bank_mask:0xf
    v_add_f32_dpp v4, v39, v4 quad_perm:[3,3,3,3] row_mask:0xf bank_mask:0xf
    v_add_f32 v60, v60, v4
    buffer_load_dwordx4 a[20:23], v77, s[52:55], s85 offen offset:0 nt
    v_mfma_f32_16x16x32_bf16 v[32:35], a[180:183], v[20:23], 0
    v_mov_b32_dpp v61, v40 quad_perm:[0,0,0,0] row_mask:0xf bank_mask:0xf
    v_mov_b32_dpp v4, v42 quad_perm:[2,2,2,2] row_mask:0xf bank_mask:0xf
    s_nop 0
    v_add_f32_dpp v61, v41, v61 quad_perm:[1,1,1,1] row_mask:0xf bank_mask:0xf
    v_add_f32_dpp v4, v43, v4 quad_perm:[3,3,3,3] row_mask:0xf bank_mask:0xf
    v_add_f32 v61, v61, v4
    v_cvt_pk_bf16_f32 v49, v60, v61
    v_mfma_f32_16x16x32_bf16 v[36:39], a[184:187], v[20:23], 0
    v_mov_b32_dpp v60, v28 quad_perm:[0,0,0,0] row_mask:0xf bank_mask:0xf
    v_mov_b32_dpp v4, v30 quad_perm:[2,2,2,2] row_mask:0xf bank_mask:0xf
    s_nop 0
    v_add_f32_dpp v60, v29, v60 quad_perm:[1,1,1,1] row_mask:0xf bank_mask:0xf
    v_add_f32_dpp v4, v31, v4 quad_perm:[3,3,3,3] row_mask:0xf bank_mask:0xf
    v_add_f32 v60, v60, v4
    v_mfma_f32_16x16x32_bf16 v[40:43], a[188:191], v[20:23], 0
    v_mov_b32_dpp v61, v32 quad_perm:[0,0,0,0] row_mask:0xf bank_mask:0xf
    v_mov_b32_dpp v4, v34 quad_perm:[2,2,2,2] row_mask:0xf bank_mask:0xf
    s_nop 0
    v_add_f32_dpp v61, v33, v61 quad_perm:[1,1,1,1] row_mask:0xf bank_mask:0xf
    v_add_f32_dpp v4, v35, v4 quad_perm:[3,3,3,3] row_mask:0xf bank_mask:0xf
    v_add_f32 v61, v61, v4
    v_cvt_pk_bf16_f32 v50, v60, v61
    v_mfma_f32_16x16x32_bf16 v[28:31], a[192:195], v[20:23], 0
    v_mov_b32_dpp v60, v36 quad_perm:[0,0,0,0] row_mask:0xf bank_mask:0xf
    v_mov_b32_dpp v4, v38 quad_perm:[2,2,2,2] row_mask:0xf bank_mask:0xf
    s_nop 0
    v_add_f32_dpp v60, v37, v60 quad_perm:[1,1,1,1] row_mask:0xf bank_mask:0xf
    v_add_f32_dpp v4, v39, v4 quad_perm:[3,3,3,3] row_mask:0xf bank_mask:0xf
    v_add_f32 v60, v60, v4
    v_mfma_f32_16x16x32_bf16 v[32:35], a[196:199], v[20:23], 0
    v_mov_b32_dpp v61, v40 quad_perm:[0,0,0,0] row_mask:0xf bank_mask:0xf
    v_mov_b32_dpp v4, v42 quad_perm:[2,2,2,2] row_mask:0xf bank_mask:0xf
    s_nop 0
    v_add_f32_dpp v61, v41, v61 quad_perm:[1,1,1,1] row_mask:0xf bank_mask:0xf
    v_add_f32_dpp v4, v43, v4 quad_perm:[3,3,3,3] row_mask:0xf bank_mask:0xf
    v_add_f32 v61, v61, v4
    v_cvt_pk_bf16_f32 v51, v60, v61
    v_mfma_f32_16x16x32_bf16 v[36:39], a[200:203], v[20:23], 0
    v_mov_b32_dpp v60, v28 quad_perm:[0,0,0,0] row_mask:0xf bank_mask:0xf
    v_mov_b32_dpp v4, v30 quad_perm:[2,2,2,2] row_mask:0xf bank_mask:0xf
    s_nop 0
    v_add_f32_dpp v60, v29, v60 quad_perm:[1,1,1,1] row_mask:0xf bank_mask:0xf
    v_add_f32_dpp v4, v31, v4 quad_perm:[3,3,3,3] row_mask:0xf bank_mask:0xf
    v_add_f32 v60, v60, v4
    v_mfma_f32_16x16x32_bf16 v[40:43], a[204:207], v[20:23], 0
    v_mov_b32_dpp v61, v32 quad_perm:[0,0,0,0] row_mask:0xf bank_mask:0xf
    v_mov_b32_dpp v4, v34 quad_perm:[2,2,2,2] row_mask:0xf bank_mask:0xf
    s_nop 0
    v_add_f32_dpp v61, v33, v61 quad_perm:[1,1,1,1] row_mask:0xf bank_mask:0xf
    v_add_f32_dpp v4, v35, v4 quad_perm:[3,3,3,3] row_mask:0xf bank_mask:0xf
    v_add_f32 v61, v61, v4
    v_cvt_pk_bf16_f32 v52, v60, v61
    v_mfma_f32_16x16x32_bf16 v[28:31], a[208:211], v[20:23], 0
    v_mov_b32_dpp v60, v36 quad_perm:[0,0,0,0] row_mask:0xf bank_mask:0xf
    v_mov_b32_dpp v4, v38 quad_perm:[2,2,2,2] row_mask:0xf bank_mask:0xf
    s_nop 0
    v_add_f32_dpp v60, v37, v60 quad_perm:[1,1,1,1] row_mask:0xf bank_mask:0xf
    v_add_f32_dpp v4, v39, v4 quad_perm:[3,3,3,3] row_mask:0xf bank_mask:0xf
    v_add_f32 v60, v60, v4
    buffer_load_dwordx4 a[24:27], v76, s[52:55], s85 offen offset:1024 nt
    v_mfma_f32_16x16x32_bf16 v[32:35], a[212:215], v[20:23], 0
    v_mov_b32_dpp v61, v40 quad_perm:[0,0,0,0] row_mask:0xf bank_mask:0xf
    v_mov_b32_dpp v4, v42 quad_perm:[2,2,2,2] row_mask:0xf bank_mask:0xf
    s_nop 0
    v_add_f32_dpp v61, v41, v61 quad_perm:[1,1,1,1] row_mask:0xf bank_mask:0xf
    v_add_f32_dpp v4, v43, v4 quad_perm:[3,3,3,3] row_mask:0xf bank_mask:0xf
    v_add_f32 v61, v61, v4
    v_cvt_pk_bf16_f32 v53, v60, v61
    v_mfma_f32_16x16x32_bf16 v[36:39], a[216:219], v[20:23], 0
    v_mov_b32_dpp v60, v28 quad_perm:[0,0,0,0] row_mask:0xf bank_mask:0xf
    v_mov_b32_dpp v4, v30 quad_perm:[2,2,2,2] row_mask:0xf bank_mask:0xf
    s_nop 0
    v_add_f32_dpp v60, v29, v60 quad_perm:[1,1,1,1] row_mask:0xf bank_mask:0xf
    v_add_f32_dpp v4, v31, v4 quad_perm:[3,3,3,3] row_mask:0xf bank_mask:0xf
    v_add_f32 v60, v60, v4
    v_mfma_f32_16x16x32_bf16 v[40:43], a[220:223], v[20:23], 0
    v_mov_b32_dpp v61, v32 quad_perm:[0,0,0,0] row_mask:0xf bank_mask:0xf
    v_mov_b32_dpp v4, v34 quad_perm:[2,2,2,2] row_mask:0xf bank_mask:0xf
    s_nop 0
    v_add_f32_dpp v61, v33, v61 quad_perm:[1,1,1,1] row_mask:0xf bank_mask:0xf
    v_add_f32_dpp v4, v35, v4 quad_perm:[3,3,3,3] row_mask:0xf bank_mask:0xf
    v_add_f32 v61, v61, v4
    v_cvt_pk_bf16_f32 v54, v60, v61
    v_mfma_f32_16x16x32_bf16 v[28:31], a[224:227], v[20:23], 0
    v_mov_b32_dpp v60, v36 quad_perm:[0,0,0,0] row_mask:0xf bank_mask:0xf
    v_mov_b32_dpp v4, v38 quad_perm:[2,2,2,2] row_mask:0xf bank_mask:0xf
    s_nop 0
    v_add_f32_dpp v60, v37, v60 quad_perm:[1,1,1,1] row_mask:0xf bank_mask:0xf
    v_add_f32_dpp v4, v39, v4 quad_perm:[3,3,3,3] row_mask:0xf bank_mask:0xf
    v_add_f32 v60, v60, v4
    v_mfma_f32_16x16x32_bf16 v[32:35], a[228:231], v[20:23], 0
    v_mov_b32_dpp v61, v40 quad_perm:[0,0,0,0] row_mask:0xf bank_mask:0xf
    v_mov_b32_dpp v4, v42 quad_perm:[2,2,2,2] row_mask:0xf bank_mask:0xf
    s_nop 0
    v_add_f32_dpp v61, v41, v61 quad_perm:[1,1,1,1] row_mask:0xf bank_mask:0xf
    v_add_f32_dpp v4, v43, v4 quad_perm:[3,3,3,3] row_mask:0xf bank_mask:0xf
    v_add_f32 v61, v61, v4
    v_cvt_pk_bf16_f32 v55, v60, v61
    v_mfma_f32_16x16x32_bf16 v[36:39], a[232:235], v[20:23], 0
    v_mov_b32_dpp v60, v28 quad_perm:[0,0,0,0] row_mask:0xf bank_mask:0xf
    v_mov_b32_dpp v4, v30 quad_perm:[2,2,2,2] row_mask:0xf bank_mask:0xf
    s_nop 0
    v_add_f32_dpp v60, v29, v60 quad_perm:[1,1,1,1] row_mask:0xf bank_mask:0xf
    v_add_f32_dpp v4, v31, v4 quad_perm:[3,3,3,3] row_mask:0xf bank_mask:0xf
    v_add_f32 v60, v60, v4
    v_mfma_f32_16x16x32_bf16 v[40:43], a[236:239], v[20:23], 0
    v_mov_b32_dpp v61, v32 quad_perm:[0,0,0,0] row_mask:0xf bank_mask:0xf
    v_mov_b32_dpp v4, v34 quad_perm:[2,2,2,2] row_mask:0xf bank_mask:0xf
    s_nop 0
    v_add_f32_dpp v61, v33, v61 quad_perm:[1,1,1,1] row_mask:0xf bank_mask:0xf
    v_add_f32_dpp v4, v35, v4 quad_perm:[3,3,3,3] row_mask:0xf bank_mask:0xf
    v_add_f32 v61, v61, v4
    v_cvt_pk_bf16_f32 v56, v60, v61
    v_mfma_f32_16x16x32_bf16 v[28:31], a[240:243], v[20:23], 0
    v_mov_b32_dpp v60, v36 quad_perm:[0,0,0,0] row_mask:0xf bank_mask:0xf
    v_mov_b32_dpp v4, v38 quad_perm:[2,2,2,2] row_mask:0xf bank_mask:0xf
    s_nop 0
    v_add_f32_dpp v60, v37, v60 quad_perm:[1,1,1,1] row_mask:0xf bank_mask:0xf
    v_add_f32_dpp v4, v39, v4 quad_perm:[3,3,3,3] row_mask:0xf bank_mask:0xf
    v_add_f32 v60, v60, v4
    buffer_load_dwordx4 a[28:31], v77, s[52:55], s85 offen offset:1024 nt
    s_add_u32 s87, s87, 7
    s_add_u32 s39, s87, s88
    s_bfe_u32 s37, s39, 0x30000
    s_lshl_b32 s37, s37, 12
    s_add_u32 s85, s37, s89
    s_bfe_u32 s37, s39, 0x10003
    s_lshl_b32 s37, s37, 11
    s_add_u32 s85, s37, s85
    s_bfe_u32 s37, s39, 0x40004
    s_lshl_b32 s37, s37, 16
    s_add_u32 s85, s37, s85
    v_mfma_f32_16x16x32_bf16 v[32:35], a[244:247], v[20:23], 0
    v_mov_b32_dpp v61, v40 quad_perm:[0,0,0,0] row_mask:0xf bank_mask:0xf
    v_mov_b32_dpp v4, v42 quad_perm:[2,2,2,2] row_mask:0xf bank_mask:0xf
    s_nop 0
    v_add_f32_dpp v61, v41, v61 quad_perm:[1,1,1,1] row_mask:0xf bank_mask:0xf
    v_add_f32_dpp v4, v43, v4 quad_perm:[3,3,3,3] row_mask:0xf bank_mask:0xf
    v_add_f32 v61, v61, v4
    v_cvt_pk_bf16_f32 v57, v60, v61
    v_mfma_f32_16x16x32_bf16 v[36:39], a[248:251], v[20:23], 0
    v_mov_b32_dpp v60, v28 quad_perm:[0,0,0,0] row_mask:0xf bank_mask:0xf
    v_mov_b32_dpp v4, v30 quad_perm:[2,2,2,2] row_mask:0xf bank_mask:0xf
    s_nop 0
    v_add_f32_dpp v60, v29, v60 quad_perm:[1,1,1,1] row_mask:0xf bank_mask:0xf
    v_add_f32_dpp v4, v31, v4 quad_perm:[3,3,3,3] row_mask:0xf bank_mask:0xf
    v_add_f32 v60, v60, v4
    v_mfma_f32_16x16x32_bf16 v[40:43], a[252:255], v[20:23], 0
    v_mov_b32_dpp v61, v32 quad_perm:[0,0,0,0] row_mask:0xf bank_mask:0xf
    v_mov_b32_dpp v4, v34 quad_perm:[2,2,2,2] row_mask:0xf bank_mask:0xf
    s_nop 0
    v_add_f32_dpp v61, v33, v61 quad_perm:[1,1,1,1] row_mask:0xf bank_mask:0xf
    v_add_f32_dpp v4, v35, v4 quad_perm:[3,3,3,3] row_mask:0xf bank_mask:0xf
    v_add_f32 v61, v61, v4
    v_cvt_pk_bf16_f32 v58, v60, v61
    v_mov_b32_dpp v60, v36 quad_perm:[0,0,0,0] row_mask:0xf bank_mask:0xf
    v_mov_b32_dpp v4, v38 quad_perm:[2,2,2,2] row_mask:0xf bank_mask:0xf
    s_nop 0
    v_add_f32_dpp v60, v37, v60 quad_perm:[1,1,1,1] row_mask:0xf bank_mask:0xf
    v_add_f32_dpp v4, v39, v4 quad_perm:[3,3,3,3] row_mask:0xf bank_mask:0xf
    v_add_f32 v60, v60, v4
    v_mov_b32_dpp v61, v40 quad_perm:[0,0,0,0] row_mask:0xf bank_mask:0xf
    v_mov_b32_dpp v4, v42 quad_perm:[2,2,2,2] row_mask:0xf bank_mask:0xf
    s_nop 0
    v_add_f32_dpp v61, v41, v61 quad_perm:[1,1,1,1] row_mask:0xf bank_mask:0xf
    v_add_f32_dpp v4, v43, v4 quad_perm:[3,3,3,3] row_mask:0xf bank_mask:0xf
    v_add_f32 v61, v61, v4
    v_cvt_pk_bf16_f32 v59, v60, v61
    s_mov_b32 exec_lo, 0x22222222
    s_mov_b32 exec_hi, 0x22222222
    v_mov_b32 v44, v48
    v_mov_b32 v45, v49
    v_mov_b32 v46, v50
    v_mov_b32 v47, v51
    s_mov_b32 exec_lo, 0x44444444
    s_mov_b32 exec_hi, 0x44444444
    v_mov_b32 v44, v52
    v_mov_b32 v45, v53
    v_mov_b32 v46, v54
    v_mov_b32 v47, v55
    s_mov_b32 exec_lo, 0x88888888
    s_mov_b32 exec_hi, 0x88888888
    v_mov_b32 v44, v56
    v_mov_b32 v45, v57
    v_mov_b32 v46, v58
    v_mov_b32 v47, v59
    s_mov_b64 exec, -1
    buffer_store_dwordx4 v[44:47], v19, s[48:51], s94 offen sc1
    s_waitcnt vmcnt(5)
L_qcheck_43:
    v_xor_b32 v68, s35, v68
    v_xor_b32 v69, s35, v69
    v_xor_b32 v70, s35, v70
    v_xor_b32 v71, s35, v71
    v_xor_b32 v72, s35, v72
    v_xor_b32 v73, s35, v73
    v_xor_b32 v74, s35, v74
    v_xor_b32 v75, s35, v75
    v_or_b32 v4, v68, v69
    v_or3_b32 v4, v4, v70, v71
    v_or3_b32 v4, v4, v72, v73
    v_or3_b32 v4, v4, v74, v75
    v_and_b32 v4, 0xff, v4
    v_cmp_ne_u32 vcc, 0, v4
    s_cbranch_vccz L_qok_44
    buffer_load_dwordx4 v[68:71], v78, s[48:51], s91 offen offset:0 sc1
    buffer_load_dwordx4 v[72:75], v78, s[48:51], s91 offen offset:16 sc1
    s_waitcnt vmcnt(0)
    s_sub_u32 s84, s84, 1
    s_cmp_lg_u32 s84, 0
    s_cbranch_scc1 L_qcheck_43
    s_branch L_end
L_qok_44:
    v_cvt_pk_bf16_f32 v68, v68, v69
    v_cvt_pk_bf16_f32 v69, v70, v71
    v_cvt_pk_bf16_f32 v70, v72, v73
    v_cvt_pk_bf16_f32 v71, v74, v75
    s_mov_b32 vcc_lo, 0xf000f
    s_mov_b32 vcc_hi, 0xf000f
    v_cndmask_b32 v80, 0, v68, vcc
    v_cndmask_b32 v81, 0, v69, vcc
    v_cndmask_b32 v82, 0, v70, vcc
    v_cndmask_b32 v83, 0, v71, vcc
    s_mov_b32 vcc_lo, 0xf000f0
    s_mov_b32 vcc_hi, 0xf000f0
    v_cndmask_b32 v84, 0, v68, vcc
    v_cndmask_b32 v85, 0, v69, vcc
    v_cndmask_b32 v86, 0, v70, vcc
    v_cndmask_b32 v87, 0, v71, vcc
    s_mov_b32 vcc_lo, 0xf000f00
    s_mov_b32 vcc_hi, 0xf000f00
    v_cndmask_b32 v88, 0, v68, vcc
    v_cndmask_b32 v89, 0, v69, vcc
    v_cndmask_b32 v90, 0, v70, vcc
    v_cndmask_b32 v91, 0, v71, vcc
    s_mov_b32 vcc_lo, 0xf000f000
    s_mov_b32 vcc_hi, 0xf000f000
    v_cndmask_b32 v92, 0, v68, vcc
    v_cndmask_b32 v93, 0, v69, vcc
    v_cndmask_b32 v94, 0, v70, vcc
    v_cndmask_b32 v95, 0, v71, vcc
    s_getreg_b32 s70, hwreg(HW_REG_XCC_ID, 0, 4)
    s_lshl_b32 s70, s70, 8
    s_or_b32 s70, s70, s35
    s_or_b32 s70, s70, 0x5e9d0000
    s_bfe_u32 s38, s2, 0x30000
    s_lshl_b32 s38, s38, 8
    s_add_u32 s69, s38, 32768
    s_lshl_b32 s38, s32, 2
    s_add_u32 s69, s38, s69
    s_lshl_b32 s38, s34, 24
    s_add_u32 s69, s38, s69
    v_mov_b32 v72, s69
    v_mov_b32 v73, s70
    s_mov_b64 exec, 1
    buffer_store_dword v73, v72, s[48:51], 0 offen sc1
    s_mov_b64 exec, -1
    v_mov_b32 v65, 0xff7f0000
    s_lshl_b32 s38, s34, 14
    s_add_u32 s38, s38, 16384
    v_lshl_add_u32 v64, v1, 2, s38
    buffer_load_dwordx4 a[32:35], v76, s[52:55], s85 offen offset:0 nt
    v_mfma_f32_16x16x32_bf16 v[112:115], v[128:131], v[80:83], 0
    v_mfma_f32_16x16x32_bf16 v[112:115], v[132:135], v[84:87], v[112:115]
    buffer_load_dwordx4 a[36:39], v77, s[52:55], s85 offen offset:0 nt
    v_mfma_f32_16x16x32_bf16 v[112:115], v[136:139], v[88:91], v[112:115]
    v_mfma_f32_16x16x32_bf16 v[112:115], v[140:143], v[92:95], v[112:115]
    buffer_load_dwordx4 a[40:43], v76, s[52:55], s85 offen offset:1024 nt
    v_mfma_f32_16x16x32_bf16 v[96:99], v[144:147], v[80:83], 0
    v_mfma_f32_16x16x32_bf16 v[96:99], v[148:151], v[84:87], v[96:99]
    s_waitcnt vmcnt(8)
    buffer_load_dwordx4 a[44:47], v77, s[52:55], s85 offen offset:1024 nt
    s_add_u32 s87, s87, 7
    s_add_u32 s39, s87, s88
    s_bfe_u32 s37, s39, 0x30000
    s_lshl_b32 s37, s37, 12
    s_add_u32 s85, s37, s89
    s_bfe_u32 s37, s39, 0x10003
    s_lshl_b32 s37, s37, 11
    s_add_u32 s85, s37, s85
    s_bfe_u32 s37, s39, 0x40004
    s_lshl_b32 s37, s37, 16
    s_add_u32 s85, s37, s85
    v_mfma_f32_16x16x32_bf16 v[96:99], v[152:155], v[88:91], v[96:99]
    v_mov_b32_dpp v122, v112 quad_perm:[0,0,0,0] row_mask:0xf bank_mask:0xf
    v_mov_b32_dpp v124, v114 quad_perm:[2,2,2,2] row_mask:0xf bank_mask:0xf
    s_nop 0
    v_add_f32_dpp v122, v113, v122 quad_perm:[1,1,1,1] row_mask:0xf bank_mask:0xf
    v_add_f32_dpp v124, v115, v124 quad_perm:[3,3,3,3] row_mask:0xf bank_mask:0xf
    v_add_f32 v122, v122, v124
    v_max_f32 v65, v65, v122
    ds_write_b32 v64, v122 offset:0
    v_mfma_f32_16x16x32_bf16 v[96:99], v[156:159], v[92:95], v[96:99]
    s_waitcnt vmcnt(8)
    buffer_load_dwordx4 a[48:51], v76, s[52:55], s85 offen offset:0 nt
    v_mfma_f32_16x16x32_bf16 v[112:115], v[160:163], v[80:83], 0
    v_mfma_f32_16x16x32_bf16 v[112:115], v[164:167], v[84:87], v[112:115]
    s_waitcnt vmcnt(8)
    buffer_load_dwordx4 a[52:55], v77, s[52:55], s85 offen offset:0 nt
    v_mfma_f32_16x16x32_bf16 v[112:115], v[168:171], v[88:91], v[112:115]
    s_nop 0
    v_mov_b32_dpp v122, v96 quad_perm:[0,0,0,0] row_mask:0xf bank_mask:0xf
    v_mov_b32_dpp v124, v98 quad_perm:[2,2,2,2] row_mask:0xf bank_mask:0xf
    s_nop 0
    v_add_f32_dpp v122, v97, v122 quad_perm:[1,1,1,1] row_mask:0xf bank_mask:0xf
    v_add_f32_dpp v124, v99, v124 quad_perm:[3,3,3,3] row_mask:0xf bank_mask:0xf
    v_add_f32 v122, v122, v124
    v_max_f32 v65, v65, v122
    ds_write_b32 v64, v122 offset:256
    v_mfma_f32_16x16x32_bf16 v[112:115], v[172:175], v[92:95], v[112:115]
    s_waitcnt vmcnt(8)
    buffer_load_dwordx4 a[56:59], v76, s[52:55], s85 offen offset:1024 nt
    v_mfma_f32_16x16x32_bf16 v[96:99], v[176:179], v[80:83], 0
    v_mfma_f32_16x16x32_bf16 v[96:99], v[180:183], v[84:87], v[96:99]
    s_waitcnt vmcnt(6)
    buffer_load_dwordx4 a[60:63], v77, s[52:55], s85 offen offset:1024 nt
    s_add_u32 s87, s87, 7
    s_add_u32 s39, s87, s88
    s_bfe_u32 s37, s39, 0x30000
    s_lshl_b32 s37, s37, 12
    s_add_u32 s85, s37, s89
    s_bfe_u32 s37, s39, 0x10003
    s_lshl_b32 s37, s37, 11
    s_add_u32 s85, s37, s85
    s_bfe_u32 s37, s39, 0x40004
    s_lshl_b32 s37, s37, 16
    s_add_u32 s85, s37, s85
    v_mfma_f32_16x16x32_bf16 v[96:99], v[184:187], v[88:91], v[96:99]
    v_mov_b32_dpp v122, v112 quad_perm:[0,0,0,0] row_mask:0xf bank_mask:0xf
    v_mov_b32_dpp v124, v114 quad_perm:[2,2,2,2] row_mask:0xf bank_mask:0xf
    s_nop 0
    v_add_f32_dpp v122, v113, v122 quad_perm:[1,1,1,1] row_mask:0xf bank_mask:0xf
    v_add_f32_dpp v124, v115, v124 quad_perm:[3,3,3,3] row_mask:0xf bank_mask:0xf
    v_add_f32 v122, v122, v124
    v_max_f32 v65, v65, v122
    ds_write_b32 v64, v122 offset:512
    s_lshl_b32 s38, s32, 8
    s_add_u32 s69, s38, 98304
    s_lshl_b32 s38, s34, 23
    s_add_u32 s69, s38, s69
    v_mov_b32 v48, s69
    v_mov_b32 v49, s68
    s_barrier
    s_mov_b64 exec, 1
    buffer_store_dword v49, v48, s[48:51], 0 offen sc1
    s_mov_b64 exec, -1
    v_mfma_f32_16x16x32_bf16 v[96:99], v[188:191], v[92:95], v[96:99]
    v_mfma_f32_16x16x32_bf16 v[112:115], v[192:195], v[80:83], 0
    s_waitcnt vmcnt(7)
    buffer_load_dwordx4 a[64:67], v76, s[52:55], s85 offen offset:0 nt
    v_mfma_f32_16x16x32_bf16 v[112:115], v[196:199], v[84:87], v[112:115]
    v_mfma_f32_16x16x32_bf16 v[112:115], v[200:203], v[88:91], v[112:115]
    s_nop 2
    v_mov_b32_dpp v122, v96 quad_perm:[0,0,0,0] row_mask:0xf bank_mask:0xf
    v_mov_b32_dpp v124, v98 quad_perm:[2,2,2,2] row_mask:0xf bank_mask:0xf
    s_nop 0
    v_add_f32_dpp v122, v97, v122 quad_perm:[1,1,1,1] row_mask:0xf bank_mask:0xf
    v_add_f32_dpp v124, v99, v124 quad_perm:[3,3,3,3] row_mask:0xf bank_mask:0xf
    v_add_f32 v122, v122, v124
    v_max_f32 v65, v65, v122
    ds_write_b32 v64, v122 offset:768
    s_waitcnt vmcnt(7)
    buffer_load_dwordx4 a[68:71], v77, s[52:55], s85 offen offset:0 nt
    v_mfma_f32_16x16x32_bf16 v[112:115], v[204:207], v[92:95], v[112:115]
    v_mfma_f32_16x16x32_bf16 v[96:99], v[208:211], v[80:83], 0
    s_waitcnt vmcnt(7)
    buffer_load_dwordx4 a[72:75], v76, s[52:55], s85 offen offset:1024 nt
    v_mfma_f32_16x16x32_bf16 v[96:99], v[212:215], v[84:87], v[96:99]
    v_mfma_f32_16x16x32_bf16 v[96:99], v[216:219], v[88:91], v[96:99]
    s_nop 2
    v_mov_b32_dpp v122, v112 quad_perm:[0,0,0,0] row_mask:0xf bank_mask:0xf
    v_mov_b32_dpp v124, v114 quad_perm:[2,2,2,2] row_mask:0xf bank_mask:0xf
    s_nop 0
    v_add_f32_dpp v122, v113, v122 quad_perm:[1,1,1,1] row_mask:0xf bank_mask:0xf
    v_add_f32_dpp v124, v115, v124 quad_perm:[3,3,3,3] row_mask:0xf bank_mask:0xf
    v_add_f32 v122, v122, v124
    v_max_f32 v65, v65, v122
    ds_write_b32 v64, v122 offset:1024
    s_waitcnt vmcnt(7)
    buffer_load_dwordx4 a[76:79], v77, s[52:55], s85 offen offset:1024 nt
    s_add_u32 s87, s87, 7
    s_add_u32 s39, s87, s88
    s_bfe_u32 s37, s39, 0x30000
    s_lshl_b32 s37, s37, 12
    s_add_u32 s85, s37, s89
    s_bfe_u32 s37, s39, 0x10003
    s_lshl_b32 s37, s37, 11
    s_add_u32 s85, s37, s85
    s_bfe_u32 s37, s39, 0x40004
    s_lshl_b32 s37, s37, 16
    s_add_u32 s85, s37, s85
    v_mfma_f32_16x16x32_bf16 v[96:99], v[220:223], v[92:95], v[96:99]
    v_mfma_f32_16x16x32_bf16 v[112:115], v[224:227], v[80:83], 0
    s_waitcnt vmcnt(7)
    buffer_load_dwordx4 a[80:83], v76, s[52:55], s85 offen offset:0 nt
    v_mfma_f32_16x16x32_bf16 v[112:115], v[228:231], v[84:87], v[112:115]
    v_mfma_f32_16x16x32_bf16 v[112:115], v[232:235], v[88:91], v[112:115]
    s_nop 2
    v_mov_b32_dpp v122, v96 quad_perm:[0,0,0,0] row_mask:0xf bank_mask:0xf
    v_mov_b32_dpp v124, v98 quad_perm:[2,2,2,2] row_mask:0xf bank_mask:0xf
    s_nop 0
    v_add_f32_dpp v122, v97, v122 quad_perm:[1,1,1,1] row_mask:0xf bank_mask:0xf
    v_add_f32_dpp v124, v99, v124 quad_perm:[3,3,3,3] row_mask:0xf bank_mask:0xf
    v_add_f32 v122, v122, v124
    v_max_f32 v65, v65, v122
    ds_write_b32 v64, v122 offset:1280
    s_waitcnt vmcnt(7)
    buffer_load_dwordx4 a[84:87], v77, s[52:55], s85 offen offset:0 nt
    v_mfma_f32_16x16x32_bf16 v[112:115], v[236:239], v[92:95], v[112:115]
    v_mfma_f32_16x16x32_bf16 v[96:99], v[240:243], v[80:83], 0
    s_waitcnt vmcnt(7)
    buffer_load_dwordx4 a[88:91], v76, s[52:55], s85 offen offset:1024 nt
    v_mfma_f32_16x16x32_bf16 v[96:99], v[244:247], v[84:87], v[96:99]
    v_mfma_f32_16x16x32_bf16 v[96:99], v[248:251], v[88:91], v[96:99]
    s_nop 2
    v_mov_b32_dpp v122, v112 quad_perm:[0,0,0,0] row_mask:0xf bank_mask:0xf
    v_mov_b32_dpp v124, v114 quad_perm:[2,2,2,2] row_mask:0xf bank_mask:0xf
    s_nop 0
    v_add_f32_dpp v122, v113, v122 quad_perm:[1,1,1,1] row_mask:0xf bank_mask:0xf
    v_add_f32_dpp v124, v115, v124 quad_perm:[3,3,3,3] row_mask:0xf bank_mask:0xf
    v_add_f32 v122, v122, v124
    v_max_f32 v65, v65, v122
    ds_write_b32 v64, v122 offset:1536
    v_mfma_f32_16x16x32_bf16 v[96:99], v[252:255], v[92:95], v[96:99]
    s_waitcnt vmcnt(6)
    buffer_load_dwordx4 a[92:95], v77, s[52:55], s85 offen offset:1024 nt
    s_add_u32 s87, s87, 7
    s_add_u32 s39, s87, s88
    s_bfe_u32 s37, s39, 0x30000
    s_lshl_b32 s37, s37, 12
    s_add_u32 s85, s37, s89
    s_bfe_u32 s37, s39, 0x10003
    s_lshl_b32 s37, s37, 11
    s_add_u32 s85, s37, s85
    s_bfe_u32 s37, s39, 0x40004
    s_lshl_b32 s37, s37, 16
    s_add_u32 s85, s37, s85
    v_mfma_f32_16x16x32_bf16 v[112:115], a[0:3], v[80:83], 0
    v_mfma_f32_16x16x32_bf16 v[112:115], a[4:7], v[84:87], v[112:115]
    s_waitcnt vmcnt(6)
    buffer_load_dwordx4 a[96:99], v76, s[52:55], s85 offen offset:0 nt
    v_mfma_f32_16x16x32_bf16 v[112:115], a[8:11], v[88:91], v[112:115]
    v_mov_b32_dpp v122, v96 quad_perm:[0,0,0,0] row_mask:0xf bank_mask:0xf
    v_mov_b32_dpp v124, v98 quad_perm:[2,2,2,2] row_mask:0xf bank_mask:0xf
    s_nop 0
    v_add_f32_dpp v122, v97, v122 quad_perm:[1,1,1,1] row_mask:0xf bank_mask:0xf
    v_add_f32_dpp v124, v99, v124 quad_perm:[3,3,3,3] row_mask:0xf bank_mask:0xf
    v_add_f32 v122, v122, v124
    v_max_f32 v65, v65, v122
    ds_write_b32 v64, v122 offset:1792
    v_mfma_f32_16x16x32_bf16 v[112:115], a[12:15], v[92:95], v[112:115]
    s_waitcnt vmcnt(6)
    buffer_load_dwordx4 a[100:103], v77, s[52:55], s85 offen offset:0 nt
    v_mfma_f32_16x16x32_bf16 v[96:99], a[16:19], v[80:83], 0
    v_mfma_f32_16x16x32_bf16 v[96:99], a[20:23], v[84:87], v[96:99]
    s_waitcnt vmcnt(6)
    buffer_load_dwordx4 a[104:107], v76, s[52:55], s85 offen offset:1024 nt
    v_mfma_f32_16x16x32_bf16 v[96:99], a[24:27], v[88:91], v[96:99]
    s_nop 0
    v_mov_b32_dpp v122, v112 quad_perm:[0,0,0,0] row_mask:0xf bank_mask:0xf
    v_mov_b32_dpp v124, v114 quad_perm:[2,2,2,2] row_mask:0xf bank_mask:0xf
    s_nop 0
    v_add_f32_dpp v122, v113, v122 quad_perm:[1,1,1,1] row_mask:0xf bank_mask:0xf
    v_add_f32_dpp v124, v115, v124 quad_perm:[3,3,3,3] row_mask:0xf bank_mask:0xf
    v_add_f32 v122, v122, v124
    v_max_f32 v65, v65, v122
    ds_write_b32 v64, v122 offset:2048
    v_mfma_f32_16x16x32_bf16 v[96:99], a[28:31], v[92:95], v[96:99]
    s_waitcnt vmcnt(6)
    buffer_load_dwordx4 a[108:111], v77, s[52:55], s85 offen offset:1024 nt
    s_add_u32 s87, s87, 7
    s_add_u32 s39, s87, s88
    s_bfe_u32 s37, s39, 0x30000
    s_lshl_b32 s37, s37, 12
    s_add_u32 s85, s37, s89
    s_bfe_u32 s37, s39, 0x10003
    s_lshl_b32 s37, s37, 11
    s_add_u32 s85, s37, s85
    s_bfe_u32 s37, s39, 0x40004
    s_lshl_b32 s37, s37, 16
    s_add_u32 s85, s37, s85
    v_mfma_f32_16x16x32_bf16 v[112:115], a[32:35], v[80:83], 0
    s_bfe_u32 s38, s2, 0x20001
    s_lshl_b32 s38, s38, 0
    s_add_u32 s90, s38, 0
    s_bfe_u32 s38, s2, 0x10000
    s_lshl_b32 s38, s38, 2
    s_add_u32 s90, s38, s90
    s_and_b32 s36, s90, 3
    s_bitcmp0_b32 s90, 2
    s_cselect_b64 s[40:41], s[24:25], s[14:15]
    s_cselect_b32 s45, 262144, 0
    s_add_u32 s45, s45, 524288
    s_lshl_b32 s38, s36, 16
    s_add_u32 s71, s38, s45
    s_lshr_b32 s38, s32, 2
    s_lshl_b32 s38, s38, 13
    s_add_u32 s71, s38, s71
    s_bfe_u32 s38, s32, 0x20000
    s_lshl_b32 s38, s38, 6
    s_add_u32 s71, s38, s71
    s_mov_b32 s42, 4194304
    s_mov_b32 s43, 0x20000
    s_lshl_b32 s38, s32, 17
    s_add_u32 s44, s38, 0
    s_lshl_b32 s38, s34, 15
    s_add_u32 s44, s38, s44
    s_lshl_b32 s38, s36, 8
    s_add_u32 s44, s38, s44
    s_lshl_b32 s38, s36, 16
    s_add_u32 s45, s38, s45
    s_lshr_b32 s38, s34, 1
    s_lshl_b32 s38, s38, 15
    s_add_u32 s45, s38, s45
    s_lshl_b32 s38, s32, 8
    s_add_u32 s45, s38, s45
    s_bfe_u32 s38, s34, 0x10000
    s_lshl_b32 s38, s38, 7
    s_add_u32 s45, s38, s45
    s_lshl_b32 s38, s32, 11
    s_add_u32 s46, s38, 196608
    s_lshl_b32 s38, s34, 9
    s_add_u32 s46, s38, s46
    s_mov_b32 s72, s26
    s_and_b32 s73, s27, 0xffff
    s_mov_b32 s74, 8192
    s_mov_b32 s75, 0x20000
    v_mfma_f32_16x16x32_bf16 v[112:115], a[36:39], v[84:87], v[112:115]
    s_waitcnt vmcnt(6)
    buffer_load_dwordx4 a[112:115], v76, s[52:55], s85 offen offset:0 nt
    v_mfma_f32_16x16x32_bf16 v[112:115], a[40:43], v[88:91], v[112:115]
    v_mov_b32_dpp v122, v96 quad_perm:[0,0,0,0] row_mask:0xf bank_mask:0xf
    v_mov_b32_dpp v124, v98 quad_perm:[2,2,2,2] row_mask:0xf bank_mask:0xf
    s_nop 0
    v_add_f32_dpp v122, v97, v122 quad_perm:[1,1,1,1] row_mask:0xf bank_mask:0xf
    v_add_f32_dpp v124, v99, v124 quad_perm:[3,3,3,3] row_mask:0xf bank_mask:0xf
    v_add_f32 v122, v122, v124
    v_max_f32 v65, v65, v122
    ds_write_b32 v64, v122 offset:2304
    v_mfma_f32_16x16x32_bf16 v[112:115], a[44:47], v[92:95], v[112:115]
    s_waitcnt vmcnt(6)
    buffer_load_dwordx4 a[116:119], v77, s[52:55], s85 offen offset:0 nt
    v_mfma_f32_16x16x32_bf16 v[96:99], a[48:51], v[80:83], 0
    v_mfma_f32_16x16x32_bf16 v[96:99], a[52:55], v[84:87], v[96:99]
    s_waitcnt vmcnt(6)
    buffer_load_dwordx4 a[120:123], v76, s[52:55], s85 offen offset:1024 nt
    v_mfma_f32_16x16x32_bf16 v[96:99], a[56:59], v[88:91], v[96:99]
    s_nop 0
    v_mov_b32_dpp v122, v112 quad_perm:[0,0,0,0] row_mask:0xf bank_mask:0xf
    v_mov_b32_dpp v124, v114 quad_perm:[2,2,2,2] row_mask:0xf bank_mask:0xf
    s_nop 0
    v_add_f32_dpp v122, v113, v122 quad_perm:[1,1,1,1] row_mask:0xf bank_mask:0xf
    v_add_f32_dpp v124, v115, v124 quad_perm:[3,3,3,3] row_mask:0xf bank_mask:0xf
    v_add_f32 v122, v122, v124
    v_max_f32 v65, v65, v122
    ds_write_b32 v64, v122 offset:2560
    v_lshlrev_b32 v4, 2, v2
    v_xor_b32 v4, v4, v3
    v_xor_b32 v5, 0, v4
    v_lshlrev_b32 v5, 4, v5
    v_lshl_add_u32 v20, v2, 10, v5
    v_xor_b32 v5, 1, v4
    v_lshlrev_b32 v5, 4, v5
    v_lshl_add_u32 v21, v2, 10, v5
    v_add_u32 v21, 3072, v21
    v_xor_b32 v5, 2, v4
    v_lshlrev_b32 v5, 4, v5
    v_lshl_add_u32 v22, v2, 10, v5
    v_add_u32 v22, 6144, v22
    v_xor_b32 v5, 3, v4
    v_lshlrev_b32 v5, 4, v5
    v_lshl_add_u32 v23, v2, 10, v5
    v_add_u32 v23, 9216, v23
    s_lshl_b32 s38, s32, 15
    s_add_u32 s47, s38, 1048576
    s_lshl_b32 s38, s3, 13
    s_add_u32 s47, s38, s47
    v_lshlrev_b32 v6, 7, v2
    v_bfe_u32 v5, v3, 0, 3
    v_lshl_add_u32 v6, v5, 4, v6
    v_lshrrev_b32 v4, 3, v3
    v_and_b32 v7, 3, v3
    v_min_u32 v7, 2, v7
    v_lshl_add_u32 v7, v7, 1, v4
    v_add_u32 v5, 0, v4
    v_cmp_le_u32 vcc, s33, v5
    s_nop 1
    v_addc_co_u32 v5, vcc, 0, v5, vcc
    v_lshl_add_u32 v50, v5, 10, v6
    v_add_u32 v5, 2, v4
    v_cmp_le_u32 vcc, s33, v5
    s_nop 1
    v_addc_co_u32 v5, vcc, 0, v5, vcc
    v_lshl_add_u32 v51, v5, 10, v6
    v_add_u32 v5, 4, v4
    v_cmp_le_u32 vcc, s33, v5
    s_nop 1
    v_addc_co_u32 v5, vcc, 0, v5, vcc
    v_lshl_add_u32 v52, v5, 10, v6
    v_mov_b32 v5, v7
    v_mov_b32 v6, 512
    v_cmp_le_u32 vcc, s33, v5
    s_nop 1
    v_addc_co_u32 v5, vcc, 0, v5, vcc
    v_lshl_add_u32 v53, v5, 10, v6
    s_mul_i32 s38, s3, 320
    s_add_u32 s38, s38, 135168
    v_lshlrev_b32 v4, 6, v2
    v_lshl_add_u32 v4, v3, 1, v4
    v_add_u32 v31, s38, v4
    v_mfma_f32_16x16x32_bf16 v[96:99], a[60:63], v[92:95], v[96:99]
    v_mfma_f32_16x16x32_bf16 v[112:115], a[64:67], v[80:83], 0
    s_waitcnt vmcnt(6)
    buffer_load_dwordx4 a[124:127], v77, s[52:55], s85 offen offset:1024 nt
    s_add_u32 s87, s87, 7
    s_add_u32 s39, s87, s88
    s_bfe_u32 s37, s39, 0x30000
    s_lshl_b32 s37, s37, 12
    s_add_u32 s85, s37, s89
    s_bfe_u32 s37, s39, 0x10003
    s_lshl_b32 s37, s37, 11
    s_add_u32 s85, s37, s85
    s_bfe_u32 s37, s39, 0x40004
    s_lshl_b32 s37, s37, 16
    s_add_u32 s85, s37, s85
    v_mfma_f32_16x16x32_bf16 v[112:115], a[68:71], v[84:87], v[112:115]
    v_mfma_f32_16x16x32_bf16 v[112:115], a[72:75], v[88:91], v[112:115]
    v_mov_b32_dpp v122, v96 quad_perm:[0,0,0,0] row_mask:0xf bank_mask:0xf
    v_mov_b32_dpp v124, v98 quad_perm:[2,2,2,2] row_mask:0xf bank_mask:0xf
    s_nop 0
    v_add_f32_dpp v122, v97, v122 quad_perm:[1,1,1,1] row_mask:0xf bank_mask:0xf
    v_add_f32_dpp v124, v99, v124 quad_perm:[3,3,3,3] row_mask:0xf bank_mask:0xf
    v_add_f32 v122, v122, v124
    v_max_f32 v65, v65, v122
    ds_write_b32 v64, v122 offset:2816
    s_waitcnt vmcnt(5)
    buffer_load_dwordx4 v[128:131], v76, s[52:55], s85 offen offset:0 nt
    v_mfma_f32_16x16x32_bf16 v[112:115], a[76:79], v[92:95], v[112:115]
    v_mfma_f32_16x16x32_bf16 v[96:99], a[80:83], v[80:83], 0
    v_lshlrev_b32 v4, 11, v2
    v_bfe_u32 v5, v1, 2, 2
    v_lshl_add_u32 v4, v5, 8, v4
    v_bfe_u32 v5, v1, 2, 2
    v_lshl_add_u32 v4, v5, 6, v4
    v_bfe_u32 v5, v1, 4, 1
    v_lshl_add_u32 v4, v5, 5, v4
    v_bfe_u32 v5, v1, 1, 1
    v_lshl_add_u32 v4, v5, 4, v4
    v_bfe_u32 v5, v1, 0, 1
    v_lshl_add_u32 v4, v5, 3, v4
    s_lshl_b32 s38, s34, 6
    s_add_u32 s38, s38, 98304
    v_xor_b32 v24, s38, v4
    v_xor_b32 v25, 16, v24
    v_xor_b32 v26, 32, v24
    v_xor_b32 v27, 48, v24
    v_and_b32 v4, 3, v3
    v_lshrrev_b32 v5, 2, v3
    v_lshlrev_b32 v6, 4, v2
    v_add_u32 v6, 135168, v6
    s_movk_i32 s36, 320
    v_cmp_eq_u32 vcc, 0, v5
    s_nop 1
    v_cndmask_b32 v28, 4, v4, vcc
    v_mad_u32_u24 v28, v28, s36, v6
    v_cmp_eq_u32 vcc, 1, v5
    s_nop 1
    v_cndmask_b32 v29, 4, v4, vcc
    v_mad_u32_u24 v29, v29, s36, v6
    v_lshlrev_b32 v5, 2, v1
    v_add_u32 v5, 136448, v5
    v_mov_b32 v6, 0
    ds_write_b32 v5, v6
    s_waitcnt vmcnt(5)
    buffer_load_dwordx4 v[132:135], v77, s[52:55], s85 offen offset:0 nt
    v_mfma_f32_16x16x32_bf16 v[96:99], a[84:87], v[84:87], v[96:99]
    v_mfma_f32_16x16x32_bf16 v[96:99], a[88:91], v[88:91], v[96:99]
    v_mov_b32_dpp v122, v112 quad_perm:[0,0,0,0] row_mask:0xf bank_mask:0xf
    v_mov_b32_dpp v124, v114 quad_perm:[2,2,2,2] row_mask:0xf bank_mask:0xf
    s_nop 0
    v_add_f32_dpp v122, v113, v122 quad_perm:[1,1,1,1] row_mask:0xf bank_mask:0xf
    v_add_f32_dpp v124, v115, v124 quad_perm:[3,3,3,3] row_mask:0xf bank_mask:0xf
    v_add_f32 v122, v122, v124
    v_max_f32 v65, v65, v122
    ds_write_b32 v64, v122 offset:3072
    s_waitcnt vmcnt(5)
    buffer_load_dwordx4 v[136:139], v76, s[52:55], s85 offen offset:1024 nt
    v_mfma_f32_16x16x32_bf16 v[96:99], a[92:95], v[92:95], v[96:99]
    v_mfma_f32_16x16x32_bf16 v[112:115], a[96:99], v[80:83], 0
    s_waitcnt vmcnt(5)
    buffer_load_dwordx4 v[140:143], v77, s[52:55], s85 offen offset:1024 nt
    s_add_u32 s87, s87, 7
    s_add_u32 s39, s87, s88
    s_bfe_u32 s37, s39, 0x30000
    s_lshl_b32 s37, s37, 12
    s_add_u32 s85, s37, s89
    s_bfe_u32 s37, s39, 0x10003
    s_lshl_b32 s37, s37, 11
    s_add_u32 s85, s37, s85
    s_bfe_u32 s37, s39, 0x40004
    s_lshl_b32 s37, s37, 16
    s_add_u32 s85, s37, s85
    v_mfma_f32_16x16x32_bf16 v[112:115], a[100:103], v[84:87], v[112:115]
    v_mfma_f32_16x16x32_bf16 v[112:115], a[104:107], v[88:91], v[112:115]
    v_mov_b32_dpp v122, v96 quad_perm:[0,0,0,0] row_mask:0xf bank_mask:0xf
    v_mov_b32_dpp v124, v98 quad_perm:[2,2,2,2] row_mask:0xf bank_mask:0xf
    s_nop 0
    v_add_f32_dpp v122, v97, v122 quad_perm:[1,1,1,1] row_mask:0xf bank_mask:0xf
    v_add_f32_dpp v124, v99, v124 quad_perm:[3,3,3,3] row_mask:0xf bank_mask:0xf
    v_add_f32 v122, v122, v124
    v_max_f32 v65, v65, v122
    ds_write_b32 v64, v122 offset:3328
    v_lshlrev_b32 v30, 4, v3
    v_lshl_add_u32 v30, v2, 13, v30
    v_lshrrev_b32 v5, 2, v1
    v_lshlrev_b32 v32, 8, v5
    v_bfe_u32 v5, v1, 0, 2
    v_lshl_add_u32 v32, v5, 4, v32
    s_xor_b32 s37, s90, 4
    s_bfe_u32 s38, s37, 0x30000
    s_lshl_b32 s38, s38, 8
    s_add_u32 s36, s38, 0
    s_lshr_b32 s38, s32, 4
    s_lshl_b32 s38, s38, 7
    s_add_u32 s36, s38, s36
    s_bfe_u32 s38, s32, 0x20000
    s_lshl_b32 s38, s38, 5
    s_add_u32 s36, s38, s36
    s_bfe_u32 s38, s32, 0x20002
    s_lshl_b32 s38, s38, 3
    s_add_u32 s36, s38, s36
    v_bfe_u32 v5, v1, 0, 2
    v_lshlrev_b32 v33, 11, v5
    v_lshl_add_u32 v33, v2, 1, v33
    v_add_u32 v33, s36, v33
    v_and_b32 v5, 31, v1
    v_lshlrev_b32 v34, 4, v5
    s_mul_i32 s38, s34, 320
    s_add_u32 s38, s38, 135168
    v_lshl_add_u32 v35, v5, 3, s38
    s_bfe_u32 s38, s34, 0x10000
    s_lshl_b32 s38, s38, 12
    s_add_u32 s36, s38, s71
    s_lshr_b32 s38, s34, 1
    s_lshl_b32 s38, s38, 24
    s_add_u32 s36, s38, s36
    s_bitcmp1_b32 s90, 2
    s_cselect_b32 s46, s46, s36
    s_cselect_b64 vcc, -1, 0
    v_cndmask_b32 v54, v32, v34, vcc
    s_waitcnt vmcnt(5)
    buffer_load_dwordx4 v[144:147], v76, s[52:55], s85 offen offset:0 nt
    v_mfma_f32_16x16x32_bf16 v[112:115], a[108:111], v[92:95], v[112:115]
    v_mfma_f32_16x16x32_bf16 v[96:99], a[112:115], v[80:83], 0
    s_waitcnt vmcnt(5)
    buffer_load_dwordx4 v[148:151], v77, s[52:55], s85 offen offset:0 nt
    v_mfma_f32_16x16x32_bf16 v[96:99], a[116:119], v[84:87], v[96:99]
    v_mfma_f32_16x16x32_bf16 v[96:99], a[120:123], v[88:91], v[96:99]
    s_nop 2
    v_mov_b32_dpp v122, v112 quad_perm:[0,0,0,0] row_mask:0xf bank_mask:0xf
    v_mov_b32_dpp v124, v114 quad_perm:[2,2,2,2] row_mask:0xf bank_mask:0xf
    s_nop 0
    v_add_f32_dpp v122, v113, v122 quad_perm:[1,1,1,1] row_mask:0xf bank_mask:0xf
    v_add_f32_dpp v124, v115, v124 quad_perm:[3,3,3,3] row_mask:0xf bank_mask:0xf
    v_add_f32 v122, v122, v124
    v_max_f32 v65, v65, v122
    ds_write_b32 v64, v122 offset:3584
    v_mfma_f32_16x16x32_bf16 v[96:99], a[124:127], v[92:95], v[96:99]
    v_add_u32 v64, 3840, v64
    s_mov_b32 s97, 8
    s_mov_b32 s92, 7
    s_lshl_b32 s38, s32, 13
    s_add_u32 s80, s38, 3145728
    s_lshl_b32 s38, s3, 11
    s_add_u32 s80, s38, s80
    v_lshrrev_b32 v4, 2, v1
    v_lshlrev_b32 v55, 3, v4
    s_mov_b32 s66, 134217728
    s_mov_b32 s67, 0x20000
    s_mov_b64 s[64:65], s[52:53]
    v_mov_b32 v62, v76
    v_mov_b32 v63, v77
    s_branch L_bloop
L_aux:
    v_lshlrev_b32 v4, 2, v2
    v_xor_b32 v4, v4, v3
    v_xor_b32 v96, 0, v4
    v_lshlrev_b32 v96, 4, v96
    v_lshl_add_u32 v10, v2, 13, v96
    v_xor_b32 v97, 1, v4
    v_lshlrev_b32 v97, 4, v97
    v_lshl_add_u32 v11, v2, 13, v97
    v_add_u32 v11, 31744, v11
    v_xor_b32 v98, 2, v4
    v_lshlrev_b32 v98, 4, v98
    v_lshl_add_u32 v12, v2, 13, v98
    v_add_u32 v12, 63488, v12
    v_xor_b32 v99, 3, v4
    v_lshlrev_b32 v99, 4, v99
    v_lshl_add_u32 v13, v2, 13, v99
    v_add_u32 v13, 95232, v13
    s_lshl_b32 s56, s34, 15
    s_mov_b32 s62, 0
    s_lshl_b32 s38, s34, 20
    s_add_u32 s95, s38, 0
    s_lshl_b32 s38, s32, 8
    s_add_u32 s95, s38, s95
    s_waitcnt lgkmcnt(0)
    s_mov_b32 s52, s12
    s_and_b32 s53, s13, 0xffff
    s_mov_b32 s54, 4194304
    s_mov_b32 s55, 0x20000
    s_add_u32 s39, s56, s62
    s_mov_b32 m0, s39
    s_add_u32 s62, s62, 4096
    s_and_b32 s62, s62, 0x7fff
    buffer_load_dwordx4 v10, s[52:55], s95 offen offset:0 nt lds
    buffer_load_dwordx4 v11, s[52:55], s95 offen offset:1024 nt lds
    buffer_load_dwordx4 v12, s[52:55], s95 offen offset:2048 nt lds
    buffer_load_dwordx4 v13, s[52:55], s95 offen offset:3072 nt lds
    s_add_u32 s95, s95, 131072
    s_add_u32 s39, s56, s62
    s_mov_b32 m0, s39
    s_add_u32 s62, s62, 4096
    s_and_b32 s62, s62, 0x7fff
    buffer_load_dwordx4 v10, s[52:55], s95 offen offset:0 nt lds
    buffer_load_dwordx4 v11, s[52:55], s95 offen offset:1024 nt lds
    buffer_load_dwordx4 v12, s[52:55], s95 offen offset:2048 nt lds
    buffer_load_dwordx4 v13, s[52:55], s95 offen offset:3072 nt lds
    s_add_u32 s95, s95, 131072
    s_load_dword s35, s[30:31], 0
    s_mov_b32 s48, s30
    s_and_b32 s49, s31, 0xffff
    s_mov_b32 s50, 8388608
    s_mov_b32 s51, 0x20000
    s_mov_b32 s82, 0xffffff00
    s_mov_b32 s83, 0x3e0293ee
    s_mov_b32 s84, 2097152
    v_lshl_add_u32 v76, v2, 10, v96
    v_lshl_add_u32 v96, v2, 8, v96
    v_lshl_add_u32 v77, v2, 10, v97
    v_lshl_add_u32 v97, v2, 8, v97
    v_add_u32 v77, 3072, v77
    v_lshl_add_u32 v78, v2, 10, v98
    v_lshl_add_u32 v98, v2, 8, v98
    v_add_u32 v78, 6144, v78
    v_lshl_add_u32 v79, v2, 10, v99
    v_lshl_add_u32 v99, v2, 8, v99
    v_add_u32 v79, 9216, v79
    v_bfe_u32 v100, v1, 0, 5
    v_lshlrev_b32 v101, 8, v100
    v_lshlrev_b32 v9, 4, v3
    v_lshl_add_u32 v9, v2, 10, v9
    v_xor_b32 v5, v3, v2
    v_bfe_u32 v4, v3, 2, 1
    v_lshlrev_b32 v6, 11, v4
    v_bfe_u32 v4, v3, 3, 1
    v_lshl_add_u32 v6, v4, 10, v6
    v_bfe_u32 v4, v3, 0, 2
    v_lshl_add_u32 v6, v4, 8, v6
    v_bfe_u32 v4, v5, 0, 2
    v_lshl_add_u32 v6, v4, 6, v6
    v_bfe_u32 v4, v3, 2, 1
    v_lshl_add_u32 v6, v4, 5, v6
    v_bfe_u32 v4, v3, 3, 1
    v_lshl_add_u32 v6, v4, 4, v6
    v_add_u32 v60, s56, v6
    v_xor_b32 v61, 16, v60
    v_xor_b32 v62, 32, v60
    v_xor_b32 v63, 48, v60
    v_lshrrev_b32 v5, 4, v1
    v_xor_b32 v5, v5, v1
    v_bfe_u32 v4, v1, 4, 1
    v_lshlrev_b32 v6, 11, v4
    v_bfe_u32 v4, v1, 5, 1
    v_lshl_add_u32 v6, v4, 10, v6
    v_bfe_u32 v4, v1, 2, 2
    v_lshl_add_u32 v6, v4, 8, v6
    v_bfe_u32 v4, v1, 2, 2
    v_lshl_add_u32 v6, v4, 6, v6
    v_bfe_u32 v4, v1, 4, 1
    v_lshl_add_u32 v6, v4, 5, v6
    v_bfe_u32 v4, v5, 1, 1
    v_lshl_add_u32 v6, v4, 4, v6
    v_bfe_u32 v4, v1, 0, 1
    v_lshl_add_u32 v6, v4, 3, v6
    v_add_u32 v82, s56, v6
    v_xor_b32 v83, 32, v82
    v_xor_b32 v84, 64, v82
    v_xor_b32 v85, 96, v82
    v_xor_b32 v86, 128, v82
    v_xor_b32 v87, 160, v82
    v_xor_b32 v88, 192, v82
    v_xor_b32 v89, 224, v82
    v_lshlrev_b32 v6, 11, v2
    v_bfe_u32 v4, v1, 2, 2
    v_lshl_add_u32 v6, v4, 8, v6
    v_bfe_u32 v4, v1, 2, 2
    v_lshl_add_u32 v6, v4, 6, v6
    v_bfe_u32 v4, v1, 4, 1
    v_lshl_add_u32 v6, v4, 5, v6
    v_bfe_u32 v4, v1, 1, 1
    v_lshl_add_u32 v6, v4, 4, v6
    v_bfe_u32 v4, v1, 0, 1
    v_lshl_add_u32 v6, v4, 3, v6
    v_add_u32 v136, s56, v6
    v_xor_b32 v137, 16, v136
    v_xor_b32 v138, 32, v136
    v_xor_b32 v139, 48, v136
    v_xor_b32 v140, 64, v136
    v_xor_b32 v141, 80, v136
    v_xor_b32 v142, 96, v136
    v_xor_b32 v143, 112, v136
    v_xor_b32 v144, 128, v136
    v_xor_b32 v145, 144, v136
    v_xor_b32 v146, 160, v136
    v_xor_b32 v147, 176, v136
    v_xor_b32 v148, 192, v136
    v_xor_b32 v149, 208, v136
    v_xor_b32 v150, 224, v136
    v_xor_b32 v151, 240, v136
    s_lshl_b32 s85, s34, 13
    s_add_u32 s85, s85, 131072
    v_lshl_add_u32 v94, v1, 4, s85
    v_add_u32 v96, s85, v96
    v_add_u32 v97, s85, v97
    v_add_u32 v98, s85, v98
    v_add_u32 v99, s85, v99
    s_add_u32 s39, s56, s62
    s_mov_b32 m0, s39
    s_add_u32 s62, s62, 4096
    s_and_b32 s62, s62, 0x7fff
    buffer_load_dwordx4 v10, s[52:55], s95 offen offset:0 nt lds
    buffer_load_dwordx4 v11, s[52:55], s95 offen offset:1024 nt lds
    buffer_load_dwordx4 v12, s[52:55], s95 offen offset:2048 nt lds
    buffer_load_dwordx4 v13, s[52:55], s95 offen offset:3072 nt lds
    s_add_u32 s95, s95, 131072
    s_add_u32 s39, s56, s62
    s_mov_b32 m0, s39
    s_add_u32 s62, s62, 4096
    s_and_b32 s62, s62, 0x7fff
    buffer_load_dwordx4 v10, s[52:55], s95 offen offset:0 nt lds
    buffer_load_dwordx4 v11, s[52:55], s95 offen offset:1024 nt lds
    buffer_load_dwordx4 v12, s[52:55], s95 offen offset:2048 nt lds
    buffer_load_dwordx4 v13, s[52:55], s95 offen offset:3072 nt lds
    s_add_u32 s95, s95, 131072
    s_add_u32 s39, s56, s62
    s_mov_b32 m0, s39
    s_add_u32 s62, s62, 4096
    s_and_b32 s62, s62, 0x7fff
    buffer_load_dwordx4 v10, s[52:55], s95 offen offset:0 nt lds
    buffer_load_dwordx4 v11, s[52:55], s95 offen offset:1024 nt lds
    buffer_load_dwordx4 v12, s[52:55], s95 offen offset:2048 nt lds
    buffer_load_dwordx4 v13, s[52:55], s95 offen offset:3072 nt lds
    s_add_u32 s95, s95, 131072
    s_add_u32 s39, s56, s62
    s_mov_b32 m0, s39
    s_add_u32 s62, s62, 4096
    s_and_b32 s62, s62, 0x7fff
    buffer_load_dwordx4 v10, s[52:55], s95 offen offset:0 nt lds
    buffer_load_dwordx4 v11, s[52:55], s95 offen offset:1024 nt lds
    buffer_load_dwordx4 v12, s[52:55], s95 offen offset:2048 nt lds
    buffer_load_dwordx4 v13, s[52:55], s95 offen offset:3072 nt lds
    s_add_u32 s95, s95, 131072
    s_add_u32 s39, s56, s62
    s_mov_b32 m0, s39
    s_add_u32 s62, s62, 4096
    s_and_b32 s62, s62, 0x7fff
    buffer_load_dwordx4 v10, s[52:55], s95 offen offset:0 nt lds
    buffer_load_dwordx4 v11, s[52:55], s95 offen offset:1024 nt lds
    buffer_load_dwordx4 v12, s[52:55], s95 offen offset:2048 nt lds
    buffer_load_dwordx4 v13, s[52:55], s95 offen offset:3072 nt lds
    s_add_u32 s95, s95, 131072
    s_add_u32 s39, s56, s62
    s_mov_b32 m0, s39
    s_add_u32 s62, s62, 4096
    s_and_b32 s62, s62, 0x7fff
    buffer_load_dwordx4 v10, s[52:55], s95 offen offset:0 nt lds
    buffer_load_dwordx4 v11, s[52:55], s95 offen offset:1024 nt lds
    buffer_load_dwordx4 v12, s[52:55], s95 offen offset:2048 nt lds
    buffer_load_dwordx4 v13, s[52:55], s95 offen offset:3072 nt lds
    s_add_u32 s95, s95, 131072
    s_waitcnt lgkmcnt(0)
    s_add_u32 s35, s35, 0x5b
    s_and_b32 s35, s35, 0xff
    v_mov_b32 v8, s35
    s_or_b32 s68, s35, 0x6b3ac500
    s_getreg_b32 s70, hwreg(HW_REG_XCC_ID, 0, 4)
    s_lshl_b32 s70, s70, 8
    s_or_b32 s70, s70, s35
    s_or_b32 s70, s70, 0x5e9d0000
    s_bfe_u32 s38, s2, 0x30000
    s_lshl_b32 s38, s38, 8
    s_add_u32 s69, s38, 32768
    s_lshl_b32 s38, s32, 2
    s_add_u32 s69, s38, s69
    s_lshl_b32 s38, s34, 24
    s_add_u32 s69, s38, s69
    v_mov_b32 v4, s69
    v_mov_b32 v5, s70
    s_mov_b64 exec, 1
    buffer_store_dword v5, v4, s[48:51], 0 offen sc1
    s_mov_b64 exec, -1
    s_mov_b32 s52, s6
    s_and_b32 s53, s7, 0xffff
    s_mov_b32 s54, 16777216
    s_mov_b32 s55, 0x20000
    s_bfe_u32 s38, s32, 0x30000
    s_lshl_b32 s38, s38, 1
    s_add_u32 s3, s38, 0
    s_lshr_b32 s38, s32, 4
    s_lshl_b32 s38, s38, 0
    s_add_u32 s3, s38, s3
    s_bfe_u32 s94, s32, 0x10003
    s_lshl_b32 s38, s3, 20
    s_add_u32 s95, s38, 0
    s_lshl_b32 s38, s34, 8
    s_add_u32 s95, s38, s95
    s_waitcnt vmcnt(25)
    ds_read_b64_tr_b16 a[128:129], v136 offset:0
    ds_read_b64_tr_b16 a[130:131], v137 offset:1024
    ds_read_b64_tr_b16 a[144:145], v138 offset:0
    ds_read_b64_tr_b16 a[146:147], v139 offset:1024
    ds_read_b64_tr_b16 a[160:161], v140 offset:0
    ds_read_b64_tr_b16 a[162:163], v141 offset:1024
    ds_read_b64_tr_b16 a[176:177], v142 offset:0
    ds_read_b64_tr_b16 a[178:179], v143 offset:1024
    ds_read_b64_tr_b16 a[192:193], v144 offset:0
    ds_read_b64_tr_b16 a[194:195], v145 offset:1024
    ds_read_b64_tr_b16 a[208:209], v146 offset:0
    ds_read_b64_tr_b16 a[210:211], v147 offset:1024
    ds_read_b64_tr_b16 a[224:225], v148 offset:0
    ds_read_b64_tr_b16 a[226:227], v149 offset:1024
    ds_read_b64_tr_b16 a[240:241], v150 offset:0
    ds_read_b64_tr_b16 a[242:243], v151 offset:1024
    s_waitcnt lgkmcnt(0)
    s_add_u32 s39, s56, s62
    s_mov_b32 m0, s39
    s_add_u32 s62, s62, 4096
    s_and_b32 s62, s62, 0x7fff
    buffer_load_dwordx4 v76, s[52:55], s95 offen offset:0 nt lds
    buffer_load_dwordx4 v77, s[52:55], s95 offen offset:1024 nt lds
    buffer_load_dwordx4 v78, s[52:55], s95 offen offset:2048 nt lds
    buffer_load_dwordx4 v79, s[52:55], s95 offen offset:3072 nt lds
    s_add_u32 s95, s95, 16384
    s_add_u32 s39, s56, s62
    s_mov_b32 m0, s39
    s_add_u32 s62, s62, 4096
    s_and_b32 s62, s62, 0x7fff
    buffer_load_dwordx4 v76, s[52:55], s95 offen offset:0 nt lds
    buffer_load_dwordx4 v77, s[52:55], s95 offen offset:1024 nt lds
    buffer_load_dwordx4 v78, s[52:55], s95 offen offset:2048 nt lds
    buffer_load_dwordx4 v79, s[52:55], s95 offen offset:3072 nt lds
    s_add_u32 s95, s95, 16384
    s_waitcnt vmcnt(25)
    ds_read_b64_tr_b16 a[132:133], v136 offset:8192
    ds_read_b64_tr_b16 a[134:135], v137 offset:9216
    ds_read_b64_tr_b16 a[148:149], v138 offset:8192
    ds_read_b64_tr_b16 a[150:151], v139 offset:9216
    ds_read_b64_tr_b16 a[164:165], v140 offset:8192
    ds_read_b64_tr_b16 a[166:167], v141 offset:9216
    ds_read_b64_tr_b16 a[180:181], v142 offset:8192
    ds_read_b64_tr_b16 a[182:183], v143 offset:9216
    ds_read_b64_tr_b16 a[196:197], v144 offset:8192
    ds_read_b64_tr_b16 a[198:199], v145 offset:9216
    ds_read_b64_tr_b16 a[212:213], v146 offset:8192
    ds_read_b64_tr_b16 a[214:215], v147 offset:9216
    ds_read_b64_tr_b16 a[228:229], v148 offset:8192
    ds_read_b64_tr_b16 a[230:231], v149 offset:9216
    ds_read_b64_tr_b16 a[244:245], v150 offset:8192
    ds_read_b64_tr_b16 a[246:247], v151 offset:9216
    s_waitcnt lgkmcnt(0)
    s_add_u32 s39, s56, s62
    s_mov_b32 m0, s39
    s_add_u32 s62, s62, 4096
    s_and_b32 s62, s62, 0x7fff
    buffer_load_dwordx4 v76, s[52:55], s95 offen offset:0 nt lds
    buffer_load_dwordx4 v77, s[52:55], s95 offen offset:1024 nt lds
    buffer_load_dwordx4 v78, s[52:55], s95 offen offset:2048 nt lds
    buffer_load_dwordx4 v79, s[52:55], s95 offen offset:3072 nt lds
    s_add_u32 s95, s95, 16384
    s_add_u32 s39, s56, s62
    s_mov_b32 m0, s39
    s_add_u32 s62, s62, 4096
    s_and_b32 s62, s62, 0x7fff
    buffer_load_dwordx4 v76, s[52:55], s95 offen offset:0 nt lds
    buffer_load_dwordx4 v77, s[52:55], s95 offen offset:1024 nt lds
    buffer_load_dwordx4 v78, s[52:55], s95 offen offset:2048 nt lds
    buffer_load_dwordx4 v79, s[52:55], s95 offen offset:3072 nt lds
    s_add_u32 s95, s95, 16384
    s_waitcnt vmcnt(25)
    ds_read_b64_tr_b16 a[136:137], v136 offset:16384
    ds_read_b64_tr_b16 a[138:139], v137 offset:17408
    ds_read_b64_tr_b16 a[152:153], v138 offset:16384
    ds_read_b64_tr_b16 a[154:155], v139 offset:17408
    ds_read_b64_tr_b16 a[168:169], v140 offset:16384
    ds_read_b64_tr_b16 a[170:171], v141 offset:17408
    ds_read_b64_tr_b16 a[184:185], v142 offset:16384
    ds_read_b64_tr_b16 a[186:187], v143 offset:17408
    ds_read_b64_tr_b16 a[200:201], v144 offset:16384
    ds_read_b64_tr_b16 a[202:203], v145 offset:17408
    ds_read_b64_tr_b16 a[216:217], v146 offset:16384
    ds_read_b64_tr_b16 a[218:219], v147 offset:17408
    ds_read_b64_tr_b16 a[232:233], v148 offset:16384
    ds_read_b64_tr_b16 a[234:235], v149 offset:17408
    ds_read_b64_tr_b16 a[248:249], v150 offset:16384
    ds_read_b64_tr_b16 a[250:251], v151 offset:17408
    s_waitcnt lgkmcnt(0)
    s_add_u32 s39, s56, s62
    s_mov_b32 m0, s39
    s_add_u32 s62, s62, 4096
    s_and_b32 s62, s62, 0x7fff
    buffer_load_dwordx4 v76, s[52:55], s95 offen offset:0 nt lds
    buffer_load_dwordx4 v77, s[52:55], s95 offen offset:1024 nt lds
    buffer_load_dwordx4 v78, s[52:55], s95 offen offset:2048 nt lds
    buffer_load_dwordx4 v79, s[52:55], s95 offen offset:3072 nt lds
    s_add_u32 s95, s95, 16384
    s_add_u32 s39, s56, s62
    s_mov_b32 m0, s39
    s_add_u32 s62, s62, 4096
    s_and_b32 s62, s62, 0x7fff
    buffer_load_dwordx4 v76, s[52:55], s95 offen offset:0 nt lds
    buffer_load_dwordx4 v77, s[52:55], s95 offen offset:1024 nt lds
    buffer_load_dwordx4 v78, s[52:55], s95 offen offset:2048 nt lds
    buffer_load_dwordx4 v79, s[52:55], s95 offen offset:3072 nt lds
    s_add_u32 s95, s95, 16384
    s_waitcnt vmcnt(25)
    ds_read_b64_tr_b16 a[140:141], v136 offset:24576
    ds_read_b64_tr_b16 a[142:143], v137 offset:25600
    ds_read_b64_tr_b16 a[156:157], v138 offset:24576
    ds_read_b64_tr_b16 a[158:159], v139 offset:25600
    ds_read_b64_tr_b16 a[172:173], v140 offset:24576
    ds_read_b64_tr_b16 a[174:175], v141 offset:25600
    ds_read_b64_tr_b16 a[188:189], v142 offset:24576
    ds_read_b64_tr_b16 a[190:191], v143 offset:25600
    ds_read_b64_tr_b16 a[204:205], v144 offset:24576
    ds_read_b64_tr_b16 a[206:207], v145 offset:25600
    ds_read_b64_tr_b16 a[220:221], v146 offset:24576
    ds_read_b64_tr_b16 a[222:223], v147 offset:25600
    ds_read_b64_tr_b16 a[236:237], v148 offset:24576
    ds_read_b64_tr_b16 a[238:239], v149 offset:25600
    ds_read_b64_tr_b16 a[252:253], v150 offset:24576
    ds_read_b64_tr_b16 a[254:255], v151 offset:25600
    s_waitcnt lgkmcnt(0)
    s_add_u32 s39, s56, s62
    s_mov_b32 m0, s39
    s_add_u32 s62, s62, 4096
    s_and_b32 s62, s62, 0x7fff
    buffer_load_dwordx4 v76, s[52:55], s95 offen offset:0 nt lds
    buffer_load_dwordx4 v77, s[52:55], s95 offen offset:1024 nt lds
    s_mov_b32 s86, 98304
    buffer_load_dword v7, v101, s[48:51], s86 offen sc1
    v_mov_b32 v104, 0
    v_mov_b32 v105, 0
    v_mov_b32 v106, 0
    v_mov_b32 v107, 0
    v_mov_b32 v108, 0
    v_mov_b32 v109, 0
    v_mov_b32 v110, 0
    v_mov_b32 v111, 0
    v_mov_b32 v112, 0
    v_mov_b32 v113, 0
    v_mov_b32 v114, 0
    v_mov_b32 v115, 0
    v_mov_b32 v116, 0
    v_mov_b32 v117, 0
    v_mov_b32 v118, 0
    v_mov_b32 v119, 0
    v_mov_b32 v120, 0
    v_mov_b32 v121, 0
    v_mov_b32 v122, 0
    v_mov_b32 v123, 0
    v_mov_b32 v124, 0
    v_mov_b32 v125, 0
    v_mov_b32 v126, 0
    v_mov_b32 v127, 0
    v_mov_b32 v128, 0
    v_mov_b32 v129, 0
    v_mov_b32 v130, 0
    v_mov_b32 v131, 0
    v_mov_b32 v132, 0
    v_mov_b32 v133, 0
    v_mov_b32 v134, 0
    v_mov_b32 v135, 0
    v_mov_b32 v90, 0xff7f0000
    s_mov_b32 s93, 0
    v_mov_b32 v102, 0
    v_mov_b32 v103, 0
    s_mov_b32 s60, s83
    s_mov_b32 s61, s83
    v_xor_b32 v5, v3, v2
    v_lshlrev_b32 v6, 8, v3
    v_bfe_u32 v4, v5, 0, 2
    v_lshl_add_u32 v6, v4, 6, v6
    v_lshrrev_b32 v4, 2, v3
    v_lshl_add_u32 v6, v4, 4, v6
    v_add_u32 v52, s85, v6
    v_xor_b32 v53, 16, v52
    v_xor_b32 v54, 32, v52
    v_xor_b32 v55, 48, v52
    s_lshr_b32 s38, s3, 2
    s_lshl_b32 s38, s38, 15
    s_add_u32 s36, s38, 393216
    s_lshl_b32 s38, s94, 14
    s_add_u32 s36, s38, s36
    s_lshl_b32 s38, s34, 8
    s_add_u32 s36, s38, s36
    s_waitcnt vmcnt(0)
L_fcheck_45:
    v_cmp_ne_u32 vcc, s68, v7
    s_cbranch_vccz L_fok_46
    s_sleep 2
    s_mov_b32 s86, 98304
    buffer_load_dword v7, v101, s[48:51], s86 offen sc1
    s_waitcnt vmcnt(0)
    s_sub_u32 s84, s84, 1
    s_cmp_lg_u32 s84, 0
    s_cbranch_scc1 L_fcheck_45
    s_branch L_end
L_fok_46:
    buffer_load_dwordx4 v[200:203], v9, s[48:51], s36 offen sc1
    s_add_u32 s36, s36, 4096
    buffer_load_dwordx4 v[204:207], v9, s[48:51], s36 offen sc1
    s_add_u32 s36, s36, 4096
    buffer_load_dwordx4 v[208:211], v9, s[48:51], s36 offen sc1
    s_add_u32 s36, s36, 4096
    buffer_load_dwordx4 v[212:215], v9, s[48:51], s36 offen sc1
    ds_read_b128 v[136:139], v60 offset:0
    ds_read_b128 v[140:143], v61 offset:0
    ds_read_b128 v[144:147], v62 offset:0
    ds_read_b128 v[148:151], v63 offset:0
    ds_read_b128 v[152:155], v60 offset:4096
    ds_read_b128 v[156:159], v61 offset:4096
    ds_read_b128 v[160:163], v62 offset:4096
    ds_read_b128 v[164:167], v63 offset:4096
    ds_read_b128 v[168:171], v60 offset:8192
    ds_read_b128 v[172:175], v61 offset:8192
    ds_read_b128 v[176:179], v62 offset:8192
    ds_read_b128 v[180:183], v63 offset:8192
    ds_read_b128 v[184:187], v60 offset:12288
    ds_read_b128 v[188:191], v61 offset:12288
    ds_read_b128 v[192:195], v62 offset:12288
    ds_read_b128 v[196:199], v63 offset:12288
    s_waitcnt vmcnt(3)
    ds_write_b128 v96, v[200:203] offset:0
    s_waitcnt vmcnt(2)
    ds_write_b128 v97, v[204:207] offset:1024
    s_waitcnt vmcnt(1)
    ds_write_b128 v98, v[208:211] offset:2048
    s_waitcnt vmcnt(0)
    ds_write_b128 v99, v[212:215] offset:3072
    s_waitcnt lgkmcnt(0)
    ds_read_b128 v[36:39], v52
    ds_read_b128 v[40:43], v53
    ds_read_b128 v[44:47], v54
    ds_read_b128 v[48:51], v55
L_att:
    s_waitcnt lgkmcnt(0)
    v_mfma_f32_16x16x32_bf16 v[200:203], v[136:139], v[36:39], 0
    ds_read_b64_tr_b16 a[0:1], v82 offset:0
    ds_read_b64_tr_b16 a[2:3], v82 offset:4096
    buffer_load_dwordx4 v78, s[52:55], s95 offen offset:2048 nt lds
    v_mfma_f32_16x16x32_bf16 v[200:203], v[140:143], v[40:43], v[200:203]
    ds_read_b64_tr_b16 a[4:5], v83 offset:0
    ds_read_b64_tr_b16 a[6:7], v83 offset:4096
    v_mfma_f32_16x16x32_bf16 v[200:203], v[144:147], v[44:47], v[200:203]
    ds_read_b64_tr_b16 a[8:9], v84 offset:0
    ds_read_b64_tr_b16 a[10:11], v84 offset:4096
    v_mfma_f32_16x16x32_bf16 v[200:203], v[148:151], v[48:51], v[200:203]
    ds_read_b64_tr_b16 a[12:13], v85 offset:0
    ds_read_b64_tr_b16 a[14:15], v85 offset:4096
    buffer_load_dwordx4 v79, s[52:55], s95 offen offset:3072 nt lds
    s_add_u32 s95, s95, 16384
    v_mfma_f32_16x16x32_bf16 v[204:207], v[152:155], v[36:39], 0
    ds_read_b64_tr_b16 a[16:17], v86 offset:0
    ds_read_b64_tr_b16 a[18:19], v86 offset:4096
    v_mfma_f32_16x16x32_bf16 v[204:207], v[156:159], v[40:43], v[204:207]
    ds_read_b64_tr_b16 a[20:21], v87 offset:0
    ds_read_b64_tr_b16 a[22:23], v87 offset:4096
    v_mfma_f32_16x16x32_bf16 v[204:207], v[160:163], v[44:47], v[204:207]
    ds_read_b64_tr_b16 a[24:25], v88 offset:0
    ds_read_b64_tr_b16 a[26:27], v88 offset:4096
    s_add_u32 s39, s56, s62
    s_mov_b32 m0, s39
    s_add_u32 s62, s62, 4096
    s_and_b32 s62, s62, 0x7fff
    buffer_load_dwordx4 v76, s[52:55], s95 offen offset:0 nt lds
    v_mfma_f32_16x16x32_bf16 v[204:207], v[164:167], v[48:51], v[204:207]
    ds_read_b64_tr_b16 a[28:29], v89 offset:0
    ds_read_b64_tr_b16 a[30:31], v89 offset:4096
    ds_write_b128 v94, v[200:203] offset:0
    v_mfma_f32_16x16x32_bf16 v[208:211], v[168:171], v[36:39], 0
    ds_read_b64_tr_b16 a[32:33], v82 offset:8192
    ds_read_b64_tr_b16 a[34:35], v82 offset:12288
    v_mfma_f32_16x16x32_bf16 v[208:211], v[172:175], v[40:43], v[208:211]
    ds_read_b64_tr_b16 a[36:37], v83 offset:8192
    ds_read_b64_tr_b16 a[38:39], v83 offset:12288
    buffer_load_dwordx4 v77, s[52:55], s95 offen offset:1024 nt lds
    v_mfma_f32_16x16x32_bf16 v[208:211], v[176:179], v[44:47], v[208:211]
    ds_read_b64_tr_b16 a[40:41], v84 offset:8192
    ds_read_b64_tr_b16 a[42:43], v84 offset:12288
    v_mfma_f32_16x16x32_bf16 v[208:211], v[180:183], v[48:51], v[208:211]
    ds_read_b64_tr_b16 a[44:45], v85 offset:8192
    ds_read_b64_tr_b16 a[46:47], v85 offset:12288
    ds_write_b128 v94, v[204:207] offset:1024
    v_mfma_f32_16x16x32_bf16 v[212:215], v[184:187], v[36:39], 0
    ds_read_b64_tr_b16 a[48:49], v86 offset:8192
    ds_read_b64_tr_b16 a[50:51], v86 offset:12288
    buffer_load_dwordx4 v78, s[52:55], s95 offen offset:2048 nt lds
    v_mfma_f32_16x16x32_bf16 v[212:215], v[188:191], v[40:43], v[212:215]
    ds_read_b64_tr_b16 a[52:53], v87 offset:8192
    ds_read_b64_tr_b16 a[54:55], v87 offset:12288
    v_mfma_f32_16x16x32_bf16 v[212:215], v[192:195], v[44:47], v[212:215]
    ds_read_b64_tr_b16 a[56:57], v88 offset:8192
    ds_read_b64_tr_b16 a[58:59], v88 offset:12288
    v_mfma_f32_16x16x32_bf16 v[212:215], v[196:199], v[48:51], v[212:215]
    ds_read_b64_tr_b16 a[60:61], v89 offset:8192
    ds_read_b64_tr_b16 a[62:63], v89 offset:12288
    buffer_load_dwordx4 v79, s[52:55], s95 offen offset:3072 nt lds
    s_add_u32 s95, s95, 16384
    ds_write_b128 v94, v[208:211] offset:2048
    v_xor_b32 v5, 0x2000, v94
    v_xor_b32 v6, 0x4000, v94
    v_xor_b32 v7, 0x6000, v94
    s_cmp_eq_u32 s93, 14
    s_cselect_b32 s95, 16777216, s95
    ds_write_b128 v94, v[212:215] offset:3072
    v_xor_b32 v82, 0x4000, v82
    v_xor_b32 v83, 0x4000, v83
    v_xor_b32 v84, 0x4000, v84
    v_xor_b32 v85, 0x4000, v85
    v_xor_b32 v86, 0x4000, v86
    v_xor_b32 v87, 0x4000, v87
    v_xor_b32 v88, 0x4000, v88
    v_xor_b32 v89, 0x4000, v89
    v_xor_b32 v60, 0x4000, v60
    v_xor_b32 v61, 0x4000, v61
    v_xor_b32 v62, 0x4000, v62
    v_xor_b32 v63, 0x4000, v63
    s_waitcnt lgkmcnt(0)
    s_barrier
    ds_read_b128 v[136:139], v5 offset:0
    ds_read_b128 v[152:155], v6 offset:0
    ds_read_b128 v[168:171], v7 offset:0
    ds_read_b128 v[140:143], v5 offset:1024
    ds_read_b128 v[156:159], v6 offset:1024
    ds_read_b128 v[172:175], v7 offset:1024
    ds_read_b128 v[144:147], v5 offset:2048
    ds_read_b128 v[160:163], v6 offset:2048
    ds_read_b128 v[176:179], v7 offset:2048
    ds_read_b128 v[148:151], v5 offset:3072
    ds_read_b128 v[164:167], v6 offset:3072
    ds_read_b128 v[180:183], v7 offset:3072
    v_xor_b32 v94, 0x1000, v94
    s_add_u32 s39, s56, s62
    s_mov_b32 m0, s39
    s_add_u32 s62, s62, 4096
    s_and_b32 s62, s62, 0x7fff
    buffer_load_dwordx4 v76, s[52:55], s95 offen offset:0 nt lds
    buffer_load_dwordx4 v77, s[52:55], s95 offen offset:1024 nt lds
    buffer_load_dwordx4 v78, s[52:55], s95 offen offset:2048 nt lds
    s_waitcnt lgkmcnt(9)
    v_pk_add_f32 v[200:201], v[200:201], v[136:137]
    v_pk_add_f32 v[152:153], v[152:153], v[168:169]
    v_pk_add_f32 v[202:203], v[202:203], v[138:139]
    v_pk_add_f32 v[154:155], v[154:155], v[170:171]
    v_pk_add_f32 v[200:201], v[200:201], v[152:153]
    v_pk_add_f32 v[202:203], v[202:203], v[154:155]
    s_waitcnt lgkmcnt(6)
    v_pk_add_f32 v[204:205], v[204:205], v[140:141]
    v_pk_add_f32 v[156:157], v[156:157], v[172:173]
    v_pk_add_f32 v[206:207], v[206:207], v[142:143]
    v_pk_add_f32 v[158:159], v[158:159], v[174:175]
    v_pk_add_f32 v[204:205], v[204:205], v[156:157]
    v_pk_add_f32 v[206:207], v[206:207], v[158:159]
    s_waitcnt lgkmcnt(3)
    v_pk_add_f32 v[208:209], v[208:209], v[144:145]
    v_pk_add_f32 v[160:161], v[160:161], v[176:177]
    v_pk_add_f32 v[210:211], v[210:211], v[146:147]
    v_pk_add_f32 v[162:163], v[162:163], v[178:179]
    v_pk_add_f32 v[208:209], v[208:209], v[160:161]
    v_pk_add_f32 v[210:211], v[210:211], v[162:163]
    s_waitcnt lgkmcnt(0)
    v_pk_add_f32 v[212:213], v[212:213], v[148:149]
    v_pk_add_f32 v[164:165], v[164:165], v[180:181]
    v_pk_add_f32 v[214:215], v[214:215], v[150:151]
    v_pk_add_f32 v[166:167], v[166:167], v[182:183]
    v_pk_add_f32 v[212:213], v[212:213], v[164:165]
    v_pk_add_f32 v[214:215], v[214:215], v[166:167]
    buffer_load_dwordx4 v79, s[52:55], s95 offen offset:3072 nt lds
    s_add_u32 s95, s95, 16384
    s_waitcnt vmcnt(4)
    v_max_f32 v4, v200, v201
    v_max3_f32 v4, v4, v202, v203
    v_max3_f32 v4, v4, v204, v205
    v_max3_f32 v4, v4, v206, v207
    v_max3_f32 v4, v4, v208, v209
    v_max3_f32 v4, v4, v210, v211
    v_max3_f32 v4, v4, v212, v213
    v_max3_f32 v4, v4, v214, v215
    v_mov_b32 v5, v4
    ds_read_b128 v[136:139], v60 offset:0
    ds_read_b128 v[140:143], v61 offset:0
    v_permlane16_swap_b32 v4, v5
    v_max_f32 v4, v4, v5
    v_mov_b32 v5, v4
    ds_read_b128 v[144:147], v62 offset:0
    ds_read_b128 v[148:151], v63 offset:0
    v_permlane32_swap_b32 v4, v5
    v_max_f32 v4, v4, v5
    v_mul_f32 v4, s83, v4
    v_max_f32 v4, v4, v90
    v_sub_f32 v92, v90, v4
    v_exp_f32 v92, v92
    v_mov_b32 v90, v4
    s_add_u32 s39, s56, s62
    s_mov_b32 m0, s39
    s_add_u32 s62, s62, 4096
    s_and_b32 s62, s62, 0x7fff
    buffer_load_dwordx4 v76, s[52:55], s95 offen offset:0 nt lds
    v_pk_fma_f32 v[200:201], v[200:201], s[60:61], v[90:91] op_sel_hi:[1,1,0] neg_lo:[0,0,1] neg_hi:[0,0,1]
    v_pk_fma_f32 v[202:203], v[202:203], s[60:61], v[90:91] op_sel_hi:[1,1,0] neg_lo:[0,0,1] neg_hi:[0,0,1]
    v_pk_fma_f32 v[204:205], v[204:205], s[60:61], v[90:91] op_sel_hi:[1,1,0] neg_lo:[0,0,1] neg_hi:[0,0,1]
    v_pk_fma_f32 v[206:207], v[206:207], s[60:61], v[90:91] op_sel_hi:[1,1,0] neg_lo:[0,0,1] neg_hi:[0,0,1]
    v_pk_fma_f32 v[208:209], v[208:209], s[60:61], v[90:91] op_sel_hi:[1,1,0] neg_lo:[0,0,1] neg_hi:[0,0,1]
    v_pk_fma_f32 v[210:211], v[210:211], s[60:61], v[90:91] op_sel_hi:[1,1,0] neg_lo:[0,0,1] neg_hi:[0,0,1]
    v_pk_fma_f32 v[212:213], v[212:213], s[60:61], v[90:91] op_sel_hi:[1,1,0] neg_lo:[0,0,1] neg_hi:[0,0,1]
    v_pk_fma_f32 v[214:215], v[214:215], s[60:61], v[90:91] op_sel_hi:[1,1,0] neg_lo:[0,0,1] neg_hi:[0,0,1]
    v_exp_f32 v200, v200
    v_exp_f32 v201, v201
    ds_read_b128 v[152:155], v60 offset:4096
    v_exp_f32 v202, v202
    v_exp_f32 v203, v203
    v_exp_f32 v204, v204
    v_exp_f32 v205, v205
    ds_read_b128 v[156:159], v61 offset:4096
    v_exp_f32 v206, v206
    v_exp_f32 v207, v207
    buffer_load_dwordx4 v77, s[52:55], s95 offen offset:1024 nt lds
    v_exp_f32 v208, v208
    v_exp_f32 v209, v209
    ds_read_b128 v[160:163], v62 offset:4096
    v_exp_f32 v210, v210
    v_exp_f32 v211, v211
    v_exp_f32 v212, v212
    v_exp_f32 v213, v213
    ds_read_b128 v[164:167], v63 offset:4096
    v_exp_f32 v214, v214
    v_exp_f32 v215, v215
    buffer_load_dwordx4 v78, s[52:55], s95 offen offset:2048 nt lds
    v_pk_mul_f32 v[102:103], v[102:103], v[92:93] op_sel_hi:[1,0]
    v_pk_mul_f32 v[104:105], v[104:105], v[92:93] op_sel_hi:[1,0]
    v_pk_mul_f32 v[106:107], v[106:107], v[92:93] op_sel_hi:[1,0]
    v_pk_mul_f32 v[108:109], v[108:109], v[92:93] op_sel_hi:[1,0]
    v_pk_mul_f32 v[110:111], v[110:111], v[92:93] op_sel_hi:[1,0]
    v_pk_mul_f32 v[112:113], v[112:113], v[92:93] op_sel_hi:[1,0]
    v_pk_mul_f32 v[114:115], v[114:115], v[92:93] op_sel_hi:[1,0]
    v_pk_mul_f32 v[116:117], v[116:117], v[92:93] op_sel_hi:[1,0]
    v_pk_mul_f32 v[118:119], v[118:119], v[92:93] op_sel_hi:[1,0]
    v_pk_mul_f32 v[120:121], v[120:121], v[92:93] op_sel_hi:[1,0]
    v_pk_mul_f32 v[122:123], v[122:123], v[92:93] op_sel_hi:[1,0]
    v_pk_mul_f32 v[124:125], v[124:125], v[92:93] op_sel_hi:[1,0]
    v_pk_mul_f32 v[126:127], v[126:127], v[92:93] op_sel_hi:[1,0]
    v_pk_mul_f32 v[128:129], v[128:129], v[92:93] op_sel_hi:[1,0]
    v_pk_mul_f32 v[130:131], v[130:131], v[92:93] op_sel_hi:[1,0]
    v_pk_mul_f32 v[132:133], v[132:133], v[92:93] op_sel_hi:[1,0]
    v_pk_mul_f32 v[134:135], v[134:135], v[92:93] op_sel_hi:[1,0]
    buffer_load_dwordx4 v79, s[52:55], s95 offen offset:3072 nt lds
    s_add_u32 s95, s95, 16384
    v_cvt_pk_bf16_f32 v52, v200, v201
    v_pk_add_f32 v[102:103], v[102:103], v[200:201]
    v_cvt_pk_bf16_f32 v53, v202, v203
    v_pk_add_f32 v[102:103], v[102:103], v[202:203]
    v_cvt_pk_bf16_f32 v54, v204, v205
    v_pk_add_f32 v[102:103], v[102:103], v[204:205]
    v_cvt_pk_bf16_f32 v55, v206, v207
    v_pk_add_f32 v[102:103], v[102:103], v[206:207]
    v_cvt_pk_bf16_f32 v56, v208, v209
    v_pk_add_f32 v[102:103], v[102:103], v[208:209]
    v_cvt_pk_bf16_f32 v57, v210, v211
    v_pk_add_f32 v[102:103], v[102:103], v[210:211]
    v_cvt_pk_bf16_f32 v58, v212, v213
    v_pk_add_f32 v[102:103], v[102:103], v[212:213]
    v_cvt_pk_bf16_f32 v59, v214, v215
    v_pk_add_f32 v[102:103], v[102:103], v[214:215]
    v_mfma_f32_16x16x32_bf16 v[104:107], a[0:3], v[52:55], v[104:107]
    ds_read_b128 v[168:171], v60 offset:8192
    v_mfma_f32_16x16x32_bf16 v[108:111], a[4:7], v[52:55], v[108:111]
    ds_read_b128 v[172:175], v61 offset:8192
    v_mfma_f32_16x16x32_bf16 v[112:115], a[8:11], v[52:55], v[112:115]
    ds_read_b128 v[176:179], v62 offset:8192
    v_mfma_f32_16x16x32_bf16 v[116:119], a[12:15], v[52:55], v[116:119]
    ds_read_b128 v[180:183], v63 offset:8192
    v_mfma_f32_16x16x32_bf16 v[120:123], a[16:19], v[52:55], v[120:123]
    ds_read_b128 v[184:187], v60 offset:12288
    v_mfma_f32_16x16x32_bf16 v[124:127], a[20:23], v[52:55], v[124:127]
    ds_read_b128 v[188:191], v61 offset:12288
    v_mfma_f32_16x16x32_bf16 v[128:131], a[24:27], v[52:55], v[128:131]
    ds_read_b128 v[192:195], v62 offset:12288
    v_mfma_f32_16x16x32_bf16 v[132:135], a[28:31], v[52:55], v[132:135]
    ds_read_b128 v[196:199], v63 offset:12288
    v_mfma_f32_16x16x32_bf16 v[104:107], a[32:35], v[56:59], v[104:107]
    v_mfma_f32_16x16x32_bf16 v[108:111], a[36:39], v[56:59], v[108:111]
    s_add_u32 s39, s56, s62
    s_mov_b32 m0, s39
    s_add_u32 s62, s62, 4096
    s_and_b32 s62, s62, 0x7fff
    buffer_load_dwordx4 v76, s[52:55], s95 offen offset:0 nt lds
    v_mfma_f32_16x16x32_bf16 v[112:115], a[40:43], v[56:59], v[112:115]
    v_mfma_f32_16x16x32_bf16 v[116:119], a[44:47], v[56:59], v[116:119]
    v_mfma_f32_16x16x32_bf16 v[120:123], a[48:51], v[56:59], v[120:123]
    v_mfma_f32_16x16x32_bf16 v[124:127], a[52:55], v[56:59], v[124:127]
    buffer_load_dwordx4 v77, s[52:55], s95 offen offset:1024 nt lds
    v_mfma_f32_16x16x32_bf16 v[128:131], a[56:59], v[56:59], v[128:131]
    v_mfma_f32_16x16x32_bf16 v[132:135], a[60:63], v[56:59], v[132:135]
    s_add_u32 s93, s93, 1
    s_cmp_lt_u32 s93, 16
    s_cbranch_scc1 L_att
    v_add_f32 v91, v102, v103
    v_mov_b32 v5, v91
    s_nop 1
    v_permlane16_swap_b32 v91, v5
    v_add_f32 v91, v91, v5
    v_mov_b32 v5, v91
    s_nop 1
    v_permlane32_swap_b32 v91, v5
    v_add_f32 v91, v91, v5
    v_lshrrev_b32 v6, 1, v2
    v_xor_b32 v6, v6, v3
    v_lshlrev_b32 v5, 8, v3
    v_lshl_add_u32 v5, v6, 4, v5
    v_bfe_u32 v4, v2, 0, 1
    v_lshl_add_u32 v5, v4, 3, v5
    v_add_u32 v5, s85, v5
    s_waitcnt vmcnt(0) lgkmcnt(0)
    s_barrier
    v_cvt_pk_bf16_f32 v216, v104, v105
    v_cvt_pk_bf16_f32 v217, v106, v107
    v_xor_b32 v82, 0, v5
    ds_write_b64 v82, v[216:217]
    v_cvt_pk_bf16_f32 v218, v108, v109
    v_cvt_pk_bf16_f32 v219, v110, v111
    v_xor_b32 v83, 32, v5
    ds_write_b64 v83, v[218:219]
    v_cvt_pk_bf16_f32 v220, v112, v113
    v_cvt_pk_bf16_f32 v221, v114, v115
    v_xor_b32 v84, 64, v5
    ds_write_b64 v84, v[220:221]
    v_cvt_pk_bf16_f32 v222, v116, v117
    v_cvt_pk_bf16_f32 v223, v118, v119
    v_xor_b32 v85, 96, v5
    ds_write_b64 v85, v[222:223]
    v_cvt_pk_bf16_f32 v224, v120, v121
    v_cvt_pk_bf16_f32 v225, v122, v123
    v_xor_b32 v86, 128, v5
    ds_write_b64 v86, v[224:225]
    v_cvt_pk_bf16_f32 v226, v124, v125
    v_cvt_pk_bf16_f32 v227, v126, v127
    v_xor_b32 v87, 160, v5
    ds_write_b64 v87, v[226:227]
    v_cvt_pk_bf16_f32 v228, v128, v129
    v_cvt_pk_bf16_f32 v229, v130, v131
    v_xor_b32 v88, 192, v5
    ds_write_b64 v88, v[228:229]
    v_cvt_pk_bf16_f32 v230, v132, v133
    v_cvt_pk_bf16_f32 v231, v134, v135
    v_xor_b32 v89, 224, v5
    ds_write_b64 v89, v[230:231]
    v_xor_b32 v6, v3, v2
    v_lshlrev_b32 v6, 4, v6
    v_lshl_add_u32 v4, v2, 8, v6
    v_add_u32 v4, s85, v4
    v_xor_b32 v60, 0, v4
    v_xor_b32 v61, 64, v4
    v_xor_b32 v62, 128, v4
    v_xor_b32 v63, 192, v4
    v_lshlrev_b32 v7, 4, v3
    v_lshl_add_u32 v7, v2, 14, v7
    s_lshl_b32 s38, s94, 18
    s_add_u32 s36, s38, 2097152
    s_lshl_b32 s38, s3, 10
    s_add_u32 s36, s38, s36
    s_lshl_b32 s38, s34, 8
    s_add_u32 s36, s38, s36
    s_waitcnt lgkmcnt(0)
    ds_read_b128 v[200:203], v60 offset:0
    ds_read_b128 v[204:207], v61 offset:1024
    ds_read_b128 v[208:211], v62 offset:2048
    ds_read_b128 v[212:215], v63 offset:3072
    v_lshlrev_b32 v4, 3, v3
    s_lshl_b32 s38, s3, 8
    s_add_u32 s37, s38, 163840
    s_lshl_b32 s38, s94, 7
    s_add_u32 s37, s38, s37
    s_lshl_b32 s38, s34, 23
    s_add_u32 s37, s38, s37
    s_mov_b32 exec_lo, 0xffff
    s_mov_b32 exec_hi, 0x0
    buffer_store_dwordx2 v[90:91], v4, s[48:51], s37 offen sc1
    s_mov_b64 exec, -1
    s_waitcnt lgkmcnt(3)
    buffer_store_dwordx4 v[200:203], v7, s[48:51], s36 offen sc1
    s_add_u32 s36, s36, 65536
    s_waitcnt lgkmcnt(2)
    buffer_store_dwordx4 v[204:207], v7, s[48:51], s36 offen sc1
    s_add_u32 s36, s36, 65536
    s_waitcnt lgkmcnt(1)
    buffer_store_dwordx4 v[208:211], v7, s[48:51], s36 offen sc1
    s_add_u32 s36, s36, 65536
    s_waitcnt lgkmcnt(0)
    buffer_store_dwordx4 v[212:215], v7, s[48:51], s36 offen sc1
    s_bfe_u32 s38, s2, 0x20001
    s_lshl_b32 s38, s38, 0
    s_add_u32 s90, s38, 0
    s_bfe_u32 s38, s2, 0x10000
    s_lshl_b32 s38, s38, 2
    s_add_u32 s90, s38, s90
    s_and_b32 s36, s90, 3
    s_bitcmp0_b32 s90, 2
    s_cselect_b64 s[40:41], s[24:25], s[14:15]
    s_cselect_b32 s45, 262144, 0
    s_add_u32 s45, s45, 524288
    s_lshl_b32 s38, s36, 16
    s_add_u32 s71, s38, s45
    s_lshr_b32 s38, s32, 2
    s_lshl_b32 s38, s38, 13
    s_add_u32 s71, s38, s71
    s_bfe_u32 s38, s32, 0x20000
    s_lshl_b32 s38, s38, 6
    s_add_u32 s71, s38, s71
    s_mov_b32 s42, 4194304
    s_mov_b32 s43, 0x20000
    s_lshl_b32 s38, s32, 17
    s_add_u32 s44, s38, 0
    s_lshl_b32 s38, s34, 15
    s_add_u32 s44, s38, s44
    s_lshl_b32 s38, s36, 8
    s_add_u32 s44, s38, s44
    s_lshl_b32 s38, s36, 16
    s_add_u32 s45, s38, s45
    s_lshr_b32 s38, s34, 1
    s_lshl_b32 s38, s38, 15
    s_add_u32 s45, s38, s45
    s_lshl_b32 s38, s32, 8
    s_add_u32 s45, s38, s45
    s_bfe_u32 s38, s34, 0x10000
    s_lshl_b32 s38, s38, 7
    s_add_u32 s45, s38, s45
    s_lshl_b32 s38, s32, 11
    s_add_u32 s46, s38, 196608
    s_lshl_b32 s38, s34, 9
    s_add_u32 s46, s38, s46
    s_mov_b32 s72, s26
    s_and_b32 s73, s27, 0xffff
    s_mov_b32 s74, 8192
    s_mov_b32 s75, 0x20000
    v_lshlrev_b32 v30, 4, v3
    v_lshl_add_u32 v30, v2, 13, v30
    v_lshrrev_b32 v5, 2, v1
    v_lshlrev_b32 v32, 8, v5
    v_bfe_u32 v5, v1, 0, 2
    v_lshl_add_u32 v32, v5, 4, v32
    s_xor_b32 s37, s90, 4
    s_bfe_u32 s38, s37, 0x30000
    s_lshl_b32 s38, s38, 8
    s_add_u32 s36, s38, 0
    s_lshr_b32 s38, s32, 4
    s_lshl_b32 s38, s38, 7
    s_add_u32 s36, s38, s36
    s_bfe_u32 s38, s32, 0x20000
    s_lshl_b32 s38, s38, 5
    s_add_u32 s36, s38, s36
    s_bfe_u32 s38, s32, 0x20002
    s_lshl_b32 s38, s38, 3
    s_add_u32 s36, s38, s36
    v_bfe_u32 v5, v1, 0, 2
    v_lshlrev_b32 v33, 11, v5
    v_lshl_add_u32 v33, v2, 1, v33
    v_add_u32 v33, s36, v33
    v_and_b32 v5, 31, v1
    v_lshlrev_b32 v34, 4, v5
    s_mul_i32 s38, s34, 320
    s_add_u32 s38, s38, 135168
    v_lshl_add_u32 v35, v5, 3, s38
    s_bfe_u32 s38, s34, 0x10000
    s_lshl_b32 s38, s38, 12
    s_add_u32 s36, s38, s71
    s_lshr_b32 s38, s34, 1
    s_lshl_b32 s38, s38, 24
    s_add_u32 s36, s38, s36
    s_bitcmp1_b32 s90, 2
    s_cselect_b32 s46, s46, s36
    s_cselect_b64 vcc, -1, 0
    v_cndmask_b32 v54, v32, v34, vcc
    s_bfe_u32 s38, s2, 0x30000
    s_lshl_b32 s38, s38, 8
    s_add_u32 s69, s38, 32768
    v_lshrrev_b32 v64, 2, v34
    buffer_load_dword v64, v64, s[48:51], s69 offen sc1
    v_bfe_u32 v5, v3, 0, 2
    v_lshlrev_b32 v81, 10, v5
    v_lshrrev_b32 v5, 2, v3
    v_lshl_add_u32 v81, v5, 8, v81
    v_add3_u32 v82, v81, v6, s85
    v_xor_b32 v83, 64, v82
    v_xor_b32 v84, 128, v82
    v_xor_b32 v85, 192, v82
    v_bfe_u32 v5, v3, 0, 2
    v_lshlrev_b32 v94, 9, v5
    v_lshl_add_u32 v94, v2, 4, v94
    v_add_u32 v94, s85, v94
    s_lshl_b32 s38, s34, 9
    s_add_u32 s38, s38, 131072
    v_add_u32 v102, s38, v34
    s_lshl_b32 s38, s32, 14
    s_add_u32 s36, s38, 2097152
    s_lshl_b32 s38, s34, 8
    s_add_u32 s36, s38, s36
    s_lshl_b32 s38, s32, 3
    s_add_u32 s37, s38, 163840
    s_lshl_b32 s38, s32, 8
    s_add_u32 s69, s38, 131072
    s_lshl_b32 s38, s34, 23
    s_add_u32 s69, s38, s69
    v_mov_b32 v4, s69
    v_mov_b32 v5, s68
    s_waitcnt vmcnt(1)
    s_barrier
    s_mov_b64 exec, 1
    buffer_store_dword v5, v4, s[48:51], 0 offen sc1
    s_mov_b64 exec, -1
    s_mov_b32 s86, 131072
    buffer_load_dword v7, v101, s[48:51], s86 offen sc1
    s_waitcnt vmcnt(0)
L_fcheck_47:
    v_cmp_ne_u32 vcc, s68, v7
    s_cbranch_vccz L_fok_48
    s_sleep 2
    s_mov_b32 s86, 131072
    buffer_load_dword v7, v101, s[48:51], s86 offen sc1
    s_waitcnt vmcnt(0)
    s_sub_u32 s84, s84, 1
    s_cmp_lg_u32 s84, 0
    s_cbranch_scc1 L_fcheck_47
    s_branch L_end
L_fok_48:
    buffer_load_dwordx2 v[52:53], v81, s[48:51], s37 offen sc1
    buffer_load_dwordx4 v[200:203], v9, s[48:51], s36 offen sc1
    s_add_u32 s36, s36, 4096
    buffer_load_dwordx4 v[204:207], v9, s[48:51], s36 offen sc1
    s_add_u32 s36, s36, 4096
    buffer_load_dwordx4 v[208:211], v9, s[48:51], s36 offen sc1
    s_add_u32 s36, s36, 4096
    buffer_load_dwordx4 v[212:215], v9, s[48:51], s36 offen sc1
    s_waitcnt vmcnt(4)
    v_max_f32_dpp v4, v52, v52 row_ror:8 row_mask:0xf bank_mask:0xf
    s_nop 1
    v_max_f32_dpp v4, v4, v4 row_ror:4 row_mask:0xf bank_mask:0xf
    v_sub_f32 v52, v52, v4
    v_exp_f32 v52, v52
    s_nop 0
    v_mul_f32 v5, v52, v53
    s_nop 1
    v_add_f32_dpp v5, v5, v5 row_ror:8 row_mask:0xf bank_mask:0xf
    s_nop 1
    v_add_f32_dpp v5, v5, v5 row_ror:4 row_mask:0xf bank_mask:0xf
    v_rcp_f32 v5, v5
    s_nop 0
    v_mul_f32 v52, v52, v5
    s_waitcnt vmcnt(3)
    ds_write_b128 v96, v[200:203] offset:0
    s_waitcnt vmcnt(2)
    ds_write_b128 v97, v[204:207] offset:1024
    s_waitcnt vmcnt(1)
    ds_write_b128 v98, v[208:211] offset:2048
    s_waitcnt vmcnt(0)
    ds_write_b128 v99, v[212:215] offset:3072
    s_waitcnt lgkmcnt(0)
    ds_read_b128 v[136:139], v82
    ds_read_b128 v[140:143], v83
    ds_read_b128 v[144:147], v84
    ds_read_b128 v[148:151], v85
    s_waitcnt lgkmcnt(0)
    v_mfma_f32_16x16x32_bf16 v[104:107], a[128:131], v[136:139], 0
    v_mfma_f32_16x16x32_bf16 v[104:107], a[132:135], v[140:143], v[104:107]
    v_mfma_f32_16x16x32_bf16 v[104:107], a[136:139], v[144:147], v[104:107]
    v_mfma_f32_16x16x32_bf16 v[104:107], a[140:143], v[148:151], v[104:107]
    v_mfma_f32_16x16x32_bf16 v[108:111], a[144:147], v[136:139], 0
    v_mfma_f32_16x16x32_bf16 v[108:111], a[148:151], v[140:143], v[108:111]
    v_mfma_f32_16x16x32_bf16 v[108:111], a[152:155], v[144:147], v[108:111]
    v_mfma_f32_16x16x32_bf16 v[108:111], a[156:159], v[148:151], v[108:111]
    v_mfma_f32_16x16x32_bf16 v[112:115], a[160:163], v[136:139], 0
    v_mfma_f32_16x16x32_bf16 v[112:115], a[164:167], v[140:143], v[112:115]
    v_mfma_f32_16x16x32_bf16 v[112:115], a[168:171], v[144:147], v[112:115]
    v_mfma_f32_16x16x32_bf16 v[112:115], a[172:175], v[148:151], v[112:115]
    v_mul_f32 v104, v104, v52
    v_mul_f32 v105, v105, v52
    v_mul_f32 v106, v106, v52
    v_mul_f32 v107, v107, v52
    v_add_f32_dpp v104, v104, v104 row_ror:8 row_mask:0xf bank_mask:0xf
    v_add_f32_dpp v105, v105, v105 row_ror:8 row_mask:0xf bank_mask:0xf
    v_add_f32_dpp v106, v106, v106 row_ror:8 row_mask:0xf bank_mask:0xf
    v_add_f32_dpp v107, v107, v107 row_ror:8 row_mask:0xf bank_mask:0xf
    v_add_f32_dpp v104, v104, v104 row_ror:4 row_mask:0xf bank_mask:0xf
    v_add_f32_dpp v105, v105, v105 row_ror:4 row_mask:0xf bank_mask:0xf
    v_add_f32_dpp v106, v106, v106 row_ror:4 row_mask:0xf bank_mask:0xf
    v_add_f32_dpp v107, v107, v107 row_ror:4 row_mask:0xf bank_mask:0xf
    ds_write_b128 v94, v[104:107] offset:0
    v_mfma_f32_16x16x32_bf16 v[116:119], a[176:179], v[136:139], 0
    v_mfma_f32_16x16x32_bf16 v[116:119], a[180:183], v[140:143], v[116:119]
    v_mfma_f32_16x16x32_bf16 v[116:119], a[184:187], v[144:147], v[116:119]
    v_mfma_f32_16x16x32_bf16 v[116:119], a[188:191], v[148:151], v[116:119]
    v_mul_f32 v108, v108, v52
    v_mul_f32 v109, v109, v52
    v_mul_f32 v110, v110, v52
    v_mul_f32 v111, v111, v52
    v_add_f32_dpp v108, v108, v108 row_ror:8 row_mask:0xf bank_mask:0xf
    v_add_f32_dpp v109, v109, v109 row_ror:8 row_mask:0xf bank_mask:0xf
    v_add_f32_dpp v110, v110, v110 row_ror:8 row_mask:0xf bank_mask:0xf
    v_add_f32_dpp v111, v111, v111 row_ror:8 row_mask:0xf bank_mask:0xf
    v_add_f32_dpp v108, v108, v108 row_ror:4 row_mask:0xf bank_mask:0xf
    v_add_f32_dpp v109, v109, v109 row_ror:4 row_mask:0xf bank_mask:0xf
    v_add_f32_dpp v110, v110, v110 row_ror:4 row_mask:0xf bank_mask:0xf
    v_add_f32_dpp v111, v111, v111 row_ror:4 row_mask:0xf bank_mask:0xf
    ds_write_b128 v94, v[108:111] offset:64
    v_mfma_f32_16x16x32_bf16 v[120:123], a[192:195], v[136:139], 0
    v_mfma_f32_16x16x32_bf16 v[120:123], a[196:199], v[140:143], v[120:123]
    v_mfma_f32_16x16x32_bf16 v[120:123], a[200:203], v[144:147], v[120:123]
    v_mfma_f32_16x16x32_bf16 v[120:123], a[204:207], v[148:151], v[120:123]
    v_mul_f32 v112, v112, v52
    v_mul_f32 v113, v113, v52
    v_mul_f32 v114, v114, v52
    v_mul_f32 v115, v115, v52
    v_add_f32_dpp v112, v112, v112 row_ror:8 row_mask:0xf bank_mask:0xf
    v_add_f32_dpp v113, v113, v113 row_ror:8 row_mask:0xf bank_mask:0xf
    v_add_f32_dpp v114, v114, v114 row_ror:8 row_mask:0xf bank_mask:0xf
    v_add_f32_dpp v115, v115, v115 row_ror:8 row_mask:0xf bank_mask:0xf
    v_add_f32_dpp v112, v112, v112 row_ror:4 row_mask:0xf bank_mask:0xf
    v_add_f32_dpp v113, v113, v113 row_ror:4 row_mask:0xf bank_mask:0xf
    v_add_f32_dpp v114, v114, v114 row_ror:4 row_mask:0xf bank_mask:0xf
    v_add_f32_dpp v115, v115, v115 row_ror:4 row_mask:0xf bank_mask:0xf
    ds_write_b128 v94, v[112:115] offset:128
    v_mfma_f32_16x16x32_bf16 v[124:127], a[208:211], v[136:139], 0
    v_mfma_f32_16x16x32_bf16 v[124:127], a[212:215], v[140:143], v[124:127]
    v_mfma_f32_16x16x32_bf16 v[124:127], a[216:219], v[144:147], v[124:127]
    v_mfma_f32_16x16x32_bf16 v[124:127], a[220:223], v[148:151], v[124:127]
    v_mul_f32 v116, v116, v52
    v_mul_f32 v117, v117, v52
    v_mul_f32 v118, v118, v52
    v_mul_f32 v119, v119, v52
    v_add_f32_dpp v116, v116, v116 row_ror:8 row_mask:0xf bank_mask:0xf
    v_add_f32_dpp v117, v117, v117 row_ror:8 row_mask:0xf bank_mask:0xf
    v_add_f32_dpp v118, v118, v118 row_ror:8 row_mask:0xf bank_mask:0xf
    v_add_f32_dpp v119, v119, v119 row_ror:8 row_mask:0xf bank_mask:0xf
    v_add_f32_dpp v116, v116, v116 row_ror:4 row_mask:0xf bank_mask:0xf
    v_add_f32_dpp v117, v117, v117 row_ror:4 row_mask:0xf bank_mask:0xf
    v_add_f32_dpp v118, v118, v118 row_ror:4 row_mask:0xf bank_mask:0xf
    v_add_f32_dpp v119, v119, v119 row_ror:4 row_mask:0xf bank_mask:0xf
    ds_write_b128 v94, v[116:119] offset:192
    v_mfma_f32_16x16x32_bf16 v[128:131], a[224:227], v[136:139], 0
    v_mfma_f32_16x16x32_bf16 v[128:131], a[228:231], v[140:143], v[128:131]
    v_mfma_f32_16x16x32_bf16 v[128:131], a[232:235], v[144:147], v[128:131]
    v_mfma_f32_16x16x32_bf16 v[128:131], a[236:239], v[148:151], v[128:131]
    v_mul_f32 v120, v120, v52
    v_mul_f32 v121, v121, v52
    v_mul_f32 v122, v122, v52
    v_mul_f32 v123, v123, v52
    v_add_f32_dpp v120, v120, v120 row_ror:8 row_mask:0xf bank_mask:0xf
    v_add_f32_dpp v121, v121, v121 row_ror:8 row_mask:0xf bank_mask:0xf
    v_add_f32_dpp v122, v122, v122 row_ror:8 row_mask:0xf bank_mask:0xf
    v_add_f32_dpp v123, v123, v123 row_ror:8 row_mask:0xf bank_mask:0xf
    v_add_f32_dpp v120, v120, v120 row_ror:4 row_mask:0xf bank_mask:0xf
    v_add_f32_dpp v121, v121, v121 row_ror:4 row_mask:0xf bank_mask:0xf
    v_add_f32_dpp v122, v122, v122 row_ror:4 row_mask:0xf bank_mask:0xf
    v_add_f32_dpp v123, v123, v123 row_ror:4 row_mask:0xf bank_mask:0xf
    ds_write_b128 v94, v[120:123] offset:256
    v_mfma_f32_16x16x32_bf16 v[132:135], a[240:243], v[136:139], 0
    v_mfma_f32_16x16x32_bf16 v[132:135], a[244:247], v[140:143], v[132:135]
    v_mfma_f32_16x16x32_bf16 v[132:135], a[248:251], v[144:147], v[132:135]
    v_mfma_f32_16x16x32_bf16 v[132:135], a[252:255], v[148:151], v[132:135]
    v_mul_f32 v124, v124, v52
    v_mul_f32 v125, v125, v52
    v_mul_f32 v126, v126, v52
    v_mul_f32 v127, v127, v52
    v_add_f32_dpp v124, v124, v124 row_ror:8 row_mask:0xf bank_mask:0xf
    v_add_f32_dpp v125, v125, v125 row_ror:8 row_mask:0xf bank_mask:0xf
    v_add_f32_dpp v126, v126, v126 row_ror:8 row_mask:0xf bank_mask:0xf
    v_add_f32_dpp v127, v127, v127 row_ror:8 row_mask:0xf bank_mask:0xf
    v_add_f32_dpp v124, v124, v124 row_ror:4 row_mask:0xf bank_mask:0xf
    v_add_f32_dpp v125, v125, v125 row_ror:4 row_mask:0xf bank_mask:0xf
    v_add_f32_dpp v126, v126, v126 row_ror:4 row_mask:0xf bank_mask:0xf
    v_add_f32_dpp v127, v127, v127 row_ror:4 row_mask:0xf bank_mask:0xf
    ds_write_b128 v94, v[124:127] offset:320
    v_mul_f32 v128, v128, v52
    v_mul_f32 v129, v129, v52
    v_mul_f32 v130, v130, v52
    v_mul_f32 v131, v131, v52
    v_add_f32_dpp v128, v128, v128 row_ror:8 row_mask:0xf bank_mask:0xf
    v_add_f32_dpp v129, v129, v129 row_ror:8 row_mask:0xf bank_mask:0xf
    v_add_f32_dpp v130, v130, v130 row_ror:8 row_mask:0xf bank_mask:0xf
    v_add_f32_dpp v131, v131, v131 row_ror:8 row_mask:0xf bank_mask:0xf
    v_add_f32_dpp v128, v128, v128 row_ror:4 row_mask:0xf bank_mask:0xf
    v_add_f32_dpp v129, v129, v129 row_ror:4 row_mask:0xf bank_mask:0xf
    v_add_f32_dpp v130, v130, v130 row_ror:4 row_mask:0xf bank_mask:0xf
    v_add_f32_dpp v131, v131, v131 row_ror:4 row_mask:0xf bank_mask:0xf
    ds_write_b128 v94, v[128:131] offset:384
    v_mul_f32 v132, v132, v52
    v_mul_f32 v133, v133, v52
    v_mul_f32 v134, v134, v52
    v_mul_f32 v135, v135, v52
    v_add_f32_dpp v132, v132, v132 row_ror:8 row_mask:0xf bank_mask:0xf
    v_add_f32_dpp v133, v133, v133 row_ror:8 row_mask:0xf bank_mask:0xf
    v_add_f32_dpp v134, v134, v134 row_ror:8 row_mask:0xf bank_mask:0xf
    v_add_f32_dpp v135, v135, v135 row_ror:8 row_mask:0xf bank_mask:0xf
    v_add_f32_dpp v132, v132, v132 row_ror:4 row_mask:0xf bank_mask:0xf
    v_add_f32_dpp v133, v133, v133 row_ror:4 row_mask:0xf bank_mask:0xf
    v_add_f32_dpp v134, v134, v134 row_ror:4 row_mask:0xf bank_mask:0xf
    v_add_f32_dpp v135, v135, v135 row_ror:4 row_mask:0xf bank_mask:0xf
    ds_write_b128 v94, v[132:135] offset:448
    s_waitcnt lgkmcnt(0)
    s_barrier
    ds_read_b128 v[136:139], v102 offset:0
    ds_read_b128 v[140:143], v102 offset:8192
    ds_read_b128 v[144:147], v102 offset:16384
    ds_read_b128 v[148:151], v102 offset:24576
    s_waitcnt lgkmcnt(0)
    v_add_f32 v136, v136, v140
    v_add_f32 v144, v144, v148
    v_add_f32 v137, v137, v141
    v_add_f32 v145, v145, v149
    v_add_f32 v138, v138, v142
    v_add_f32 v146, v146, v150
    v_add_f32 v139, v139, v143
    v_add_f32 v147, v147, v151
    v_add_f32 v136, v136, v144
    v_add_f32 v137, v137, v145
    v_add_f32 v138, v138, v146
    v_add_f32 v139, v139, v147
    s_mov_b32 s38, 0xffff0000
    v_cvt_pk_bf16_f32 v136, v136, v136
    v_cvt_pk_bf16_f32 v137, v137, v137
    v_cvt_pk_bf16_f32 v138, v138, v138
    v_cvt_pk_bf16_f32 v139, v139, v139
    v_and_or_b32 v136, v136, s38, v8
    v_and_or_b32 v137, v137, s38, v8
    v_and_or_b32 v138, v138, s38, v8
    v_and_or_b32 v139, v139, s38, v8
    s_lshl_b32 s38, s32, 11
    s_add_u32 s36, s38, 196608
    s_lshl_b32 s38, s34, 9
    s_add_u32 s36, s38, s36
    s_mov_b32 exec_lo, 0xffffffff
    s_mov_b32 exec_hi, 0x0
    buffer_store_dwordx4 v[136:139], v34, s[48:51], s36 offen sc1
    s_mov_b64 exec, -1
    v_xor_b32 v224, s35, v136
    v_xor_b32 v225, s35, v137
    v_xor_b32 v226, s35, v138
    v_xor_b32 v227, s35, v139
    v_lshlrev_b32 v4, 11, v2
    v_bfe_u32 v5, v1, 2, 2
    v_lshl_add_u32 v4, v5, 8, v4
    v_bfe_u32 v5, v1, 2, 2
    v_lshl_add_u32 v4, v5, 6, v4
    v_bfe_u32 v5, v1, 4, 1
    v_lshl_add_u32 v4, v5, 5, v4
    v_bfe_u32 v5, v1, 1, 1
    v_lshl_add_u32 v4, v5, 4, v4
    v_bfe_u32 v5, v1, 0, 1
    v_lshl_add_u32 v4, v5, 3, v4
    s_lshl_b32 s38, s34, 6
    s_add_u32 s38, s38, 98304
    v_xor_b32 v24, s38, v4
    v_xor_b32 v25, 16, v24
    v_xor_b32 v26, 32, v24
    v_xor_b32 v27, 48, v24
    v_and_b32 v4, 3, v3
    v_lshrrev_b32 v5, 2, v3
    v_lshlrev_b32 v6, 4, v2
    v_add_u32 v6, 135168, v6
    s_movk_i32 s36, 320
    v_cmp_eq_u32 vcc, 0, v5
    s_nop 1
    v_cndmask_b32 v28, 4, v4, vcc
    v_mad_u32_u24 v28, v28, s36, v6
    v_cmp_eq_u32 vcc, 1, v5
    s_nop 1
    v_cndmask_b32 v29, 4, v4, vcc
    v_mad_u32_u24 v29, v29, s36, v6
    v_lshlrev_b32 v5, 2, v1
    v_add_u32 v5, 136448, v5
    v_mov_b32 v6, 0
    ds_write_b32 v5, v6
    v_cmp_ne_u32 vcc, s70, v64
    s_nop 0
    s_cmp_eq_u64 vcc, 0
    s_cselect_b32 s70, 1, 0
    s_mov_b32 s3, s34
    v_lshlrev_b32 v4, 2, v2
    v_xor_b32 v4, v4, v3
    v_xor_b32 v5, 0, v4
    v_lshlrev_b32 v5, 4, v5
    v_lshl_add_u32 v20, v2, 10, v5
    v_xor_b32 v5, 1, v4
    v_lshlrev_b32 v5, 4, v5
    v_lshl_add_u32 v21, v2, 10, v5
    v_add_u32 v21, 3072, v21
    v_xor_b32 v5, 2, v4
    v_lshlrev_b32 v5, 4, v5
    v_lshl_add_u32 v22, v2, 10, v5
    v_add_u32 v22, 6144, v22
    v_xor_b32 v5, 3, v4
    v_lshlrev_b32 v5, 4, v5
    v_lshl_add_u32 v23, v2, 10, v5
    v_add_u32 v23, 9216, v23
    s_lshl_b32 s38, s32, 15
    s_add_u32 s47, s38, 1048576
    s_lshl_b32 s38, s3, 13
    s_add_u32 s47, s38, s47
    v_lshlrev_b32 v6, 7, v2
    v_bfe_u32 v5, v3, 0, 3
    v_lshl_add_u32 v6, v5, 4, v6
    v_lshrrev_b32 v4, 3, v3
    v_and_b32 v7, 3, v3
    v_min_u32 v7, 2, v7
    v_lshl_add_u32 v7, v7, 1, v4
    v_add_u32 v5, 0, v4
    v_cmp_le_u32 vcc, s33, v5
    s_nop 1
    v_addc_co_u32 v5, vcc, 0, v5, vcc
    v_lshl_add_u32 v50, v5, 10, v6
    v_add_u32 v5, 2, v4
    v_cmp_le_u32 vcc, s33, v5
    s_nop 1
    v_addc_co_u32 v5, vcc, 0, v5, vcc
    v_lshl_add_u32 v51, v5, 10, v6
    v_add_u32 v5, 4, v4
    v_cmp_le_u32 vcc, s33, v5
    s_nop 1
    v_addc_co_u32 v5, vcc, 0, v5, vcc
    v_lshl_add_u32 v52, v5, 10, v6
    v_mov_b32 v5, v7
    v_mov_b32 v6, 512
    v_cmp_le_u32 vcc, s33, v5
    s_nop 1
    v_addc_co_u32 v5, vcc, 0, v5, vcc
    v_lshl_add_u32 v53, v5, 10, v6
    s_mul_i32 s38, s3, 320
    s_add_u32 s38, s38, 135168
    v_lshlrev_b32 v4, 6, v2
    v_lshl_add_u32 v4, v3, 1, v4
    v_add_u32 v31, s38, v4
    v_lshlrev_b32 v4, 7, v2
    v_lshl_add_u32 v4, v3, 4, v4
    v_mov_b32 v5, 512
    v_cmp_gt_u32 vcc, 8, v3
    s_nop 1
    v_cndmask_b32 v79, v5, v4, vcc
    s_mov_b32 s86, 0x88888888
    s_mov_b32 s87, 0x88888888
    v_mov_b32 v120, 0xff7f0000
    s_lshl_b32 s38, s32, 10
    s_add_u32 s37, s38, 65540
    s_lshr_b32 s38, s32, 3
    s_lshl_b32 s38, s38, 8
    s_add_u32 s37, s38, s37
    s_bitcmp1_b32 s90, 2
    s_cselect_b32 s36, 22, 18
    v_mov_b32 v5, 0
L_watch:
    buffer_load_dword v6, v5, s[48:51], s37 offen sc1
    s_waitcnt vmcnt(0)
    v_cmp_le_u32 vcc, s36, v6
    s_cbranch_vccnz L_seen
    s_sleep 4
    s_sub_u32 s84, s84, 1
    s_cmp_lg_u32 s84, 0
    s_cbranch_scc1 L_watch
    s_branch L_end
L_seen:
    s_lshl_b32 s39, s34, 13
    s_add_u32 s39, s39, 98304
    s_mov_b32 m0, s39
    s_nop 0
    buffer_load_dwordx4 v20, s[40:43], s44 offen offset:0 nt lds
    buffer_load_dwordx4 v21, s[40:43], s44 offen offset:1024 nt lds
    buffer_load_dwordx4 v22, s[40:43], s44 offen offset:2048 nt lds
    buffer_load_dwordx4 v23, s[40:43], s44 offen offset:3072 nt lds
    s_lshl_b32 s39, s34, 13
    s_add_u32 s39, s39, 102400
    s_mov_b32 m0, s39
    s_add_u32 s44, s44, 16384
    buffer_load_dwordx4 v20, s[40:43], s44 offen offset:0 nt lds
    buffer_load_dwordx4 v21, s[40:43], s44 offen offset:1024 nt lds
    buffer_load_dwordx4 v22, s[40:43], s44 offen offset:2048 nt lds
    buffer_load_dwordx4 v23, s[40:43], s44 offen offset:3072 nt lds
    s_bitcmp1_b32 s90, 2
    s_cbranch_scc1 L_ctxok
    buffer_load_dwordx4 v[224:227], v54, s[48:51], s46 offen sc1
    s_add_u32 s37, s47, 6144
L_auxpoll:
    buffer_load_dwordx4 v[204:207], v53, s[48:51], s47 offen sc1
    buffer_load_dwordx4 v[192:195], v50, s[48:51], s47 offen sc1
    buffer_load_dwordx4 v[196:199], v51, s[48:51], s47 offen sc1
    buffer_load_dwordx4 v[200:203], v52, s[48:51], s47 offen sc1
    buffer_load_dwordx4 v[104:107], v79, s[48:51], s37 offen sc1
    s_waitcnt vmcnt(0)
    v_xor_b32 v104, s35, v104
    v_xor_b32 v105, s35, v105
    v_xor_b32 v106, s35, v106
    v_xor_b32 v107, s35, v107
    v_xor_b32 v192, s35, v192
    v_xor_b32 v193, s35, v193
    v_xor_b32 v194, s35, v194
    v_xor_b32 v195, s35, v195
    v_xor_b32 v196, s35, v196
    v_xor_b32 v197, s35, v197
    v_xor_b32 v198, s35, v198
    v_xor_b32 v199, s35, v199
    v_xor_b32 v200, s35, v200
    v_xor_b32 v201, s35, v201
    v_xor_b32 v202, s35, v202
    v_xor_b32 v203, s35, v203
    v_xor_b32 v204, s35, v204
    v_xor_b32 v205, s35, v205
    v_xor_b32 v206, s35, v206
    v_xor_b32 v207, s35, v207
    v_or_b32 v4, v104, v105
    v_or3_b32 v4, v4, v106, v107
    v_or3_b32 v4, v4, v192, v193
    v_or3_b32 v4, v4, v194, v195
    v_or3_b32 v4, v4, v196, v197
    v_or3_b32 v4, v4, v198, v199
    v_or3_b32 v4, v4, v200, v201
    v_or3_b32 v4, v4, v202, v203
    v_or3_b32 v4, v4, v204, v205
    v_or3_b32 v4, v4, v206, v207
    v_and_b32 v4, 0xff, v4
    v_cmp_ne_u32 vcc, 0, v4
    v_add_f32 v123, v104, v106
    v_add_f32 v122, v204, v206
    v_mov_b32_dpp v121, v105 row_newbcast:8 row_mask:0xf bank_mask:0xf
    v_mov_b32_dpp v120, v123 row_newbcast:8 row_mask:0xf bank_mask:0x3
    s_cbranch_vccz L_hop1ok
    s_sub_u32 s84, s84, 1
    s_cmp_lg_u32 s84, 0
    s_cbranch_scc1 L_auxpoll
    s_branch L_end
.section .rodata,"a"
.p2align 6
.amdhsa_kernel concat_heads__compressed_kv_cla__mha_block_cached__decode_kernel
  .amdhsa_next_free_vgpr 512
  .amdhsa_next_free_sgpr 102
  .amdhsa_accum_offset 256
  .amdhsa_group_segment_fixed_size 0
  .amdhsa_kernarg_size 112
  .amdhsa_user_sgpr_count 2
  .amdhsa_user_sgpr_kernarg_segment_ptr 1
  .amdhsa_system_sgpr_workgroup_id_x 1
.end_amdhsa_kernel
```

```asm
; @launch grid=(256,1,1) block=(256,1,1) lds=163840
    .amdgcn_target "amdgcn-amd-amdhsa--gfx950"
    .text
    .globl concat_heads__compressed_kv_cla__mha_block_cached__decode_kernel
    .p2align 8
    .type concat_heads__compressed_kv_cla__mha_block_cached__decode_kernel,@function
concat_heads__compressed_kv_cla__mha_block_cached__decode_kernel:
    s_cmp_ge_u32 s2, 256
    s_cbranch_scc1 L_end
    s_load_dwordx16 s[4:19], s[0:1], 0
    s_load_dwordx8 s[20:27], s[0:1], 64
    s_load_dwordx4 s[28:31], s[0:1], 96
    v_lshrrev_b32 v4, 6, v0
    v_and_b32 v1, 63, v0
    v_readfirstlane_b32 s34, v4
    s_lshr_b32 s32, s2, 3
    s_sub_u32 s33, s2, s32
    s_sub_u32 s33, s33, 1
    s_and_b32 s33, s33, 7
    v_lshrrev_b32 v2, 4, v1
    v_and_b32 v3, 15, v1
    s_cmp_lt_u32 s33, 2
    s_cbranch_scc1 L_qp
    s_cmp_eq_u32 s33, 2
    s_cbranch_scc1 L_ql
    s_cmp_eq_u32 s33, 7
    s_cbranch_scc1 L_aux
    s_bfe_u32 s38, s2, 0x30000
    s_lshl_b32 s38, s38, 21
    s_add_u32 s36, s38, -393216
    s_lshr_b32 s38, s32, 3
    s_lshl_b32 s38, s38, 19
    s_add_u32 s36, s38, s36
    s_lshl_b32 s38, s33, 17
    s_add_u32 s36, s38, s36
    s_lshl_b32 s38, s34, 12
    s_add_u32 s36, s38, s36
    v_bfe_u32 v5, v1, 0, 5
    v_lshlrev_b32 v4, 7, v5
    v_lshrrev_b32 v5, 5, v1
    v_lshl_add_u32 v4, v5, 15, v4
    s_mov_b32 s42, 16777216
    s_mov_b32 s43, 0x20000
    s_waitcnt lgkmcnt(0)
    s_mov_b64 s[40:41], s[6:7]
    buffer_load_dword v20, v4, s[40:43], s36 offen
    s_add_u32 s36, s36, 16384
    buffer_load_dword v21, v4, s[40:43], s36 offen
    s_add_u32 s36, s36, 49152
    buffer_load_dword v22, v4, s[40:43], s36 offen
    s_add_u32 s36, s36, 16384
    buffer_load_dword v23, v4, s[40:43], s36 offen
    s_load_dword s35, s[30:31], 0
    s_mov_b32 s48, s30
    s_and_b32 s49, s31, 0xffff
    s_mov_b32 s50, 8388608
    s_mov_b32 s51, 0x20000
    s_mov_b32 s82, 0xffffff00
    s_mov_b32 s83, 0x3e0293ee
    s_mov_b32 s84, 8388608
    v_lshrrev_b32 v4, 2, v3
    v_and_b32 v5, 3, v3
    v_lshlrev_b32 v76, 8, v4
    v_lshlrev_b32 v126, 8, v2
    v_lshl_add_u32 v76, v2, 6, v76
    v_lshl_add_u32 v76, v5, 4, v76
    v_lshl_add_u32 v126, v3, 4, v126
    v_xor_b32 v77, 32768, v76
    v_xor_b32 v127, 32768, v126
    s_add_u32 s3, s34, s33
    s_and_b32 s3, s3, 3
    s_lshl_b32 s89, s3, 5
    s_add_u32 s89, s89, s32
    s_lshl_b32 s89, s89, 20
    s_mul_i32 s88, s32, 8
    s_mul_i32 s38, s3, 2
    s_add_u32 s88, s88, s38
    s_lshl_b32 s87, s33, 1
    s_mov_b32 s52, s18
    s_and_b32 s53, s19, 0xffff
    s_mov_b32 s54, 134217728
    s_mov_b32 s55, 0x20000
    s_mov_b32 s56, s20
    s_and_b32 s57, s21, 0xffff
    s_mov_b32 s58, 134217728
    s_mov_b32 s59, 0x20000
    v_and_b32 v4, 1, v1
    v_lshlrev_b32 v4, 4, v4
    v_mov_b32 v5, 0xffff
    v_lshlrev_b32 v4, v4, v5
    v_bfe_u32 v5, v1, 1, 2
    v_cmp_eq_u32 vcc, 0, v5
    s_nop 1
    v_cndmask_b32 v10, 0, v4, vcc
    v_cmp_eq_u32 vcc, 1, v5
    s_nop 1
    v_cndmask_b32 v11, 0, v4, vcc
    v_cmp_eq_u32 vcc, 2, v5
    s_nop 1
    v_cndmask_b32 v12, 0, v4, vcc
    v_cmp_eq_u32 vcc, 3, v5
    s_nop 1
    v_cndmask_b32 v13, 0, v4, vcc
    v_mov_b32 v120, 0xff7f0000
    v_mov_b32 v121, 0
    v_mov_b32 v18, 1
    v_mov_b32 v116, 0
    v_mov_b32 v117, 0
    v_mov_b32 v118, 0
    v_mov_b32 v119, 0
    v_lshlrev_b32 v0, 3, v1
    ds_write_b64 v0, v[116:117] offset:8192
    v_mov_b32 v0, 8192
    s_lshl_b32 s38, s32, 10
    s_add_u32 s96, s38, 65536
    s_lshr_b32 s38, s32, 3
    s_lshl_b32 s38, s38, 8
    s_add_u32 s96, s38, s96
    v_mov_b32 v9, s96
    s_lshl_b32 s38, s32, 15
    s_add_u32 s96, s38, 1048576
    s_lshl_b32 s38, s3, 13
    s_add_u32 s96, s38, s96
    s_lshl_b32 s38, s33, 10
    s_add_u32 s96, s38, s96
    v_and_b32 v5, 3, v3
    v_lshlrev_b32 v78, 7, v2
    v_lshl_add_u32 v78, v5, 5, v78
    s_lshl_b32 s38, s32, 12
    s_add_u32 s91, s38, 262144
    s_lshl_b32 s38, s3, 9
    s_add_u32 s91, s38, s91
    v_lshlrev_b32 v4, 7, v2
    v_lshl_add_u32 v4, v3, 4, v4
    v_mov_b32 v5, 512
    v_cmp_gt_u32 vcc, 8, v3
    s_nop 1
    v_cndmask_b32 v79, v5, v4, vcc
    s_add_u32 s39, s87, s88
    s_bfe_u32 s37, s39, 0x10000
    s_lshl_b32 s37, s37, 13
    s_add_u32 s85, s37, s89
    s_bfe_u32 s37, s39, 0x10001
    s_lshl_b32 s37, s37, 12
    s_add_u32 s85, s37, s85
    s_bfe_u32 s37, s39, 0x10002
    s_lshl_b32 s37, s37, 11
    s_add_u32 s85, s37, s85
    s_bfe_u32 s37, s39, 0x10003
    s_lshl_b32 s37, s37, 14
    s_add_u32 s85, s37, s85
    s_bfe_u32 s37, s39, 0x40004
    s_lshl_b32 s37, s37, 16
    s_add_u32 s85, s37, s85
    buffer_load_dwordx4 v[128:131], v76, s[52:55], s85 offen offset:0 nt
    buffer_load_dwordx4 v[132:135], v77, s[52:55], s85 offen offset:0 nt
    buffer_load_dwordx4 v[136:139], v76, s[52:55], s85 offen offset:1024 nt
    buffer_load_dwordx4 v[140:143], v77, s[52:55], s85 offen offset:1024 nt
    s_add_u32 s87, s87, 1
    s_add_u32 s39, s87, s88
    s_bfe_u32 s37, s39, 0x10000
    s_lshl_b32 s37, s37, 13
    s_add_u32 s85, s37, s89
    s_bfe_u32 s37, s39, 0x10001
    s_lshl_b32 s37, s37, 12
    s_add_u32 s85, s37, s85
    s_bfe_u32 s37, s39, 0x10002
    s_lshl_b32 s37, s37, 11
    s_add_u32 s85, s37, s85
    s_bfe_u32 s37, s39, 0x10003
    s_lshl_b32 s37, s37, 14
    s_add_u32 s85, s37, s85
    s_bfe_u32 s37, s39, 0x40004
    s_lshl_b32 s37, s37, 16
    s_add_u32 s85, s37, s85
    buffer_load_dwordx4 v[144:147], v76, s[52:55], s85 offen offset:0 nt
    buffer_load_dwordx4 v[148:151], v77, s[52:55], s85 offen offset:0 nt
    buffer_load_dwordx4 v[152:155], v76, s[52:55], s85 offen offset:1024 nt
    s_waitcnt lgkmcnt(0)
    s_add_u32 s35, s35, 0x5b
    s_and_b32 s35, s35, 0xff
    v_mov_b32 v8, s35
    s_barrier
    s_waitcnt vmcnt(6)
    buffer_load_dwordx4 v[156:159], v77, s[52:55], s85 offen offset:1024 nt
    s_add_u32 s87, s87, 13
    s_add_u32 s39, s87, s88
    s_bfe_u32 s37, s39, 0x10000
    s_lshl_b32 s37, s37, 13
    s_add_u32 s85, s37, s89
    s_bfe_u32 s37, s39, 0x10001
    s_lshl_b32 s37, s37, 12
    s_add_u32 s85, s37, s85
    s_bfe_u32 s37, s39, 0x10002
    s_lshl_b32 s37, s37, 11
    s_add_u32 s85, s37, s85
    s_bfe_u32 s37, s39, 0x10003
    s_lshl_b32 s37, s37, 14
    s_add_u32 s85, s37, s85
    s_bfe_u32 s37, s39, 0x40004
    s_lshl_b32 s37, s37, 16
    s_add_u32 s85, s37, s85
    s_waitcnt vmcnt(6)
    buffer_load_dwordx4 v[160:163], v76, s[52:55], s85 offen offset:0 nt
    s_waitcnt vmcnt(6)
    buffer_load_dwordx4 v[164:167], v77, s[52:55], s85 offen offset:0 nt
    s_waitcnt vmcnt(6)
    buffer_load_dwordx4 v[168:171], v76, s[52:55], s85 offen offset:1024 nt
    s_waitcnt vmcnt(6)
    buffer_load_dwordx4 v[172:175], v77, s[52:55], s85 offen offset:1024 nt
    s_add_u32 s87, s87, 1
    s_add_u32 s39, s87, s88
    s_bfe_u32 s37, s39, 0x10000
    s_lshl_b32 s37, s37, 13
    s_add_u32 s85, s37, s89
    s_bfe_u32 s37, s39, 0x10001
    s_lshl_b32 s37, s37, 12
    s_add_u32 s85, s37, s85
    s_bfe_u32 s37, s39, 0x10002
    s_lshl_b32 s37, s37, 11
    s_add_u32 s85, s37, s85
    s_bfe_u32 s37, s39, 0x10003
    s_lshl_b32 s37, s37, 14
    s_add_u32 s85, s37, s85
    s_bfe_u32 s37, s39, 0x40004
    s_lshl_b32 s37, s37, 16
    s_add_u32 s85, s37, s85
    s_waitcnt vmcnt(6)
    buffer_load_dwordx4 v[176:179], v76, s[52:55], s85 offen offset:0 nt
    s_waitcnt vmcnt(6)
    buffer_load_dwordx4 v[180:183], v77, s[52:55], s85 offen offset:0 nt
    s_waitcnt vmcnt(6)
    buffer_load_dwordx4 v[184:187], v76, s[52:55], s85 offen offset:1024 nt
    s_waitcnt vmcnt(6)
    buffer_load_dwordx4 v[188:191], v77, s[52:55], s85 offen offset:1024 nt
    s_add_u32 s87, s87, 13
    s_add_u32 s39, s87, s88
    s_bfe_u32 s37, s39, 0x10000
    s_lshl_b32 s37, s37, 13
    s_add_u32 s85, s37, s89
    s_bfe_u32 s37, s39, 0x10001
    s_lshl_b32 s37, s37, 12
    s_add_u32 s85, s37, s85
    s_bfe_u32 s37, s39, 0x10002
    s_lshl_b32 s37, s37, 11
    s_add_u32 s85, s37, s85
    s_bfe_u32 s37, s39, 0x10003
    s_lshl_b32 s37, s37, 14
    s_add_u32 s85, s37, s85
    s_bfe_u32 s37, s39, 0x40004
    s_lshl_b32 s37, s37, 16
    s_add_u32 s85, s37, s85
    s_waitcnt vmcnt(6)
    buffer_load_dwordx4 v[192:195], v76, s[52:55], s85 offen offset:0 nt
    s_waitcnt vmcnt(6)
    buffer_load_dwordx4 v[196:199], v77, s[52:55], s85 offen offset:0 nt
    s_waitcnt vmcnt(6)
    buffer_load_dwordx4 v[200:203], v76, s[52:55], s85 offen offset:1024 nt
    s_waitcnt vmcnt(6)
    buffer_load_dwordx4 v[204:207], v77, s[52:55], s85 offen offset:1024 nt
    s_add_u32 s87, s87, 1
    s_add_u32 s39, s87, s88
    s_bfe_u32 s37, s39, 0x10000
    s_lshl_b32 s37, s37, 13
    s_add_u32 s85, s37, s89
    s_bfe_u32 s37, s39, 0x10001
    s_lshl_b32 s37, s37, 12
    s_add_u32 s85, s37, s85
    s_bfe_u32 s37, s39, 0x10002
    s_lshl_b32 s37, s37, 11
    s_add_u32 s85, s37, s85
    s_bfe_u32 s37, s39, 0x10003
    s_lshl_b32 s37, s37, 14
    s_add_u32 s85, s37, s85
    s_bfe_u32 s37, s39, 0x40004
    s_lshl_b32 s37, s37, 16
    s_add_u32 s85, s37, s85
    s_waitcnt vmcnt(6)
    buffer_load_dwordx4 v[208:211], v76, s[52:55], s85 offen offset:0 nt
    s_waitcnt vmcnt(6)
    buffer_load_dwordx4 v[212:215], v77, s[52:55], s85 offen offset:0 nt
    s_waitcnt vmcnt(6)
    buffer_load_dwordx4 v[216:219], v76, s[52:55], s85 offen offset:1024 nt
    s_waitcnt vmcnt(6)
    buffer_load_dwordx4 v[220:223], v77, s[52:55], s85 offen offset:1024 nt
    s_add_u32 s87, s87, 13
    s_add_u32 s39, s87, s88
    s_bfe_u32 s37, s39, 0x10000
    s_lshl_b32 s37, s37, 13
    s_add_u32 s85, s37, s89
    s_bfe_u32 s37, s39, 0x10001
    s_lshl_b32 s37, s37, 12
    s_add_u32 s85, s37, s85
    s_bfe_u32 s37, s39, 0x10002
    s_lshl_b32 s37, s37, 11
    s_add_u32 s85, s37, s85
    s_bfe_u32 s37, s39, 0x10003
    s_lshl_b32 s37, s37, 14
    s_add_u32 s85, s37, s85
    s_bfe_u32 s37, s39, 0x40004
    s_lshl_b32 s37, s37, 16
    s_add_u32 s85, s37, s85
    s_waitcnt vmcnt(6)
    buffer_load_dwordx4 v[224:227], v76, s[52:55], s85 offen offset:0 nt
    s_waitcnt vmcnt(6)
    buffer_load_dwordx4 v[228:231], v77, s[52:55], s85 offen offset:0 nt
    s_waitcnt vmcnt(6)
    buffer_load_dwordx4 v[232:235], v76, s[52:55], s85 offen offset:1024 nt
    s_waitcnt vmcnt(6)
    buffer_load_dwordx4 v[236:239], v77, s[52:55], s85 offen offset:1024 nt
    s_add_u32 s87, s87, 1
    s_add_u32 s39, s87, s88
    s_bfe_u32 s37, s39, 0x10000
    s_lshl_b32 s37, s37, 13
    s_add_u32 s85, s37, s89
    s_bfe_u32 s37, s39, 0x10001
    s_lshl_b32 s37, s37, 12
    s_add_u32 s85, s37, s85
    s_bfe_u32 s37, s39, 0x10002
    s_lshl_b32 s37, s37, 11
    s_add_u32 s85, s37, s85
    s_bfe_u32 s37, s39, 0x10003
    s_lshl_b32 s37, s37, 14
    s_add_u32 s85, s37, s85
    s_bfe_u32 s37, s39, 0x40004
    s_lshl_b32 s37, s37, 16
    s_add_u32 s85, s37, s85
    s_waitcnt vmcnt(6)
    buffer_load_dwordx4 v[240:243], v76, s[52:55], s85 offen offset:0 nt
    s_waitcnt vmcnt(6)
    buffer_load_dwordx4 v[244:247], v77, s[52:55], s85 offen offset:0 nt
    s_waitcnt vmcnt(6)
    buffer_load_dwordx4 v[248:251], v76, s[52:55], s85 offen offset:1024 nt
    s_waitcnt vmcnt(6)
    buffer_load_dwordx4 v[252:255], v77, s[52:55], s85 offen offset:1024 nt
    s_add_u32 s87, s87, 13
    s_add_u32 s39, s87, s88
    s_bfe_u32 s37, s39, 0x10000
    s_lshl_b32 s37, s37, 13
    s_add_u32 s85, s37, s89
    s_bfe_u32 s37, s39, 0x10001
    s_lshl_b32 s37, s37, 12
    s_add_u32 s85, s37, s85
    s_bfe_u32 s37, s39, 0x10002
    s_lshl_b32 s37, s37, 11
    s_add_u32 s85, s37, s85
    s_bfe_u32 s37, s39, 0x10003
    s_lshl_b32 s37, s37, 14
    s_add_u32 s85, s37, s85
    s_bfe_u32 s37, s39, 0x40004
    s_lshl_b32 s37, s37, 16
    s_add_u32 s85, s37, s85
    s_waitcnt vmcnt(6)
    buffer_load_dwordx4 a[0:3], v76, s[52:55], s85 offen offset:0 nt
    s_waitcnt vmcnt(6)
    buffer_load_dwordx4 a[4:7], v77, s[52:55], s85 offen offset:0 nt
    s_waitcnt vmcnt(6)
    buffer_load_dwordx4 a[8:11], v76, s[52:55], s85 offen offset:1024 nt
    s_waitcnt vmcnt(6)
    buffer_load_dwordx4 a[12:15], v77, s[52:55], s85 offen offset:1024 nt
    s_add_u32 s87, s87, 1
    s_add_u32 s39, s87, s88
    s_bfe_u32 s37, s39, 0x10000
    s_lshl_b32 s37, s37, 13
    s_add_u32 s85, s37, s89
    s_bfe_u32 s37, s39, 0x10001
    s_lshl_b32 s37, s37, 12
    s_add_u32 s85, s37, s85
    s_bfe_u32 s37, s39, 0x10002
    s_lshl_b32 s37, s37, 11
    s_add_u32 s85, s37, s85
    s_bfe_u32 s37, s39, 0x10003
    s_lshl_b32 s37, s37, 14
    s_add_u32 s85, s37, s85
    s_bfe_u32 s37, s39, 0x40004
    s_lshl_b32 s37, s37, 16
    s_add_u32 s85, s37, s85
    s_waitcnt vmcnt(6)
    buffer_load_dwordx4 a[16:19], v76, s[52:55], s85 offen offset:0 nt
    s_waitcnt vmcnt(6)
    buffer_load_dwordx4 a[20:23], v77, s[52:55], s85 offen offset:0 nt
    s_waitcnt vmcnt(6)
    buffer_load_dwordx4 a[24:27], v76, s[52:55], s85 offen offset:1024 nt
    s_waitcnt vmcnt(6)
    buffer_load_dwordx4 a[28:31], v77, s[52:55], s85 offen offset:1024 nt
    s_add_u32 s87, s87, 13
    s_add_u32 s39, s87, s88
    s_bfe_u32 s37, s39, 0x10000
    s_lshl_b32 s37, s37, 13
    s_add_u32 s85, s37, s89
    s_bfe_u32 s37, s39, 0x10001
    s_lshl_b32 s37, s37, 12
    s_add_u32 s85, s37, s85
    s_bfe_u32 s37, s39, 0x10002
    s_lshl_b32 s37, s37, 11
    s_add_u32 s85, s37, s85
    s_bfe_u32 s37, s39, 0x10003
    s_lshl_b32 s37, s37, 14
    s_add_u32 s85, s37, s85
    s_bfe_u32 s37, s39, 0x40004
    s_lshl_b32 s37, s37, 16
    s_add_u32 s85, s37, s85
    s_waitcnt vmcnt(6)
    buffer_load_dwordx4 a[32:35], v76, s[52:55], s85 offen offset:0 nt
    s_waitcnt vmcnt(6)
    buffer_load_dwordx4 a[36:39], v77, s[52:55], s85 offen offset:0 nt
    s_waitcnt vmcnt(6)
    buffer_load_dwordx4 a[40:43], v76, s[52:55], s85 offen offset:1024 nt
    s_waitcnt vmcnt(6)
    buffer_load_dwordx4 a[44:47], v77, s[52:55], s85 offen offset:1024 nt
    s_add_u32 s87, s87, 1
    s_add_u32 s39, s87, s88
    s_bfe_u32 s37, s39, 0x10000
    s_lshl_b32 s37, s37, 13
    s_add_u32 s85, s37, s89
    s_bfe_u32 s37, s39, 0x10001
    s_lshl_b32 s37, s37, 12
    s_add_u32 s85, s37, s85
    s_bfe_u32 s37, s39, 0x10002
    s_lshl_b32 s37, s37, 11
    s_add_u32 s85, s37, s85
    s_bfe_u32 s37, s39, 0x10003
    s_lshl_b32 s37, s37, 14
    s_add_u32 s85, s37, s85
    s_bfe_u32 s37, s39, 0x40004
    s_lshl_b32 s37, s37, 16
    s_add_u32 s85, s37, s85
    s_waitcnt vmcnt(6)
    buffer_load_dwordx4 a[48:51], v76, s[52:55], s85 offen offset:0 nt
    s_waitcnt vmcnt(6)
    buffer_load_dwordx4 a[52:55], v77, s[52:55], s85 offen offset:0 nt
    buffer_load_dwordx4 v[68:71], v78, s[48:51], s91 offen offset:0 sc1
    buffer_load_dwordx4 v[72:75], v78, s[48:51], s91 offen offset:16 sc1
    s_waitcnt vmcnt(8)
    buffer_load_dwordx4 a[56:59], v76, s[52:55], s85 offen offset:1024 nt
    s_waitcnt vmcnt(8)
    buffer_load_dwordx4 a[60:63], v77, s[52:55], s85 offen offset:1024 nt
    s_add_u32 s87, s87, 13
    s_add_u32 s39, s87, s88
    s_bfe_u32 s37, s39, 0x10000
    s_lshl_b32 s37, s37, 13
    s_add_u32 s85, s37, s89
    s_bfe_u32 s37, s39, 0x10001
    s_lshl_b32 s37, s37, 12
    s_add_u32 s85, s37, s85
    s_bfe_u32 s37, s39, 0x10002
    s_lshl_b32 s37, s37, 11
    s_add_u32 s85, s37, s85
    s_bfe_u32 s37, s39, 0x10003
    s_lshl_b32 s37, s37, 14
    s_add_u32 s85, s37, s85
    s_bfe_u32 s37, s39, 0x40004
    s_lshl_b32 s37, s37, 16
    s_add_u32 s85, s37, s85
    s_waitcnt vmcnt(8)
    buffer_load_dwordx4 a[64:67], v76, s[52:55], s85 offen offset:0 nt
    s_waitcnt vmcnt(8)
    buffer_load_dwordx4 a[68:71], v77, s[52:55], s85 offen offset:0 nt
    s_waitcnt vmcnt(8)
    buffer_load_dwordx4 a[72:75], v76, s[52:55], s85 offen offset:1024 nt
    s_waitcnt vmcnt(8)
    buffer_load_dwordx4 a[76:79], v77, s[52:55], s85 offen offset:1024 nt
    s_add_u32 s87, s87, 1
    s_add_u32 s39, s87, s88
    s_bfe_u32 s37, s39, 0x10000
    s_lshl_b32 s37, s37, 13
    s_add_u32 s85, s37, s89
    s_bfe_u32 s37, s39, 0x10001
    s_lshl_b32 s37, s37, 12
    s_add_u32 s85, s37, s85
    s_bfe_u32 s37, s39, 0x10002
    s_lshl_b32 s37, s37, 11
    s_add_u32 s85, s37, s85
    s_bfe_u32 s37, s39, 0x10003
    s_lshl_b32 s37, s37, 14
    s_add_u32 s85, s37, s85
    s_bfe_u32 s37, s39, 0x40004
    s_lshl_b32 s37, s37, 16
    s_add_u32 s85, s37, s85
    s_waitcnt vmcnt(6)
L_qcheck_1:
    v_xor_b32 v68, s35, v68
    v_xor_b32 v69, s35, v69
    v_xor_b32 v70, s35, v70
    v_xor_b32 v71, s35, v71
    v_xor_b32 v72, s35, v72
    v_xor_b32 v73, s35, v73
    v_xor_b32 v74, s35, v74
    v_xor_b32 v75, s35, v75
    v_or_b32 v4, v68, v69
    v_or3_b32 v4, v4, v70, v71
    v_or3_b32 v4, v4, v72, v73
    v_or3_b32 v4, v4, v74, v75
    v_and_b32 v4, 0xff, v4
    v_cmp_ne_u32 vcc, 0, v4
    s_cbranch_vccz L_qok_2
    buffer_load_dwordx4 v[68:71], v78, s[48:51], s91 offen offset:0 sc1
    buffer_load_dwordx4 v[72:75], v78, s[48:51], s91 offen offset:16 sc1
    s_waitcnt vmcnt(0)
    s_sub_u32 s84, s84, 1
    s_cmp_lg_u32 s84, 0
    s_cbranch_scc1 L_qcheck_1
    s_branch L_end
L_qok_2:
    v_cvt_pk_bf16_f32 v68, v68, v69
    v_cvt_pk_bf16_f32 v69, v70, v71
    v_cvt_pk_bf16_f32 v70, v72, v73
    v_cvt_pk_bf16_f32 v71, v74, v75
    s_mov_b32 vcc_lo, 0xf000f
    s_mov_b32 vcc_hi, 0xf000f
    v_cndmask_b32 v80, 0, v68, vcc
    v_cndmask_b32 v81, 0, v69, vcc
    v_cndmask_b32 v82, 0, v70, vcc
    v_cndmask_b32 v83, 0, v71, vcc
    s_mov_b32 vcc_lo, 0xf000f0
    s_mov_b32 vcc_hi, 0xf000f0
    v_cndmask_b32 v84, 0, v68, vcc
    v_cndmask_b32 v85, 0, v69, vcc
    v_cndmask_b32 v86, 0, v70, vcc
    v_cndmask_b32 v87, 0, v71, vcc
    s_mov_b32 vcc_lo, 0xf000f00
    s_mov_b32 vcc_hi, 0xf000f00
    v_cndmask_b32 v88, 0, v68, vcc
    v_cndmask_b32 v89, 0, v69, vcc
    v_cndmask_b32 v90, 0, v70, vcc
    v_cndmask_b32 v91, 0, v71, vcc
    s_mov_b32 vcc_lo, 0xf000f000
    s_mov_b32 vcc_hi, 0xf000f000
    v_cndmask_b32 v92, 0, v68, vcc
    v_cndmask_b32 v93, 0, v69, vcc
    v_cndmask_b32 v94, 0, v70, vcc
    v_cndmask_b32 v95, 0, v71, vcc
    s_getreg_b32 s70, hwreg(HW_REG_XCC_ID, 0, 4)
    s_lshl_b32 s70, s70, 8
    s_or_b32 s70, s70, s35
    s_or_b32 s70, s70, 0x5e9d0000
    s_bfe_u32 s38, s2, 0x30000
    s_lshl_b32 s38, s38, 8
    s_add_u32 s69, s38, 32768
    s_lshl_b32 s38, s32, 2
    s_add_u32 s69, s38, s69
    s_lshl_b32 s38, s34, 24
    s_add_u32 s69, s38, s69
    v_mov_b32 v72, s69
    v_mov_b32 v73, s70
    s_mov_b64 exec, 1
    buffer_store_dword v73, v72, s[48:51], 0 offen sc1
    s_mov_b64 exec, -1
    v_mov_b32 v65, 0xff7f0000
    s_lshl_b32 s38, s34, 14
    s_add_u32 s38, s38, 16384
    v_lshl_add_u32 v64, v1, 2, s38
    buffer_load_dwordx4 a[80:83], v76, s[52:55], s85 offen offset:0 nt
    v_mfma_f32_16x16x32_bf16 v[112:115], v[128:131], v[80:83], 0
    v_mfma_f32_16x16x32_bf16 v[112:115], v[132:135], v[84:87], v[112:115]
    v_mfma_f32_16x16x32_bf16 v[112:115], v[136:139], v[88:91], v[112:115]
    s_waitcnt vmcnt(7)
    buffer_load_dwordx4 a[84:87], v77, s[52:55], s85 offen offset:0 nt
    v_mfma_f32_16x16x32_bf16 v[112:115], v[140:143], v[92:95], v[112:115]
    v_mfma_f32_16x16x32_bf16 v[96:99], v[144:147], v[80:83], 0
    v_mfma_f32_16x16x32_bf16 v[96:99], v[148:151], v[84:87], v[96:99]
    v_mfma_f32_16x16x32_bf16 v[96:99], v[152:155], v[88:91], v[96:99]
    s_nop 4
    v_mov_b32_dpp v122, v112 quad_perm:[0,0,0,0] row_mask:0xf bank_mask:0xf
    v_mov_b32_dpp v124, v114 quad_perm:[2,2,2,2] row_mask:0xf bank_mask:0xf
    s_nop 0
    v_add_f32_dpp v122, v113, v122 quad_perm:[1,1,1,1] row_mask:0xf bank_mask:0xf
    v_add_f32_dpp v124, v115, v124 quad_perm:[3,3,3,3] row_mask:0xf bank_mask:0xf
    v_add_f32 v122, v122, v124
    v_max_f32 v65, v65, v122
    ds_write_b32 v64, v122 offset:0
    s_waitcnt vmcnt(7)
    buffer_load_dwordx4 a[88:91], v76, s[52:55], s85 offen offset:1024 nt
    v_mfma_f32_16x16x32_bf16 v[96:99], v[156:159], v[92:95], v[96:99]
    v_mfma_f32_16x16x32_bf16 v[112:115], v[160:163], v[80:83], 0
    v_mfma_f32_16x16x32_bf16 v[112:115], v[164:167], v[84:87], v[112:115]
    s_waitcnt vmcnt(7)
    buffer_load_dwordx4 a[92:95], v77, s[52:55], s85 offen offset:1024 nt
    s_add_u32 s87, s87, 13
    s_add_u32 s39, s87, s88
    s_bfe_u32 s37, s39, 0x10000
    s_lshl_b32 s37, s37, 13
    s_add_u32 s85, s37, s89
    s_bfe_u32 s37, s39, 0x10001
    s_lshl_b32 s37, s37, 12
    s_add_u32 s85, s37, s85
    s_bfe_u32 s37, s39, 0x10002
    s_lshl_b32 s37, s37, 11
    s_add_u32 s85, s37, s85
    s_bfe_u32 s37, s39, 0x10003
    s_lshl_b32 s37, s37, 14
    s_add_u32 s85, s37, s85
    s_bfe_u32 s37, s39, 0x40004
    s_lshl_b32 s37, s37, 16
    s_add_u32 s85, s37, s85
    v_mfma_f32_16x16x32_bf16 v[112:115], v[168:171], v[88:91], v[112:115]
    v_mov_b32_dpp v122, v96 quad_perm:[0,0,0,0] row_mask:0xf bank_mask:0xf
    v_mov_b32_dpp v124, v98 quad_perm:[2,2,2,2] row_mask:0xf bank_mask:0xf
    s_nop 0
    v_add_f32_dpp v122, v97, v122 quad_perm:[1,1,1,1] row_mask:0xf bank_mask:0xf
    v_add_f32_dpp v124, v99, v124 quad_perm:[3,3,3,3] row_mask:0xf bank_mask:0xf
    v_add_f32 v122, v122, v124
    v_max_f32 v65, v65, v122
    ds_write_b32 v64, v122 offset:256
    v_mfma_f32_16x16x32_bf16 v[112:115], v[172:175], v[92:95], v[112:115]
    v_mfma_f32_16x16x32_bf16 v[96:99], v[176:179], v[80:83], 0
    v_mfma_f32_16x16x32_bf16 v[96:99], v[180:183], v[84:87], v[96:99]
    s_waitcnt vmcnt(7)
    buffer_load_dwordx4 a[96:99], v76, s[52:55], s85 offen offset:0 nt
    v_mfma_f32_16x16x32_bf16 v[96:99], v[184:187], v[88:91], v[96:99]
    s_nop 2
    v_mov_b32_dpp v122, v112 quad_perm:[0,0,0,0] row_mask:0xf bank_mask:0xf
    v_mov_b32_dpp v124, v114 quad_perm:[2,2,2,2] row_mask:0xf bank_mask:0xf
    s_nop 0
    v_add_f32_dpp v122, v113, v122 quad_perm:[1,1,1,1] row_mask:0xf bank_mask:0xf
    v_add_f32_dpp v124, v115, v124 quad_perm:[3,3,3,3] row_mask:0xf bank_mask:0xf
    v_add_f32 v122, v122, v124
    v_max_f32 v65, v65, v122
    ds_write_b32 v64, v122 offset:512
    v_mfma_f32_16x16x32_bf16 v[96:99], v[188:191], v[92:95], v[96:99]
    v_mfma_f32_16x16x32_bf16 v[112:115], v[192:195], v[80:83], 0
    s_waitcnt vmcnt(7)
    buffer_load_dwordx4 a[100:103], v77, s[52:55], s85 offen offset:0 nt
    v_mfma_f32_16x16x32_bf16 v[112:115], v[196:199], v[84:87], v[112:115]
    v_mfma_f32_16x16x32_bf16 v[112:115], v[200:203], v[88:91], v[112:115]
    s_nop 2
    v_mov_b32_dpp v122, v96 quad_perm:[0,0,0,0] row_mask:0xf bank_mask:0xf
    v_mov_b32_dpp v124, v98 quad_perm:[2,2,2,2] row_mask:0xf bank_mask:0xf
    s_nop 0
    v_add_f32_dpp v122, v97, v122 quad_perm:[1,1,1,1] row_mask:0xf bank_mask:0xf
    v_add_f32_dpp v124, v99, v124 quad_perm:[3,3,3,3] row_mask:0xf bank_mask:0xf
    v_add_f32 v122, v122, v124
    v_max_f32 v65, v65, v122
    ds_write_b32 v64, v122 offset:768
    v_mfma_f32_16x16x32_bf16 v[112:115], v[204:207], v[92:95], v[112:115]
    v_mfma_f32_16x16x32_bf16 v[96:99], v[208:211], v[80:83], 0
    s_waitcnt vmcnt(7)
    buffer_load_dwordx4 a[104:107], v76, s[52:55], s85 offen offset:1024 nt
    v_mfma_f32_16x16x32_bf16 v[96:99], v[212:215], v[84:87], v[96:99]
    v_mfma_f32_16x16x32_bf16 v[96:99], v[216:219], v[88:91], v[96:99]
    s_nop 2
    v_mov_b32_dpp v122, v112 quad_perm:[0,0,0,0] row_mask:0xf bank_mask:0xf
    v_mov_b32_dpp v124, v114 quad_perm:[2,2,2,2] row_mask:0xf bank_mask:0xf
    s_nop 0
    v_add_f32_dpp v122, v113, v122 quad_perm:[1,1,1,1] row_mask:0xf bank_mask:0xf
    v_add_f32_dpp v124, v115, v124 quad_perm:[3,3,3,3] row_mask:0xf bank_mask:0xf
    v_add_f32 v122, v122, v124
    v_max_f32 v65, v65, v122
    ds_write_b32 v64, v122 offset:1024
    v_mfma_f32_16x16x32_bf16 v[96:99], v[220:223], v[92:95], v[96:99]
    s_waitcnt vmcnt(6)
    buffer_load_dwordx4 a[108:111], v77, s[52:55], s85 offen offset:1024 nt
    s_add_u32 s87, s87, 1
    s_add_u32 s39, s87, s88
    s_bfe_u32 s37, s39, 0x10000
    s_lshl_b32 s37, s37, 13
    s_add_u32 s85, s37, s89
    s_bfe_u32 s37, s39, 0x10001
    s_lshl_b32 s37, s37, 12
    s_add_u32 s85, s37, s85
    s_bfe_u32 s37, s39, 0x10002
    s_lshl_b32 s37, s37, 11
    s_add_u32 s85, s37, s85
    s_bfe_u32 s37, s39, 0x10003
    s_lshl_b32 s37, s37, 14
    s_add_u32 s85, s37, s85
    s_bfe_u32 s37, s39, 0x40004
    s_lshl_b32 s37, s37, 16
    s_add_u32 s85, s37, s85
    v_mfma_f32_16x16x32_bf16 v[112:115], v[224:227], v[80:83], 0
    v_mfma_f32_16x16x32_bf16 v[112:115], v[228:231], v[84:87], v[112:115]
    v_mfma_f32_16x16x32_bf16 v[112:115], v[232:235], v[88:91], v[112:115]
    v_mov_b32_dpp v122, v96 quad_perm:[0,0,0,0] row_mask:0xf bank_mask:0xf
    v_mov_b32_dpp v124, v98 quad_perm:[2,2,2,2] row_mask:0xf bank_mask:0xf
    s_nop 0
    v_add_f32_dpp v122, v97, v122 quad_perm:[1,1,1,1] row_mask:0xf bank_mask:0xf
    v_add_f32_dpp v124, v99, v124 quad_perm:[3,3,3,3] row_mask:0xf bank_mask:0xf
    v_add_f32 v122, v122, v124
    v_max_f32 v65, v65, v122
    ds_write_b32 v64, v122 offset:1280
    v_mfma_f32_16x16x32_bf16 v[112:115], v[236:239], v[92:95], v[112:115]
    s_waitcnt vmcnt(6)
    buffer_load_dwordx4 a[112:115], v76, s[52:55], s85 offen offset:0 nt
    v_mfma_f32_16x16x32_bf16 v[96:99], v[240:243], v[80:83], 0
    v_mfma_f32_16x16x32_bf16 v[96:99], v[244:247], v[84:87], v[96:99]
    v_mfma_f32_16x16x32_bf16 v[96:99], v[248:251], v[88:91], v[96:99]
    s_nop 2
    v_mov_b32_dpp v122, v112 quad_perm:[0,0,0,0] row_mask:0xf bank_mask:0xf
    v_mov_b32_dpp v124, v114 quad_perm:[2,2,2,2] row_mask:0xf bank_mask:0xf
    s_nop 0
    v_add_f32_dpp v122, v113, v122 quad_perm:[1,1,1,1] row_mask:0xf bank_mask:0xf
    v_add_f32_dpp v124, v115, v124 quad_perm:[3,3,3,3] row_mask:0xf bank_mask:0xf
    v_add_f32 v122, v122, v124
    v_max_f32 v65, v65, v122
    ds_write_b32 v64, v122 offset:1536
    v_mfma_f32_16x16x32_bf16 v[96:99], v[252:255], v[92:95], v[96:99]
    s_waitcnt vmcnt(6)
    buffer_load_dwordx4 a[116:119], v77, s[52:55], s85 offen offset:0 nt
    v_mfma_f32_16x16x32_bf16 v[112:115], a[0:3], v[80:83], 0
    v_mfma_f32_16x16x32_bf16 v[112:115], a[4:7], v[84:87], v[112:115]
    v_mfma_f32_16x16x32_bf16 v[112:115], a[8:11], v[88:91], v[112:115]
    s_nop 2
    v_mov_b32_dpp v122, v96 quad_perm:[0,0,0,0] row_mask:0xf bank_mask:0xf
    v_mov_b32_dpp v124, v98 quad_perm:[2,2,2,2] row_mask:0xf bank_mask:0xf
    s_nop 0
    v_add_f32_dpp v122, v97, v122 quad_perm:[1,1,1,1] row_mask:0xf bank_mask:0xf
    v_add_f32_dpp v124, v99, v124 quad_perm:[3,3,3,3] row_mask:0xf bank_mask:0xf
    v_add_f32 v122, v122, v124
    v_max_f32 v65, v65, v122
    ds_write_b32 v64, v122 offset:1792
    s_waitcnt vmcnt(6)
    buffer_load_dwordx4 a[120:123], v76, s[52:55], s85 offen offset:1024 nt
    v_mfma_f32_16x16x32_bf16 v[112:115], a[12:15], v[92:95], v[112:115]
    v_mfma_f32_16x16x32_bf16 v[96:99], a[16:19], v[80:83], 0
    v_mfma_f32_16x16x32_bf16 v[96:99], a[20:23], v[84:87], v[96:99]
    v_mfma_f32_16x16x32_bf16 v[96:99], a[24:27], v[88:91], v[96:99]
    s_nop 4
    v_mov_b32_dpp v122, v112 quad_perm:[0,0,0,0] row_mask:0xf bank_mask:0xf
    v_mov_b32_dpp v124, v114 quad_perm:[2,2,2,2] row_mask:0xf bank_mask:0xf
    s_nop 0
    v_add_f32_dpp v122, v113, v122 quad_perm:[1,1,1,1] row_mask:0xf bank_mask:0xf
    v_add_f32_dpp v124, v115, v124 quad_perm:[3,3,3,3] row_mask:0xf bank_mask:0xf
    v_add_f32 v122, v122, v124
    v_max_f32 v65, v65, v122
    ds_write_b32 v64, v122 offset:2048
    s_waitcnt vmcnt(6)
    buffer_load_dwordx4 a[124:127], v77, s[52:55], s85 offen offset:1024 nt
    s_add_u32 s87, s87, 13
    s_add_u32 s39, s87, s88
    s_bfe_u32 s37, s39, 0x10000
    s_lshl_b32 s37, s37, 13
    s_add_u32 s85, s37, s89
    s_bfe_u32 s37, s39, 0x10001
    s_lshl_b32 s37, s37, 12
    s_add_u32 s85, s37, s85
    s_bfe_u32 s37, s39, 0x10002
    s_lshl_b32 s37, s37, 11
    s_add_u32 s85, s37, s85
    s_bfe_u32 s37, s39, 0x10003
    s_lshl_b32 s37, s37, 14
    s_add_u32 s85, s37, s85
    s_bfe_u32 s37, s39, 0x40004
    s_lshl_b32 s37, s37, 16
    s_add_u32 s85, s37, s85
    v_mfma_f32_16x16x32_bf16 v[96:99], a[28:31], v[92:95], v[96:99]
    v_mfma_f32_16x16x32_bf16 v[112:115], a[32:35], v[80:83], 0
    s_bfe_u32 s38, s2, 0x20001
    s_lshl_b32 s38, s38, 0
    s_add_u32 s90, s38, 0
    s_bfe_u32 s38, s2, 0x10000
    s_lshl_b32 s38, s38, 2
    s_add_u32 s90, s38, s90
    s_and_b32 s36, s90, 3
    s_bitcmp0_b32 s90, 2
    s_cselect_b64 s[40:41], s[24:25], s[14:15]
    s_cselect_b32 s45, 262144, 0
    s_add_u32 s45, s45, 524288
    s_lshl_b32 s38, s36, 16
    s_add_u32 s71, s38, s45
    s_lshr_b32 s38, s32, 2
    s_lshl_b32 s38, s38, 13
    s_add_u32 s71, s38, s71
    s_bfe_u32 s38, s32, 0x20000
    s_lshl_b32 s38, s38, 6
    s_add_u32 s71, s38, s71
    s_mov_b32 s42, 4194304
    s_mov_b32 s43, 0x20000
    s_lshl_b32 s38, s32, 17
    s_add_u32 s44, s38, 0
    s_lshl_b32 s38, s34, 15
    s_add_u32 s44, s38, s44
    s_lshl_b32 s38, s36, 8
    s_add_u32 s44, s38, s44
    s_lshl_b32 s38, s36, 16
    s_add_u32 s45, s38, s45
    s_lshr_b32 s38, s34, 1
    s_lshl_b32 s38, s38, 15
    s_add_u32 s45, s38, s45
    s_lshl_b32 s38, s32, 8
    s_add_u32 s45, s38, s45
    s_bfe_u32 s38, s34, 0x10000
    s_lshl_b32 s38, s38, 7
    s_add_u32 s45, s38, s45
    s_lshl_b32 s38, s32, 11
    s_add_u32 s46, s38, 196608
    s_lshl_b32 s38, s34, 9
    s_add_u32 s46, s38, s46
    s_mov_b32 s72, s26
    s_and_b32 s73, s27, 0xffff
    s_mov_b32 s74, 8192
    s_mov_b32 s75, 0x20000
    v_mfma_f32_16x16x32_bf16 v[112:115], a[36:39], v[84:87], v[112:115]
    s_waitcnt vmcnt(5)
    buffer_load_dwordx4 v[128:131], v76, s[52:55], s85 offen offset:0 nt
    v_mfma_f32_16x16x32_bf16 v[112:115], a[40:43], v[88:91], v[112:115]
    v_mov_b32_dpp v122, v96 quad_perm:[0,0,0,0] row_mask:0xf bank_mask:0xf
    v_mov_b32_dpp v124, v98 quad_perm:[2,2,2,2] row_mask:0xf bank_mask:0xf
    s_nop 0
    v_add_f32_dpp v122, v97, v122 quad_perm:[1,1,1,1] row_mask:0xf bank_mask:0xf
    v_add_f32_dpp v124, v99, v124 quad_perm:[3,3,3,3] row_mask:0xf bank_mask:0xf
    v_add_f32 v122, v122, v124
    v_max_f32 v65, v65, v122
    ds_write_b32 v64, v122 offset:2304
    v_mfma_f32_16x16x32_bf16 v[112:115], a[44:47], v[92:95], v[112:115]
    v_mfma_f32_16x16x32_bf16 v[96:99], a[48:51], v[80:83], 0
    v_mfma_f32_16x16x32_bf16 v[96:99], a[52:55], v[84:87], v[96:99]
    s_waitcnt vmcnt(5)
    buffer_load_dwordx4 v[132:135], v77, s[52:55], s85 offen offset:0 nt
    v_mfma_f32_16x16x32_bf16 v[96:99], a[56:59], v[88:91], v[96:99]
    s_nop 2
    v_mov_b32_dpp v122, v112 quad_perm:[0,0,0,0] row_mask:0xf bank_mask:0xf
    v_mov_b32_dpp v124, v114 quad_perm:[2,2,2,2] row_mask:0xf bank_mask:0xf
    s_nop 0
    v_add_f32_dpp v122, v113, v122 quad_perm:[1,1,1,1] row_mask:0xf bank_mask:0xf
    v_add_f32_dpp v124, v115, v124 quad_perm:[3,3,3,3] row_mask:0xf bank_mask:0xf
    v_add_f32 v122, v122, v124
    v_max_f32 v65, v65, v122
    ds_write_b32 v64, v122 offset:2560
    v_lshlrev_b32 v4, 2, v2
    v_xor_b32 v4, v4, v3
    v_xor_b32 v5, 0, v4
    v_lshlrev_b32 v5, 4, v5
    v_lshl_add_u32 v20, v2, 10, v5
    v_xor_b32 v5, 1, v4
    v_lshlrev_b32 v5, 4, v5
    v_lshl_add_u32 v21, v2, 10, v5
    v_add_u32 v21, 3072, v21
    v_xor_b32 v5, 2, v4
    v_lshlrev_b32 v5, 4, v5
    v_lshl_add_u32 v22, v2, 10, v5
    v_add_u32 v22, 6144, v22
    v_xor_b32 v5, 3, v4
    v_lshlrev_b32 v5, 4, v5
    v_lshl_add_u32 v23, v2, 10, v5
    v_add_u32 v23, 9216, v23
    s_lshl_b32 s38, s32, 15
    s_add_u32 s47, s38, 1048576
    s_lshl_b32 s38, s3, 13
    s_add_u32 s47, s38, s47
    v_lshlrev_b32 v6, 7, v2
    v_bfe_u32 v5, v3, 0, 3
    v_lshl_add_u32 v6, v5, 4, v6
    v_lshrrev_b32 v4, 3, v3
    v_and_b32 v7, 3, v3
    v_min_u32 v7, 2, v7
    v_lshl_add_u32 v7, v7, 1, v4
    v_add_u32 v5, 0, v4
    v_cmp_le_u32 vcc, s33, v5
    s_nop 1
    v_addc_co_u32 v5, vcc, 0, v5, vcc
    v_lshl_add_u32 v50, v5, 10, v6
    v_add_u32 v5, 2, v4
    v_cmp_le_u32 vcc, s33, v5
    s_nop 1
    v_addc_co_u32 v5, vcc, 0, v5, vcc
    v_lshl_add_u32 v51, v5, 10, v6
    v_add_u32 v5, 4, v4
    v_cmp_le_u32 vcc, s33, v5
    s_nop 1
    v_addc_co_u32 v5, vcc, 0, v5, vcc
    v_lshl_add_u32 v52, v5, 10, v6
    v_mov_b32 v5, v7
    v_mov_b32 v6, 512
    v_cmp_le_u32 vcc, s33, v5
    s_nop 1
    v_addc_co_u32 v5, vcc, 0, v5, vcc
    v_lshl_add_u32 v53, v5, 10, v6
    s_mul_i32 s38, s3, 320
    s_add_u32 s38, s38, 135168
    v_lshlrev_b32 v4, 6, v2
    v_lshl_add_u32 v4, v3, 1, v4
    v_add_u32 v31, s38, v4
    v_mfma_f32_16x16x32_bf16 v[96:99], a[60:63], v[92:95], v[96:99]
    v_mfma_f32_16x16x32_bf16 v[112:115], a[64:67], v[80:83], 0
    s_waitcnt vmcnt(5)
    buffer_load_dwordx4 v[136:139], v76, s[52:55], s85 offen offset:1024 nt
    v_mfma_f32_16x16x32_bf16 v[112:115], a[68:71], v[84:87], v[112:115]
    v_mfma_f32_16x16x32_bf16 v[112:115], a[72:75], v[88:91], v[112:115]
    s_nop 2
    v_mov_b32_dpp v122, v96 quad_perm:[0,0,0,0] row_mask:0xf bank_mask:0xf
    v_mov_b32_dpp v124, v98 quad_perm:[2,2,2,2] row_mask:0xf bank_mask:0xf
    s_nop 0
    v_add_f32_dpp v122, v97, v122 quad_perm:[1,1,1,1] row_mask:0xf bank_mask:0xf
    v_add_f32_dpp v124, v99, v124 quad_perm:[3,3,3,3] row_mask:0xf bank_mask:0xf
    v_add_f32 v122, v122, v124
    v_max_f32 v65, v65, v122
    ds_write_b32 v64, v122 offset:2816
    v_mfma_f32_16x16x32_bf16 v[112:115], a[76:79], v[92:95], v[112:115]
    v_mfma_f32_16x16x32_bf16 v[96:99], a[80:83], v[80:83], 0
    v_lshlrev_b32 v4, 11, v2
    v_bfe_u32 v5, v1, 2, 2
    v_lshl_add_u32 v4, v5, 8, v4
    v_bfe_u32 v5, v1, 2, 2
    v_lshl_add_u32 v4, v5, 6, v4
    v_bfe_u32 v5, v1, 4, 1
    v_lshl_add_u32 v4, v5, 5, v4
    v_bfe_u32 v5, v1, 1, 1
    v_lshl_add_u32 v4, v5, 4, v4
    v_bfe_u32 v5, v1, 0, 1
    v_lshl_add_u32 v4, v5, 3, v4
    s_lshl_b32 s38, s34, 6
    s_add_u32 s38, s38, 98304
    v_xor_b32 v24, s38, v4
    v_xor_b32 v25, 16, v24
    v_xor_b32 v26, 32, v24
    v_xor_b32 v27, 48, v24
    v_and_b32 v4, 3, v3
    v_lshrrev_b32 v5, 2, v3
    v_lshlrev_b32 v6, 4, v2
    v_add_u32 v6, 135168, v6
    s_movk_i32 s36, 320
    v_cmp_eq_u32 vcc, 0, v5
    s_nop 1
    v_cndmask_b32 v28, 4, v4, vcc
    v_mad_u32_u24 v28, v28, s36, v6
    v_cmp_eq_u32 vcc, 1, v5
    s_nop 1
    v_cndmask_b32 v29, 4, v4, vcc
    v_mad_u32_u24 v29, v29, s36, v6
    v_lshlrev_b32 v5, 2, v1
    v_add_u32 v5, 136448, v5
    v_mov_b32 v6, 0
    ds_write_b32 v5, v6
    s_waitcnt vmcnt(5)
    buffer_load_dwordx4 v[140:143], v77, s[52:55], s85 offen offset:1024 nt
    s_add_u32 s87, s87, 1
    s_add_u32 s39, s87, s88
    s_bfe_u32 s37, s39, 0x10000
    s_lshl_b32 s37, s37, 13
    s_add_u32 s85, s37, s89
    s_bfe_u32 s37, s39, 0x10001
    s_lshl_b32 s37, s37, 12
    s_add_u32 s85, s37, s85
    s_bfe_u32 s37, s39, 0x10002
    s_lshl_b32 s37, s37, 11
    s_add_u32 s85, s37, s85
    s_bfe_u32 s37, s39, 0x10003
    s_lshl_b32 s37, s37, 14
    s_add_u32 s85, s37, s85
    s_bfe_u32 s37, s39, 0x40004
    s_lshl_b32 s37, s37, 16
    s_add_u32 s85, s37, s85
    v_mfma_f32_16x16x32_bf16 v[96:99], a[84:87], v[84:87], v[96:99]
    v_mfma_f32_16x16x32_bf16 v[96:99], a[88:91], v[88:91], v[96:99]
    v_mov_b32_dpp v122, v112 quad_perm:[0,0,0,0] row_mask:0xf bank_mask:0xf
    v_mov_b32_dpp v124, v114 quad_perm:[2,2,2,2] row_mask:0xf bank_mask:0xf
    s_nop 0
    v_add_f32_dpp v122, v113, v122 quad_perm:[1,1,1,1] row_mask:0xf bank_mask:0xf
    v_add_f32_dpp v124, v115, v124 quad_perm:[3,3,3,3] row_mask:0xf bank_mask:0xf
    v_add_f32 v122, v122, v124
    v_max_f32 v65, v65, v122
    ds_write_b32 v64, v122 offset:3072
    v_mfma_f32_16x16x32_bf16 v[96:99], a[92:95], v[92:95], v[96:99]
    s_waitcnt vmcnt(5)
    buffer_load_dwordx4 v[144:147], v76, s[52:55], s85 offen offset:0 nt
    v_mfma_f32_16x16x32_bf16 v[112:115], a[96:99], v[80:83], 0
    v_mfma_f32_16x16x32_bf16 v[112:115], a[100:103], v[84:87], v[112:115]
    v_mfma_f32_16x16x32_bf16 v[112:115], a[104:107], v[88:91], v[112:115]
    s_nop 2
    v_mov_b32_dpp v122, v96 quad_perm:[0,0,0,0] row_mask:0xf bank_mask:0xf
    v_mov_b32_dpp v124, v98 quad_perm:[2,2,2,2] row_mask:0xf bank_mask:0xf
    s_nop 0
    v_add_f32_dpp v122, v97, v122 quad_perm:[1,1,1,1] row_mask:0xf bank_mask:0xf
    v_add_f32_dpp v124, v99, v124 quad_perm:[3,3,3,3] row_mask:0xf bank_mask:0xf
    v_add_f32 v122, v122, v124
    v_max_f32 v65, v65, v122
    ds_write_b32 v64, v122 offset:3328
    v_lshlrev_b32 v30, 4, v3
    v_lshl_add_u32 v30, v2, 13, v30
    v_lshrrev_b32 v5, 2, v1
    v_lshlrev_b32 v32, 8, v5
    v_bfe_u32 v5, v1, 0, 2
    v_lshl_add_u32 v32, v5, 4, v32
    s_xor_b32 s37, s90, 4
    s_bfe_u32 s38, s37, 0x30000
    s_lshl_b32 s38, s38, 8
    s_add_u32 s36, s38, 0
    s_lshr_b32 s38, s32, 4
    s_lshl_b32 s38, s38, 7
    s_add_u32 s36, s38, s36
    s_bfe_u32 s38, s32, 0x20000
    s_lshl_b32 s38, s38, 5
    s_add_u32 s36, s38, s36
    s_bfe_u32 s38, s32, 0x20002
    s_lshl_b32 s38, s38, 3
    s_add_u32 s36, s38, s36
    v_bfe_u32 v5, v1, 0, 2
    v_lshlrev_b32 v33, 11, v5
    v_lshl_add_u32 v33, v2, 1, v33
    v_add_u32 v33, s36, v33
    v_and_b32 v5, 31, v1
    v_lshlrev_b32 v34, 4, v5
    s_mul_i32 s38, s34, 320
    s_add_u32 s38, s38, 135168
    v_lshl_add_u32 v35, v5, 3, s38
    s_bfe_u32 s38, s34, 0x10000
    s_lshl_b32 s38, s38, 12
    s_add_u32 s36, s38, s71
    s_lshr_b32 s38, s34, 1
    s_lshl_b32 s38, s38, 24
    s_add_u32 s36, s38, s36
    s_bitcmp1_b32 s90, 2
    s_cselect_b32 s46, s46, s36
    s_cselect_b64 vcc, -1, 0
    v_cndmask_b32 v54, v32, v34, vcc
    v_mfma_f32_16x16x32_bf16 v[112:115], a[108:111], v[92:95], v[112:115]
    s_waitcnt vmcnt(5)
    buffer_load_dwordx4 v[148:151], v77, s[52:55], s85 offen offset:0 nt
    v_mfma_f32_16x16x32_bf16 v[96:99], a[112:115], v[80:83], 0
    v_mfma_f32_16x16x32_bf16 v[96:99], a[116:119], v[84:87], v[96:99]
    v_mfma_f32_16x16x32_bf16 v[96:99], a[120:123], v[88:91], v[96:99]
    s_nop 2
    v_mov_b32_dpp v122, v112 quad_perm:[0,0,0,0] row_mask:0xf bank_mask:0xf
    v_mov_b32_dpp v124, v114 quad_perm:[2,2,2,2] row_mask:0xf bank_mask:0xf
    s_nop 0
    v_add_f32_dpp v122, v113, v122 quad_perm:[1,1,1,1] row_mask:0xf bank_mask:0xf
    v_add_f32_dpp v124, v115, v124 quad_perm:[3,3,3,3] row_mask:0xf bank_mask:0xf
    v_add_f32 v122, v122, v124
    v_max_f32 v65, v65, v122
    ds_write_b32 v64, v122 offset:3584
    v_mfma_f32_16x16x32_bf16 v[96:99], a[124:127], v[92:95], v[96:99]
    v_add_u32 v64, 3840, v64
    s_mov_b32 s97, 8
    s_mov_b32 s92, 1
    s_lshl_b32 s38, s32, 13
    s_add_u32 s80, s38, 3145728
    s_lshl_b32 s38, s3, 11
    s_add_u32 s80, s38, s80
    v_lshrrev_b32 v4, 2, v1
    v_lshlrev_b32 v55, 3, v4
    s_mov_b32 s66, 134217728
    s_mov_b32 s67, 0x20000
    s_mov_b64 s[64:65], s[52:53]
    v_mov_b32 v62, v76
    v_mov_b32 v63, v77
L_bloop:
    s_waitcnt vmcnt(5)
    buffer_load_dwordx4 v[152:155], v62, s[64:67], s85 offen offset:1024 nt
    v_mfma_f32_16x16x32_bf16 v[112:115], v[128:131], v[80:83], 0
    s_waitcnt vmcnt(5)
    buffer_load_dwordx4 v[156:159], v63, s[64:67], s85 offen offset:1024 nt
    v_mfma_f32_16x16x32_bf16 v[112:115], v[132:135], v[84:87], v[112:115]
    s_cmp_le_u32 s97, 2
    s_cbranch_scc1 L_rare_3
L_back_4:
    s_add_u32 s87, s87, 13
L_done_5:
    s_add_u32 s39, s87, s88
    s_bfe_u32 s37, s39, 0x10000
    s_lshl_b32 s37, s37, 13
    s_add_u32 s85, s37, s89
    s_bfe_u32 s37, s39, 0x10001
    s_lshl_b32 s37, s37, 12
    s_add_u32 s85, s37, s85
    s_bfe_u32 s37, s39, 0x10002
    s_lshl_b32 s37, s37, 11
    s_add_u32 s85, s37, s85
    s_bfe_u32 s37, s39, 0x10003
    s_lshl_b32 s37, s37, 14
    s_add_u32 s85, s37, s85
    s_bfe_u32 s37, s39, 0x40004
    s_lshl_b32 s37, s37, 16
    s_add_u32 s85, s37, s85
    v_mov_b32_dpp v122, v96 quad_perm:[0,0,0,0] row_mask:0xf bank_mask:0xf
    v_mov_b32_dpp v124, v98 quad_perm:[2,2,2,2] row_mask:0xf bank_mask:0xf
    s_nop 0
    v_add_f32_dpp v122, v97, v122 quad_perm:[1,1,1,1] row_mask:0xf bank_mask:0xf
    v_add_f32_dpp v124, v99, v124 quad_perm:[3,3,3,3] row_mask:0xf bank_mask:0xf
    v_add_f32 v122, v122, v124
    v_max_f32 v65, v65, v122
    ds_write_b32 v64, v122 offset:0
    s_waitcnt vmcnt(5)
    buffer_load_dwordx4 v[128:131], v62, s[64:67], s85 offen offset:0 nt
    v_mfma_f32_16x16x32_bf16 v[112:115], v[136:139], v[88:91], v[112:115]
    s_waitcnt vmcnt(5)
    buffer_load_dwordx4 v[132:135], v63, s[64:67], s85 offen offset:0 nt
    v_mfma_f32_16x16x32_bf16 v[112:115], v[140:143], v[92:95], v[112:115]
    s_waitcnt vmcnt(5)
    buffer_load_dwordx4 v[136:139], v62, s[64:67], s85 offen offset:1024 nt
    v_mfma_f32_16x16x32_bf16 v[96:99], v[144:147], v[80:83], 0
    s_waitcnt vmcnt(5)
    buffer_load_dwordx4 v[140:143], v63, s[64:67], s85 offen offset:1024 nt
    v_mfma_f32_16x16x32_bf16 v[96:99], v[148:151], v[84:87], v[96:99]
    s_add_u32 s87, s87, s92
    s_add_u32 s39, s87, s88
    s_bfe_u32 s37, s39, 0x10000
    s_lshl_b32 s37, s37, 13
    s_add_u32 s85, s37, s89
    s_bfe_u32 s37, s39, 0x10001
    s_lshl_b32 s37, s37, 12
    s_add_u32 s85, s37, s85
    s_bfe_u32 s37, s39, 0x10002
    s_lshl_b32 s37, s37, 11
    s_add_u32 s85, s37, s85
    s_bfe_u32 s37, s39, 0x10003
    s_lshl_b32 s37, s37, 14
    s_add_u32 s85, s37, s85
    s_bfe_u32 s37, s39, 0x40004
    s_lshl_b32 s37, s37, 16
    s_add_u32 s85, s37, s85
    v_mov_b32_dpp v122, v112 quad_perm:[0,0,0,0] row_mask:0xf bank_mask:0xf
    v_mov_b32_dpp v124, v114 quad_perm:[2,2,2,2] row_mask:0xf bank_mask:0xf
    s_nop 0
    v_add_f32_dpp v122, v113, v122 quad_perm:[1,1,1,1] row_mask:0xf bank_mask:0xf
    v_add_f32_dpp v124, v115, v124 quad_perm:[3,3,3,3] row_mask:0xf bank_mask:0xf
    v_add_f32 v122, v122, v124
    v_max_f32 v65, v65, v122
    ds_write_b32 v64, v122 offset:256
    s_waitcnt vmcnt(5)
    buffer_load_dwordx4 v[144:147], v62, s[64:67], s85 offen offset:0 nt
    v_mfma_f32_16x16x32_bf16 v[96:99], v[152:155], v[88:91], v[96:99]
    s_waitcnt vmcnt(5)
    buffer_load_dwordx4 v[148:151], v63, s[64:67], s85 offen offset:0 nt
    v_mfma_f32_16x16x32_bf16 v[96:99], v[156:159], v[92:95], v[96:99]
    v_add_u32 v64, 512, v64
    s_sub_u32 s97, s97, 1
    s_cmp_lg_u32 s97, 0
    s_cbranch_scc1 L_bloop
    s_bfe_u32 s38, s2, 0x30000
    s_lshl_b32 s38, s38, 8
    s_add_u32 s69, s38, 32768
    v_lshrrev_b32 v68, 2, v34
    buffer_load_dword v68, v68, s[48:51], s69 offen sc1
    v_mov_b32_dpp v122, v96 quad_perm:[0,0,0,0] row_mask:0xf bank_mask:0xf
    v_mov_b32_dpp v124, v98 quad_perm:[2,2,2,2] row_mask:0xf bank_mask:0xf
    s_nop 0
    v_add_f32_dpp v122, v97, v122 quad_perm:[1,1,1,1] row_mask:0xf bank_mask:0xf
    v_add_f32_dpp v124, v99, v124 quad_perm:[3,3,3,3] row_mask:0xf bank_mask:0xf
    v_add_f32 v122, v122, v124
    v_max_f32 v65, v65, v122
    ds_write_b32 v64, v122 offset:0
    v_mov_b32 v123, 0xff7f0000
    ds_write_b32 v64, v123 offset:256
    s_lshl_b32 s38, s34, 14
    s_add_u32 s38, s38, 16384
    v_lshl_add_u32 v64, v1, 2, s38
    ds_read_b32 v66, v64
    ds_read_b32 v67, v64 offset:256
    v_mul_f32 v65, s83, v65
    s_nop 1
    v_max_f32_dpp v124, v65, v65 row_ror:4 row_mask:0xf bank_mask:0xf
    s_nop 1
    v_max_f32_dpp v124, v124, v124 row_ror:8 row_mask:0xf bank_mask:0xf
    v_mov_b32 v125, v124
    s_nop 1
    v_permlane16_swap_b32 v124, v125
    v_max_f32 v124, v124, v125
    v_mov_b32 v125, v124
    s_nop 1
    v_permlane32_swap_b32 v124, v125
    v_max_f32 v124, v124, v125
    v_mov_b32 v120, v124
    s_mov_b32 s97, 16
    s_waitcnt lgkmcnt(1)
    v_fma_f32 v123, v66, s83, -v120
    v_exp_f32 v123, v123
    ds_read_b32 v66, v64 offset:512
    v_cvt_pk_bf16_f32 v100, v123, v123
    v_add_f32 v121, v121, v123
    v_and_b32 v65, 1, v1
    v_lshl_add_u32 v65, v65, 2, v55
    s_mov_b32 vcc_lo, 0xaaaaaaaa
    s_mov_b32 vcc_hi, 0xaaaaaaaa
    s_cmp_ge_u32 s93, 16
    s_cbranch_scc1 L_kdone
L_kdyn:
    s_lshl_b32 s81, s93, 7
    s_add_u32 s81, s81, s80
    s_waitcnt vmcnt(5)
    buffer_load_dwordx4 v[152:155], v62, s[64:67], s85 offen offset:1024 nt
    v_mfma_f32_16x16x32_bf16 v[112:115], v[128:131], v[80:83], 0
    s_waitcnt vmcnt(5)
    buffer_load_dwordx4 v[156:159], v63, s[64:67], s85 offen offset:1024 nt
    v_mfma_f32_16x16x32_bf16 v[112:115], v[132:135], v[84:87], v[112:115]
    s_cmp_lg_u32 s62, 0
    s_cbranch_scc1 L_nopost_11
    v_add_u32 v19, 1, v19
    s_mov_b64 exec, 1
    ds_write_b32 v0, v19 offset:4
L_nopost_11:
    s_mov_b64 exec, 1
    ds_add_rtn_u32 v5, v0, v18 offset:8
    s_mov_b64 exec, -1
L_again_12:
    ds_read_b32 v4, v0 offset:4
    s_waitcnt lgkmcnt(0)
    v_readfirstlane_b32 s93, v4
    s_nop 0
    s_sub_u32 s93, s93, 1
    s_cbranch_scc1 L_retry_13
    v_add_u32 v0, 8, v0
    s_cmp_ge_u32 s93, 16
    s_cbranch_scc1 L_gone_10
    s_lshl_b32 s87, s93, 1
    s_add_u32 s87, s87, 224
    s_mov_b32 s92, 1
    v_mov_b32 v19, 64
    s_mov_b32 s62, 0
    s_cmp_ge_u32 s93, 15
    s_cbranch_scc1 L_lastone_14
    v_readfirstlane_b32 s62, v5
    s_nop 0
    s_cmp_lg_u32 s62, 0
    s_cbranch_scc1 L_nodraw_15
    s_mov_b64 exec, 1
    global_atomic_add v19, v9, v18, s[30:31] offset:0 sc0 sc1
    s_mov_b64 exec, -1
L_nodraw_15:
L_lastone_14:
L_done_9:
    s_add_u32 s39, s87, s88
    s_bfe_u32 s37, s39, 0x10000
    s_lshl_b32 s37, s37, 13
    s_add_u32 s85, s37, s89
    s_bfe_u32 s37, s39, 0x10001
    s_lshl_b32 s37, s37, 12
    s_add_u32 s85, s37, s85
    s_bfe_u32 s37, s39, 0x10002
    s_lshl_b32 s37, s37, 11
    s_add_u32 s85, s37, s85
    s_bfe_u32 s37, s39, 0x10003
    s_lshl_b32 s37, s37, 14
    s_add_u32 s85, s37, s85
    s_bfe_u32 s37, s39, 0x40004
    s_lshl_b32 s37, s37, 16
    s_add_u32 s85, s37, s85
    s_waitcnt vmcnt(5)
    buffer_load_dwordx4 v[128:131], v62, s[64:67], s85 offen offset:0 nt
    v_mfma_f32_16x16x32_bf16 v[112:115], v[136:139], v[88:91], v[112:115]
    s_waitcnt vmcnt(5)
    buffer_load_dwordx4 v[132:135], v63, s[64:67], s85 offen offset:0 nt
    v_mfma_f32_16x16x32_bf16 v[112:115], v[140:143], v[92:95], v[112:115]
    s_waitcnt vmcnt(5)
    buffer_load_dwordx4 v[136:139], v62, s[64:67], s85 offen offset:1024 nt
    v_mfma_f32_16x16x32_bf16 v[96:99], v[144:147], v[80:83], 0
    s_waitcnt vmcnt(5)
    buffer_load_dwordx4 v[140:143], v63, s[64:67], s85 offen offset:1024 nt
    v_mfma_f32_16x16x32_bf16 v[96:99], v[148:151], v[84:87], v[96:99]
    s_add_u32 s87, s87, s92
    s_add_u32 s39, s87, s88
    s_bfe_u32 s37, s39, 0x10000
    s_lshl_b32 s37, s37, 13
    s_add_u32 s85, s37, s89
    s_bfe_u32 s37, s39, 0x10001
    s_lshl_b32 s37, s37, 12
    s_add_u32 s85, s37, s85
    s_bfe_u32 s37, s39, 0x10002
    s_lshl_b32 s37, s37, 11
    s_add_u32 s85, s37, s85
    s_bfe_u32 s37, s39, 0x10003
    s_lshl_b32 s37, s37, 14
    s_add_u32 s85, s37, s85
    s_bfe_u32 s37, s39, 0x40004
    s_lshl_b32 s37, s37, 16
    s_add_u32 s85, s37, s85
    v_mov_b32_dpp v123, v112 quad_perm:[0,0,0,0] row_mask:0xf bank_mask:0xf
    v_mov_b32_dpp v124, v114 quad_perm:[2,2,2,2] row_mask:0xf bank_mask:0xf
    s_nop 0
    v_add_f32_dpp v123, v113, v123 quad_perm:[1,1,1,1] row_mask:0xf bank_mask:0xf
    v_add_f32_dpp v124, v115, v124 quad_perm:[3,3,3,3] row_mask:0xf bank_mask:0xf
    v_add_f32 v123, v123, v124
    s_waitcnt vmcnt(5)
    buffer_load_dwordx4 v[144:147], v62, s[64:67], s85 offen offset:0 nt
    v_mfma_f32_16x16x32_bf16 v[96:99], v[152:155], v[88:91], v[96:99]
    s_waitcnt vmcnt(5)
    buffer_load_dwordx4 v[148:151], v63, s[64:67], s85 offen offset:0 nt
    v_mfma_f32_16x16x32_bf16 v[96:99], v[156:159], v[92:95], v[96:99]
    s_nop 7
    v_mov_b32_dpp v122, v96 quad_perm:[0,0,0,0] row_mask:0xf bank_mask:0xf
    v_mov_b32_dpp v124, v98 quad_perm:[2,2,2,2] row_mask:0xf bank_mask:0xf
    s_nop 0
    v_add_f32_dpp v122, v97, v122 quad_perm:[1,1,1,1] row_mask:0xf bank_mask:0xf
    v_add_f32_dpp v124, v99, v124 quad_perm:[3,3,3,3] row_mask:0xf bank_mask:0xf
    v_add_f32 v122, v122, v124
    v_cndmask_b32 v123, v123, v122, vcc
    v_and_or_b32 v123, v123, s82, v8
    s_mov_b32 exec_lo, 0x33333333
    s_mov_b32 exec_hi, 0x33333333
    buffer_store_dword v123, v65, s[48:51], s81 offen sc1
    s_mov_b64 exec, -1
    s_cmp_lt_u32 s93, 16
    s_cbranch_scc1 L_kdyn
L_kdone:
L_vloop:
    v_and_b32_dpp v104, v100, v10 row_newbcast:0 row_mask:0xf bank_mask:0xf
    v_and_b32_dpp v105, v100, v11 row_newbcast:0 row_mask:0xf bank_mask:0xf
    v_and_b32_dpp v106, v100, v12 row_newbcast:0 row_mask:0xf bank_mask:0xf
    v_and_b32_dpp v107, v100, v13 row_newbcast:0 row_mask:0xf bank_mask:0xf
    s_waitcnt vmcnt(5)
    buffer_load_dwordx4 v[152:155], v62, s[64:67], s85 offen offset:1024 nt
    v_mfma_f32_16x16x32_bf16 v[116:119], v[128:131], v[104:107], v[116:119]
    v_and_b32_dpp v108, v100, v10 row_newbcast:4 row_mask:0xf bank_mask:0xf
    v_and_b32_dpp v109, v100, v11 row_newbcast:4 row_mask:0xf bank_mask:0xf
    v_and_b32_dpp v110, v100, v12 row_newbcast:4 row_mask:0xf bank_mask:0xf
    v_and_b32_dpp v111, v100, v13 row_newbcast:4 row_mask:0xf bank_mask:0xf
    s_waitcnt vmcnt(5)
    buffer_load_dwordx4 v[156:159], v63, s[64:67], s85 offen offset:1024 nt
    v_mfma_f32_16x16x32_bf16 v[116:119], v[132:135], v[108:111], v[116:119]
    s_cmp_le_u32 s97, 2
    s_cbranch_scc1 L_rare_16
L_back_17:
    s_add_u32 s87, s87, 13
L_done_18:
    s_add_u32 s39, s87, s88
    s_bfe_u32 s37, s39, 0x10000
    s_lshl_b32 s37, s37, 13
    s_add_u32 s85, s37, s89
    s_bfe_u32 s37, s39, 0x10001
    s_lshl_b32 s37, s37, 12
    s_add_u32 s85, s37, s85
    s_bfe_u32 s37, s39, 0x10002
    s_lshl_b32 s37, s37, 11
    s_add_u32 s85, s37, s85
    s_bfe_u32 s37, s39, 0x10003
    s_lshl_b32 s37, s37, 14
    s_add_u32 s85, s37, s85
    s_bfe_u32 s37, s39, 0x40004
    s_lshl_b32 s37, s37, 16
    s_add_u32 s85, s37, s85
    s_waitcnt lgkmcnt(1)
    v_fma_f32 v123, v67, s83, -v120
    v_exp_f32 v123, v123
    ds_read_b32 v67, v64 offset:768
    v_cvt_pk_bf16_f32 v101, v123, v123
    v_add_f32 v121, v121, v123
    v_and_b32_dpp v104, v100, v10 row_newbcast:8 row_mask:0xf bank_mask:0xf
    v_and_b32_dpp v105, v100, v11 row_newbcast:8 row_mask:0xf bank_mask:0xf
    v_and_b32_dpp v106, v100, v12 row_newbcast:8 row_mask:0xf bank_mask:0xf
    v_and_b32_dpp v107, v100, v13 row_newbcast:8 row_mask:0xf bank_mask:0xf
    s_waitcnt vmcnt(5)
    buffer_load_dwordx4 v[128:131], v62, s[64:67], s85 offen offset:0 nt
    v_mfma_f32_16x16x32_bf16 v[116:119], v[136:139], v[104:107], v[116:119]
    v_and_b32_dpp v108, v100, v10 row_newbcast:12 row_mask:0xf bank_mask:0xf
    v_and_b32_dpp v109, v100, v11 row_newbcast:12 row_mask:0xf bank_mask:0xf
    v_and_b32_dpp v110, v100, v12 row_newbcast:12 row_mask:0xf bank_mask:0xf
    v_and_b32_dpp v111, v100, v13 row_newbcast:12 row_mask:0xf bank_mask:0xf
    s_waitcnt vmcnt(5)
    buffer_load_dwordx4 v[132:135], v63, s[64:67], s85 offen offset:0 nt
    v_mfma_f32_16x16x32_bf16 v[116:119], v[140:143], v[108:111], v[116:119]
    v_and_b32_dpp v104, v101, v10 row_newbcast:0 row_mask:0xf bank_mask:0xf
    v_and_b32_dpp v105, v101, v11 row_newbcast:0 row_mask:0xf bank_mask:0xf
    v_and_b32_dpp v106, v101, v12 row_newbcast:0 row_mask:0xf bank_mask:0xf
    v_and_b32_dpp v107, v101, v13 row_newbcast:0 row_mask:0xf bank_mask:0xf
    s_waitcnt vmcnt(5)
    buffer_load_dwordx4 v[136:139], v62, s[64:67], s85 offen offset:1024 nt
    v_mfma_f32_16x16x32_bf16 v[116:119], v[144:147], v[104:107], v[116:119]
    v_and_b32_dpp v108, v101, v10 row_newbcast:4 row_mask:0xf bank_mask:0xf
    v_and_b32_dpp v109, v101, v11 row_newbcast:4 row_mask:0xf bank_mask:0xf
    v_and_b32_dpp v110, v101, v12 row_newbcast:4 row_mask:0xf bank_mask:0xf
    v_and_b32_dpp v111, v101, v13 row_newbcast:4 row_mask:0xf bank_mask:0xf
    s_waitcnt vmcnt(5)
    buffer_load_dwordx4 v[140:143], v63, s[64:67], s85 offen offset:1024 nt
    v_mfma_f32_16x16x32_bf16 v[116:119], v[148:151], v[108:111], v[116:119]
    s_add_u32 s87, s87, s92
    s_add_u32 s39, s87, s88
    s_bfe_u32 s37, s39, 0x10000
    s_lshl_b32 s37, s37, 13
    s_add_u32 s85, s37, s89
    s_bfe_u32 s37, s39, 0x10001
    s_lshl_b32 s37, s37, 12
    s_add_u32 s85, s37, s85
    s_bfe_u32 s37, s39, 0x10002
    s_lshl_b32 s37, s37, 11
    s_add_u32 s85, s37, s85
    s_bfe_u32 s37, s39, 0x10003
    s_lshl_b32 s37, s37, 14
    s_add_u32 s85, s37, s85
    s_bfe_u32 s37, s39, 0x40004
    s_lshl_b32 s37, s37, 16
    s_add_u32 s85, s37, s85
    v_add_u32 v64, 512, v64
    s_waitcnt lgkmcnt(1)
    v_fma_f32 v123, v66, s83, -v120
    v_exp_f32 v123, v123
    ds_read_b32 v66, v64 offset:512
    v_cvt_pk_bf16_f32 v100, v123, v123
    v_add_f32 v121, v121, v123
    v_and_b32_dpp v104, v101, v10 row_newbcast:8 row_mask:0xf bank_mask:0xf
    v_and_b32_dpp v105, v101, v11 row_newbcast:8 row_mask:0xf bank_mask:0xf
    v_and_b32_dpp v106, v101, v12 row_newbcast:8 row_mask:0xf bank_mask:0xf
    v_and_b32_dpp v107, v101, v13 row_newbcast:8 row_mask:0xf bank_mask:0xf
    s_waitcnt vmcnt(5)
    buffer_load_dwordx4 v[144:147], v62, s[64:67], s85 offen offset:0 nt
    v_mfma_f32_16x16x32_bf16 v[116:119], v[152:155], v[104:107], v[116:119]
    v_and_b32_dpp v108, v101, v10 row_newbcast:12 row_mask:0xf bank_mask:0xf
    v_and_b32_dpp v109, v101, v11 row_newbcast:12 row_mask:0xf bank_mask:0xf
    v_and_b32_dpp v110, v101, v12 row_newbcast:12 row_mask:0xf bank_mask:0xf
    v_and_b32_dpp v111, v101, v13 row_newbcast:12 row_mask:0xf bank_mask:0xf
    s_waitcnt vmcnt(5)
    buffer_load_dwordx4 v[148:151], v63, s[64:67], s85 offen offset:0 nt
    v_mfma_f32_16x16x32_bf16 v[116:119], v[156:159], v[108:111], v[116:119]
    s_sub_u32 s97, s97, 1
    s_cmp_lg_u32 s97, 0
    s_cbranch_scc1 L_vloop
    buffer_load_dwordx4 v[152:155], v62, s[64:67], s85 offen offset:1024 nt
    v_cmp_ne_u32 vcc, s70, v68
    s_nop 0
    s_cmp_eq_u64 vcc, 0
    s_cselect_b32 s70, 1, 0
    s_cmp_ge_u32 s93, 16
    s_cbranch_scc1 L_none
L_vdyn:
    s_waitcnt vmcnt(6)
    buffer_load_dwordx4 v[156:159], v63, s[64:67], s85 offen offset:1024 nt
L_sccheck:
    v_xor_b32 v102, s35, v102
    v_xor_b32 v103, s35, v103
    v_or_b32 v4, v102, v103
    v_and_b32 v4, 0xff, v4
    v_cmp_ne_u32 vcc, 0, v4
    v_fma_f32 v123, v102, s83, -v120
    v_fma_f32 v122, v103, s83, -v120
    s_cbranch_vccnz L_scretry
    v_max_f32 v124, v123, v122
    v_cmp_lt_f32 vcc, 0, v124
    s_cbranch_vccnz L_newmax
L_oldmax:
    v_exp_f32 v123, v123
    v_exp_f32 v122, v122
    v_cvt_pk_bf16_f32 v100, v123, v123
    v_add_f32 v121, v121, v123
    v_cvt_pk_bf16_f32 v101, v122, v122
    v_add_f32 v121, v121, v122
    s_cmp_lg_u32 s62, 0
    s_cbranch_scc1 L_nopost_20
    v_add_u32 v19, 1, v19
    s_mov_b64 exec, 1
    ds_write_b32 v0, v19 offset:4
L_nopost_20:
    s_mov_b64 exec, 1
    ds_add_rtn_u32 v5, v0, v18 offset:8
    s_mov_b64 exec, -1
L_again_21:
    ds_read_b32 v4, v0 offset:4
    s_waitcnt lgkmcnt(0)
    v_readfirstlane_b32 s93, v4
    s_nop 0
    s_sub_u32 s93, s93, 1
    s_cbranch_scc1 L_retry_22
    v_add_u32 v0, 8, v0
    s_cmp_ge_u32 s93, 16
    s_cbranch_scc1 L_last
    s_lshl_b32 s81, s93, 7
    s_add_u32 s81, s81, s80
    buffer_load_dwordx2 v[102:103], v55, s[48:51], s81 offen sc1
    s_lshl_b32 s87, s93, 1
    s_add_u32 s87, s87, 224
    s_mov_b32 s92, 1
    v_mov_b32 v19, 64
    s_mov_b32 s62, 0
    s_cmp_ge_u32 s93, 15
    s_cbranch_scc1 L_lastone_23
    v_readfirstlane_b32 s62, v5
    s_nop 0
    s_cmp_lg_u32 s62, 0
    s_cbranch_scc1 L_nodraw_24
    s_mov_b64 exec, 1
    global_atomic_add v19, v9, v18, s[30:31] offset:4 sc0 sc1
    s_mov_b64 exec, -1
L_nodraw_24:
L_lastone_23:
    s_add_u32 s39, s87, s88
    s_bfe_u32 s37, s39, 0x10000
    s_lshl_b32 s37, s37, 13
    s_add_u32 s85, s37, s89
    s_bfe_u32 s37, s39, 0x10001
    s_lshl_b32 s37, s37, 12
    s_add_u32 s85, s37, s85
    s_bfe_u32 s37, s39, 0x10002
    s_lshl_b32 s37, s37, 11
    s_add_u32 s85, s37, s85
    s_bfe_u32 s37, s39, 0x10003
    s_lshl_b32 s37, s37, 14
    s_add_u32 s85, s37, s85
    s_bfe_u32 s37, s39, 0x40004
    s_lshl_b32 s37, s37, 16
    s_add_u32 s85, s37, s85
    v_and_b32_dpp v104, v100, v10 row_newbcast:0 row_mask:0xf bank_mask:0xf
    v_and_b32_dpp v105, v100, v11 row_newbcast:0 row_mask:0xf bank_mask:0xf
    v_and_b32_dpp v106, v100, v12 row_newbcast:0 row_mask:0xf bank_mask:0xf
    v_and_b32_dpp v107, v100, v13 row_newbcast:0 row_mask:0xf bank_mask:0xf
    s_nop 1
    v_mfma_f32_16x16x32_bf16 v[116:119], v[128:131], v[104:107], v[116:119]
    v_and_b32_dpp v108, v100, v10 row_newbcast:4 row_mask:0xf bank_mask:0xf
    v_and_b32_dpp v109, v100, v11 row_newbcast:4 row_mask:0xf bank_mask:0xf
    v_and_b32_dpp v110, v100, v12 row_newbcast:4 row_mask:0xf bank_mask:0xf
    v_and_b32_dpp v111, v100, v13 row_newbcast:4 row_mask:0xf bank_mask:0xf
    s_waitcnt vmcnt(7)
    buffer_load_dwordx4 v[128:131], v62, s[64:67], s85 offen offset:0 nt
    v_mfma_f32_16x16x32_bf16 v[116:119], v[132:135], v[108:111], v[116:119]
    v_and_b32_dpp v104, v100, v10 row_newbcast:8 row_mask:0xf bank_mask:0xf
    v_and_b32_dpp v105, v100, v11 row_newbcast:8 row_mask:0xf bank_mask:0xf
    v_and_b32_dpp v106, v100, v12 row_newbcast:8 row_mask:0xf bank_mask:0xf
    v_and_b32_dpp v107, v100, v13 row_newbcast:8 row_mask:0xf bank_mask:0xf
    s_waitcnt vmcnt(7)
    buffer_load_dwordx4 v[132:135], v63, s[64:67], s85 offen offset:0 nt
    v_mfma_f32_16x16x32_bf16 v[116:119], v[136:139], v[104:107], v[116:119]
    v_and_b32_dpp v108, v100, v10 row_newbcast:12 row_mask:0xf bank_mask:0xf
    v_and_b32_dpp v109, v100, v11 row_newbcast:12 row_mask:0xf bank_mask:0xf
    v_and_b32_dpp v110, v100, v12 row_newbcast:12 row_mask:0xf bank_mask:0xf
    v_and_b32_dpp v111, v100, v13 row_newbcast:12 row_mask:0xf bank_mask:0xf
    s_waitcnt vmcnt(7)
    buffer_load_dwordx4 v[136:139], v62, s[64:67], s85 offen offset:1024 nt
    v_mfma_f32_16x16x32_bf16 v[116:119], v[140:143], v[108:111], v[116:119]
    v_and_b32_dpp v104, v101, v10 row_newbcast:0 row_mask:0xf bank_mask:0xf
    v_and_b32_dpp v105, v101, v11 row_newbcast:0 row_mask:0xf bank_mask:0xf
    v_and_b32_dpp v106, v101, v12 row_newbcast:0 row_mask:0xf bank_mask:0xf
    v_and_b32_dpp v107, v101, v13 row_newbcast:0 row_mask:0xf bank_mask:0xf
    s_waitcnt vmcnt(7)
    buffer_load_dwordx4 v[140:143], v63, s[64:67], s85 offen offset:1024 nt
    v_mfma_f32_16x16x32_bf16 v[116:119], v[144:147], v[104:107], v[116:119]
    s_add_u32 s87, s87, s92
    s_add_u32 s39, s87, s88
    s_bfe_u32 s37, s39, 0x10000
    s_lshl_b32 s37, s37, 13
    s_add_u32 s85, s37, s89
    s_bfe_u32 s37, s39, 0x10001
    s_lshl_b32 s37, s37, 12
    s_add_u32 s85, s37, s85
    s_bfe_u32 s37, s39, 0x10002
    s_lshl_b32 s37, s37, 11
    s_add_u32 s85, s37, s85
    s_bfe_u32 s37, s39, 0x10003
    s_lshl_b32 s37, s37, 14
    s_add_u32 s85, s37, s85
    s_bfe_u32 s37, s39, 0x40004
    s_lshl_b32 s37, s37, 16
    s_add_u32 s85, s37, s85
    v_and_b32_dpp v108, v101, v10 row_newbcast:4 row_mask:0xf bank_mask:0xf
    v_and_b32_dpp v109, v101, v11 row_newbcast:4 row_mask:0xf bank_mask:0xf
    v_and_b32_dpp v110, v101, v12 row_newbcast:4 row_mask:0xf bank_mask:0xf
    v_and_b32_dpp v111, v101, v13 row_newbcast:4 row_mask:0xf bank_mask:0xf
    s_waitcnt vmcnt(7)
    buffer_load_dwordx4 v[144:147], v62, s[64:67], s85 offen offset:0 nt
    v_mfma_f32_16x16x32_bf16 v[116:119], v[148:151], v[108:111], v[116:119]
    v_and_b32_dpp v104, v101, v10 row_newbcast:8 row_mask:0xf bank_mask:0xf
    v_and_b32_dpp v105, v101, v11 row_newbcast:8 row_mask:0xf bank_mask:0xf
    v_and_b32_dpp v106, v101, v12 row_newbcast:8 row_mask:0xf bank_mask:0xf
    v_and_b32_dpp v107, v101, v13 row_newbcast:8 row_mask:0xf bank_mask:0xf
    s_waitcnt vmcnt(7)
    buffer_load_dwordx4 v[148:151], v63, s[64:67], s85 offen offset:0 nt
    v_mfma_f32_16x16x32_bf16 v[116:119], v[152:155], v[104:107], v[116:119]
    v_and_b32_dpp v108, v101, v10 row_newbcast:12 row_mask:0xf bank_mask:0xf
    v_and_b32_dpp v109, v101, v11 row_newbcast:12 row_mask:0xf bank_mask:0xf
    v_and_b32_dpp v110, v101, v12 row_newbcast:12 row_mask:0xf bank_mask:0xf
    v_and_b32_dpp v111, v101, v13 row_newbcast:12 row_mask:0xf bank_mask:0xf
    s_waitcnt vmcnt(7)
    buffer_load_dwordx4 v[152:155], v62, s[64:67], s85 offen offset:1024 nt
    v_mfma_f32_16x16x32_bf16 v[116:119], v[156:159], v[108:111], v[116:119]
    s_branch L_vdyn
L_scretry:
    buffer_load_dwordx2 v[102:103], v55, s[48:51], s81 offen sc1
    s_waitcnt vmcnt(0)
    s_sub_u32 s84, s84, 1
    s_cmp_lg_u32 s84, 0
    s_cbranch_scc1 L_sccheck
    s_branch L_end
L_newmax:
    v_max_f32 v123, v102, v103
    v_mul_f32 v123, s83, v123
    s_nop 1
    v_max_f32_dpp v124, v123, v123 row_ror:4 row_mask:0xf bank_mask:0xf
    s_nop 1
    v_max_f32_dpp v124, v124, v124 row_ror:8 row_mask:0xf bank_mask:0xf
    v_mov_b32 v125, v124
    s_nop 1
    v_permlane16_swap_b32 v124, v125
    v_max_f32 v124, v124, v125
    v_mov_b32 v125, v124
    s_nop 1
    v_permlane32_swap_b32 v124, v125
    v_max_f32 v124, v124, v125
    v_max_f32 v124, v124, v120
    v_sub_f32 v125, v120, v124
    v_exp_f32 v125, v125
    v_mov_b32 v120, v124
    v_fma_f32 v123, v102, s83, -v120
    v_fma_f32 v122, v103, s83, -v120
    v_mul_f32 v121, v121, v125
    v_mul_f32 v116, v116, v125
    v_mul_f32 v117, v117, v125
    v_mul_f32 v118, v118, v125
    v_mul_f32 v119, v119, v125
    s_branch L_oldmax
L_rare_3:
    s_cmp_eq_u32 s97, 1
    s_cbranch_scc1 L_last_25
    s_mov_b64 exec, 1
    ds_add_rtn_u32 v5, v0, v18 offset:0
    s_mov_b64 exec, -1
    s_waitcnt lgkmcnt(0)
    v_readfirstlane_b32 s62, v5
    s_nop 0
    s_cmp_lg_u32 s62, 0
    s_cbranch_scc1 L_nodraw_26
    s_mov_b64 exec, 1
    global_atomic_add v19, v9, v18, s[30:31] offset:0 sc0 sc1
    s_mov_b64 exec, -1
L_nodraw_26:
    s_branch L_back_4
L_last_25:
    s_cmp_lg_u32 s62, 0
    s_cbranch_scc1 L_nopost_27
    v_add_u32 v19, 1, v19
    s_mov_b64 exec, 1
    ds_write_b32 v0, v19 offset:4
L_nopost_27:
    s_mov_b64 exec, 1
    ds_add_rtn_u32 v5, v0, v18 offset:8
    s_mov_b64 exec, -1
L_again_28:
    ds_read_b32 v4, v0 offset:4
    s_waitcnt lgkmcnt(0)
    v_readfirstlane_b32 s93, v4
    s_nop 0
    s_sub_u32 s93, s93, 1
    s_cbranch_scc1 L_retry_29
    v_add_u32 v0, 8, v0
    s_cmp_ge_u32 s93, 16
    s_cbranch_scc1 L_gone_6
    s_lshl_b32 s87, s93, 1
    s_add_u32 s87, s87, 224
    s_mov_b32 s92, 1
    v_mov_b32 v19, 64
    s_mov_b32 s62, 0
    s_cmp_ge_u32 s93, 15
    s_cbranch_scc1 L_lastone_30
    v_readfirstlane_b32 s62, v5
    s_nop 0
    s_cmp_lg_u32 s62, 0
    s_cbranch_scc1 L_nodraw_31
    s_mov_b64 exec, 1
    global_atomic_add v19, v9, v18, s[30:31] offset:0 sc0 sc1
    s_mov_b64 exec, -1
L_nodraw_31:
L_lastone_30:
    s_branch L_done_5
L_gone_6:
    s_mov_b64 s[64:65], s[56:57]
    v_mov_b32 v62, v126
    v_mov_b32 v63, v127
    s_lshl_b32 s87, s33, 1
    s_mov_b32 s92, 1
    v_add_u32 v0, 8, v0
    s_branch L_done_5
L_retry_13:
    s_sub_u32 s84, s84, 1
    s_cmp_lg_u32 s84, 0
    s_cbranch_scc1 L_again_12
    s_branch L_end
L_gone_10:
    s_mov_b64 s[64:65], s[56:57]
    v_mov_b32 v62, v126
    v_mov_b32 v63, v127
    s_lshl_b32 s87, s33, 1
    s_mov_b32 s92, 1
    v_add_u32 v0, 8, v0
    s_branch L_done_9
L_rare_16:
    s_cmp_eq_u32 s97, 1
    s_cbranch_scc1 L_last_32
    s_mov_b64 exec, 1
    ds_add_rtn_u32 v5, v0, v18 offset:0
    s_mov_b64 exec, -1
    s_waitcnt lgkmcnt(0)
    v_readfirstlane_b32 s62, v5
    s_nop 0
    s_cmp_lg_u32 s62, 0
    s_cbranch_scc1 L_nodraw_33
    s_mov_b64 exec, 1
    global_atomic_add v19, v9, v18, s[30:31] offset:4 sc0 sc1
    s_mov_b64 exec, -1
L_nodraw_33:
    s_branch L_back_17
L_last_32:
    s_cmp_lg_u32 s62, 0
    s_cbranch_scc1 L_nopost_34
    v_add_u32 v19, 1, v19
    s_mov_b64 exec, 1
    ds_write_b32 v0, v19 offset:4
L_nopost_34:
    s_mov_b64 exec, 1
    ds_add_rtn_u32 v5, v0, v18 offset:8
    s_mov_b64 exec, -1
L_again_35:
    ds_read_b32 v4, v0 offset:4
    s_waitcnt lgkmcnt(0)
    v_readfirstlane_b32 s93, v4
    s_nop 0
    s_sub_u32 s93, s93, 1
    s_cbranch_scc1 L_retry_36
    v_add_u32 v0, 8, v0
    s_cmp_ge_u32 s93, 16
    s_cbranch_scc1 L_gone_19
    s_lshl_b32 s81, s93, 7
    s_add_u32 s81, s81, s80
    buffer_load_dwordx2 v[102:103], v55, s[48:51], s81 offen sc1
    s_lshl_b32 s87, s93, 1
    s_add_u32 s87, s87, 224
    s_mov_b32 s92, 1
    v_mov_b32 v19, 64
    s_mov_b32 s62, 0
    s_cmp_ge_u32 s93, 15
    s_cbranch_scc1 L_lastone_37
    v_readfirstlane_b32 s62, v5
    s_nop 0
    s_cmp_lg_u32 s62, 0
    s_cbranch_scc1 L_nodraw_38
    s_mov_b64 exec, 1
    global_atomic_add v19, v9, v18, s[30:31] offset:4 sc0 sc1
    s_mov_b64 exec, -1
L_nodraw_38:
L_lastone_37:
    s_branch L_done_18
L_gone_19:
    s_mov_b32 s89, 134217728
    s_branch L_done_18
L_retry_22:
    s_sub_u32 s84, s84, 1
    s_cmp_lg_u32 s84, 0
    s_cbranch_scc1 L_again_21
    s_branch L_end
L_retry_29:
    s_sub_u32 s84, s84, 1
    s_cmp_lg_u32 s84, 0
    s_cbranch_scc1 L_again_28
    s_branch L_end
L_retry_36:
    s_sub_u32 s84, s84, 1
    s_cmp_lg_u32 s84, 0
    s_cbranch_scc1 L_again_35
    s_branch L_end
L_none:
    buffer_load_dwordx4 v[224:227], v54, s[48:51], s46 offen sc1
    s_mov_b32 s86, s44
    s_bitcmp1_b32 s90, 2
    s_cselect_b32 s44, 4194304, s44
    s_lshl_b32 s39, s34, 13
    s_add_u32 s39, s39, 98304
    s_mov_b32 m0, s39
    s_nop 0
    buffer_load_dwordx4 v20, s[40:43], s44 offen offset:0 nt lds
    buffer_load_dwordx4 v21, s[40:43], s44 offen offset:1024 nt lds
    buffer_load_dwordx4 v22, s[40:43], s44 offen offset:2048 nt lds
    buffer_load_dwordx4 v23, s[40:43], s44 offen offset:3072 nt lds
    s_lshl_b32 s39, s34, 13
    s_add_u32 s39, s39, 102400
    s_mov_b32 m0, s39
    s_add_u32 s44, s44, 16384
    buffer_load_dwordx4 v20, s[40:43], s44 offen offset:0 nt lds
    buffer_load_dwordx4 v21, s[40:43], s44 offen offset:1024 nt lds
    buffer_load_dwordx4 v22, s[40:43], s44 offen offset:2048 nt lds
    buffer_load_dwordx4 v23, s[40:43], s44 offen offset:3072 nt lds
    v_add_f32_dpp v121, v121, v121 row_ror:8 row_mask:0xf bank_mask:0xf
    s_nop 1
    v_add_f32_dpp v121, v121, v121 row_ror:4 row_mask:0xf bank_mask:0xf
    v_mov_b32 v125, v121
    s_nop 1
    v_permlane16_swap_b32 v121, v125
    v_add_f32 v121, v121, v125
    v_mov_b32 v125, v121
    s_nop 1
    v_permlane32_swap_b32 v121, v125
    v_add_f32 v121, v121, v125
    v_and_b32 v125, s82, v120
    v_sub_f32 v125, v120, v125
    s_mov_b32 vcc_lo, 0xff00ff00
    s_mov_b32 vcc_hi, 0xff00ff00
    s_branch L_bdone
L_last:
    buffer_load_dwordx4 v[224:227], v54, s[48:51], s46 offen sc1
    s_mov_b32 s86, s44
    s_bitcmp1_b32 s90, 2
    s_cselect_b32 s44, 4194304, s44
    v_and_b32_dpp v104, v100, v10 row_newbcast:0 row_mask:0xf bank_mask:0xf
    v_and_b32_dpp v105, v100, v11 row_newbcast:0 row_mask:0xf bank_mask:0xf
    v_and_b32_dpp v106, v100, v12 row_newbcast:0 row_mask:0xf bank_mask:0xf
    v_and_b32_dpp v107, v100, v13 row_newbcast:0 row_mask:0xf bank_mask:0xf
    s_lshl_b32 s39, s34, 13
    s_add_u32 s39, s39, 98304
    s_mov_b32 m0, s39
    s_nop 0
    buffer_load_dwordx4 v20, s[40:43], s44 offen offset:0 nt lds
    v_mfma_f32_16x16x32_bf16 v[116:119], v[128:131], v[104:107], v[116:119]
    v_and_b32_dpp v108, v100, v10 row_newbcast:4 row_mask:0xf bank_mask:0xf
    v_and_b32_dpp v109, v100, v11 row_newbcast:4 row_mask:0xf bank_mask:0xf
    v_and_b32_dpp v110, v100, v12 row_newbcast:4 row_mask:0xf bank_mask:0xf
    v_and_b32_dpp v111, v100, v13 row_newbcast:4 row_mask:0xf bank_mask:0xf
    s_waitcnt vmcnt(8)
    buffer_load_dwordx4 v21, s[40:43], s44 offen offset:1024 nt lds
    v_mfma_f32_16x16x32_bf16 v[116:119], v[132:135], v[108:111], v[116:119]
    v_add_f32_dpp v121, v121, v121 row_ror:8 row_mask:0xf bank_mask:0xf
    s_nop 1
    v_add_f32_dpp v121, v121, v121 row_ror:4 row_mask:0xf bank_mask:0xf
    v_mov_b32 v125, v121
    s_nop 1
    v_permlane16_swap_b32 v121, v125
    v_add_f32 v121, v121, v125
    v_mov_b32 v125, v121
    s_nop 1
    v_permlane32_swap_b32 v121, v125
    v_add_f32 v121, v121, v125
    v_and_b32 v125, s82, v120
    v_sub_f32 v125, v120, v125
    s_mov_b32 vcc_lo, 0xff00ff00
    s_mov_b32 vcc_hi, 0xff00ff00
    v_and_b32_dpp v104, v100, v10 row_newbcast:8 row_mask:0xf bank_mask:0xf
    v_and_b32_dpp v105, v100, v11 row_newbcast:8 row_mask:0xf bank_mask:0xf
    v_and_b32_dpp v106, v100, v12 row_newbcast:8 row_mask:0xf bank_mask:0xf
    v_and_b32_dpp v107, v100, v13 row_newbcast:8 row_mask:0xf bank_mask:0xf
    s_waitcnt vmcnt(8)
    buffer_load_dwordx4 v22, s[40:43], s44 offen offset:2048 nt lds
    v_mfma_f32_16x16x32_bf16 v[116:119], v[136:139], v[104:107], v[116:119]
    v_and_b32_dpp v108, v100, v10 row_newbcast:12 row_mask:0xf bank_mask:0xf
    v_and_b32_dpp v109, v100, v11 row_newbcast:12 row_mask:0xf bank_mask:0xf
    v_and_b32_dpp v110, v100, v12 row_newbcast:12 row_mask:0xf bank_mask:0xf
    v_and_b32_dpp v111, v100, v13 row_newbcast:12 row_mask:0xf bank_mask:0xf
    s_waitcnt vmcnt(8)
    buffer_load_dwordx4 v23, s[40:43], s44 offen offset:3072 nt lds
    v_mfma_f32_16x16x32_bf16 v[116:119], v[140:143], v[108:111], v[116:119]
    v_and_b32_dpp v104, v101, v10 row_newbcast:0 row_mask:0xf bank_mask:0xf
    v_and_b32_dpp v105, v101, v11 row_newbcast:0 row_mask:0xf bank_mask:0xf
    v_and_b32_dpp v106, v101, v12 row_newbcast:0 row_mask:0xf bank_mask:0xf
    v_and_b32_dpp v107, v101, v13 row_newbcast:0 row_mask:0xf bank_mask:0xf
    s_waitcnt vmcnt(8)
    s_lshl_b32 s39, s34, 13
    s_add_u32 s39, s39, 102400
    s_mov_b32 m0, s39
    s_add_u32 s44, s44, 16384
    buffer_load_dwordx4 v20, s[40:43], s44 offen offset:0 nt lds
    v_mfma_f32_16x16x32_bf16 v[116:119], v[144:147], v[104:107], v[116:119]
    v_and_b32_dpp v108, v101, v10 row_newbcast:4 row_mask:0xf bank_mask:0xf
    v_and_b32_dpp v109, v101, v11 row_newbcast:4 row_mask:0xf bank_mask:0xf
    v_and_b32_dpp v110, v101, v12 row_newbcast:4 row_mask:0xf bank_mask:0xf
    v_and_b32_dpp v111, v101, v13 row_newbcast:4 row_mask:0xf bank_mask:0xf
    s_waitcnt vmcnt(8)
    buffer_load_dwordx4 v21, s[40:43], s44 offen offset:1024 nt lds
    v_mfma_f32_16x16x32_bf16 v[116:119], v[148:151], v[108:111], v[116:119]
    v_and_b32_dpp v104, v101, v10 row_newbcast:8 row_mask:0xf bank_mask:0xf
    v_and_b32_dpp v105, v101, v11 row_newbcast:8 row_mask:0xf bank_mask:0xf
    v_and_b32_dpp v106, v101, v12 row_newbcast:8 row_mask:0xf bank_mask:0xf
    v_and_b32_dpp v107, v101, v13 row_newbcast:8 row_mask:0xf bank_mask:0xf
    s_waitcnt vmcnt(8)
    buffer_load_dwordx4 v22, s[40:43], s44 offen offset:2048 nt lds
    v_mfma_f32_16x16x32_bf16 v[116:119], v[152:155], v[104:107], v[116:119]
    v_and_b32_dpp v108, v101, v10 row_newbcast:12 row_mask:0xf bank_mask:0xf
    v_and_b32_dpp v109, v101, v11 row_newbcast:12 row_mask:0xf bank_mask:0xf
    v_and_b32_dpp v110, v101, v12 row_newbcast:12 row_mask:0xf bank_mask:0xf
    v_and_b32_dpp v111, v101, v13 row_newbcast:12 row_mask:0xf bank_mask:0xf
    s_waitcnt vmcnt(8)
    buffer_load_dwordx4 v23, s[40:43], s44 offen offset:3072 nt lds
    v_mfma_f32_16x16x32_bf16 v[116:119], v[156:159], v[108:111], v[116:119]
L_bdone:
    s_nop 7
    v_cndmask_b32 v116, v116, v120, vcc
    v_cndmask_b32 v117, v117, v121, vcc
    v_cndmask_b32 v118, v118, v125, vcc
    v_and_or_b32 v119, v119, s82, v8
    v_and_or_b32 v116, v116, s82, v8
    v_and_or_b32 v117, v117, s82, v8
    v_and_or_b32 v118, v118, s82, v8
    s_mov_b32 exec_lo, 0xff01ff
    s_mov_b32 exec_hi, 0xff00ff
    buffer_store_dwordx4 v[116:119], v79, s[48:51], s96 offen sc1
    s_mov_b64 exec, -1
    s_bitcmp1_b32 s90, 2
    s_cbranch_scc1 L_ctx
    buffer_load_dwordx4 v[204:207], v53, s[48:51], s47 offen sc1
    buffer_load_dwordx4 v[192:195], v50, s[48:51], s47 offen sc1
    buffer_load_dwordx4 v[196:199], v51, s[48:51], s47 offen sc1
    buffer_load_dwordx4 v[200:203], v52, s[48:51], s47 offen sc1
    v_xor_b32 v104, s35, v116
    v_xor_b32 v105, s35, v117
    v_xor_b32 v106, s35, v118
    v_xor_b32 v107, s35, v119
    v_mov_b32 v5, 0xff7f0000
    v_cndmask_b32 v120, v120, v5, vcc
    v_and_b32 v121, s82, v121
    s_mov_b32 s86, 0x88888888
    s_mov_b32 s87, 0x88888888
    s_waitcnt vmcnt(0)
L_hop1poll:
    v_xor_b32 v192, s35, v192
    v_xor_b32 v193, s35, v193
    v_xor_b32 v194, s35, v194
    v_xor_b32 v195, s35, v195
    v_xor_b32 v196, s35, v196
    v_xor_b32 v197, s35, v197
    v_xor_b32 v198, s35, v198
    v_xor_b32 v199, s35, v199
    v_xor_b32 v200, s35, v200
    v_xor_b32 v201, s35, v201
    v_xor_b32 v202, s35, v202
    v_xor_b32 v203, s35, v203
    v_xor_b32 v204, s35, v204
    v_xor_b32 v205, s35, v205
    v_xor_b32 v206, s35, v206
    v_xor_b32 v207, s35, v207
    v_or_b32 v4, v192, v193
    v_or3_b32 v4, v4, v194, v195
    v_or3_b32 v4, v4, v196, v197
    v_or3_b32 v4, v4, v198, v199
    v_or3_b32 v4, v4, v200, v201
    v_or3_b32 v4, v4, v202, v203
    v_or3_b32 v4, v4, v204, v205
    v_or3_b32 v4, v4, v206, v207
    v_and_b32 v4, 0xff, v4
    v_cmp_ne_u32 vcc, 0, v4
    v_add_f32 v122, v204, v206
    s_cbranch_vccz L_hop1ok
    buffer_load_dwordx4 v[204:207], v53, s[48:51], s47 offen sc1
    buffer_load_dwordx4 v[192:195], v50, s[48:51], s47 offen sc1
    buffer_load_dwordx4 v[196:199], v51, s[48:51], s47 offen sc1
    buffer_load_dwordx4 v[200:203], v52, s[48:51], s47 offen sc1
    s_waitcnt vmcnt(0)
    s_sub_u32 s84, s84, 1
    s_cmp_lg_u32 s84, 0
    s_cbranch_scc1 L_hop1poll
    s_branch L_end
L_ctx:
    s_mov_b32 s44, s86
    s_lshl_b32 s39, s34, 13
    s_add_u32 s39, s39, 98304
    s_mov_b32 m0, s39
    s_nop 0
    buffer_load_dwordx4 v20, s[40:43], s44 offen offset:0 nt lds
    buffer_load_dwordx4 v21, s[40:43], s44 offen offset:1024 nt lds
    buffer_load_dwordx4 v22, s[40:43], s44 offen offset:2048 nt lds
    buffer_load_dwordx4 v23, s[40:43], s44 offen offset:3072 nt lds
    s_lshl_b32 s39, s34, 13
    s_add_u32 s39, s39, 102400
    s_mov_b32 m0, s39
    s_add_u32 s44, s44, 16384
    buffer_load_dwordx4 v20, s[40:43], s44 offen offset:0 nt lds
    buffer_load_dwordx4 v21, s[40:43], s44 offen offset:1024 nt lds
    buffer_load_dwordx4 v22, s[40:43], s44 offen offset:2048 nt lds
    buffer_load_dwordx4 v23, s[40:43], s44 offen offset:3072 nt lds
    s_waitcnt vmcnt(9)
L_ctxcheck:
    v_xor_b32 v224, s35, v224
    v_xor_b32 v225, s35, v225
    v_xor_b32 v226, s35, v226
    v_xor_b32 v227, s35, v227
    v_or_b32 v4, v224, v225
    v_or3_b32 v4, v4, v226, v227
    v_and_b32 v4, 0xff, v4
    v_cmp_ne_u32 vcc, 0, v4
    s_cbranch_vccz L_ctxok
    buffer_load_dwordx4 v[224:227], v54, s[48:51], s46 offen sc1
    s_waitcnt vmcnt(0)
    s_sub_u32 s84, s84, 1
    s_cmp_lg_u32 s84, 0
    s_cbranch_scc1 L_ctxcheck
    s_branch L_end
L_ctxok:
    v_cvt_pk_bf16_f32 v224, v224, v225
    v_cvt_pk_bf16_f32 v225, v226, v227
    ds_write_b64 v35, v[224:225]
    s_branch L_final
L_hop1ok:
    v_cndmask_b32 v122, v122, v120, s[86:87]
    v_cndmask_b32 v123, v205, v121, s[86:87]
    s_nop 0
    v_max_f32_dpp v5, v122, v122 quad_perm:[1,0,3,2] row_mask:0xf bank_mask:0xf
    s_nop 1
    v_max_f32_dpp v5, v5, v5 quad_perm:[2,3,0,1] row_mask:0xf bank_mask:0xf
    s_nop 1
    v_max_f32_dpp v5, v5, v5 row_ror:8 row_mask:0xf bank_mask:0xf
    v_sub_f32 v122, v122, v5
    v_exp_f32 v122, v122
    s_nop 0
    v_mul_f32 v123, v123, v122
    v_mul_f32_dpp v104, v122, v104 quad_perm:[3,3,3,3] row_mask:0xf bank_mask:0xf
    v_mul_f32_dpp v105, v122, v105 quad_perm:[3,3,3,3] row_mask:0xf bank_mask:0xf
    v_mul_f32_dpp v106, v122, v106 quad_perm:[3,3,3,3] row_mask:0xf bank_mask:0xf
    v_mul_f32_dpp v107, v122, v107 quad_perm:[3,3,3,3] row_mask:0xf bank_mask:0xf
    v_add_f32_dpp v123, v123, v123 quad_perm:[1,0,3,2] row_mask:0xf bank_mask:0xf
    v_fmac_f32_dpp v104, v122, v192 quad_perm:[0,0,0,0] row_mask:0xf bank_mask:0xf
    v_fmac_f32_dpp v105, v122, v193 quad_perm:[0,0,0,0] row_mask:0xf bank_mask:0xf
    v_fmac_f32_dpp v106, v122, v194 quad_perm:[0,0,0,0] row_mask:0xf bank_mask:0xf
    v_fmac_f32_dpp v107, v122, v195 quad_perm:[0,0,0,0] row_mask:0xf bank_mask:0xf
    v_add_f32_dpp v123, v123, v123 quad_perm:[2,3,0,1] row_mask:0xf bank_mask:0xf
    v_fmac_f32_dpp v104, v122, v196 quad_perm:[1,1,1,1] row_mask:0xf bank_mask:0xf
    v_fmac_f32_dpp v105, v122, v197 quad_perm:[1,1,1,1] row_mask:0xf bank_mask:0xf
    v_fmac_f32_dpp v106, v122, v198 quad_perm:[1,1,1,1] row_mask:0xf bank_mask:0xf
    v_fmac_f32_dpp v107, v122, v199 quad_perm:[1,1,1,1] row_mask:0xf bank_mask:0xf
    v_add_f32_dpp v123, v123, v123 row_ror:8 row_mask:0xf bank_mask:0xf
    v_fmac_f32_dpp v104, v122, v200 quad_perm:[2,2,2,2] row_mask:0xf bank_mask:0xf
    v_fmac_f32_dpp v105, v122, v201 quad_perm:[2,2,2,2] row_mask:0xf bank_mask:0xf
    v_fmac_f32_dpp v106, v122, v202 quad_perm:[2,2,2,2] row_mask:0xf bank_mask:0xf
    v_fmac_f32_dpp v107, v122, v203 quad_perm:[2,2,2,2] row_mask:0xf bank_mask:0xf
    v_rcp_f32 v123, v123
    v_add_f32_dpp v104, v104, v104 row_ror:8 row_mask:0xf bank_mask:0xf
    v_add_f32_dpp v105, v105, v105 row_ror:8 row_mask:0xf bank_mask:0xf
    v_add_f32_dpp v106, v106, v106 row_ror:8 row_mask:0xf bank_mask:0xf
    v_add_f32_dpp v107, v107, v107 row_ror:8 row_mask:0xf bank_mask:0xf
    v_mul_f32 v104, v104, v123
    v_mul_f32 v105, v105, v123
    v_mul_f32 v106, v106, v123
    v_mul_f32 v107, v107, v123
    v_cvt_pk_bf16_f32 v104, v104, v105
    v_cvt_pk_bf16_f32 v106, v106, v107
    s_mov_b32 exec_lo, 0xff00ff
    s_mov_b32 exec_hi, 0xff00ff
    ds_write_b16 v31, v104
    ds_write_b16_d16_hi v31, v104 offset:16
    ds_write_b16 v31, v106 offset:32
    ds_write_b16_d16_hi v31, v106 offset:48
    s_mov_b64 exec, -1
L_final:
    s_waitcnt vmcnt(0) lgkmcnt(0)
    s_barrier
    ds_read_b64_tr_b16 v[128:129], v24 offset:0
    ds_read_b64_tr_b16 v[130:131], v25 offset:1024
    ds_read_b128 v[160:163], v28 offset:0
    ds_read_b64_tr_b16 v[132:133], v24 offset:8192
    ds_read_b64_tr_b16 v[134:135], v25 offset:9216
    ds_read_b128 v[164:167], v28 offset:64
    ds_read_b64_tr_b16 v[136:137], v24 offset:16384
    ds_read_b64_tr_b16 v[138:139], v25 offset:17408
    ds_read_b128 v[168:171], v28 offset:128
    ds_read_b64_tr_b16 v[140:141], v24 offset:24576
    ds_read_b64_tr_b16 v[142:143], v25 offset:25600
    ds_read_b128 v[172:175], v28 offset:192
    ds_read_b64_tr_b16 v[144:145], v26 offset:0
    ds_read_b64_tr_b16 v[146:147], v27 offset:1024
    ds_read_b128 v[176:179], v29 offset:0
    s_waitcnt lgkmcnt(12)
    v_mfma_f32_16x16x32_bf16 v[112:115], v[128:131], v[160:163], 0
    ds_read_b64_tr_b16 v[148:149], v26 offset:8192
    ds_read_b64_tr_b16 v[150:151], v27 offset:9216
    ds_read_b128 v[180:183], v29 offset:64
    s_waitcnt lgkmcnt(12)
    v_mfma_f32_16x16x32_bf16 v[112:115], v[132:135], v[164:167], v[112:115]
    ds_read_b64_tr_b16 v[152:153], v26 offset:16384
    ds_read_b64_tr_b16 v[154:155], v27 offset:17408
    ds_read_b128 v[184:187], v29 offset:128
    s_waitcnt lgkmcnt(12)
    v_mfma_f32_16x16x32_bf16 v[112:115], v[136:139], v[168:171], v[112:115]
    ds_read_b64_tr_b16 v[156:157], v26 offset:24576
    ds_read_b64_tr_b16 v[158:159], v27 offset:25600
    ds_read_b128 v[188:191], v29 offset:192
    s_waitcnt lgkmcnt(12)
    v_mfma_f32_16x16x32_bf16 v[112:115], v[140:143], v[172:175], v[112:115]
    s_waitcnt lgkmcnt(9)
    v_mfma_f32_16x16x32_bf16 v[112:115], v[144:147], v[176:179], v[112:115]
    s_waitcnt lgkmcnt(6)
    v_mfma_f32_16x16x32_bf16 v[112:115], v[148:151], v[180:183], v[112:115]
    s_waitcnt lgkmcnt(3)
    v_mfma_f32_16x16x32_bf16 v[112:115], v[152:155], v[184:187], v[112:115]
    s_waitcnt lgkmcnt(0)
    v_mfma_f32_16x16x32_bf16 v[112:115], v[156:159], v[188:191], v[112:115]
    s_add_u32 s37, s71, 4096
    s_cmp_eq_u32 s70, 1
    s_mov_b32 exec_lo, 0xff00ff
    s_mov_b32 exec_hi, 0xff00ff
    s_nop 3
    v_and_or_b32 v112, v112, s82, v8
    v_and_or_b32 v113, v113, s82, v8
    v_and_or_b32 v114, v114, s82, v8
    v_and_or_b32 v115, v115, s82, v8
    s_cbranch_scc1 L_ylocal
    buffer_store_dwordx4 v[112:115], v30, s[48:51], s45 offen sc1
    s_branch L_ydone
L_ylocal:
    buffer_store_dwordx4 v[112:115], v30, s[48:51], s45 offen
L_ydone:
    s_mov_b64 exec, -1
    s_cmp_lg_u32 s34, 0
    s_cbranch_scc1 L_done
L_hop2:
    buffer_load_dwordx4 v[224:227], v32, s[48:51], s71 offen sc1
    buffer_load_dwordx4 v[228:231], v32, s[48:51], s37 offen sc1
    s_waitcnt vmcnt(0)
    v_xor_b32 v224, s35, v224
    v_xor_b32 v225, s35, v225
    v_xor_b32 v226, s35, v226
    v_xor_b32 v227, s35, v227
    v_xor_b32 v228, s35, v228
    v_xor_b32 v229, s35, v229
    v_xor_b32 v230, s35, v230
    v_xor_b32 v231, s35, v231
    v_or_b32 v4, v224, v225
    v_or3_b32 v4, v4, v226, v227
    v_or3_b32 v4, v4, v228, v229
    v_or3_b32 v4, v4, v230, v231
    v_and_b32 v4, 0xff, v4
    v_cmp_ne_u32 vcc, 0, v4
    v_add_f32 v232, v224, v228
    v_add_f32 v233, v225, v229
    v_add_f32 v234, v226, v230
    v_add_f32 v235, v227, v231
    s_cbranch_vccz L_hop2ok
    s_sub_u32 s84, s84, 1
    s_cmp_lg_u32 s84, 0
    s_cbranch_scc1 L_hop2
    s_branch L_end
L_hop2ok:
    v_permlane16_swap_b32 v232, v233
    v_permlane16_swap_b32 v234, v235
    v_add_f32 v232, v232, v233
    v_add_f32 v234, v234, v235
    s_nop 1
    v_permlane32_swap_b32 v232, v234
    v_add_f32 v232, v232, v234
    s_nop 1
    v_add_f32_dpp v232, v232, v232 row_ror:8 row_mask:0xf bank_mask:0xf
    s_nop 1
    v_add_f32_dpp v232, v232, v232 row_ror:4 row_mask:0xf bank_mask:0xf
    v_cvt_pk_bf16_f32 v232, v232, v232
    s_mov_b32 exec_lo, 0xf000f
    s_mov_b32 exec_hi, 0xf000f
    buffer_store_short v232, v33, s[72:75], 0 offen
    s_cmp_lg_u32 s2, 0
    s_cbranch_scc1 L_done
    v_mov_b32 v4, 0
    s_mov_b64 exec, 1
    buffer_store_dword v8, v4, s[48:51], 0 offen
L_done:
L_end:
    s_endpgm
L_qp:
    v_lshlrev_b32 v4, 18, v2
    v_lshl_add_u32 v14, v3, 4, v4
    v_lshrrev_b32 v5, 3, v3
    v_lshlrev_b32 v5, 10, v5
    v_lshl_add_u32 v15, v2, 6, v5
    s_cmp_eq_u32 s33, 0
    s_cselect_b32 s61, 3, 2
    s_xor_b32 s61, s61, s32
    s_lshl_b32 s86, s34, 8
    s_lshl_b32 s63, s34, 20
    s_lshl_b32 s38, s61, 8
    s_add_u32 s63, s63, s38
    s_mov_b32 s42, 4194304
    s_mov_b32 s43, 0x20000
    s_mov_b32 s46, 4096
    s_mov_b32 s47, 0x20000
    s_cmp_eq_u32 s33, 0
    s_waitcnt lgkmcnt(0)
    s_cselect_b64 s[40:41], s[22:23], s[8:9]
    s_cselect_b64 s[44:45], s[16:17], s[4:5]
    buffer_load_dwordx4 a[128:131], v14, s[40:43], s63 offen nt
    s_add_u32 s63, s63, 8192
    buffer_load_dwordx4 a[132:135], v14, s[40:43], s63 offen nt
    s_add_u32 s63, s63, 8192
    buffer_load_dwordx4 v[20:23], v15, s[44:47], s86 offen offset:0
    buffer_load_dwordx4 v[36:39], v15, s[44:47], s86 offen offset:2048
    buffer_load_dwordx4 a[136:139], v14, s[40:43], s63 offen nt
    s_add_u32 s63, s63, 8192
    buffer_load_dwordx4 a[140:143], v14, s[40:43], s63 offen nt
    s_add_u32 s63, s63, 8192
    buffer_load_dwordx4 a[144:147], v14, s[40:43], s63 offen nt
    s_add_u32 s63, s63, 8192
    buffer_load_dwordx4 a[148:151], v14, s[40:43], s63 offen nt
    s_add_u32 s63, s63, 8192
    buffer_load_dwordx4 a[152:155], v14, s[40:43], s63 offen nt
    s_add_u32 s63, s63, 8192
    buffer_load_dwordx4 a[156:159], v14, s[40:43], s63 offen nt
    s_add_u32 s63, s63, 8192
    s_load_dword s35, s[30:31], 0
    s_mov_b32 s48, s30
    s_and_b32 s49, s31, 0xffff
    s_mov_b32 s50, 8388608
    s_mov_b32 s51, 0x20000
    s_mov_b32 s82, 0xffffff00
    s_mov_b32 s83, 0x3e0293ee
    s_mov_b32 s84, 8388608
    v_and_b32 v4, 1, v1
    v_lshlrev_b32 v4, 4, v4
    v_mov_b32 v5, 0xffff
    v_lshlrev_b32 v4, v4, v5
    v_bfe_u32 v5, v1, 1, 2
    v_cmp_eq_u32 vcc, 0, v5
    s_nop 1
    v_cndmask_b32 v10, 0, v4, vcc
    v_cmp_eq_u32 vcc, 1, v5
    s_nop 1
    v_cndmask_b32 v11, 0, v4, vcc
    v_cmp_eq_u32 vcc, 2, v5
    s_nop 1
    v_cndmask_b32 v12, 0, v4, vcc
    v_cmp_eq_u32 vcc, 3, v5
    s_nop 1
    v_cndmask_b32 v13, 0, v4, vcc
    buffer_load_dwordx4 v[24:27], v15, s[44:47], s86 offen offset:16
    buffer_load_dwordx4 v[40:43], v15, s[44:47], s86 offen offset:2064
    buffer_load_dwordx4 v[28:31], v15, s[44:47], s86 offen offset:32
    buffer_load_dwordx4 v[44:47], v15, s[44:47], s86 offen offset:2080
    buffer_load_dwordx4 v[32:35], v15, s[44:47], s86 offen offset:48
    buffer_load_dwordx4 v[48:51], v15, s[44:47], s86 offen offset:2096
    s_lshl_b32 s38, s61, 10
    s_add_u32 s36, s38, 65536
    s_lshr_b32 s38, s61, 3
    s_lshl_b32 s38, s38, 8
    s_add_u32 s36, s38, s36
    s_lshl_b32 s38, s34, 23
    s_add_u32 s36, s38, s36
    v_mov_b32 v18, 0
    v_mov_b32 v19, 0
    s_cmp_eq_u32 s33, 0
    s_cselect_b32 s38, s36, 8388608
    s_mov_b64 exec, 1
    buffer_store_dwordx2 v[18:19], v19, s[48:51], s38 offen sc1
    s_mov_b64 exec, -1
    buffer_load_dwordx4 a[160:163], v14, s[40:43], s63 offen nt
    s_add_u32 s63, s63, 8192
    buffer_load_dwordx4 a[164:167], v14, s[40:43], s63 offen nt
    s_add_u32 s63, s63, 8192
    buffer_load_dwordx4 a[168:171], v14, s[40:43], s63 offen nt
    s_add_u32 s63, s63, 8192
    buffer_load_dwordx4 a[172:175], v14, s[40:43], s63 offen nt
    s_add_u32 s63, s63, 8192
    s_mov_b32 s80, 0x01000100
    s_mov_b32 s81, 0x03020302
    s_waitcnt vmcnt(17)
    buffer_load_dwordx4 a[176:179], v14, s[40:43], s63 offen nt
    s_add_u32 s63, s63, 8192
    v_perm_b32 v4, v20, v20, s80
    v_perm_b32 v5, v36, v36, s80
    v_and_b32 v52, v4, v10
    v_and_b32 v53, v4, v11
    v_and_b32 v54, v4, v12
    v_and_b32 v55, v4, v13
    v_and_b32 v56, v5, v10
    v_and_b32 v57, v5, v11
    v_and_b32 v58, v5, v12
    v_and_b32 v59, v5, v13
    v_mfma_f32_16x16x32_bf16 v[60:63], a[128:131], v[52:55], 0
    s_nop 0
    v_mfma_f32_16x16x32_bf16 v[64:67], a[128:131], v[56:59], 0
    buffer_load_dwordx4 a[180:183], v14, s[40:43], s63 offen nt
    s_add_u32 s63, s63, 8192
    v_perm_b32 v4, v20, v20, s81
    v_perm_b32 v5, v36, v36, s81
    v_and_b32 v52, v4, v10
    v_and_b32 v53, v4, v11
    v_and_b32 v54, v4, v12
    v_and_b32 v55, v4, v13
    v_and_b32 v56, v5, v10
    v_and_b32 v57, v5, v11
    v_and_b32 v58, v5, v12
    v_and_b32 v59, v5, v13
    v_mfma_f32_16x16x32_bf16 v[60:63], a[132:135], v[52:55], v[60:63]
    s_nop 0
    v_mfma_f32_16x16x32_bf16 v[64:67], a[132:135], v[56:59], v[64:67]
    s_waitcnt vmcnt(18)
    buffer_load_dwordx4 a[184:187], v14, s[40:43], s63 offen nt
    s_add_u32 s63, s63, 8192
    v_perm_b32 v4, v21, v21, s80
    v_perm_b32 v5, v37, v37, s80
    v_and_b32 v52, v4, v10
    v_and_b32 v53, v4, v11
    v_and_b32 v54, v4, v12
    v_and_b32 v55, v4, v13
    v_and_b32 v56, v5, v10
    v_and_b32 v57, v5, v11
    v_and_b32 v58, v5, v12
    v_and_b32 v59, v5, v13
    v_mfma_f32_16x16x32_bf16 v[60:63], a[136:139], v[52:55], v[60:63]
    s_nop 0
    v_mfma_f32_16x16x32_bf16 v[64:67], a[136:139], v[56:59], v[64:67]
    s_waitcnt vmcnt(18)
    buffer_load_dwordx4 a[188:191], v14, s[40:43], s63 offen nt
    s_add_u32 s63, s63, 8192
    v_perm_b32 v4, v21, v21, s81
    v_perm_b32 v5, v37, v37, s81
    v_and_b32 v52, v4, v10
    v_and_b32 v53, v4, v11
    v_and_b32 v54, v4, v12
    v_and_b32 v55, v4, v13
    v_and_b32 v56, v5, v10
    v_and_b32 v57, v5, v11
    v_and_b32 v58, v5, v12
    v_and_b32 v59, v5, v13
    v_mfma_f32_16x16x32_bf16 v[60:63], a[140:143], v[52:55], v[60:63]
    s_nop 0
    v_mfma_f32_16x16x32_bf16 v[64:67], a[140:143], v[56:59], v[64:67]
    s_waitcnt vmcnt(18)
    buffer_load_dwordx4 a[192:195], v14, s[40:43], s63 offen nt
    s_add_u32 s63, s63, 8192
    v_lshrrev_b32 v4, 2, v3
    v_and_b32 v5, 3, v3
    v_lshlrev_b32 v76, 8, v4
    v_lshlrev_b32 v126, 8, v2
    v_lshl_add_u32 v76, v2, 6, v76
    v_lshl_add_u32 v76, v5, 4, v76
    v_lshl_add_u32 v126, v3, 4, v126
    v_xor_b32 v77, 32768, v76
    v_xor_b32 v127, 32768, v126
    s_add_u32 s3, s34, s33
    s_and_b32 s3, s3, 3
    s_lshl_b32 s89, s3, 5
    s_add_u32 s89, s89, s32
    s_lshl_b32 s89, s89, 20
    s_mul_i32 s88, s32, 8
    s_mul_i32 s38, s3, 2
    s_add_u32 s88, s88, s38
    s_lshl_b32 s87, s33, 1
    v_perm_b32 v4, v22, v22, s80
    v_perm_b32 v5, v38, v38, s80
    v_and_b32 v52, v4, v10
    v_and_b32 v53, v4, v11
    v_and_b32 v54, v4, v12
    v_and_b32 v55, v4, v13
    v_and_b32 v56, v5, v10
    v_and_b32 v57, v5, v11
    v_and_b32 v58, v5, v12
    v_and_b32 v59, v5, v13
    v_mfma_f32_16x16x32_bf16 v[60:63], a[144:147], v[52:55], v[60:63]
    s_nop 0
    v_mfma_f32_16x16x32_bf16 v[64:67], a[144:147], v[56:59], v[64:67]
    s_waitcnt vmcnt(18)
    buffer_load_dwordx4 a[196:199], v14, s[40:43], s63 offen nt
    s_add_u32 s63, s63, 8192
    v_perm_b32 v4, v22, v22, s81
    v_perm_b32 v5, v38, v38, s81
    v_and_b32 v52, v4, v10
    v_and_b32 v53, v4, v11
    v_and_b32 v54, v4, v12
    v_and_b32 v55, v4, v13
    v_and_b32 v56, v5, v10
    v_and_b32 v57, v5, v11
    v_and_b32 v58, v5, v12
    v_and_b32 v59, v5, v13
    v_mfma_f32_16x16x32_bf16 v[60:63], a[148:151], v[52:55], v[60:63]
    s_nop 0
    v_mfma_f32_16x16x32_bf16 v[64:67], a[148:151], v[56:59], v[64:67]
    s_waitcnt vmcnt(18)
    buffer_load_dwordx4 a[200:203], v14, s[40:43], s63 offen nt
    s_add_u32 s63, s63, 8192
    v_perm_b32 v4, v23, v23, s80
    v_perm_b32 v5, v39, v39, s80
    v_and_b32 v52, v4, v10
    v_and_b32 v53, v4, v11
    v_and_b32 v54, v4, v12
    v_and_b32 v55, v4, v13
    v_and_b32 v56, v5, v10
    v_and_b32 v57, v5, v11
    v_and_b32 v58, v5, v12
    v_and_b32 v59, v5, v13
    v_mfma_f32_16x16x32_bf16 v[60:63], a[152:155], v[52:55], v[60:63]
    s_nop 0
    v_mfma_f32_16x16x32_bf16 v[64:67], a[152:155], v[56:59], v[64:67]
    s_waitcnt vmcnt(18)
    buffer_load_dwordx4 a[204:207], v14, s[40:43], s63 offen nt
    s_add_u32 s63, s63, 8192
    v_perm_b32 v4, v23, v23, s81
    v_perm_b32 v5, v39, v39, s81
    v_and_b32 v52, v4, v10
    v_and_b32 v53, v4, v11
    v_and_b32 v54, v4, v12
    v_and_b32 v55, v4, v13
    v_and_b32 v56, v5, v10
    v_and_b32 v57, v5, v11
    v_and_b32 v58, v5, v12
    v_and_b32 v59, v5, v13
    v_mfma_f32_16x16x32_bf16 v[60:63], a[156:159], v[52:55], v[60:63]
    s_nop 0
    v_mfma_f32_16x16x32_bf16 v[64:67], a[156:159], v[56:59], v[64:67]
    s_waitcnt vmcnt(17)
    s_waitcnt vmcnt(11)
    buffer_load_dwordx4 a[208:211], v14, s[40:43], s63 offen nt
    s_add_u32 s63, s63, 8192
    s_mov_b32 s52, s18
    s_and_b32 s53, s19, 0xffff
    s_mov_b32 s54, 134217728
    s_mov_b32 s55, 0x20000
    s_mov_b32 s56, s20
    s_and_b32 s57, s21, 0xffff
    s_mov_b32 s58, 134217728
    s_mov_b32 s59, 0x20000
    v_perm_b32 v4, v24, v24, s80
    v_perm_b32 v5, v40, v40, s80
    v_and_b32 v52, v4, v10
    v_and_b32 v53, v4, v11
    v_and_b32 v54, v4, v12
    v_and_b32 v55, v4, v13
    v_and_b32 v56, v5, v10
    v_and_b32 v57, v5, v11
    v_and_b32 v58, v5, v12
    v_and_b32 v59, v5, v13
    v_mfma_f32_16x16x32_bf16 v[60:63], a[160:163], v[52:55], v[60:63]
    s_nop 0
    v_mfma_f32_16x16x32_bf16 v[64:67], a[160:163], v[56:59], v[64:67]
    s_waitcnt vmcnt(11)
    buffer_load_dwordx4 a[212:215], v14, s[40:43], s63 offen nt
    s_add_u32 s63, s63, 8192
    v_perm_b32 v4, v24, v24, s81
    v_perm_b32 v5, v40, v40, s81
    v_and_b32 v52, v4, v10
    v_and_b32 v53, v4, v11
    v_and_b32 v54, v4, v12
    v_and_b32 v55, v4, v13
    v_and_b32 v56, v5, v10
    v_and_b32 v57, v5, v11
    v_and_b32 v58, v5, v12
    v_and_b32 v59, v5, v13
    v_mfma_f32_16x16x32_bf16 v[60:63], a[164:167], v[52:55], v[60:63]
    s_nop 0
    v_mfma_f32_16x16x32_bf16 v[64:67], a[164:167], v[56:59], v[64:67]
    s_waitcnt vmcnt(11)
    buffer_load_dwordx4 a[216:219], v14, s[40:43], s63 offen nt
    s_add_u32 s63, s63, 8192
    v_perm_b32 v4, v25, v25, s80
    v_perm_b32 v5, v41, v41, s80
    v_and_b32 v52, v4, v10
    v_and_b32 v53, v4, v11
    v_and_b32 v54, v4, v12
    v_and_b32 v55, v4, v13
    v_and_b32 v56, v5, v10
    v_and_b32 v57, v5, v11
    v_and_b32 v58, v5, v12
    v_and_b32 v59, v5, v13
    v_mfma_f32_16x16x32_bf16 v[60:63], a[168:171], v[52:55], v[60:63]
    s_nop 0
    v_mfma_f32_16x16x32_bf16 v[64:67], a[168:171], v[56:59], v[64:67]
    s_waitcnt vmcnt(11)
    buffer_load_dwordx4 a[220:223], v14, s[40:43], s63 offen nt
    s_add_u32 s63, s63, 8192
    v_perm_b32 v4, v25, v25, s81
    v_perm_b32 v5, v41, v41, s81
    v_and_b32 v52, v4, v10
    v_and_b32 v53, v4, v11
    v_and_b32 v54, v4, v12
    v_and_b32 v55, v4, v13
    v_and_b32 v56, v5, v10
    v_and_b32 v57, v5, v11
    v_and_b32 v58, v5, v12
    v_and_b32 v59, v5, v13
    v_mfma_f32_16x16x32_bf16 v[60:63], a[172:175], v[52:55], v[60:63]
    s_nop 0
    v_mfma_f32_16x16x32_bf16 v[64:67], a[172:175], v[56:59], v[64:67]
    s_waitcnt vmcnt(11)
    buffer_load_dwordx4 a[224:227], v14, s[40:43], s63 offen nt
    s_add_u32 s63, s63, 8192
    v_mov_b32 v120, 0xff7f0000
    v_mov_b32 v121, 0
    v_mov_b32 v18, 1
    v_mov_b32 v116, 0
    v_mov_b32 v117, 0
    v_mov_b32 v118, 0
    v_mov_b32 v119, 0
    v_lshlrev_b32 v0, 3, v1
    ds_write_b64 v0, v[116:117] offset:8192
    v_mov_b32 v0, 8192
    s_lshl_b32 s38, s32, 10
    s_add_u32 s96, s38, 65536
    s_lshr_b32 s38, s32, 3
    s_lshl_b32 s38, s38, 8
    s_add_u32 s96, s38, s96
    v_mov_b32 v9, s96
    s_lshl_b32 s38, s32, 15
    s_add_u32 s96, s38, 1048576
    s_lshl_b32 s38, s3, 13
    s_add_u32 s96, s38, s96
    s_lshl_b32 s38, s33, 10
    s_add_u32 s96, s38, s96
    v_and_b32 v5, 3, v3
    v_lshlrev_b32 v78, 7, v2
    v_lshl_add_u32 v78, v5, 5, v78
    s_lshl_b32 s38, s32, 12
    s_add_u32 s91, s38, 262144
    s_lshl_b32 s38, s3, 9
    s_add_u32 s91, s38, s91
    v_lshlrev_b32 v4, 7, v2
    v_lshl_add_u32 v4, v3, 4, v4
    v_mov_b32 v5, 512
    v_cmp_gt_u32 vcc, 8, v3
    s_nop 1
    v_cndmask_b32 v79, v5, v4, vcc
    v_perm_b32 v4, v26, v26, s80
    v_perm_b32 v5, v42, v42, s80
    v_and_b32 v52, v4, v10
    v_and_b32 v53, v4, v11
    v_and_b32 v54, v4, v12
    v_and_b32 v55, v4, v13
    v_and_b32 v56, v5, v10
    v_and_b32 v57, v5, v11
    v_and_b32 v58, v5, v12
    v_and_b32 v59, v5, v13
    v_mfma_f32_16x16x32_bf16 v[60:63], a[176:179], v[52:55], v[60:63]
    s_nop 0
    v_mfma_f32_16x16x32_bf16 v[64:67], a[176:179], v[56:59], v[64:67]
    s_waitcnt vmcnt(11)
    buffer_load_dwordx4 a[228:231], v14, s[40:43], s63 offen nt
    s_add_u32 s63, s63, 8192
    v_perm_b32 v4, v26, v26, s81
    v_perm_b32 v5, v42, v42, s81
    v_and_b32 v52, v4, v10
    v_and_b32 v53, v4, v11
    v_and_b32 v54, v4, v12
    v_and_b32 v55, v4, v13
    v_and_b32 v56, v5, v10
    v_and_b32 v57, v5, v11
    v_and_b32 v58, v5, v12
    v_and_b32 v59, v5, v13
    v_mfma_f32_16x16x32_bf16 v[60:63], a[180:183], v[52:55], v[60:63]
    s_nop 0
    v_mfma_f32_16x16x32_bf16 v[64:67], a[180:183], v[56:59], v[64:67]
    s_waitcnt vmcnt(11)
    buffer_load_dwordx4 a[232:235], v14, s[40:43], s63 offen nt
    s_add_u32 s63, s63, 8192
    v_perm_b32 v4, v27, v27, s80
    v_perm_b32 v5, v43, v43, s80
    v_and_b32 v52, v4, v10
    v_and_b32 v53, v4, v11
    v_and_b32 v54, v4, v12
    v_and_b32 v55, v4, v13
    v_and_b32 v56, v5, v10
    v_and_b32 v57, v5, v11
    v_and_b32 v58, v5, v12
    v_and_b32 v59, v5, v13
    v_mfma_f32_16x16x32_bf16 v[60:63], a[184:187], v[52:55], v[60:63]
    s_nop 0
    v_mfma_f32_16x16x32_bf16 v[64:67], a[184:187], v[56:59], v[64:67]
    s_waitcnt vmcnt(11)
    buffer_load_dwordx4 a[236:239], v14, s[40:43], s63 offen nt
    s_add_u32 s63, s63, 8192
    v_perm_b32 v4, v27, v27, s81
    v_perm_b32 v5, v43, v43, s81
    v_and_b32 v52, v4, v10
    v_and_b32 v53, v4, v11
    v_and_b32 v54, v4, v12
    v_and_b32 v55, v4, v13
    v_and_b32 v56, v5, v10
    v_and_b32 v57, v5, v11
    v_and_b32 v58, v5, v12
    v_and_b32 v59, v5, v13
    v_mfma_f32_16x16x32_bf16 v[60:63], a[188:191], v[52:55], v[60:63]
    s_nop 0
    v_mfma_f32_16x16x32_bf16 v[64:67], a[188:191], v[56:59], v[64:67]
    s_waitcnt vmcnt(11)
    buffer_load_dwordx4 a[240:243], v14, s[40:43], s63 offen nt
    s_add_u32 s63, s63, 8192
    v_perm_b32 v4, v28, v28, s80
    v_perm_b32 v5, v44, v44, s80
    v_and_b32 v52, v4, v10
    v_and_b32 v53, v4, v11
    v_and_b32 v54, v4, v12
    v_and_b32 v55, v4, v13
    v_and_b32 v56, v5, v10
    v_and_b32 v57, v5, v11
    v_and_b32 v58, v5, v12
    v_and_b32 v59, v5, v13
    v_mfma_f32_16x16x32_bf16 v[60:63], a[192:195], v[52:55], v[60:63]
    s_nop 0
    v_mfma_f32_16x16x32_bf16 v[64:67], a[192:195], v[56:59], v[64:67]
    s_waitcnt vmcnt(11)
    buffer_load_dwordx4 a[244:247], v14, s[40:43], s63 offen nt
    s_add_u32 s63, s63, 8192
    v_perm_b32 v4, v28, v28, s81
    v_perm_b32 v5, v44, v44, s81
    v_and_b32 v52, v4, v10
    v_and_b32 v53, v4, v11
    v_and_b32 v54, v4, v12
    v_and_b32 v55, v4, v13
    v_and_b32 v56, v5, v10
    v_and_b32 v57, v5, v11
    v_and_b32 v58, v5, v12
    v_and_b32 v59, v5, v13
    v_mfma_f32_16x16x32_bf16 v[60:63], a[196:199], v[52:55], v[60:63]
    s_nop 0
    v_mfma_f32_16x16x32_bf16 v[64:67], a[196:199], v[56:59], v[64:67]
    s_waitcnt vmcnt(11)
    buffer_load_dwordx4 a[248:251], v14, s[40:43], s63 offen nt
    s_add_u32 s63, s63, 8192
    v_perm_b32 v4, v29, v29, s80
    v_perm_b32 v5, v45, v45, s80
    v_and_b32 v52, v4, v10
    v_and_b32 v53, v4, v11
    v_and_b32 v54, v4, v12
    v_and_b32 v55, v4, v13
    v_and_b32 v56, v5, v10
    v_and_b32 v57, v5, v11
    v_and_b32 v58, v5, v12
    v_and_b32 v59, v5, v13
    v_mfma_f32_16x16x32_bf16 v[60:63], a[200:203], v[52:55], v[60:63]
    s_nop 0
    v_mfma_f32_16x16x32_bf16 v[64:67], a[200:203], v[56:59], v[64:67]
    s_waitcnt vmcnt(11)
    buffer_load_dwordx4 a[252:255], v14, s[40:43], s63 offen nt
    s_add_u32 s63, s63, 8192
    v_perm_b32 v4, v29, v29, s81
    v_perm_b32 v5, v45, v45, s81
    v_and_b32 v52, v4, v10
    v_and_b32 v53, v4, v11
    v_and_b32 v54, v4, v12
    v_and_b32 v55, v4, v13
    v_and_b32 v56, v5, v10
    v_and_b32 v57, v5, v11
    v_and_b32 v58, v5, v12
    v_and_b32 v59, v5, v13
    v_mfma_f32_16x16x32_bf16 v[60:63], a[204:207], v[52:55], v[60:63]
    s_nop 0
    v_mfma_f32_16x16x32_bf16 v[64:67], a[204:207], v[56:59], v[64:67]
    s_waitcnt vmcnt(11)
    v_perm_b32 v4, v30, v30, s80
    v_perm_b32 v5, v46, v46, s80
    v_and_b32 v52, v4, v10
    v_and_b32 v53, v4, v11
    v_and_b32 v54, v4, v12
    v_and_b32 v55, v4, v13
    v_and_b32 v56, v5, v10
    v_and_b32 v57, v5, v11
    v_and_b32 v58, v5, v12
    v_and_b32 v59, v5, v13
    v_mfma_f32_16x16x32_bf16 v[60:63], a[208:211], v[52:55], v[60:63]
    s_nop 0
    v_mfma_f32_16x16x32_bf16 v[64:67], a[208:211], v[56:59], v[64:67]
    s_waitcnt vmcnt(10)
    v_perm_b32 v4, v30, v30, s81
    v_perm_b32 v5, v46, v46, s81
    v_and_b32 v52, v4, v10
    v_and_b32 v53, v4, v11
    v_and_b32 v54, v4, v12
    v_and_b32 v55, v4, v13
    v_and_b32 v56, v5, v10
    v_and_b32 v57, v5, v11
    v_and_b32 v58, v5, v12
    v_and_b32 v59, v5, v13
    v_mfma_f32_16x16x32_bf16 v[60:63], a[212:215], v[52:55], v[60:63]
    s_nop 0
    v_mfma_f32_16x16x32_bf16 v[64:67], a[212:215], v[56:59], v[64:67]
    s_waitcnt vmcnt(9)
    v_perm_b32 v4, v31, v31, s80
    v_perm_b32 v5, v47, v47, s80
    v_and_b32 v52, v4, v10
    v_and_b32 v53, v4, v11
    v_and_b32 v54, v4, v12
    v_and_b32 v55, v4, v13
    v_and_b32 v56, v5, v10
    v_and_b32 v57, v5, v11
    v_and_b32 v58, v5, v12
    v_and_b32 v59, v5, v13
    v_mfma_f32_16x16x32_bf16 v[60:63], a[216:219], v[52:55], v[60:63]
    s_nop 0
    v_mfma_f32_16x16x32_bf16 v[64:67], a[216:219], v[56:59], v[64:67]
    s_waitcnt vmcnt(8)
    v_perm_b32 v4, v31, v31, s81
    v_perm_b32 v5, v47, v47, s81
    v_and_b32 v52, v4, v10
    v_and_b32 v53, v4, v11
    v_and_b32 v54, v4, v12
    v_and_b32 v55, v4, v13
    v_and_b32 v56, v5, v10
    v_and_b32 v57, v5, v11
    v_and_b32 v58, v5, v12
    v_and_b32 v59, v5, v13
    v_mfma_f32_16x16x32_bf16 v[60:63], a[220:223], v[52:55], v[60:63]
    s_nop 0
    v_mfma_f32_16x16x32_bf16 v[64:67], a[220:223], v[56:59], v[64:67]
    s_waitcnt vmcnt(7)
    v_perm_b32 v4, v32, v32, s80
    v_perm_b32 v5, v48, v48, s80
    v_and_b32 v52, v4, v10
    v_and_b32 v53, v4, v11
    v_and_b32 v54, v4, v12
    v_and_b32 v55, v4, v13
    v_and_b32 v56, v5, v10
    v_and_b32 v57, v5, v11
    v_and_b32 v58, v5, v12
    v_and_b32 v59, v5, v13
    v_mfma_f32_16x16x32_bf16 v[60:63], a[224:227], v[52:55], v[60:63]
    s_nop 0
    v_mfma_f32_16x16x32_bf16 v[64:67], a[224:227], v[56:59], v[64:67]
    s_waitcnt vmcnt(6)
    s_add_u32 s39, s87, s88
    s_bfe_u32 s37, s39, 0x10000
    s_lshl_b32 s37, s37, 13
    s_add_u32 s85, s37, s89
    s_bfe_u32 s37, s39, 0x10001
    s_lshl_b32 s37, s37, 12
    s_add_u32 s85, s37, s85
    s_bfe_u32 s37, s39, 0x10002
    s_lshl_b32 s37, s37, 11
    s_add_u32 s85, s37, s85
    s_bfe_u32 s37, s39, 0x10003
    s_lshl_b32 s37, s37, 14
    s_add_u32 s85, s37, s85
    s_bfe_u32 s37, s39, 0x40004
    s_lshl_b32 s37, s37, 16
    s_add_u32 s85, s37, s85
    buffer_load_dwordx4 v[128:131], v76, s[52:55], s85 offen offset:0 nt
    v_perm_b32 v4, v32, v32, s81
    v_perm_b32 v5, v48, v48, s81
    v_and_b32 v52, v4, v10
    v_and_b32 v53, v4, v11
    v_and_b32 v54, v4, v12
    v_and_b32 v55, v4, v13
    v_and_b32 v56, v5, v10
    v_and_b32 v57, v5, v11
    v_and_b32 v58, v5, v12
    v_and_b32 v59, v5, v13
    v_mfma_f32_16x16x32_bf16 v[60:63], a[228:231], v[52:55], v[60:63]
    s_nop 0
    v_mfma_f32_16x16x32_bf16 v[64:67], a[228:231], v[56:59], v[64:67]
    s_waitcnt vmcnt(6)
    buffer_load_dwordx4 v[132:135], v77, s[52:55], s85 offen offset:0 nt
    v_perm_b32 v4, v33, v33, s80
    v_perm_b32 v5, v49, v49, s80
    v_and_b32 v52, v4, v10
    v_and_b32 v53, v4, v11
    v_and_b32 v54, v4, v12
    v_and_b32 v55, v4, v13
    v_and_b32 v56, v5, v10
    v_and_b32 v57, v5, v11
    v_and_b32 v58, v5, v12
    v_and_b32 v59, v5, v13
    v_mfma_f32_16x16x32_bf16 v[60:63], a[232:235], v[52:55], v[60:63]
    s_nop 0
    v_mfma_f32_16x16x32_bf16 v[64:67], a[232:235], v[56:59], v[64:67]
    s_waitcnt vmcnt(6)
    buffer_load_dwordx4 v[136:139], v76, s[52:55], s85 offen offset:1024 nt
    v_perm_b32 v4, v33, v33, s81
    v_perm_b32 v5, v49, v49, s81
    v_and_b32 v52, v4, v10
    v_and_b32 v53, v4, v11
    v_and_b32 v54, v4, v12
    v_and_b32 v55, v4, v13
    v_and_b32 v56, v5, v10
    v_and_b32 v57, v5, v11
    v_and_b32 v58, v5, v12
    v_and_b32 v59, v5, v13
    v_mfma_f32_16x16x32_bf16 v[60:63], a[236:239], v[52:55], v[60:63]
    s_nop 0
    v_mfma_f32_16x16x32_bf16 v[64:67], a[236:239], v[56:59], v[64:67]
    s_waitcnt vmcnt(6)
    buffer_load_dwordx4 v[140:143], v77, s[52:55], s85 offen offset:1024 nt
    s_add_u32 s87, s87, 1
    s_add_u32 s39, s87, s88
    s_bfe_u32 s37, s39, 0x10000
    s_lshl_b32 s37, s37, 13
    s_add_u32 s85, s37, s89
    s_bfe_u32 s37, s39, 0x10001
    s_lshl_b32 s37, s37, 12
    s_add_u32 s85, s37, s85
    s_bfe_u32 s37, s39, 0x10002
    s_lshl_b32 s37, s37, 11
    s_add_u32 s85, s37, s85
    s_bfe_u32 s37, s39, 0x10003
    s_lshl_b32 s37, s37, 14
    s_add_u32 s85, s37, s85
    s_bfe_u32 s37, s39, 0x40004
    s_lshl_b32 s37, s37, 16
    s_add_u32 s85, s37, s85
    v_perm_b32 v4, v34, v34, s80
    v_perm_b32 v5, v50, v50, s80
    v_and_b32 v52, v4, v10
    v_and_b32 v53, v4, v11
    v_and_b32 v54, v4, v12
    v_and_b32 v55, v4, v13
    v_and_b32 v56, v5, v10
    v_and_b32 v57, v5, v11
    v_and_b32 v58, v5, v12
    v_and_b32 v59, v5, v13
    v_mfma_f32_16x16x32_bf16 v[60:63], a[240:243], v[52:55], v[60:63]
    s_nop 0
    v_mfma_f32_16x16x32_bf16 v[64:67], a[240:243], v[56:59], v[64:67]
    s_waitcnt vmcnt(6)
    buffer_load_dwordx4 v[144:147], v76, s[52:55], s85 offen offset:0 nt
    v_perm_b32 v4, v34, v34, s81
    v_perm_b32 v5, v50, v50, s81
    v_and_b32 v52, v4, v10
    v_and_b32 v53, v4, v11
    v_and_b32 v54, v4, v12
    v_and_b32 v55, v4, v13
    v_and_b32 v56, v5, v10
    v_and_b32 v57, v5, v11
    v_and_b32 v58, v5, v12
    v_and_b32 v59, v5, v13
    v_mfma_f32_16x16x32_bf16 v[60:63], a[244:247], v[52:55], v[60:63]
    s_nop 0
    v_mfma_f32_16x16x32_bf16 v[64:67], a[244:247], v[56:59], v[64:67]
    s_waitcnt vmcnt(6)
    buffer_load_dwordx4 v[148:151], v77, s[52:55], s85 offen offset:0 nt
    v_perm_b32 v4, v35, v35, s80
    v_perm_b32 v5, v51, v51, s80
    v_and_b32 v52, v4, v10
    v_and_b32 v53, v4, v11
    v_and_b32 v54, v4, v12
    v_and_b32 v55, v4, v13
    v_and_b32 v56, v5, v10
    v_and_b32 v57, v5, v11
    v_and_b32 v58, v5, v12
    v_and_b32 v59, v5, v13
    v_mfma_f32_16x16x32_bf16 v[60:63], a[248:251], v[52:55], v[60:63]
    s_nop 0
    v_mfma_f32_16x16x32_bf16 v[64:67], a[248:251], v[56:59], v[64:67]
    s_waitcnt vmcnt(6)
    buffer_load_dwordx4 v[152:155], v76, s[52:55], s85 offen offset:1024 nt
    v_perm_b32 v4, v35, v35, s81
    v_perm_b32 v5, v51, v51, s81
    v_and_b32 v52, v4, v10
    v_and_b32 v53, v4, v11
    v_and_b32 v54, v4, v12
    v_and_b32 v55, v4, v13
    v_and_b32 v56, v5, v10
    v_and_b32 v57, v5, v11
    v_and_b32 v58, v5, v12
    v_and_b32 v59, v5, v13
    v_mfma_f32_16x16x32_bf16 v[60:63], a[252:255], v[52:55], v[60:63]
    s_nop 0
    v_mfma_f32_16x16x32_bf16 v[64:67], a[252:255], v[56:59], v[64:67]
    s_lshl_b32 s38, s34, 11
    v_lshrrev_b32 v4, 3, v3
    v_lshlrev_b32 v4, 9, v4
    v_lshl_add_u32 v4, v2, 7, v4
    v_and_b32 v5, 7, v3
    v_lshl_add_u32 v4, v5, 2, v4
    v_add_u32 v4, s38, v4
    ds_write_b32 v4, v60 offset:0
    ds_write_b32 v4, v61 offset:32
    ds_write_b32 v4, v62 offset:64
    ds_write_b32 v4, v63 offset:96
    ds_write_b32 v4, v64 offset:1024
    ds_write_b32 v4, v65 offset:1056
    ds_write_b32 v4, v66 offset:1088
    ds_write_b32 v4, v67 offset:1120
    s_lshl_b32 s38, s34, 9
    v_and_b32 v5, 31, v1
    v_lshl_add_u32 v5, v5, 4, s38
    s_waitcnt lgkmcnt(0)
    s_add_u32 s35, s35, 0x5b
    s_and_b32 s35, s35, 0xff
    v_mov_b32 v8, s35
    s_barrier
    ds_read_b128 v[20:23], v5 offset:0
    ds_read_b128 v[24:27], v5 offset:2048
    ds_read_b128 v[28:31], v5 offset:4096
    ds_read_b128 v[32:35], v5 offset:6144
    s_lshl_b32 s38, s61, 12
    s_add_u32 s36, s38, 262144
    s_lshl_b32 s38, s33, 11
    s_add_u32 s36, s38, s36
    s_waitcnt lgkmcnt(0)
    v_add_f32 v20, v20, v24
    v_add_f32 v28, v28, v32
    v_add_f32 v21, v21, v25
    v_add_f32 v29, v29, v33
    v_add_f32 v22, v22, v26
    v_add_f32 v30, v30, v34
    v_add_f32 v23, v23, v27
    v_add_f32 v31, v31, v35
    v_add_f32 v20, v20, v28
    v_add_f32 v21, v21, v29
    v_add_f32 v22, v22, v30
    v_add_f32 v23, v23, v31
    s_mov_b32 s38, 0xffff0000
    v_cvt_pk_bf16_f32 v20, v20, v20
    v_cvt_pk_bf16_f32 v21, v21, v21
    v_cvt_pk_bf16_f32 v22, v22, v22
    v_cvt_pk_bf16_f32 v23, v23, v23
    v_and_or_b32 v20, v20, s38, v8
    v_and_or_b32 v21, v21, s38, v8
    v_and_or_b32 v22, v22, s38, v8
    v_and_or_b32 v23, v23, s38, v8
    s_mov_b32 exec_lo, 0xffffffff
    s_mov_b32 exec_hi, 0x0
    buffer_store_dwordx4 v[20:23], v5, s[48:51], s36 offen sc1
    s_mov_b64 exec, -1
    s_waitcnt vmcnt(7)
    buffer_load_dwordx4 v[156:159], v77, s[52:55], s85 offen offset:1024 nt
    s_add_u32 s87, s87, 13
    s_add_u32 s39, s87, s88
    s_bfe_u32 s37, s39, 0x10000
    s_lshl_b32 s37, s37, 13
    s_add_u32 s85, s37, s89
    s_bfe_u32 s37, s39, 0x10001
    s_lshl_b32 s37, s37, 12
    s_add_u32 s85, s37, s85
    s_bfe_u32 s37, s39, 0x10002
    s_lshl_b32 s37, s37, 11
    s_add_u32 s85, s37, s85
    s_bfe_u32 s37, s39, 0x10003
    s_lshl_b32 s37, s37, 14
    s_add_u32 s85, s37, s85
    s_bfe_u32 s37, s39, 0x40004
    s_lshl_b32 s37, s37, 16
    s_add_u32 s85, s37, s85
    s_waitcnt vmcnt(7)
    buffer_load_dwordx4 v[160:163], v76, s[52:55], s85 offen offset:0 nt
    s_waitcnt vmcnt(7)
    buffer_load_dwordx4 v[164:167], v77, s[52:55], s85 offen offset:0 nt
    s_waitcnt vmcnt(7)
    buffer_load_dwordx4 v[168:171], v76, s[52:55], s85 offen offset:1024 nt
    s_waitcnt vmcnt(7)
    buffer_load_dwordx4 v[172:175], v77, s[52:55], s85 offen offset:1024 nt
    s_add_u32 s87, s87, 1
    s_add_u32 s39, s87, s88
    s_bfe_u32 s37, s39, 0x10000
    s_lshl_b32 s37, s37, 13
    s_add_u32 s85, s37, s89
    s_bfe_u32 s37, s39, 0x10001
    s_lshl_b32 s37, s37, 12
    s_add_u32 s85, s37, s85
    s_bfe_u32 s37, s39, 0x10002
    s_lshl_b32 s37, s37, 11
    s_add_u32 s85, s37, s85
    s_bfe_u32 s37, s39, 0x10003
    s_lshl_b32 s37, s37, 14
    s_add_u32 s85, s37, s85
    s_bfe_u32 s37, s39, 0x40004
    s_lshl_b32 s37, s37, 16
    s_add_u32 s85, s37, s85
    s_waitcnt vmcnt(7)
    buffer_load_dwordx4 v[176:179], v76, s[52:55], s85 offen offset:0 nt
    s_waitcnt vmcnt(7)
    buffer_load_dwordx4 v[180:183], v77, s[52:55], s85 offen offset:0 nt
    s_waitcnt vmcnt(6)
    buffer_load_dwordx4 v[184:187], v76, s[52:55], s85 offen offset:1024 nt
    s_waitcnt vmcnt(6)
    buffer_load_dwordx4 v[188:191], v77, s[52:55], s85 offen offset:1024 nt
    s_add_u32 s87, s87, 13
    s_add_u32 s39, s87, s88
    s_bfe_u32 s37, s39, 0x10000
    s_lshl_b32 s37, s37, 13
    s_add_u32 s85, s37, s89
    s_bfe_u32 s37, s39, 0x10001
    s_lshl_b32 s37, s37, 12
    s_add_u32 s85, s37, s85
    s_bfe_u32 s37, s39, 0x10002
    s_lshl_b32 s37, s37, 11
    s_add_u32 s85, s37, s85
    s_bfe_u32 s37, s39, 0x10003
    s_lshl_b32 s37, s37, 14
    s_add_u32 s85, s37, s85
    s_bfe_u32 s37, s39, 0x40004
    s_lshl_b32 s37, s37, 16
    s_add_u32 s85, s37, s85
    s_waitcnt vmcnt(6)
    buffer_load_dwordx4 v[192:195], v76, s[52:55], s85 offen offset:0 nt
    s_waitcnt vmcnt(6)
    buffer_load_dwordx4 v[196:199], v77, s[52:55], s85 offen offset:0 nt
    s_waitcnt vmcnt(6)
    buffer_load_dwordx4 v[200:203], v76, s[52:55], s85 offen offset:1024 nt
    s_waitcnt vmcnt(6)
    buffer_load_dwordx4 v[204:207], v77, s[52:55], s85 offen offset:1024 nt
    s_add_u32 s87, s87, 1
    s_add_u32 s39, s87, s88
    s_bfe_u32 s37, s39, 0x10000
    s_lshl_b32 s37, s37, 13
    s_add_u32 s85, s37, s89
    s_bfe_u32 s37, s39, 0x10001
    s_lshl_b32 s37, s37, 12
    s_add_u32 s85, s37, s85
    s_bfe_u32 s37, s39, 0x10002
    s_lshl_b32 s37, s37, 11
    s_add_u32 s85, s37, s85
    s_bfe_u32 s37, s39, 0x10003
    s_lshl_b32 s37, s37, 14
    s_add_u32 s85, s37, s85
    s_bfe_u32 s37, s39, 0x40004
    s_lshl_b32 s37, s37, 16
    s_add_u32 s85, s37, s85
    s_waitcnt vmcnt(6)
    buffer_load_dwordx4 v[208:211], v76, s[52:55], s85 offen offset:0 nt
    s_waitcnt vmcnt(6)
    buffer_load_dwordx4 v[212:215], v77, s[52:55], s85 offen offset:0 nt
    s_waitcnt vmcnt(6)
    buffer_load_dwordx4 v[216:219], v76, s[52:55], s85 offen offset:1024 nt
    s_waitcnt vmcnt(6)
    buffer_load_dwordx4 v[220:223], v77, s[52:55], s85 offen offset:1024 nt
    s_add_u32 s87, s87, 13
    s_add_u32 s39, s87, s88
    s_bfe_u32 s37, s39, 0x10000
    s_lshl_b32 s37, s37, 13
    s_add_u32 s85, s37, s89
    s_bfe_u32 s37, s39, 0x10001
    s_lshl_b32 s37, s37, 12
    s_add_u32 s85, s37, s85
    s_bfe_u32 s37, s39, 0x10002
    s_lshl_b32 s37, s37, 11
    s_add_u32 s85, s37, s85
    s_bfe_u32 s37, s39, 0x10003
    s_lshl_b32 s37, s37, 14
    s_add_u32 s85, s37, s85
    s_bfe_u32 s37, s39, 0x40004
    s_lshl_b32 s37, s37, 16
    s_add_u32 s85, s37, s85
    s_waitcnt vmcnt(6)
    buffer_load_dwordx4 v[224:227], v76, s[52:55], s85 offen offset:0 nt
    s_waitcnt vmcnt(6)
    buffer_load_dwordx4 v[228:231], v77, s[52:55], s85 offen offset:0 nt
    s_waitcnt vmcnt(6)
    buffer_load_dwordx4 v[232:235], v76, s[52:55], s85 offen offset:1024 nt
    s_waitcnt vmcnt(6)
    buffer_load_dwordx4 v[236:239], v77, s[52:55], s85 offen offset:1024 nt
    s_add_u32 s87, s87, 1
    s_add_u32 s39, s87, s88
    s_bfe_u32 s37, s39, 0x10000
    s_lshl_b32 s37, s37, 13
    s_add_u32 s85, s37, s89
    s_bfe_u32 s37, s39, 0x10001
    s_lshl_b32 s37, s37, 12
    s_add_u32 s85, s37, s85
    s_bfe_u32 s37, s39, 0x10002
    s_lshl_b32 s37, s37, 11
    s_add_u32 s85, s37, s85
    s_bfe_u32 s37, s39, 0x10003
    s_lshl_b32 s37, s37, 14
    s_add_u32 s85, s37, s85
    s_bfe_u32 s37, s39, 0x40004
    s_lshl_b32 s37, s37, 16
    s_add_u32 s85, s37, s85
    s_waitcnt vmcnt(6)
    buffer_load_dwordx4 v[240:243], v76, s[52:55], s85 offen offset:0 nt
    s_waitcnt vmcnt(6)
    buffer_load_dwordx4 v[244:247], v77, s[52:55], s85 offen offset:0 nt
    s_waitcnt vmcnt(6)
    buffer_load_dwordx4 v[248:251], v76, s[52:55], s85 offen offset:1024 nt
    s_waitcnt vmcnt(6)
    buffer_load_dwordx4 v[252:255], v77, s[52:55], s85 offen offset:1024 nt
    s_add_u32 s87, s87, 13
    s_add_u32 s39, s87, s88
    s_bfe_u32 s37, s39, 0x10000
    s_lshl_b32 s37, s37, 13
    s_add_u32 s85, s37, s89
    s_bfe_u32 s37, s39, 0x10001
    s_lshl_b32 s37, s37, 12
    s_add_u32 s85, s37, s85
    s_bfe_u32 s37, s39, 0x10002
    s_lshl_b32 s37, s37, 11
    s_add_u32 s85, s37, s85
    s_bfe_u32 s37, s39, 0x10003
    s_lshl_b32 s37, s37, 14
    s_add_u32 s85, s37, s85
    s_bfe_u32 s37, s39, 0x40004
    s_lshl_b32 s37, s37, 16
    s_add_u32 s85, s37, s85
    s_waitcnt vmcnt(6)
    buffer_load_dwordx4 a[0:3], v76, s[52:55], s85 offen offset:0 nt
    s_waitcnt vmcnt(6)
    buffer_load_dwordx4 a[4:7], v77, s[52:55], s85 offen offset:0 nt
    s_waitcnt vmcnt(6)
    buffer_load_dwordx4 a[8:11], v76, s[52:55], s85 offen offset:1024 nt
    s_waitcnt vmcnt(6)
    buffer_load_dwordx4 a[12:15], v77, s[52:55], s85 offen offset:1024 nt
    s_add_u32 s87, s87, 1
    s_add_u32 s39, s87, s88
    s_bfe_u32 s37, s39, 0x10000
    s_lshl_b32 s37, s37, 13
    s_add_u32 s85, s37, s89
    s_bfe_u32 s37, s39, 0x10001
    s_lshl_b32 s37, s37, 12
    s_add_u32 s85, s37, s85
    s_bfe_u32 s37, s39, 0x10002
    s_lshl_b32 s37, s37, 11
    s_add_u32 s85, s37, s85
    s_bfe_u32 s37, s39, 0x10003
    s_lshl_b32 s37, s37, 14
    s_add_u32 s85, s37, s85
    s_bfe_u32 s37, s39, 0x40004
    s_lshl_b32 s37, s37, 16
    s_add_u32 s85, s37, s85
    s_waitcnt vmcnt(6)
    buffer_load_dwordx4 a[16:19], v76, s[52:55], s85 offen offset:0 nt
    s_waitcnt vmcnt(6)
    buffer_load_dwordx4 a[20:23], v77, s[52:55], s85 offen offset:0 nt
    s_waitcnt vmcnt(6)
    buffer_load_dwordx4 a[24:27], v76, s[52:55], s85 offen offset:1024 nt
    s_waitcnt vmcnt(6)
    buffer_load_dwordx4 a[28:31], v77, s[52:55], s85 offen offset:1024 nt
    s_add_u32 s87, s87, 13
    s_add_u32 s39, s87, s88
    s_bfe_u32 s37, s39, 0x10000
    s_lshl_b32 s37, s37, 13
    s_add_u32 s85, s37, s89
    s_bfe_u32 s37, s39, 0x10001
    s_lshl_b32 s37, s37, 12
    s_add_u32 s85, s37, s85
    s_bfe_u32 s37, s39, 0x10002
    s_lshl_b32 s37, s37, 11
    s_add_u32 s85, s37, s85
    s_bfe_u32 s37, s39, 0x10003
    s_lshl_b32 s37, s37, 14
    s_add_u32 s85, s37, s85
    s_bfe_u32 s37, s39, 0x40004
    s_lshl_b32 s37, s37, 16
    s_add_u32 s85, s37, s85
    s_waitcnt vmcnt(6)
    buffer_load_dwordx4 a[32:35], v76, s[52:55], s85 offen offset:0 nt
    s_waitcnt vmcnt(6)
    buffer_load_dwordx4 a[36:39], v77, s[52:55], s85 offen offset:0 nt
    s_waitcnt vmcnt(6)
    buffer_load_dwordx4 a[40:43], v76, s[52:55], s85 offen offset:1024 nt
    s_waitcnt vmcnt(6)
    buffer_load_dwordx4 a[44:47], v77, s[52:55], s85 offen offset:1024 nt
    s_add_u32 s87, s87, 1
    s_add_u32 s39, s87, s88
    s_bfe_u32 s37, s39, 0x10000
    s_lshl_b32 s37, s37, 13
    s_add_u32 s85, s37, s89
    s_bfe_u32 s37, s39, 0x10001
    s_lshl_b32 s37, s37, 12
    s_add_u32 s85, s37, s85
    s_bfe_u32 s37, s39, 0x10002
    s_lshl_b32 s37, s37, 11
    s_add_u32 s85, s37, s85
    s_bfe_u32 s37, s39, 0x10003
    s_lshl_b32 s37, s37, 14
    s_add_u32 s85, s37, s85
    s_bfe_u32 s37, s39, 0x40004
    s_lshl_b32 s37, s37, 16
    s_add_u32 s85, s37, s85
    s_waitcnt vmcnt(6)
    buffer_load_dwordx4 a[48:51], v76, s[52:55], s85 offen offset:0 nt
    s_waitcnt vmcnt(6)
    buffer_load_dwordx4 a[52:55], v77, s[52:55], s85 offen offset:0 nt
    buffer_load_dwordx4 v[68:71], v78, s[48:51], s91 offen offset:0 sc1
    buffer_load_dwordx4 v[72:75], v78, s[48:51], s91 offen offset:16 sc1
    s_waitcnt vmcnt(8)
    buffer_load_dwordx4 a[56:59], v76, s[52:55], s85 offen offset:1024 nt
    s_waitcnt vmcnt(8)
    buffer_load_dwordx4 a[60:63], v77, s[52:55], s85 offen offset:1024 nt
    s_add_u32 s87, s87, 13
    s_add_u32 s39, s87, s88
    s_bfe_u32 s37, s39, 0x10000
    s_lshl_b32 s37, s37, 13
    s_add_u32 s85, s37, s89
    s_bfe_u32 s37, s39, 0x10001
    s_lshl_b32 s37, s37, 12
    s_add_u32 s85, s37, s85
    s_bfe_u32 s37, s39, 0x10002
    s_lshl_b32 s37, s37, 11
    s_add_u32 s85, s37, s85
    s_bfe_u32 s37, s39, 0x10003
    s_lshl_b32 s37, s37, 14
    s_add_u32 s85, s37, s85
    s_bfe_u32 s37, s39, 0x40004
    s_lshl_b32 s37, s37, 16
    s_add_u32 s85, s37, s85
    s_waitcnt vmcnt(8)
    buffer_load_dwordx4 a[64:67], v76, s[52:55], s85 offen offset:0 nt
    s_waitcnt vmcnt(8)
    buffer_load_dwordx4 a[68:71], v77, s[52:55], s85 offen offset:0 nt
    s_waitcnt vmcnt(8)
    buffer_load_dwordx4 a[72:75], v76, s[52:55], s85 offen offset:1024 nt
    s_waitcnt vmcnt(8)
    buffer_load_dwordx4 a[76:79], v77, s[52:55], s85 offen offset:1024 nt
    s_add_u32 s87, s87, 1
    s_add_u32 s39, s87, s88
    s_bfe_u32 s37, s39, 0x10000
    s_lshl_b32 s37, s37, 13
    s_add_u32 s85, s37, s89
    s_bfe_u32 s37, s39, 0x10001
    s_lshl_b32 s37, s37, 12
    s_add_u32 s85, s37, s85
    s_bfe_u32 s37, s39, 0x10002
    s_lshl_b32 s37, s37, 11
    s_add_u32 s85, s37, s85
    s_bfe_u32 s37, s39, 0x10003
    s_lshl_b32 s37, s37, 14
    s_add_u32 s85, s37, s85
    s_bfe_u32 s37, s39, 0x40004
    s_lshl_b32 s37, s37, 16
    s_add_u32 s85, s37, s85
    s_waitcnt vmcnt(6)
L_qcheck_39:
    v_xor_b32 v68, s35, v68
    v_xor_b32 v69, s35, v69
    v_xor_b32 v70, s35, v70
    v_xor_b32 v71, s35, v71
    v_xor_b32 v72, s35, v72
    v_xor_b32 v73, s35, v73
    v_xor_b32 v74, s35, v74
    v_xor_b32 v75, s35, v75
    v_or_b32 v4, v68, v69
    v_or3_b32 v4, v4, v70, v71
    v_or3_b32 v4, v4, v72, v73
    v_or3_b32 v4, v4, v74, v75
    v_and_b32 v4, 0xff, v4
    v_cmp_ne_u32 vcc, 0, v4
    s_cbranch_vccz L_qok_40
    buffer_load_dwordx4 v[68:71], v78, s[48:51], s91 offen offset:0 sc1
    buffer_load_dwordx4 v[72:75], v78, s[48:51], s91 offen offset:16 sc1
    s_waitcnt vmcnt(0)
    s_sub_u32 s84, s84, 1
    s_cmp_lg_u32 s84, 0
    s_cbranch_scc1 L_qcheck_39
    s_branch L_end
L_qok_40:
    v_cvt_pk_bf16_f32 v68, v68, v69
    v_cvt_pk_bf16_f32 v69, v70, v71
    v_cvt_pk_bf16_f32 v70, v72, v73
    v_cvt_pk_bf16_f32 v71, v74, v75
    s_mov_b32 vcc_lo, 0xf000f
    s_mov_b32 vcc_hi, 0xf000f
    v_cndmask_b32 v80, 0, v68, vcc
    v_cndmask_b32 v81, 0, v69, vcc
    v_cndmask_b32 v82, 0, v70, vcc
    v_cndmask_b32 v83, 0, v71, vcc
    s_mov_b32 vcc_lo, 0xf000f0
    s_mov_b32 vcc_hi, 0xf000f0
    v_cndmask_b32 v84, 0, v68, vcc
    v_cndmask_b32 v85, 0, v69, vcc
    v_cndmask_b32 v86, 0, v70, vcc
    v_cndmask_b32 v87, 0, v71, vcc
    s_mov_b32 vcc_lo, 0xf000f00
    s_mov_b32 vcc_hi, 0xf000f00
    v_cndmask_b32 v88, 0, v68, vcc
    v_cndmask_b32 v89, 0, v69, vcc
    v_cndmask_b32 v90, 0, v70, vcc
    v_cndmask_b32 v91, 0, v71, vcc
    s_mov_b32 vcc_lo, 0xf000f000
    s_mov_b32 vcc_hi, 0xf000f000
    v_cndmask_b32 v92, 0, v68, vcc
    v_cndmask_b32 v93, 0, v69, vcc
    v_cndmask_b32 v94, 0, v70, vcc
    v_cndmask_b32 v95, 0, v71, vcc
    s_getreg_b32 s70, hwreg(HW_REG_XCC_ID, 0, 4)
    s_lshl_b32 s70, s70, 8
    s_or_b32 s70, s70, s35
    s_or_b32 s70, s70, 0x5e9d0000
    s_bfe_u32 s38, s2, 0x30000
    s_lshl_b32 s38, s38, 8
    s_add_u32 s69, s38, 32768
    s_lshl_b32 s38, s32, 2
    s_add_u32 s69, s38, s69
    s_lshl_b32 s38, s34, 24
    s_add_u32 s69, s38, s69
    v_mov_b32 v72, s69
    v_mov_b32 v73, s70
    s_mov_b64 exec, 1
    buffer_store_dword v73, v72, s[48:51], 0 offen sc1
    s_mov_b64 exec, -1
    v_mov_b32 v65, 0xff7f0000
    s_lshl_b32 s38, s34, 14
    s_add_u32 s38, s38, 16384
    v_lshl_add_u32 v64, v1, 2, s38
    buffer_load_dwordx4 a[80:83], v76, s[52:55], s85 offen offset:0 nt
    v_mfma_f32_16x16x32_bf16 v[112:115], v[128:131], v[80:83], 0
    v_mfma_f32_16x16x32_bf16 v[112:115], v[132:135], v[84:87], v[112:115]
    v_mfma_f32_16x16x32_bf16 v[112:115], v[136:139], v[88:91], v[112:115]
    s_waitcnt vmcnt(7)
    buffer_load_dwordx4 a[84:87], v77, s[52:55], s85 offen offset:0 nt
    v_mfma_f32_16x16x32_bf16 v[112:115], v[140:143], v[92:95], v[112:115]
    v_mfma_f32_16x16x32_bf16 v[96:99], v[144:147], v[80:83], 0
    v_mfma_f32_16x16x32_bf16 v[96:99], v[148:151], v[84:87], v[96:99]
    v_mfma_f32_16x16x32_bf16 v[96:99], v[152:155], v[88:91], v[96:99]
    s_nop 4
    v_mov_b32_dpp v122, v112 quad_perm:[0,0,0,0] row_mask:0xf bank_mask:0xf
    v_mov_b32_dpp v124, v114 quad_perm:[2,2,2,2] row_mask:0xf bank_mask:0xf
    s_nop 0
    v_add_f32_dpp v122, v113, v122 quad_perm:[1,1,1,1] row_mask:0xf bank_mask:0xf
    v_add_f32_dpp v124, v115, v124 quad_perm:[3,3,3,3] row_mask:0xf bank_mask:0xf
    v_add_f32 v122, v122, v124
    v_max_f32 v65, v65, v122
    ds_write_b32 v64, v122 offset:0
    s_waitcnt vmcnt(7)
    buffer_load_dwordx4 a[88:91], v76, s[52:55], s85 offen offset:1024 nt
    v_mfma_f32_16x16x32_bf16 v[96:99], v[156:159], v[92:95], v[96:99]
    v_mfma_f32_16x16x32_bf16 v[112:115], v[160:163], v[80:83], 0
    v_mfma_f32_16x16x32_bf16 v[112:115], v[164:167], v[84:87], v[112:115]
    s_waitcnt vmcnt(7)
    buffer_load_dwordx4 a[92:95], v77, s[52:55], s85 offen offset:1024 nt
    s_add_u32 s87, s87, 13
    s_add_u32 s39, s87, s88
    s_bfe_u32 s37, s39, 0x10000
    s_lshl_b32 s37, s37, 13
    s_add_u32 s85, s37, s89
    s_bfe_u32 s37, s39, 0x10001
    s_lshl_b32 s37, s37, 12
    s_add_u32 s85, s37, s85
    s_bfe_u32 s37, s39, 0x10002
    s_lshl_b32 s37, s37, 11
    s_add_u32 s85, s37, s85
    s_bfe_u32 s37, s39, 0x10003
    s_lshl_b32 s37, s37, 14
    s_add_u32 s85, s37, s85
    s_bfe_u32 s37, s39, 0x40004
    s_lshl_b32 s37, s37, 16
    s_add_u32 s85, s37, s85
    v_mfma_f32_16x16x32_bf16 v[112:115], v[168:171], v[88:91], v[112:115]
    v_mov_b32_dpp v122, v96 quad_perm:[0,0,0,0] row_mask:0xf bank_mask:0xf
    v_mov_b32_dpp v124, v98 quad_perm:[2,2,2,2] row_mask:0xf bank_mask:0xf
    s_nop 0
    v_add_f32_dpp v122, v97, v122 quad_perm:[1,1,1,1] row_mask:0xf bank_mask:0xf
    v_add_f32_dpp v124, v99, v124 quad_perm:[3,3,3,3] row_mask:0xf bank_mask:0xf
    v_add_f32 v122, v122, v124
    v_max_f32 v65, v65, v122
    ds_write_b32 v64, v122 offset:256
    v_mfma_f32_16x16x32_bf16 v[112:115], v[172:175], v[92:95], v[112:115]
    v_mfma_f32_16x16x32_bf16 v[96:99], v[176:179], v[80:83], 0
    v_mfma_f32_16x16x32_bf16 v[96:99], v[180:183], v[84:87], v[96:99]
    s_waitcnt vmcnt(7)
    buffer_load_dwordx4 a[96:99], v76, s[52:55], s85 offen offset:0 nt
    v_mfma_f32_16x16x32_bf16 v[96:99], v[184:187], v[88:91], v[96:99]
    s_nop 2
    v_mov_b32_dpp v122, v112 quad_perm:[0,0,0,0] row_mask:0xf bank_mask:0xf
    v_mov_b32_dpp v124, v114 quad_perm:[2,2,2,2] row_mask:0xf bank_mask:0xf
    s_nop 0
    v_add_f32_dpp v122, v113, v122 quad_perm:[1,1,1,1] row_mask:0xf bank_mask:0xf
    v_add_f32_dpp v124, v115, v124 quad_perm:[3,3,3,3] row_mask:0xf bank_mask:0xf
    v_add_f32 v122, v122, v124
    v_max_f32 v65, v65, v122
    ds_write_b32 v64, v122 offset:512
    v_mfma_f32_16x16x32_bf16 v[96:99], v[188:191], v[92:95], v[96:99]
    v_mfma_f32_16x16x32_bf16 v[112:115], v[192:195], v[80:83], 0
    s_waitcnt vmcnt(7)
    buffer_load_dwordx4 a[100:103], v77, s[52:55], s85 offen offset:0 nt
    v_mfma_f32_16x16x32_bf16 v[112:115], v[196:199], v[84:87], v[112:115]
    v_mfma_f32_16x16x32_bf16 v[112:115], v[200:203], v[88:91], v[112:115]
    s_nop 2
    v_mov_b32_dpp v122, v96 quad_perm:[0,0,0,0] row_mask:0xf bank_mask:0xf
    v_mov_b32_dpp v124, v98 quad_perm:[2,2,2,2] row_mask:0xf bank_mask:0xf
    s_nop 0
    v_add_f32_dpp v122, v97, v122 quad_perm:[1,1,1,1] row_mask:0xf bank_mask:0xf
    v_add_f32_dpp v124, v99, v124 quad_perm:[3,3,3,3] row_mask:0xf bank_mask:0xf
    v_add_f32 v122, v122, v124
    v_max_f32 v65, v65, v122
    ds_write_b32 v64, v122 offset:768
    v_mfma_f32_16x16x32_bf16 v[112:115], v[204:207], v[92:95], v[112:115]
    v_mfma_f32_16x16x32_bf16 v[96:99], v[208:211], v[80:83], 0
    s_waitcnt vmcnt(7)
    buffer_load_dwordx4 a[104:107], v76, s[52:55], s85 offen offset:1024 nt
    v_mfma_f32_16x16x32_bf16 v[96:99], v[212:215], v[84:87], v[96:99]
    v_mfma_f32_16x16x32_bf16 v[96:99], v[216:219], v[88:91], v[96:99]
    s_nop 2
    v_mov_b32_dpp v122, v112 quad_perm:[0,0,0,0] row_mask:0xf bank_mask:0xf
    v_mov_b32_dpp v124, v114 quad_perm:[2,2,2,2] row_mask:0xf bank_mask:0xf
    s_nop 0
    v_add_f32_dpp v122, v113, v122 quad_perm:[1,1,1,1] row_mask:0xf bank_mask:0xf
    v_add_f32_dpp v124, v115, v124 quad_perm:[3,3,3,3] row_mask:0xf bank_mask:0xf
    v_add_f32 v122, v122, v124
    v_max_f32 v65, v65, v122
    ds_write_b32 v64, v122 offset:1024
    v_mfma_f32_16x16x32_bf16 v[96:99], v[220:223], v[92:95], v[96:99]
    s_waitcnt vmcnt(6)
    buffer_load_dwordx4 a[108:111], v77, s[52:55], s85 offen offset:1024 nt
    s_add_u32 s87, s87, 1
    s_add_u32 s39, s87, s88
    s_bfe_u32 s37, s39, 0x10000
    s_lshl_b32 s37, s37, 13
    s_add_u32 s85, s37, s89
    s_bfe_u32 s37, s39, 0x10001
    s_lshl_b32 s37, s37, 12
    s_add_u32 s85, s37, s85
    s_bfe_u32 s37, s39, 0x10002
    s_lshl_b32 s37, s37, 11
    s_add_u32 s85, s37, s85
    s_bfe_u32 s37, s39, 0x10003
    s_lshl_b32 s37, s37, 14
    s_add_u32 s85, s37, s85
    s_bfe_u32 s37, s39, 0x40004
    s_lshl_b32 s37, s37, 16
    s_add_u32 s85, s37, s85
    v_mfma_f32_16x16x32_bf16 v[112:115], v[224:227], v[80:83], 0
    v_mfma_f32_16x16x32_bf16 v[112:115], v[228:231], v[84:87], v[112:115]
    v_mfma_f32_16x16x32_bf16 v[112:115], v[232:235], v[88:91], v[112:115]
    v_mov_b32_dpp v122, v96 quad_perm:[0,0,0,0] row_mask:0xf bank_mask:0xf
    v_mov_b32_dpp v124, v98 quad_perm:[2,2,2,2] row_mask:0xf bank_mask:0xf
    s_nop 0
    v_add_f32_dpp v122, v97, v122 quad_perm:[1,1,1,1] row_mask:0xf bank_mask:0xf
    v_add_f32_dpp v124, v99, v124 quad_perm:[3,3,3,3] row_mask:0xf bank_mask:0xf
    v_add_f32 v122, v122, v124
    v_max_f32 v65, v65, v122
    ds_write_b32 v64, v122 offset:1280
    v_mfma_f32_16x16x32_bf16 v[112:115], v[236:239], v[92:95], v[112:115]
    s_waitcnt vmcnt(6)
    buffer_load_dwordx4 a[112:115], v76, s[52:55], s85 offen offset:0 nt
    v_mfma_f32_16x16x32_bf16 v[96:99], v[240:243], v[80:83], 0
    v_mfma_f32_16x16x32_bf16 v[96:99], v[244:247], v[84:87], v[96:99]
    v_mfma_f32_16x16x32_bf16 v[96:99], v[248:251], v[88:91], v[96:99]
    s_nop 2
    v_mov_b32_dpp v122, v112 quad_perm:[0,0,0,0] row_mask:0xf bank_mask:0xf
    v_mov_b32_dpp v124, v114 quad_perm:[2,2,2,2] row_mask:0xf bank_mask:0xf
    s_nop 0
    v_add_f32_dpp v122, v113, v122 quad_perm:[1,1,1,1] row_mask:0xf bank_mask:0xf
    v_add_f32_dpp v124, v115, v124 quad_perm:[3,3,3,3] row_mask:0xf bank_mask:0xf
    v_add_f32 v122, v122, v124
    v_max_f32 v65, v65, v122
    ds_write_b32 v64, v122 offset:1536
    v_mfma_f32_16x16x32_bf16 v[96:99], v[252:255], v[92:95], v[96:99]
    s_waitcnt vmcnt(6)
    buffer_load_dwordx4 a[116:119], v77, s[52:55], s85 offen offset:0 nt
    v_mfma_f32_16x16x32_bf16 v[112:115], a[0:3], v[80:83], 0
    v_mfma_f32_16x16x32_bf16 v[112:115], a[4:7], v[84:87], v[112:115]
    v_mfma_f32_16x16x32_bf16 v[112:115], a[8:11], v[88:91], v[112:115]
    s_nop 2
    v_mov_b32_dpp v122, v96 quad_perm:[0,0,0,0] row_mask:0xf bank_mask:0xf
    v_mov_b32_dpp v124, v98 quad_perm:[2,2,2,2] row_mask:0xf bank_mask:0xf
    s_nop 0
    v_add_f32_dpp v122, v97, v122 quad_perm:[1,1,1,1] row_mask:0xf bank_mask:0xf
    v_add_f32_dpp v124, v99, v124 quad_perm:[3,3,3,3] row_mask:0xf bank_mask:0xf
    v_add_f32 v122, v122, v124
    v_max_f32 v65, v65, v122
    ds_write_b32 v64, v122 offset:1792
    s_waitcnt vmcnt(6)
    buffer_load_dwordx4 a[120:123], v76, s[52:55], s85 offen offset:1024 nt
    v_mfma_f32_16x16x32_bf16 v[112:115], a[12:15], v[92:95], v[112:115]
    v_mfma_f32_16x16x32_bf16 v[96:99], a[16:19], v[80:83], 0
    v_mfma_f32_16x16x32_bf16 v[96:99], a[20:23], v[84:87], v[96:99]
    v_mfma_f32_16x16x32_bf16 v[96:99], a[24:27], v[88:91], v[96:99]
    s_nop 4
    v_mov_b32_dpp v122, v112 quad_perm:[0,0,0,0] row_mask:0xf bank_mask:0xf
    v_mov_b32_dpp v124, v114 quad_perm:[2,2,2,2] row_mask:0xf bank_mask:0xf
    s_nop 0
    v_add_f32_dpp v122, v113, v122 quad_perm:[1,1,1,1] row_mask:0xf bank_mask:0xf
    v_add_f32_dpp v124, v115, v124 quad_perm:[3,3,3,3] row_mask:0xf bank_mask:0xf
    v_add_f32 v122, v122, v124
    v_max_f32 v65, v65, v122
    ds_write_b32 v64, v122 offset:2048
    s_waitcnt vmcnt(6)
    buffer_load_dwordx4 a[124:127], v77, s[52:55], s85 offen offset:1024 nt
    s_add_u32 s87, s87, 13
    s_add_u32 s39, s87, s88
    s_bfe_u32 s37, s39, 0x10000
    s_lshl_b32 s37, s37, 13
    s_add_u32 s85, s37, s89
    s_bfe_u32 s37, s39, 0x10001
    s_lshl_b32 s37, s37, 12
    s_add_u32 s85, s37, s85
    s_bfe_u32 s37, s39, 0x10002
    s_lshl_b32 s37, s37, 11
    s_add_u32 s85, s37, s85
    s_bfe_u32 s37, s39, 0x10003
    s_lshl_b32 s37, s37, 14
    s_add_u32 s85, s37, s85
    s_bfe_u32 s37, s39, 0x40004
    s_lshl_b32 s37, s37, 16
    s_add_u32 s85, s37, s85
    v_mfma_f32_16x16x32_bf16 v[96:99], a[28:31], v[92:95], v[96:99]
    v_mfma_f32_16x16x32_bf16 v[112:115], a[32:35], v[80:83], 0
    s_bfe_u32 s38, s2, 0x20001
    s_lshl_b32 s38, s38, 0
    s_add_u32 s90, s38, 0
    s_bfe_u32 s38, s2, 0x10000
    s_lshl_b32 s38, s38, 2
    s_add_u32 s90, s38, s90
    s_and_b32 s36, s90, 3
    s_bitcmp0_b32 s90, 2
    s_cselect_b64 s[40:41], s[24:25], s[14:15]
    s_cselect_b32 s45, 262144, 0
    s_add_u32 s45, s45, 524288
    s_lshl_b32 s38, s36, 16
    s_add_u32 s71, s38, s45
    s_lshr_b32 s38, s32, 2
    s_lshl_b32 s38, s38, 13
    s_add_u32 s71, s38, s71
    s_bfe_u32 s38, s32, 0x20000
    s_lshl_b32 s38, s38, 6
    s_add_u32 s71, s38, s71
    s_mov_b32 s42, 4194304
    s_mov_b32 s43, 0x20000
    s_lshl_b32 s38, s32, 17
    s_add_u32 s44, s38, 0
    s_lshl_b32 s38, s34, 15
    s_add_u32 s44, s38, s44
    s_lshl_b32 s38, s36, 8
    s_add_u32 s44, s38, s44
    s_lshl_b32 s38, s36, 16
    s_add_u32 s45, s38, s45
    s_lshr_b32 s38, s34, 1
    s_lshl_b32 s38, s38, 15
    s_add_u32 s45, s38, s45
    s_lshl_b32 s38, s32, 8
    s_add_u32 s45, s38, s45
    s_bfe_u32 s38, s34, 0x10000
    s_lshl_b32 s38, s38, 7
    s_add_u32 s45, s38, s45
    s_lshl_b32 s38, s32, 11
    s_add_u32 s46, s38, 196608
    s_lshl_b32 s38, s34, 9
    s_add_u32 s46, s38, s46
    s_mov_b32 s72, s26
    s_and_b32 s73, s27, 0xffff
    s_mov_b32 s74, 8192
    s_mov_b32 s75, 0x20000
    v_mfma_f32_16x16x32_bf16 v[112:115], a[36:39], v[84:87], v[112:115]
    s_waitcnt vmcnt(5)
    buffer_load_dwordx4 v[128:131], v76, s[52:55], s85 offen offset:0 nt
    v_mfma_f32_16x16x32_bf16 v[112:115], a[40:43], v[88:91], v[112:115]
    v_mov_b32_dpp v122, v96 quad_perm:[0,0,0,0] row_mask:0xf bank_mask:0xf
    v_mov_b32_dpp v124, v98 quad_perm:[2,2,2,2] row_mask:0xf bank_mask:0xf
    s_nop 0
    v_add_f32_dpp v122, v97, v122 quad_perm:[1,1,1,1] row_mask:0xf bank_mask:0xf
    v_add_f32_dpp v124, v99, v124 quad_perm:[3,3,3,3] row_mask:0xf bank_mask:0xf
    v_add_f32 v122, v122, v124
    v_max_f32 v65, v65, v122
    ds_write_b32 v64, v122 offset:2304
    v_mfma_f32_16x16x32_bf16 v[112:115], a[44:47], v[92:95], v[112:115]
    v_mfma_f32_16x16x32_bf16 v[96:99], a[48:51], v[80:83], 0
    v_mfma_f32_16x16x32_bf16 v[96:99], a[52:55], v[84:87], v[96:99]
    s_waitcnt vmcnt(5)
    buffer_load_dwordx4 v[132:135], v77, s[52:55], s85 offen offset:0 nt
    v_mfma_f32_16x16x32_bf16 v[96:99], a[56:59], v[88:91], v[96:99]
    s_nop 2
    v_mov_b32_dpp v122, v112 quad_perm:[0,0,0,0] row_mask:0xf bank_mask:0xf
    v_mov_b32_dpp v124, v114 quad_perm:[2,2,2,2] row_mask:0xf bank_mask:0xf
    s_nop 0
    v_add_f32_dpp v122, v113, v122 quad_perm:[1,1,1,1] row_mask:0xf bank_mask:0xf
    v_add_f32_dpp v124, v115, v124 quad_perm:[3,3,3,3] row_mask:0xf bank_mask:0xf
    v_add_f32 v122, v122, v124
    v_max_f32 v65, v65, v122
    ds_write_b32 v64, v122 offset:2560
    v_lshlrev_b32 v4, 2, v2
    v_xor_b32 v4, v4, v3
    v_xor_b32 v5, 0, v4
    v_lshlrev_b32 v5, 4, v5
    v_lshl_add_u32 v20, v2, 10, v5
    v_xor_b32 v5, 1, v4
    v_lshlrev_b32 v5, 4, v5
    v_lshl_add_u32 v21, v2, 10, v5
    v_add_u32 v21, 3072, v21
    v_xor_b32 v5, 2, v4
    v_lshlrev_b32 v5, 4, v5
    v_lshl_add_u32 v22, v2, 10, v5
    v_add_u32 v22, 6144, v22
    v_xor_b32 v5, 3, v4
    v_lshlrev_b32 v5, 4, v5
    v_lshl_add_u32 v23, v2, 10, v5
    v_add_u32 v23, 9216, v23
    s_lshl_b32 s38, s32, 15
    s_add_u32 s47, s38, 1048576
    s_lshl_b32 s38, s3, 13
    s_add_u32 s47, s38, s47
    v_lshlrev_b32 v6, 7, v2
    v_bfe_u32 v5, v3, 0, 3
    v_lshl_add_u32 v6, v5, 4, v6
    v_lshrrev_b32 v4, 3, v3
    v_and_b32 v7, 3, v3
    v_min_u32 v7, 2, v7
    v_lshl_add_u32 v7, v7, 1, v4
    v_add_u32 v5, 0, v4
    v_cmp_le_u32 vcc, s33, v5
    s_nop 1
    v_addc_co_u32 v5, vcc, 0, v5, vcc
    v_lshl_add_u32 v50, v5, 10, v6
    v_add_u32 v5, 2, v4
    v_cmp_le_u32 vcc, s33, v5
    s_nop 1
    v_addc_co_u32 v5, vcc, 0, v5, vcc
    v_lshl_add_u32 v51, v5, 10, v6
    v_add_u32 v5, 4, v4
    v_cmp_le_u32 vcc, s33, v5
    s_nop 1
    v_addc_co_u32 v5, vcc, 0, v5, vcc
    v_lshl_add_u32 v52, v5, 10, v6
    v_mov_b32 v5, v7
    v_mov_b32 v6, 512
    v_cmp_le_u32 vcc, s33, v5
    s_nop 1
    v_addc_co_u32 v5, vcc, 0, v5, vcc
    v_lshl_add_u32 v53, v5, 10, v6
    s_mul_i32 s38, s3, 320
    s_add_u32 s38, s38, 135168
    v_lshlrev_b32 v4, 6, v2
    v_lshl_add_u32 v4, v3, 1, v4
    v_add_u32 v31, s38, v4
    v_mfma_f32_16x16x32_bf16 v[96:99], a[60:63], v[92:95], v[96:99]
    v_mfma_f32_16x16x32_bf16 v[112:115], a[64:67], v[80:83], 0
    s_waitcnt vmcnt(5)
    buffer_load_dwordx4 v[136:139], v76, s[52:55], s85 offen offset:1024 nt
    v_mfma_f32_16x16x32_bf16 v[112:115], a[68:71], v[84:87], v[112:115]
    v_mfma_f32_16x16x32_bf16 v[112:115], a[72:75], v[88:91], v[112:115]
    s_nop 2
    v_mov_b32_dpp v122, v96 quad_perm:[0,0,0,0] row_mask:0xf bank_mask:0xf
    v_mov_b32_dpp v124, v98 quad_perm:[2,2,2,2] row_mask:0xf bank_mask:0xf
    s_nop 0
    v_add_f32_dpp v122, v97, v122 quad_perm:[1,1,1,1] row_mask:0xf bank_mask:0xf
    v_add_f32_dpp v124, v99, v124 quad_perm:[3,3,3,3] row_mask:0xf bank_mask:0xf
    v_add_f32 v122, v122, v124
    v_max_f32 v65, v65, v122
    ds_write_b32 v64, v122 offset:2816
    v_mfma_f32_16x16x32_bf16 v[112:115], a[76:79], v[92:95], v[112:115]
    v_mfma_f32_16x16x32_bf16 v[96:99], a[80:83], v[80:83], 0
    v_lshlrev_b32 v4, 11, v2
    v_bfe_u32 v5, v1, 2, 2
    v_lshl_add_u32 v4, v5, 8, v4
    v_bfe_u32 v5, v1, 2, 2
    v_lshl_add_u32 v4, v5, 6, v4
    v_bfe_u32 v5, v1, 4, 1
    v_lshl_add_u32 v4, v5, 5, v4
    v_bfe_u32 v5, v1, 1, 1
    v_lshl_add_u32 v4, v5, 4, v4
    v_bfe_u32 v5, v1, 0, 1
    v_lshl_add_u32 v4, v5, 3, v4
    s_lshl_b32 s38, s34, 6
    s_add_u32 s38, s38, 98304
    v_xor_b32 v24, s38, v4
    v_xor_b32 v25, 16, v24
    v_xor_b32 v26, 32, v24
    v_xor_b32 v27, 48, v24
    v_and_b32 v4, 3, v3
    v_lshrrev_b32 v5, 2, v3
    v_lshlrev_b32 v6, 4, v2
    v_add_u32 v6, 135168, v6
    s_movk_i32 s36, 320
    v_cmp_eq_u32 vcc, 0, v5
    s_nop 1
    v_cndmask_b32 v28, 4, v4, vcc
    v_mad_u32_u24 v28, v28, s36, v6
    v_cmp_eq_u32 vcc, 1, v5
    s_nop 1
    v_cndmask_b32 v29, 4, v4, vcc
    v_mad_u32_u24 v29, v29, s36, v6
    v_lshlrev_b32 v5, 2, v1
    v_add_u32 v5, 136448, v5
    v_mov_b32 v6, 0
    ds_write_b32 v5, v6
    s_waitcnt vmcnt(5)
    buffer_load_dwordx4 v[140:143], v77, s[52:55], s85 offen offset:1024 nt
    s_add_u32 s87, s87, 1
    s_add_u32 s39, s87, s88
    s_bfe_u32 s37, s39, 0x10000
    s_lshl_b32 s37, s37, 13
    s_add_u32 s85, s37, s89
    s_bfe_u32 s37, s39, 0x10001
    s_lshl_b32 s37, s37, 12
    s_add_u32 s85, s37, s85
    s_bfe_u32 s37, s39, 0x10002
    s_lshl_b32 s37, s37, 11
    s_add_u32 s85, s37, s85
    s_bfe_u32 s37, s39, 0x10003
    s_lshl_b32 s37, s37, 14
    s_add_u32 s85, s37, s85
    s_bfe_u32 s37, s39, 0x40004
    s_lshl_b32 s37, s37, 16
    s_add_u32 s85, s37, s85
    v_mfma_f32_16x16x32_bf16 v[96:99], a[84:87], v[84:87], v[96:99]
    v_mfma_f32_16x16x32_bf16 v[96:99], a[88:91], v[88:91], v[96:99]
    v_mov_b32_dpp v122, v112 quad_perm:[0,0,0,0] row_mask:0xf bank_mask:0xf
    v_mov_b32_dpp v124, v114 quad_perm:[2,2,2,2] row_mask:0xf bank_mask:0xf
    s_nop 0
    v_add_f32_dpp v122, v113, v122 quad_perm:[1,1,1,1] row_mask:0xf bank_mask:0xf
    v_add_f32_dpp v124, v115, v124 quad_perm:[3,3,3,3] row_mask:0xf bank_mask:0xf
    v_add_f32 v122, v122, v124
    v_max_f32 v65, v65, v122
    ds_write_b32 v64, v122 offset:3072
    v_mfma_f32_16x16x32_bf16 v[96:99], a[92:95], v[92:95], v[96:99]
    s_waitcnt vmcnt(5)
    buffer_load_dwordx4 v[144:147], v76, s[52:55], s85 offen offset:0 nt
    v_mfma_f32_16x16x32_bf16 v[112:115], a[96:99], v[80:83], 0
    v_mfma_f32_16x16x32_bf16 v[112:115], a[100:103], v[84:87], v[112:115]
    v_mfma_f32_16x16x32_bf16 v[112:115], a[104:107], v[88:91], v[112:115]
    s_nop 2
    v_mov_b32_dpp v122, v96 quad_perm:[0,0,0,0] row_mask:0xf bank_mask:0xf
    v_mov_b32_dpp v124, v98 quad_perm:[2,2,2,2] row_mask:0xf bank_mask:0xf
    s_nop 0
    v_add_f32_dpp v122, v97, v122 quad_perm:[1,1,1,1] row_mask:0xf bank_mask:0xf
    v_add_f32_dpp v124, v99, v124 quad_perm:[3,3,3,3] row_mask:0xf bank_mask:0xf
    v_add_f32 v122, v122, v124
    v_max_f32 v65, v65, v122
    ds_write_b32 v64, v122 offset:3328
    v_lshlrev_b32 v30, 4, v3
    v_lshl_add_u32 v30, v2, 13, v30
    v_lshrrev_b32 v5, 2, v1
    v_lshlrev_b32 v32, 8, v5
    v_bfe_u32 v5, v1, 0, 2
    v_lshl_add_u32 v32, v5, 4, v32
    s_xor_b32 s37, s90, 4
    s_bfe_u32 s38, s37, 0x30000
    s_lshl_b32 s38, s38, 8
    s_add_u32 s36, s38, 0
    s_lshr_b32 s38, s32, 4
    s_lshl_b32 s38, s38, 7
    s_add_u32 s36, s38, s36
    s_bfe_u32 s38, s32, 0x20000
    s_lshl_b32 s38, s38, 5
    s_add_u32 s36, s38, s36
    s_bfe_u32 s38, s32, 0x20002
    s_lshl_b32 s38, s38, 3
    s_add_u32 s36, s38, s36
    v_bfe_u32 v5, v1, 0, 2
    v_lshlrev_b32 v33, 11, v5
    v_lshl_add_u32 v33, v2, 1, v33
    v_add_u32 v33, s36, v33
    v_and_b32 v5, 31, v1
    v_lshlrev_b32 v34, 4, v5
    s_mul_i32 s38, s34, 320
    s_add_u32 s38, s38, 135168
    v_lshl_add_u32 v35, v5, 3, s38
    s_bfe_u32 s38, s34, 0x10000
    s_lshl_b32 s38, s38, 12
    s_add_u32 s36, s38, s71
    s_lshr_b32 s38, s34, 1
    s_lshl_b32 s38, s38, 24
    s_add_u32 s36, s38, s36
    s_bitcmp1_b32 s90, 2
    s_cselect_b32 s46, s46, s36
    s_cselect_b64 vcc, -1, 0
    v_cndmask_b32 v54, v32, v34, vcc
    v_mfma_f32_16x16x32_bf16 v[112:115], a[108:111], v[92:95], v[112:115]
    s_waitcnt vmcnt(5)
    buffer_load_dwordx4 v[148:151], v77, s[52:55], s85 offen offset:0 nt
    v_mfma_f32_16x16x32_bf16 v[96:99], a[112:115], v[80:83], 0
    v_mfma_f32_16x16x32_bf16 v[96:99], a[116:119], v[84:87], v[96:99]
    v_mfma_f32_16x16x32_bf16 v[96:99], a[120:123], v[88:91], v[96:99]
    s_nop 2
    v_mov_b32_dpp v122, v112 quad_perm:[0,0,0,0] row_mask:0xf bank_mask:0xf
    v_mov_b32_dpp v124, v114 quad_perm:[2,2,2,2] row_mask:0xf bank_mask:0xf
    s_nop 0
    v_add_f32_dpp v122, v113, v122 quad_perm:[1,1,1,1] row_mask:0xf bank_mask:0xf
    v_add_f32_dpp v124, v115, v124 quad_perm:[3,3,3,3] row_mask:0xf bank_mask:0xf
    v_add_f32 v122, v122, v124
    v_max_f32 v65, v65, v122
    ds_write_b32 v64, v122 offset:3584
    v_mfma_f32_16x16x32_bf16 v[96:99], a[124:127], v[92:95], v[96:99]
    v_add_u32 v64, 3840, v64
    s_mov_b32 s97, 8
    s_mov_b32 s92, 1
    s_lshl_b32 s38, s32, 13
    s_add_u32 s80, s38, 3145728
    s_lshl_b32 s38, s3, 11
    s_add_u32 s80, s38, s80
    v_lshrrev_b32 v4, 2, v1
    v_lshlrev_b32 v55, 3, v4
    s_mov_b32 s66, 134217728
    s_mov_b32 s67, 0x20000
    s_mov_b64 s[64:65], s[52:53]
    v_mov_b32 v62, v76
    v_mov_b32 v63, v77
    s_branch L_bloop
L_ql:
    v_lshrrev_b32 v4, 2, v3
    v_and_b32 v5, 3, v3
    v_lshlrev_b32 v19, 6, v2
    v_lshl_add_u32 v19, v5, 4, v19
    v_lshl_add_u32 v14, v4, 18, v19
    s_and_b32 s61, s32, 28
    s_add_u32 s61, s61, s34
    s_and_b32 s60, s32, 3
    s_lshl_b32 s38, s60, 20
    s_add_u32 s63, s38, 0
    s_lshl_b32 s38, s61, 8
    s_add_u32 s63, s38, s63
    s_mov_b32 s74, 4194304
    s_mov_b32 s75, 0x20000
    s_waitcnt lgkmcnt(0)
    s_mov_b64 s[72:73], s[10:11]
    buffer_load_dwordx4 a[128:131], v14, s[72:75], s63 offen nt
    s_add_u32 s63, s63, 8192
    buffer_load_dwordx4 a[132:135], v14, s[72:75], s63 offen nt
    s_add_u32 s63, s63, 8192
    buffer_load_dwordx4 a[136:139], v14, s[72:75], s63 offen nt
    s_add_u32 s63, s63, 8192
    buffer_load_dwordx4 a[140:143], v14, s[72:75], s63 offen nt
    s_add_u32 s63, s63, 8192
    buffer_load_dwordx4 a[144:147], v14, s[72:75], s63 offen nt
    s_add_u32 s63, s63, 8192
    buffer_load_dwordx4 a[148:151], v14, s[72:75], s63 offen nt
    s_add_u32 s63, s63, 8192
    buffer_load_dwordx4 a[152:155], v14, s[72:75], s63 offen nt
    s_add_u32 s63, s63, 8192
    buffer_load_dwordx4 a[156:159], v14, s[72:75], s63 offen nt
    s_add_u32 s63, s63, 8192
    v_lshlrev_b32 v15, 1, v19
    v_lshl_add_u32 v15, v4, 9, v15
    v_lshl_add_u32 v19, v4, 15, v19
    s_load_dword s35, s[30:31], 0
    s_mov_b32 s48, s30
    s_and_b32 s49, s31, 0xffff
    s_mov_b32 s50, 8388608
    s_mov_b32 s51, 0x20000
    s_mov_b32 s82, 0xffffff00
    s_mov_b32 s83, 0x3e0293ee
    s_mov_b32 s84, 8388608
    s_lshl_b32 s38, s61, 12
    s_add_u32 s95, s38, 264192
    s_lshl_b32 s38, s61, 10
    s_add_u32 s94, s38, 393216
    s_lshl_b32 s38, s60, 8
    s_add_u32 s94, s38, s94
    buffer_load_dwordx4 a[160:163], v14, s[72:75], s63 offen nt
    s_add_u32 s63, s63, 8192
    buffer_load_dwordx4 a[164:167], v14, s[72:75], s63 offen nt
    s_add_u32 s63, s63, 8192
    buffer_load_dwordx4 a[168:171], v14, s[72:75], s63 offen nt
    s_add_u32 s63, s63, 8192
    buffer_load_dwordx4 a[172:175], v14, s[72:75], s63 offen nt
    s_add_u32 s63, s63, 8192
    s_waitcnt vmcnt(11)
    buffer_load_dwordx4 a[176:179], v14, s[72:75], s63 offen nt
    s_add_u32 s63, s63, 8192
    v_and_b32 v4, 1, v1
    v_lshlrev_b32 v4, 4, v4
    v_mov_b32 v5, 0xffff
    v_lshlrev_b32 v4, v4, v5
    v_bfe_u32 v5, v1, 1, 2
    v_cmp_eq_u32 vcc, 0, v5
    s_nop 1
    v_cndmask_b32 v10, 0, v4, vcc
    v_cmp_eq_u32 vcc, 1, v5
    s_nop 1
    v_cndmask_b32 v11, 0, v4, vcc
    v_cmp_eq_u32 vcc, 2, v5
    s_nop 1
    v_cndmask_b32 v12, 0, v4, vcc
    v_cmp_eq_u32 vcc, 3, v5
    s_nop 1
    v_cndmask_b32 v13, 0, v4, vcc
    s_waitcnt vmcnt(11)
    buffer_load_dwordx4 a[180:183], v14, s[72:75], s63 offen nt
    s_add_u32 s63, s63, 8192
    s_waitcnt vmcnt(11)
    buffer_load_dwordx4 a[184:187], v14, s[72:75], s63 offen nt
    s_add_u32 s63, s63, 8192
    s_waitcnt vmcnt(11)
    buffer_load_dwordx4 a[188:191], v14, s[72:75], s63 offen nt
    s_add_u32 s63, s63, 8192
    s_waitcnt vmcnt(11)
    buffer_load_dwordx4 a[192:195], v14, s[72:75], s63 offen nt
    s_add_u32 s63, s63, 8192
    v_lshrrev_b32 v4, 2, v3
    v_and_b32 v5, 3, v3
    v_lshlrev_b32 v76, 8, v4
    v_lshlrev_b32 v126, 8, v2
    v_lshl_add_u32 v76, v2, 6, v76
    v_lshl_add_u32 v76, v5, 4, v76
    v_lshl_add_u32 v126, v3, 4, v126
    v_xor_b32 v77, 32768, v76
    v_xor_b32 v127, 32768, v126
    s_add_u32 s3, s34, s33
    s_and_b32 s3, s3, 3
    s_lshl_b32 s89, s3, 5
    s_add_u32 s89, s89, s32
    s_lshl_b32 s89, s89, 20
    s_mul_i32 s88, s32, 8
    s_mul_i32 s38, s3, 2
    s_add_u32 s88, s88, s38
    s_lshl_b32 s87, s33, 1
    s_waitcnt vmcnt(11)
    buffer_load_dwordx4 a[196:199], v14, s[72:75], s63 offen nt
    s_add_u32 s63, s63, 8192
    s_waitcnt vmcnt(11)
    buffer_load_dwordx4 a[200:203], v14, s[72:75], s63 offen nt
    s_add_u32 s63, s63, 8192
    s_waitcnt vmcnt(11)
    buffer_load_dwordx4 a[204:207], v14, s[72:75], s63 offen nt
    s_add_u32 s63, s63, 8192
    s_waitcnt vmcnt(11)
    buffer_load_dwordx4 a[208:211], v14, s[72:75], s63 offen nt
    s_add_u32 s63, s63, 8192
    s_mov_b32 s52, s18
    s_and_b32 s53, s19, 0xffff
    s_mov_b32 s54, 134217728
    s_mov_b32 s55, 0x20000
    s_mov_b32 s56, s20
    s_and_b32 s57, s21, 0xffff
    s_mov_b32 s58, 134217728
    s_mov_b32 s59, 0x20000
    s_waitcnt vmcnt(11)
    buffer_load_dwordx4 a[212:215], v14, s[72:75], s63 offen nt
    s_add_u32 s63, s63, 8192
    s_waitcnt vmcnt(11)
    buffer_load_dwordx4 a[216:219], v14, s[72:75], s63 offen nt
    s_add_u32 s63, s63, 8192
    s_waitcnt vmcnt(11)
    buffer_load_dwordx4 a[220:223], v14, s[72:75], s63 offen nt
    s_add_u32 s63, s63, 8192
    s_waitcnt vmcnt(11)
    buffer_load_dwordx4 a[224:227], v14, s[72:75], s63 offen nt
    s_add_u32 s63, s63, 8192
    v_mov_b32 v120, 0xff7f0000
    v_mov_b32 v121, 0
    v_mov_b32 v18, 1
    v_mov_b32 v116, 0
    v_mov_b32 v117, 0
    v_mov_b32 v118, 0
    v_mov_b32 v119, 0
    v_lshlrev_b32 v0, 3, v1
    ds_write_b64 v0, v[116:117] offset:8192
    v_mov_b32 v0, 8192
    s_lshl_b32 s38, s32, 10
    s_add_u32 s96, s38, 65536
    s_lshr_b32 s38, s32, 3
    s_lshl_b32 s38, s38, 8
    s_add_u32 s96, s38, s96
    v_mov_b32 v9, s96
    s_lshl_b32 s38, s32, 15
    s_add_u32 s96, s38, 1048576
    s_lshl_b32 s38, s3, 13
    s_add_u32 s96, s38, s96
    s_lshl_b32 s38, s33, 10
    s_add_u32 s96, s38, s96
    v_and_b32 v5, 3, v3
    v_lshlrev_b32 v78, 7, v2
    v_lshl_add_u32 v78, v5, 5, v78
    s_lshl_b32 s38, s32, 12
    s_add_u32 s91, s38, 262144
    s_lshl_b32 s38, s3, 9
    s_add_u32 s91, s38, s91
    v_lshlrev_b32 v4, 7, v2
    v_lshl_add_u32 v4, v3, 4, v4
    v_mov_b32 v5, 512
    v_cmp_gt_u32 vcc, 8, v3
    s_nop 1
    v_cndmask_b32 v79, v5, v4, vcc
    s_waitcnt vmcnt(11)
    buffer_load_dwordx4 a[228:231], v14, s[72:75], s63 offen nt
    s_add_u32 s63, s63, 8192
    s_waitcnt vmcnt(11)
    buffer_load_dwordx4 a[232:235], v14, s[72:75], s63 offen nt
    s_add_u32 s63, s63, 8192
    s_waitcnt vmcnt(11)
    buffer_load_dwordx4 a[236:239], v14, s[72:75], s63 offen nt
    s_add_u32 s63, s63, 8192
    s_waitcnt vmcnt(11)
    buffer_load_dwordx4 a[240:243], v14, s[72:75], s63 offen nt
    s_add_u32 s63, s63, 8192
    s_waitcnt vmcnt(11)
    buffer_load_dwordx4 a[244:247], v14, s[72:75], s63 offen nt
    s_add_u32 s63, s63, 8192
    s_waitcnt vmcnt(11)
    buffer_load_dwordx4 a[248:251], v14, s[72:75], s63 offen nt
    s_add_u32 s63, s63, 8192
    s_waitcnt vmcnt(11)
    buffer_load_dwordx4 a[252:255], v14, s[72:75], s63 offen nt
    s_add_u32 s63, s63, 8192
    s_waitcnt lgkmcnt(0)
    s_add_u32 s35, s35, 0x5b
    s_and_b32 s35, s35, 0xff
    v_mov_b32 v8, s35
    s_or_b32 s68, s35, 0x6b3ac500
    s_waitcnt vmcnt(6)
    s_add_u32 s39, s87, s88
    s_bfe_u32 s37, s39, 0x10000
    s_lshl_b32 s37, s37, 13
    s_add_u32 s85, s37, s89
    s_bfe_u32 s37, s39, 0x10001
    s_lshl_b32 s37, s37, 12
    s_add_u32 s85, s37, s85
    s_bfe_u32 s37, s39, 0x10002
    s_lshl_b32 s37, s37, 11
    s_add_u32 s85, s37, s85
    s_bfe_u32 s37, s39, 0x10003
    s_lshl_b32 s37, s37, 14
    s_add_u32 s85, s37, s85
    s_bfe_u32 s37, s39, 0x40004
    s_lshl_b32 s37, s37, 16
    s_add_u32 s85, s37, s85
    buffer_load_dwordx4 v[128:131], v76, s[52:55], s85 offen offset:0 nt
    s_waitcnt vmcnt(6)
    buffer_load_dwordx4 v[132:135], v77, s[52:55], s85 offen offset:0 nt
    s_waitcnt vmcnt(6)
    buffer_load_dwordx4 v[136:139], v76, s[52:55], s85 offen offset:1024 nt
    s_waitcnt vmcnt(6)
    buffer_load_dwordx4 v[140:143], v77, s[52:55], s85 offen offset:1024 nt
    s_add_u32 s87, s87, 1
    s_add_u32 s39, s87, s88
    s_bfe_u32 s37, s39, 0x10000
    s_lshl_b32 s37, s37, 13
    s_add_u32 s85, s37, s89
    s_bfe_u32 s37, s39, 0x10001
    s_lshl_b32 s37, s37, 12
    s_add_u32 s85, s37, s85
    s_bfe_u32 s37, s39, 0x10002
    s_lshl_b32 s37, s37, 11
    s_add_u32 s85, s37, s85
    s_bfe_u32 s37, s39, 0x10003
    s_lshl_b32 s37, s37, 14
    s_add_u32 s85, s37, s85
    s_bfe_u32 s37, s39, 0x40004
    s_lshl_b32 s37, s37, 16
    s_add_u32 s85, s37, s85
    s_waitcnt vmcnt(6)
    buffer_load_dwordx4 v[144:147], v76, s[52:55], s85 offen offset:0 nt
    s_waitcnt vmcnt(6)
    buffer_load_dwordx4 v[148:151], v77, s[52:55], s85 offen offset:0 nt
    s_waitcnt vmcnt(6)
    buffer_load_dwordx4 v[152:155], v76, s[52:55], s85 offen offset:1024 nt
    s_waitcnt vmcnt(6)
    buffer_load_dwordx4 v[156:159], v77, s[52:55], s85 offen offset:1024 nt
    s_add_u32 s87, s87, 13
    s_add_u32 s39, s87, s88
    s_bfe_u32 s37, s39, 0x10000
    s_lshl_b32 s37, s37, 13
    s_add_u32 s85, s37, s89
    s_bfe_u32 s37, s39, 0x10001
    s_lshl_b32 s37, s37, 12
    s_add_u32 s85, s37, s85
    s_bfe_u32 s37, s39, 0x10002
    s_lshl_b32 s37, s37, 11
    s_add_u32 s85, s37, s85
    s_bfe_u32 s37, s39, 0x10003
    s_lshl_b32 s37, s37, 14
    s_add_u32 s85, s37, s85
    s_bfe_u32 s37, s39, 0x40004
    s_lshl_b32 s37, s37, 16
    s_add_u32 s85, s37, s85
    s_waitcnt vmcnt(6)
    buffer_load_dwordx4 v[160:163], v76, s[52:55], s85 offen offset:0 nt
    s_waitcnt vmcnt(6)
    buffer_load_dwordx4 v[164:167], v77, s[52:55], s85 offen offset:0 nt
    s_waitcnt vmcnt(6)
    buffer_load_dwordx4 v[168:171], v76, s[52:55], s85 offen offset:1024 nt
    s_waitcnt vmcnt(6)
    buffer_load_dwordx4 v[172:175], v77, s[52:55], s85 offen offset:1024 nt
    s_add_u32 s87, s87, 1
    s_add_u32 s39, s87, s88
    s_bfe_u32 s37, s39, 0x10000
    s_lshl_b32 s37, s37, 13
    s_add_u32 s85, s37, s89
    s_bfe_u32 s37, s39, 0x10001
    s_lshl_b32 s37, s37, 12
    s_add_u32 s85, s37, s85
    s_bfe_u32 s37, s39, 0x10002
    s_lshl_b32 s37, s37, 11
    s_add_u32 s85, s37, s85
    s_bfe_u32 s37, s39, 0x10003
    s_lshl_b32 s37, s37, 14
    s_add_u32 s85, s37, s85
    s_bfe_u32 s37, s39, 0x40004
    s_lshl_b32 s37, s37, 16
    s_add_u32 s85, s37, s85
    s_waitcnt vmcnt(6)
    buffer_load_dwordx4 v[176:179], v76, s[52:55], s85 offen offset:0 nt
    s_waitcnt vmcnt(6)
    buffer_load_dwordx4 v[180:183], v77, s[52:55], s85 offen offset:0 nt
    s_waitcnt vmcnt(6)
    buffer_load_dwordx4 v[184:187], v76, s[52:55], s85 offen offset:1024 nt
    s_waitcnt vmcnt(6)
    buffer_load_dwordx4 v[188:191], v77, s[52:55], s85 offen offset:1024 nt
    s_add_u32 s87, s87, 13
    s_add_u32 s39, s87, s88
    s_bfe_u32 s37, s39, 0x10000
    s_lshl_b32 s37, s37, 13
    s_add_u32 s85, s37, s89
    s_bfe_u32 s37, s39, 0x10001
    s_lshl_b32 s37, s37, 12
    s_add_u32 s85, s37, s85
    s_bfe_u32 s37, s39, 0x10002
    s_lshl_b32 s37, s37, 11
    s_add_u32 s85, s37, s85
    s_bfe_u32 s37, s39, 0x10003
    s_lshl_b32 s37, s37, 14
    s_add_u32 s85, s37, s85
    s_bfe_u32 s37, s39, 0x40004
    s_lshl_b32 s37, s37, 16
    s_add_u32 s85, s37, s85
    s_waitcnt vmcnt(6)
    buffer_load_dwordx4 v[192:195], v76, s[52:55], s85 offen offset:0 nt
    s_waitcnt vmcnt(6)
    buffer_load_dwordx4 v[196:199], v77, s[52:55], s85 offen offset:0 nt
    s_waitcnt vmcnt(6)
    buffer_load_dwordx4 v[200:203], v76, s[52:55], s85 offen offset:1024 nt
    s_waitcnt vmcnt(6)
    buffer_load_dwordx4 v[204:207], v77, s[52:55], s85 offen offset:1024 nt
    s_add_u32 s87, s87, 1
    s_add_u32 s39, s87, s88
    s_bfe_u32 s37, s39, 0x10000
    s_lshl_b32 s37, s37, 13
    s_add_u32 s85, s37, s89
    s_bfe_u32 s37, s39, 0x10001
    s_lshl_b32 s37, s37, 12
    s_add_u32 s85, s37, s85
    s_bfe_u32 s37, s39, 0x10002
    s_lshl_b32 s37, s37, 11
    s_add_u32 s85, s37, s85
    s_bfe_u32 s37, s39, 0x10003
    s_lshl_b32 s37, s37, 14
    s_add_u32 s85, s37, s85
    s_bfe_u32 s37, s39, 0x40004
    s_lshl_b32 s37, s37, 16
    s_add_u32 s85, s37, s85
    s_waitcnt vmcnt(6)
    buffer_load_dwordx4 v[208:211], v76, s[52:55], s85 offen offset:0 nt
    s_waitcnt vmcnt(6)
    buffer_load_dwordx4 v[212:215], v77, s[52:55], s85 offen offset:0 nt
    s_waitcnt vmcnt(6)
    buffer_load_dwordx4 v[216:219], v76, s[52:55], s85 offen offset:1024 nt
    s_waitcnt vmcnt(6)
    buffer_load_dwordx4 v[220:223], v77, s[52:55], s85 offen offset:1024 nt
    s_add_u32 s87, s87, 13
    s_add_u32 s39, s87, s88
    s_bfe_u32 s37, s39, 0x10000
    s_lshl_b32 s37, s37, 13
    s_add_u32 s85, s37, s89
    s_bfe_u32 s37, s39, 0x10001
    s_lshl_b32 s37, s37, 12
    s_add_u32 s85, s37, s85
    s_bfe_u32 s37, s39, 0x10002
    s_lshl_b32 s37, s37, 11
    s_add_u32 s85, s37, s85
    s_bfe_u32 s37, s39, 0x10003
    s_lshl_b32 s37, s37, 14
    s_add_u32 s85, s37, s85
    s_bfe_u32 s37, s39, 0x40004
    s_lshl_b32 s37, s37, 16
    s_add_u32 s85, s37, s85
    s_waitcnt vmcnt(6)
    buffer_load_dwordx4 v[224:227], v76, s[52:55], s85 offen offset:0 nt
    s_waitcnt vmcnt(6)
    buffer_load_dwordx4 v[228:231], v77, s[52:55], s85 offen offset:0 nt
    s_waitcnt vmcnt(6)
    buffer_load_dwordx4 v[232:235], v76, s[52:55], s85 offen offset:1024 nt
    s_waitcnt vmcnt(6)
    buffer_load_dwordx4 v[236:239], v77, s[52:55], s85 offen offset:1024 nt
    s_add_u32 s87, s87, 1
    s_add_u32 s39, s87, s88
    s_bfe_u32 s37, s39, 0x10000
    s_lshl_b32 s37, s37, 13
    s_add_u32 s85, s37, s89
    s_bfe_u32 s37, s39, 0x10001
    s_lshl_b32 s37, s37, 12
    s_add_u32 s85, s37, s85
    s_bfe_u32 s37, s39, 0x10002
    s_lshl_b32 s37, s37, 11
    s_add_u32 s85, s37, s85
    s_bfe_u32 s37, s39, 0x10003
    s_lshl_b32 s37, s37, 14
    s_add_u32 s85, s37, s85
    s_bfe_u32 s37, s39, 0x40004
    s_lshl_b32 s37, s37, 16
    s_add_u32 s85, s37, s85
    s_waitcnt vmcnt(6)
    buffer_load_dwordx4 v[240:243], v76, s[52:55], s85 offen offset:0 nt
    s_waitcnt vmcnt(6)
    buffer_load_dwordx4 v[244:247], v77, s[52:55], s85 offen offset:0 nt
    buffer_load_dwordx4 v[20:23], v15, s[48:51], s95 offen offset:0 sc1
    buffer_load_dwordx4 v[24:27], v15, s[48:51], s95 offen offset:16 sc1
    s_waitcnt vmcnt(8)
    buffer_load_dwordx4 v[248:251], v76, s[52:55], s85 offen offset:1024 nt
    s_waitcnt vmcnt(8)
    buffer_load_dwordx4 v[252:255], v77, s[52:55], s85 offen offset:1024 nt
    s_add_u32 s87, s87, 13
    s_add_u32 s39, s87, s88
    s_bfe_u32 s37, s39, 0x10000
    s_lshl_b32 s37, s37, 13
    s_add_u32 s85, s37, s89
    s_bfe_u32 s37, s39, 0x10001
    s_lshl_b32 s37, s37, 12
    s_add_u32 s85, s37, s85
    s_bfe_u32 s37, s39, 0x10002
    s_lshl_b32 s37, s37, 11
    s_add_u32 s85, s37, s85
    s_bfe_u32 s37, s39, 0x10003
    s_lshl_b32 s37, s37, 14
    s_add_u32 s85, s37, s85
    s_bfe_u32 s37, s39, 0x40004
    s_lshl_b32 s37, s37, 16
    s_add_u32 s85, s37, s85
    s_waitcnt vmcnt(8)
    buffer_load_dwordx4 a[0:3], v76, s[52:55], s85 offen offset:0 nt
    s_waitcnt vmcnt(8)
    buffer_load_dwordx4 a[4:7], v77, s[52:55], s85 offen offset:0 nt
    s_waitcnt vmcnt(8)
    buffer_load_dwordx4 a[8:11], v76, s[52:55], s85 offen offset:1024 nt
    s_waitcnt vmcnt(8)
    buffer_load_dwordx4 a[12:15], v77, s[52:55], s85 offen offset:1024 nt
    s_add_u32 s87, s87, 1
    s_add_u32 s39, s87, s88
    s_bfe_u32 s37, s39, 0x10000
    s_lshl_b32 s37, s37, 13
    s_add_u32 s85, s37, s89
    s_bfe_u32 s37, s39, 0x10001
    s_lshl_b32 s37, s37, 12
    s_add_u32 s85, s37, s85
    s_bfe_u32 s37, s39, 0x10002
    s_lshl_b32 s37, s37, 11
    s_add_u32 s85, s37, s85
    s_bfe_u32 s37, s39, 0x10003
    s_lshl_b32 s37, s37, 14
    s_add_u32 s85, s37, s85
    s_bfe_u32 s37, s39, 0x40004
    s_lshl_b32 s37, s37, 16
    s_add_u32 s85, s37, s85
    s_waitcnt vmcnt(6)
L_qacheck_41:
    v_xor_b32 v20, s35, v20
    v_xor_b32 v21, s35, v21
    v_xor_b32 v22, s35, v22
    v_xor_b32 v23, s35, v23
    v_xor_b32 v24, s35, v24
    v_xor_b32 v25, s35, v25
    v_xor_b32 v26, s35, v26
    v_xor_b32 v27, s35, v27
    v_or_b32 v4, v20, v21
    v_or3_b32 v4, v4, v22, v23
    v_or3_b32 v4, v4, v24, v25
    v_or3_b32 v4, v4, v26, v27
    v_and_b32 v4, 0xff, v4
    v_cmp_ne_u32 vcc, 0, v4
    s_cbranch_vccz L_qaok_42
    buffer_load_dwordx4 v[20:23], v15, s[48:51], s95 offen offset:0 sc1
    buffer_load_dwordx4 v[24:27], v15, s[48:51], s95 offen offset:16 sc1
    s_waitcnt vmcnt(0)
    s_sub_u32 s84, s84, 1
    s_cmp_lg_u32 s84, 0
    s_cbranch_scc1 L_qacheck_41
    s_branch L_end
L_qaok_42:
    buffer_load_dwordx4 v[68:71], v78, s[48:51], s91 offen offset:0 sc1
    buffer_load_dwordx4 v[72:75], v78, s[48:51], s91 offen offset:16 sc1
    v_cvt_pk_bf16_f32 v20, v20, v21
    v_cvt_pk_bf16_f32 v21, v22, v23
    v_cvt_pk_bf16_f32 v22, v24, v25
    v_cvt_pk_bf16_f32 v23, v26, v27
    s_nop 1
    v_mfma_f32_16x16x32_bf16 v[28:31], a[128:131], v[20:23], 0
    v_mfma_f32_16x16x32_bf16 v[32:35], a[132:135], v[20:23], 0
    v_mfma_f32_16x16x32_bf16 v[36:39], a[136:139], v[20:23], 0
    s_nop 5
    v_mov_b32_dpp v60, v28 quad_perm:[0,0,0,0] row_mask:0xf bank_mask:0xf
    v_mov_b32_dpp v4, v30 quad_perm:[2,2,2,2] row_mask:0xf bank_mask:0xf
    s_nop 0
    v_add_f32_dpp v60, v29, v60 quad_perm:[1,1,1,1] row_mask:0xf bank_mask:0xf
    v_add_f32_dpp v4, v31, v4 quad_perm:[3,3,3,3] row_mask:0xf bank_mask:0xf
    v_add_f32 v60, v60, v4
    v_mfma_f32_16x16x32_bf16 v[40:43], a[140:143], v[20:23], 0
    v_mov_b32_dpp v61, v32 quad_perm:[0,0,0,0] row_mask:0xf bank_mask:0xf
    v_mov_b32_dpp v4, v34 quad_perm:[2,2,2,2] row_mask:0xf bank_mask:0xf
    s_nop 0
    v_add_f32_dpp v61, v33, v61 quad_perm:[1,1,1,1] row_mask:0xf bank_mask:0xf
    v_add_f32_dpp v4, v35, v4 quad_perm:[3,3,3,3] row_mask:0xf bank_mask:0xf
    v_add_f32 v61, v61, v4
    v_cvt_pk_bf16_f32 v44, v60, v61
    v_mfma_f32_16x16x32_bf16 v[28:31], a[144:147], v[20:23], 0
    v_mov_b32_dpp v60, v36 quad_perm:[0,0,0,0] row_mask:0xf bank_mask:0xf
    v_mov_b32_dpp v4, v38 quad_perm:[2,2,2,2] row_mask:0xf bank_mask:0xf
    s_nop 0
    v_add_f32_dpp v60, v37, v60 quad_perm:[1,1,1,1] row_mask:0xf bank_mask:0xf
    v_add_f32_dpp v4, v39, v4 quad_perm:[3,3,3,3] row_mask:0xf bank_mask:0xf
    v_add_f32 v60, v60, v4
    buffer_load_dwordx4 a[16:19], v76, s[52:55], s85 offen offset:0 nt
    v_mfma_f32_16x16x32_bf16 v[32:35], a[148:151], v[20:23], 0
    v_mov_b32_dpp v61, v40 quad_perm:[0,0,0,0] row_mask:0xf bank_mask:0xf
    v_mov_b32_dpp v4, v42 quad_perm:[2,2,2,2] row_mask:0xf bank_mask:0xf
    s_nop 0
    v_add_f32_dpp v61, v41, v61 quad_perm:[1,1,1,1] row_mask:0xf bank_mask:0xf
    v_add_f32_dpp v4, v43, v4 quad_perm:[3,3,3,3] row_mask:0xf bank_mask:0xf
    v_add_f32 v61, v61, v4
    v_cvt_pk_bf16_f32 v45, v60, v61
    v_mfma_f32_16x16x32_bf16 v[36:39], a[152:155], v[20:23], 0
    v_mov_b32_dpp v60, v28 quad_perm:[0,0,0,0] row_mask:0xf bank_mask:0xf
    v_mov_b32_dpp v4, v30 quad_perm:[2,2,2,2] row_mask:0xf bank_mask:0xf
    s_nop 0
    v_add_f32_dpp v60, v29, v60 quad_perm:[1,1,1,1] row_mask:0xf bank_mask:0xf
    v_add_f32_dpp v4, v31, v4 quad_perm:[3,3,3,3] row_mask:0xf bank_mask:0xf
    v_add_f32 v60, v60, v4
    v_mfma_f32_16x16x32_bf16 v[40:43], a[156:159], v[20:23], 0
    v_mov_b32_dpp v61, v32 quad_perm:[0,0,0,0] row_mask:0xf bank_mask:0xf
    v_mov_b32_dpp v4, v34 quad_perm:[2,2,2,2] row_mask:0xf bank_mask:0xf
    s_nop 0
    v_add_f32_dpp v61, v33, v61 quad_perm:[1,1,1,1] row_mask:0xf bank_mask:0xf
    v_add_f32_dpp v4, v35, v4 quad_perm:[3,3,3,3] row_mask:0xf bank_mask:0xf
    v_add_f32 v61, v61, v4
    v_cvt_pk_bf16_f32 v46, v60, v61
    v_mfma_f32_16x16x32_bf16 v[28:31], a[160:163], v[20:23], 0
    v_mov_b32_dpp v60, v36 quad_perm:[0,0,0,0] row_mask:0xf bank_mask:0xf
    v_mov_b32_dpp v4, v38 quad_perm:[2,2,2,2] row_mask:0xf bank_mask:0xf
    s_nop 0
    v_add_f32_dpp v60, v37, v60 quad_perm:[1,1,1,1] row_mask:0xf bank_mask:0xf
    v_add_f32_dpp v4, v39, v4 quad_perm:[3,3,3,3] row_mask:0xf bank_mask:0xf
    v_add_f32 v60, v60, v4
    v_mfma_f32_16x16x32_bf16 v[32:35], a[164:167], v[20:23], 0
    v_mov_b32_dpp v61, v40 quad_perm:[0,0,0,0] row_mask:0xf bank_mask:0xf
    v_mov_b32_dpp v4, v42 quad_perm:[2,2,2,2] row_mask:0xf bank_mask:0xf
    s_nop 0
    v_add_f32_dpp v61, v41, v61 quad_perm:[1,1,1,1] row_mask:0xf bank_mask:0xf
    v_add_f32_dpp v4, v43, v4 quad_perm:[3,3,3,3] row_mask:0xf bank_mask:0xf
    v_add_f32 v61, v61, v4
    v_cvt_pk_bf16_f32 v47, v60, v61
    v_mfma_f32_16x16x32_bf16 v[36:39], a[168:171], v[20:23], 0
    v_mov_b32_dpp v60, v28 quad_perm:[0,0,0,0] row_mask:0xf bank_mask:0xf
    v_mov_b32_dpp v4, v30 quad_perm:[2,2,2,2] row_mask:0xf bank_mask:0xf
    s_nop 0
    v_add_f32_dpp v60, v29, v60 quad_perm:[1,1,1,1] row_mask:0xf bank_mask:0xf
    v_add_f32_dpp v4, v31, v4 quad_perm:[3,3,3,3] row_mask:0xf bank_mask:0xf
    v_add_f32 v60, v60, v4
    v_mfma_f32_16x16x32_bf16 v[40:43], a[172:175], v[20:23], 0
    v_mov_b32_dpp v61, v32 quad_perm:[0,0,0,0] row_mask:0xf bank_mask:0xf
    v_mov_b32_dpp v4, v34 quad_perm:[2,2,2,2] row_mask:0xf bank_mask:0xf
    s_nop 0
    v_add_f32_dpp v61, v33, v61 quad_perm:[1,1,1,1] row_mask:0xf bank_mask:0xf
    v_add_f32_dpp v4, v35, v4 quad_perm:[3,3,3,3] row_mask:0xf bank_mask:0xf
    v_add_f32 v61, v61, v4
    v_cvt_pk_bf16_f32 v48, v60, v61
    v_mfma_f32_16x16x32_bf16 v[28:31], a[176:179], v[20:23], 0
    v_mov_b32_dpp v60, v36 quad_perm:[0,0,0,0] row_mask:0xf bank_mask:0xf
    v_mov_b32_dpp v4, v38 quad_perm:[2,2,2,2] row_mask:0xf bank_mask:0xf
    s_nop 0
    v_add_f32_dpp v60, v37, v60 quad_perm:[1,1,1,1] row_mask:0xf bank_mask:0xf
    v_add_f32_dpp v4, v39, v4 quad_perm:[3,3,3,3] row_mask:0xf bank_mask:0xf
    v_add_f32 v60, v60, v4
    buffer_load_dwordx4 a[20:23], v77, s[52:55], s85 offen offset:0 nt
    v_mfma_f32_16x16x32_bf16 v[32:35], a[180:183], v[20:23], 0
    v_mov_b32_dpp v61, v40 quad_perm:[0,0,0,0] row_mask:0xf bank_mask:0xf
    v_mov_b32_dpp v4, v42 quad_perm:[2,2,2,2] row_mask:0xf bank_mask:0xf
    s_nop 0
    v_add_f32_dpp v61, v41, v61 quad_perm:[1,1,1,1] row_mask:0xf bank_mask:0xf
    v_add_f32_dpp v4, v43, v4 quad_perm:[3,3,3,3] row_mask:0xf bank_mask:0xf
    v_add_f32 v61, v61, v4
    v_cvt_pk_bf16_f32 v49, v60, v61
    v_mfma_f32_16x16x32_bf16 v[36:39], a[184:187], v[20:23], 0
    v_mov_b32_dpp v60, v28 quad_perm:[0,0,0,0] row_mask:0xf bank_mask:0xf
    v_mov_b32_dpp v4, v30 quad_perm:[2,2,2,2] row_mask:0xf bank_mask:0xf
    s_nop 0
    v_add_f32_dpp v60, v29, v60 quad_perm:[1,1,1,1] row_mask:0xf bank_mask:0xf
    v_add_f32_dpp v4, v31, v4 quad_perm:[3,3,3,3] row_mask:0xf bank_mask:0xf
    v_add_f32 v60, v60, v4
    v_mfma_f32_16x16x32_bf16 v[40:43], a[188:191], v[20:23], 0
    v_mov_b32_dpp v61, v32 quad_perm:[0,0,0,0] row_mask:0xf bank_mask:0xf
    v_mov_b32_dpp v4, v34 quad_perm:[2,2,2,2] row_mask:0xf bank_mask:0xf
    s_nop 0
    v_add_f32_dpp v61, v33, v61 quad_perm:[1,1,1,1] row_mask:0xf bank_mask:0xf
    v_add_f32_dpp v4, v35, v4 quad_perm:[3,3,3,3] row_mask:0xf bank_mask:0xf
    v_add_f32 v61, v61, v4
    v_cvt_pk_bf16_f32 v50, v60, v61
    v_mfma_f32_16x16x32_bf16 v[28:31], a[192:195], v[20:23], 0
    v_mov_b32_dpp v60, v36 quad_perm:[0,0,0,0] row_mask:0xf bank_mask:0xf
    v_mov_b32_dpp v4, v38 quad_perm:[2,2,2,2] row_mask:0xf bank_mask:0xf
    s_nop 0
    v_add_f32_dpp v60, v37, v60 quad_perm:[1,1,1,1] row_mask:0xf bank_mask:0xf
    v_add_f32_dpp v4, v39, v4 quad_perm:[3,3,3,3] row_mask:0xf bank_mask:0xf
    v_add_f32 v60, v60, v4
    v_mfma_f32_16x16x32_bf16 v[32:35], a[196:199], v[20:23], 0
    v_mov_b32_dpp v61, v40 quad_perm:[0,0,0,0] row_mask:0xf bank_mask:0xf
    v_mov_b32_dpp v4, v42 quad_perm:[2,2,2,2] row_mask:0xf bank_mask:0xf
    s_nop 0
    v_add_f32_dpp v61, v41, v61 quad_perm:[1,1,1,1] row_mask:0xf bank_mask:0xf
    v_add_f32_dpp v4, v43, v4 quad_perm:[3,3,3,3] row_mask:0xf bank_mask:0xf
    v_add_f32 v61, v61, v4
    v_cvt_pk_bf16_f32 v51, v60, v61
    v_mfma_f32_16x16x32_bf16 v[36:39], a[200:203], v[20:23], 0
    v_mov_b32_dpp v60, v28 quad_perm:[0,0,0,0] row_mask:0xf bank_mask:0xf
    v_mov_b32_dpp v4, v30 quad_perm:[2,2,2,2] row_mask:0xf bank_mask:0xf
    s_nop 0
    v_add_f32_dpp v60, v29, v60 quad_perm:[1,1,1,1] row_mask:0xf bank_mask:0xf
    v_add_f32_dpp v4, v31, v4 quad_perm:[3,3,3,3] row_mask:0xf bank_mask:0xf
    v_add_f32 v60, v60, v4
    v_mfma_f32_16x16x32_bf16 v[40:43], a[204:207], v[20:23], 0
    v_mov_b32_dpp v61, v32 quad_perm:[0,0,0,0] row_mask:0xf bank_mask:0xf
    v_mov_b32_dpp v4, v34 quad_perm:[2,2,2,2] row_mask:0xf bank_mask:0xf
    s_nop 0
    v_add_f32_dpp v61, v33, v61 quad_perm:[1,1,1,1] row_mask:0xf bank_mask:0xf
    v_add_f32_dpp v4, v35, v4 quad_perm:[3,3,3,3] row_mask:0xf bank_mask:0xf
    v_add_f32 v61, v61, v4
    v_cvt_pk_bf16_f32 v52, v60, v61
    v_mfma_f32_16x16x32_bf16 v[28:31], a[208:211], v[20:23], 0
    v_mov_b32_dpp v60, v36 quad_perm:[0,0,0,0] row_mask:0xf bank_mask:0xf
    v_mov_b32_dpp v4, v38 quad_perm:[2,2,2,2] row_mask:0xf bank_mask:0xf
    s_nop 0
    v_add_f32_dpp v60, v37, v60 quad_perm:[1,1,1,1] row_mask:0xf bank_mask:0xf
    v_add_f32_dpp v4, v39, v4 quad_perm:[3,3,3,3] row_mask:0xf bank_mask:0xf
    v_add_f32 v60, v60, v4
    buffer_load_dwordx4 a[24:27], v76, s[52:55], s85 offen offset:1024 nt
    v_mfma_f32_16x16x32_bf16 v[32:35], a[212:215], v[20:23], 0
    v_mov_b32_dpp v61, v40 quad_perm:[0,0,0,0] row_mask:0xf bank_mask:0xf
    v_mov_b32_dpp v4, v42 quad_perm:[2,2,2,2] row_mask:0xf bank_mask:0xf
    s_nop 0
    v_add_f32_dpp v61, v41, v61 quad_perm:[1,1,1,1] row_mask:0xf bank_mask:0xf
    v_add_f32_dpp v4, v43, v4 quad_perm:[3,3,3,3] row_mask:0xf bank_mask:0xf
    v_add_f32 v61, v61, v4
    v_cvt_pk_bf16_f32 v53, v60, v61
    v_mfma_f32_16x16x32_bf16 v[36:39], a[216:219], v[20:23], 0
    v_mov_b32_dpp v60, v28 quad_perm:[0,0,0,0] row_mask:0xf bank_mask:0xf
    v_mov_b32_dpp v4, v30 quad_perm:[2,2,2,2] row_mask:0xf bank_mask:0xf
    s_nop 0
    v_add_f32_dpp v60, v29, v60 quad_perm:[1,1,1,1] row_mask:0xf bank_mask:0xf
    v_add_f32_dpp v4, v31, v4 quad_perm:[3,3,3,3] row_mask:0xf bank_mask:0xf
    v_add_f32 v60, v60, v4
    v_mfma_f32_16x16x32_bf16 v[40:43], a[220:223], v[20:23], 0
    v_mov_b32_dpp v61, v32 quad_perm:[0,0,0,0] row_mask:0xf bank_mask:0xf
    v_mov_b32_dpp v4, v34 quad_perm:[2,2,2,2] row_mask:0xf bank_mask:0xf
    s_nop 0
    v_add_f32_dpp v61, v33, v61 quad_perm:[1,1,1,1] row_mask:0xf bank_mask:0xf
    v_add_f32_dpp v4, v35, v4 quad_perm:[3,3,3,3] row_mask:0xf bank_mask:0xf
    v_add_f32 v61, v61, v4
    v_cvt_pk_bf16_f32 v54, v60, v61
    v_mfma_f32_16x16x32_bf16 v[28:31], a[224:227], v[20:23], 0
    v_mov_b32_dpp v60, v36 quad_perm:[0,0,0,0] row_mask:0xf bank_mask:0xf
    v_mov_b32_dpp v4, v38 quad_perm:[2,2,2,2] row_mask:0xf bank_mask:0xf
    s_nop 0
    v_add_f32_dpp v60, v37, v60 quad_perm:[1,1,1,1] row_mask:0xf bank_mask:0xf
    v_add_f32_dpp v4, v39, v4 quad_perm:[3,3,3,3] row_mask:0xf bank_mask:0xf
    v_add_f32 v60, v60, v4
    v_mfma_f32_16x16x32_bf16 v[32:35], a[228:231], v[20:23], 0
    v_mov_b32_dpp v61, v40 quad_perm:[0,0,0,0] row_mask:0xf bank_mask:0xf
    v_mov_b32_dpp v4, v42 quad_perm:[2,2,2,2] row_mask:0xf bank_mask:0xf
    s_nop 0
    v_add_f32_dpp v61, v41, v61 quad_perm:[1,1,1,1] row_mask:0xf bank_mask:0xf
    v_add_f32_dpp v4, v43, v4 quad_perm:[3,3,3,3] row_mask:0xf bank_mask:0xf
    v_add_f32 v61, v61, v4
    v_cvt_pk_bf16_f32 v55, v60, v61
    v_mfma_f32_16x16x32_bf16 v[36:39], a[232:235], v[20:23], 0
    v_mov_b32_dpp v60, v28 quad_perm:[0,0,0,0] row_mask:0xf bank_mask:0xf
    v_mov_b32_dpp v4, v30 quad_perm:[2,2,2,2] row_mask:0xf bank_mask:0xf
    s_nop 0
    v_add_f32_dpp v60, v29, v60 quad_perm:[1,1,1,1] row_mask:0xf bank_mask:0xf
    v_add_f32_dpp v4, v31, v4 quad_perm:[3,3,3,3] row_mask:0xf bank_mask:0xf
    v_add_f32 v60, v60, v4
    v_mfma_f32_16x16x32_bf16 v[40:43], a[236:239], v[20:23], 0
    v_mov_b32_dpp v61, v32 quad_perm:[0,0,0,0] row_mask:0xf bank_mask:0xf
    v_mov_b32_dpp v4, v34 quad_perm:[2,2,2,2] row_mask:0xf bank_mask:0xf
    s_nop 0
    v_add_f32_dpp v61, v33, v61 quad_perm:[1,1,1,1] row_mask:0xf bank_mask:0xf
    v_add_f32_dpp v4, v35, v4 quad_perm:[3,3,3,3] row_mask:0xf bank_mask:0xf
    v_add_f32 v61, v61, v4
    v_cvt_pk_bf16_f32 v56, v60, v61
    v_mfma_f32_16x16x32_bf16 v[28:31], a[240:243], v[20:23], 0
    v_mov_b32_dpp v60, v36 quad_perm:[0,0,0,0] row_mask:0xf bank_mask:0xf
    v_mov_b32_dpp v4, v38 quad_perm:[2,2,2,2] row_mask:0xf bank_mask:0xf
    s_nop 0
    v_add_f32_dpp v60, v37, v60 quad_perm:[1,1,1,1] row_mask:0xf bank_mask:0xf
    v_add_f32_dpp v4, v39, v4 quad_perm:[3,3,3,3] row_mask:0xf bank_mask:0xf
    v_add_f32 v60, v60, v4
    buffer_load_dwordx4 a[28:31], v77, s[52:55], s85 offen offset:1024 nt
    s_add_u32 s87, s87, 13
    s_add_u32 s39, s87, s88
    s_bfe_u32 s37, s39, 0x10000
    s_lshl_b32 s37, s37, 13
    s_add_u32 s85, s37, s89
    s_bfe_u32 s37, s39, 0x10001
    s_lshl_b32 s37, s37, 12
    s_add_u32 s85, s37, s85
    s_bfe_u32 s37, s39, 0x10002
    s_lshl_b32 s37, s37, 11
    s_add_u32 s85, s37, s85
    s_bfe_u32 s37, s39, 0x10003
    s_lshl_b32 s37, s37, 14
    s_add_u32 s85, s37, s85
    s_bfe_u32 s37, s39, 0x40004
    s_lshl_b32 s37, s37, 16
    s_add_u32 s85, s37, s85
    v_mfma_f32_16x16x32_bf16 v[32:35], a[244:247], v[20:23], 0
    v_mov_b32_dpp v61, v40 quad_perm:[0,0,0,0] row_mask:0xf bank_mask:0xf
    v_mov_b32_dpp v4, v42 quad_perm:[2,2,2,2] row_mask:0xf bank_mask:0xf
    s_nop 0
    v_add_f32_dpp v61, v41, v61 quad_perm:[1,1,1,1] row_mask:0xf bank_mask:0xf
    v_add_f32_dpp v4, v43, v4 quad_perm:[3,3,3,3] row_mask:0xf bank_mask:0xf
    v_add_f32 v61, v61, v4
    v_cvt_pk_bf16_f32 v57, v60, v61
    v_mfma_f32_16x16x32_bf16 v[36:39], a[248:251], v[20:23], 0
    v_mov_b32_dpp v60, v28 quad_perm:[0,0,0,0] row_mask:0xf bank_mask:0xf
    v_mov_b32_dpp v4, v30 quad_perm:[2,2,2,2] row_mask:0xf bank_mask:0xf
    s_nop 0
    v_add_f32_dpp v60, v29, v60 quad_perm:[1,1,1,1] row_mask:0xf bank_mask:0xf
    v_add_f32_dpp v4, v31, v4 quad_perm:[3,3,3,3] row_mask:0xf bank_mask:0xf
    v_add_f32 v60, v60, v4
    v_mfma_f32_16x16x32_bf16 v[40:43], a[252:255], v[20:23], 0
    v_mov_b32_dpp v61, v32 quad_perm:[0,0,0,0] row_mask:0xf bank_mask:0xf
    v_mov_b32_dpp v4, v34 quad_perm:[2,2,2,2] row_mask:0xf bank_mask:0xf
    s_nop 0
    v_add_f32_dpp v61, v33, v61 quad_perm:[1,1,1,1] row_mask:0xf bank_mask:0xf
    v_add_f32_dpp v4, v35, v4 quad_perm:[3,3,3,3] row_mask:0xf bank_mask:0xf
    v_add_f32 v61, v61, v4
    v_cvt_pk_bf16_f32 v58, v60, v61
    v_mov_b32_dpp v60, v36 quad_perm:[0,0,0,0] row_mask:0xf bank_mask:0xf
    v_mov_b32_dpp v4, v38 quad_perm:[2,2,2,2] row_mask:0xf bank_mask:0xf
    s_nop 0
    v_add_f32_dpp v60, v37, v60 quad_perm:[1,1,1,1] row_mask:0xf bank_mask:0xf
    v_add_f32_dpp v4, v39, v4 quad_perm:[3,3,3,3] row_mask:0xf bank_mask:0xf
    v_add_f32 v60, v60, v4
    v_mov_b32_dpp v61, v40 quad_perm:[0,0,0,0] row_mask:0xf bank_mask:0xf
    v_mov_b32_dpp v4, v42 quad_perm:[2,2,2,2] row_mask:0xf bank_mask:0xf
    s_nop 0
    v_add_f32_dpp v61, v41, v61 quad_perm:[1,1,1,1] row_mask:0xf bank_mask:0xf
    v_add_f32_dpp v4, v43, v4 quad_perm:[3,3,3,3] row_mask:0xf bank_mask:0xf
    v_add_f32 v61, v61, v4
    v_cvt_pk_bf16_f32 v59, v60, v61
    s_mov_b32 exec_lo, 0x22222222
    s_mov_b32 exec_hi, 0x22222222
    v_mov_b32 v44, v48
    v_mov_b32 v45, v49
    v_mov_b32 v46, v50
    v_mov_b32 v47, v51
    s_mov_b32 exec_lo, 0x44444444
    s_mov_b32 exec_hi, 0x44444444
    v_mov_b32 v44, v52
    v_mov_b32 v45, v53
    v_mov_b32 v46, v54
    v_mov_b32 v47, v55
    s_mov_b32 exec_lo, 0x88888888
    s_mov_b32 exec_hi, 0x88888888
    v_mov_b32 v44, v56
    v_mov_b32 v45, v57
    v_mov_b32 v46, v58
    v_mov_b32 v47, v59
    s_mov_b64 exec, -1
    buffer_store_dwordx4 v[44:47], v19, s[48:51], s94 offen sc1
    s_waitcnt vmcnt(5)
L_qcheck_43:
    v_xor_b32 v68, s35, v68
    v_xor_b32 v69, s35, v69
    v_xor_b32 v70, s35, v70
    v_xor_b32 v71, s35, v71
    v_xor_b32 v72, s35, v72
    v_xor_b32 v73, s35, v73
    v_xor_b32 v74, s35, v74
    v_xor_b32 v75, s35, v75
    v_or_b32 v4, v68, v69
    v_or3_b32 v4, v4, v70, v71
    v_or3_b32 v4, v4, v72, v73
    v_or3_b32 v4, v4, v74, v75
    v_and_b32 v4, 0xff, v4
    v_cmp_ne_u32 vcc, 0, v4
    s_cbranch_vccz L_qok_44
    buffer_load_dwordx4 v[68:71], v78, s[48:51], s91 offen offset:0 sc1
    buffer_load_dwordx4 v[72:75], v78, s[48:51], s91 offen offset:16 sc1
    s_waitcnt vmcnt(0)
    s_sub_u32 s84, s84, 1
    s_cmp_lg_u32 s84, 0
    s_cbranch_scc1 L_qcheck_43
    s_branch L_end
L_qok_44:
    v_cvt_pk_bf16_f32 v68, v68, v69
    v_cvt_pk_bf16_f32 v69, v70, v71
    v_cvt_pk_bf16_f32 v70, v72, v73
    v_cvt_pk_bf16_f32 v71, v74, v75
    s_mov_b32 vcc_lo, 0xf000f
    s_mov_b32 vcc_hi, 0xf000f
    v_cndmask_b32 v80, 0, v68, vcc
    v_cndmask_b32 v81, 0, v69, vcc
    v_cndmask_b32 v82, 0, v70, vcc
    v_cndmask_b32 v83, 0, v71, vcc
    s_mov_b32 vcc_lo, 0xf000f0
    s_mov_b32 vcc_hi, 0xf000f0
    v_cndmask_b32 v84, 0, v68, vcc
    v_cndmask_b32 v85, 0, v69, vcc
    v_cndmask_b32 v86, 0, v70, vcc
    v_cndmask_b32 v87, 0, v71, vcc
    s_mov_b32 vcc_lo, 0xf000f00
    s_mov_b32 vcc_hi, 0xf000f00
    v_cndmask_b32 v88, 0, v68, vcc
    v_cndmask_b32 v89, 0, v69, vcc
    v_cndmask_b32 v90, 0, v70, vcc
    v_cndmask_b32 v91, 0, v71, vcc
    s_mov_b32 vcc_lo, 0xf000f000
    s_mov_b32 vcc_hi, 0xf000f000
    v_cndmask_b32 v92, 0, v68, vcc
    v_cndmask_b32 v93, 0, v69, vcc
    v_cndmask_b32 v94, 0, v70, vcc
    v_cndmask_b32 v95, 0, v71, vcc
    s_getreg_b32 s70, hwreg(HW_REG_XCC_ID, 0, 4)
    s_lshl_b32 s70, s70, 8
    s_or_b32 s70, s70, s35
    s_or_b32 s70, s70, 0x5e9d0000
    s_bfe_u32 s38, s2, 0x30000
    s_lshl_b32 s38, s38, 8
    s_add_u32 s69, s38, 32768
    s_lshl_b32 s38, s32, 2
    s_add_u32 s69, s38, s69
    s_lshl_b32 s38, s34, 24
    s_add_u32 s69, s38, s69
    v_mov_b32 v72, s69
    v_mov_b32 v73, s70
    s_mov_b64 exec, 1
    buffer_store_dword v73, v72, s[48:51], 0 offen sc1
    s_mov_b64 exec, -1
    v_mov_b32 v65, 0xff7f0000
    s_lshl_b32 s38, s34, 14
    s_add_u32 s38, s38, 16384
    v_lshl_add_u32 v64, v1, 2, s38
    buffer_load_dwordx4 a[32:35], v76, s[52:55], s85 offen offset:0 nt
    v_mfma_f32_16x16x32_bf16 v[112:115], v[128:131], v[80:83], 0
    v_mfma_f32_16x16x32_bf16 v[112:115], v[132:135], v[84:87], v[112:115]
    buffer_load_dwordx4 a[36:39], v77, s[52:55], s85 offen offset:0 nt
    v_mfma_f32_16x16x32_bf16 v[112:115], v[136:139], v[88:91], v[112:115]
    v_mfma_f32_16x16x32_bf16 v[112:115], v[140:143], v[92:95], v[112:115]
    buffer_load_dwordx4 a[40:43], v76, s[52:55], s85 offen offset:1024 nt
    v_mfma_f32_16x16x32_bf16 v[96:99], v[144:147], v[80:83], 0
    v_mfma_f32_16x16x32_bf16 v[96:99], v[148:151], v[84:87], v[96:99]
    s_waitcnt vmcnt(8)
    buffer_load_dwordx4 a[44:47], v77, s[52:55], s85 offen offset:1024 nt
    s_add_u32 s87, s87, 1
    s_add_u32 s39, s87, s88
    s_bfe_u32 s37, s39, 0x10000
    s_lshl_b32 s37, s37, 13
    s_add_u32 s85, s37, s89
    s_bfe_u32 s37, s39, 0x10001
    s_lshl_b32 s37, s37, 12
    s_add_u32 s85, s37, s85
    s_bfe_u32 s37, s39, 0x10002
    s_lshl_b32 s37, s37, 11
    s_add_u32 s85, s37, s85
    s_bfe_u32 s37, s39, 0x10003
    s_lshl_b32 s37, s37, 14
    s_add_u32 s85, s37, s85
    s_bfe_u32 s37, s39, 0x40004
    s_lshl_b32 s37, s37, 16
    s_add_u32 s85, s37, s85
    v_mfma_f32_16x16x32_bf16 v[96:99], v[152:155], v[88:91], v[96:99]
    v_mov_b32_dpp v122, v112 quad_perm:[0,0,0,0] row_mask:0xf bank_mask:0xf
    v_mov_b32_dpp v124, v114 quad_perm:[2,2,2,2] row_mask:0xf bank_mask:0xf
    s_nop 0
    v_add_f32_dpp v122, v113, v122 quad_perm:[1,1,1,1] row_mask:0xf bank_mask:0xf
    v_add_f32_dpp v124, v115, v124 quad_perm:[3,3,3,3] row_mask:0xf bank_mask:0xf
    v_add_f32 v122, v122, v124
    v_max_f32 v65, v65, v122
    ds_write_b32 v64, v122 offset:0
    v_mfma_f32_16x16x32_bf16 v[96:99], v[156:159], v[92:95], v[96:99]
    s_waitcnt vmcnt(8)
    buffer_load_dwordx4 a[48:51], v76, s[52:55], s85 offen offset:0 nt
    v_mfma_f32_16x16x32_bf16 v[112:115], v[160:163], v[80:83], 0
    v_mfma_f32_16x16x32_bf16 v[112:115], v[164:167], v[84:87], v[112:115]
    s_waitcnt vmcnt(8)
    buffer_load_dwordx4 a[52:55], v77, s[52:55], s85 offen offset:0 nt
    v_mfma_f32_16x16x32_bf16 v[112:115], v[168:171], v[88:91], v[112:115]
    s_nop 0
    v_mov_b32_dpp v122, v96 quad_perm:[0,0,0,0] row_mask:0xf bank_mask:0xf
    v_mov_b32_dpp v124, v98 quad_perm:[2,2,2,2] row_mask:0xf bank_mask:0xf
    s_nop 0
    v_add_f32_dpp v122, v97, v122 quad_perm:[1,1,1,1] row_mask:0xf bank_mask:0xf
    v_add_f32_dpp v124, v99, v124 quad_perm:[3,3,3,3] row_mask:0xf bank_mask:0xf
    v_add_f32 v122, v122, v124
    v_max_f32 v65, v65, v122
    ds_write_b32 v64, v122 offset:256
    v_mfma_f32_16x16x32_bf16 v[112:115], v[172:175], v[92:95], v[112:115]
    s_waitcnt vmcnt(8)
    buffer_load_dwordx4 a[56:59], v76, s[52:55], s85 offen offset:1024 nt
    v_mfma_f32_16x16x32_bf16 v[96:99], v[176:179], v[80:83], 0
    v_mfma_f32_16x16x32_bf16 v[96:99], v[180:183], v[84:87], v[96:99]
    s_waitcnt vmcnt(6)
    buffer_load_dwordx4 a[60:63], v77, s[52:55], s85 offen offset:1024 nt
    s_add_u32 s87, s87, 13
    s_add_u32 s39, s87, s88
    s_bfe_u32 s37, s39, 0x10000
    s_lshl_b32 s37, s37, 13
    s_add_u32 s85, s37, s89
    s_bfe_u32 s37, s39, 0x10001
    s_lshl_b32 s37, s37, 12
    s_add_u32 s85, s37, s85
    s_bfe_u32 s37, s39, 0x10002
    s_lshl_b32 s37, s37, 11
    s_add_u32 s85, s37, s85
    s_bfe_u32 s37, s39, 0x10003
    s_lshl_b32 s37, s37, 14
    s_add_u32 s85, s37, s85
    s_bfe_u32 s37, s39, 0x40004
    s_lshl_b32 s37, s37, 16
    s_add_u32 s85, s37, s85
    v_mfma_f32_16x16x32_bf16 v[96:99], v[184:187], v[88:91], v[96:99]
    v_mov_b32_dpp v122, v112 quad_perm:[0,0,0,0] row_mask:0xf bank_mask:0xf
    v_mov_b32_dpp v124, v114 quad_perm:[2,2,2,2] row_mask:0xf bank_mask:0xf
    s_nop 0
    v_add_f32_dpp v122, v113, v122 quad_perm:[1,1,1,1] row_mask:0xf bank_mask:0xf
    v_add_f32_dpp v124, v115, v124 quad_perm:[3,3,3,3] row_mask:0xf bank_mask:0xf
    v_add_f32 v122, v122, v124
    v_max_f32 v65, v65, v122
    ds_write_b32 v64, v122 offset:512
    s_lshl_b32 s38, s32, 8
    s_add_u32 s69, s38, 98304
    s_lshl_b32 s38, s34, 23
    s_add_u32 s69, s38, s69
    v_mov_b32 v48, s69
    v_mov_b32 v49, s68
    s_barrier
    s_mov_b64 exec, 1
    buffer_store_dword v49, v48, s[48:51], 0 offen sc1
    s_mov_b64 exec, -1
    v_mfma_f32_16x16x32_bf16 v[96:99], v[188:191], v[92:95], v[96:99]
    v_mfma_f32_16x16x32_bf16 v[112:115], v[192:195], v[80:83], 0
    s_waitcnt vmcnt(7)
    buffer_load_dwordx4 a[64:67], v76, s[52:55], s85 offen offset:0 nt
    v_mfma_f32_16x16x32_bf16 v[112:115], v[196:199], v[84:87], v[112:115]
    v_mfma_f32_16x16x32_bf16 v[112:115], v[200:203], v[88:91], v[112:115]
    s_nop 2
    v_mov_b32_dpp v122, v96 quad_perm:[0,0,0,0] row_mask:0xf bank_mask:0xf
    v_mov_b32_dpp v124, v98 quad_perm:[2,2,2,2] row_mask:0xf bank_mask:0xf
    s_nop 0
    v_add_f32_dpp v122, v97, v122 quad_perm:[1,1,1,1] row_mask:0xf bank_mask:0xf
    v_add_f32_dpp v124, v99, v124 quad_perm:[3,3,3,3] row_mask:0xf bank_mask:0xf
    v_add_f32 v122, v122, v124
    v_max_f32 v65, v65, v122
    ds_write_b32 v64, v122 offset:768
    s_waitcnt vmcnt(7)
    buffer_load_dwordx4 a[68:71], v77, s[52:55], s85 offen offset:0 nt
    v_mfma_f32_16x16x32_bf16 v[112:115], v[204:207], v[92:95], v[112:115]
    v_mfma_f32_16x16x32_bf16 v[96:99], v[208:211], v[80:83], 0
    s_waitcnt vmcnt(7)
    buffer_load_dwordx4 a[72:75], v76, s[52:55], s85 offen offset:1024 nt
    v_mfma_f32_16x16x32_bf16 v[96:99], v[212:215], v[84:87], v[96:99]
    v_mfma_f32_16x16x32_bf16 v[96:99], v[216:219], v[88:91], v[96:99]
    s_nop 2
    v_mov_b32_dpp v122, v112 quad_perm:[0,0,0,0] row_mask:0xf bank_mask:0xf
    v_mov_b32_dpp v124, v114 quad_perm:[2,2,2,2] row_mask:0xf bank_mask:0xf
    s_nop 0
    v_add_f32_dpp v122, v113, v122 quad_perm:[1,1,1,1] row_mask:0xf bank_mask:0xf
    v_add_f32_dpp v124, v115, v124 quad_perm:[3,3,3,3] row_mask:0xf bank_mask:0xf
    v_add_f32 v122, v122, v124
    v_max_f32 v65, v65, v122
    ds_write_b32 v64, v122 offset:1024
    s_waitcnt vmcnt(7)
    buffer_load_dwordx4 a[76:79], v77, s[52:55], s85 offen offset:1024 nt
    s_add_u32 s87, s87, 1
    s_add_u32 s39, s87, s88
    s_bfe_u32 s37, s39, 0x10000
    s_lshl_b32 s37, s37, 13
    s_add_u32 s85, s37, s89
    s_bfe_u32 s37, s39, 0x10001
    s_lshl_b32 s37, s37, 12
    s_add_u32 s85, s37, s85
    s_bfe_u32 s37, s39, 0x10002
    s_lshl_b32 s37, s37, 11
    s_add_u32 s85, s37, s85
    s_bfe_u32 s37, s39, 0x10003
    s_lshl_b32 s37, s37, 14
    s_add_u32 s85, s37, s85
    s_bfe_u32 s37, s39, 0x40004
    s_lshl_b32 s37, s37, 16
    s_add_u32 s85, s37, s85
    v_mfma_f32_16x16x32_bf16 v[96:99], v[220:223], v[92:95], v[96:99]
    v_mfma_f32_16x16x32_bf16 v[112:115], v[224:227], v[80:83], 0
    s_waitcnt vmcnt(7)
    buffer_load_dwordx4 a[80:83], v76, s[52:55], s85 offen offset:0 nt
    v_mfma_f32_16x16x32_bf16 v[112:115], v[228:231], v[84:87], v[112:115]
    v_mfma_f32_16x16x32_bf16 v[112:115], v[232:235], v[88:91], v[112:115]
    s_nop 2
    v_mov_b32_dpp v122, v96 quad_perm:[0,0,0,0] row_mask:0xf bank_mask:0xf
    v_mov_b32_dpp v124, v98 quad_perm:[2,2,2,2] row_mask:0xf bank_mask:0xf
    s_nop 0
    v_add_f32_dpp v122, v97, v122 quad_perm:[1,1,1,1] row_mask:0xf bank_mask:0xf
    v_add_f32_dpp v124, v99, v124 quad_perm:[3,3,3,3] row_mask:0xf bank_mask:0xf
    v_add_f32 v122, v122, v124
    v_max_f32 v65, v65, v122
    ds_write_b32 v64, v122 offset:1280
    s_waitcnt vmcnt(7)
    buffer_load_dwordx4 a[84:87], v77, s[52:55], s85 offen offset:0 nt
    v_mfma_f32_16x16x32_bf16 v[112:115], v[236:239], v[92:95], v[112:115]
    v_mfma_f32_16x16x32_bf16 v[96:99], v[240:243], v[80:83], 0
    s_waitcnt vmcnt(7)
    buffer_load_dwordx4 a[88:91], v76, s[52:55], s85 offen offset:1024 nt
    v_mfma_f32_16x16x32_bf16 v[96:99], v[244:247], v[84:87], v[96:99]
    v_mfma_f32_16x16x32_bf16 v[96:99], v[248:251], v[88:91], v[96:99]
    s_nop 2
    v_mov_b32_dpp v122, v112 quad_perm:[0,0,0,0] row_mask:0xf bank_mask:0xf
    v_mov_b32_dpp v124, v114 quad_perm:[2,2,2,2] row_mask:0xf bank_mask:0xf
    s_nop 0
    v_add_f32_dpp v122, v113, v122 quad_perm:[1,1,1,1] row_mask:0xf bank_mask:0xf
    v_add_f32_dpp v124, v115, v124 quad_perm:[3,3,3,3] row_mask:0xf bank_mask:0xf
    v_add_f32 v122, v122, v124
    v_max_f32 v65, v65, v122
    ds_write_b32 v64, v122 offset:1536
    v_mfma_f32_16x16x32_bf16 v[96:99], v[252:255], v[92:95], v[96:99]
    s_waitcnt vmcnt(6)
    buffer_load_dwordx4 a[92:95], v77, s[52:55], s85 offen offset:1024 nt
    s_add_u32 s87, s87, 13
    s_add_u32 s39, s87, s88
    s_bfe_u32 s37, s39, 0x10000
    s_lshl_b32 s37, s37, 13
    s_add_u32 s85, s37, s89
    s_bfe_u32 s37, s39, 0x10001
    s_lshl_b32 s37, s37, 12
    s_add_u32 s85, s37, s85
    s_bfe_u32 s37, s39, 0x10002
    s_lshl_b32 s37, s37, 11
    s_add_u32 s85, s37, s85
    s_bfe_u32 s37, s39, 0x10003
    s_lshl_b32 s37, s37, 14
    s_add_u32 s85, s37, s85
    s_bfe_u32 s37, s39, 0x40004
    s_lshl_b32 s37, s37, 16
    s_add_u32 s85, s37, s85
    v_mfma_f32_16x16x32_bf16 v[112:115], a[0:3], v[80:83], 0
    v_mfma_f32_16x16x32_bf16 v[112:115], a[4:7], v[84:87], v[112:115]
    s_waitcnt vmcnt(6)
    buffer_load_dwordx4 a[96:99], v76, s[52:55], s85 offen offset:0 nt
    v_mfma_f32_16x16x32_bf16 v[112:115], a[8:11], v[88:91], v[112:115]
    v_mov_b32_dpp v122, v96 quad_perm:[0,0,0,0] row_mask:0xf bank_mask:0xf
    v_mov_b32_dpp v124, v98 quad_perm:[2,2,2,2] row_mask:0xf bank_mask:0xf
    s_nop 0
    v_add_f32_dpp v122, v97, v122 quad_perm:[1,1,1,1] row_mask:0xf bank_mask:0xf
    v_add_f32_dpp v124, v99, v124 quad_perm:[3,3,3,3] row_mask:0xf bank_mask:0xf
    v_add_f32 v122, v122, v124
    v_max_f32 v65, v65, v122
    ds_write_b32 v64, v122 offset:1792
    v_mfma_f32_16x16x32_bf16 v[112:115], a[12:15], v[92:95], v[112:115]
    s_waitcnt vmcnt(6)
    buffer_load_dwordx4 a[100:103], v77, s[52:55], s85 offen offset:0 nt
    v_mfma_f32_16x16x32_bf16 v[96:99], a[16:19], v[80:83], 0
    v_mfma_f32_16x16x32_bf16 v[96:99], a[20:23], v[84:87], v[96:99]
    s_waitcnt vmcnt(6)
    buffer_load_dwordx4 a[104:107], v76, s[52:55], s85 offen offset:1024 nt
    v_mfma_f32_16x16x32_bf16 v[96:99], a[24:27], v[88:91], v[96:99]
    s_nop 0
    v_mov_b32_dpp v122, v112 quad_perm:[0,0,0,0] row_mask:0xf bank_mask:0xf
    v_mov_b32_dpp v124, v114 quad_perm:[2,2,2,2] row_mask:0xf bank_mask:0xf
    s_nop 0
    v_add_f32_dpp v122, v113, v122 quad_perm:[1,1,1,1] row_mask:0xf bank_mask:0xf
    v_add_f32_dpp v124, v115, v124 quad_perm:[3,3,3,3] row_mask:0xf bank_mask:0xf
    v_add_f32 v122, v122, v124
    v_max_f32 v65, v65, v122
    ds_write_b32 v64, v122 offset:2048
    v_mfma_f32_16x16x32_bf16 v[96:99], a[28:31], v[92:95], v[96:99]
    s_waitcnt vmcnt(6)
    buffer_load_dwordx4 a[108:111], v77, s[52:55], s85 offen offset:1024 nt
    s_add_u32 s87, s87, 1
    s_add_u32 s39, s87, s88
    s_bfe_u32 s37, s39, 0x10000
    s_lshl_b32 s37, s37, 13
    s_add_u32 s85, s37, s89
    s_bfe_u32 s37, s39, 0x10001
    s_lshl_b32 s37, s37, 12
    s_add_u32 s85, s37, s85
    s_bfe_u32 s37, s39, 0x10002
    s_lshl_b32 s37, s37, 11
    s_add_u32 s85, s37, s85
    s_bfe_u32 s37, s39, 0x10003
    s_lshl_b32 s37, s37, 14
    s_add_u32 s85, s37, s85
    s_bfe_u32 s37, s39, 0x40004
    s_lshl_b32 s37, s37, 16
    s_add_u32 s85, s37, s85
    v_mfma_f32_16x16x32_bf16 v[112:115], a[32:35], v[80:83], 0
    s_bfe_u32 s38, s2, 0x20001
    s_lshl_b32 s38, s38, 0
    s_add_u32 s90, s38, 0
    s_bfe_u32 s38, s2, 0x10000
    s_lshl_b32 s38, s38, 2
    s_add_u32 s90, s38, s90
    s_and_b32 s36, s90, 3
    s_bitcmp0_b32 s90, 2
    s_cselect_b64 s[40:41], s[24:25], s[14:15]
    s_cselect_b32 s45, 262144, 0
    s_add_u32 s45, s45, 524288
    s_lshl_b32 s38, s36, 16
    s_add_u32 s71, s38, s45
    s_lshr_b32 s38, s32, 2
    s_lshl_b32 s38, s38, 13
    s_add_u32 s71, s38, s71
    s_bfe_u32 s38, s32, 0x20000
    s_lshl_b32 s38, s38, 6
    s_add_u32 s71, s38, s71
    s_mov_b32 s42, 4194304
    s_mov_b32 s43, 0x20000
    s_lshl_b32 s38, s32, 17
    s_add_u32 s44, s38, 0
    s_lshl_b32 s38, s34, 15
    s_add_u32 s44, s38, s44
    s_lshl_b32 s38, s36, 8
    s_add_u32 s44, s38, s44
    s_lshl_b32 s38, s36, 16
    s_add_u32 s45, s38, s45
    s_lshr_b32 s38, s34, 1
    s_lshl_b32 s38, s38, 15
    s_add_u32 s45, s38, s45
    s_lshl_b32 s38, s32, 8
    s_add_u32 s45, s38, s45
    s_bfe_u32 s38, s34, 0x10000
    s_lshl_b32 s38, s38, 7
    s_add_u32 s45, s38, s45
    s_lshl_b32 s38, s32, 11
    s_add_u32 s46, s38, 196608
    s_lshl_b32 s38, s34, 9
    s_add_u32 s46, s38, s46
    s_mov_b32 s72, s26
    s_and_b32 s73, s27, 0xffff
    s_mov_b32 s74, 8192
    s_mov_b32 s75, 0x20000
    v_mfma_f32_16x16x32_bf16 v[112:115], a[36:39], v[84:87], v[112:115]
    s_waitcnt vmcnt(6)
    buffer_load_dwordx4 a[112:115], v76, s[52:55], s85 offen offset:0 nt
    v_mfma_f32_16x16x32_bf16 v[112:115], a[40:43], v[88:91], v[112:115]
    v_mov_b32_dpp v122, v96 quad_perm:[0,0,0,0] row_mask:0xf bank_mask:0xf
    v_mov_b32_dpp v124, v98 quad_perm:[2,2,2,2] row_mask:0xf bank_mask:0xf
    s_nop 0
    v_add_f32_dpp v122, v97, v122 quad_perm:[1,1,1,1] row_mask:0xf bank_mask:0xf
    v_add_f32_dpp v124, v99, v124 quad_perm:[3,3,3,3] row_mask:0xf bank_mask:0xf
    v_add_f32 v122, v122, v124
    v_max_f32 v65, v65, v122
    ds_write_b32 v64, v122 offset:2304
    v_mfma_f32_16x16x32_bf16 v[112:115], a[44:47], v[92:95], v[112:115]
    s_waitcnt vmcnt(6)
    buffer_load_dwordx4 a[116:119], v77, s[52:55], s85 offen offset:0 nt
    v_mfma_f32_16x16x32_bf16 v[96:99], a[48:51], v[80:83], 0
    v_mfma_f32_16x16x32_bf16 v[96:99], a[52:55], v[84:87], v[96:99]
    s_waitcnt vmcnt(6)
    buffer_load_dwordx4 a[120:123], v76, s[52:55], s85 offen offset:1024 nt
    v_mfma_f32_16x16x32_bf16 v[96:99], a[56:59], v[88:91], v[96:99]
    s_nop 0
    v_mov_b32_dpp v122, v112 quad_perm:[0,0,0,0] row_mask:0xf bank_mask:0xf
    v_mov_b32_dpp v124, v114 quad_perm:[2,2,2,2] row_mask:0xf bank_mask:0xf
    s_nop 0
    v_add_f32_dpp v122, v113, v122 quad_perm:[1,1,1,1] row_mask:0xf bank_mask:0xf
    v_add_f32_dpp v124, v115, v124 quad_perm:[3,3,3,3] row_mask:0xf bank_mask:0xf
    v_add_f32 v122, v122, v124
    v_max_f32 v65, v65, v122
    ds_write_b32 v64, v122 offset:2560
    v_lshlrev_b32 v4, 2, v2
    v_xor_b32 v4, v4, v3
    v_xor_b32 v5, 0, v4
    v_lshlrev_b32 v5, 4, v5
    v_lshl_add_u32 v20, v2, 10, v5
    v_xor_b32 v5, 1, v4
    v_lshlrev_b32 v5, 4, v5
    v_lshl_add_u32 v21, v2, 10, v5
    v_add_u32 v21, 3072, v21
    v_xor_b32 v5, 2, v4
    v_lshlrev_b32 v5, 4, v5
    v_lshl_add_u32 v22, v2, 10, v5
    v_add_u32 v22, 6144, v22
    v_xor_b32 v5, 3, v4
    v_lshlrev_b32 v5, 4, v5
    v_lshl_add_u32 v23, v2, 10, v5
    v_add_u32 v23, 9216, v23
    s_lshl_b32 s38, s32, 15
    s_add_u32 s47, s38, 1048576
    s_lshl_b32 s38, s3, 13
    s_add_u32 s47, s38, s47
    v_lshlrev_b32 v6, 7, v2
    v_bfe_u32 v5, v3, 0, 3
    v_lshl_add_u32 v6, v5, 4, v6
    v_lshrrev_b32 v4, 3, v3
    v_and_b32 v7, 3, v3
    v_min_u32 v7, 2, v7
    v_lshl_add_u32 v7, v7, 1, v4
    v_add_u32 v5, 0, v4
    v_cmp_le_u32 vcc, s33, v5
    s_nop 1
    v_addc_co_u32 v5, vcc, 0, v5, vcc
    v_lshl_add_u32 v50, v5, 10, v6
    v_add_u32 v5, 2, v4
    v_cmp_le_u32 vcc, s33, v5
    s_nop 1
    v_addc_co_u32 v5, vcc, 0, v5, vcc
    v_lshl_add_u32 v51, v5, 10, v6
    v_add_u32 v5, 4, v4
    v_cmp_le_u32 vcc, s33, v5
    s_nop 1
    v_addc_co_u32 v5, vcc, 0, v5, vcc
    v_lshl_add_u32 v52, v5, 10, v6
    v_mov_b32 v5, v7
    v_mov_b32 v6, 512
    v_cmp_le_u32 vcc, s33, v5
    s_nop 1
    v_addc_co_u32 v5, vcc, 0, v5, vcc
    v_lshl_add_u32 v53, v5, 10, v6
    s_mul_i32 s38, s3, 320
    s_add_u32 s38, s38, 135168
    v_lshlrev_b32 v4, 6, v2
    v_lshl_add_u32 v4, v3, 1, v4
    v_add_u32 v31, s38, v4
    v_mfma_f32_16x16x32_bf16 v[96:99], a[60:63], v[92:95], v[96:99]
    v_mfma_f32_16x16x32_bf16 v[112:115], a[64:67], v[80:83], 0
    s_waitcnt vmcnt(6)
    buffer_load_dwordx4 a[124:127], v77, s[52:55], s85 offen offset:1024 nt
    s_add_u32 s87, s87, 13
    s_add_u32 s39, s87, s88
    s_bfe_u32 s37, s39, 0x10000
    s_lshl_b32 s37, s37, 13
    s_add_u32 s85, s37, s89
    s_bfe_u32 s37, s39, 0x10001
    s_lshl_b32 s37, s37, 12
    s_add_u32 s85, s37, s85
    s_bfe_u32 s37, s39, 0x10002
    s_lshl_b32 s37, s37, 11
    s_add_u32 s85, s37, s85
    s_bfe_u32 s37, s39, 0x10003
    s_lshl_b32 s37, s37, 14
    s_add_u32 s85, s37, s85
    s_bfe_u32 s37, s39, 0x40004
    s_lshl_b32 s37, s37, 16
    s_add_u32 s85, s37, s85
    v_mfma_f32_16x16x32_bf16 v[112:115], a[68:71], v[84:87], v[112:115]
    v_mfma_f32_16x16x32_bf16 v[112:115], a[72:75], v[88:91], v[112:115]
    v_mov_b32_dpp v122, v96 quad_perm:[0,0,0,0] row_mask:0xf bank_mask:0xf
    v_mov_b32_dpp v124, v98 quad_perm:[2,2,2,2] row_mask:0xf bank_mask:0xf
    s_nop 0
    v_add_f32_dpp v122, v97, v122 quad_perm:[1,1,1,1] row_mask:0xf bank_mask:0xf
    v_add_f32_dpp v124, v99, v124 quad_perm:[3,3,3,3] row_mask:0xf bank_mask:0xf
    v_add_f32 v122, v122, v124
    v_max_f32 v65, v65, v122
    ds_write_b32 v64, v122 offset:2816
    s_waitcnt vmcnt(5)
    buffer_load_dwordx4 v[128:131], v76, s[52:55], s85 offen offset:0 nt
    v_mfma_f32_16x16x32_bf16 v[112:115], a[76:79], v[92:95], v[112:115]
    v_mfma_f32_16x16x32_bf16 v[96:99], a[80:83], v[80:83], 0
    v_lshlrev_b32 v4, 11, v2
    v_bfe_u32 v5, v1, 2, 2
    v_lshl_add_u32 v4, v5, 8, v4
    v_bfe_u32 v5, v1, 2, 2
    v_lshl_add_u32 v4, v5, 6, v4
    v_bfe_u32 v5, v1, 4, 1
    v_lshl_add_u32 v4, v5, 5, v4
    v_bfe_u32 v5, v1, 1, 1
    v_lshl_add_u32 v4, v5, 4, v4
    v_bfe_u32 v5, v1, 0, 1
    v_lshl_add_u32 v4, v5, 3, v4
    s_lshl_b32 s38, s34, 6
    s_add_u32 s38, s38, 98304
    v_xor_b32 v24, s38, v4
    v_xor_b32 v25, 16, v24
    v_xor_b32 v26, 32, v24
    v_xor_b32 v27, 48, v24
    v_and_b32 v4, 3, v3
    v_lshrrev_b32 v5, 2, v3
    v_lshlrev_b32 v6, 4, v2
    v_add_u32 v6, 135168, v6
    s_movk_i32 s36, 320
    v_cmp_eq_u32 vcc, 0, v5
    s_nop 1
    v_cndmask_b32 v28, 4, v4, vcc
    v_mad_u32_u24 v28, v28, s36, v6
    v_cmp_eq_u32 vcc, 1, v5
    s_nop 1
    v_cndmask_b32 v29, 4, v4, vcc
    v_mad_u32_u24 v29, v29, s36, v6
    v_lshlrev_b32 v5, 2, v1
    v_add_u32 v5, 136448, v5
    v_mov_b32 v6, 0
    ds_write_b32 v5, v6
    s_waitcnt vmcnt(5)
    buffer_load_dwordx4 v[132:135], v77, s[52:55], s85 offen offset:0 nt
    v_mfma_f32_16x16x32_bf16 v[96:99], a[84:87], v[84:87], v[96:99]
    v_mfma_f32_16x16x32_bf16 v[96:99], a[88:91], v[88:91], v[96:99]
    v_mov_b32_dpp v122, v112 quad_perm:[0,0,0,0] row_mask:0xf bank_mask:0xf
    v_mov_b32_dpp v124, v114 quad_perm:[2,2,2,2] row_mask:0xf bank_mask:0xf
    s_nop 0
    v_add_f32_dpp v122, v113, v122 quad_perm:[1,1,1,1] row_mask:0xf bank_mask:0xf
    v_add_f32_dpp v124, v115, v124 quad_perm:[3,3,3,3] row_mask:0xf bank_mask:0xf
    v_add_f32 v122, v122, v124
    v_max_f32 v65, v65, v122
    ds_write_b32 v64, v122 offset:3072
    s_waitcnt vmcnt(5)
    buffer_load_dwordx4 v[136:139], v76, s[52:55], s85 offen offset:1024 nt
    v_mfma_f32_16x16x32_bf16 v[96:99], a[92:95], v[92:95], v[96:99]
    v_mfma_f32_16x16x32_bf16 v[112:115], a[96:99], v[80:83], 0
    s_waitcnt vmcnt(5)
    buffer_load_dwordx4 v[140:143], v77, s[52:55], s85 offen offset:1024 nt
    s_add_u32 s87, s87, 1
    s_add_u32 s39, s87, s88
    s_bfe_u32 s37, s39, 0x10000
    s_lshl_b32 s37, s37, 13
    s_add_u32 s85, s37, s89
    s_bfe_u32 s37, s39, 0x10001
    s_lshl_b32 s37, s37, 12
    s_add_u32 s85, s37, s85
    s_bfe_u32 s37, s39, 0x10002
    s_lshl_b32 s37, s37, 11
    s_add_u32 s85, s37, s85
    s_bfe_u32 s37, s39, 0x10003
    s_lshl_b32 s37, s37, 14
    s_add_u32 s85, s37, s85
    s_bfe_u32 s37, s39, 0x40004
    s_lshl_b32 s37, s37, 16
    s_add_u32 s85, s37, s85
    v_mfma_f32_16x16x32_bf16 v[112:115], a[100:103], v[84:87], v[112:115]
    v_mfma_f32_16x16x32_bf16 v[112:115], a[104:107], v[88:91], v[112:115]
    v_mov_b32_dpp v122, v96 quad_perm:[0,0,0,0] row_mask:0xf bank_mask:0xf
    v_mov_b32_dpp v124, v98 quad_perm:[2,2,2,2] row_mask:0xf bank_mask:0xf
    s_nop 0
    v_add_f32_dpp v122, v97, v122 quad_perm:[1,1,1,1] row_mask:0xf bank_mask:0xf
    v_add_f32_dpp v124, v99, v124 quad_perm:[3,3,3,3] row_mask:0xf bank_mask:0xf
    v_add_f32 v122, v122, v124
    v_max_f32 v65, v65, v122
    ds_write_b32 v64, v122 offset:3328
    v_lshlrev_b32 v30, 4, v3
    v_lshl_add_u32 v30, v2, 13, v30
    v_lshrrev_b32 v5, 2, v1
    v_lshlrev_b32 v32, 8, v5
    v_bfe_u32 v5, v1, 0, 2
    v_lshl_add_u32 v32, v5, 4, v32
    s_xor_b32 s37, s90, 4
    s_bfe_u32 s38, s37, 0x30000
    s_lshl_b32 s38, s38, 8
    s_add_u32 s36, s38, 0
    s_lshr_b32 s38, s32, 4
    s_lshl_b32 s38, s38, 7
    s_add_u32 s36, s38, s36
    s_bfe_u32 s38, s32, 0x20000
    s_lshl_b32 s38, s38, 5
    s_add_u32 s36, s38, s36
    s_bfe_u32 s38, s32, 0x20002
    s_lshl_b32 s38, s38, 3
    s_add_u32 s36, s38, s36
    v_bfe_u32 v5, v1, 0, 2
    v_lshlrev_b32 v33, 11, v5
    v_lshl_add_u32 v33, v2, 1, v33
    v_add_u32 v33, s36, v33
    v_and_b32 v5, 31, v1
    v_lshlrev_b32 v34, 4, v5
    s_mul_i32 s38, s34, 320
    s_add_u32 s38, s38, 135168
    v_lshl_add_u32 v35, v5, 3, s38
    s_bfe_u32 s38, s34, 0x10000
    s_lshl_b32 s38, s38, 12
    s_add_u32 s36, s38, s71
    s_lshr_b32 s38, s34, 1
    s_lshl_b32 s38, s38, 24
    s_add_u32 s36, s38, s36
    s_bitcmp1_b32 s90, 2
    s_cselect_b32 s46, s46, s36
    s_cselect_b64 vcc, -1, 0
    v_cndmask_b32 v54, v32, v34, vcc
    s_waitcnt vmcnt(5)
    buffer_load_dwordx4 v[144:147], v76, s[52:55], s85 offen offset:0 nt
    v_mfma_f32_16x16x32_bf16 v[112:115], a[108:111], v[92:95], v[112:115]
    v_mfma_f32_16x16x32_bf16 v[96:99], a[112:115], v[80:83], 0
    s_waitcnt vmcnt(5)
    buffer_load_dwordx4 v[148:151], v77, s[52:55], s85 offen offset:0 nt
    v_mfma_f32_16x16x32_bf16 v[96:99], a[116:119], v[84:87], v[96:99]
    v_mfma_f32_16x16x32_bf16 v[96:99], a[120:123], v[88:91], v[96:99]
    s_nop 2
    v_mov_b32_dpp v122, v112 quad_perm:[0,0,0,0] row_mask:0xf bank_mask:0xf
    v_mov_b32_dpp v124, v114 quad_perm:[2,2,2,2] row_mask:0xf bank_mask:0xf
    s_nop 0
    v_add_f32_dpp v122, v113, v122 quad_perm:[1,1,1,1] row_mask:0xf bank_mask:0xf
    v_add_f32_dpp v124, v115, v124 quad_perm:[3,3,3,3] row_mask:0xf bank_mask:0xf
    v_add_f32 v122, v122, v124
    v_max_f32 v65, v65, v122
    ds_write_b32 v64, v122 offset:3584
    v_mfma_f32_16x16x32_bf16 v[96:99], a[124:127], v[92:95], v[96:99]
    v_add_u32 v64, 3840, v64
    s_mov_b32 s97, 8
    s_mov_b32 s92, 1
    s_lshl_b32 s38, s32, 13
    s_add_u32 s80, s38, 3145728
    s_lshl_b32 s38, s3, 11
    s_add_u32 s80, s38, s80
    v_lshrrev_b32 v4, 2, v1
    v_lshlrev_b32 v55, 3, v4
    s_mov_b32 s66, 134217728
    s_mov_b32 s67, 0x20000
    s_mov_b64 s[64:65], s[52:53]
    v_mov_b32 v62, v76
    v_mov_b32 v63, v77
    s_branch L_bloop
L_aux:
    v_lshlrev_b32 v4, 2, v2
    v_xor_b32 v4, v4, v3
    v_xor_b32 v96, 0, v4
    v_lshlrev_b32 v96, 4, v96
    v_lshl_add_u32 v10, v2, 13, v96
    v_xor_b32 v97, 1, v4
    v_lshlrev_b32 v97, 4, v97
    v_lshl_add_u32 v11, v2, 13, v97
    v_add_u32 v11, 31744, v11
    v_xor_b32 v98, 2, v4
    v_lshlrev_b32 v98, 4, v98
    v_lshl_add_u32 v12, v2, 13, v98
    v_add_u32 v12, 63488, v12
    v_xor_b32 v99, 3, v4
    v_lshlrev_b32 v99, 4, v99
    v_lshl_add_u32 v13, v2, 13, v99
    v_add_u32 v13, 95232, v13
    s_lshl_b32 s56, s34, 15
    s_mov_b32 s62, 0
    s_lshl_b32 s38, s34, 20
    s_add_u32 s95, s38, 0
    s_lshl_b32 s38, s32, 8
    s_add_u32 s95, s38, s95
    s_waitcnt lgkmcnt(0)
    s_mov_b32 s52, s12
    s_and_b32 s53, s13, 0xffff
    s_mov_b32 s54, 4194304
    s_mov_b32 s55, 0x20000
    s_add_u32 s39, s56, s62
    s_mov_b32 m0, s39
    s_add_u32 s62, s62, 4096
    s_and_b32 s62, s62, 0x7fff
    buffer_load_dwordx4 v10, s[52:55], s95 offen offset:0 nt lds
    buffer_load_dwordx4 v11, s[52:55], s95 offen offset:1024 nt lds
    buffer_load_dwordx4 v12, s[52:55], s95 offen offset:2048 nt lds
    buffer_load_dwordx4 v13, s[52:55], s95 offen offset:3072 nt lds
    s_add_u32 s95, s95, 131072
    s_add_u32 s39, s56, s62
    s_mov_b32 m0, s39
    s_add_u32 s62, s62, 4096
    s_and_b32 s62, s62, 0x7fff
    buffer_load_dwordx4 v10, s[52:55], s95 offen offset:0 nt lds
    buffer_load_dwordx4 v11, s[52:55], s95 offen offset:1024 nt lds
    buffer_load_dwordx4 v12, s[52:55], s95 offen offset:2048 nt lds
    buffer_load_dwordx4 v13, s[52:55], s95 offen offset:3072 nt lds
    s_add_u32 s95, s95, 131072
    s_load_dword s35, s[30:31], 0
    s_mov_b32 s48, s30
    s_and_b32 s49, s31, 0xffff
    s_mov_b32 s50, 8388608
    s_mov_b32 s51, 0x20000
    s_mov_b32 s82, 0xffffff00
    s_mov_b32 s83, 0x3e0293ee
    s_mov_b32 s84, 8388608
    v_lshl_add_u32 v76, v2, 10, v96
    v_lshl_add_u32 v96, v2, 8, v96
    v_lshl_add_u32 v77, v2, 10, v97
    v_lshl_add_u32 v97, v2, 8, v97
    v_add_u32 v77, 3072, v77
    v_lshl_add_u32 v78, v2, 10, v98
    v_lshl_add_u32 v98, v2, 8, v98
    v_add_u32 v78, 6144, v78
    v_lshl_add_u32 v79, v2, 10, v99
    v_lshl_add_u32 v99, v2, 8, v99
    v_add_u32 v79, 9216, v79
    v_bfe_u32 v100, v1, 0, 5
    v_lshlrev_b32 v101, 8, v100
    v_lshlrev_b32 v9, 4, v3
    v_lshl_add_u32 v9, v2, 10, v9
    v_xor_b32 v5, v3, v2
    v_bfe_u32 v4, v3, 2, 1
    v_lshlrev_b32 v6, 11, v4
    v_bfe_u32 v4, v3, 3, 1
    v_lshl_add_u32 v6, v4, 10, v6
    v_bfe_u32 v4, v3, 0, 2
    v_lshl_add_u32 v6, v4, 8, v6
    v_bfe_u32 v4, v5, 0, 2
    v_lshl_add_u32 v6, v4, 6, v6
    v_bfe_u32 v4, v3, 2, 1
    v_lshl_add_u32 v6, v4, 5, v6
    v_bfe_u32 v4, v3, 3, 1
    v_lshl_add_u32 v6, v4, 4, v6
    v_add_u32 v60, s56, v6
    v_xor_b32 v61, 16, v60
    v_xor_b32 v62, 32, v60
    v_xor_b32 v63, 48, v60
    v_lshrrev_b32 v5, 4, v1
    v_xor_b32 v5, v5, v1
    v_bfe_u32 v4, v1, 4, 1
    v_lshlrev_b32 v6, 11, v4
    v_bfe_u32 v4, v1, 5, 1
    v_lshl_add_u32 v6, v4, 10, v6
    v_bfe_u32 v4, v1, 2, 2
    v_lshl_add_u32 v6, v4, 8, v6
    v_bfe_u32 v4, v1, 2, 2
    v_lshl_add_u32 v6, v4, 6, v6
    v_bfe_u32 v4, v1, 4, 1
    v_lshl_add_u32 v6, v4, 5, v6
    v_bfe_u32 v4, v5, 1, 1
    v_lshl_add_u32 v6, v4, 4, v6
    v_bfe_u32 v4, v1, 0, 1
    v_lshl_add_u32 v6, v4, 3, v6
    v_add_u32 v82, s56, v6
    v_xor_b32 v83, 32, v82
    v_xor_b32 v84, 64, v82
    v_xor_b32 v85, 96, v82
    v_xor_b32 v86, 128, v82
    v_xor_b32 v87, 160, v82
    v_xor_b32 v88, 192, v82
    v_xor_b32 v89, 224, v82
    v_lshlrev_b32 v6, 11, v2
    v_bfe_u32 v4, v1, 2, 2
    v_lshl_add_u32 v6, v4, 8, v6
    v_bfe_u32 v4, v1, 2, 2
    v_lshl_add_u32 v6, v4, 6, v6
    v_bfe_u32 v4, v1, 4, 1
    v_lshl_add_u32 v6, v4, 5, v6
    v_bfe_u32 v4, v1, 1, 1
    v_lshl_add_u32 v6, v4, 4, v6
    v_bfe_u32 v4, v1, 0, 1
    v_lshl_add_u32 v6, v4, 3, v6
    v_add_u32 v136, s56, v6
    v_xor_b32 v137, 16, v136
    v_xor_b32 v138, 32, v136
    v_xor_b32 v139, 48, v136
    v_xor_b32 v140, 64, v136
    v_xor_b32 v141, 80, v136
    v_xor_b32 v142, 96, v136
    v_xor_b32 v143, 112, v136
    v_xor_b32 v144, 128, v136
    v_xor_b32 v145, 144, v136
    v_xor_b32 v146, 160, v136
    v_xor_b32 v147, 176, v136
    v_xor_b32 v148, 192, v136
    v_xor_b32 v149, 208, v136
    v_xor_b32 v150, 224, v136
    v_xor_b32 v151, 240, v136
    s_lshl_b32 s85, s34, 13
    s_add_u32 s85, s85, 131072
    v_lshl_add_u32 v94, v1, 4, s85
    v_add_u32 v96, s85, v96
    v_add_u32 v97, s85, v97
    v_add_u32 v98, s85, v98
    v_add_u32 v99, s85, v99
    s_add_u32 s39, s56, s62
    s_mov_b32 m0, s39
    s_add_u32 s62, s62, 4096
    s_and_b32 s62, s62, 0x7fff
    buffer_load_dwordx4 v10, s[52:55], s95 offen offset:0 nt lds
    buffer_load_dwordx4 v11, s[52:55], s95 offen offset:1024 nt lds
    buffer_load_dwordx4 v12, s[52:55], s95 offen offset:2048 nt lds
    buffer_load_dwordx4 v13, s[52:55], s95 offen offset:3072 nt lds
    s_add_u32 s95, s95, 131072
    s_add_u32 s39, s56, s62
    s_mov_b32 m0, s39
    s_add_u32 s62, s62, 4096
    s_and_b32 s62, s62, 0x7fff
    buffer_load_dwordx4 v10, s[52:55], s95 offen offset:0 nt lds
    buffer_load_dwordx4 v11, s[52:55], s95 offen offset:1024 nt lds
    buffer_load_dwordx4 v12, s[52:55], s95 offen offset:2048 nt lds
    buffer_load_dwordx4 v13, s[52:55], s95 offen offset:3072 nt lds
    s_add_u32 s95, s95, 131072
    s_add_u32 s39, s56, s62
    s_mov_b32 m0, s39
    s_add_u32 s62, s62, 4096
    s_and_b32 s62, s62, 0x7fff
    buffer_load_dwordx4 v10, s[52:55], s95 offen offset:0 nt lds
    buffer_load_dwordx4 v11, s[52:55], s95 offen offset:1024 nt lds
    buffer_load_dwordx4 v12, s[52:55], s95 offen offset:2048 nt lds
    buffer_load_dwordx4 v13, s[52:55], s95 offen offset:3072 nt lds
    s_add_u32 s95, s95, 131072
    s_add_u32 s39, s56, s62
    s_mov_b32 m0, s39
    s_add_u32 s62, s62, 4096
    s_and_b32 s62, s62, 0x7fff
    buffer_load_dwordx4 v10, s[52:55], s95 offen offset:0 nt lds
    buffer_load_dwordx4 v11, s[52:55], s95 offen offset:1024 nt lds
    buffer_load_dwordx4 v12, s[52:55], s95 offen offset:2048 nt lds
    buffer_load_dwordx4 v13, s[52:55], s95 offen offset:3072 nt lds
    s_add_u32 s95, s95, 131072
    s_add_u32 s39, s56, s62
    s_mov_b32 m0, s39
    s_add_u32 s62, s62, 4096
    s_and_b32 s62, s62, 0x7fff
    buffer_load_dwordx4 v10, s[52:55], s95 offen offset:0 nt lds
    buffer_load_dwordx4 v11, s[52:55], s95 offen offset:1024 nt lds
    buffer_load_dwordx4 v12, s[52:55], s95 offen offset:2048 nt lds
    buffer_load_dwordx4 v13, s[52:55], s95 offen offset:3072 nt lds
    s_add_u32 s95, s95, 131072
    s_add_u32 s39, s56, s62
    s_mov_b32 m0, s39
    s_add_u32 s62, s62, 4096
    s_and_b32 s62, s62, 0x7fff
    buffer_load_dwordx4 v10, s[52:55], s95 offen offset:0 nt lds
    buffer_load_dwordx4 v11, s[52:55], s95 offen offset:1024 nt lds
    buffer_load_dwordx4 v12, s[52:55], s95 offen offset:2048 nt lds
    buffer_load_dwordx4 v13, s[52:55], s95 offen offset:3072 nt lds
    s_add_u32 s95, s95, 131072
    s_waitcnt lgkmcnt(0)
    s_add_u32 s35, s35, 0x5b
    s_and_b32 s35, s35, 0xff
    v_mov_b32 v8, s35
    s_or_b32 s68, s35, 0x6b3ac500
    s_getreg_b32 s70, hwreg(HW_REG_XCC_ID, 0, 4)
    s_lshl_b32 s70, s70, 8
    s_or_b32 s70, s70, s35
    s_or_b32 s70, s70, 0x5e9d0000
    s_bfe_u32 s38, s2, 0x30000
    s_lshl_b32 s38, s38, 8
    s_add_u32 s69, s38, 32768
    s_lshl_b32 s38, s32, 2
    s_add_u32 s69, s38, s69
    s_lshl_b32 s38, s34, 24
    s_add_u32 s69, s38, s69
    v_mov_b32 v4, s69
    v_mov_b32 v5, s70
    s_mov_b64 exec, 1
    buffer_store_dword v5, v4, s[48:51], 0 offen sc1
    s_mov_b64 exec, -1
    s_mov_b32 s52, s6
    s_and_b32 s53, s7, 0xffff
    s_mov_b32 s54, 16777216
    s_mov_b32 s55, 0x20000
    s_bfe_u32 s38, s32, 0x30000
    s_lshl_b32 s38, s38, 1
    s_add_u32 s3, s38, 0
    s_lshr_b32 s38, s32, 4
    s_lshl_b32 s38, s38, 0
    s_add_u32 s3, s38, s3
    s_bfe_u32 s94, s32, 0x10003
    s_lshl_b32 s38, s3, 20
    s_add_u32 s95, s38, 0
    s_lshl_b32 s38, s34, 8
    s_add_u32 s95, s38, s95
    s_waitcnt vmcnt(25)
    ds_read_b64_tr_b16 a[128:129], v136 offset:0
    ds_read_b64_tr_b16 a[130:131], v137 offset:1024
    ds_read_b64_tr_b16 a[144:145], v138 offset:0
    ds_read_b64_tr_b16 a[146:147], v139 offset:1024
    ds_read_b64_tr_b16 a[160:161], v140 offset:0
    ds_read_b64_tr_b16 a[162:163], v141 offset:1024
    ds_read_b64_tr_b16 a[176:177], v142 offset:0
    ds_read_b64_tr_b16 a[178:179], v143 offset:1024
    ds_read_b64_tr_b16 a[192:193], v144 offset:0
    ds_read_b64_tr_b16 a[194:195], v145 offset:1024
    ds_read_b64_tr_b16 a[208:209], v146 offset:0
    ds_read_b64_tr_b16 a[210:211], v147 offset:1024
    ds_read_b64_tr_b16 a[224:225], v148 offset:0
    ds_read_b64_tr_b16 a[226:227], v149 offset:1024
    ds_read_b64_tr_b16 a[240:241], v150 offset:0
    ds_read_b64_tr_b16 a[242:243], v151 offset:1024
    s_waitcnt lgkmcnt(0)
    s_add_u32 s39, s56, s62
    s_mov_b32 m0, s39
    s_add_u32 s62, s62, 4096
    s_and_b32 s62, s62, 0x7fff
    buffer_load_dwordx4 v76, s[52:55], s95 offen offset:0 nt lds
    buffer_load_dwordx4 v77, s[52:55], s95 offen offset:1024 nt lds
    buffer_load_dwordx4 v78, s[52:55], s95 offen offset:2048 nt lds
    buffer_load_dwordx4 v79, s[52:55], s95 offen offset:3072 nt lds
    s_add_u32 s95, s95, 16384
    s_add_u32 s39, s56, s62
    s_mov_b32 m0, s39
    s_add_u32 s62, s62, 4096
    s_and_b32 s62, s62, 0x7fff
    buffer_load_dwordx4 v76, s[52:55], s95 offen offset:0 nt lds
    buffer_load_dwordx4 v77, s[52:55], s95 offen offset:1024 nt lds
    buffer_load_dwordx4 v78, s[52:55], s95 offen offset:2048 nt lds
    buffer_load_dwordx4 v79, s[52:55], s95 offen offset:3072 nt lds
    s_add_u32 s95, s95, 16384
    s_waitcnt vmcnt(25)
    ds_read_b64_tr_b16 a[132:133], v136 offset:8192
    ds_read_b64_tr_b16 a[134:135], v137 offset:9216
    ds_read_b64_tr_b16 a[148:149], v138 offset:8192
    ds_read_b64_tr_b16 a[150:151], v139 offset:9216
    ds_read_b64_tr_b16 a[164:165], v140 offset:8192
    ds_read_b64_tr_b16 a[166:167], v141 offset:9216
    ds_read_b64_tr_b16 a[180:181], v142 offset:8192
    ds_read_b64_tr_b16 a[182:183], v143 offset:9216
    ds_read_b64_tr_b16 a[196:197], v144 offset:8192
    ds_read_b64_tr_b16 a[198:199], v145 offset:9216
    ds_read_b64_tr_b16 a[212:213], v146 offset:8192
    ds_read_b64_tr_b16 a[214:215], v147 offset:9216
    ds_read_b64_tr_b16 a[228:229], v148 offset:8192
    ds_read_b64_tr_b16 a[230:231], v149 offset:9216
    ds_read_b64_tr_b16 a[244:245], v150 offset:8192
    ds_read_b64_tr_b16 a[246:247], v151 offset:9216
    s_waitcnt lgkmcnt(0)
    s_add_u32 s39, s56, s62
    s_mov_b32 m0, s39
    s_add_u32 s62, s62, 4096
    s_and_b32 s62, s62, 0x7fff
    buffer_load_dwordx4 v76, s[52:55], s95 offen offset:0 nt lds
    buffer_load_dwordx4 v77, s[52:55], s95 offen offset:1024 nt lds
    buffer_load_dwordx4 v78, s[52:55], s95 offen offset:2048 nt lds
    buffer_load_dwordx4 v79, s[52:55], s95 offen offset:3072 nt lds
    s_add_u32 s95, s95, 16384
    s_add_u32 s39, s56, s62
    s_mov_b32 m0, s39
    s_add_u32 s62, s62, 4096
    s_and_b32 s62, s62, 0x7fff
    buffer_load_dwordx4 v76, s[52:55], s95 offen offset:0 nt lds
    buffer_load_dwordx4 v77, s[52:55], s95 offen offset:1024 nt lds
    buffer_load_dwordx4 v78, s[52:55], s95 offen offset:2048 nt lds
    buffer_load_dwordx4 v79, s[52:55], s95 offen offset:3072 nt lds
    s_add_u32 s95, s95, 16384
    s_waitcnt vmcnt(25)
    ds_read_b64_tr_b16 a[136:137], v136 offset:16384
    ds_read_b64_tr_b16 a[138:139], v137 offset:17408
    ds_read_b64_tr_b16 a[152:153], v138 offset:16384
    ds_read_b64_tr_b16 a[154:155], v139 offset:17408
    ds_read_b64_tr_b16 a[168:169], v140 offset:16384
    ds_read_b64_tr_b16 a[170:171], v141 offset:17408
    ds_read_b64_tr_b16 a[184:185], v142 offset:16384
    ds_read_b64_tr_b16 a[186:187], v143 offset:17408
    ds_read_b64_tr_b16 a[200:201], v144 offset:16384
    ds_read_b64_tr_b16 a[202:203], v145 offset:17408
    ds_read_b64_tr_b16 a[216:217], v146 offset:16384
    ds_read_b64_tr_b16 a[218:219], v147 offset:17408
    ds_read_b64_tr_b16 a[232:233], v148 offset:16384
    ds_read_b64_tr_b16 a[234:235], v149 offset:17408
    ds_read_b64_tr_b16 a[248:249], v150 offset:16384
    ds_read_b64_tr_b16 a[250:251], v151 offset:17408
    s_waitcnt lgkmcnt(0)
    s_add_u32 s39, s56, s62
    s_mov_b32 m0, s39
    s_add_u32 s62, s62, 4096
    s_and_b32 s62, s62, 0x7fff
    buffer_load_dwordx4 v76, s[52:55], s95 offen offset:0 nt lds
    buffer_load_dwordx4 v77, s[52:55], s95 offen offset:1024 nt lds
    buffer_load_dwordx4 v78, s[52:55], s95 offen offset:2048 nt lds
    buffer_load_dwordx4 v79, s[52:55], s95 offen offset:3072 nt lds
    s_add_u32 s95, s95, 16384
    s_add_u32 s39, s56, s62
    s_mov_b32 m0, s39
    s_add_u32 s62, s62, 4096
    s_and_b32 s62, s62, 0x7fff
    buffer_load_dwordx4 v76, s[52:55], s95 offen offset:0 nt lds
    buffer_load_dwordx4 v77, s[52:55], s95 offen offset:1024 nt lds
    buffer_load_dwordx4 v78, s[52:55], s95 offen offset:2048 nt lds
    buffer_load_dwordx4 v79, s[52:55], s95 offen offset:3072 nt lds
    s_add_u32 s95, s95, 16384
    s_waitcnt vmcnt(25)
    ds_read_b64_tr_b16 a[140:141], v136 offset:24576
    ds_read_b64_tr_b16 a[142:143], v137 offset:25600
    ds_read_b64_tr_b16 a[156:157], v138 offset:24576
    ds_read_b64_tr_b16 a[158:159], v139 offset:25600
    ds_read_b64_tr_b16 a[172:173], v140 offset:24576
    ds_read_b64_tr_b16 a[174:175], v141 offset:25600
    ds_read_b64_tr_b16 a[188:189], v142 offset:24576
    ds_read_b64_tr_b16 a[190:191], v143 offset:25600
    ds_read_b64_tr_b16 a[204:205], v144 offset:24576
    ds_read_b64_tr_b16 a[206:207], v145 offset:25600
    ds_read_b64_tr_b16 a[220:221], v146 offset:24576
    ds_read_b64_tr_b16 a[222:223], v147 offset:25600
    ds_read_b64_tr_b16 a[236:237], v148 offset:24576
    ds_read_b64_tr_b16 a[238:239], v149 offset:25600
    ds_read_b64_tr_b16 a[252:253], v150 offset:24576
    ds_read_b64_tr_b16 a[254:255], v151 offset:25600
    s_waitcnt lgkmcnt(0)
    s_add_u32 s39, s56, s62
    s_mov_b32 m0, s39
    s_add_u32 s62, s62, 4096
    s_and_b32 s62, s62, 0x7fff
    buffer_load_dwordx4 v76, s[52:55], s95 offen offset:0 nt lds
    buffer_load_dwordx4 v77, s[52:55], s95 offen offset:1024 nt lds
    s_mov_b32 s86, 98304
    buffer_load_dword v7, v101, s[48:51], s86 offen sc1
    v_mov_b32 v104, 0
    v_mov_b32 v105, 0
    v_mov_b32 v106, 0
    v_mov_b32 v107, 0
    v_mov_b32 v108, 0
    v_mov_b32 v109, 0
    v_mov_b32 v110, 0
    v_mov_b32 v111, 0
    v_mov_b32 v112, 0
    v_mov_b32 v113, 0
    v_mov_b32 v114, 0
    v_mov_b32 v115, 0
    v_mov_b32 v116, 0
    v_mov_b32 v117, 0
    v_mov_b32 v118, 0
    v_mov_b32 v119, 0
    v_mov_b32 v120, 0
    v_mov_b32 v121, 0
    v_mov_b32 v122, 0
    v_mov_b32 v123, 0
    v_mov_b32 v124, 0
    v_mov_b32 v125, 0
    v_mov_b32 v126, 0
    v_mov_b32 v127, 0
    v_mov_b32 v128, 0
    v_mov_b32 v129, 0
    v_mov_b32 v130, 0
    v_mov_b32 v131, 0
    v_mov_b32 v132, 0
    v_mov_b32 v133, 0
    v_mov_b32 v134, 0
    v_mov_b32 v135, 0
    v_mov_b32 v90, 0xff7f0000
    s_mov_b32 s93, 0
    v_mov_b32 v102, 0
    v_mov_b32 v103, 0
    s_mov_b32 s60, s83
    s_mov_b32 s61, s83
    v_xor_b32 v5, v3, v2
    v_lshlrev_b32 v6, 8, v3
    v_bfe_u32 v4, v5, 0, 2
    v_lshl_add_u32 v6, v4, 6, v6
    v_lshrrev_b32 v4, 2, v3
    v_lshl_add_u32 v6, v4, 4, v6
    v_add_u32 v52, s85, v6
    v_xor_b32 v53, 16, v52
    v_xor_b32 v54, 32, v52
    v_xor_b32 v55, 48, v52
    s_lshr_b32 s38, s3, 2
    s_lshl_b32 s38, s38, 15
    s_add_u32 s36, s38, 393216
    s_lshl_b32 s38, s94, 14
    s_add_u32 s36, s38, s36
    s_lshl_b32 s38, s34, 8
    s_add_u32 s36, s38, s36
    s_waitcnt vmcnt(0)
L_fcheck_45:
    v_cmp_ne_u32 vcc, s68, v7
    s_cbranch_vccz L_fok_46
    s_sleep 2
    s_mov_b32 s86, 98304
    buffer_load_dword v7, v101, s[48:51], s86 offen sc1
    s_waitcnt vmcnt(0)
    s_sub_u32 s84, s84, 1
    s_cmp_lg_u32 s84, 0
    s_cbranch_scc1 L_fcheck_45
    s_branch L_end
L_fok_46:
    buffer_load_dwordx4 v[200:203], v9, s[48:51], s36 offen sc1
    s_add_u32 s36, s36, 4096
    buffer_load_dwordx4 v[204:207], v9, s[48:51], s36 offen sc1
    s_add_u32 s36, s36, 4096
    buffer_load_dwordx4 v[208:211], v9, s[48:51], s36 offen sc1
    s_add_u32 s36, s36, 4096
    buffer_load_dwordx4 v[212:215], v9, s[48:51], s36 offen sc1
    ds_read_b128 v[136:139], v60 offset:0
    ds_read_b128 v[140:143], v61 offset:0
    ds_read_b128 v[144:147], v62 offset:0
    ds_read_b128 v[148:151], v63 offset:0
    ds_read_b128 v[152:155], v60 offset:4096
    ds_read_b128 v[156:159], v61 offset:4096
    ds_read_b128 v[160:163], v62 offset:4096
    ds_read_b128 v[164:167], v63 offset:4096
    ds_read_b128 v[168:171], v60 offset:8192
    ds_read_b128 v[172:175], v61 offset:8192
    ds_read_b128 v[176:179], v62 offset:8192
    ds_read_b128 v[180:183], v63 offset:8192
    ds_read_b128 v[184:187], v60 offset:12288
    ds_read_b128 v[188:191], v61 offset:12288
    ds_read_b128 v[192:195], v62 offset:12288
    ds_read_b128 v[196:199], v63 offset:12288
    s_waitcnt vmcnt(3)
    ds_write_b128 v96, v[200:203] offset:0
    s_waitcnt vmcnt(2)
    ds_write_b128 v97, v[204:207] offset:1024
    s_waitcnt vmcnt(1)
    ds_write_b128 v98, v[208:211] offset:2048
    s_waitcnt vmcnt(0)
    ds_write_b128 v99, v[212:215] offset:3072
    s_waitcnt lgkmcnt(0)
    ds_read_b128 v[36:39], v52
    ds_read_b128 v[40:43], v53
    ds_read_b128 v[44:47], v54
    ds_read_b128 v[48:51], v55
L_att:
    s_waitcnt lgkmcnt(0)
    v_mfma_f32_16x16x32_bf16 v[200:203], v[136:139], v[36:39], 0
    ds_read_b64_tr_b16 a[0:1], v82 offset:0
    ds_read_b64_tr_b16 a[2:3], v82 offset:4096
    buffer_load_dwordx4 v78, s[52:55], s95 offen offset:2048 nt lds
    v_mfma_f32_16x16x32_bf16 v[200:203], v[140:143], v[40:43], v[200:203]
    ds_read_b64_tr_b16 a[4:5], v83 offset:0
    ds_read_b64_tr_b16 a[6:7], v83 offset:4096
    v_mfma_f32_16x16x32_bf16 v[200:203], v[144:147], v[44:47], v[200:203]
    ds_read_b64_tr_b16 a[8:9], v84 offset:0
    ds_read_b64_tr_b16 a[10:11], v84 offset:4096
    v_mfma_f32_16x16x32_bf16 v[200:203], v[148:151], v[48:51], v[200:203]
    ds_read_b64_tr_b16 a[12:13], v85 offset:0
    ds_read_b64_tr_b16 a[14:15], v85 offset:4096
    buffer_load_dwordx4 v79, s[52:55], s95 offen offset:3072 nt lds
    s_add_u32 s95, s95, 16384
    v_mfma_f32_16x16x32_bf16 v[204:207], v[152:155], v[36:39], 0
    ds_read_b64_tr_b16 a[16:17], v86 offset:0
    ds_read_b64_tr_b16 a[18:19], v86 offset:4096
    v_mfma_f32_16x16x32_bf16 v[204:207], v[156:159], v[40:43], v[204:207]
    ds_read_b64_tr_b16 a[20:21], v87 offset:0
    ds_read_b64_tr_b16 a[22:23], v87 offset:4096
    v_mfma_f32_16x16x32_bf16 v[204:207], v[160:163], v[44:47], v[204:207]
    ds_read_b64_tr_b16 a[24:25], v88 offset:0
    ds_read_b64_tr_b16 a[26:27], v88 offset:4096
    s_add_u32 s39, s56, s62
    s_mov_b32 m0, s39
    s_add_u32 s62, s62, 4096
    s_and_b32 s62, s62, 0x7fff
    buffer_load_dwordx4 v76, s[52:55], s95 offen offset:0 nt lds
    v_mfma_f32_16x16x32_bf16 v[204:207], v[164:167], v[48:51], v[204:207]
    ds_read_b64_tr_b16 a[28:29], v89 offset:0
    ds_read_b64_tr_b16 a[30:31], v89 offset:4096
    ds_write_b128 v94, v[200:203] offset:0
    v_mfma_f32_16x16x32_bf16 v[208:211], v[168:171], v[36:39], 0
    ds_read_b64_tr_b16 a[32:33], v82 offset:8192
    ds_read_b64_tr_b16 a[34:35], v82 offset:12288
    v_mfma_f32_16x16x32_bf16 v[208:211], v[172:175], v[40:43], v[208:211]
    ds_read_b64_tr_b16 a[36:37], v83 offset:8192
    ds_read_b64_tr_b16 a[38:39], v83 offset:12288
    buffer_load_dwordx4 v77, s[52:55], s95 offen offset:1024 nt lds
    v_mfma_f32_16x16x32_bf16 v[208:211], v[176:179], v[44:47], v[208:211]
    ds_read_b64_tr_b16 a[40:41], v84 offset:8192
    ds_read_b64_tr_b16 a[42:43], v84 offset:12288
    v_mfma_f32_16x16x32_bf16 v[208:211], v[180:183], v[48:51], v[208:211]
    ds_read_b64_tr_b16 a[44:45], v85 offset:8192
    ds_read_b64_tr_b16 a[46:47], v85 offset:12288
    ds_write_b128 v94, v[204:207] offset:1024
    v_mfma_f32_16x16x32_bf16 v[212:215], v[184:187], v[36:39], 0
    ds_read_b64_tr_b16 a[48:49], v86 offset:8192
    ds_read_b64_tr_b16 a[50:51], v86 offset:12288
    buffer_load_dwordx4 v78, s[52:55], s95 offen offset:2048 nt lds
    v_mfma_f32_16x16x32_bf16 v[212:215], v[188:191], v[40:43], v[212:215]
    ds_read_b64_tr_b16 a[52:53], v87 offset:8192
    ds_read_b64_tr_b16 a[54:55], v87 offset:12288
    v_mfma_f32_16x16x32_bf16 v[212:215], v[192:195], v[44:47], v[212:215]
    ds_read_b64_tr_b16 a[56:57], v88 offset:8192
    ds_read_b64_tr_b16 a[58:59], v88 offset:12288
    v_mfma_f32_16x16x32_bf16 v[212:215], v[196:199], v[48:51], v[212:215]
    ds_read_b64_tr_b16 a[60:61], v89 offset:8192
    ds_read_b64_tr_b16 a[62:63], v89 offset:12288
    buffer_load_dwordx4 v79, s[52:55], s95 offen offset:3072 nt lds
    s_add_u32 s95, s95, 16384
    ds_write_b128 v94, v[208:211] offset:2048
    v_xor_b32 v5, 0x2000, v94
    v_xor_b32 v6, 0x4000, v94
    v_xor_b32 v7, 0x6000, v94
    s_cmp_eq_u32 s93, 14
    s_cselect_b32 s95, 16777216, s95
    ds_write_b128 v94, v[212:215] offset:3072
    v_xor_b32 v82, 0x4000, v82
    v_xor_b32 v83, 0x4000, v83
    v_xor_b32 v84, 0x4000, v84
    v_xor_b32 v85, 0x4000, v85
    v_xor_b32 v86, 0x4000, v86
    v_xor_b32 v87, 0x4000, v87
    v_xor_b32 v88, 0x4000, v88
    v_xor_b32 v89, 0x4000, v89
    v_xor_b32 v60, 0x4000, v60
    v_xor_b32 v61, 0x4000, v61
    v_xor_b32 v62, 0x4000, v62
    v_xor_b32 v63, 0x4000, v63
    s_waitcnt lgkmcnt(0)
    s_barrier
    ds_read_b128 v[136:139], v5 offset:0
    ds_read_b128 v[152:155], v6 offset:0
    ds_read_b128 v[168:171], v7 offset:0
    ds_read_b128 v[140:143], v5 offset:1024
    ds_read_b128 v[156:159], v6 offset:1024
    ds_read_b128 v[172:175], v7 offset:1024
    ds_read_b128 v[144:147], v5 offset:2048
    ds_read_b128 v[160:163], v6 offset:2048
    ds_read_b128 v[176:179], v7 offset:2048
    ds_read_b128 v[148:151], v5 offset:3072
    ds_read_b128 v[164:167], v6 offset:3072
    ds_read_b128 v[180:183], v7 offset:3072
    v_xor_b32 v94, 0x1000, v94
    s_add_u32 s39, s56, s62
    s_mov_b32 m0, s39
    s_add_u32 s62, s62, 4096
    s_and_b32 s62, s62, 0x7fff
    buffer_load_dwordx4 v76, s[52:55], s95 offen offset:0 nt lds
    buffer_load_dwordx4 v77, s[52:55], s95 offen offset:1024 nt lds
    buffer_load_dwordx4 v78, s[52:55], s95 offen offset:2048 nt lds
    s_waitcnt lgkmcnt(9)
    v_pk_add_f32 v[200:201], v[200:201], v[136:137]
    v_pk_add_f32 v[152:153], v[152:153], v[168:169]
    v_pk_add_f32 v[202:203], v[202:203], v[138:139]
    v_pk_add_f32 v[154:155], v[154:155], v[170:171]
    v_pk_add_f32 v[200:201], v[200:201], v[152:153]
    v_pk_add_f32 v[202:203], v[202:203], v[154:155]
    s_waitcnt lgkmcnt(6)
    v_pk_add_f32 v[204:205], v[204:205], v[140:141]
    v_pk_add_f32 v[156:157], v[156:157], v[172:173]
    v_pk_add_f32 v[206:207], v[206:207], v[142:143]
    v_pk_add_f32 v[158:159], v[158:159], v[174:175]
    v_pk_add_f32 v[204:205], v[204:205], v[156:157]
    v_pk_add_f32 v[206:207], v[206:207], v[158:159]
    s_waitcnt lgkmcnt(3)
    v_pk_add_f32 v[208:209], v[208:209], v[144:145]
    v_pk_add_f32 v[160:161], v[160:161], v[176:177]
    v_pk_add_f32 v[210:211], v[210:211], v[146:147]
    v_pk_add_f32 v[162:163], v[162:163], v[178:179]
    v_pk_add_f32 v[208:209], v[208:209], v[160:161]
    v_pk_add_f32 v[210:211], v[210:211], v[162:163]
    s_waitcnt lgkmcnt(0)
    v_pk_add_f32 v[212:213], v[212:213], v[148:149]
    v_pk_add_f32 v[164:165], v[164:165], v[180:181]
    v_pk_add_f32 v[214:215], v[214:215], v[150:151]
    v_pk_add_f32 v[166:167], v[166:167], v[182:183]
    v_pk_add_f32 v[212:213], v[212:213], v[164:165]
    v_pk_add_f32 v[214:215], v[214:215], v[166:167]
    buffer_load_dwordx4 v79, s[52:55], s95 offen offset:3072 nt lds
    s_add_u32 s95, s95, 16384
    s_waitcnt vmcnt(4)
    v_max_f32 v4, v200, v201
    v_max3_f32 v4, v4, v202, v203
    v_max3_f32 v4, v4, v204, v205
    v_max3_f32 v4, v4, v206, v207
    v_max3_f32 v4, v4, v208, v209
    v_max3_f32 v4, v4, v210, v211
    v_max3_f32 v4, v4, v212, v213
    v_max3_f32 v4, v4, v214, v215
    v_mov_b32 v5, v4
    ds_read_b128 v[136:139], v60 offset:0
    ds_read_b128 v[140:143], v61 offset:0
    v_permlane16_swap_b32 v4, v5
    v_max_f32 v4, v4, v5
    v_mov_b32 v5, v4
    ds_read_b128 v[144:147], v62 offset:0
    ds_read_b128 v[148:151], v63 offset:0
    v_permlane32_swap_b32 v4, v5
    v_max_f32 v4, v4, v5
    v_mul_f32 v4, s83, v4
    v_max_f32 v4, v4, v90
    v_sub_f32 v92, v90, v4
    v_exp_f32 v92, v92
    v_mov_b32 v90, v4
    s_add_u32 s39, s56, s62
    s_mov_b32 m0, s39
    s_add_u32 s62, s62, 4096
    s_and_b32 s62, s62, 0x7fff
    buffer_load_dwordx4 v76, s[52:55], s95 offen offset:0 nt lds
    v_pk_fma_f32 v[200:201], v[200:201], s[60:61], v[90:91] op_sel_hi:[1,1,0] neg_lo:[0,0,1] neg_hi:[0,0,1]
    v_pk_fma_f32 v[202:203], v[202:203], s[60:61], v[90:91] op_sel_hi:[1,1,0] neg_lo:[0,0,1] neg_hi:[0,0,1]
    v_pk_fma_f32 v[204:205], v[204:205], s[60:61], v[90:91] op_sel_hi:[1,1,0] neg_lo:[0,0,1] neg_hi:[0,0,1]
    v_pk_fma_f32 v[206:207], v[206:207], s[60:61], v[90:91] op_sel_hi:[1,1,0] neg_lo:[0,0,1] neg_hi:[0,0,1]
    v_pk_fma_f32 v[208:209], v[208:209], s[60:61], v[90:91] op_sel_hi:[1,1,0] neg_lo:[0,0,1] neg_hi:[0,0,1]
    v_pk_fma_f32 v[210:211], v[210:211], s[60:61], v[90:91] op_sel_hi:[1,1,0] neg_lo:[0,0,1] neg_hi:[0,0,1]
    v_pk_fma_f32 v[212:213], v[212:213], s[60:61], v[90:91] op_sel_hi:[1,1,0] neg_lo:[0,0,1] neg_hi:[0,0,1]
    v_pk_fma_f32 v[214:215], v[214:215], s[60:61], v[90:91] op_sel_hi:[1,1,0] neg_lo:[0,0,1] neg_hi:[0,0,1]
    v_exp_f32 v200, v200
    v_exp_f32 v201, v201
    ds_read_b128 v[152:155], v60 offset:4096
    v_exp_f32 v202, v202
    v_exp_f32 v203, v203
    v_exp_f32 v204, v204
    v_exp_f32 v205, v205
    ds_read_b128 v[156:159], v61 offset:4096
    v_exp_f32 v206, v206
    v_exp_f32 v207, v207
    buffer_load_dwordx4 v77, s[52:55], s95 offen offset:1024 nt lds
    v_exp_f32 v208, v208
    v_exp_f32 v209, v209
    ds_read_b128 v[160:163], v62 offset:4096
    v_exp_f32 v210, v210
    v_exp_f32 v211, v211
    v_exp_f32 v212, v212
    v_exp_f32 v213, v213
    ds_read_b128 v[164:167], v63 offset:4096
    v_exp_f32 v214, v214
    v_exp_f32 v215, v215
    buffer_load_dwordx4 v78, s[52:55], s95 offen offset:2048 nt lds
    v_pk_mul_f32 v[102:103], v[102:103], v[92:93] op_sel_hi:[1,0]
    v_pk_mul_f32 v[104:105], v[104:105], v[92:93] op_sel_hi:[1,0]
    v_pk_mul_f32 v[106:107], v[106:107], v[92:93] op_sel_hi:[1,0]
    v_pk_mul_f32 v[108:109], v[108:109], v[92:93] op_sel_hi:[1,0]
    v_pk_mul_f32 v[110:111], v[110:111], v[92:93] op_sel_hi:[1,0]
    v_pk_mul_f32 v[112:113], v[112:113], v[92:93] op_sel_hi:[1,0]
    v_pk_mul_f32 v[114:115], v[114:115], v[92:93] op_sel_hi:[1,0]
    v_pk_mul_f32 v[116:117], v[116:117], v[92:93] op_sel_hi:[1,0]
    v_pk_mul_f32 v[118:119], v[118:119], v[92:93] op_sel_hi:[1,0]
    v_pk_mul_f32 v[120:121], v[120:121], v[92:93] op_sel_hi:[1,0]
    v_pk_mul_f32 v[122:123], v[122:123], v[92:93] op_sel_hi:[1,0]
    v_pk_mul_f32 v[124:125], v[124:125], v[92:93] op_sel_hi:[1,0]
    v_pk_mul_f32 v[126:127], v[126:127], v[92:93] op_sel_hi:[1,0]
    v_pk_mul_f32 v[128:129], v[128:129], v[92:93] op_sel_hi:[1,0]
    v_pk_mul_f32 v[130:131], v[130:131], v[92:93] op_sel_hi:[1,0]
    v_pk_mul_f32 v[132:133], v[132:133], v[92:93] op_sel_hi:[1,0]
    v_pk_mul_f32 v[134:135], v[134:135], v[92:93] op_sel_hi:[1,0]
    buffer_load_dwordx4 v79, s[52:55], s95 offen offset:3072 nt lds
    s_add_u32 s95, s95, 16384
    v_cvt_pk_bf16_f32 v52, v200, v201
    v_pk_add_f32 v[102:103], v[102:103], v[200:201]
    v_cvt_pk_bf16_f32 v53, v202, v203
    v_pk_add_f32 v[102:103], v[102:103], v[202:203]
    v_cvt_pk_bf16_f32 v54, v204, v205
    v_pk_add_f32 v[102:103], v[102:103], v[204:205]
    v_cvt_pk_bf16_f32 v55, v206, v207
    v_pk_add_f32 v[102:103], v[102:103], v[206:207]
    v_cvt_pk_bf16_f32 v56, v208, v209
    v_pk_add_f32 v[102:103], v[102:103], v[208:209]
    v_cvt_pk_bf16_f32 v57, v210, v211
    v_pk_add_f32 v[102:103], v[102:103], v[210:211]
    v_cvt_pk_bf16_f32 v58, v212, v213
    v_pk_add_f32 v[102:103], v[102:103], v[212:213]
    v_cvt_pk_bf16_f32 v59, v214, v215
    v_pk_add_f32 v[102:103], v[102:103], v[214:215]
    v_mfma_f32_16x16x32_bf16 v[104:107], a[0:3], v[52:55], v[104:107]
    ds_read_b128 v[168:171], v60 offset:8192
    v_mfma_f32_16x16x32_bf16 v[108:111], a[4:7], v[52:55], v[108:111]
    ds_read_b128 v[172:175], v61 offset:8192
    v_mfma_f32_16x16x32_bf16 v[112:115], a[8:11], v[52:55], v[112:115]
    ds_read_b128 v[176:179], v62 offset:8192
    v_mfma_f32_16x16x32_bf16 v[116:119], a[12:15], v[52:55], v[116:119]
    ds_read_b128 v[180:183], v63 offset:8192
    v_mfma_f32_16x16x32_bf16 v[120:123], a[16:19], v[52:55], v[120:123]
    ds_read_b128 v[184:187], v60 offset:12288
    v_mfma_f32_16x16x32_bf16 v[124:127], a[20:23], v[52:55], v[124:127]
    ds_read_b128 v[188:191], v61 offset:12288
    v_mfma_f32_16x16x32_bf16 v[128:131], a[24:27], v[52:55], v[128:131]
    ds_read_b128 v[192:195], v62 offset:12288
    v_mfma_f32_16x16x32_bf16 v[132:135], a[28:31], v[52:55], v[132:135]
    ds_read_b128 v[196:199], v63 offset:12288
    v_mfma_f32_16x16x32_bf16 v[104:107], a[32:35], v[56:59], v[104:107]
    v_mfma_f32_16x16x32_bf16 v[108:111], a[36:39], v[56:59], v[108:111]
    s_add_u32 s39, s56, s62
    s_mov_b32 m0, s39
    s_add_u32 s62, s62, 4096
    s_and_b32 s62, s62, 0x7fff
    buffer_load_dwordx4 v76, s[52:55], s95 offen offset:0 nt lds
    v_mfma_f32_16x16x32_bf16 v[112:115], a[40:43], v[56:59], v[112:115]
    v_mfma_f32_16x16x32_bf16 v[116:119], a[44:47], v[56:59], v[116:119]
    v_mfma_f32_16x16x32_bf16 v[120:123], a[48:51], v[56:59], v[120:123]
    v_mfma_f32_16x16x32_bf16 v[124:127], a[52:55], v[56:59], v[124:127]
    buffer_load_dwordx4 v77, s[52:55], s95 offen offset:1024 nt lds
    v_mfma_f32_16x16x32_bf16 v[128:131], a[56:59], v[56:59], v[128:131]
    v_mfma_f32_16x16x32_bf16 v[132:135], a[60:63], v[56:59], v[132:135]
    s_add_u32 s93, s93, 1
    s_cmp_lt_u32 s93, 16
    s_cbranch_scc1 L_att
    v_add_f32 v91, v102, v103
    v_mov_b32 v5, v91
    s_nop 1
    v_permlane16_swap_b32 v91, v5
    v_add_f32 v91, v91, v5
    v_mov_b32 v5, v91
    s_nop 1
    v_permlane32_swap_b32 v91, v5
    v_add_f32 v91, v91, v5
    v_lshrrev_b32 v6, 1, v2
    v_xor_b32 v6, v6, v3
    v_lshlrev_b32 v5, 8, v3
    v_lshl_add_u32 v5, v6, 4, v5
    v_bfe_u32 v4, v2, 0, 1
    v_lshl_add_u32 v5, v4, 3, v5
    v_add_u32 v5, s85, v5
    s_waitcnt vmcnt(0) lgkmcnt(0)
    s_barrier
    v_cvt_pk_bf16_f32 v216, v104, v105
    v_cvt_pk_bf16_f32 v217, v106, v107
    v_xor_b32 v82, 0, v5
    ds_write_b64 v82, v[216:217]
    v_cvt_pk_bf16_f32 v218, v108, v109
    v_cvt_pk_bf16_f32 v219, v110, v111
    v_xor_b32 v83, 32, v5
    ds_write_b64 v83, v[218:219]
    v_cvt_pk_bf16_f32 v220, v112, v113
    v_cvt_pk_bf16_f32 v221, v114, v115
    v_xor_b32 v84, 64, v5
    ds_write_b64 v84, v[220:221]
    v_cvt_pk_bf16_f32 v222, v116, v117
    v_cvt_pk_bf16_f32 v223, v118, v119
    v_xor_b32 v85, 96, v5
    ds_write_b64 v85, v[222:223]
    v_cvt_pk_bf16_f32 v224, v120, v121
    v_cvt_pk_bf16_f32 v225, v122, v123
    v_xor_b32 v86, 128, v5
    ds_write_b64 v86, v[224:225]
    v_cvt_pk_bf16_f32 v226, v124, v125
    v_cvt_pk_bf16_f32 v227, v126, v127
    v_xor_b32 v87, 160, v5
    ds_write_b64 v87, v[226:227]
    v_cvt_pk_bf16_f32 v228, v128, v129
    v_cvt_pk_bf16_f32 v229, v130, v131
    v_xor_b32 v88, 192, v5
    ds_write_b64 v88, v[228:229]
    v_cvt_pk_bf16_f32 v230, v132, v133
    v_cvt_pk_bf16_f32 v231, v134, v135
    v_xor_b32 v89, 224, v5
    ds_write_b64 v89, v[230:231]
    v_xor_b32 v6, v3, v2
    v_lshlrev_b32 v6, 4, v6
    v_lshl_add_u32 v4, v2, 8, v6
    v_add_u32 v4, s85, v4
    v_xor_b32 v60, 0, v4
    v_xor_b32 v61, 64, v4
    v_xor_b32 v62, 128, v4
    v_xor_b32 v63, 192, v4
    v_lshlrev_b32 v7, 4, v3
    v_lshl_add_u32 v7, v2, 14, v7
    s_lshl_b32 s38, s94, 18
    s_add_u32 s36, s38, 2097152
    s_lshl_b32 s38, s3, 10
    s_add_u32 s36, s38, s36
    s_lshl_b32 s38, s34, 8
    s_add_u32 s36, s38, s36
    s_waitcnt lgkmcnt(0)
    ds_read_b128 v[200:203], v60 offset:0
    ds_read_b128 v[204:207], v61 offset:1024
    ds_read_b128 v[208:211], v62 offset:2048
    ds_read_b128 v[212:215], v63 offset:3072
    v_lshlrev_b32 v4, 3, v3
    s_lshl_b32 s38, s3, 8
    s_add_u32 s37, s38, 163840
    s_lshl_b32 s38, s94, 7
    s_add_u32 s37, s38, s37
    s_lshl_b32 s38, s34, 23
    s_add_u32 s37, s38, s37
    s_mov_b32 exec_lo, 0xffff
    s_mov_b32 exec_hi, 0x0
    buffer_store_dwordx2 v[90:91], v4, s[48:51], s37 offen sc1
    s_mov_b64 exec, -1
    s_waitcnt lgkmcnt(3)
    buffer_store_dwordx4 v[200:203], v7, s[48:51], s36 offen sc1
    s_add_u32 s36, s36, 65536
    s_waitcnt lgkmcnt(2)
    buffer_store_dwordx4 v[204:207], v7, s[48:51], s36 offen sc1
    s_add_u32 s36, s36, 65536
    s_waitcnt lgkmcnt(1)
    buffer_store_dwordx4 v[208:211], v7, s[48:51], s36 offen sc1
    s_add_u32 s36, s36, 65536
    s_waitcnt lgkmcnt(0)
    buffer_store_dwordx4 v[212:215], v7, s[48:51], s36 offen sc1
    s_bfe_u32 s38, s2, 0x20001
    s_lshl_b32 s38, s38, 0
    s_add_u32 s90, s38, 0
    s_bfe_u32 s38, s2, 0x10000
    s_lshl_b32 s38, s38, 2
    s_add_u32 s90, s38, s90
    s_and_b32 s36, s90, 3
    s_bitcmp0_b32 s90, 2
    s_cselect_b64 s[40:41], s[24:25], s[14:15]
    s_cselect_b32 s45, 262144, 0
    s_add_u32 s45, s45, 524288
    s_lshl_b32 s38, s36, 16
    s_add_u32 s71, s38, s45
    s_lshr_b32 s38, s32, 2
    s_lshl_b32 s38, s38, 13
    s_add_u32 s71, s38, s71
    s_bfe_u32 s38, s32, 0x20000
    s_lshl_b32 s38, s38, 6
    s_add_u32 s71, s38, s71
    s_mov_b32 s42, 4194304
    s_mov_b32 s43, 0x20000
    s_lshl_b32 s38, s32, 17
    s_add_u32 s44, s38, 0
    s_lshl_b32 s38, s34, 15
    s_add_u32 s44, s38, s44
    s_lshl_b32 s38, s36, 8
    s_add_u32 s44, s38, s44
    s_lshl_b32 s38, s36, 16
    s_add_u32 s45, s38, s45
    s_lshr_b32 s38, s34, 1
    s_lshl_b32 s38, s38, 15
    s_add_u32 s45, s38, s45
    s_lshl_b32 s38, s32, 8
    s_add_u32 s45, s38, s45
    s_bfe_u32 s38, s34, 0x10000
    s_lshl_b32 s38, s38, 7
    s_add_u32 s45, s38, s45
    s_lshl_b32 s38, s32, 11
    s_add_u32 s46, s38, 196608
    s_lshl_b32 s38, s34, 9
    s_add_u32 s46, s38, s46
    s_mov_b32 s72, s26
    s_and_b32 s73, s27, 0xffff
    s_mov_b32 s74, 8192
    s_mov_b32 s75, 0x20000
    v_lshlrev_b32 v30, 4, v3
    v_lshl_add_u32 v30, v2, 13, v30
    v_lshrrev_b32 v5, 2, v1
    v_lshlrev_b32 v32, 8, v5
    v_bfe_u32 v5, v1, 0, 2
    v_lshl_add_u32 v32, v5, 4, v32
    s_xor_b32 s37, s90, 4
    s_bfe_u32 s38, s37, 0x30000
    s_lshl_b32 s38, s38, 8
    s_add_u32 s36, s38, 0
    s_lshr_b32 s38, s32, 4
    s_lshl_b32 s38, s38, 7
    s_add_u32 s36, s38, s36
    s_bfe_u32 s38, s32, 0x20000
    s_lshl_b32 s38, s38, 5
    s_add_u32 s36, s38, s36
    s_bfe_u32 s38, s32, 0x20002
    s_lshl_b32 s38, s38, 3
    s_add_u32 s36, s38, s36
    v_bfe_u32 v5, v1, 0, 2
    v_lshlrev_b32 v33, 11, v5
    v_lshl_add_u32 v33, v2, 1, v33
    v_add_u32 v33, s36, v33
    v_and_b32 v5, 31, v1
    v_lshlrev_b32 v34, 4, v5
    s_mul_i32 s38, s34, 320
    s_add_u32 s38, s38, 135168
    v_lshl_add_u32 v35, v5, 3, s38
    s_bfe_u32 s38, s34, 0x10000
    s_lshl_b32 s38, s38, 12
    s_add_u32 s36, s38, s71
    s_lshr_b32 s38, s34, 1
    s_lshl_b32 s38, s38, 24
    s_add_u32 s36, s38, s36
    s_bitcmp1_b32 s90, 2
    s_cselect_b32 s46, s46, s36
    s_cselect_b64 vcc, -1, 0
    v_cndmask_b32 v54, v32, v34, vcc
    s_bfe_u32 s38, s2, 0x30000
    s_lshl_b32 s38, s38, 8
    s_add_u32 s69, s38, 32768
    v_lshrrev_b32 v64, 2, v34
    buffer_load_dword v64, v64, s[48:51], s69 offen sc1
    v_bfe_u32 v5, v3, 0, 2
    v_lshlrev_b32 v81, 10, v5
    v_lshrrev_b32 v5, 2, v3
    v_lshl_add_u32 v81, v5, 8, v81
    v_add3_u32 v82, v81, v6, s85
    v_xor_b32 v83, 64, v82
    v_xor_b32 v84, 128, v82
    v_xor_b32 v85, 192, v82
    v_bfe_u32 v5, v3, 0, 2
    v_lshlrev_b32 v94, 9, v5
    v_lshl_add_u32 v94, v2, 4, v94
    v_add_u32 v94, s85, v94
    s_lshl_b32 s38, s34, 9
    s_add_u32 s38, s38, 131072
    v_add_u32 v102, s38, v34
    s_lshl_b32 s38, s32, 14
    s_add_u32 s36, s38, 2097152
    s_lshl_b32 s38, s34, 8
    s_add_u32 s36, s38, s36
    s_lshl_b32 s38, s32, 3
    s_add_u32 s37, s38, 163840
    s_lshl_b32 s38, s32, 8
    s_add_u32 s69, s38, 131072
    s_lshl_b32 s38, s34, 23
    s_add_u32 s69, s38, s69
    v_mov_b32 v4, s69
    v_mov_b32 v5, s68
    s_waitcnt vmcnt(1)
    s_barrier
    s_mov_b64 exec, 1
    buffer_store_dword v5, v4, s[48:51], 0 offen sc1
    s_mov_b64 exec, -1
    s_mov_b32 s86, 131072
    buffer_load_dword v7, v101, s[48:51], s86 offen sc1
    s_waitcnt vmcnt(0)
L_fcheck_47:
    v_cmp_ne_u32 vcc, s68, v7
    s_cbranch_vccz L_fok_48
    s_sleep 2
    s_mov_b32 s86, 131072
    buffer_load_dword v7, v101, s[48:51], s86 offen sc1
    s_waitcnt vmcnt(0)
    s_sub_u32 s84, s84, 1
    s_cmp_lg_u32 s84, 0
    s_cbranch_scc1 L_fcheck_47
    s_branch L_end
L_fok_48:
    buffer_load_dwordx2 v[52:53], v81, s[48:51], s37 offen sc1
    buffer_load_dwordx4 v[200:203], v9, s[48:51], s36 offen sc1
    s_add_u32 s36, s36, 4096
    buffer_load_dwordx4 v[204:207], v9, s[48:51], s36 offen sc1
    s_add_u32 s36, s36, 4096
    buffer_load_dwordx4 v[208:211], v9, s[48:51], s36 offen sc1
    s_add_u32 s36, s36, 4096
    buffer_load_dwordx4 v[212:215], v9, s[48:51], s36 offen sc1
    s_waitcnt vmcnt(4)
    v_max_f32_dpp v4, v52, v52 row_ror:8 row_mask:0xf bank_mask:0xf
    s_nop 1
    v_max_f32_dpp v4, v4, v4 row_ror:4 row_mask:0xf bank_mask:0xf
    v_sub_f32 v52, v52, v4
    v_exp_f32 v52, v52
    s_nop 0
    v_mul_f32 v5, v52, v53
    s_nop 1
    v_add_f32_dpp v5, v5, v5 row_ror:8 row_mask:0xf bank_mask:0xf
    s_nop 1
    v_add_f32_dpp v5, v5, v5 row_ror:4 row_mask:0xf bank_mask:0xf
    v_rcp_f32 v5, v5
    s_nop 0
    v_mul_f32 v52, v52, v5
    s_waitcnt vmcnt(3)
    ds_write_b128 v96, v[200:203] offset:0
    s_waitcnt vmcnt(2)
    ds_write_b128 v97, v[204:207] offset:1024
    s_waitcnt vmcnt(1)
    ds_write_b128 v98, v[208:211] offset:2048
    s_waitcnt vmcnt(0)
    ds_write_b128 v99, v[212:215] offset:3072
    s_waitcnt lgkmcnt(0)
    ds_read_b128 v[136:139], v82
    ds_read_b128 v[140:143], v83
    ds_read_b128 v[144:147], v84
    ds_read_b128 v[148:151], v85
    s_waitcnt lgkmcnt(0)
    v_mfma_f32_16x16x32_bf16 v[104:107], a[128:131], v[136:139], 0
    v_mfma_f32_16x16x32_bf16 v[104:107], a[132:135], v[140:143], v[104:107]
    v_mfma_f32_16x16x32_bf16 v[104:107], a[136:139], v[144:147], v[104:107]
    v_mfma_f32_16x16x32_bf16 v[104:107], a[140:143], v[148:151], v[104:107]
    v_mfma_f32_16x16x32_bf16 v[108:111], a[144:147], v[136:139], 0
    v_mfma_f32_16x16x32_bf16 v[108:111], a[148:151], v[140:143], v[108:111]
    v_mfma_f32_16x16x32_bf16 v[108:111], a[152:155], v[144:147], v[108:111]
    v_mfma_f32_16x16x32_bf16 v[108:111], a[156:159], v[148:151], v[108:111]
    v_mfma_f32_16x16x32_bf16 v[112:115], a[160:163], v[136:139], 0
    v_mfma_f32_16x16x32_bf16 v[112:115], a[164:167], v[140:143], v[112:115]
    v_mfma_f32_16x16x32_bf16 v[112:115], a[168:171], v[144:147], v[112:115]
    v_mfma_f32_16x16x32_bf16 v[112:115], a[172:175], v[148:151], v[112:115]
    v_mul_f32 v104, v104, v52
    v_mul_f32 v105, v105, v52
    v_mul_f32 v106, v106, v52
    v_mul_f32 v107, v107, v52
    v_add_f32_dpp v104, v104, v104 row_ror:8 row_mask:0xf bank_mask:0xf
    v_add_f32_dpp v105, v105, v105 row_ror:8 row_mask:0xf bank_mask:0xf
    v_add_f32_dpp v106, v106, v106 row_ror:8 row_mask:0xf bank_mask:0xf
    v_add_f32_dpp v107, v107, v107 row_ror:8 row_mask:0xf bank_mask:0xf
    v_add_f32_dpp v104, v104, v104 row_ror:4 row_mask:0xf bank_mask:0xf
    v_add_f32_dpp v105, v105, v105 row_ror:4 row_mask:0xf bank_mask:0xf
    v_add_f32_dpp v106, v106, v106 row_ror:4 row_mask:0xf bank_mask:0xf
    v_add_f32_dpp v107, v107, v107 row_ror:4 row_mask:0xf bank_mask:0xf
    ds_write_b128 v94, v[104:107] offset:0
    v_mfma_f32_16x16x32_bf16 v[116:119], a[176:179], v[136:139], 0
    v_mfma_f32_16x16x32_bf16 v[116:119], a[180:183], v[140:143], v[116:119]
    v_mfma_f32_16x16x32_bf16 v[116:119], a[184:187], v[144:147], v[116:119]
    v_mfma_f32_16x16x32_bf16 v[116:119], a[188:191], v[148:151], v[116:119]
    v_mul_f32 v108, v108, v52
    v_mul_f32 v109, v109, v52
    v_mul_f32 v110, v110, v52
    v_mul_f32 v111, v111, v52
    v_add_f32_dpp v108, v108, v108 row_ror:8 row_mask:0xf bank_mask:0xf
    v_add_f32_dpp v109, v109, v109 row_ror:8 row_mask:0xf bank_mask:0xf
    v_add_f32_dpp v110, v110, v110 row_ror:8 row_mask:0xf bank_mask:0xf
    v_add_f32_dpp v111, v111, v111 row_ror:8 row_mask:0xf bank_mask:0xf
    v_add_f32_dpp v108, v108, v108 row_ror:4 row_mask:0xf bank_mask:0xf
    v_add_f32_dpp v109, v109, v109 row_ror:4 row_mask:0xf bank_mask:0xf
    v_add_f32_dpp v110, v110, v110 row_ror:4 row_mask:0xf bank_mask:0xf
    v_add_f32_dpp v111, v111, v111 row_ror:4 row_mask:0xf bank_mask:0xf
    ds_write_b128 v94, v[108:111] offset:64
    v_mfma_f32_16x16x32_bf16 v[120:123], a[192:195], v[136:139], 0
    v_mfma_f32_16x16x32_bf16 v[120:123], a[196:199], v[140:143], v[120:123]
    v_mfma_f32_16x16x32_bf16 v[120:123], a[200:203], v[144:147], v[120:123]
    v_mfma_f32_16x16x32_bf16 v[120:123], a[204:207], v[148:151], v[120:123]
    v_mul_f32 v112, v112, v52
    v_mul_f32 v113, v113, v52
    v_mul_f32 v114, v114, v52
    v_mul_f32 v115, v115, v52
    v_add_f32_dpp v112, v112, v112 row_ror:8 row_mask:0xf bank_mask:0xf
    v_add_f32_dpp v113, v113, v113 row_ror:8 row_mask:0xf bank_mask:0xf
    v_add_f32_dpp v114, v114, v114 row_ror:8 row_mask:0xf bank_mask:0xf
    v_add_f32_dpp v115, v115, v115 row_ror:8 row_mask:0xf bank_mask:0xf
    v_add_f32_dpp v112, v112, v112 row_ror:4 row_mask:0xf bank_mask:0xf
    v_add_f32_dpp v113, v113, v113 row_ror:4 row_mask:0xf bank_mask:0xf
    v_add_f32_dpp v114, v114, v114 row_ror:4 row_mask:0xf bank_mask:0xf
    v_add_f32_dpp v115, v115, v115 row_ror:4 row_mask:0xf bank_mask:0xf
    ds_write_b128 v94, v[112:115] offset:128
    v_mfma_f32_16x16x32_bf16 v[124:127], a[208:211], v[136:139], 0
    v_mfma_f32_16x16x32_bf16 v[124:127], a[212:215], v[140:143], v[124:127]
    v_mfma_f32_16x16x32_bf16 v[124:127], a[216:219], v[144:147], v[124:127]
    v_mfma_f32_16x16x32_bf16 v[124:127], a[220:223], v[148:151], v[124:127]
    v_mul_f32 v116, v116, v52
    v_mul_f32 v117, v117, v52
    v_mul_f32 v118, v118, v52
    v_mul_f32 v119, v119, v52
    v_add_f32_dpp v116, v116, v116 row_ror:8 row_mask:0xf bank_mask:0xf
    v_add_f32_dpp v117, v117, v117 row_ror:8 row_mask:0xf bank_mask:0xf
    v_add_f32_dpp v118, v118, v118 row_ror:8 row_mask:0xf bank_mask:0xf
    v_add_f32_dpp v119, v119, v119 row_ror:8 row_mask:0xf bank_mask:0xf
    v_add_f32_dpp v116, v116, v116 row_ror:4 row_mask:0xf bank_mask:0xf
    v_add_f32_dpp v117, v117, v117 row_ror:4 row_mask:0xf bank_mask:0xf
    v_add_f32_dpp v118, v118, v118 row_ror:4 row_mask:0xf bank_mask:0xf
    v_add_f32_dpp v119, v119, v119 row_ror:4 row_mask:0xf bank_mask:0xf
    ds_write_b128 v94, v[116:119] offset:192
    v_mfma_f32_16x16x32_bf16 v[128:131], a[224:227], v[136:139], 0
    v_mfma_f32_16x16x32_bf16 v[128:131], a[228:231], v[140:143], v[128:131]
    v_mfma_f32_16x16x32_bf16 v[128:131], a[232:235], v[144:147], v[128:131]
    v_mfma_f32_16x16x32_bf16 v[128:131], a[236:239], v[148:151], v[128:131]
    v_mul_f32 v120, v120, v52
    v_mul_f32 v121, v121, v52
    v_mul_f32 v122, v122, v52
    v_mul_f32 v123, v123, v52
    v_add_f32_dpp v120, v120, v120 row_ror:8 row_mask:0xf bank_mask:0xf
    v_add_f32_dpp v121, v121, v121 row_ror:8 row_mask:0xf bank_mask:0xf
    v_add_f32_dpp v122, v122, v122 row_ror:8 row_mask:0xf bank_mask:0xf
    v_add_f32_dpp v123, v123, v123 row_ror:8 row_mask:0xf bank_mask:0xf
    v_add_f32_dpp v120, v120, v120 row_ror:4 row_mask:0xf bank_mask:0xf
    v_add_f32_dpp v121, v121, v121 row_ror:4 row_mask:0xf bank_mask:0xf
    v_add_f32_dpp v122, v122, v122 row_ror:4 row_mask:0xf bank_mask:0xf
    v_add_f32_dpp v123, v123, v123 row_ror:4 row_mask:0xf bank_mask:0xf
    ds_write_b128 v94, v[120:123] offset:256
    v_mfma_f32_16x16x32_bf16 v[132:135], a[240:243], v[136:139], 0
    v_mfma_f32_16x16x32_bf16 v[132:135], a[244:247], v[140:143], v[132:135]
    v_mfma_f32_16x16x32_bf16 v[132:135], a[248:251], v[144:147], v[132:135]
    v_mfma_f32_16x16x32_bf16 v[132:135], a[252:255], v[148:151], v[132:135]
    v_mul_f32 v124, v124, v52
    v_mul_f32 v125, v125, v52
    v_mul_f32 v126, v126, v52
    v_mul_f32 v127, v127, v52
    v_add_f32_dpp v124, v124, v124 row_ror:8 row_mask:0xf bank_mask:0xf
    v_add_f32_dpp v125, v125, v125 row_ror:8 row_mask:0xf bank_mask:0xf
    v_add_f32_dpp v126, v126, v126 row_ror:8 row_mask:0xf bank_mask:0xf
    v_add_f32_dpp v127, v127, v127 row_ror:8 row_mask:0xf bank_mask:0xf
    v_add_f32_dpp v124, v124, v124 row_ror:4 row_mask:0xf bank_mask:0xf
    v_add_f32_dpp v125, v125, v125 row_ror:4 row_mask:0xf bank_mask:0xf
    v_add_f32_dpp v126, v126, v126 row_ror:4 row_mask:0xf bank_mask:0xf
    v_add_f32_dpp v127, v127, v127 row_ror:4 row_mask:0xf bank_mask:0xf
    ds_write_b128 v94, v[124:127] offset:320
    v_mul_f32 v128, v128, v52
    v_mul_f32 v129, v129, v52
    v_mul_f32 v130, v130, v52
    v_mul_f32 v131, v131, v52
    v_add_f32_dpp v128, v128, v128 row_ror:8 row_mask:0xf bank_mask:0xf
    v_add_f32_dpp v129, v129, v129 row_ror:8 row_mask:0xf bank_mask:0xf
    v_add_f32_dpp v130, v130, v130 row_ror:8 row_mask:0xf bank_mask:0xf
    v_add_f32_dpp v131, v131, v131 row_ror:8 row_mask:0xf bank_mask:0xf
    v_add_f32_dpp v128, v128, v128 row_ror:4 row_mask:0xf bank_mask:0xf
    v_add_f32_dpp v129, v129, v129 row_ror:4 row_mask:0xf bank_mask:0xf
    v_add_f32_dpp v130, v130, v130 row_ror:4 row_mask:0xf bank_mask:0xf
    v_add_f32_dpp v131, v131, v131 row_ror:4 row_mask:0xf bank_mask:0xf
    ds_write_b128 v94, v[128:131] offset:384
    v_mul_f32 v132, v132, v52
    v_mul_f32 v133, v133, v52
    v_mul_f32 v134, v134, v52
    v_mul_f32 v135, v135, v52
    v_add_f32_dpp v132, v132, v132 row_ror:8 row_mask:0xf bank_mask:0xf
    v_add_f32_dpp v133, v133, v133 row_ror:8 row_mask:0xf bank_mask:0xf
    v_add_f32_dpp v134, v134, v134 row_ror:8 row_mask:0xf bank_mask:0xf
    v_add_f32_dpp v135, v135, v135 row_ror:8 row_mask:0xf bank_mask:0xf
    v_add_f32_dpp v132, v132, v132 row_ror:4 row_mask:0xf bank_mask:0xf
    v_add_f32_dpp v133, v133, v133 row_ror:4 row_mask:0xf bank_mask:0xf
    v_add_f32_dpp v134, v134, v134 row_ror:4 row_mask:0xf bank_mask:0xf
    v_add_f32_dpp v135, v135, v135 row_ror:4 row_mask:0xf bank_mask:0xf
    ds_write_b128 v94, v[132:135] offset:448
    s_waitcnt lgkmcnt(0)
    s_barrier
    ds_read_b128 v[136:139], v102 offset:0
    ds_read_b128 v[140:143], v102 offset:8192
    ds_read_b128 v[144:147], v102 offset:16384
    ds_read_b128 v[148:151], v102 offset:24576
    s_waitcnt lgkmcnt(0)
    v_add_f32 v136, v136, v140
    v_add_f32 v144, v144, v148
    v_add_f32 v137, v137, v141
    v_add_f32 v145, v145, v149
    v_add_f32 v138, v138, v142
    v_add_f32 v146, v146, v150
    v_add_f32 v139, v139, v143
    v_add_f32 v147, v147, v151
    v_add_f32 v136, v136, v144
    v_add_f32 v137, v137, v145
    v_add_f32 v138, v138, v146
    v_add_f32 v139, v139, v147
    s_mov_b32 s38, 0xffff0000
    v_cvt_pk_bf16_f32 v136, v136, v136
    v_cvt_pk_bf16_f32 v137, v137, v137
    v_cvt_pk_bf16_f32 v138, v138, v138
    v_cvt_pk_bf16_f32 v139, v139, v139
    v_and_or_b32 v136, v136, s38, v8
    v_and_or_b32 v137, v137, s38, v8
    v_and_or_b32 v138, v138, s38, v8
    v_and_or_b32 v139, v139, s38, v8
    s_lshl_b32 s38, s32, 11
    s_add_u32 s36, s38, 196608
    s_lshl_b32 s38, s34, 9
    s_add_u32 s36, s38, s36
    s_mov_b32 exec_lo, 0xffffffff
    s_mov_b32 exec_hi, 0x0
    buffer_store_dwordx4 v[136:139], v34, s[48:51], s36 offen sc1
    s_mov_b64 exec, -1
    v_xor_b32 v224, s35, v136
    v_xor_b32 v225, s35, v137
    v_xor_b32 v226, s35, v138
    v_xor_b32 v227, s35, v139
    v_lshlrev_b32 v4, 11, v2
    v_bfe_u32 v5, v1, 2, 2
    v_lshl_add_u32 v4, v5, 8, v4
    v_bfe_u32 v5, v1, 2, 2
    v_lshl_add_u32 v4, v5, 6, v4
    v_bfe_u32 v5, v1, 4, 1
    v_lshl_add_u32 v4, v5, 5, v4
    v_bfe_u32 v5, v1, 1, 1
    v_lshl_add_u32 v4, v5, 4, v4
    v_bfe_u32 v5, v1, 0, 1
    v_lshl_add_u32 v4, v5, 3, v4
    s_lshl_b32 s38, s34, 6
    s_add_u32 s38, s38, 98304
    v_xor_b32 v24, s38, v4
    v_xor_b32 v25, 16, v24
    v_xor_b32 v26, 32, v24
    v_xor_b32 v27, 48, v24
    v_and_b32 v4, 3, v3
    v_lshrrev_b32 v5, 2, v3
    v_lshlrev_b32 v6, 4, v2
    v_add_u32 v6, 135168, v6
    s_movk_i32 s36, 320
    v_cmp_eq_u32 vcc, 0, v5
    s_nop 1
    v_cndmask_b32 v28, 4, v4, vcc
    v_mad_u32_u24 v28, v28, s36, v6
    v_cmp_eq_u32 vcc, 1, v5
    s_nop 1
    v_cndmask_b32 v29, 4, v4, vcc
    v_mad_u32_u24 v29, v29, s36, v6
    v_lshlrev_b32 v5, 2, v1
    v_add_u32 v5, 136448, v5
    v_mov_b32 v6, 0
    ds_write_b32 v5, v6
    v_cmp_ne_u32 vcc, s70, v64
    s_nop 0
    s_cmp_eq_u64 vcc, 0
    s_cselect_b32 s70, 1, 0
    s_mov_b32 s3, s34
    v_lshlrev_b32 v4, 2, v2
    v_xor_b32 v4, v4, v3
    v_xor_b32 v5, 0, v4
    v_lshlrev_b32 v5, 4, v5
    v_lshl_add_u32 v20, v2, 10, v5
    v_xor_b32 v5, 1, v4
    v_lshlrev_b32 v5, 4, v5
    v_lshl_add_u32 v21, v2, 10, v5
    v_add_u32 v21, 3072, v21
    v_xor_b32 v5, 2, v4
    v_lshlrev_b32 v5, 4, v5
    v_lshl_add_u32 v22, v2, 10, v5
    v_add_u32 v22, 6144, v22
    v_xor_b32 v5, 3, v4
    v_lshlrev_b32 v5, 4, v5
    v_lshl_add_u32 v23, v2, 10, v5
    v_add_u32 v23, 9216, v23
    s_lshl_b32 s38, s32, 15
    s_add_u32 s47, s38, 1048576
    s_lshl_b32 s38, s3, 13
    s_add_u32 s47, s38, s47
    v_lshlrev_b32 v6, 7, v2
    v_bfe_u32 v5, v3, 0, 3
    v_lshl_add_u32 v6, v5, 4, v6
    v_lshrrev_b32 v4, 3, v3
    v_and_b32 v7, 3, v3
    v_min_u32 v7, 2, v7
    v_lshl_add_u32 v7, v7, 1, v4
    v_add_u32 v5, 0, v4
    v_cmp_le_u32 vcc, s33, v5
    s_nop 1
    v_addc_co_u32 v5, vcc, 0, v5, vcc
    v_lshl_add_u32 v50, v5, 10, v6
    v_add_u32 v5, 2, v4
    v_cmp_le_u32 vcc, s33, v5
    s_nop 1
    v_addc_co_u32 v5, vcc, 0, v5, vcc
    v_lshl_add_u32 v51, v5, 10, v6
    v_add_u32 v5, 4, v4
    v_cmp_le_u32 vcc, s33, v5
    s_nop 1
    v_addc_co_u32 v5, vcc, 0, v5, vcc
    v_lshl_add_u32 v52, v5, 10, v6
    v_mov_b32 v5, v7
    v_mov_b32 v6, 512
    v_cmp_le_u32 vcc, s33, v5
    s_nop 1
    v_addc_co_u32 v5, vcc, 0, v5, vcc
    v_lshl_add_u32 v53, v5, 10, v6
    s_mul_i32 s38, s3, 320
    s_add_u32 s38, s38, 135168
    v_lshlrev_b32 v4, 6, v2
    v_lshl_add_u32 v4, v3, 1, v4
    v_add_u32 v31, s38, v4
    v_lshlrev_b32 v4, 7, v2
    v_lshl_add_u32 v4, v3, 4, v4
    v_mov_b32 v5, 512
    v_cmp_gt_u32 vcc, 8, v3
    s_nop 1
    v_cndmask_b32 v79, v5, v4, vcc
    s_mov_b32 s86, 0x88888888
    s_mov_b32 s87, 0x88888888
    v_mov_b32 v120, 0xff7f0000
    s_lshl_b32 s38, s32, 10
    s_add_u32 s37, s38, 65540
    s_lshr_b32 s38, s32, 3
    s_lshl_b32 s38, s38, 8
    s_add_u32 s37, s38, s37
    s_bitcmp1_b32 s90, 2
    s_cselect_b32 s36, 22, 18
    v_mov_b32 v5, 0
L_watch:
    buffer_load_dword v6, v5, s[48:51], s37 offen sc1
    s_waitcnt vmcnt(0)
    v_cmp_le_u32 vcc, s36, v6
    s_cbranch_vccnz L_seen
    s_sleep 4
    s_sub_u32 s84, s84, 1
    s_cmp_lg_u32 s84, 0
    s_cbranch_scc1 L_watch
    s_branch L_end
L_seen:
    s_lshl_b32 s39, s34, 13
    s_add_u32 s39, s39, 98304
    s_mov_b32 m0, s39
    s_nop 0
    buffer_load_dwordx4 v20, s[40:43], s44 offen offset:0 nt lds
    buffer_load_dwordx4 v21, s[40:43], s44 offen offset:1024 nt lds
    buffer_load_dwordx4 v22, s[40:43], s44 offen offset:2048 nt lds
    buffer_load_dwordx4 v23, s[40:43], s44 offen offset:3072 nt lds
    s_lshl_b32 s39, s34, 13
    s_add_u32 s39, s39, 102400
    s_mov_b32 m0, s39
    s_add_u32 s44, s44, 16384
    buffer_load_dwordx4 v20, s[40:43], s44 offen offset:0 nt lds
    buffer_load_dwordx4 v21, s[40:43], s44 offen offset:1024 nt lds
    buffer_load_dwordx4 v22, s[40:43], s44 offen offset:2048 nt lds
    buffer_load_dwordx4 v23, s[40:43], s44 offen offset:3072 nt lds
    s_bitcmp1_b32 s90, 2
    s_cbranch_scc1 L_ctxok
    buffer_load_dwordx4 v[224:227], v54, s[48:51], s46 offen sc1
    s_add_u32 s37, s47, 6144
L_auxpoll:
    buffer_load_dwordx4 v[204:207], v53, s[48:51], s47 offen sc1
    buffer_load_dwordx4 v[192:195], v50, s[48:51], s47 offen sc1
    buffer_load_dwordx4 v[196:199], v51, s[48:51], s47 offen sc1
    buffer_load_dwordx4 v[200:203], v52, s[48:51], s47 offen sc1
    buffer_load_dwordx4 v[104:107], v79, s[48:51], s37 offen sc1
    s_waitcnt vmcnt(0)
    v_xor_b32 v104, s35, v104
    v_xor_b32 v105, s35, v105
    v_xor_b32 v106, s35, v106
    v_xor_b32 v107, s35, v107
    v_xor_b32 v192, s35, v192
    v_xor_b32 v193, s35, v193
    v_xor_b32 v194, s35, v194
    v_xor_b32 v195, s35, v195
    v_xor_b32 v196, s35, v196
    v_xor_b32 v197, s35, v197
    v_xor_b32 v198, s35, v198
    v_xor_b32 v199, s35, v199
    v_xor_b32 v200, s35, v200
    v_xor_b32 v201, s35, v201
    v_xor_b32 v202, s35, v202
    v_xor_b32 v203, s35, v203
    v_xor_b32 v204, s35, v204
    v_xor_b32 v205, s35, v205
    v_xor_b32 v206, s35, v206
    v_xor_b32 v207, s35, v207
    v_or_b32 v4, v104, v105
    v_or3_b32 v4, v4, v106, v107
    v_or3_b32 v4, v4, v192, v193
    v_or3_b32 v4, v4, v194, v195
    v_or3_b32 v4, v4, v196, v197
    v_or3_b32 v4, v4, v198, v199
    v_or3_b32 v4, v4, v200, v201
    v_or3_b32 v4, v4, v202, v203
    v_or3_b32 v4, v4, v204, v205
    v_or3_b32 v4, v4, v206, v207
    v_and_b32 v4, 0xff, v4
    v_cmp_ne_u32 vcc, 0, v4
    v_add_f32 v123, v104, v106
    v_add_f32 v122, v204, v206
    v_mov_b32_dpp v121, v105 row_newbcast:8 row_mask:0xf bank_mask:0xf
    v_mov_b32_dpp v120, v123 row_newbcast:8 row_mask:0xf bank_mask:0x3
    s_cbranch_vccz L_hop1ok
    s_sub_u32 s84, s84, 1
    s_cmp_lg_u32 s84, 0
    s_cbranch_scc1 L_auxpoll
    s_branch L_end
.section .rodata,"a"
.p2align 6
.amdhsa_kernel concat_heads__compressed_kv_cla__mha_block_cached__decode_kernel
  .amdhsa_next_free_vgpr 512
  .amdhsa_next_free_sgpr 102
  .amdhsa_accum_offset 256
  .amdhsa_group_segment_fixed_size 0
  .amdhsa_kernarg_size 112
  .amdhsa_user_sgpr_count 2
  .amdhsa_user_sgpr_kernarg_segment_ptr 1
  .amdhsa_system_sgpr_workgroup_id_x 1
.end_amdhsa_kernel
```

```asm
; @launch grid=(256,1,1) block=(256,1,1) lds=163840
    .amdgcn_target "amdgcn-amd-amdhsa--gfx950"
    .text
    .globl concat_heads__compressed_kv_cla__mha_block_cached__decode_kernel
    .p2align 8
    .type concat_heads__compressed_kv_cla__mha_block_cached__decode_kernel,@function
concat_heads__compressed_kv_cla__mha_block_cached__decode_kernel:
    s_cmp_ge_u32 s2, 256
    s_cbranch_scc1 L_end
    s_load_dwordx16 s[4:19], s[0:1], 0
    s_load_dwordx8 s[20:27], s[0:1], 64
    s_load_dwordx4 s[28:31], s[0:1], 96
    v_lshrrev_b32 v4, 6, v0
    v_and_b32 v1, 63, v0
    v_readfirstlane_b32 s34, v4
    s_lshr_b32 s32, s2, 3
    s_sub_u32 s33, s2, s32
    s_sub_u32 s33, s33, 1
    s_and_b32 s33, s33, 7
    v_lshrrev_b32 v2, 4, v1
    v_and_b32 v3, 15, v1
    s_cmp_lt_u32 s33, 2
    s_cbranch_scc1 L_qp
    s_cmp_eq_u32 s33, 2
    s_cbranch_scc1 L_ql
    s_cmp_eq_u32 s33, 7
    s_cbranch_scc1 L_aux
    s_bfe_u32 s38, s2, 0x30000
    s_lshl_b32 s38, s38, 21
    s_add_u32 s36, s38, -393216
    s_lshr_b32 s38, s32, 3
    s_lshl_b32 s38, s38, 19
    s_add_u32 s36, s38, s36
    s_lshl_b32 s38, s33, 17
    s_add_u32 s36, s38, s36
    s_lshl_b32 s38, s34, 12
    s_add_u32 s36, s38, s36
    v_bfe_u32 v5, v1, 0, 5
    v_lshlrev_b32 v4, 7, v5
    v_lshrrev_b32 v5, 5, v1
    v_lshl_add_u32 v4, v5, 15, v4
    s_mov_b32 s42, 16777216
    s_mov_b32 s43, 0x20000
    s_waitcnt lgkmcnt(0)
    s_mov_b64 s[40:41], s[6:7]
    buffer_load_dword v20, v4, s[40:43], s36 offen
    s_add_u32 s36, s36, 16384
    buffer_load_dword v21, v4, s[40:43], s36 offen
    s_add_u32 s36, s36, 49152
    buffer_load_dword v22, v4, s[40:43], s36 offen
    s_add_u32 s36, s36, 16384
    buffer_load_dword v23, v4, s[40:43], s36 offen
    s_load_dword s35, s[30:31], 0
    s_mov_b32 s48, s30
    s_and_b32 s49, s31, 0xffff
    s_mov_b32 s50, 8388608
    s_mov_b32 s51, 0x20000
    s_mov_b32 s82, 0xffffff00
    s_mov_b32 s83, 0x3e0293ee
    s_mov_b32 s84, 8388608
    v_lshrrev_b32 v4, 2, v3
    v_and_b32 v5, 3, v3
    v_lshlrev_b32 v76, 8, v4
    v_lshlrev_b32 v126, 8, v2
    v_lshl_add_u32 v76, v2, 6, v76
    v_lshl_add_u32 v76, v5, 4, v76
    v_lshl_add_u32 v126, v3, 4, v126
    v_xor_b32 v77, 32768, v76
    v_xor_b32 v127, 32768, v126
    s_add_u32 s3, s34, s33
    s_and_b32 s3, s3, 3
    s_lshl_b32 s89, s3, 5
    s_add_u32 s89, s89, s32
    s_lshl_b32 s89, s89, 20
    s_mul_i32 s88, s32, 8
    s_mul_i32 s38, s3, 2
    s_add_u32 s88, s88, s38
    s_lshl_b32 s87, s33, 1
    s_mov_b32 s52, s18
    s_and_b32 s53, s19, 0xffff
    s_mov_b32 s54, 134217728
    s_mov_b32 s55, 0x20000
    s_mov_b32 s56, s20
    s_and_b32 s57, s21, 0xffff
    s_mov_b32 s58, 134217728
    s_mov_b32 s59, 0x20000
    v_and_b32 v4, 1, v1
    v_lshlrev_b32 v4, 4, v4
    v_mov_b32 v5, 0xffff
    v_lshlrev_b32 v4, v4, v5
    v_bfe_u32 v5, v1, 1, 2
    v_cmp_eq_u32 vcc, 0, v5
    s_nop 1
    v_cndmask_b32 v10, 0, v4, vcc
    v_cmp_eq_u32 vcc, 1, v5
    s_nop 1
    v_cndmask_b32 v11, 0, v4, vcc
    v_cmp_eq_u32 vcc, 2, v5
    s_nop 1
    v_cndmask_b32 v12, 0, v4, vcc
    v_cmp_eq_u32 vcc, 3, v5
    s_nop 1
    v_cndmask_b32 v13, 0, v4, vcc
    v_mov_b32 v120, 0xff7f0000
    v_mov_b32 v121, 0
    v_mov_b32 v18, 1
    v_mov_b32 v116, 0
    v_mov_b32 v117, 0
    v_mov_b32 v118, 0
    v_mov_b32 v119, 0
    v_lshlrev_b32 v0, 3, v1
    ds_write_b64 v0, v[116:117] offset:8192
    v_mov_b32 v0, 8192
    s_lshl_b32 s38, s32, 10
    s_add_u32 s96, s38, 65536
    s_lshr_b32 s38, s32, 3
    s_lshl_b32 s38, s38, 8
    s_add_u32 s96, s38, s96
    v_mov_b32 v9, s96
    s_lshl_b32 s38, s32, 15
    s_add_u32 s96, s38, 1048576
    s_lshl_b32 s38, s3, 13
    s_add_u32 s96, s38, s96
    s_lshl_b32 s38, s33, 10
    s_add_u32 s96, s38, s96
    v_and_b32 v5, 3, v3
    v_lshlrev_b32 v78, 7, v2
    v_lshl_add_u32 v78, v5, 5, v78
    s_lshl_b32 s38, s32, 12
    s_add_u32 s91, s38, 262144
    s_lshl_b32 s38, s3, 9
    s_add_u32 s91, s38, s91
    v_lshlrev_b32 v4, 7, v2
    v_lshl_add_u32 v4, v3, 4, v4
    v_mov_b32 v5, 512
    v_cmp_gt_u32 vcc, 8, v3
    s_nop 1
    v_cndmask_b32 v79, v5, v4, vcc
    s_add_u32 s39, s87, s88
    s_bfe_u32 s37, s39, 0x10000
    s_lshl_b32 s37, s37, 13
    s_add_u32 s85, s37, s89
    s_bfe_u32 s37, s39, 0x10001
    s_lshl_b32 s37, s37, 12
    s_add_u32 s85, s37, s85
    s_bfe_u32 s37, s39, 0x10002
    s_lshl_b32 s37, s37, 11
    s_add_u32 s85, s37, s85
    s_bfe_u32 s37, s39, 0x10003
    s_lshl_b32 s37, s37, 14
    s_add_u32 s85, s37, s85
    s_bfe_u32 s37, s39, 0x40004
    s_lshl_b32 s37, s37, 16
    s_add_u32 s85, s37, s85
    buffer_load_dwordx4 v[128:131], v76, s[52:55], s85 offen offset:0 nt
    buffer_load_dwordx4 v[132:135], v77, s[52:55], s85 offen offset:0 nt
    buffer_load_dwordx4 v[136:139], v76, s[52:55], s85 offen offset:1024 nt
    buffer_load_dwordx4 v[140:143], v77, s[52:55], s85 offen offset:1024 nt
    s_add_u32 s87, s87, 1
    s_add_u32 s39, s87, s88
    s_bfe_u32 s37, s39, 0x10000
    s_lshl_b32 s37, s37, 13
    s_add_u32 s85, s37, s89
    s_bfe_u32 s37, s39, 0x10001
    s_lshl_b32 s37, s37, 12
    s_add_u32 s85, s37, s85
    s_bfe_u32 s37, s39, 0x10002
    s_lshl_b32 s37, s37, 11
    s_add_u32 s85, s37, s85
    s_bfe_u32 s37, s39, 0x10003
    s_lshl_b32 s37, s37, 14
    s_add_u32 s85, s37, s85
    s_bfe_u32 s37, s39, 0x40004
    s_lshl_b32 s37, s37, 16
    s_add_u32 s85, s37, s85
    buffer_load_dwordx4 v[144:147], v76, s[52:55], s85 offen offset:0 nt
    buffer_load_dwordx4 v[148:151], v77, s[52:55], s85 offen offset:0 nt
    buffer_load_dwordx4 v[152:155], v76, s[52:55], s85 offen offset:1024 nt
    s_waitcnt lgkmcnt(0)
    s_add_u32 s35, s35, 0x5b
    s_and_b32 s35, s35, 0xff
    v_mov_b32 v8, s35
    s_barrier
    s_waitcnt vmcnt(6)
    buffer_load_dwordx4 v[156:159], v77, s[52:55], s85 offen offset:1024 nt
    s_add_u32 s87, s87, 13
    s_add_u32 s39, s87, s88
    s_bfe_u32 s37, s39, 0x10000
    s_lshl_b32 s37, s37, 13
    s_add_u32 s85, s37, s89
    s_bfe_u32 s37, s39, 0x10001
    s_lshl_b32 s37, s37, 12
    s_add_u32 s85, s37, s85
    s_bfe_u32 s37, s39, 0x10002
    s_lshl_b32 s37, s37, 11
    s_add_u32 s85, s37, s85
    s_bfe_u32 s37, s39, 0x10003
    s_lshl_b32 s37, s37, 14
    s_add_u32 s85, s37, s85
    s_bfe_u32 s37, s39, 0x40004
    s_lshl_b32 s37, s37, 16
    s_add_u32 s85, s37, s85
    s_waitcnt vmcnt(6)
    buffer_load_dwordx4 v[160:163], v76, s[52:55], s85 offen offset:0 nt
    s_waitcnt vmcnt(6)
    buffer_load_dwordx4 v[164:167], v77, s[52:55], s85 offen offset:0 nt
    s_waitcnt vmcnt(6)
    buffer_load_dwordx4 v[168:171], v76, s[52:55], s85 offen offset:1024 nt
    s_waitcnt vmcnt(6)
    buffer_load_dwordx4 v[172:175], v77, s[52:55], s85 offen offset:1024 nt
    s_add_u32 s87, s87, 1
    s_add_u32 s39, s87, s88
    s_bfe_u32 s37, s39, 0x10000
    s_lshl_b32 s37, s37, 13
    s_add_u32 s85, s37, s89
    s_bfe_u32 s37, s39, 0x10001
    s_lshl_b32 s37, s37, 12
    s_add_u32 s85, s37, s85
    s_bfe_u32 s37, s39, 0x10002
    s_lshl_b32 s37, s37, 11
    s_add_u32 s85, s37, s85
    s_bfe_u32 s37, s39, 0x10003
    s_lshl_b32 s37, s37, 14
    s_add_u32 s85, s37, s85
    s_bfe_u32 s37, s39, 0x40004
    s_lshl_b32 s37, s37, 16
    s_add_u32 s85, s37, s85
    s_waitcnt vmcnt(6)
    buffer_load_dwordx4 v[176:179], v76, s[52:55], s85 offen offset:0 nt
    s_waitcnt vmcnt(6)
    buffer_load_dwordx4 v[180:183], v77, s[52:55], s85 offen offset:0 nt
    s_waitcnt vmcnt(6)
    buffer_load_dwordx4 v[184:187], v76, s[52:55], s85 offen offset:1024 nt
    s_waitcnt vmcnt(6)
    buffer_load_dwordx4 v[188:191], v77, s[52:55], s85 offen offset:1024 nt
    s_add_u32 s87, s87, 13
    s_add_u32 s39, s87, s88
    s_bfe_u32 s37, s39, 0x10000
    s_lshl_b32 s37, s37, 13
    s_add_u32 s85, s37, s89
    s_bfe_u32 s37, s39, 0x10001
    s_lshl_b32 s37, s37, 12
    s_add_u32 s85, s37, s85
    s_bfe_u32 s37, s39, 0x10002
    s_lshl_b32 s37, s37, 11
    s_add_u32 s85, s37, s85
    s_bfe_u32 s37, s39, 0x10003
    s_lshl_b32 s37, s37, 14
    s_add_u32 s85, s37, s85
    s_bfe_u32 s37, s39, 0x40004
    s_lshl_b32 s37, s37, 16
    s_add_u32 s85, s37, s85
    s_waitcnt vmcnt(6)
    buffer_load_dwordx4 v[192:195], v76, s[52:55], s85 offen offset:0 nt
    s_waitcnt vmcnt(6)
    buffer_load_dwordx4 v[196:199], v77, s[52:55], s85 offen offset:0 nt
    s_waitcnt vmcnt(6)
    buffer_load_dwordx4 v[200:203], v76, s[52:55], s85 offen offset:1024 nt
    s_waitcnt vmcnt(6)
    buffer_load_dwordx4 v[204:207], v77, s[52:55], s85 offen offset:1024 nt
    s_add_u32 s87, s87, 1
    s_add_u32 s39, s87, s88
    s_bfe_u32 s37, s39, 0x10000
    s_lshl_b32 s37, s37, 13
    s_add_u32 s85, s37, s89
    s_bfe_u32 s37, s39, 0x10001
    s_lshl_b32 s37, s37, 12
    s_add_u32 s85, s37, s85
    s_bfe_u32 s37, s39, 0x10002
    s_lshl_b32 s37, s37, 11
    s_add_u32 s85, s37, s85
    s_bfe_u32 s37, s39, 0x10003
    s_lshl_b32 s37, s37, 14
    s_add_u32 s85, s37, s85
    s_bfe_u32 s37, s39, 0x40004
    s_lshl_b32 s37, s37, 16
    s_add_u32 s85, s37, s85
    s_waitcnt vmcnt(6)
    buffer_load_dwordx4 v[208:211], v76, s[52:55], s85 offen offset:0 nt
    s_waitcnt vmcnt(6)
    buffer_load_dwordx4 v[212:215], v77, s[52:55], s85 offen offset:0 nt
    s_waitcnt vmcnt(6)
    buffer_load_dwordx4 v[216:219], v76, s[52:55], s85 offen offset:1024 nt
    s_waitcnt vmcnt(6)
    buffer_load_dwordx4 v[220:223], v77, s[52:55], s85 offen offset:1024 nt
    s_add_u32 s87, s87, 13
    s_add_u32 s39, s87, s88
    s_bfe_u32 s37, s39, 0x10000
    s_lshl_b32 s37, s37, 13
    s_add_u32 s85, s37, s89
    s_bfe_u32 s37, s39, 0x10001
    s_lshl_b32 s37, s37, 12
    s_add_u32 s85, s37, s85
    s_bfe_u32 s37, s39, 0x10002
    s_lshl_b32 s37, s37, 11
    s_add_u32 s85, s37, s85
    s_bfe_u32 s37, s39, 0x10003
    s_lshl_b32 s37, s37, 14
    s_add_u32 s85, s37, s85
    s_bfe_u32 s37, s39, 0x40004
    s_lshl_b32 s37, s37, 16
    s_add_u32 s85, s37, s85
    s_waitcnt vmcnt(6)
    buffer_load_dwordx4 v[224:227], v76, s[52:55], s85 offen offset:0 nt
    s_waitcnt vmcnt(6)
    buffer_load_dwordx4 v[228:231], v77, s[52:55], s85 offen offset:0 nt
    s_waitcnt vmcnt(6)
    buffer_load_dwordx4 v[232:235], v76, s[52:55], s85 offen offset:1024 nt
    s_waitcnt vmcnt(6)
    buffer_load_dwordx4 v[236:239], v77, s[52:55], s85 offen offset:1024 nt
    s_add_u32 s87, s87, 1
    s_add_u32 s39, s87, s88
    s_bfe_u32 s37, s39, 0x10000
    s_lshl_b32 s37, s37, 13
    s_add_u32 s85, s37, s89
    s_bfe_u32 s37, s39, 0x10001
    s_lshl_b32 s37, s37, 12
    s_add_u32 s85, s37, s85
    s_bfe_u32 s37, s39, 0x10002
    s_lshl_b32 s37, s37, 11
    s_add_u32 s85, s37, s85
    s_bfe_u32 s37, s39, 0x10003
    s_lshl_b32 s37, s37, 14
    s_add_u32 s85, s37, s85
    s_bfe_u32 s37, s39, 0x40004
    s_lshl_b32 s37, s37, 16
    s_add_u32 s85, s37, s85
    s_waitcnt vmcnt(6)
    buffer_load_dwordx4 v[240:243], v76, s[52:55], s85 offen offset:0 nt
    s_waitcnt vmcnt(6)
    buffer_load_dwordx4 v[244:247], v77, s[52:55], s85 offen offset:0 nt
    s_waitcnt vmcnt(6)
    buffer_load_dwordx4 v[248:251], v76, s[52:55], s85 offen offset:1024 nt
    s_waitcnt vmcnt(6)
    buffer_load_dwordx4 v[252:255], v77, s[52:55], s85 offen offset:1024 nt
    s_add_u32 s87, s87, 13
    s_add_u32 s39, s87, s88
    s_bfe_u32 s37, s39, 0x10000
    s_lshl_b32 s37, s37, 13
    s_add_u32 s85, s37, s89
    s_bfe_u32 s37, s39, 0x10001
    s_lshl_b32 s37, s37, 12
    s_add_u32 s85, s37, s85
    s_bfe_u32 s37, s39, 0x10002
    s_lshl_b32 s37, s37, 11
    s_add_u32 s85, s37, s85
    s_bfe_u32 s37, s39, 0x10003
    s_lshl_b32 s37, s37, 14
    s_add_u32 s85, s37, s85
    s_bfe_u32 s37, s39, 0x40004
    s_lshl_b32 s37, s37, 16
    s_add_u32 s85, s37, s85
    s_waitcnt vmcnt(6)
    buffer_load_dwordx4 a[0:3], v76, s[52:55], s85 offen offset:0 nt
    s_waitcnt vmcnt(6)
    buffer_load_dwordx4 a[4:7], v77, s[52:55], s85 offen offset:0 nt
    s_waitcnt vmcnt(6)
    buffer_load_dwordx4 a[8:11], v76, s[52:55], s85 offen offset:1024 nt
    s_waitcnt vmcnt(6)
    buffer_load_dwordx4 a[12:15], v77, s[52:55], s85 offen offset:1024 nt
    s_add_u32 s87, s87, 1
    s_add_u32 s39, s87, s88
    s_bfe_u32 s37, s39, 0x10000
    s_lshl_b32 s37, s37, 13
    s_add_u32 s85, s37, s89
    s_bfe_u32 s37, s39, 0x10001
    s_lshl_b32 s37, s37, 12
    s_add_u32 s85, s37, s85
    s_bfe_u32 s37, s39, 0x10002
    s_lshl_b32 s37, s37, 11
    s_add_u32 s85, s37, s85
    s_bfe_u32 s37, s39, 0x10003
    s_lshl_b32 s37, s37, 14
    s_add_u32 s85, s37, s85
    s_bfe_u32 s37, s39, 0x40004
    s_lshl_b32 s37, s37, 16
    s_add_u32 s85, s37, s85
    s_waitcnt vmcnt(6)
    buffer_load_dwordx4 a[16:19], v76, s[52:55], s85 offen offset:0 nt
    s_waitcnt vmcnt(6)
    buffer_load_dwordx4 a[20:23], v77, s[52:55], s85 offen offset:0 nt
    s_waitcnt vmcnt(6)
    buffer_load_dwordx4 a[24:27], v76, s[52:55], s85 offen offset:1024 nt
    s_waitcnt vmcnt(6)
    buffer_load_dwordx4 a[28:31], v77, s[52:55], s85 offen offset:1024 nt
    s_add_u32 s87, s87, 13
    s_add_u32 s39, s87, s88
    s_bfe_u32 s37, s39, 0x10000
    s_lshl_b32 s37, s37, 13
    s_add_u32 s85, s37, s89
    s_bfe_u32 s37, s39, 0x10001
    s_lshl_b32 s37, s37, 12
    s_add_u32 s85, s37, s85
    s_bfe_u32 s37, s39, 0x10002
    s_lshl_b32 s37, s37, 11
    s_add_u32 s85, s37, s85
    s_bfe_u32 s37, s39, 0x10003
    s_lshl_b32 s37, s37, 14
    s_add_u32 s85, s37, s85
    s_bfe_u32 s37, s39, 0x40004
    s_lshl_b32 s37, s37, 16
    s_add_u32 s85, s37, s85
    s_waitcnt vmcnt(6)
    buffer_load_dwordx4 a[32:35], v76, s[52:55], s85 offen offset:0 nt
    s_waitcnt vmcnt(6)
    buffer_load_dwordx4 a[36:39], v77, s[52:55], s85 offen offset:0 nt
    s_waitcnt vmcnt(6)
    buffer_load_dwordx4 a[40:43], v76, s[52:55], s85 offen offset:1024 nt
    s_waitcnt vmcnt(6)
    buffer_load_dwordx4 a[44:47], v77, s[52:55], s85 offen offset:1024 nt
    s_add_u32 s87, s87, 1
    s_add_u32 s39, s87, s88
    s_bfe_u32 s37, s39, 0x10000
    s_lshl_b32 s37, s37, 13
    s_add_u32 s85, s37, s89
    s_bfe_u32 s37, s39, 0x10001
    s_lshl_b32 s37, s37, 12
    s_add_u32 s85, s37, s85
    s_bfe_u32 s37, s39, 0x10002
    s_lshl_b32 s37, s37, 11
    s_add_u32 s85, s37, s85
    s_bfe_u32 s37, s39, 0x10003
    s_lshl_b32 s37, s37, 14
    s_add_u32 s85, s37, s85
    s_bfe_u32 s37, s39, 0x40004
    s_lshl_b32 s37, s37, 16
    s_add_u32 s85, s37, s85
    s_waitcnt vmcnt(6)
    buffer_load_dwordx4 a[48:51], v76, s[52:55], s85 offen offset:0 nt
    s_waitcnt vmcnt(6)
    buffer_load_dwordx4 a[52:55], v77, s[52:55], s85 offen offset:0 nt
    buffer_load_dwordx4 v[68:71], v78, s[48:51], s91 offen offset:0 sc1
    buffer_load_dwordx4 v[72:75], v78, s[48:51], s91 offen offset:16 sc1
    s_waitcnt vmcnt(8)
    buffer_load_dwordx4 a[56:59], v76, s[52:55], s85 offen offset:1024 nt
    s_waitcnt vmcnt(8)
    buffer_load_dwordx4 a[60:63], v77, s[52:55], s85 offen offset:1024 nt
    s_add_u32 s87, s87, 13
    s_add_u32 s39, s87, s88
    s_bfe_u32 s37, s39, 0x10000
    s_lshl_b32 s37, s37, 13
    s_add_u32 s85, s37, s89
    s_bfe_u32 s37, s39, 0x10001
    s_lshl_b32 s37, s37, 12
    s_add_u32 s85, s37, s85
    s_bfe_u32 s37, s39, 0x10002
    s_lshl_b32 s37, s37, 11
    s_add_u32 s85, s37, s85
    s_bfe_u32 s37, s39, 0x10003
    s_lshl_b32 s37, s37, 14
    s_add_u32 s85, s37, s85
    s_bfe_u32 s37, s39, 0x40004
    s_lshl_b32 s37, s37, 16
    s_add_u32 s85, s37, s85
    s_waitcnt vmcnt(8)
    buffer_load_dwordx4 a[64:67], v76, s[52:55], s85 offen offset:0 nt
    s_waitcnt vmcnt(8)
    buffer_load_dwordx4 a[68:71], v77, s[52:55], s85 offen offset:0 nt
    s_waitcnt vmcnt(8)
    buffer_load_dwordx4 a[72:75], v76, s[52:55], s85 offen offset:1024 nt
    s_waitcnt vmcnt(8)
    buffer_load_dwordx4 a[76:79], v77, s[52:55], s85 offen offset:1024 nt
    s_add_u32 s87, s87, 1
    s_add_u32 s39, s87, s88
    s_bfe_u32 s37, s39, 0x10000
    s_lshl_b32 s37, s37, 13
    s_add_u32 s85, s37, s89
    s_bfe_u32 s37, s39, 0x10001
    s_lshl_b32 s37, s37, 12
    s_add_u32 s85, s37, s85
    s_bfe_u32 s37, s39, 0x10002
    s_lshl_b32 s37, s37, 11
    s_add_u32 s85, s37, s85
    s_bfe_u32 s37, s39, 0x10003
    s_lshl_b32 s37, s37, 14
    s_add_u32 s85, s37, s85
    s_bfe_u32 s37, s39, 0x40004
    s_lshl_b32 s37, s37, 16
    s_add_u32 s85, s37, s85
    s_waitcnt vmcnt(6)
L_qcheck_1:
    v_xor_b32 v68, s35, v68
    v_xor_b32 v69, s35, v69
    v_xor_b32 v70, s35, v70
    v_xor_b32 v71, s35, v71
    v_xor_b32 v72, s35, v72
    v_xor_b32 v73, s35, v73
    v_xor_b32 v74, s35, v74
    v_xor_b32 v75, s35, v75
    v_or_b32 v4, v68, v69
    v_or3_b32 v4, v4, v70, v71
    v_or3_b32 v4, v4, v72, v73
    v_or3_b32 v4, v4, v74, v75
    v_and_b32 v4, 0xff, v4
    v_cmp_ne_u32 vcc, 0, v4
    s_cbranch_vccz L_qok_2
    buffer_load_dwordx4 v[68:71], v78, s[48:51], s91 offen offset:0 sc1
    buffer_load_dwordx4 v[72:75], v78, s[48:51], s91 offen offset:16 sc1
    s_waitcnt vmcnt(0)
    s_sub_u32 s84, s84, 1
    s_cmp_lg_u32 s84, 0
    s_cbranch_scc1 L_qcheck_1
    s_branch L_end
L_qok_2:
    v_cvt_pk_bf16_f32 v68, v68, v69
    v_cvt_pk_bf16_f32 v69, v70, v71
    v_cvt_pk_bf16_f32 v70, v72, v73
    v_cvt_pk_bf16_f32 v71, v74, v75
    s_mov_b32 vcc_lo, 0xf000f
    s_mov_b32 vcc_hi, 0xf000f
    v_cndmask_b32 v80, 0, v68, vcc
    v_cndmask_b32 v81, 0, v69, vcc
    v_cndmask_b32 v82, 0, v70, vcc
    v_cndmask_b32 v83, 0, v71, vcc
    s_mov_b32 vcc_lo, 0xf000f0
    s_mov_b32 vcc_hi, 0xf000f0
    v_cndmask_b32 v84, 0, v68, vcc
    v_cndmask_b32 v85, 0, v69, vcc
    v_cndmask_b32 v86, 0, v70, vcc
    v_cndmask_b32 v87, 0, v71, vcc
    s_mov_b32 vcc_lo, 0xf000f00
    s_mov_b32 vcc_hi, 0xf000f00
    v_cndmask_b32 v88, 0, v68, vcc
    v_cndmask_b32 v89, 0, v69, vcc
    v_cndmask_b32 v90, 0, v70, vcc
    v_cndmask_b32 v91, 0, v71, vcc
    s_mov_b32 vcc_lo, 0xf000f000
    s_mov_b32 vcc_hi, 0xf000f000
    v_cndmask_b32 v92, 0, v68, vcc
    v_cndmask_b32 v93, 0, v69, vcc
    v_cndmask_b32 v94, 0, v70, vcc
    v_cndmask_b32 v95, 0, v71, vcc
    s_getreg_b32 s70, hwreg(HW_REG_XCC_ID, 0, 4)
    s_lshl_b32 s70, s70, 8
    s_or_b32 s70, s70, s35
    s_or_b32 s70, s70, 0x5e9d0000
    s_bfe_u32 s38, s2, 0x30000
    s_lshl_b32 s38, s38, 8
    s_add_u32 s69, s38, 32768
    s_lshl_b32 s38, s32, 2
    s_add_u32 s69, s38, s69
    s_lshl_b32 s38, s34, 24
    s_add_u32 s69, s38, s69
    v_mov_b32 v72, s69
    v_mov_b32 v73, s70
    s_mov_b64 exec, 1
    buffer_store_dword v73, v72, s[48:51], 0 offen sc1
    s_mov_b64 exec, -1
    v_mov_b32 v65, 0xff7f0000
    s_lshl_b32 s38, s34, 14
    s_add_u32 s38, s38, 16384
    v_lshl_add_u32 v64, v1, 2, s38
    buffer_load_dwordx4 a[80:83], v76, s[52:55], s85 offen offset:0 nt
    v_mfma_f32_16x16x32_bf16 v[112:115], v[128:131], v[80:83], 0
    v_mfma_f32_16x16x32_bf16 v[112:115], v[132:135], v[84:87], v[112:115]
    v_mfma_f32_16x16x32_bf16 v[112:115], v[136:139], v[88:91], v[112:115]
    s_waitcnt vmcnt(7)
    buffer_load_dwordx4 a[84:87], v77, s[52:55], s85 offen offset:0 nt
    v_mfma_f32_16x16x32_bf16 v[112:115], v[140:143], v[92:95], v[112:115]
    v_mfma_f32_16x16x32_bf16 v[96:99], v[144:147], v[80:83], 0
    v_mfma_f32_16x16x32_bf16 v[96:99], v[148:151], v[84:87], v[96:99]
    v_mfma_f32_16x16x32_bf16 v[96:99], v[152:155], v[88:91], v[96:99]
    s_nop 4
    v_mov_b32_dpp v122, v112 quad_perm:[0,0,0,0] row_mask:0xf bank_mask:0xf
    v_mov_b32_dpp v124, v114 quad_perm:[2,2,2,2] row_mask:0xf bank_mask:0xf
    s_nop 0
    v_add_f32_dpp v122, v113, v122 quad_perm:[1,1,1,1] row_mask:0xf bank_mask:0xf
    v_add_f32_dpp v124, v115, v124 quad_perm:[3,3,3,3] row_mask:0xf bank_mask:0xf
    v_add_f32 v122, v122, v124
    v_max_f32 v65, v65, v122
    ds_write_b32 v64, v122 offset:0
    s_waitcnt vmcnt(7)
    buffer_load_dwordx4 a[88:91], v76, s[52:55], s85 offen offset:1024 nt
    v_mfma_f32_16x16x32_bf16 v[96:99], v[156:159], v[92:95], v[96:99]
    v_mfma_f32_16x16x32_bf16 v[112:115], v[160:163], v[80:83], 0
    v_mfma_f32_16x16x32_bf16 v[112:115], v[164:167], v[84:87], v[112:115]
    s_waitcnt vmcnt(7)
    buffer_load_dwordx4 a[92:95], v77, s[52:55], s85 offen offset:1024 nt
    s_add_u32 s87, s87, 13
    s_add_u32 s39, s87, s88
    s_bfe_u32 s37, s39, 0x10000
    s_lshl_b32 s37, s37, 13
    s_add_u32 s85, s37, s89
    s_bfe_u32 s37, s39, 0x10001
    s_lshl_b32 s37, s37, 12
    s_add_u32 s85, s37, s85
    s_bfe_u32 s37, s39, 0x10002
    s_lshl_b32 s37, s37, 11
    s_add_u32 s85, s37, s85
    s_bfe_u32 s37, s39, 0x10003
    s_lshl_b32 s37, s37, 14
    s_add_u32 s85, s37, s85
    s_bfe_u32 s37, s39, 0x40004
    s_lshl_b32 s37, s37, 16
    s_add_u32 s85, s37, s85
    v_mfma_f32_16x16x32_bf16 v[112:115], v[168:171], v[88:91], v[112:115]
    v_mov_b32_dpp v122, v96 quad_perm:[0,0,0,0] row_mask:0xf bank_mask:0xf
    v_mov_b32_dpp v124, v98 quad_perm:[2,2,2,2] row_mask:0xf bank_mask:0xf
    s_nop 0
    v_add_f32_dpp v122, v97, v122 quad_perm:[1,1,1,1] row_mask:0xf bank_mask:0xf
    v_add_f32_dpp v124, v99, v124 quad_perm:[3,3,3,3] row_mask:0xf bank_mask:0xf
    v_add_f32 v122, v122, v124
    v_max_f32 v65, v65, v122
    ds_write_b32 v64, v122 offset:256
    v_mfma_f32_16x16x32_bf16 v[112:115], v[172:175], v[92:95], v[112:115]
    v_mfma_f32_16x16x32_bf16 v[96:99], v[176:179], v[80:83], 0
    v_mfma_f32_16x16x32_bf16 v[96:99], v[180:183], v[84:87], v[96:99]
    s_waitcnt vmcnt(7)
    buffer_load_dwordx4 a[96:99], v76, s[52:55], s85 offen offset:0 nt
    v_mfma_f32_16x16x32_bf16 v[96:99], v[184:187], v[88:91], v[96:99]
    s_nop 2
    v_mov_b32_dpp v122, v112 quad_perm:[0,0,0,0] row_mask:0xf bank_mask:0xf
    v_mov_b32_dpp v124, v114 quad_perm:[2,2,2,2] row_mask:0xf bank_mask:0xf
    s_nop 0
    v_add_f32_dpp v122, v113, v122 quad_perm:[1,1,1,1] row_mask:0xf bank_mask:0xf
    v_add_f32_dpp v124, v115, v124 quad_perm:[3,3,3,3] row_mask:0xf bank_mask:0xf
    v_add_f32 v122, v122, v124
    v_max_f32 v65, v65, v122
    ds_write_b32 v64, v122 offset:512
    v_mfma_f32_16x16x32_bf16 v[96:99], v[188:191], v[92:95], v[96:99]
    v_mfma_f32_16x16x32_bf16 v[112:115], v[192:195], v[80:83], 0
    s_waitcnt vmcnt(7)
    buffer_load_dwordx4 a[100:103], v77, s[52:55], s85 offen offset:0 nt
    v_mfma_f32_16x16x32_bf16 v[112:115], v[196:199], v[84:87], v[112:115]
    v_mfma_f32_16x16x32_bf16 v[112:115], v[200:203], v[88:91], v[112:115]
    s_nop 2
    v_mov_b32_dpp v122, v96 quad_perm:[0,0,0,0] row_mask:0xf bank_mask:0xf
    v_mov_b32_dpp v124, v98 quad_perm:[2,2,2,2] row_mask:0xf bank_mask:0xf
    s_nop 0
    v_add_f32_dpp v122, v97, v122 quad_perm:[1,1,1,1] row_mask:0xf bank_mask:0xf
    v_add_f32_dpp v124, v99, v124 quad_perm:[3,3,3,3] row_mask:0xf bank_mask:0xf
    v_add_f32 v122, v122, v124
    v_max_f32 v65, v65, v122
    ds_write_b32 v64, v122 offset:768
    v_mfma_f32_16x16x32_bf16 v[112:115], v[204:207], v[92:95], v[112:115]
    v_mfma_f32_16x16x32_bf16 v[96:99], v[208:211], v[80:83], 0
    s_waitcnt vmcnt(7)
    buffer_load_dwordx4 a[104:107], v76, s[52:55], s85 offen offset:1024 nt
    v_mfma_f32_16x16x32_bf16 v[96:99], v[212:215], v[84:87], v[96:99]
    v_mfma_f32_16x16x32_bf16 v[96:99], v[216:219], v[88:91], v[96:99]
    s_nop 2
    v_mov_b32_dpp v122, v112 quad_perm:[0,0,0,0] row_mask:0xf bank_mask:0xf
    v_mov_b32_dpp v124, v114 quad_perm:[2,2,2,2] row_mask:0xf bank_mask:0xf
    s_nop 0
    v_add_f32_dpp v122, v113, v122 quad_perm:[1,1,1,1] row_mask:0xf bank_mask:0xf
    v_add_f32_dpp v124, v115, v124 quad_perm:[3,3,3,3] row_mask:0xf bank_mask:0xf
    v_add_f32 v122, v122, v124
    v_max_f32 v65, v65, v122
    ds_write_b32 v64, v122 offset:1024
    v_mfma_f32_16x16x32_bf16 v[96:99], v[220:223], v[92:95], v[96:99]
    s_waitcnt vmcnt(6)
    buffer_load_dwordx4 a[108:111], v77, s[52:55], s85 offen offset:1024 nt
    s_add_u32 s87, s87, 1
    s_add_u32 s39, s87, s88
    s_bfe_u32 s37, s39, 0x10000
    s_lshl_b32 s37, s37, 13
    s_add_u32 s85, s37, s89
    s_bfe_u32 s37, s39, 0x10001
    s_lshl_b32 s37, s37, 12
    s_add_u32 s85, s37, s85
    s_bfe_u32 s37, s39, 0x10002
    s_lshl_b32 s37, s37, 11
    s_add_u32 s85, s37, s85
    s_bfe_u32 s37, s39, 0x10003
    s_lshl_b32 s37, s37, 14
    s_add_u32 s85, s37, s85
    s_bfe_u32 s37, s39, 0x40004
    s_lshl_b32 s37, s37, 16
    s_add_u32 s85, s37, s85
    v_mfma_f32_16x16x32_bf16 v[112:115], v[224:227], v[80:83], 0
    v_mfma_f32_16x16x32_bf16 v[112:115], v[228:231], v[84:87], v[112:115]
    v_mfma_f32_16x16x32_bf16 v[112:115], v[232:235], v[88:91], v[112:115]
    v_mov_b32_dpp v122, v96 quad_perm:[0,0,0,0] row_mask:0xf bank_mask:0xf
    v_mov_b32_dpp v124, v98 quad_perm:[2,2,2,2] row_mask:0xf bank_mask:0xf
    s_nop 0
    v_add_f32_dpp v122, v97, v122 quad_perm:[1,1,1,1] row_mask:0xf bank_mask:0xf
    v_add_f32_dpp v124, v99, v124 quad_perm:[3,3,3,3] row_mask:0xf bank_mask:0xf
    v_add_f32 v122, v122, v124
    v_max_f32 v65, v65, v122
    ds_write_b32 v64, v122 offset:1280
    v_mfma_f32_16x16x32_bf16 v[112:115], v[236:239], v[92:95], v[112:115]
    s_waitcnt vmcnt(6)
    buffer_load_dwordx4 a[112:115], v76, s[52:55], s85 offen offset:0 nt
    v_mfma_f32_16x16x32_bf16 v[96:99], v[240:243], v[80:83], 0
    v_mfma_f32_16x16x32_bf16 v[96:99], v[244:247], v[84:87], v[96:99]
    v_mfma_f32_16x16x32_bf16 v[96:99], v[248:251], v[88:91], v[96:99]
    s_nop 2
    v_mov_b32_dpp v122, v112 quad_perm:[0,0,0,0] row_mask:0xf bank_mask:0xf
    v_mov_b32_dpp v124, v114 quad_perm:[2,2,2,2] row_mask:0xf bank_mask:0xf
    s_nop 0
    v_add_f32_dpp v122, v113, v122 quad_perm:[1,1,1,1] row_mask:0xf bank_mask:0xf
    v_add_f32_dpp v124, v115, v124 quad_perm:[3,3,3,3] row_mask:0xf bank_mask:0xf
    v_add_f32 v122, v122, v124
    v_max_f32 v65, v65, v122
    ds_write_b32 v64, v122 offset:1536
    v_mfma_f32_16x16x32_bf16 v[96:99], v[252:255], v[92:95], v[96:99]
    s_waitcnt vmcnt(6)
    buffer_load_dwordx4 a[116:119], v77, s[52:55], s85 offen offset:0 nt
    v_mfma_f32_16x16x32_bf16 v[112:115], a[0:3], v[80:83], 0
    v_mfma_f32_16x16x32_bf16 v[112:115], a[4:7], v[84:87], v[112:115]
    v_mfma_f32_16x16x32_bf16 v[112:115], a[8:11], v[88:91], v[112:115]
    s_nop 2
    v_mov_b32_dpp v122, v96 quad_perm:[0,0,0,0] row_mask:0xf bank_mask:0xf
    v_mov_b32_dpp v124, v98 quad_perm:[2,2,2,2] row_mask:0xf bank_mask:0xf
    s_nop 0
    v_add_f32_dpp v122, v97, v122 quad_perm:[1,1,1,1] row_mask:0xf bank_mask:0xf
    v_add_f32_dpp v124, v99, v124 quad_perm:[3,3,3,3] row_mask:0xf bank_mask:0xf
    v_add_f32 v122, v122, v124
    v_max_f32 v65, v65, v122
    ds_write_b32 v64, v122 offset:1792
    s_waitcnt vmcnt(6)
    buffer_load_dwordx4 a[120:123], v76, s[52:55], s85 offen offset:1024 nt
    v_mfma_f32_16x16x32_bf16 v[112:115], a[12:15], v[92:95], v[112:115]
    v_mfma_f32_16x16x32_bf16 v[96:99], a[16:19], v[80:83], 0
    v_mfma_f32_16x16x32_bf16 v[96:99], a[20:23], v[84:87], v[96:99]
    v_mfma_f32_16x16x32_bf16 v[96:99], a[24:27], v[88:91], v[96:99]
    s_nop 4
    v_mov_b32_dpp v122, v112 quad_perm:[0,0,0,0] row_mask:0xf bank_mask:0xf
    v_mov_b32_dpp v124, v114 quad_perm:[2,2,2,2] row_mask:0xf bank_mask:0xf
    s_nop 0
    v_add_f32_dpp v122, v113, v122 quad_perm:[1,1,1,1] row_mask:0xf bank_mask:0xf
    v_add_f32_dpp v124, v115, v124 quad_perm:[3,3,3,3] row_mask:0xf bank_mask:0xf
    v_add_f32 v122, v122, v124
    v_max_f32 v65, v65, v122
    ds_write_b32 v64, v122 offset:2048
    s_waitcnt vmcnt(6)
    buffer_load_dwordx4 a[124:127], v77, s[52:55], s85 offen offset:1024 nt
    s_add_u32 s87, s87, 13
    s_add_u32 s39, s87, s88
    s_bfe_u32 s37, s39, 0x10000
    s_lshl_b32 s37, s37, 13
    s_add_u32 s85, s37, s89
    s_bfe_u32 s37, s39, 0x10001
    s_lshl_b32 s37, s37, 12
    s_add_u32 s85, s37, s85
    s_bfe_u32 s37, s39, 0x10002
    s_lshl_b32 s37, s37, 11
    s_add_u32 s85, s37, s85
    s_bfe_u32 s37, s39, 0x10003
    s_lshl_b32 s37, s37, 14
    s_add_u32 s85, s37, s85
    s_bfe_u32 s37, s39, 0x40004
    s_lshl_b32 s37, s37, 16
    s_add_u32 s85, s37, s85
    v_mfma_f32_16x16x32_bf16 v[96:99], a[28:31], v[92:95], v[96:99]
    v_mfma_f32_16x16x32_bf16 v[112:115], a[32:35], v[80:83], 0
    s_bfe_u32 s38, s2, 0x20001
    s_lshl_b32 s38, s38, 0
    s_add_u32 s90, s38, 0
    s_bfe_u32 s38, s2, 0x10000
    s_lshl_b32 s38, s38, 2
    s_add_u32 s90, s38, s90
    s_and_b32 s36, s90, 3
    s_bitcmp0_b32 s90, 2
    s_cselect_b64 s[40:41], s[24:25], s[14:15]
    s_cselect_b32 s45, 262144, 0
    s_add_u32 s45, s45, 524288
    s_lshl_b32 s38, s36, 16
    s_add_u32 s71, s38, s45
    s_lshr_b32 s38, s32, 2
    s_lshl_b32 s38, s38, 13
    s_add_u32 s71, s38, s71
    s_bfe_u32 s38, s32, 0x20000
    s_lshl_b32 s38, s38, 6
    s_add_u32 s71, s38, s71
    s_mov_b32 s42, 4194304
    s_mov_b32 s43, 0x20000
    s_lshl_b32 s38, s32, 17
    s_add_u32 s44, s38, 0
    s_lshl_b32 s38, s34, 15
    s_add_u32 s44, s38, s44
    s_lshl_b32 s38, s36, 8
    s_add_u32 s44, s38, s44
    s_lshl_b32 s38, s36, 16
    s_add_u32 s45, s38, s45
    s_lshr_b32 s38, s34, 1
    s_lshl_b32 s38, s38, 15
    s_add_u32 s45, s38, s45
    s_lshl_b32 s38, s32, 8
    s_add_u32 s45, s38, s45
    s_bfe_u32 s38, s34, 0x10000
    s_lshl_b32 s38, s38, 7
    s_add_u32 s45, s38, s45
    s_lshl_b32 s38, s32, 11
    s_add_u32 s46, s38, 196608
    s_lshl_b32 s38, s34, 9
    s_add_u32 s46, s38, s46
    s_mov_b32 s72, s26
    s_and_b32 s73, s27, 0xffff
    s_mov_b32 s74, 8192
    s_mov_b32 s75, 0x20000
    v_mfma_f32_16x16x32_bf16 v[112:115], a[36:39], v[84:87], v[112:115]
    s_waitcnt vmcnt(5)
    buffer_load_dwordx4 v[128:131], v76, s[52:55], s85 offen offset:0 nt
    v_mfma_f32_16x16x32_bf16 v[112:115], a[40:43], v[88:91], v[112:115]
    v_mov_b32_dpp v122, v96 quad_perm:[0,0,0,0] row_mask:0xf bank_mask:0xf
    v_mov_b32_dpp v124, v98 quad_perm:[2,2,2,2] row_mask:0xf bank_mask:0xf
    s_nop 0
    v_add_f32_dpp v122, v97, v122 quad_perm:[1,1,1,1] row_mask:0xf bank_mask:0xf
    v_add_f32_dpp v124, v99, v124 quad_perm:[3,3,3,3] row_mask:0xf bank_mask:0xf
    v_add_f32 v122, v122, v124
    v_max_f32 v65, v65, v122
    ds_write_b32 v64, v122 offset:2304
    v_mfma_f32_16x16x32_bf16 v[112:115], a[44:47], v[92:95], v[112:115]
    v_mfma_f32_16x16x32_bf16 v[96:99], a[48:51], v[80:83], 0
    v_mfma_f32_16x16x32_bf16 v[96:99], a[52:55], v[84:87], v[96:99]
    s_waitcnt vmcnt(5)
    buffer_load_dwordx4 v[132:135], v77, s[52:55], s85 offen offset:0 nt
    v_mfma_f32_16x16x32_bf16 v[96:99], a[56:59], v[88:91], v[96:99]
    s_nop 2
    v_mov_b32_dpp v122, v112 quad_perm:[0,0,0,0] row_mask:0xf bank_mask:0xf
    v_mov_b32_dpp v124, v114 quad_perm:[2,2,2,2] row_mask:0xf bank_mask:0xf
    s_nop 0
    v_add_f32_dpp v122, v113, v122 quad_perm:[1,1,1,1] row_mask:0xf bank_mask:0xf
    v_add_f32_dpp v124, v115, v124 quad_perm:[3,3,3,3] row_mask:0xf bank_mask:0xf
    v_add_f32 v122, v122, v124
    v_max_f32 v65, v65, v122
    ds_write_b32 v64, v122 offset:2560
    v_lshlrev_b32 v4, 2, v2
    v_xor_b32 v4, v4, v3
    v_xor_b32 v5, 0, v4
    v_lshlrev_b32 v5, 4, v5
    v_lshl_add_u32 v20, v2, 10, v5
    v_xor_b32 v5, 1, v4
    v_lshlrev_b32 v5, 4, v5
    v_lshl_add_u32 v21, v2, 10, v5
    v_add_u32 v21, 3072, v21
    v_xor_b32 v5, 2, v4
    v_lshlrev_b32 v5, 4, v5
    v_lshl_add_u32 v22, v2, 10, v5
    v_add_u32 v22, 6144, v22
    v_xor_b32 v5, 3, v4
    v_lshlrev_b32 v5, 4, v5
    v_lshl_add_u32 v23, v2, 10, v5
    v_add_u32 v23, 9216, v23
    s_lshl_b32 s38, s32, 15
    s_add_u32 s47, s38, 1048576
    s_lshl_b32 s38, s3, 13
    s_add_u32 s47, s38, s47
    v_lshlrev_b32 v6, 7, v2
    v_bfe_u32 v5, v3, 0, 3
    v_lshl_add_u32 v6, v5, 4, v6
    v_lshrrev_b32 v4, 3, v3
    v_and_b32 v7, 3, v3
    v_min_u32 v7, 2, v7
    v_lshl_add_u32 v7, v7, 1, v4
    v_add_u32 v5, 0, v4
    v_cmp_le_u32 vcc, s33, v5
    s_nop 1
    v_addc_co_u32 v5, vcc, 0, v5, vcc
    v_lshl_add_u32 v50, v5, 10, v6
    v_add_u32 v5, 2, v4
    v_cmp_le_u32 vcc, s33, v5
    s_nop 1
    v_addc_co_u32 v5, vcc, 0, v5, vcc
    v_lshl_add_u32 v51, v5, 10, v6
    v_add_u32 v5, 4, v4
    v_cmp_le_u32 vcc, s33, v5
    s_nop 1
    v_addc_co_u32 v5, vcc, 0, v5, vcc
    v_lshl_add_u32 v52, v5, 10, v6
    v_mov_b32 v5, v7
    v_mov_b32 v6, 512
    v_cmp_le_u32 vcc, s33, v5
    s_nop 1
    v_addc_co_u32 v5, vcc, 0, v5, vcc
    v_lshl_add_u32 v53, v5, 10, v6
    s_mul_i32 s38, s3, 320
    s_add_u32 s38, s38, 135168
    v_lshlrev_b32 v4, 6, v2
    v_lshl_add_u32 v4, v3, 1, v4
    v_add_u32 v31, s38, v4
    v_mfma_f32_16x16x32_bf16 v[96:99], a[60:63], v[92:95], v[96:99]
    v_mfma_f32_16x16x32_bf16 v[112:115], a[64:67], v[80:83], 0
    s_waitcnt vmcnt(5)
    buffer_load_dwordx4 v[136:139], v76, s[52:55], s85 offen offset:1024 nt
    v_mfma_f32_16x16x32_bf16 v[112:115], a[68:71], v[84:87], v[112:115]
    v_mfma_f32_16x16x32_bf16 v[112:115], a[72:75], v[88:91], v[112:115]
    s_nop 2
    v_mov_b32_dpp v122, v96 quad_perm:[0,0,0,0] row_mask:0xf bank_mask:0xf
    v_mov_b32_dpp v124, v98 quad_perm:[2,2,2,2] row_mask:0xf bank_mask:0xf
    s_nop 0
    v_add_f32_dpp v122, v97, v122 quad_perm:[1,1,1,1] row_mask:0xf bank_mask:0xf
    v_add_f32_dpp v124, v99, v124 quad_perm:[3,3,3,3] row_mask:0xf bank_mask:0xf
    v_add_f32 v122, v122, v124
    v_max_f32 v65, v65, v122
    ds_write_b32 v64, v122 offset:2816
    v_mfma_f32_16x16x32_bf16 v[112:115], a[76:79], v[92:95], v[112:115]
    v_mfma_f32_16x16x32_bf16 v[96:99], a[80:83], v[80:83], 0
    v_lshlrev_b32 v4, 11, v2
    v_bfe_u32 v5, v1, 2, 2
    v_lshl_add_u32 v4, v5, 8, v4
    v_bfe_u32 v5, v1, 2, 2
    v_lshl_add_u32 v4, v5, 6, v4
    v_bfe_u32 v5, v1, 4, 1
    v_lshl_add_u32 v4, v5, 5, v4
    v_bfe_u32 v5, v1, 1, 1
    v_lshl_add_u32 v4, v5, 4, v4
    v_bfe_u32 v5, v1, 0, 1
    v_lshl_add_u32 v4, v5, 3, v4
    s_lshl_b32 s38, s34, 6
    s_add_u32 s38, s38, 98304
    v_xor_b32 v24, s38, v4
    v_xor_b32 v25, 16, v24
    v_xor_b32 v26, 32, v24
    v_xor_b32 v27, 48, v24
    v_and_b32 v4, 3, v3
    v_lshrrev_b32 v5, 2, v3
    v_lshlrev_b32 v6, 4, v2
    v_add_u32 v6, 135168, v6
    s_movk_i32 s36, 320
    v_cmp_eq_u32 vcc, 0, v5
    s_nop 1
    v_cndmask_b32 v28, 4, v4, vcc
    v_mad_u32_u24 v28, v28, s36, v6
    v_cmp_eq_u32 vcc, 1, v5
    s_nop 1
    v_cndmask_b32 v29, 4, v4, vcc
    v_mad_u32_u24 v29, v29, s36, v6
    v_lshlrev_b32 v5, 2, v1
    v_add_u32 v5, 136448, v5
    v_mov_b32 v6, 0
    ds_write_b32 v5, v6
    s_waitcnt vmcnt(5)
    buffer_load_dwordx4 v[140:143], v77, s[52:55], s85 offen offset:1024 nt
    s_add_u32 s87, s87, 1
    s_add_u32 s39, s87, s88
    s_bfe_u32 s37, s39, 0x10000
    s_lshl_b32 s37, s37, 13
    s_add_u32 s85, s37, s89
    s_bfe_u32 s37, s39, 0x10001
    s_lshl_b32 s37, s37, 12
    s_add_u32 s85, s37, s85
    s_bfe_u32 s37, s39, 0x10002
    s_lshl_b32 s37, s37, 11
    s_add_u32 s85, s37, s85
    s_bfe_u32 s37, s39, 0x10003
    s_lshl_b32 s37, s37, 14
    s_add_u32 s85, s37, s85
    s_bfe_u32 s37, s39, 0x40004
    s_lshl_b32 s37, s37, 16
    s_add_u32 s85, s37, s85
    v_mfma_f32_16x16x32_bf16 v[96:99], a[84:87], v[84:87], v[96:99]
    v_mfma_f32_16x16x32_bf16 v[96:99], a[88:91], v[88:91], v[96:99]
    v_mov_b32_dpp v122, v112 quad_perm:[0,0,0,0] row_mask:0xf bank_mask:0xf
    v_mov_b32_dpp v124, v114 quad_perm:[2,2,2,2] row_mask:0xf bank_mask:0xf
    s_nop 0
    v_add_f32_dpp v122, v113, v122 quad_perm:[1,1,1,1] row_mask:0xf bank_mask:0xf
    v_add_f32_dpp v124, v115, v124 quad_perm:[3,3,3,3] row_mask:0xf bank_mask:0xf
    v_add_f32 v122, v122, v124
    v_max_f32 v65, v65, v122
    ds_write_b32 v64, v122 offset:3072
    v_mfma_f32_16x16x32_bf16 v[96:99], a[92:95], v[92:95], v[96:99]
    s_waitcnt vmcnt(5)
    buffer_load_dwordx4 v[144:147], v76, s[52:55], s85 offen offset:0 nt
    v_mfma_f32_16x16x32_bf16 v[112:115], a[96:99], v[80:83], 0
    v_mfma_f32_16x16x32_bf16 v[112:115], a[100:103], v[84:87], v[112:115]
    v_mfma_f32_16x16x32_bf16 v[112:115], a[104:107], v[88:91], v[112:115]
    s_nop 2
    v_mov_b32_dpp v122, v96 quad_perm:[0,0,0,0] row_mask:0xf bank_mask:0xf
    v_mov_b32_dpp v124, v98 quad_perm:[2,2,2,2] row_mask:0xf bank_mask:0xf
    s_nop 0
    v_add_f32_dpp v122, v97, v122 quad_perm:[1,1,1,1] row_mask:0xf bank_mask:0xf
    v_add_f32_dpp v124, v99, v124 quad_perm:[3,3,3,3] row_mask:0xf bank_mask:0xf
    v_add_f32 v122, v122, v124
    v_max_f32 v65, v65, v122
    ds_write_b32 v64, v122 offset:3328
    v_lshlrev_b32 v30, 4, v3
    v_lshl_add_u32 v30, v2, 13, v30
    v_lshrrev_b32 v5, 2, v1
    v_lshlrev_b32 v32, 8, v5
    v_bfe_u32 v5, v1, 0, 2
    v_lshl_add_u32 v32, v5, 4, v32
    s_xor_b32 s37, s90, 4
    s_bfe_u32 s38, s37, 0x30000
    s_lshl_b32 s38, s38, 8
    s_add_u32 s36, s38, 0
    s_lshr_b32 s38, s32, 4
    s_lshl_b32 s38, s38, 7
    s_add_u32 s36, s38, s36
    s_bfe_u32 s38, s32, 0x20000
    s_lshl_b32 s38, s38, 5
    s_add_u32 s36, s38, s36
    s_bfe_u32 s38, s32, 0x20002
    s_lshl_b32 s38, s38, 3
    s_add_u32 s36, s38, s36
    v_bfe_u32 v5, v1, 0, 2
    v_lshlrev_b32 v33, 11, v5
    v_lshl_add_u32 v33, v2, 1, v33
    v_add_u32 v33, s36, v33
    v_and_b32 v5, 31, v1
    v_lshlrev_b32 v34, 4, v5
    s_mul_i32 s38, s34, 320
    s_add_u32 s38, s38, 135168
    v_lshl_add_u32 v35, v5, 3, s38
    s_bfe_u32 s38, s34, 0x10000
    s_lshl_b32 s38, s38, 12
    s_add_u32 s36, s38, s71
    s_lshr_b32 s38, s34, 1
    s_lshl_b32 s38, s38, 24
    s_add_u32 s36, s38, s36
    s_bitcmp1_b32 s90, 2
    s_cselect_b32 s46, s46, s36
    s_cselect_b64 vcc, -1, 0
    v_cndmask_b32 v54, v32, v34, vcc
    v_mfma_f32_16x16x32_bf16 v[112:115], a[108:111], v[92:95], v[112:115]
    s_waitcnt vmcnt(5)
    buffer_load_dwordx4 v[148:151], v77, s[52:55], s85 offen offset:0 nt
    v_mfma_f32_16x16x32_bf16 v[96:99], a[112:115], v[80:83], 0
    v_mfma_f32_16x16x32_bf16 v[96:99], a[116:119], v[84:87], v[96:99]
    v_mfma_f32_16x16x32_bf16 v[96:99], a[120:123], v[88:91], v[96:99]
    s_nop 2
    v_mov_b32_dpp v122, v112 quad_perm:[0,0,0,0] row_mask:0xf bank_mask:0xf
    v_mov_b32_dpp v124, v114 quad_perm:[2,2,2,2] row_mask:0xf bank_mask:0xf
    s_nop 0
    v_add_f32_dpp v122, v113, v122 quad_perm:[1,1,1,1] row_mask:0xf bank_mask:0xf
    v_add_f32_dpp v124, v115, v124 quad_perm:[3,3,3,3] row_mask:0xf bank_mask:0xf
    v_add_f32 v122, v122, v124
    v_max_f32 v65, v65, v122
    ds_write_b32 v64, v122 offset:3584
    v_mfma_f32_16x16x32_bf16 v[96:99], a[124:127], v[92:95], v[96:99]
    v_add_u32 v64, 3840, v64
    s_mov_b32 s97, 8
    s_mov_b32 s92, 1
    s_lshl_b32 s38, s32, 13
    s_add_u32 s80, s38, 3145728
    s_lshl_b32 s38, s3, 11
    s_add_u32 s80, s38, s80
    v_lshrrev_b32 v4, 2, v1
    v_lshlrev_b32 v55, 3, v4
    s_mov_b32 s66, 134217728
    s_mov_b32 s67, 0x20000
    s_mov_b64 s[64:65], s[52:53]
    v_mov_b32 v62, v76
    v_mov_b32 v63, v77
L_bloop:
    s_waitcnt vmcnt(5)
    buffer_load_dwordx4 v[152:155], v62, s[64:67], s85 offen offset:1024 nt
    v_mfma_f32_16x16x32_bf16 v[112:115], v[128:131], v[80:83], 0
    s_waitcnt vmcnt(5)
    buffer_load_dwordx4 v[156:159], v63, s[64:67], s85 offen offset:1024 nt
    v_mfma_f32_16x16x32_bf16 v[112:115], v[132:135], v[84:87], v[112:115]
    s_cmp_le_u32 s97, 2
    s_cbranch_scc1 L_rare_3
L_back_4:
    s_add_u32 s87, s87, 13
L_done_5:
    s_add_u32 s39, s87, s88
    s_bfe_u32 s37, s39, 0x10000
    s_lshl_b32 s37, s37, 13
    s_add_u32 s85, s37, s89
    s_bfe_u32 s37, s39, 0x10001
    s_lshl_b32 s37, s37, 12
    s_add_u32 s85, s37, s85
    s_bfe_u32 s37, s39, 0x10002
    s_lshl_b32 s37, s37, 11
    s_add_u32 s85, s37, s85
    s_bfe_u32 s37, s39, 0x10003
    s_lshl_b32 s37, s37, 14
    s_add_u32 s85, s37, s85
    s_bfe_u32 s37, s39, 0x40004
    s_lshl_b32 s37, s37, 16
    s_add_u32 s85, s37, s85
    v_mov_b32_dpp v122, v96 quad_perm:[0,0,0,0] row_mask:0xf bank_mask:0xf
    v_mov_b32_dpp v124, v98 quad_perm:[2,2,2,2] row_mask:0xf bank_mask:0xf
    s_nop 0
    v_add_f32_dpp v122, v97, v122 quad_perm:[1,1,1,1] row_mask:0xf bank_mask:0xf
    v_add_f32_dpp v124, v99, v124 quad_perm:[3,3,3,3] row_mask:0xf bank_mask:0xf
    v_add_f32 v122, v122, v124
    v_max_f32 v65, v65, v122
    ds_write_b32 v64, v122 offset:0
    s_waitcnt vmcnt(5)
    buffer_load_dwordx4 v[128:131], v62, s[64:67], s85 offen offset:0 nt
    v_mfma_f32_16x16x32_bf16 v[112:115], v[136:139], v[88:91], v[112:115]
    s_waitcnt vmcnt(5)
    buffer_load_dwordx4 v[132:135], v63, s[64:67], s85 offen offset:0 nt
    v_mfma_f32_16x16x32_bf16 v[112:115], v[140:143], v[92:95], v[112:115]
    s_waitcnt vmcnt(5)
    buffer_load_dwordx4 v[136:139], v62, s[64:67], s85 offen offset:1024 nt
    v_mfma_f32_16x16x32_bf16 v[96:99], v[144:147], v[80:83], 0
    s_waitcnt vmcnt(5)
    buffer_load_dwordx4 v[140:143], v63, s[64:67], s85 offen offset:1024 nt
    v_mfma_f32_16x16x32_bf16 v[96:99], v[148:151], v[84:87], v[96:99]
    s_add_u32 s87, s87, s92
    s_add_u32 s39, s87, s88
    s_bfe_u32 s37, s39, 0x10000
    s_lshl_b32 s37, s37, 13
    s_add_u32 s85, s37, s89
    s_bfe_u32 s37, s39, 0x10001
    s_lshl_b32 s37, s37, 12
    s_add_u32 s85, s37, s85
    s_bfe_u32 s37, s39, 0x10002
    s_lshl_b32 s37, s37, 11
    s_add_u32 s85, s37, s85
    s_bfe_u32 s37, s39, 0x10003
    s_lshl_b32 s37, s37, 14
    s_add_u32 s85, s37, s85
    s_bfe_u32 s37, s39, 0x40004
    s_lshl_b32 s37, s37, 16
    s_add_u32 s85, s37, s85
    v_mov_b32_dpp v122, v112 quad_perm:[0,0,0,0] row_mask:0xf bank_mask:0xf
    v_mov_b32_dpp v124, v114 quad_perm:[2,2,2,2] row_mask:0xf bank_mask:0xf
    s_nop 0
    v_add_f32_dpp v122, v113, v122 quad_perm:[1,1,1,1] row_mask:0xf bank_mask:0xf
    v_add_f32_dpp v124, v115, v124 quad_perm:[3,3,3,3] row_mask:0xf bank_mask:0xf
    v_add_f32 v122, v122, v124
    v_max_f32 v65, v65, v122
    ds_write_b32 v64, v122 offset:256
    s_waitcnt vmcnt(5)
    buffer_load_dwordx4 v[144:147], v62, s[64:67], s85 offen offset:0 nt
    v_mfma_f32_16x16x32_bf16 v[96:99], v[152:155], v[88:91], v[96:99]
    s_waitcnt vmcnt(5)
    buffer_load_dwordx4 v[148:151], v63, s[64:67], s85 offen offset:0 nt
    v_mfma_f32_16x16x32_bf16 v[96:99], v[156:159], v[92:95], v[96:99]
    v_add_u32 v64, 512, v64
    s_sub_u32 s97, s97, 1
    s_cmp_lg_u32 s97, 0
    s_cbranch_scc1 L_bloop
    s_bfe_u32 s38, s2, 0x30000
    s_lshl_b32 s38, s38, 8
    s_add_u32 s69, s38, 32768
    v_lshrrev_b32 v68, 2, v34
    buffer_load_dword v68, v68, s[48:51], s69 offen sc1
    v_mov_b32_dpp v122, v96 quad_perm:[0,0,0,0] row_mask:0xf bank_mask:0xf
    v_mov_b32_dpp v124, v98 quad_perm:[2,2,2,2] row_mask:0xf bank_mask:0xf
    s_nop 0
    v_add_f32_dpp v122, v97, v122 quad_perm:[1,1,1,1] row_mask:0xf bank_mask:0xf
    v_add_f32_dpp v124, v99, v124 quad_perm:[3,3,3,3] row_mask:0xf bank_mask:0xf
    v_add_f32 v122, v122, v124
    v_max_f32 v65, v65, v122
    ds_write_b32 v64, v122 offset:0
    v_mov_b32 v123, 0xff7f0000
    ds_write_b32 v64, v123 offset:256
    s_lshl_b32 s38, s34, 14
    s_add_u32 s38, s38, 16384
    v_lshl_add_u32 v64, v1, 2, s38
    ds_read_b32 v66, v64
    ds_read_b32 v67, v64 offset:256
    v_mul_f32 v65, s83, v65
    s_nop 1
    v_max_f32_dpp v124, v65, v65 row_ror:4 row_mask:0xf bank_mask:0xf
    s_nop 1
    v_max_f32_dpp v124, v124, v124 row_ror:8 row_mask:0xf bank_mask:0xf
    v_mov_b32 v125, v124
    s_nop 1
    v_permlane16_swap_b32 v124, v125
    v_max_f32 v124, v124, v125
    v_mov_b32 v125, v124
    s_nop 1
    v_permlane32_swap_b32 v124, v125
    v_max_f32 v124, v124, v125
    v_mov_b32 v120, v124
    s_mov_b32 s97, 16
    s_waitcnt lgkmcnt(1)
    v_fma_f32 v123, v66, s83, -v120
    v_exp_f32 v123, v123
    ds_read_b32 v66, v64 offset:512
    v_cvt_pk_bf16_f32 v100, v123, v123
    v_add_f32 v121, v121, v123
    v_and_b32 v65, 1, v1
    v_lshl_add_u32 v65, v65, 2, v55
    s_mov_b32 vcc_lo, 0xaaaaaaaa
    s_mov_b32 vcc_hi, 0xaaaaaaaa
    s_cmp_ge_u32 s93, 16
    s_cbranch_scc1 L_kdone
L_kdyn:
    s_lshl_b32 s81, s93, 7
    s_add_u32 s81, s81, s80
    s_waitcnt vmcnt(5)
    buffer_load_dwordx4 v[152:155], v62, s[64:67], s85 offen offset:1024 nt
    v_mfma_f32_16x16x32_bf16 v[112:115], v[128:131], v[80:83], 0
    s_waitcnt vmcnt(5)
    buffer_load_dwordx4 v[156:159], v63, s[64:67], s85 offen offset:1024 nt
    v_mfma_f32_16x16x32_bf16 v[112:115], v[132:135], v[84:87], v[112:115]
    s_cmp_lg_u32 s62, 0
    s_cbranch_scc1 L_nopost_11
    v_add_u32 v19, 1, v19
    s_mov_b64 exec, 1
    ds_write_b32 v0, v19 offset:4
L_nopost_11:
    s_mov_b64 exec, 1
    ds_add_rtn_u32 v5, v0, v18 offset:8
    s_mov_b64 exec, -1
L_again_12:
    ds_read_b32 v4, v0 offset:4
    s_waitcnt lgkmcnt(0)
    v_readfirstlane_b32 s93, v4
    s_nop 0
    s_sub_u32 s93, s93, 1
    s_cbranch_scc1 L_retry_13
    v_add_u32 v0, 8, v0
    s_cmp_ge_u32 s93, 16
    s_cbranch_scc1 L_gone_10
    s_lshl_b32 s87, s93, 1
    s_add_u32 s87, s87, 224
    s_mov_b32 s92, 1
    v_mov_b32 v19, 64
    s_mov_b32 s62, 0
    s_cmp_ge_u32 s93, 15
    s_cbranch_scc1 L_lastone_14
    v_readfirstlane_b32 s62, v5
    s_nop 0
    s_cmp_lg_u32 s62, 0
    s_cbranch_scc1 L_nodraw_15
    s_mov_b64 exec, 1
    global_atomic_add v19, v9, v18, s[30:31] offset:0 sc0 sc1
    s_mov_b64 exec, -1
L_nodraw_15:
L_lastone_14:
L_done_9:
    s_add_u32 s39, s87, s88
    s_bfe_u32 s37, s39, 0x10000
    s_lshl_b32 s37, s37, 13
    s_add_u32 s85, s37, s89
    s_bfe_u32 s37, s39, 0x10001
    s_lshl_b32 s37, s37, 12
    s_add_u32 s85, s37, s85
    s_bfe_u32 s37, s39, 0x10002
    s_lshl_b32 s37, s37, 11
    s_add_u32 s85, s37, s85
    s_bfe_u32 s37, s39, 0x10003
    s_lshl_b32 s37, s37, 14
    s_add_u32 s85, s37, s85
    s_bfe_u32 s37, s39, 0x40004
    s_lshl_b32 s37, s37, 16
    s_add_u32 s85, s37, s85
    s_waitcnt vmcnt(5)
    buffer_load_dwordx4 v[128:131], v62, s[64:67], s85 offen offset:0 nt
    v_mfma_f32_16x16x32_bf16 v[112:115], v[136:139], v[88:91], v[112:115]
    s_waitcnt vmcnt(5)
    buffer_load_dwordx4 v[132:135], v63, s[64:67], s85 offen offset:0 nt
    v_mfma_f32_16x16x32_bf16 v[112:115], v[140:143], v[92:95], v[112:115]
    s_waitcnt vmcnt(5)
    buffer_load_dwordx4 v[136:139], v62, s[64:67], s85 offen offset:1024 nt
    v_mfma_f32_16x16x32_bf16 v[96:99], v[144:147], v[80:83], 0
    s_waitcnt vmcnt(5)
    buffer_load_dwordx4 v[140:143], v63, s[64:67], s85 offen offset:1024 nt
    v_mfma_f32_16x16x32_bf16 v[96:99], v[148:151], v[84:87], v[96:99]
    s_add_u32 s87, s87, s92
    s_add_u32 s39, s87, s88
    s_bfe_u32 s37, s39, 0x10000
    s_lshl_b32 s37, s37, 13
    s_add_u32 s85, s37, s89
    s_bfe_u32 s37, s39, 0x10001
    s_lshl_b32 s37, s37, 12
    s_add_u32 s85, s37, s85
    s_bfe_u32 s37, s39, 0x10002
    s_lshl_b32 s37, s37, 11
    s_add_u32 s85, s37, s85
    s_bfe_u32 s37, s39, 0x10003
    s_lshl_b32 s37, s37, 14
    s_add_u32 s85, s37, s85
    s_bfe_u32 s37, s39, 0x40004
    s_lshl_b32 s37, s37, 16
    s_add_u32 s85, s37, s85
    v_mov_b32_dpp v123, v112 quad_perm:[0,0,0,0] row_mask:0xf bank_mask:0xf
    v_mov_b32_dpp v124, v114 quad_perm:[2,2,2,2] row_mask:0xf bank_mask:0xf
    s_nop 0
    v_add_f32_dpp v123, v113, v123 quad_perm:[1,1,1,1] row_mask:0xf bank_mask:0xf
    v_add_f32_dpp v124, v115, v124 quad_perm:[3,3,3,3] row_mask:0xf bank_mask:0xf
    v_add_f32 v123, v123, v124
    s_waitcnt vmcnt(5)
    buffer_load_dwordx4 v[144:147], v62, s[64:67], s85 offen offset:0 nt
    v_mfma_f32_16x16x32_bf16 v[96:99], v[152:155], v[88:91], v[96:99]
    s_waitcnt vmcnt(5)
    buffer_load_dwordx4 v[148:151], v63, s[64:67], s85 offen offset:0 nt
    v_mfma_f32_16x16x32_bf16 v[96:99], v[156:159], v[92:95], v[96:99]
    s_nop 7
    v_mov_b32_dpp v122, v96 quad_perm:[0,0,0,0] row_mask:0xf bank_mask:0xf
    v_mov_b32_dpp v124, v98 quad_perm:[2,2,2,2] row_mask:0xf bank_mask:0xf
    s_nop 0
    v_add_f32_dpp v122, v97, v122 quad_perm:[1,1,1,1] row_mask:0xf bank_mask:0xf
    v_add_f32_dpp v124, v99, v124 quad_perm:[3,3,3,3] row_mask:0xf bank_mask:0xf
    v_add_f32 v122, v122, v124
    v_cndmask_b32 v123, v123, v122, vcc
    v_and_or_b32 v123, v123, s82, v8
    s_mov_b32 exec_lo, 0x33333333
    s_mov_b32 exec_hi, 0x33333333
    buffer_store_dword v123, v65, s[48:51], s81 offen sc1
    s_mov_b64 exec, -1
    s_cmp_lt_u32 s93, 16
    s_cbranch_scc1 L_kdyn
L_kdone:
L_vloop:
    v_and_b32_dpp v104, v100, v10 row_newbcast:0 row_mask:0xf bank_mask:0xf
    v_and_b32_dpp v105, v100, v11 row_newbcast:0 row_mask:0xf bank_mask:0xf
    v_and_b32_dpp v106, v100, v12 row_newbcast:0 row_mask:0xf bank_mask:0xf
    v_and_b32_dpp v107, v100, v13 row_newbcast:0 row_mask:0xf bank_mask:0xf
    s_waitcnt vmcnt(5)
    buffer_load_dwordx4 v[152:155], v62, s[64:67], s85 offen offset:1024 nt
    v_mfma_f32_16x16x32_bf16 v[116:119], v[128:131], v[104:107], v[116:119]
    v_and_b32_dpp v108, v100, v10 row_newbcast:4 row_mask:0xf bank_mask:0xf
    v_and_b32_dpp v109, v100, v11 row_newbcast:4 row_mask:0xf bank_mask:0xf
    v_and_b32_dpp v110, v100, v12 row_newbcast:4 row_mask:0xf bank_mask:0xf
    v_and_b32_dpp v111, v100, v13 row_newbcast:4 row_mask:0xf bank_mask:0xf
    s_waitcnt vmcnt(5)
    buffer_load_dwordx4 v[156:159], v63, s[64:67], s85 offen offset:1024 nt
    v_mfma_f32_16x16x32_bf16 v[116:119], v[132:135], v[108:111], v[116:119]
    s_cmp_le_u32 s97, 2
    s_cbranch_scc1 L_rare_16
L_back_17:
    s_add_u32 s87, s87, 13
L_done_18:
    s_add_u32 s39, s87, s88
    s_bfe_u32 s37, s39, 0x10000
    s_lshl_b32 s37, s37, 13
    s_add_u32 s85, s37, s89
    s_bfe_u32 s37, s39, 0x10001
    s_lshl_b32 s37, s37, 12
    s_add_u32 s85, s37, s85
    s_bfe_u32 s37, s39, 0x10002
    s_lshl_b32 s37, s37, 11
    s_add_u32 s85, s37, s85
    s_bfe_u32 s37, s39, 0x10003
    s_lshl_b32 s37, s37, 14
    s_add_u32 s85, s37, s85
    s_bfe_u32 s37, s39, 0x40004
    s_lshl_b32 s37, s37, 16
    s_add_u32 s85, s37, s85
    s_waitcnt lgkmcnt(1)
    v_fma_f32 v123, v67, s83, -v120
    v_exp_f32 v123, v123
    ds_read_b32 v67, v64 offset:768
    v_cvt_pk_bf16_f32 v101, v123, v123
    v_add_f32 v121, v121, v123
    v_and_b32_dpp v104, v100, v10 row_newbcast:8 row_mask:0xf bank_mask:0xf
    v_and_b32_dpp v105, v100, v11 row_newbcast:8 row_mask:0xf bank_mask:0xf
    v_and_b32_dpp v106, v100, v12 row_newbcast:8 row_mask:0xf bank_mask:0xf
    v_and_b32_dpp v107, v100, v13 row_newbcast:8 row_mask:0xf bank_mask:0xf
    s_waitcnt vmcnt(5)
    buffer_load_dwordx4 v[128:131], v62, s[64:67], s85 offen offset:0 nt
    v_mfma_f32_16x16x32_bf16 v[116:119], v[136:139], v[104:107], v[116:119]
    v_and_b32_dpp v108, v100, v10 row_newbcast:12 row_mask:0xf bank_mask:0xf
    v_and_b32_dpp v109, v100, v11 row_newbcast:12 row_mask:0xf bank_mask:0xf
    v_and_b32_dpp v110, v100, v12 row_newbcast:12 row_mask:0xf bank_mask:0xf
    v_and_b32_dpp v111, v100, v13 row_newbcast:12 row_mask:0xf bank_mask:0xf
    s_waitcnt vmcnt(5)
    buffer_load_dwordx4 v[132:135], v63, s[64:67], s85 offen offset:0 nt
    v_mfma_f32_16x16x32_bf16 v[116:119], v[140:143], v[108:111], v[116:119]
    v_and_b32_dpp v104, v101, v10 row_newbcast:0 row_mask:0xf bank_mask:0xf
    v_and_b32_dpp v105, v101, v11 row_newbcast:0 row_mask:0xf bank_mask:0xf
    v_and_b32_dpp v106, v101, v12 row_newbcast:0 row_mask:0xf bank_mask:0xf
    v_and_b32_dpp v107, v101, v13 row_newbcast:0 row_mask:0xf bank_mask:0xf
    s_waitcnt vmcnt(5)
    buffer_load_dwordx4 v[136:139], v62, s[64:67], s85 offen offset:1024 nt
    v_mfma_f32_16x16x32_bf16 v[116:119], v[144:147], v[104:107], v[116:119]
    v_and_b32_dpp v108, v101, v10 row_newbcast:4 row_mask:0xf bank_mask:0xf
    v_and_b32_dpp v109, v101, v11 row_newbcast:4 row_mask:0xf bank_mask:0xf
    v_and_b32_dpp v110, v101, v12 row_newbcast:4 row_mask:0xf bank_mask:0xf
    v_and_b32_dpp v111, v101, v13 row_newbcast:4 row_mask:0xf bank_mask:0xf
    s_waitcnt vmcnt(5)
    buffer_load_dwordx4 v[140:143], v63, s[64:67], s85 offen offset:1024 nt
    v_mfma_f32_16x16x32_bf16 v[116:119], v[148:151], v[108:111], v[116:119]
    s_add_u32 s87, s87, s92
    s_add_u32 s39, s87, s88
    s_bfe_u32 s37, s39, 0x10000
    s_lshl_b32 s37, s37, 13
    s_add_u32 s85, s37, s89
    s_bfe_u32 s37, s39, 0x10001
    s_lshl_b32 s37, s37, 12
    s_add_u32 s85, s37, s85
    s_bfe_u32 s37, s39, 0x10002
    s_lshl_b32 s37, s37, 11
    s_add_u32 s85, s37, s85
    s_bfe_u32 s37, s39, 0x10003
    s_lshl_b32 s37, s37, 14
    s_add_u32 s85, s37, s85
    s_bfe_u32 s37, s39, 0x40004
    s_lshl_b32 s37, s37, 16
    s_add_u32 s85, s37, s85
    v_add_u32 v64, 512, v64
    s_waitcnt lgkmcnt(1)
    v_fma_f32 v123, v66, s83, -v120
    v_exp_f32 v123, v123
    ds_read_b32 v66, v64 offset:512
    v_cvt_pk_bf16_f32 v100, v123, v123
    v_add_f32 v121, v121, v123
    v_and_b32_dpp v104, v101, v10 row_newbcast:8 row_mask:0xf bank_mask:0xf
    v_and_b32_dpp v105, v101, v11 row_newbcast:8 row_mask:0xf bank_mask:0xf
    v_and_b32_dpp v106, v101, v12 row_newbcast:8 row_mask:0xf bank_mask:0xf
    v_and_b32_dpp v107, v101, v13 row_newbcast:8 row_mask:0xf bank_mask:0xf
    s_waitcnt vmcnt(5)
    buffer_load_dwordx4 v[144:147], v62, s[64:67], s85 offen offset:0 nt
    v_mfma_f32_16x16x32_bf16 v[116:119], v[152:155], v[104:107], v[116:119]
    v_and_b32_dpp v108, v101, v10 row_newbcast:12 row_mask:0xf bank_mask:0xf
    v_and_b32_dpp v109, v101, v11 row_newbcast:12 row_mask:0xf bank_mask:0xf
    v_and_b32_dpp v110, v101, v12 row_newbcast:12 row_mask:0xf bank_mask:0xf
    v_and_b32_dpp v111, v101, v13 row_newbcast:12 row_mask:0xf bank_mask:0xf
    s_waitcnt vmcnt(5)
    buffer_load_dwordx4 v[148:151], v63, s[64:67], s85 offen offset:0 nt
    v_mfma_f32_16x16x32_bf16 v[116:119], v[156:159], v[108:111], v[116:119]
    s_sub_u32 s97, s97, 1
    s_cmp_lg_u32 s97, 0
    s_cbranch_scc1 L_vloop
    buffer_load_dwordx4 v[152:155], v62, s[64:67], s85 offen offset:1024 nt
    v_cmp_ne_u32 vcc, s70, v68
    s_nop 0
    s_cmp_eq_u64 vcc, 0
    s_cselect_b32 s70, 1, 0
    s_cmp_ge_u32 s93, 16
    s_cbranch_scc1 L_none
L_vdyn:
    s_waitcnt vmcnt(6)
    buffer_load_dwordx4 v[156:159], v63, s[64:67], s85 offen offset:1024 nt
L_sccheck:
    v_xor_b32 v102, s35, v102
    v_xor_b32 v103, s35, v103
    v_or_b32 v4, v102, v103
    v_and_b32 v4, 0xff, v4
    v_cmp_ne_u32 vcc, 0, v4
    v_fma_f32 v123, v102, s83, -v120
    v_fma_f32 v122, v103, s83, -v120
    s_cbranch_vccnz L_scretry
    v_max_f32 v124, v123, v122
    v_cmp_lt_f32 vcc, 0, v124
    s_cbranch_vccnz L_newmax
L_oldmax:
    v_exp_f32 v123, v123
    v_exp_f32 v122, v122
    v_cvt_pk_bf16_f32 v100, v123, v123
    v_add_f32 v121, v121, v123
    v_cvt_pk_bf16_f32 v101, v122, v122
    v_add_f32 v121, v121, v122
    s_cmp_lg_u32 s62, 0
    s_cbranch_scc1 L_nopost_20
    v_add_u32 v19, 1, v19
    s_mov_b64 exec, 1
    ds_write_b32 v0, v19 offset:4
L_nopost_20:
    s_mov_b64 exec, 1
    ds_add_rtn_u32 v5, v0, v18 offset:8
    s_mov_b64 exec, -1
L_again_21:
    ds_read_b32 v4, v0 offset:4
    s_waitcnt lgkmcnt(0)
    v_readfirstlane_b32 s93, v4
    s_nop 0
    s_sub_u32 s93, s93, 1
    s_cbranch_scc1 L_retry_22
    v_add_u32 v0, 8, v0
    s_cmp_ge_u32 s93, 16
    s_cbranch_scc1 L_last
    s_lshl_b32 s81, s93, 7
    s_add_u32 s81, s81, s80
    buffer_load_dwordx2 v[102:103], v55, s[48:51], s81 offen sc1
    s_lshl_b32 s87, s93, 1
    s_add_u32 s87, s87, 224
    s_mov_b32 s92, 1
    v_mov_b32 v19, 64
    s_mov_b32 s62, 0
    s_cmp_ge_u32 s93, 15
    s_cbranch_scc1 L_lastone_23
    v_readfirstlane_b32 s62, v5
    s_nop 0
    s_cmp_lg_u32 s62, 0
    s_cbranch_scc1 L_nodraw_24
    s_mov_b64 exec, 1
    global_atomic_add v19, v9, v18, s[30:31] offset:4 sc0 sc1
    s_mov_b64 exec, -1
L_nodraw_24:
L_lastone_23:
    s_add_u32 s39, s87, s88
    s_bfe_u32 s37, s39, 0x10000
    s_lshl_b32 s37, s37, 13
    s_add_u32 s85, s37, s89
    s_bfe_u32 s37, s39, 0x10001
    s_lshl_b32 s37, s37, 12
    s_add_u32 s85, s37, s85
    s_bfe_u32 s37, s39, 0x10002
    s_lshl_b32 s37, s37, 11
    s_add_u32 s85, s37, s85
    s_bfe_u32 s37, s39, 0x10003
    s_lshl_b32 s37, s37, 14
    s_add_u32 s85, s37, s85
    s_bfe_u32 s37, s39, 0x40004
    s_lshl_b32 s37, s37, 16
    s_add_u32 s85, s37, s85
    v_and_b32_dpp v104, v100, v10 row_newbcast:0 row_mask:0xf bank_mask:0xf
    v_and_b32_dpp v105, v100, v11 row_newbcast:0 row_mask:0xf bank_mask:0xf
    v_and_b32_dpp v106, v100, v12 row_newbcast:0 row_mask:0xf bank_mask:0xf
    v_and_b32_dpp v107, v100, v13 row_newbcast:0 row_mask:0xf bank_mask:0xf
    s_nop 1
    v_mfma_f32_16x16x32_bf16 v[116:119], v[128:131], v[104:107], v[116:119]
    v_and_b32_dpp v108, v100, v10 row_newbcast:4 row_mask:0xf bank_mask:0xf
    v_and_b32_dpp v109, v100, v11 row_newbcast:4 row_mask:0xf bank_mask:0xf
    v_and_b32_dpp v110, v100, v12 row_newbcast:4 row_mask:0xf bank_mask:0xf
    v_and_b32_dpp v111, v100, v13 row_newbcast:4 row_mask:0xf bank_mask:0xf
    s_waitcnt vmcnt(7)
    buffer_load_dwordx4 v[128:131], v62, s[64:67], s85 offen offset:0 nt
    v_mfma_f32_16x16x32_bf16 v[116:119], v[132:135], v[108:111], v[116:119]
    v_and_b32_dpp v104, v100, v10 row_newbcast:8 row_mask:0xf bank_mask:0xf
    v_and_b32_dpp v105, v100, v11 row_newbcast:8 row_mask:0xf bank_mask:0xf
    v_and_b32_dpp v106, v100, v12 row_newbcast:8 row_mask:0xf bank_mask:0xf
    v_and_b32_dpp v107, v100, v13 row_newbcast:8 row_mask:0xf bank_mask:0xf
    s_waitcnt vmcnt(7)
    buffer_load_dwordx4 v[132:135], v63, s[64:67], s85 offen offset:0 nt
    v_mfma_f32_16x16x32_bf16 v[116:119], v[136:139], v[104:107], v[116:119]
    v_and_b32_dpp v108, v100, v10 row_newbcast:12 row_mask:0xf bank_mask:0xf
    v_and_b32_dpp v109, v100, v11 row_newbcast:12 row_mask:0xf bank_mask:0xf
    v_and_b32_dpp v110, v100, v12 row_newbcast:12 row_mask:0xf bank_mask:0xf
    v_and_b32_dpp v111, v100, v13 row_newbcast:12 row_mask:0xf bank_mask:0xf
    s_waitcnt vmcnt(7)
    buffer_load_dwordx4 v[136:139], v62, s[64:67], s85 offen offset:1024 nt
    v_mfma_f32_16x16x32_bf16 v[116:119], v[140:143], v[108:111], v[116:119]
    v_and_b32_dpp v104, v101, v10 row_newbcast:0 row_mask:0xf bank_mask:0xf
    v_and_b32_dpp v105, v101, v11 row_newbcast:0 row_mask:0xf bank_mask:0xf
    v_and_b32_dpp v106, v101, v12 row_newbcast:0 row_mask:0xf bank_mask:0xf
    v_and_b32_dpp v107, v101, v13 row_newbcast:0 row_mask:0xf bank_mask:0xf
    s_waitcnt vmcnt(7)
    buffer_load_dwordx4 v[140:143], v63, s[64:67], s85 offen offset:1024 nt
    v_mfma_f32_16x16x32_bf16 v[116:119], v[144:147], v[104:107], v[116:119]
    s_add_u32 s87, s87, s92
    s_add_u32 s39, s87, s88
    s_bfe_u32 s37, s39, 0x10000
    s_lshl_b32 s37, s37, 13
    s_add_u32 s85, s37, s89
    s_bfe_u32 s37, s39, 0x10001
    s_lshl_b32 s37, s37, 12
    s_add_u32 s85, s37, s85
    s_bfe_u32 s37, s39, 0x10002
    s_lshl_b32 s37, s37, 11
    s_add_u32 s85, s37, s85
    s_bfe_u32 s37, s39, 0x10003
    s_lshl_b32 s37, s37, 14
    s_add_u32 s85, s37, s85
    s_bfe_u32 s37, s39, 0x40004
    s_lshl_b32 s37, s37, 16
    s_add_u32 s85, s37, s85
    v_and_b32_dpp v108, v101, v10 row_newbcast:4 row_mask:0xf bank_mask:0xf
    v_and_b32_dpp v109, v101, v11 row_newbcast:4 row_mask:0xf bank_mask:0xf
    v_and_b32_dpp v110, v101, v12 row_newbcast:4 row_mask:0xf bank_mask:0xf
    v_and_b32_dpp v111, v101, v13 row_newbcast:4 row_mask:0xf bank_mask:0xf
    s_waitcnt vmcnt(7)
    buffer_load_dwordx4 v[144:147], v62, s[64:67], s85 offen offset:0 nt
    v_mfma_f32_16x16x32_bf16 v[116:119], v[148:151], v[108:111], v[116:119]
    v_and_b32_dpp v104, v101, v10 row_newbcast:8 row_mask:0xf bank_mask:0xf
    v_and_b32_dpp v105, v101, v11 row_newbcast:8 row_mask:0xf bank_mask:0xf
    v_and_b32_dpp v106, v101, v12 row_newbcast:8 row_mask:0xf bank_mask:0xf
    v_and_b32_dpp v107, v101, v13 row_newbcast:8 row_mask:0xf bank_mask:0xf
    s_waitcnt vmcnt(7)
    buffer_load_dwordx4 v[148:151], v63, s[64:67], s85 offen offset:0 nt
    v_mfma_f32_16x16x32_bf16 v[116:119], v[152:155], v[104:107], v[116:119]
    v_and_b32_dpp v108, v101, v10 row_newbcast:12 row_mask:0xf bank_mask:0xf
    v_and_b32_dpp v109, v101, v11 row_newbcast:12 row_mask:0xf bank_mask:0xf
    v_and_b32_dpp v110, v101, v12 row_newbcast:12 row_mask:0xf bank_mask:0xf
    v_and_b32_dpp v111, v101, v13 row_newbcast:12 row_mask:0xf bank_mask:0xf
    s_waitcnt vmcnt(7)
    buffer_load_dwordx4 v[152:155], v62, s[64:67], s85 offen offset:1024 nt
    v_mfma_f32_16x16x32_bf16 v[116:119], v[156:159], v[108:111], v[116:119]
    s_branch L_vdyn
L_scretry:
    buffer_load_dwordx2 v[102:103], v55, s[48:51], s81 offen sc1
    s_waitcnt vmcnt(0)
    s_sub_u32 s84, s84, 1
    s_cmp_lg_u32 s84, 0
    s_cbranch_scc1 L_sccheck
    s_branch L_end
L_newmax:
    v_max_f32 v123, v102, v103
    v_mul_f32 v123, s83, v123
    s_nop 1
    v_max_f32_dpp v124, v123, v123 row_ror:4 row_mask:0xf bank_mask:0xf
    s_nop 1
    v_max_f32_dpp v124, v124, v124 row_ror:8 row_mask:0xf bank_mask:0xf
    v_mov_b32 v125, v124
    s_nop 1
    v_permlane16_swap_b32 v124, v125
    v_max_f32 v124, v124, v125
    v_mov_b32 v125, v124
    s_nop 1
    v_permlane32_swap_b32 v124, v125
    v_max_f32 v124, v124, v125
    v_max_f32 v124, v124, v120
    v_sub_f32 v125, v120, v124
    v_exp_f32 v125, v125
    v_mov_b32 v120, v124
    v_fma_f32 v123, v102, s83, -v120
    v_fma_f32 v122, v103, s83, -v120
    v_mul_f32 v121, v121, v125
    v_mul_f32 v116, v116, v125
    v_mul_f32 v117, v117, v125
    v_mul_f32 v118, v118, v125
    v_mul_f32 v119, v119, v125
    s_branch L_oldmax
L_rare_3:
    s_cmp_eq_u32 s97, 1
    s_cbranch_scc1 L_last_25
    s_mov_b64 exec, 1
    ds_add_rtn_u32 v5, v0, v18 offset:0
    s_mov_b64 exec, -1
    s_waitcnt lgkmcnt(0)
    v_readfirstlane_b32 s62, v5
    s_nop 0
    s_cmp_lg_u32 s62, 0
    s_cbranch_scc1 L_nodraw_26
    s_mov_b64 exec, 1
    global_atomic_add v19, v9, v18, s[30:31] offset:0 sc0 sc1
    s_mov_b64 exec, -1
L_nodraw_26:
    s_branch L_back_4
L_last_25:
    s_cmp_lg_u32 s62, 0
    s_cbranch_scc1 L_nopost_27
    v_add_u32 v19, 1, v19
    s_mov_b64 exec, 1
    ds_write_b32 v0, v19 offset:4
L_nopost_27:
    s_mov_b64 exec, 1
    ds_add_rtn_u32 v5, v0, v18 offset:8
    s_mov_b64 exec, -1
L_again_28:
    ds_read_b32 v4, v0 offset:4
    s_waitcnt lgkmcnt(0)
    v_readfirstlane_b32 s93, v4
    s_nop 0
    s_sub_u32 s93, s93, 1
    s_cbranch_scc1 L_retry_29
    v_add_u32 v0, 8, v0
    s_cmp_ge_u32 s93, 16
    s_cbranch_scc1 L_gone_6
    s_lshl_b32 s87, s93, 1
    s_add_u32 s87, s87, 224
    s_mov_b32 s92, 1
    v_mov_b32 v19, 64
    s_mov_b32 s62, 0
    s_cmp_ge_u32 s93, 15
    s_cbranch_scc1 L_lastone_30
    v_readfirstlane_b32 s62, v5
    s_nop 0
    s_cmp_lg_u32 s62, 0
    s_cbranch_scc1 L_nodraw_31
    s_mov_b64 exec, 1
    global_atomic_add v19, v9, v18, s[30:31] offset:0 sc0 sc1
    s_mov_b64 exec, -1
L_nodraw_31:
L_lastone_30:
    s_branch L_done_5
L_gone_6:
    s_mov_b64 s[64:65], s[56:57]
    v_mov_b32 v62, v126
    v_mov_b32 v63, v127
    s_lshl_b32 s87, s33, 1
    s_mov_b32 s92, 1
    v_add_u32 v0, 8, v0
    s_branch L_done_5
L_retry_13:
    s_sub_u32 s84, s84, 1
    s_cmp_lg_u32 s84, 0
    s_cbranch_scc1 L_again_12
    s_branch L_end
L_gone_10:
    s_mov_b64 s[64:65], s[56:57]
    v_mov_b32 v62, v126
    v_mov_b32 v63, v127
    s_lshl_b32 s87, s33, 1
    s_mov_b32 s92, 1
    v_add_u32 v0, 8, v0
    s_branch L_done_9
L_rare_16:
    s_cmp_eq_u32 s97, 1
    s_cbranch_scc1 L_last_32
    s_mov_b64 exec, 1
    ds_add_rtn_u32 v5, v0, v18 offset:0
    s_mov_b64 exec, -1
    s_waitcnt lgkmcnt(0)
    v_readfirstlane_b32 s62, v5
    s_nop 0
    s_cmp_lg_u32 s62, 0
    s_cbranch_scc1 L_nodraw_33
    s_mov_b64 exec, 1
    global_atomic_add v19, v9, v18, s[30:31] offset:4 sc0 sc1
    s_mov_b64 exec, -1
L_nodraw_33:
    s_branch L_back_17
L_last_32:
    s_cmp_lg_u32 s62, 0
    s_cbranch_scc1 L_nopost_34
    v_add_u32 v19, 1, v19
    s_mov_b64 exec, 1
    ds_write_b32 v0, v19 offset:4
L_nopost_34:
    s_mov_b64 exec, 1
    ds_add_rtn_u32 v5, v0, v18 offset:8
    s_mov_b64 exec, -1
L_again_35:
    ds_read_b32 v4, v0 offset:4
    s_waitcnt lgkmcnt(0)
    v_readfirstlane_b32 s93, v4
    s_nop 0
    s_sub_u32 s93, s93, 1
    s_cbranch_scc1 L_retry_36
    v_add_u32 v0, 8, v0
    s_cmp_ge_u32 s93, 16
    s_cbranch_scc1 L_gone_19
    s_lshl_b32 s81, s93, 7
    s_add_u32 s81, s81, s80
    buffer_load_dwordx2 v[102:103], v55, s[48:51], s81 offen sc1
    s_lshl_b32 s87, s93, 1
    s_add_u32 s87, s87, 224
    s_mov_b32 s92, 1
    v_mov_b32 v19, 64
    s_mov_b32 s62, 0
    s_cmp_ge_u32 s93, 15
    s_cbranch_scc1 L_lastone_37
    v_readfirstlane_b32 s62, v5
    s_nop 0
    s_cmp_lg_u32 s62, 0
    s_cbranch_scc1 L_nodraw_38
    s_mov_b64 exec, 1
    global_atomic_add v19, v9, v18, s[30:31] offset:4 sc0 sc1
    s_mov_b64 exec, -1
L_nodraw_38:
L_lastone_37:
    s_branch L_done_18
L_gone_19:
    s_mov_b32 s89, 134217728
    s_branch L_done_18
L_retry_22:
    s_sub_u32 s84, s84, 1
    s_cmp_lg_u32 s84, 0
    s_cbranch_scc1 L_again_21
    s_branch L_end
L_retry_29:
    s_sub_u32 s84, s84, 1
    s_cmp_lg_u32 s84, 0
    s_cbranch_scc1 L_again_28
    s_branch L_end
L_retry_36:
    s_sub_u32 s84, s84, 1
    s_cmp_lg_u32 s84, 0
    s_cbranch_scc1 L_again_35
    s_branch L_end
L_none:
    buffer_load_dwordx4 v[224:227], v54, s[48:51], s46 offen sc1
    s_mov_b32 s86, s44
    s_bitcmp1_b32 s90, 2
    s_cselect_b32 s44, 4194304, s44
    s_lshl_b32 s39, s34, 13
    s_add_u32 s39, s39, 98304
    s_mov_b32 m0, s39
    s_nop 0
    buffer_load_dwordx4 v20, s[40:43], s44 offen offset:0 nt lds
    buffer_load_dwordx4 v21, s[40:43], s44 offen offset:1024 nt lds
    buffer_load_dwordx4 v22, s[40:43], s44 offen offset:2048 nt lds
    buffer_load_dwordx4 v23, s[40:43], s44 offen offset:3072 nt lds
    s_lshl_b32 s39, s34, 13
    s_add_u32 s39, s39, 102400
    s_mov_b32 m0, s39
    s_add_u32 s44, s44, 16384
    buffer_load_dwordx4 v20, s[40:43], s44 offen offset:0 nt lds
    buffer_load_dwordx4 v21, s[40:43], s44 offen offset:1024 nt lds
    v_add_f32_dpp v121, v121, v121 row_ror:8 row_mask:0xf bank_mask:0xf
    s_nop 1
    v_add_f32_dpp v121, v121, v121 row_ror:4 row_mask:0xf bank_mask:0xf
    v_mov_b32 v125, v121
    s_nop 1
    v_permlane16_swap_b32 v121, v125
    v_add_f32 v121, v121, v125
    v_mov_b32 v125, v121
    s_nop 1
    v_permlane32_swap_b32 v121, v125
    v_add_f32 v121, v121, v125
    v_and_b32 v125, s82, v120
    v_sub_f32 v125, v120, v125
    s_mov_b32 vcc_lo, 0xff00ff00
    s_mov_b32 vcc_hi, 0xff00ff00
    s_branch L_bdone
L_last:
    buffer_load_dwordx4 v[224:227], v54, s[48:51], s46 offen sc1
    s_mov_b32 s86, s44
    s_bitcmp1_b32 s90, 2
    s_cselect_b32 s44, 4194304, s44
    v_and_b32_dpp v104, v100, v10 row_newbcast:0 row_mask:0xf bank_mask:0xf
    v_and_b32_dpp v105, v100, v11 row_newbcast:0 row_mask:0xf bank_mask:0xf
    v_and_b32_dpp v106, v100, v12 row_newbcast:0 row_mask:0xf bank_mask:0xf
    v_and_b32_dpp v107, v100, v13 row_newbcast:0 row_mask:0xf bank_mask:0xf
    s_lshl_b32 s39, s34, 13
    s_add_u32 s39, s39, 98304
    s_mov_b32 m0, s39
    s_nop 0
    buffer_load_dwordx4 v20, s[40:43], s44 offen offset:0 nt lds
    v_mfma_f32_16x16x32_bf16 v[116:119], v[128:131], v[104:107], v[116:119]
    v_and_b32_dpp v108, v100, v10 row_newbcast:4 row_mask:0xf bank_mask:0xf
    v_and_b32_dpp v109, v100, v11 row_newbcast:4 row_mask:0xf bank_mask:0xf
    v_and_b32_dpp v110, v100, v12 row_newbcast:4 row_mask:0xf bank_mask:0xf
    v_and_b32_dpp v111, v100, v13 row_newbcast:4 row_mask:0xf bank_mask:0xf
    s_waitcnt vmcnt(8)
    buffer_load_dwordx4 v21, s[40:43], s44 offen offset:1024 nt lds
    v_mfma_f32_16x16x32_bf16 v[116:119], v[132:135], v[108:111], v[116:119]
    v_add_f32_dpp v121, v121, v121 row_ror:8 row_mask:0xf bank_mask:0xf
    s_nop 1
    v_add_f32_dpp v121, v121, v121 row_ror:4 row_mask:0xf bank_mask:0xf
    v_mov_b32 v125, v121
    s_nop 1
    v_permlane16_swap_b32 v121, v125
    v_add_f32 v121, v121, v125
    v_mov_b32 v125, v121
    s_nop 1
    v_permlane32_swap_b32 v121, v125
    v_add_f32 v121, v121, v125
    v_and_b32 v125, s82, v120
    v_sub_f32 v125, v120, v125
    s_mov_b32 vcc_lo, 0xff00ff00
    s_mov_b32 vcc_hi, 0xff00ff00
    v_and_b32_dpp v104, v100, v10 row_newbcast:8 row_mask:0xf bank_mask:0xf
    v_and_b32_dpp v105, v100, v11 row_newbcast:8 row_mask:0xf bank_mask:0xf
    v_and_b32_dpp v106, v100, v12 row_newbcast:8 row_mask:0xf bank_mask:0xf
    v_and_b32_dpp v107, v100, v13 row_newbcast:8 row_mask:0xf bank_mask:0xf
    s_waitcnt vmcnt(8)
    buffer_load_dwordx4 v22, s[40:43], s44 offen offset:2048 nt lds
    v_mfma_f32_16x16x32_bf16 v[116:119], v[136:139], v[104:107], v[116:119]
    v_and_b32_dpp v108, v100, v10 row_newbcast:12 row_mask:0xf bank_mask:0xf
    v_and_b32_dpp v109, v100, v11 row_newbcast:12 row_mask:0xf bank_mask:0xf
    v_and_b32_dpp v110, v100, v12 row_newbcast:12 row_mask:0xf bank_mask:0xf
    v_and_b32_dpp v111, v100, v13 row_newbcast:12 row_mask:0xf bank_mask:0xf
    s_waitcnt vmcnt(8)
    buffer_load_dwordx4 v23, s[40:43], s44 offen offset:3072 nt lds
    v_mfma_f32_16x16x32_bf16 v[116:119], v[140:143], v[108:111], v[116:119]
    v_and_b32_dpp v104, v101, v10 row_newbcast:0 row_mask:0xf bank_mask:0xf
    v_and_b32_dpp v105, v101, v11 row_newbcast:0 row_mask:0xf bank_mask:0xf
    v_and_b32_dpp v106, v101, v12 row_newbcast:0 row_mask:0xf bank_mask:0xf
    v_and_b32_dpp v107, v101, v13 row_newbcast:0 row_mask:0xf bank_mask:0xf
    s_waitcnt vmcnt(8)
    s_lshl_b32 s39, s34, 13
    s_add_u32 s39, s39, 102400
    s_mov_b32 m0, s39
    s_add_u32 s44, s44, 16384
    buffer_load_dwordx4 v20, s[40:43], s44 offen offset:0 nt lds
    v_mfma_f32_16x16x32_bf16 v[116:119], v[144:147], v[104:107], v[116:119]
    v_and_b32_dpp v108, v101, v10 row_newbcast:4 row_mask:0xf bank_mask:0xf
    v_and_b32_dpp v109, v101, v11 row_newbcast:4 row_mask:0xf bank_mask:0xf
    v_and_b32_dpp v110, v101, v12 row_newbcast:4 row_mask:0xf bank_mask:0xf
    v_and_b32_dpp v111, v101, v13 row_newbcast:4 row_mask:0xf bank_mask:0xf
    s_waitcnt vmcnt(8)
    buffer_load_dwordx4 v21, s[40:43], s44 offen offset:1024 nt lds
    v_mfma_f32_16x16x32_bf16 v[116:119], v[148:151], v[108:111], v[116:119]
    v_and_b32_dpp v104, v101, v10 row_newbcast:8 row_mask:0xf bank_mask:0xf
    v_and_b32_dpp v105, v101, v11 row_newbcast:8 row_mask:0xf bank_mask:0xf
    v_and_b32_dpp v106, v101, v12 row_newbcast:8 row_mask:0xf bank_mask:0xf
    v_and_b32_dpp v107, v101, v13 row_newbcast:8 row_mask:0xf bank_mask:0xf
    s_waitcnt vmcnt(8)
    s_nop 0
    v_mfma_f32_16x16x32_bf16 v[116:119], v[152:155], v[104:107], v[116:119]
    v_and_b32_dpp v108, v101, v10 row_newbcast:12 row_mask:0xf bank_mask:0xf
    v_and_b32_dpp v109, v101, v11 row_newbcast:12 row_mask:0xf bank_mask:0xf
    v_and_b32_dpp v110, v101, v12 row_newbcast:12 row_mask:0xf bank_mask:0xf
    v_and_b32_dpp v111, v101, v13 row_newbcast:12 row_mask:0xf bank_mask:0xf
    s_waitcnt vmcnt(7)
    s_nop 0
    v_mfma_f32_16x16x32_bf16 v[116:119], v[156:159], v[108:111], v[116:119]
L_bdone:
    s_nop 7
    v_cndmask_b32 v116, v116, v120, vcc
    v_cndmask_b32 v117, v117, v121, vcc
    v_cndmask_b32 v118, v118, v125, vcc
    v_and_or_b32 v119, v119, s82, v8
    v_and_or_b32 v116, v116, s82, v8
    v_and_or_b32 v117, v117, s82, v8
    v_and_or_b32 v118, v118, s82, v8
    s_mov_b32 exec_lo, 0xff01ff
    s_mov_b32 exec_hi, 0xff00ff
    buffer_store_dwordx4 v[116:119], v79, s[48:51], s96 offen sc1
    s_mov_b64 exec, -1
    s_barrier
    s_bitcmp1_b32 s90, 2
    s_cbranch_scc1 L_ctx
    buffer_load_dwordx4 v[204:207], v53, s[48:51], s47 offen sc1
    buffer_load_dwordx4 v[192:195], v50, s[48:51], s47 offen sc1
    buffer_load_dwordx4 v[196:199], v51, s[48:51], s47 offen sc1
    buffer_load_dwordx4 v[200:203], v52, s[48:51], s47 offen sc1
    buffer_load_dwordx4 v22, s[40:43], s44 offen offset:2048 nt lds
    buffer_load_dwordx4 v23, s[40:43], s44 offen offset:3072 nt lds
    v_xor_b32 v104, s35, v116
    v_xor_b32 v105, s35, v117
    v_xor_b32 v106, s35, v118
    v_xor_b32 v107, s35, v119
    v_mov_b32 v5, 0xff7f0000
    v_cndmask_b32 v120, v120, v5, vcc
    v_and_b32 v121, s82, v121
    s_mov_b32 s86, 0x88888888
    s_mov_b32 s87, 0x88888888
    s_waitcnt vmcnt(2)
L_hop1poll:
    v_xor_b32 v192, s35, v192
    v_xor_b32 v193, s35, v193
    v_xor_b32 v194, s35, v194
    v_xor_b32 v195, s35, v195
    v_xor_b32 v196, s35, v196
    v_xor_b32 v197, s35, v197
    v_xor_b32 v198, s35, v198
    v_xor_b32 v199, s35, v199
    v_xor_b32 v200, s35, v200
    v_xor_b32 v201, s35, v201
    v_xor_b32 v202, s35, v202
    v_xor_b32 v203, s35, v203
    v_xor_b32 v204, s35, v204
    v_xor_b32 v205, s35, v205
    v_xor_b32 v206, s35, v206
    v_xor_b32 v207, s35, v207
    v_or_b32 v4, v192, v193
    v_or3_b32 v4, v4, v194, v195
    v_or3_b32 v4, v4, v196, v197
    v_or3_b32 v4, v4, v198, v199
    v_or3_b32 v4, v4, v200, v201
    v_or3_b32 v4, v4, v202, v203
    v_or3_b32 v4, v4, v204, v205
    v_or3_b32 v4, v4, v206, v207
    v_and_b32 v4, 0xff, v4
    v_cmp_ne_u32 vcc, 0, v4
    v_add_f32 v122, v204, v206
    s_cbranch_vccz L_hop1ok
    buffer_load_dwordx4 v[204:207], v53, s[48:51], s47 offen sc1
    buffer_load_dwordx4 v[192:195], v50, s[48:51], s47 offen sc1
    buffer_load_dwordx4 v[196:199], v51, s[48:51], s47 offen sc1
    buffer_load_dwordx4 v[200:203], v52, s[48:51], s47 offen sc1
    s_waitcnt vmcnt(0)
    s_sub_u32 s84, s84, 1
    s_cmp_lg_u32 s84, 0
    s_cbranch_scc1 L_hop1poll
    s_branch L_end
L_ctx:
    s_mov_b32 s44, s86
    s_lshl_b32 s39, s34, 13
    s_add_u32 s39, s39, 98304
    s_mov_b32 m0, s39
    s_nop 0
    buffer_load_dwordx4 v20, s[40:43], s44 offen offset:0 nt lds
    buffer_load_dwordx4 v21, s[40:43], s44 offen offset:1024 nt lds
    buffer_load_dwordx4 v22, s[40:43], s44 offen offset:2048 nt lds
    buffer_load_dwordx4 v23, s[40:43], s44 offen offset:3072 nt lds
    s_lshl_b32 s39, s34, 13
    s_add_u32 s39, s39, 102400
    s_mov_b32 m0, s39
    s_add_u32 s44, s44, 16384
    buffer_load_dwordx4 v20, s[40:43], s44 offen offset:0 nt lds
    buffer_load_dwordx4 v21, s[40:43], s44 offen offset:1024 nt lds
    buffer_load_dwordx4 v22, s[40:43], s44 offen offset:2048 nt lds
    buffer_load_dwordx4 v23, s[40:43], s44 offen offset:3072 nt lds
    s_waitcnt vmcnt(9)
L_ctxcheck:
    v_xor_b32 v224, s35, v224
    v_xor_b32 v225, s35, v225
    v_xor_b32 v226, s35, v226
    v_xor_b32 v227, s35, v227
    v_or_b32 v4, v224, v225
    v_or3_b32 v4, v4, v226, v227
    v_and_b32 v4, 0xff, v4
    v_cmp_ne_u32 vcc, 0, v4
    s_cbranch_vccz L_ctxok
    buffer_load_dwordx4 v[224:227], v54, s[48:51], s46 offen sc1
    s_waitcnt vmcnt(0)
    s_sub_u32 s84, s84, 1
    s_cmp_lg_u32 s84, 0
    s_cbranch_scc1 L_ctxcheck
    s_branch L_end
L_ctxok:
    v_cvt_pk_bf16_f32 v224, v224, v225
    v_cvt_pk_bf16_f32 v225, v226, v227
    ds_write_b64 v35, v[224:225]
    s_branch L_final
L_hop1ok:
    v_cndmask_b32 v122, v122, v120, s[86:87]
    v_cndmask_b32 v123, v205, v121, s[86:87]
    s_nop 0
    v_max_f32_dpp v5, v122, v122 quad_perm:[1,0,3,2] row_mask:0xf bank_mask:0xf
    s_nop 1
    v_max_f32_dpp v5, v5, v5 quad_perm:[2,3,0,1] row_mask:0xf bank_mask:0xf
    s_nop 1
    v_max_f32_dpp v5, v5, v5 row_ror:8 row_mask:0xf bank_mask:0xf
    v_sub_f32 v122, v122, v5
    v_exp_f32 v122, v122
    s_nop 0
    v_mul_f32 v123, v123, v122
    v_mul_f32_dpp v104, v122, v104 quad_perm:[3,3,3,3] row_mask:0xf bank_mask:0xf
    v_mul_f32_dpp v105, v122, v105 quad_perm:[3,3,3,3] row_mask:0xf bank_mask:0xf
    v_mul_f32_dpp v106, v122, v106 quad_perm:[3,3,3,3] row_mask:0xf bank_mask:0xf
    v_mul_f32_dpp v107, v122, v107 quad_perm:[3,3,3,3] row_mask:0xf bank_mask:0xf
    v_add_f32_dpp v123, v123, v123 quad_perm:[1,0,3,2] row_mask:0xf bank_mask:0xf
    v_fmac_f32_dpp v104, v122, v192 quad_perm:[0,0,0,0] row_mask:0xf bank_mask:0xf
    v_fmac_f32_dpp v105, v122, v193 quad_perm:[0,0,0,0] row_mask:0xf bank_mask:0xf
    v_fmac_f32_dpp v106, v122, v194 quad_perm:[0,0,0,0] row_mask:0xf bank_mask:0xf
    v_fmac_f32_dpp v107, v122, v195 quad_perm:[0,0,0,0] row_mask:0xf bank_mask:0xf
    v_add_f32_dpp v123, v123, v123 quad_perm:[2,3,0,1] row_mask:0xf bank_mask:0xf
    v_fmac_f32_dpp v104, v122, v196 quad_perm:[1,1,1,1] row_mask:0xf bank_mask:0xf
    v_fmac_f32_dpp v105, v122, v197 quad_perm:[1,1,1,1] row_mask:0xf bank_mask:0xf
    v_fmac_f32_dpp v106, v122, v198 quad_perm:[1,1,1,1] row_mask:0xf bank_mask:0xf
    v_fmac_f32_dpp v107, v122, v199 quad_perm:[1,1,1,1] row_mask:0xf bank_mask:0xf
    v_add_f32_dpp v123, v123, v123 row_ror:8 row_mask:0xf bank_mask:0xf
    v_fmac_f32_dpp v104, v122, v200 quad_perm:[2,2,2,2] row_mask:0xf bank_mask:0xf
    v_fmac_f32_dpp v105, v122, v201 quad_perm:[2,2,2,2] row_mask:0xf bank_mask:0xf
    v_fmac_f32_dpp v106, v122, v202 quad_perm:[2,2,2,2] row_mask:0xf bank_mask:0xf
    v_fmac_f32_dpp v107, v122, v203 quad_perm:[2,2,2,2] row_mask:0xf bank_mask:0xf
    v_rcp_f32 v123, v123
    v_add_f32_dpp v104, v104, v104 row_ror:8 row_mask:0xf bank_mask:0xf
    v_add_f32_dpp v105, v105, v105 row_ror:8 row_mask:0xf bank_mask:0xf
    v_add_f32_dpp v106, v106, v106 row_ror:8 row_mask:0xf bank_mask:0xf
    v_add_f32_dpp v107, v107, v107 row_ror:8 row_mask:0xf bank_mask:0xf
    v_mul_f32 v104, v104, v123
    v_mul_f32 v105, v105, v123
    v_mul_f32 v106, v106, v123
    v_mul_f32 v107, v107, v123
    v_cvt_pk_bf16_f32 v104, v104, v105
    v_cvt_pk_bf16_f32 v106, v106, v107
    s_mov_b32 exec_lo, 0xff00ff
    s_mov_b32 exec_hi, 0xff00ff
    ds_write_b16 v31, v104
    ds_write_b16_d16_hi v31, v104 offset:16
    ds_write_b16 v31, v106 offset:32
    ds_write_b16_d16_hi v31, v106 offset:48
    s_mov_b64 exec, -1
L_final:
    s_waitcnt vmcnt(0) lgkmcnt(0)
    s_barrier
    ds_read_b64_tr_b16 v[128:129], v24 offset:0
    ds_read_b64_tr_b16 v[130:131], v25 offset:1024
    ds_read_b128 v[160:163], v28 offset:0
    ds_read_b64_tr_b16 v[132:133], v24 offset:8192
    ds_read_b64_tr_b16 v[134:135], v25 offset:9216
    ds_read_b128 v[164:167], v28 offset:64
    ds_read_b64_tr_b16 v[136:137], v24 offset:16384
    ds_read_b64_tr_b16 v[138:139], v25 offset:17408
    ds_read_b128 v[168:171], v28 offset:128
    ds_read_b64_tr_b16 v[140:141], v24 offset:24576
    ds_read_b64_tr_b16 v[142:143], v25 offset:25600
    ds_read_b128 v[172:175], v28 offset:192
    ds_read_b64_tr_b16 v[144:145], v26 offset:0
    ds_read_b64_tr_b16 v[146:147], v27 offset:1024
    ds_read_b128 v[176:179], v29 offset:0
    s_waitcnt lgkmcnt(12)
    v_mfma_f32_16x16x32_bf16 v[112:115], v[128:131], v[160:163], 0
    ds_read_b64_tr_b16 v[148:149], v26 offset:8192
    ds_read_b64_tr_b16 v[150:151], v27 offset:9216
    ds_read_b128 v[180:183], v29 offset:64
    s_waitcnt lgkmcnt(12)
    v_mfma_f32_16x16x32_bf16 v[112:115], v[132:135], v[164:167], v[112:115]
    ds_read_b64_tr_b16 v[152:153], v26 offset:16384
    ds_read_b64_tr_b16 v[154:155], v27 offset:17408
    ds_read_b128 v[184:187], v29 offset:128
    s_waitcnt lgkmcnt(12)
    v_mfma_f32_16x16x32_bf16 v[112:115], v[136:139], v[168:171], v[112:115]
    ds_read_b64_tr_b16 v[156:157], v26 offset:24576
    ds_read_b64_tr_b16 v[158:159], v27 offset:25600
    ds_read_b128 v[188:191], v29 offset:192
    s_waitcnt lgkmcnt(12)
    v_mfma_f32_16x16x32_bf16 v[112:115], v[140:143], v[172:175], v[112:115]
    s_waitcnt lgkmcnt(9)
    v_mfma_f32_16x16x32_bf16 v[112:115], v[144:147], v[176:179], v[112:115]
    s_waitcnt lgkmcnt(6)
    v_mfma_f32_16x16x32_bf16 v[112:115], v[148:151], v[180:183], v[112:115]
    s_waitcnt lgkmcnt(3)
    v_mfma_f32_16x16x32_bf16 v[112:115], v[152:155], v[184:187], v[112:115]
    s_waitcnt lgkmcnt(0)
    v_mfma_f32_16x16x32_bf16 v[112:115], v[156:159], v[188:191], v[112:115]
    s_add_u32 s37, s71, 4096
    s_cmp_eq_u32 s70, 1
    s_mov_b32 exec_lo, 0xff00ff
    s_mov_b32 exec_hi, 0xff00ff
    s_nop 3
    v_and_or_b32 v112, v112, s82, v8
    v_and_or_b32 v113, v113, s82, v8
    v_and_or_b32 v114, v114, s82, v8
    v_and_or_b32 v115, v115, s82, v8
    s_cbranch_scc1 L_ylocal
    buffer_store_dwordx4 v[112:115], v30, s[48:51], s45 offen sc1
    s_branch L_ydone
L_ylocal:
    buffer_store_dwordx4 v[112:115], v30, s[48:51], s45 offen
L_ydone:
    s_mov_b64 exec, -1
    s_cmp_lg_u32 s34, 0
    s_cbranch_scc1 L_done
L_hop2:
    buffer_load_dwordx4 v[224:227], v32, s[48:51], s71 offen sc1
    buffer_load_dwordx4 v[228:231], v32, s[48:51], s37 offen sc1
    s_waitcnt vmcnt(0)
    v_xor_b32 v224, s35, v224
    v_xor_b32 v225, s35, v225
    v_xor_b32 v226, s35, v226
    v_xor_b32 v227, s35, v227
    v_xor_b32 v228, s35, v228
    v_xor_b32 v229, s35, v229
    v_xor_b32 v230, s35, v230
    v_xor_b32 v231, s35, v231
    v_or_b32 v4, v224, v225
    v_or3_b32 v4, v4, v226, v227
    v_or3_b32 v4, v4, v228, v229
    v_or3_b32 v4, v4, v230, v231
    v_and_b32 v4, 0xff, v4
    v_cmp_ne_u32 vcc, 0, v4
    v_add_f32 v232, v224, v228
    v_add_f32 v233, v225, v229
    v_add_f32 v234, v226, v230
    v_add_f32 v235, v227, v231
    s_cbranch_vccz L_hop2ok
    s_sub_u32 s84, s84, 1
    s_cmp_lg_u32 s84, 0
    s_cbranch_scc1 L_hop2
    s_branch L_end
L_hop2ok:
    v_permlane16_swap_b32 v232, v233
    v_permlane16_swap_b32 v234, v235
    v_add_f32 v232, v232, v233
    v_add_f32 v234, v234, v235
    s_nop 1
    v_permlane32_swap_b32 v232, v234
    v_add_f32 v232, v232, v234
    s_nop 1
    v_add_f32_dpp v232, v232, v232 row_ror:8 row_mask:0xf bank_mask:0xf
    s_nop 1
    v_add_f32_dpp v232, v232, v232 row_ror:4 row_mask:0xf bank_mask:0xf
    v_cvt_pk_bf16_f32 v232, v232, v232
    s_mov_b32 exec_lo, 0xf000f
    s_mov_b32 exec_hi, 0xf000f
    buffer_store_short v232, v33, s[72:75], 0 offen
    s_cmp_lg_u32 s2, 0
    s_cbranch_scc1 L_done
    v_mov_b32 v4, 0
    s_mov_b64 exec, 1
    buffer_store_dword v8, v4, s[48:51], 0 offen
L_done:
L_end:
    s_endpgm
L_qp:
    v_lshlrev_b32 v4, 18, v2
    v_lshl_add_u32 v14, v3, 4, v4
    v_lshrrev_b32 v5, 3, v3
    v_lshlrev_b32 v5, 10, v5
    v_lshl_add_u32 v15, v2, 6, v5
    s_cmp_eq_u32 s33, 0
    s_cselect_b32 s61, 3, 2
    s_xor_b32 s61, s61, s32
    s_lshl_b32 s86, s34, 8
    s_lshl_b32 s63, s34, 20
    s_lshl_b32 s38, s61, 8
    s_add_u32 s63, s63, s38
    s_mov_b32 s42, 4194304
    s_mov_b32 s43, 0x20000
    s_mov_b32 s46, 4096
    s_mov_b32 s47, 0x20000
    s_cmp_eq_u32 s33, 0
    s_waitcnt lgkmcnt(0)
    s_cselect_b64 s[40:41], s[22:23], s[8:9]
    s_cselect_b64 s[44:45], s[16:17], s[4:5]
    buffer_load_dwordx4 a[128:131], v14, s[40:43], s63 offen nt
    s_add_u32 s63, s63, 8192
    buffer_load_dwordx4 a[132:135], v14, s[40:43], s63 offen nt
    s_add_u32 s63, s63, 8192
    buffer_load_dwordx4 v[20:23], v15, s[44:47], s86 offen offset:0
    buffer_load_dwordx4 v[36:39], v15, s[44:47], s86 offen offset:2048
    buffer_load_dwordx4 a[136:139], v14, s[40:43], s63 offen nt
    s_add_u32 s63, s63, 8192
    buffer_load_dwordx4 a[140:143], v14, s[40:43], s63 offen nt
    s_add_u32 s63, s63, 8192
    buffer_load_dwordx4 a[144:147], v14, s[40:43], s63 offen nt
    s_add_u32 s63, s63, 8192
    buffer_load_dwordx4 a[148:151], v14, s[40:43], s63 offen nt
    s_add_u32 s63, s63, 8192
    buffer_load_dwordx4 a[152:155], v14, s[40:43], s63 offen nt
    s_add_u32 s63, s63, 8192
    buffer_load_dwordx4 a[156:159], v14, s[40:43], s63 offen nt
    s_add_u32 s63, s63, 8192
    s_load_dword s35, s[30:31], 0
    s_mov_b32 s48, s30
    s_and_b32 s49, s31, 0xffff
    s_mov_b32 s50, 8388608
    s_mov_b32 s51, 0x20000
    s_mov_b32 s82, 0xffffff00
    s_mov_b32 s83, 0x3e0293ee
    s_mov_b32 s84, 8388608
    v_and_b32 v4, 1, v1
    v_lshlrev_b32 v4, 4, v4
    v_mov_b32 v5, 0xffff
    v_lshlrev_b32 v4, v4, v5
    v_bfe_u32 v5, v1, 1, 2
    v_cmp_eq_u32 vcc, 0, v5
    s_nop 1
    v_cndmask_b32 v10, 0, v4, vcc
    v_cmp_eq_u32 vcc, 1, v5
    s_nop 1
    v_cndmask_b32 v11, 0, v4, vcc
    v_cmp_eq_u32 vcc, 2, v5
    s_nop 1
    v_cndmask_b32 v12, 0, v4, vcc
    v_cmp_eq_u32 vcc, 3, v5
    s_nop 1
    v_cndmask_b32 v13, 0, v4, vcc
    buffer_load_dwordx4 v[24:27], v15, s[44:47], s86 offen offset:16
    buffer_load_dwordx4 v[40:43], v15, s[44:47], s86 offen offset:2064
    buffer_load_dwordx4 v[28:31], v15, s[44:47], s86 offen offset:32
    buffer_load_dwordx4 v[44:47], v15, s[44:47], s86 offen offset:2080
    buffer_load_dwordx4 v[32:35], v15, s[44:47], s86 offen offset:48
    buffer_load_dwordx4 v[48:51], v15, s[44:47], s86 offen offset:2096
    s_lshl_b32 s38, s61, 10
    s_add_u32 s36, s38, 65536
    s_lshr_b32 s38, s61, 3
    s_lshl_b32 s38, s38, 8
    s_add_u32 s36, s38, s36
    s_lshl_b32 s38, s34, 23
    s_add_u32 s36, s38, s36
    v_mov_b32 v18, 0
    v_mov_b32 v19, 0
    s_cmp_eq_u32 s33, 0
    s_cselect_b32 s38, s36, 8388608
    s_mov_b64 exec, 1
    buffer_store_dwordx2 v[18:19], v19, s[48:51], s38 offen sc1
    s_mov_b64 exec, -1
    buffer_load_dwordx4 a[160:163], v14, s[40:43], s63 offen nt
    s_add_u32 s63, s63, 8192
    buffer_load_dwordx4 a[164:167], v14, s[40:43], s63 offen nt
    s_add_u32 s63, s63, 8192
    buffer_load_dwordx4 a[168:171], v14, s[40:43], s63 offen nt
    s_add_u32 s63, s63, 8192
    buffer_load_dwordx4 a[172:175], v14, s[40:43], s63 offen nt
    s_add_u32 s63, s63, 8192
    s_mov_b32 s80, 0x01000100
    s_mov_b32 s81, 0x03020302
    s_waitcnt vmcnt(17)
    buffer_load_dwordx4 a[176:179], v14, s[40:43], s63 offen nt
    s_add_u32 s63, s63, 8192
    v_perm_b32 v4, v20, v20, s80
    v_perm_b32 v5, v36, v36, s80
    v_and_b32 v52, v4, v10
    v_and_b32 v53, v4, v11
    v_and_b32 v54, v4, v12
    v_and_b32 v55, v4, v13
    v_and_b32 v56, v5, v10
    v_and_b32 v57, v5, v11
    v_and_b32 v58, v5, v12
    v_and_b32 v59, v5, v13
    v_mfma_f32_16x16x32_bf16 v[60:63], a[128:131], v[52:55], 0
    s_nop 0
    v_mfma_f32_16x16x32_bf16 v[64:67], a[128:131], v[56:59], 0
    buffer_load_dwordx4 a[180:183], v14, s[40:43], s63 offen nt
    s_add_u32 s63, s63, 8192
    v_perm_b32 v4, v20, v20, s81
    v_perm_b32 v5, v36, v36, s81
    v_and_b32 v52, v4, v10
    v_and_b32 v53, v4, v11
    v_and_b32 v54, v4, v12
    v_and_b32 v55, v4, v13
    v_and_b32 v56, v5, v10
    v_and_b32 v57, v5, v11
    v_and_b32 v58, v5, v12
    v_and_b32 v59, v5, v13
    v_mfma_f32_16x16x32_bf16 v[60:63], a[132:135], v[52:55], v[60:63]
    s_nop 0
    v_mfma_f32_16x16x32_bf16 v[64:67], a[132:135], v[56:59], v[64:67]
    s_waitcnt vmcnt(18)
    buffer_load_dwordx4 a[184:187], v14, s[40:43], s63 offen nt
    s_add_u32 s63, s63, 8192
    v_perm_b32 v4, v21, v21, s80
    v_perm_b32 v5, v37, v37, s80
    v_and_b32 v52, v4, v10
    v_and_b32 v53, v4, v11
    v_and_b32 v54, v4, v12
    v_and_b32 v55, v4, v13
    v_and_b32 v56, v5, v10
    v_and_b32 v57, v5, v11
    v_and_b32 v58, v5, v12
    v_and_b32 v59, v5, v13
    v_mfma_f32_16x16x32_bf16 v[60:63], a[136:139], v[52:55], v[60:63]
    s_nop 0
    v_mfma_f32_16x16x32_bf16 v[64:67], a[136:139], v[56:59], v[64:67]
    s_waitcnt vmcnt(18)
    buffer_load_dwordx4 a[188:191], v14, s[40:43], s63 offen nt
    s_add_u32 s63, s63, 8192
    v_perm_b32 v4, v21, v21, s81
    v_perm_b32 v5, v37, v37, s81
    v_and_b32 v52, v4, v10
    v_and_b32 v53, v4, v11
    v_and_b32 v54, v4, v12
    v_and_b32 v55, v4, v13
    v_and_b32 v56, v5, v10
    v_and_b32 v57, v5, v11
    v_and_b32 v58, v5, v12
    v_and_b32 v59, v5, v13
    v_mfma_f32_16x16x32_bf16 v[60:63], a[140:143], v[52:55], v[60:63]
    s_nop 0
    v_mfma_f32_16x16x32_bf16 v[64:67], a[140:143], v[56:59], v[64:67]
    s_waitcnt vmcnt(18)
    buffer_load_dwordx4 a[192:195], v14, s[40:43], s63 offen nt
    s_add_u32 s63, s63, 8192
    v_lshrrev_b32 v4, 2, v3
    v_and_b32 v5, 3, v3
    v_lshlrev_b32 v76, 8, v4
    v_lshlrev_b32 v126, 8, v2
    v_lshl_add_u32 v76, v2, 6, v76
    v_lshl_add_u32 v76, v5, 4, v76
    v_lshl_add_u32 v126, v3, 4, v126
    v_xor_b32 v77, 32768, v76
    v_xor_b32 v127, 32768, v126
    s_add_u32 s3, s34, s33
    s_and_b32 s3, s3, 3
    s_lshl_b32 s89, s3, 5
    s_add_u32 s89, s89, s32
    s_lshl_b32 s89, s89, 20
    s_mul_i32 s88, s32, 8
    s_mul_i32 s38, s3, 2
    s_add_u32 s88, s88, s38
    s_lshl_b32 s87, s33, 1
    v_perm_b32 v4, v22, v22, s80
    v_perm_b32 v5, v38, v38, s80
    v_and_b32 v52, v4, v10
    v_and_b32 v53, v4, v11
    v_and_b32 v54, v4, v12
    v_and_b32 v55, v4, v13
    v_and_b32 v56, v5, v10
    v_and_b32 v57, v5, v11
    v_and_b32 v58, v5, v12
    v_and_b32 v59, v5, v13
    v_mfma_f32_16x16x32_bf16 v[60:63], a[144:147], v[52:55], v[60:63]
    s_nop 0
    v_mfma_f32_16x16x32_bf16 v[64:67], a[144:147], v[56:59], v[64:67]
    s_waitcnt vmcnt(18)
    buffer_load_dwordx4 a[196:199], v14, s[40:43], s63 offen nt
    s_add_u32 s63, s63, 8192
    v_perm_b32 v4, v22, v22, s81
    v_perm_b32 v5, v38, v38, s81
    v_and_b32 v52, v4, v10
    v_and_b32 v53, v4, v11
    v_and_b32 v54, v4, v12
    v_and_b32 v55, v4, v13
    v_and_b32 v56, v5, v10
    v_and_b32 v57, v5, v11
    v_and_b32 v58, v5, v12
    v_and_b32 v59, v5, v13
    v_mfma_f32_16x16x32_bf16 v[60:63], a[148:151], v[52:55], v[60:63]
    s_nop 0
    v_mfma_f32_16x16x32_bf16 v[64:67], a[148:151], v[56:59], v[64:67]
    s_waitcnt vmcnt(18)
    buffer_load_dwordx4 a[200:203], v14, s[40:43], s63 offen nt
    s_add_u32 s63, s63, 8192
    v_perm_b32 v4, v23, v23, s80
    v_perm_b32 v5, v39, v39, s80
    v_and_b32 v52, v4, v10
    v_and_b32 v53, v4, v11
    v_and_b32 v54, v4, v12
    v_and_b32 v55, v4, v13
    v_and_b32 v56, v5, v10
    v_and_b32 v57, v5, v11
    v_and_b32 v58, v5, v12
    v_and_b32 v59, v5, v13
    v_mfma_f32_16x16x32_bf16 v[60:63], a[152:155], v[52:55], v[60:63]
    s_nop 0
    v_mfma_f32_16x16x32_bf16 v[64:67], a[152:155], v[56:59], v[64:67]
    s_waitcnt vmcnt(18)
    buffer_load_dwordx4 a[204:207], v14, s[40:43], s63 offen nt
    s_add_u32 s63, s63, 8192
    v_perm_b32 v4, v23, v23, s81
    v_perm_b32 v5, v39, v39, s81
    v_and_b32 v52, v4, v10
    v_and_b32 v53, v4, v11
    v_and_b32 v54, v4, v12
    v_and_b32 v55, v4, v13
    v_and_b32 v56, v5, v10
    v_and_b32 v57, v5, v11
    v_and_b32 v58, v5, v12
    v_and_b32 v59, v5, v13
    v_mfma_f32_16x16x32_bf16 v[60:63], a[156:159], v[52:55], v[60:63]
    s_nop 0
    v_mfma_f32_16x16x32_bf16 v[64:67], a[156:159], v[56:59], v[64:67]
    s_waitcnt vmcnt(17)
    s_waitcnt vmcnt(11)
    buffer_load_dwordx4 a[208:211], v14, s[40:43], s63 offen nt
    s_add_u32 s63, s63, 8192
    s_mov_b32 s52, s18
    s_and_b32 s53, s19, 0xffff
    s_mov_b32 s54, 134217728
    s_mov_b32 s55, 0x20000
    s_mov_b32 s56, s20
    s_and_b32 s57, s21, 0xffff
    s_mov_b32 s58, 134217728
    s_mov_b32 s59, 0x20000
    v_perm_b32 v4, v24, v24, s80
    v_perm_b32 v5, v40, v40, s80
    v_and_b32 v52, v4, v10
    v_and_b32 v53, v4, v11
    v_and_b32 v54, v4, v12
    v_and_b32 v55, v4, v13
    v_and_b32 v56, v5, v10
    v_and_b32 v57, v5, v11
    v_and_b32 v58, v5, v12
    v_and_b32 v59, v5, v13
    v_mfma_f32_16x16x32_bf16 v[60:63], a[160:163], v[52:55], v[60:63]
    s_nop 0
    v_mfma_f32_16x16x32_bf16 v[64:67], a[160:163], v[56:59], v[64:67]
    s_waitcnt vmcnt(11)
    buffer_load_dwordx4 a[212:215], v14, s[40:43], s63 offen nt
    s_add_u32 s63, s63, 8192
    v_perm_b32 v4, v24, v24, s81
    v_perm_b32 v5, v40, v40, s81
    v_and_b32 v52, v4, v10
    v_and_b32 v53, v4, v11
    v_and_b32 v54, v4, v12
    v_and_b32 v55, v4, v13
    v_and_b32 v56, v5, v10
    v_and_b32 v57, v5, v11
    v_and_b32 v58, v5, v12
    v_and_b32 v59, v5, v13
    v_mfma_f32_16x16x32_bf16 v[60:63], a[164:167], v[52:55], v[60:63]
    s_nop 0
    v_mfma_f32_16x16x32_bf16 v[64:67], a[164:167], v[56:59], v[64:67]
    s_waitcnt vmcnt(11)
    buffer_load_dwordx4 a[216:219], v14, s[40:43], s63 offen nt
    s_add_u32 s63, s63, 8192
    v_perm_b32 v4, v25, v25, s80
    v_perm_b32 v5, v41, v41, s80
    v_and_b32 v52, v4, v10
    v_and_b32 v53, v4, v11
    v_and_b32 v54, v4, v12
    v_and_b32 v55, v4, v13
    v_and_b32 v56, v5, v10
    v_and_b32 v57, v5, v11
    v_and_b32 v58, v5, v12
    v_and_b32 v59, v5, v13
    v_mfma_f32_16x16x32_bf16 v[60:63], a[168:171], v[52:55], v[60:63]
    s_nop 0
    v_mfma_f32_16x16x32_bf16 v[64:67], a[168:171], v[56:59], v[64:67]
    s_waitcnt vmcnt(11)
    buffer_load_dwordx4 a[220:223], v14, s[40:43], s63 offen nt
    s_add_u32 s63, s63, 8192
    v_perm_b32 v4, v25, v25, s81
    v_perm_b32 v5, v41, v41, s81
    v_and_b32 v52, v4, v10
    v_and_b32 v53, v4, v11
    v_and_b32 v54, v4, v12
    v_and_b32 v55, v4, v13
    v_and_b32 v56, v5, v10
    v_and_b32 v57, v5, v11
    v_and_b32 v58, v5, v12
    v_and_b32 v59, v5, v13
    v_mfma_f32_16x16x32_bf16 v[60:63], a[172:175], v[52:55], v[60:63]
    s_nop 0
    v_mfma_f32_16x16x32_bf16 v[64:67], a[172:175], v[56:59], v[64:67]
    s_waitcnt vmcnt(11)
    buffer_load_dwordx4 a[224:227], v14, s[40:43], s63 offen nt
    s_add_u32 s63, s63, 8192
    v_mov_b32 v120, 0xff7f0000
    v_mov_b32 v121, 0
    v_mov_b32 v18, 1
    v_mov_b32 v116, 0
    v_mov_b32 v117, 0
    v_mov_b32 v118, 0
    v_mov_b32 v119, 0
    v_lshlrev_b32 v0, 3, v1
    ds_write_b64 v0, v[116:117] offset:8192
    v_mov_b32 v0, 8192
    s_lshl_b32 s38, s32, 10
    s_add_u32 s96, s38, 65536
    s_lshr_b32 s38, s32, 3
    s_lshl_b32 s38, s38, 8
    s_add_u32 s96, s38, s96
    v_mov_b32 v9, s96
    s_lshl_b32 s38, s32, 15
    s_add_u32 s96, s38, 1048576
    s_lshl_b32 s38, s3, 13
    s_add_u32 s96, s38, s96
    s_lshl_b32 s38, s33, 10
    s_add_u32 s96, s38, s96
    v_and_b32 v5, 3, v3
    v_lshlrev_b32 v78, 7, v2
    v_lshl_add_u32 v78, v5, 5, v78
    s_lshl_b32 s38, s32, 12
    s_add_u32 s91, s38, 262144
    s_lshl_b32 s38, s3, 9
    s_add_u32 s91, s38, s91
    v_lshlrev_b32 v4, 7, v2
    v_lshl_add_u32 v4, v3, 4, v4
    v_mov_b32 v5, 512
    v_cmp_gt_u32 vcc, 8, v3
    s_nop 1
    v_cndmask_b32 v79, v5, v4, vcc
    v_perm_b32 v4, v26, v26, s80
    v_perm_b32 v5, v42, v42, s80
    v_and_b32 v52, v4, v10
    v_and_b32 v53, v4, v11
    v_and_b32 v54, v4, v12
    v_and_b32 v55, v4, v13
    v_and_b32 v56, v5, v10
    v_and_b32 v57, v5, v11
    v_and_b32 v58, v5, v12
    v_and_b32 v59, v5, v13
    v_mfma_f32_16x16x32_bf16 v[60:63], a[176:179], v[52:55], v[60:63]
    s_nop 0
    v_mfma_f32_16x16x32_bf16 v[64:67], a[176:179], v[56:59], v[64:67]
    s_waitcnt vmcnt(11)
    buffer_load_dwordx4 a[228:231], v14, s[40:43], s63 offen nt
    s_add_u32 s63, s63, 8192
    v_perm_b32 v4, v26, v26, s81
    v_perm_b32 v5, v42, v42, s81
    v_and_b32 v52, v4, v10
    v_and_b32 v53, v4, v11
    v_and_b32 v54, v4, v12
    v_and_b32 v55, v4, v13
    v_and_b32 v56, v5, v10
    v_and_b32 v57, v5, v11
    v_and_b32 v58, v5, v12
    v_and_b32 v59, v5, v13
    v_mfma_f32_16x16x32_bf16 v[60:63], a[180:183], v[52:55], v[60:63]
    s_nop 0
    v_mfma_f32_16x16x32_bf16 v[64:67], a[180:183], v[56:59], v[64:67]
    s_waitcnt vmcnt(11)
    buffer_load_dwordx4 a[232:235], v14, s[40:43], s63 offen nt
    s_add_u32 s63, s63, 8192
    v_perm_b32 v4, v27, v27, s80
    v_perm_b32 v5, v43, v43, s80
    v_and_b32 v52, v4, v10
    v_and_b32 v53, v4, v11
    v_and_b32 v54, v4, v12
    v_and_b32 v55, v4, v13
    v_and_b32 v56, v5, v10
    v_and_b32 v57, v5, v11
    v_and_b32 v58, v5, v12
    v_and_b32 v59, v5, v13
    v_mfma_f32_16x16x32_bf16 v[60:63], a[184:187], v[52:55], v[60:63]
    s_nop 0
    v_mfma_f32_16x16x32_bf16 v[64:67], a[184:187], v[56:59], v[64:67]
    s_waitcnt vmcnt(11)
    buffer_load_dwordx4 a[236:239], v14, s[40:43], s63 offen nt
    s_add_u32 s63, s63, 8192
    v_perm_b32 v4, v27, v27, s81
    v_perm_b32 v5, v43, v43, s81
    v_and_b32 v52, v4, v10
    v_and_b32 v53, v4, v11
    v_and_b32 v54, v4, v12
    v_and_b32 v55, v4, v13
    v_and_b32 v56, v5, v10
    v_and_b32 v57, v5, v11
    v_and_b32 v58, v5, v12
    v_and_b32 v59, v5, v13
    v_mfma_f32_16x16x32_bf16 v[60:63], a[188:191], v[52:55], v[60:63]
    s_nop 0
    v_mfma_f32_16x16x32_bf16 v[64:67], a[188:191], v[56:59], v[64:67]
    s_waitcnt vmcnt(11)
    buffer_load_dwordx4 a[240:243], v14, s[40:43], s63 offen nt
    s_add_u32 s63, s63, 8192
    v_perm_b32 v4, v28, v28, s80
    v_perm_b32 v5, v44, v44, s80
    v_and_b32 v52, v4, v10
    v_and_b32 v53, v4, v11
    v_and_b32 v54, v4, v12
    v_and_b32 v55, v4, v13
    v_and_b32 v56, v5, v10
    v_and_b32 v57, v5, v11
    v_and_b32 v58, v5, v12
    v_and_b32 v59, v5, v13
    v_mfma_f32_16x16x32_bf16 v[60:63], a[192:195], v[52:55], v[60:63]
    s_nop 0
    v_mfma_f32_16x16x32_bf16 v[64:67], a[192:195], v[56:59], v[64:67]
    s_waitcnt vmcnt(11)
    buffer_load_dwordx4 a[244:247], v14, s[40:43], s63 offen nt
    s_add_u32 s63, s63, 8192
    v_perm_b32 v4, v28, v28, s81
    v_perm_b32 v5, v44, v44, s81
    v_and_b32 v52, v4, v10
    v_and_b32 v53, v4, v11
    v_and_b32 v54, v4, v12
    v_and_b32 v55, v4, v13
    v_and_b32 v56, v5, v10
    v_and_b32 v57, v5, v11
    v_and_b32 v58, v5, v12
    v_and_b32 v59, v5, v13
    v_mfma_f32_16x16x32_bf16 v[60:63], a[196:199], v[52:55], v[60:63]
    s_nop 0
    v_mfma_f32_16x16x32_bf16 v[64:67], a[196:199], v[56:59], v[64:67]
    s_waitcnt vmcnt(11)
    buffer_load_dwordx4 a[248:251], v14, s[40:43], s63 offen nt
    s_add_u32 s63, s63, 8192
    v_perm_b32 v4, v29, v29, s80
    v_perm_b32 v5, v45, v45, s80
    v_and_b32 v52, v4, v10
    v_and_b32 v53, v4, v11
    v_and_b32 v54, v4, v12
    v_and_b32 v55, v4, v13
    v_and_b32 v56, v5, v10
    v_and_b32 v57, v5, v11
    v_and_b32 v58, v5, v12
    v_and_b32 v59, v5, v13
    v_mfma_f32_16x16x32_bf16 v[60:63], a[200:203], v[52:55], v[60:63]
    s_nop 0
    v_mfma_f32_16x16x32_bf16 v[64:67], a[200:203], v[56:59], v[64:67]
    s_waitcnt vmcnt(11)
    buffer_load_dwordx4 a[252:255], v14, s[40:43], s63 offen nt
    s_add_u32 s63, s63, 8192
    v_perm_b32 v4, v29, v29, s81
    v_perm_b32 v5, v45, v45, s81
    v_and_b32 v52, v4, v10
    v_and_b32 v53, v4, v11
    v_and_b32 v54, v4, v12
    v_and_b32 v55, v4, v13
    v_and_b32 v56, v5, v10
    v_and_b32 v57, v5, v11
    v_and_b32 v58, v5, v12
    v_and_b32 v59, v5, v13
    v_mfma_f32_16x16x32_bf16 v[60:63], a[204:207], v[52:55], v[60:63]
    s_nop 0
    v_mfma_f32_16x16x32_bf16 v[64:67], a[204:207], v[56:59], v[64:67]
    s_waitcnt vmcnt(11)
    v_perm_b32 v4, v30, v30, s80
    v_perm_b32 v5, v46, v46, s80
    v_and_b32 v52, v4, v10
    v_and_b32 v53, v4, v11
    v_and_b32 v54, v4, v12
    v_and_b32 v55, v4, v13
    v_and_b32 v56, v5, v10
    v_and_b32 v57, v5, v11
    v_and_b32 v58, v5, v12
    v_and_b32 v59, v5, v13
    v_mfma_f32_16x16x32_bf16 v[60:63], a[208:211], v[52:55], v[60:63]
    s_nop 0
    v_mfma_f32_16x16x32_bf16 v[64:67], a[208:211], v[56:59], v[64:67]
    s_waitcnt vmcnt(10)
    v_perm_b32 v4, v30, v30, s81
    v_perm_b32 v5, v46, v46, s81
    v_and_b32 v52, v4, v10
    v_and_b32 v53, v4, v11
    v_and_b32 v54, v4, v12
    v_and_b32 v55, v4, v13
    v_and_b32 v56, v5, v10
    v_and_b32 v57, v5, v11
    v_and_b32 v58, v5, v12
    v_and_b32 v59, v5, v13
    v_mfma_f32_16x16x32_bf16 v[60:63], a[212:215], v[52:55], v[60:63]
    s_nop 0
    v_mfma_f32_16x16x32_bf16 v[64:67], a[212:215], v[56:59], v[64:67]
    s_waitcnt vmcnt(9)
    v_perm_b32 v4, v31, v31, s80
    v_perm_b32 v5, v47, v47, s80
    v_and_b32 v52, v4, v10
    v_and_b32 v53, v4, v11
    v_and_b32 v54, v4, v12
    v_and_b32 v55, v4, v13
    v_and_b32 v56, v5, v10
    v_and_b32 v57, v5, v11
    v_and_b32 v58, v5, v12
    v_and_b32 v59, v5, v13
    v_mfma_f32_16x16x32_bf16 v[60:63], a[216:219], v[52:55], v[60:63]
    s_nop 0
    v_mfma_f32_16x16x32_bf16 v[64:67], a[216:219], v[56:59], v[64:67]
    s_waitcnt vmcnt(8)
    v_perm_b32 v4, v31, v31, s81
    v_perm_b32 v5, v47, v47, s81
    v_and_b32 v52, v4, v10
    v_and_b32 v53, v4, v11
    v_and_b32 v54, v4, v12
    v_and_b32 v55, v4, v13
    v_and_b32 v56, v5, v10
    v_and_b32 v57, v5, v11
    v_and_b32 v58, v5, v12
    v_and_b32 v59, v5, v13
    v_mfma_f32_16x16x32_bf16 v[60:63], a[220:223], v[52:55], v[60:63]
    s_nop 0
    v_mfma_f32_16x16x32_bf16 v[64:67], a[220:223], v[56:59], v[64:67]
    s_waitcnt vmcnt(7)
    v_perm_b32 v4, v32, v32, s80
    v_perm_b32 v5, v48, v48, s80
    v_and_b32 v52, v4, v10
    v_and_b32 v53, v4, v11
    v_and_b32 v54, v4, v12
    v_and_b32 v55, v4, v13
    v_and_b32 v56, v5, v10
    v_and_b32 v57, v5, v11
    v_and_b32 v58, v5, v12
    v_and_b32 v59, v5, v13
    v_mfma_f32_16x16x32_bf16 v[60:63], a[224:227], v[52:55], v[60:63]
    s_nop 0
    v_mfma_f32_16x16x32_bf16 v[64:67], a[224:227], v[56:59], v[64:67]
    s_waitcnt vmcnt(6)
    s_add_u32 s39, s87, s88
    s_bfe_u32 s37, s39, 0x10000
    s_lshl_b32 s37, s37, 13
    s_add_u32 s85, s37, s89
    s_bfe_u32 s37, s39, 0x10001
    s_lshl_b32 s37, s37, 12
    s_add_u32 s85, s37, s85
    s_bfe_u32 s37, s39, 0x10002
    s_lshl_b32 s37, s37, 11
    s_add_u32 s85, s37, s85
    s_bfe_u32 s37, s39, 0x10003
    s_lshl_b32 s37, s37, 14
    s_add_u32 s85, s37, s85
    s_bfe_u32 s37, s39, 0x40004
    s_lshl_b32 s37, s37, 16
    s_add_u32 s85, s37, s85
    buffer_load_dwordx4 v[128:131], v76, s[52:55], s85 offen offset:0 nt
    v_perm_b32 v4, v32, v32, s81
    v_perm_b32 v5, v48, v48, s81
    v_and_b32 v52, v4, v10
    v_and_b32 v53, v4, v11
    v_and_b32 v54, v4, v12
    v_and_b32 v55, v4, v13
    v_and_b32 v56, v5, v10
    v_and_b32 v57, v5, v11
    v_and_b32 v58, v5, v12
    v_and_b32 v59, v5, v13
    v_mfma_f32_16x16x32_bf16 v[60:63], a[228:231], v[52:55], v[60:63]
    s_nop 0
    v_mfma_f32_16x16x32_bf16 v[64:67], a[228:231], v[56:59], v[64:67]
    s_waitcnt vmcnt(6)
    buffer_load_dwordx4 v[132:135], v77, s[52:55], s85 offen offset:0 nt
    v_perm_b32 v4, v33, v33, s80
    v_perm_b32 v5, v49, v49, s80
    v_and_b32 v52, v4, v10
    v_and_b32 v53, v4, v11
    v_and_b32 v54, v4, v12
    v_and_b32 v55, v4, v13
    v_and_b32 v56, v5, v10
    v_and_b32 v57, v5, v11
    v_and_b32 v58, v5, v12
    v_and_b32 v59, v5, v13
    v_mfma_f32_16x16x32_bf16 v[60:63], a[232:235], v[52:55], v[60:63]
    s_nop 0
    v_mfma_f32_16x16x32_bf16 v[64:67], a[232:235], v[56:59], v[64:67]
    s_waitcnt vmcnt(6)
    buffer_load_dwordx4 v[136:139], v76, s[52:55], s85 offen offset:1024 nt
    v_perm_b32 v4, v33, v33, s81
    v_perm_b32 v5, v49, v49, s81
    v_and_b32 v52, v4, v10
    v_and_b32 v53, v4, v11
    v_and_b32 v54, v4, v12
    v_and_b32 v55, v4, v13
    v_and_b32 v56, v5, v10
    v_and_b32 v57, v5, v11
    v_and_b32 v58, v5, v12
    v_and_b32 v59, v5, v13
    v_mfma_f32_16x16x32_bf16 v[60:63], a[236:239], v[52:55], v[60:63]
    s_nop 0
    v_mfma_f32_16x16x32_bf16 v[64:67], a[236:239], v[56:59], v[64:67]
    s_waitcnt vmcnt(6)
    buffer_load_dwordx4 v[140:143], v77, s[52:55], s85 offen offset:1024 nt
    s_add_u32 s87, s87, 1
    s_add_u32 s39, s87, s88
    s_bfe_u32 s37, s39, 0x10000
    s_lshl_b32 s37, s37, 13
    s_add_u32 s85, s37, s89
    s_bfe_u32 s37, s39, 0x10001
    s_lshl_b32 s37, s37, 12
    s_add_u32 s85, s37, s85
    s_bfe_u32 s37, s39, 0x10002
    s_lshl_b32 s37, s37, 11
    s_add_u32 s85, s37, s85
    s_bfe_u32 s37, s39, 0x10003
    s_lshl_b32 s37, s37, 14
    s_add_u32 s85, s37, s85
    s_bfe_u32 s37, s39, 0x40004
    s_lshl_b32 s37, s37, 16
    s_add_u32 s85, s37, s85
    v_perm_b32 v4, v34, v34, s80
    v_perm_b32 v5, v50, v50, s80
    v_and_b32 v52, v4, v10
    v_and_b32 v53, v4, v11
    v_and_b32 v54, v4, v12
    v_and_b32 v55, v4, v13
    v_and_b32 v56, v5, v10
    v_and_b32 v57, v5, v11
    v_and_b32 v58, v5, v12
    v_and_b32 v59, v5, v13
    v_mfma_f32_16x16x32_bf16 v[60:63], a[240:243], v[52:55], v[60:63]
    s_nop 0
    v_mfma_f32_16x16x32_bf16 v[64:67], a[240:243], v[56:59], v[64:67]
    s_waitcnt vmcnt(6)
    buffer_load_dwordx4 v[144:147], v76, s[52:55], s85 offen offset:0 nt
    v_perm_b32 v4, v34, v34, s81
    v_perm_b32 v5, v50, v50, s81
    v_and_b32 v52, v4, v10
    v_and_b32 v53, v4, v11
    v_and_b32 v54, v4, v12
    v_and_b32 v55, v4, v13
    v_and_b32 v56, v5, v10
    v_and_b32 v57, v5, v11
    v_and_b32 v58, v5, v12
    v_and_b32 v59, v5, v13
    v_mfma_f32_16x16x32_bf16 v[60:63], a[244:247], v[52:55], v[60:63]
    s_nop 0
    v_mfma_f32_16x16x32_bf16 v[64:67], a[244:247], v[56:59], v[64:67]
    s_waitcnt vmcnt(6)
    buffer_load_dwordx4 v[148:151], v77, s[52:55], s85 offen offset:0 nt
    v_perm_b32 v4, v35, v35, s80
    v_perm_b32 v5, v51, v51, s80
    v_and_b32 v52, v4, v10
    v_and_b32 v53, v4, v11
    v_and_b32 v54, v4, v12
    v_and_b32 v55, v4, v13
    v_and_b32 v56, v5, v10
    v_and_b32 v57, v5, v11
    v_and_b32 v58, v5, v12
    v_and_b32 v59, v5, v13
    v_mfma_f32_16x16x32_bf16 v[60:63], a[248:251], v[52:55], v[60:63]
    s_nop 0
    v_mfma_f32_16x16x32_bf16 v[64:67], a[248:251], v[56:59], v[64:67]
    s_waitcnt vmcnt(6)
    buffer_load_dwordx4 v[152:155], v76, s[52:55], s85 offen offset:1024 nt
    v_perm_b32 v4, v35, v35, s81
    v_perm_b32 v5, v51, v51, s81
    v_and_b32 v52, v4, v10
    v_and_b32 v53, v4, v11
    v_and_b32 v54, v4, v12
    v_and_b32 v55, v4, v13
    v_and_b32 v56, v5, v10
    v_and_b32 v57, v5, v11
    v_and_b32 v58, v5, v12
    v_and_b32 v59, v5, v13
    v_mfma_f32_16x16x32_bf16 v[60:63], a[252:255], v[52:55], v[60:63]
    s_nop 0
    v_mfma_f32_16x16x32_bf16 v[64:67], a[252:255], v[56:59], v[64:67]
    s_lshl_b32 s38, s34, 11
    v_lshrrev_b32 v4, 3, v3
    v_lshlrev_b32 v4, 9, v4
    v_lshl_add_u32 v4, v2, 7, v4
    v_and_b32 v5, 7, v3
    v_lshl_add_u32 v4, v5, 2, v4
    v_add_u32 v4, s38, v4
    ds_write_b32 v4, v60 offset:0
    ds_write_b32 v4, v61 offset:32
    ds_write_b32 v4, v62 offset:64
    ds_write_b32 v4, v63 offset:96
    ds_write_b32 v4, v64 offset:1024
    ds_write_b32 v4, v65 offset:1056
    ds_write_b32 v4, v66 offset:1088
    ds_write_b32 v4, v67 offset:1120
    s_lshl_b32 s38, s34, 9
    v_and_b32 v5, 31, v1
    v_lshl_add_u32 v5, v5, 4, s38
    s_waitcnt lgkmcnt(0)
    s_add_u32 s35, s35, 0x5b
    s_and_b32 s35, s35, 0xff
    v_mov_b32 v8, s35
    s_barrier
    ds_read_b128 v[20:23], v5 offset:0
    ds_read_b128 v[24:27], v5 offset:2048
    ds_read_b128 v[28:31], v5 offset:4096
    ds_read_b128 v[32:35], v5 offset:6144
    s_lshl_b32 s38, s61, 12
    s_add_u32 s36, s38, 262144
    s_lshl_b32 s38, s33, 11
    s_add_u32 s36, s38, s36
    s_waitcnt lgkmcnt(0)
    v_add_f32 v20, v20, v24
    v_add_f32 v28, v28, v32
    v_add_f32 v21, v21, v25
    v_add_f32 v29, v29, v33
    v_add_f32 v22, v22, v26
    v_add_f32 v30, v30, v34
    v_add_f32 v23, v23, v27
    v_add_f32 v31, v31, v35
    v_add_f32 v20, v20, v28
    v_add_f32 v21, v21, v29
    v_add_f32 v22, v22, v30
    v_add_f32 v23, v23, v31
    s_mov_b32 s38, 0xffff0000
    v_cvt_pk_bf16_f32 v20, v20, v20
    v_cvt_pk_bf16_f32 v21, v21, v21
    v_cvt_pk_bf16_f32 v22, v22, v22
    v_cvt_pk_bf16_f32 v23, v23, v23
    v_and_or_b32 v20, v20, s38, v8
    v_and_or_b32 v21, v21, s38, v8
    v_and_or_b32 v22, v22, s38, v8
    v_and_or_b32 v23, v23, s38, v8
    s_mov_b32 exec_lo, 0xffffffff
    s_mov_b32 exec_hi, 0x0
    buffer_store_dwordx4 v[20:23], v5, s[48:51], s36 offen sc1
    s_mov_b64 exec, -1
    s_waitcnt vmcnt(7)
    buffer_load_dwordx4 v[156:159], v77, s[52:55], s85 offen offset:1024 nt
    s_add_u32 s87, s87, 13
    s_add_u32 s39, s87, s88
    s_bfe_u32 s37, s39, 0x10000
    s_lshl_b32 s37, s37, 13
    s_add_u32 s85, s37, s89
    s_bfe_u32 s37, s39, 0x10001
    s_lshl_b32 s37, s37, 12
    s_add_u32 s85, s37, s85
    s_bfe_u32 s37, s39, 0x10002
    s_lshl_b32 s37, s37, 11
    s_add_u32 s85, s37, s85
    s_bfe_u32 s37, s39, 0x10003
    s_lshl_b32 s37, s37, 14
    s_add_u32 s85, s37, s85
    s_bfe_u32 s37, s39, 0x40004
    s_lshl_b32 s37, s37, 16
    s_add_u32 s85, s37, s85
    s_waitcnt vmcnt(7)
    buffer_load_dwordx4 v[160:163], v76, s[52:55], s85 offen offset:0 nt
    s_waitcnt vmcnt(7)
    buffer_load_dwordx4 v[164:167], v77, s[52:55], s85 offen offset:0 nt
    s_waitcnt vmcnt(7)
    buffer_load_dwordx4 v[168:171], v76, s[52:55], s85 offen offset:1024 nt
    s_waitcnt vmcnt(7)
    buffer_load_dwordx4 v[172:175], v77, s[52:55], s85 offen offset:1024 nt
    s_add_u32 s87, s87, 1
    s_add_u32 s39, s87, s88
    s_bfe_u32 s37, s39, 0x10000
    s_lshl_b32 s37, s37, 13
    s_add_u32 s85, s37, s89
    s_bfe_u32 s37, s39, 0x10001
    s_lshl_b32 s37, s37, 12
    s_add_u32 s85, s37, s85
    s_bfe_u32 s37, s39, 0x10002
    s_lshl_b32 s37, s37, 11
    s_add_u32 s85, s37, s85
    s_bfe_u32 s37, s39, 0x10003
    s_lshl_b32 s37, s37, 14
    s_add_u32 s85, s37, s85
    s_bfe_u32 s37, s39, 0x40004
    s_lshl_b32 s37, s37, 16
    s_add_u32 s85, s37, s85
    s_waitcnt vmcnt(7)
    buffer_load_dwordx4 v[176:179], v76, s[52:55], s85 offen offset:0 nt
    s_waitcnt vmcnt(7)
    buffer_load_dwordx4 v[180:183], v77, s[52:55], s85 offen offset:0 nt
    s_waitcnt vmcnt(6)
    buffer_load_dwordx4 v[184:187], v76, s[52:55], s85 offen offset:1024 nt
    s_waitcnt vmcnt(6)
    buffer_load_dwordx4 v[188:191], v77, s[52:55], s85 offen offset:1024 nt
    s_add_u32 s87, s87, 13
    s_add_u32 s39, s87, s88
    s_bfe_u32 s37, s39, 0x10000
    s_lshl_b32 s37, s37, 13
    s_add_u32 s85, s37, s89
    s_bfe_u32 s37, s39, 0x10001
    s_lshl_b32 s37, s37, 12
    s_add_u32 s85, s37, s85
    s_bfe_u32 s37, s39, 0x10002
    s_lshl_b32 s37, s37, 11
    s_add_u32 s85, s37, s85
    s_bfe_u32 s37, s39, 0x10003
    s_lshl_b32 s37, s37, 14
    s_add_u32 s85, s37, s85
    s_bfe_u32 s37, s39, 0x40004
    s_lshl_b32 s37, s37, 16
    s_add_u32 s85, s37, s85
    s_waitcnt vmcnt(6)
    buffer_load_dwordx4 v[192:195], v76, s[52:55], s85 offen offset:0 nt
    s_waitcnt vmcnt(6)
    buffer_load_dwordx4 v[196:199], v77, s[52:55], s85 offen offset:0 nt
    s_waitcnt vmcnt(6)
    buffer_load_dwordx4 v[200:203], v76, s[52:55], s85 offen offset:1024 nt
    s_waitcnt vmcnt(6)
    buffer_load_dwordx4 v[204:207], v77, s[52:55], s85 offen offset:1024 nt
    s_add_u32 s87, s87, 1
    s_add_u32 s39, s87, s88
    s_bfe_u32 s37, s39, 0x10000
    s_lshl_b32 s37, s37, 13
    s_add_u32 s85, s37, s89
    s_bfe_u32 s37, s39, 0x10001
    s_lshl_b32 s37, s37, 12
    s_add_u32 s85, s37, s85
    s_bfe_u32 s37, s39, 0x10002
    s_lshl_b32 s37, s37, 11
    s_add_u32 s85, s37, s85
    s_bfe_u32 s37, s39, 0x10003
    s_lshl_b32 s37, s37, 14
    s_add_u32 s85, s37, s85
    s_bfe_u32 s37, s39, 0x40004
    s_lshl_b32 s37, s37, 16
    s_add_u32 s85, s37, s85
    s_waitcnt vmcnt(6)
    buffer_load_dwordx4 v[208:211], v76, s[52:55], s85 offen offset:0 nt
    s_waitcnt vmcnt(6)
    buffer_load_dwordx4 v[212:215], v77, s[52:55], s85 offen offset:0 nt
    s_waitcnt vmcnt(6)
    buffer_load_dwordx4 v[216:219], v76, s[52:55], s85 offen offset:1024 nt
    s_waitcnt vmcnt(6)
    buffer_load_dwordx4 v[220:223], v77, s[52:55], s85 offen offset:1024 nt
    s_add_u32 s87, s87, 13
    s_add_u32 s39, s87, s88
    s_bfe_u32 s37, s39, 0x10000
    s_lshl_b32 s37, s37, 13
    s_add_u32 s85, s37, s89
    s_bfe_u32 s37, s39, 0x10001
    s_lshl_b32 s37, s37, 12
    s_add_u32 s85, s37, s85
    s_bfe_u32 s37, s39, 0x10002
    s_lshl_b32 s37, s37, 11
    s_add_u32 s85, s37, s85
    s_bfe_u32 s37, s39, 0x10003
    s_lshl_b32 s37, s37, 14
    s_add_u32 s85, s37, s85
    s_bfe_u32 s37, s39, 0x40004
    s_lshl_b32 s37, s37, 16
    s_add_u32 s85, s37, s85
    s_waitcnt vmcnt(6)
    buffer_load_dwordx4 v[224:227], v76, s[52:55], s85 offen offset:0 nt
    s_waitcnt vmcnt(6)
    buffer_load_dwordx4 v[228:231], v77, s[52:55], s85 offen offset:0 nt
    s_waitcnt vmcnt(6)
    buffer_load_dwordx4 v[232:235], v76, s[52:55], s85 offen offset:1024 nt
    s_waitcnt vmcnt(6)
    buffer_load_dwordx4 v[236:239], v77, s[52:55], s85 offen offset:1024 nt
    s_add_u32 s87, s87, 1
    s_add_u32 s39, s87, s88
    s_bfe_u32 s37, s39, 0x10000
    s_lshl_b32 s37, s37, 13
    s_add_u32 s85, s37, s89
    s_bfe_u32 s37, s39, 0x10001
    s_lshl_b32 s37, s37, 12
    s_add_u32 s85, s37, s85
    s_bfe_u32 s37, s39, 0x10002
    s_lshl_b32 s37, s37, 11
    s_add_u32 s85, s37, s85
    s_bfe_u32 s37, s39, 0x10003
    s_lshl_b32 s37, s37, 14
    s_add_u32 s85, s37, s85
    s_bfe_u32 s37, s39, 0x40004
    s_lshl_b32 s37, s37, 16
    s_add_u32 s85, s37, s85
    s_waitcnt vmcnt(6)
    buffer_load_dwordx4 v[240:243], v76, s[52:55], s85 offen offset:0 nt
    s_waitcnt vmcnt(6)
    buffer_load_dwordx4 v[244:247], v77, s[52:55], s85 offen offset:0 nt
    s_waitcnt vmcnt(6)
    buffer_load_dwordx4 v[248:251], v76, s[52:55], s85 offen offset:1024 nt
    s_waitcnt vmcnt(6)
    buffer_load_dwordx4 v[252:255], v77, s[52:55], s85 offen offset:1024 nt
    s_add_u32 s87, s87, 13
    s_add_u32 s39, s87, s88
    s_bfe_u32 s37, s39, 0x10000
    s_lshl_b32 s37, s37, 13
    s_add_u32 s85, s37, s89
    s_bfe_u32 s37, s39, 0x10001
    s_lshl_b32 s37, s37, 12
    s_add_u32 s85, s37, s85
    s_bfe_u32 s37, s39, 0x10002
    s_lshl_b32 s37, s37, 11
    s_add_u32 s85, s37, s85
    s_bfe_u32 s37, s39, 0x10003
    s_lshl_b32 s37, s37, 14
    s_add_u32 s85, s37, s85
    s_bfe_u32 s37, s39, 0x40004
    s_lshl_b32 s37, s37, 16
    s_add_u32 s85, s37, s85
    s_waitcnt vmcnt(6)
    buffer_load_dwordx4 a[0:3], v76, s[52:55], s85 offen offset:0 nt
    s_waitcnt vmcnt(6)
    buffer_load_dwordx4 a[4:7], v77, s[52:55], s85 offen offset:0 nt
    s_waitcnt vmcnt(6)
    buffer_load_dwordx4 a[8:11], v76, s[52:55], s85 offen offset:1024 nt
    s_waitcnt vmcnt(6)
    buffer_load_dwordx4 a[12:15], v77, s[52:55], s85 offen offset:1024 nt
    s_add_u32 s87, s87, 1
    s_add_u32 s39, s87, s88
    s_bfe_u32 s37, s39, 0x10000
    s_lshl_b32 s37, s37, 13
    s_add_u32 s85, s37, s89
    s_bfe_u32 s37, s39, 0x10001
    s_lshl_b32 s37, s37, 12
    s_add_u32 s85, s37, s85
    s_bfe_u32 s37, s39, 0x10002
    s_lshl_b32 s37, s37, 11
    s_add_u32 s85, s37, s85
    s_bfe_u32 s37, s39, 0x10003
    s_lshl_b32 s37, s37, 14
    s_add_u32 s85, s37, s85
    s_bfe_u32 s37, s39, 0x40004
    s_lshl_b32 s37, s37, 16
    s_add_u32 s85, s37, s85
    s_waitcnt vmcnt(6)
    buffer_load_dwordx4 a[16:19], v76, s[52:55], s85 offen offset:0 nt
    s_waitcnt vmcnt(6)
    buffer_load_dwordx4 a[20:23], v77, s[52:55], s85 offen offset:0 nt
    s_waitcnt vmcnt(6)
    buffer_load_dwordx4 a[24:27], v76, s[52:55], s85 offen offset:1024 nt
    s_waitcnt vmcnt(6)
    buffer_load_dwordx4 a[28:31], v77, s[52:55], s85 offen offset:1024 nt
    s_add_u32 s87, s87, 13
    s_add_u32 s39, s87, s88
    s_bfe_u32 s37, s39, 0x10000
    s_lshl_b32 s37, s37, 13
    s_add_u32 s85, s37, s89
    s_bfe_u32 s37, s39, 0x10001
    s_lshl_b32 s37, s37, 12
    s_add_u32 s85, s37, s85
    s_bfe_u32 s37, s39, 0x10002
    s_lshl_b32 s37, s37, 11
    s_add_u32 s85, s37, s85
    s_bfe_u32 s37, s39, 0x10003
    s_lshl_b32 s37, s37, 14
    s_add_u32 s85, s37, s85
    s_bfe_u32 s37, s39, 0x40004
    s_lshl_b32 s37, s37, 16
    s_add_u32 s85, s37, s85
    s_waitcnt vmcnt(6)
    buffer_load_dwordx4 a[32:35], v76, s[52:55], s85 offen offset:0 nt
    s_waitcnt vmcnt(6)
    buffer_load_dwordx4 a[36:39], v77, s[52:55], s85 offen offset:0 nt
    s_waitcnt vmcnt(6)
    buffer_load_dwordx4 a[40:43], v76, s[52:55], s85 offen offset:1024 nt
    s_waitcnt vmcnt(6)
    buffer_load_dwordx4 a[44:47], v77, s[52:55], s85 offen offset:1024 nt
    s_add_u32 s87, s87, 1
    s_add_u32 s39, s87, s88
    s_bfe_u32 s37, s39, 0x10000
    s_lshl_b32 s37, s37, 13
    s_add_u32 s85, s37, s89
    s_bfe_u32 s37, s39, 0x10001
    s_lshl_b32 s37, s37, 12
    s_add_u32 s85, s37, s85
    s_bfe_u32 s37, s39, 0x10002
    s_lshl_b32 s37, s37, 11
    s_add_u32 s85, s37, s85
    s_bfe_u32 s37, s39, 0x10003
    s_lshl_b32 s37, s37, 14
    s_add_u32 s85, s37, s85
    s_bfe_u32 s37, s39, 0x40004
    s_lshl_b32 s37, s37, 16
    s_add_u32 s85, s37, s85
    s_waitcnt vmcnt(6)
    buffer_load_dwordx4 a[48:51], v76, s[52:55], s85 offen offset:0 nt
    s_waitcnt vmcnt(6)
    buffer_load_dwordx4 a[52:55], v77, s[52:55], s85 offen offset:0 nt
    buffer_load_dwordx4 v[68:71], v78, s[48:51], s91 offen offset:0 sc1
    buffer_load_dwordx4 v[72:75], v78, s[48:51], s91 offen offset:16 sc1
    s_waitcnt vmcnt(8)
    buffer_load_dwordx4 a[56:59], v76, s[52:55], s85 offen offset:1024 nt
    s_waitcnt vmcnt(8)
    buffer_load_dwordx4 a[60:63], v77, s[52:55], s85 offen offset:1024 nt
    s_add_u32 s87, s87, 13
    s_add_u32 s39, s87, s88
    s_bfe_u32 s37, s39, 0x10000
    s_lshl_b32 s37, s37, 13
    s_add_u32 s85, s37, s89
    s_bfe_u32 s37, s39, 0x10001
    s_lshl_b32 s37, s37, 12
    s_add_u32 s85, s37, s85
    s_bfe_u32 s37, s39, 0x10002
    s_lshl_b32 s37, s37, 11
    s_add_u32 s85, s37, s85
    s_bfe_u32 s37, s39, 0x10003
    s_lshl_b32 s37, s37, 14
    s_add_u32 s85, s37, s85
    s_bfe_u32 s37, s39, 0x40004
    s_lshl_b32 s37, s37, 16
    s_add_u32 s85, s37, s85
    s_waitcnt vmcnt(8)
    buffer_load_dwordx4 a[64:67], v76, s[52:55], s85 offen offset:0 nt
    s_waitcnt vmcnt(8)
    buffer_load_dwordx4 a[68:71], v77, s[52:55], s85 offen offset:0 nt
    s_waitcnt vmcnt(8)
    buffer_load_dwordx4 a[72:75], v76, s[52:55], s85 offen offset:1024 nt
    s_waitcnt vmcnt(8)
    buffer_load_dwordx4 a[76:79], v77, s[52:55], s85 offen offset:1024 nt
    s_add_u32 s87, s87, 1
    s_add_u32 s39, s87, s88
    s_bfe_u32 s37, s39, 0x10000
    s_lshl_b32 s37, s37, 13
    s_add_u32 s85, s37, s89
    s_bfe_u32 s37, s39, 0x10001
    s_lshl_b32 s37, s37, 12
    s_add_u32 s85, s37, s85
    s_bfe_u32 s37, s39, 0x10002
    s_lshl_b32 s37, s37, 11
    s_add_u32 s85, s37, s85
    s_bfe_u32 s37, s39, 0x10003
    s_lshl_b32 s37, s37, 14
    s_add_u32 s85, s37, s85
    s_bfe_u32 s37, s39, 0x40004
    s_lshl_b32 s37, s37, 16
    s_add_u32 s85, s37, s85
    s_waitcnt vmcnt(6)
L_qcheck_39:
    v_xor_b32 v68, s35, v68
    v_xor_b32 v69, s35, v69
    v_xor_b32 v70, s35, v70
    v_xor_b32 v71, s35, v71
    v_xor_b32 v72, s35, v72
    v_xor_b32 v73, s35, v73
    v_xor_b32 v74, s35, v74
    v_xor_b32 v75, s35, v75
    v_or_b32 v4, v68, v69
    v_or3_b32 v4, v4, v70, v71
    v_or3_b32 v4, v4, v72, v73
    v_or3_b32 v4, v4, v74, v75
    v_and_b32 v4, 0xff, v4
    v_cmp_ne_u32 vcc, 0, v4
    s_cbranch_vccz L_qok_40
    buffer_load_dwordx4 v[68:71], v78, s[48:51], s91 offen offset:0 sc1
    buffer_load_dwordx4 v[72:75], v78, s[48:51], s91 offen offset:16 sc1
    s_waitcnt vmcnt(0)
    s_sub_u32 s84, s84, 1
    s_cmp_lg_u32 s84, 0
    s_cbranch_scc1 L_qcheck_39
    s_branch L_end
L_qok_40:
    v_cvt_pk_bf16_f32 v68, v68, v69
    v_cvt_pk_bf16_f32 v69, v70, v71
    v_cvt_pk_bf16_f32 v70, v72, v73
    v_cvt_pk_bf16_f32 v71, v74, v75
    s_mov_b32 vcc_lo, 0xf000f
    s_mov_b32 vcc_hi, 0xf000f
    v_cndmask_b32 v80, 0, v68, vcc
    v_cndmask_b32 v81, 0, v69, vcc
    v_cndmask_b32 v82, 0, v70, vcc
    v_cndmask_b32 v83, 0, v71, vcc
    s_mov_b32 vcc_lo, 0xf000f0
    s_mov_b32 vcc_hi, 0xf000f0
    v_cndmask_b32 v84, 0, v68, vcc
    v_cndmask_b32 v85, 0, v69, vcc
    v_cndmask_b32 v86, 0, v70, vcc
    v_cndmask_b32 v87, 0, v71, vcc
    s_mov_b32 vcc_lo, 0xf000f00
    s_mov_b32 vcc_hi, 0xf000f00
    v_cndmask_b32 v88, 0, v68, vcc
    v_cndmask_b32 v89, 0, v69, vcc
    v_cndmask_b32 v90, 0, v70, vcc
    v_cndmask_b32 v91, 0, v71, vcc
    s_mov_b32 vcc_lo, 0xf000f000
    s_mov_b32 vcc_hi, 0xf000f000
    v_cndmask_b32 v92, 0, v68, vcc
    v_cndmask_b32 v93, 0, v69, vcc
    v_cndmask_b32 v94, 0, v70, vcc
    v_cndmask_b32 v95, 0, v71, vcc
    s_getreg_b32 s70, hwreg(HW_REG_XCC_ID, 0, 4)
    s_lshl_b32 s70, s70, 8
    s_or_b32 s70, s70, s35
    s_or_b32 s70, s70, 0x5e9d0000
    s_bfe_u32 s38, s2, 0x30000
    s_lshl_b32 s38, s38, 8
    s_add_u32 s69, s38, 32768
    s_lshl_b32 s38, s32, 2
    s_add_u32 s69, s38, s69
    s_lshl_b32 s38, s34, 24
    s_add_u32 s69, s38, s69
    v_mov_b32 v72, s69
    v_mov_b32 v73, s70
    s_mov_b64 exec, 1
    buffer_store_dword v73, v72, s[48:51], 0 offen sc1
    s_mov_b64 exec, -1
    v_mov_b32 v65, 0xff7f0000
    s_lshl_b32 s38, s34, 14
    s_add_u32 s38, s38, 16384
    v_lshl_add_u32 v64, v1, 2, s38
    buffer_load_dwordx4 a[80:83], v76, s[52:55], s85 offen offset:0 nt
    v_mfma_f32_16x16x32_bf16 v[112:115], v[128:131], v[80:83], 0
    v_mfma_f32_16x16x32_bf16 v[112:115], v[132:135], v[84:87], v[112:115]
    v_mfma_f32_16x16x32_bf16 v[112:115], v[136:139], v[88:91], v[112:115]
    s_waitcnt vmcnt(7)
    buffer_load_dwordx4 a[84:87], v77, s[52:55], s85 offen offset:0 nt
    v_mfma_f32_16x16x32_bf16 v[112:115], v[140:143], v[92:95], v[112:115]
    v_mfma_f32_16x16x32_bf16 v[96:99], v[144:147], v[80:83], 0
    v_mfma_f32_16x16x32_bf16 v[96:99], v[148:151], v[84:87], v[96:99]
    v_mfma_f32_16x16x32_bf16 v[96:99], v[152:155], v[88:91], v[96:99]
    s_nop 4
    v_mov_b32_dpp v122, v112 quad_perm:[0,0,0,0] row_mask:0xf bank_mask:0xf
    v_mov_b32_dpp v124, v114 quad_perm:[2,2,2,2] row_mask:0xf bank_mask:0xf
    s_nop 0
    v_add_f32_dpp v122, v113, v122 quad_perm:[1,1,1,1] row_mask:0xf bank_mask:0xf
    v_add_f32_dpp v124, v115, v124 quad_perm:[3,3,3,3] row_mask:0xf bank_mask:0xf
    v_add_f32 v122, v122, v124
    v_max_f32 v65, v65, v122
    ds_write_b32 v64, v122 offset:0
    s_waitcnt vmcnt(7)
    buffer_load_dwordx4 a[88:91], v76, s[52:55], s85 offen offset:1024 nt
    v_mfma_f32_16x16x32_bf16 v[96:99], v[156:159], v[92:95], v[96:99]
    v_mfma_f32_16x16x32_bf16 v[112:115], v[160:163], v[80:83], 0
    v_mfma_f32_16x16x32_bf16 v[112:115], v[164:167], v[84:87], v[112:115]
    s_waitcnt vmcnt(7)
    buffer_load_dwordx4 a[92:95], v77, s[52:55], s85 offen offset:1024 nt
    s_add_u32 s87, s87, 13
    s_add_u32 s39, s87, s88
    s_bfe_u32 s37, s39, 0x10000
    s_lshl_b32 s37, s37, 13
    s_add_u32 s85, s37, s89
    s_bfe_u32 s37, s39, 0x10001
    s_lshl_b32 s37, s37, 12
    s_add_u32 s85, s37, s85
    s_bfe_u32 s37, s39, 0x10002
    s_lshl_b32 s37, s37, 11
    s_add_u32 s85, s37, s85
    s_bfe_u32 s37, s39, 0x10003
    s_lshl_b32 s37, s37, 14
    s_add_u32 s85, s37, s85
    s_bfe_u32 s37, s39, 0x40004
    s_lshl_b32 s37, s37, 16
    s_add_u32 s85, s37, s85
    v_mfma_f32_16x16x32_bf16 v[112:115], v[168:171], v[88:91], v[112:115]
    v_mov_b32_dpp v122, v96 quad_perm:[0,0,0,0] row_mask:0xf bank_mask:0xf
    v_mov_b32_dpp v124, v98 quad_perm:[2,2,2,2] row_mask:0xf bank_mask:0xf
    s_nop 0
    v_add_f32_dpp v122, v97, v122 quad_perm:[1,1,1,1] row_mask:0xf bank_mask:0xf
    v_add_f32_dpp v124, v99, v124 quad_perm:[3,3,3,3] row_mask:0xf bank_mask:0xf
    v_add_f32 v122, v122, v124
    v_max_f32 v65, v65, v122
    ds_write_b32 v64, v122 offset:256
    v_mfma_f32_16x16x32_bf16 v[112:115], v[172:175], v[92:95], v[112:115]
    v_mfma_f32_16x16x32_bf16 v[96:99], v[176:179], v[80:83], 0
    v_mfma_f32_16x16x32_bf16 v[96:99], v[180:183], v[84:87], v[96:99]
    s_waitcnt vmcnt(7)
    buffer_load_dwordx4 a[96:99], v76, s[52:55], s85 offen offset:0 nt
    v_mfma_f32_16x16x32_bf16 v[96:99], v[184:187], v[88:91], v[96:99]
    s_nop 2
    v_mov_b32_dpp v122, v112 quad_perm:[0,0,0,0] row_mask:0xf bank_mask:0xf
    v_mov_b32_dpp v124, v114 quad_perm:[2,2,2,2] row_mask:0xf bank_mask:0xf
    s_nop 0
    v_add_f32_dpp v122, v113, v122 quad_perm:[1,1,1,1] row_mask:0xf bank_mask:0xf
    v_add_f32_dpp v124, v115, v124 quad_perm:[3,3,3,3] row_mask:0xf bank_mask:0xf
    v_add_f32 v122, v122, v124
    v_max_f32 v65, v65, v122
    ds_write_b32 v64, v122 offset:512
    v_mfma_f32_16x16x32_bf16 v[96:99], v[188:191], v[92:95], v[96:99]
    v_mfma_f32_16x16x32_bf16 v[112:115], v[192:195], v[80:83], 0
    s_waitcnt vmcnt(7)
    buffer_load_dwordx4 a[100:103], v77, s[52:55], s85 offen offset:0 nt
    v_mfma_f32_16x16x32_bf16 v[112:115], v[196:199], v[84:87], v[112:115]
    v_mfma_f32_16x16x32_bf16 v[112:115], v[200:203], v[88:91], v[112:115]
    s_nop 2
    v_mov_b32_dpp v122, v96 quad_perm:[0,0,0,0] row_mask:0xf bank_mask:0xf
    v_mov_b32_dpp v124, v98 quad_perm:[2,2,2,2] row_mask:0xf bank_mask:0xf
    s_nop 0
    v_add_f32_dpp v122, v97, v122 quad_perm:[1,1,1,1] row_mask:0xf bank_mask:0xf
    v_add_f32_dpp v124, v99, v124 quad_perm:[3,3,3,3] row_mask:0xf bank_mask:0xf
    v_add_f32 v122, v122, v124
    v_max_f32 v65, v65, v122
    ds_write_b32 v64, v122 offset:768
    v_mfma_f32_16x16x32_bf16 v[112:115], v[204:207], v[92:95], v[112:115]
    v_mfma_f32_16x16x32_bf16 v[96:99], v[208:211], v[80:83], 0
    s_waitcnt vmcnt(7)
    buffer_load_dwordx4 a[104:107], v76, s[52:55], s85 offen offset:1024 nt
    v_mfma_f32_16x16x32_bf16 v[96:99], v[212:215], v[84:87], v[96:99]
    v_mfma_f32_16x16x32_bf16 v[96:99], v[216:219], v[88:91], v[96:99]
    s_nop 2
    v_mov_b32_dpp v122, v112 quad_perm:[0,0,0,0] row_mask:0xf bank_mask:0xf
    v_mov_b32_dpp v124, v114 quad_perm:[2,2,2,2] row_mask:0xf bank_mask:0xf
    s_nop 0
    v_add_f32_dpp v122, v113, v122 quad_perm:[1,1,1,1] row_mask:0xf bank_mask:0xf
    v_add_f32_dpp v124, v115, v124 quad_perm:[3,3,3,3] row_mask:0xf bank_mask:0xf
    v_add_f32 v122, v122, v124
    v_max_f32 v65, v65, v122
    ds_write_b32 v64, v122 offset:1024
    v_mfma_f32_16x16x32_bf16 v[96:99], v[220:223], v[92:95], v[96:99]
    s_waitcnt vmcnt(6)
    buffer_load_dwordx4 a[108:111], v77, s[52:55], s85 offen offset:1024 nt
    s_add_u32 s87, s87, 1
    s_add_u32 s39, s87, s88
    s_bfe_u32 s37, s39, 0x10000
    s_lshl_b32 s37, s37, 13
    s_add_u32 s85, s37, s89
    s_bfe_u32 s37, s39, 0x10001
    s_lshl_b32 s37, s37, 12
    s_add_u32 s85, s37, s85
    s_bfe_u32 s37, s39, 0x10002
    s_lshl_b32 s37, s37, 11
    s_add_u32 s85, s37, s85
    s_bfe_u32 s37, s39, 0x10003
    s_lshl_b32 s37, s37, 14
    s_add_u32 s85, s37, s85
    s_bfe_u32 s37, s39, 0x40004
    s_lshl_b32 s37, s37, 16
    s_add_u32 s85, s37, s85
    v_mfma_f32_16x16x32_bf16 v[112:115], v[224:227], v[80:83], 0
    v_mfma_f32_16x16x32_bf16 v[112:115], v[228:231], v[84:87], v[112:115]
    v_mfma_f32_16x16x32_bf16 v[112:115], v[232:235], v[88:91], v[112:115]
    v_mov_b32_dpp v122, v96 quad_perm:[0,0,0,0] row_mask:0xf bank_mask:0xf
    v_mov_b32_dpp v124, v98 quad_perm:[2,2,2,2] row_mask:0xf bank_mask:0xf
    s_nop 0
    v_add_f32_dpp v122, v97, v122 quad_perm:[1,1,1,1] row_mask:0xf bank_mask:0xf
    v_add_f32_dpp v124, v99, v124 quad_perm:[3,3,3,3] row_mask:0xf bank_mask:0xf
    v_add_f32 v122, v122, v124
    v_max_f32 v65, v65, v122
    ds_write_b32 v64, v122 offset:1280
    v_mfma_f32_16x16x32_bf16 v[112:115], v[236:239], v[92:95], v[112:115]
    s_waitcnt vmcnt(6)
    buffer_load_dwordx4 a[112:115], v76, s[52:55], s85 offen offset:0 nt
    v_mfma_f32_16x16x32_bf16 v[96:99], v[240:243], v[80:83], 0
    v_mfma_f32_16x16x32_bf16 v[96:99], v[244:247], v[84:87], v[96:99]
    v_mfma_f32_16x16x32_bf16 v[96:99], v[248:251], v[88:91], v[96:99]
    s_nop 2
    v_mov_b32_dpp v122, v112 quad_perm:[0,0,0,0] row_mask:0xf bank_mask:0xf
    v_mov_b32_dpp v124, v114 quad_perm:[2,2,2,2] row_mask:0xf bank_mask:0xf
    s_nop 0
    v_add_f32_dpp v122, v113, v122 quad_perm:[1,1,1,1] row_mask:0xf bank_mask:0xf
    v_add_f32_dpp v124, v115, v124 quad_perm:[3,3,3,3] row_mask:0xf bank_mask:0xf
    v_add_f32 v122, v122, v124
    v_max_f32 v65, v65, v122
    ds_write_b32 v64, v122 offset:1536
    v_mfma_f32_16x16x32_bf16 v[96:99], v[252:255], v[92:95], v[96:99]
    s_waitcnt vmcnt(6)
    buffer_load_dwordx4 a[116:119], v77, s[52:55], s85 offen offset:0 nt
    v_mfma_f32_16x16x32_bf16 v[112:115], a[0:3], v[80:83], 0
    v_mfma_f32_16x16x32_bf16 v[112:115], a[4:7], v[84:87], v[112:115]
    v_mfma_f32_16x16x32_bf16 v[112:115], a[8:11], v[88:91], v[112:115]
    s_nop 2
    v_mov_b32_dpp v122, v96 quad_perm:[0,0,0,0] row_mask:0xf bank_mask:0xf
    v_mov_b32_dpp v124, v98 quad_perm:[2,2,2,2] row_mask:0xf bank_mask:0xf
    s_nop 0
    v_add_f32_dpp v122, v97, v122 quad_perm:[1,1,1,1] row_mask:0xf bank_mask:0xf
    v_add_f32_dpp v124, v99, v124 quad_perm:[3,3,3,3] row_mask:0xf bank_mask:0xf
    v_add_f32 v122, v122, v124
    v_max_f32 v65, v65, v122
    ds_write_b32 v64, v122 offset:1792
    s_waitcnt vmcnt(6)
    buffer_load_dwordx4 a[120:123], v76, s[52:55], s85 offen offset:1024 nt
    v_mfma_f32_16x16x32_bf16 v[112:115], a[12:15], v[92:95], v[112:115]
    v_mfma_f32_16x16x32_bf16 v[96:99], a[16:19], v[80:83], 0
    v_mfma_f32_16x16x32_bf16 v[96:99], a[20:23], v[84:87], v[96:99]
    v_mfma_f32_16x16x32_bf16 v[96:99], a[24:27], v[88:91], v[96:99]
    s_nop 4
    v_mov_b32_dpp v122, v112 quad_perm:[0,0,0,0] row_mask:0xf bank_mask:0xf
    v_mov_b32_dpp v124, v114 quad_perm:[2,2,2,2] row_mask:0xf bank_mask:0xf
    s_nop 0
    v_add_f32_dpp v122, v113, v122 quad_perm:[1,1,1,1] row_mask:0xf bank_mask:0xf
    v_add_f32_dpp v124, v115, v124 quad_perm:[3,3,3,3] row_mask:0xf bank_mask:0xf
    v_add_f32 v122, v122, v124
    v_max_f32 v65, v65, v122
    ds_write_b32 v64, v122 offset:2048
    s_waitcnt vmcnt(6)
    buffer_load_dwordx4 a[124:127], v77, s[52:55], s85 offen offset:1024 nt
    s_add_u32 s87, s87, 13
    s_add_u32 s39, s87, s88
    s_bfe_u32 s37, s39, 0x10000
    s_lshl_b32 s37, s37, 13
    s_add_u32 s85, s37, s89
    s_bfe_u32 s37, s39, 0x10001
    s_lshl_b32 s37, s37, 12
    s_add_u32 s85, s37, s85
    s_bfe_u32 s37, s39, 0x10002
    s_lshl_b32 s37, s37, 11
    s_add_u32 s85, s37, s85
    s_bfe_u32 s37, s39, 0x10003
    s_lshl_b32 s37, s37, 14
    s_add_u32 s85, s37, s85
    s_bfe_u32 s37, s39, 0x40004
    s_lshl_b32 s37, s37, 16
    s_add_u32 s85, s37, s85
    v_mfma_f32_16x16x32_bf16 v[96:99], a[28:31], v[92:95], v[96:99]
    v_mfma_f32_16x16x32_bf16 v[112:115], a[32:35], v[80:83], 0
    s_bfe_u32 s38, s2, 0x20001
    s_lshl_b32 s38, s38, 0
    s_add_u32 s90, s38, 0
    s_bfe_u32 s38, s2, 0x10000
    s_lshl_b32 s38, s38, 2
    s_add_u32 s90, s38, s90
    s_and_b32 s36, s90, 3
    s_bitcmp0_b32 s90, 2
    s_cselect_b64 s[40:41], s[24:25], s[14:15]
    s_cselect_b32 s45, 262144, 0
    s_add_u32 s45, s45, 524288
    s_lshl_b32 s38, s36, 16
    s_add_u32 s71, s38, s45
    s_lshr_b32 s38, s32, 2
    s_lshl_b32 s38, s38, 13
    s_add_u32 s71, s38, s71
    s_bfe_u32 s38, s32, 0x20000
    s_lshl_b32 s38, s38, 6
    s_add_u32 s71, s38, s71
    s_mov_b32 s42, 4194304
    s_mov_b32 s43, 0x20000
    s_lshl_b32 s38, s32, 17
    s_add_u32 s44, s38, 0
    s_lshl_b32 s38, s34, 15
    s_add_u32 s44, s38, s44
    s_lshl_b32 s38, s36, 8
    s_add_u32 s44, s38, s44
    s_lshl_b32 s38, s36, 16
    s_add_u32 s45, s38, s45
    s_lshr_b32 s38, s34, 1
    s_lshl_b32 s38, s38, 15
    s_add_u32 s45, s38, s45
    s_lshl_b32 s38, s32, 8
    s_add_u32 s45, s38, s45
    s_bfe_u32 s38, s34, 0x10000
    s_lshl_b32 s38, s38, 7
    s_add_u32 s45, s38, s45
    s_lshl_b32 s38, s32, 11
    s_add_u32 s46, s38, 196608
    s_lshl_b32 s38, s34, 9
    s_add_u32 s46, s38, s46
    s_mov_b32 s72, s26
    s_and_b32 s73, s27, 0xffff
    s_mov_b32 s74, 8192
    s_mov_b32 s75, 0x20000
    v_mfma_f32_16x16x32_bf16 v[112:115], a[36:39], v[84:87], v[112:115]
    s_waitcnt vmcnt(5)
    buffer_load_dwordx4 v[128:131], v76, s[52:55], s85 offen offset:0 nt
    v_mfma_f32_16x16x32_bf16 v[112:115], a[40:43], v[88:91], v[112:115]
    v_mov_b32_dpp v122, v96 quad_perm:[0,0,0,0] row_mask:0xf bank_mask:0xf
    v_mov_b32_dpp v124, v98 quad_perm:[2,2,2,2] row_mask:0xf bank_mask:0xf
    s_nop 0
    v_add_f32_dpp v122, v97, v122 quad_perm:[1,1,1,1] row_mask:0xf bank_mask:0xf
    v_add_f32_dpp v124, v99, v124 quad_perm:[3,3,3,3] row_mask:0xf bank_mask:0xf
    v_add_f32 v122, v122, v124
    v_max_f32 v65, v65, v122
    ds_write_b32 v64, v122 offset:2304
    v_mfma_f32_16x16x32_bf16 v[112:115], a[44:47], v[92:95], v[112:115]
    v_mfma_f32_16x16x32_bf16 v[96:99], a[48:51], v[80:83], 0
    v_mfma_f32_16x16x32_bf16 v[96:99], a[52:55], v[84:87], v[96:99]
    s_waitcnt vmcnt(5)
    buffer_load_dwordx4 v[132:135], v77, s[52:55], s85 offen offset:0 nt
    v_mfma_f32_16x16x32_bf16 v[96:99], a[56:59], v[88:91], v[96:99]
    s_nop 2
    v_mov_b32_dpp v122, v112 quad_perm:[0,0,0,0] row_mask:0xf bank_mask:0xf
    v_mov_b32_dpp v124, v114 quad_perm:[2,2,2,2] row_mask:0xf bank_mask:0xf
    s_nop 0
    v_add_f32_dpp v122, v113, v122 quad_perm:[1,1,1,1] row_mask:0xf bank_mask:0xf
    v_add_f32_dpp v124, v115, v124 quad_perm:[3,3,3,3] row_mask:0xf bank_mask:0xf
    v_add_f32 v122, v122, v124
    v_max_f32 v65, v65, v122
    ds_write_b32 v64, v122 offset:2560
    v_lshlrev_b32 v4, 2, v2
    v_xor_b32 v4, v4, v3
    v_xor_b32 v5, 0, v4
    v_lshlrev_b32 v5, 4, v5
    v_lshl_add_u32 v20, v2, 10, v5
    v_xor_b32 v5, 1, v4
    v_lshlrev_b32 v5, 4, v5
    v_lshl_add_u32 v21, v2, 10, v5
    v_add_u32 v21, 3072, v21
    v_xor_b32 v5, 2, v4
    v_lshlrev_b32 v5, 4, v5
    v_lshl_add_u32 v22, v2, 10, v5
    v_add_u32 v22, 6144, v22
    v_xor_b32 v5, 3, v4
    v_lshlrev_b32 v5, 4, v5
    v_lshl_add_u32 v23, v2, 10, v5
    v_add_u32 v23, 9216, v23
    s_lshl_b32 s38, s32, 15
    s_add_u32 s47, s38, 1048576
    s_lshl_b32 s38, s3, 13
    s_add_u32 s47, s38, s47
    v_lshlrev_b32 v6, 7, v2
    v_bfe_u32 v5, v3, 0, 3
    v_lshl_add_u32 v6, v5, 4, v6
    v_lshrrev_b32 v4, 3, v3
    v_and_b32 v7, 3, v3
    v_min_u32 v7, 2, v7
    v_lshl_add_u32 v7, v7, 1, v4
    v_add_u32 v5, 0, v4
    v_cmp_le_u32 vcc, s33, v5
    s_nop 1
    v_addc_co_u32 v5, vcc, 0, v5, vcc
    v_lshl_add_u32 v50, v5, 10, v6
    v_add_u32 v5, 2, v4
    v_cmp_le_u32 vcc, s33, v5
    s_nop 1
    v_addc_co_u32 v5, vcc, 0, v5, vcc
    v_lshl_add_u32 v51, v5, 10, v6
    v_add_u32 v5, 4, v4
    v_cmp_le_u32 vcc, s33, v5
    s_nop 1
    v_addc_co_u32 v5, vcc, 0, v5, vcc
    v_lshl_add_u32 v52, v5, 10, v6
    v_mov_b32 v5, v7
    v_mov_b32 v6, 512
    v_cmp_le_u32 vcc, s33, v5
    s_nop 1
    v_addc_co_u32 v5, vcc, 0, v5, vcc
    v_lshl_add_u32 v53, v5, 10, v6
    s_mul_i32 s38, s3, 320
    s_add_u32 s38, s38, 135168
    v_lshlrev_b32 v4, 6, v2
    v_lshl_add_u32 v4, v3, 1, v4
    v_add_u32 v31, s38, v4
    v_mfma_f32_16x16x32_bf16 v[96:99], a[60:63], v[92:95], v[96:99]
    v_mfma_f32_16x16x32_bf16 v[112:115], a[64:67], v[80:83], 0
    s_waitcnt vmcnt(5)
    buffer_load_dwordx4 v[136:139], v76, s[52:55], s85 offen offset:1024 nt
    v_mfma_f32_16x16x32_bf16 v[112:115], a[68:71], v[84:87], v[112:115]
    v_mfma_f32_16x16x32_bf16 v[112:115], a[72:75], v[88:91], v[112:115]
    s_nop 2
    v_mov_b32_dpp v122, v96 quad_perm:[0,0,0,0] row_mask:0xf bank_mask:0xf
    v_mov_b32_dpp v124, v98 quad_perm:[2,2,2,2] row_mask:0xf bank_mask:0xf
    s_nop 0
    v_add_f32_dpp v122, v97, v122 quad_perm:[1,1,1,1] row_mask:0xf bank_mask:0xf
    v_add_f32_dpp v124, v99, v124 quad_perm:[3,3,3,3] row_mask:0xf bank_mask:0xf
    v_add_f32 v122, v122, v124
    v_max_f32 v65, v65, v122
    ds_write_b32 v64, v122 offset:2816
    v_mfma_f32_16x16x32_bf16 v[112:115], a[76:79], v[92:95], v[112:115]
    v_mfma_f32_16x16x32_bf16 v[96:99], a[80:83], v[80:83], 0
    v_lshlrev_b32 v4, 11, v2
    v_bfe_u32 v5, v1, 2, 2
    v_lshl_add_u32 v4, v5, 8, v4
    v_bfe_u32 v5, v1, 2, 2
    v_lshl_add_u32 v4, v5, 6, v4
    v_bfe_u32 v5, v1, 4, 1
    v_lshl_add_u32 v4, v5, 5, v4
    v_bfe_u32 v5, v1, 1, 1
    v_lshl_add_u32 v4, v5, 4, v4
    v_bfe_u32 v5, v1, 0, 1
    v_lshl_add_u32 v4, v5, 3, v4
    s_lshl_b32 s38, s34, 6
    s_add_u32 s38, s38, 98304
    v_xor_b32 v24, s38, v4
    v_xor_b32 v25, 16, v24
    v_xor_b32 v26, 32, v24
    v_xor_b32 v27, 48, v24
    v_and_b32 v4, 3, v3
    v_lshrrev_b32 v5, 2, v3
    v_lshlrev_b32 v6, 4, v2
    v_add_u32 v6, 135168, v6
    s_movk_i32 s36, 320
    v_cmp_eq_u32 vcc, 0, v5
    s_nop 1
    v_cndmask_b32 v28, 4, v4, vcc
    v_mad_u32_u24 v28, v28, s36, v6
    v_cmp_eq_u32 vcc, 1, v5
    s_nop 1
    v_cndmask_b32 v29, 4, v4, vcc
    v_mad_u32_u24 v29, v29, s36, v6
    v_lshlrev_b32 v5, 2, v1
    v_add_u32 v5, 136448, v5
    v_mov_b32 v6, 0
    ds_write_b32 v5, v6
    s_waitcnt vmcnt(5)
    buffer_load_dwordx4 v[140:143], v77, s[52:55], s85 offen offset:1024 nt
    s_add_u32 s87, s87, 1
    s_add_u32 s39, s87, s88
    s_bfe_u32 s37, s39, 0x10000
    s_lshl_b32 s37, s37, 13
    s_add_u32 s85, s37, s89
    s_bfe_u32 s37, s39, 0x10001
    s_lshl_b32 s37, s37, 12
    s_add_u32 s85, s37, s85
    s_bfe_u32 s37, s39, 0x10002
    s_lshl_b32 s37, s37, 11
    s_add_u32 s85, s37, s85
    s_bfe_u32 s37, s39, 0x10003
    s_lshl_b32 s37, s37, 14
    s_add_u32 s85, s37, s85
    s_bfe_u32 s37, s39, 0x40004
    s_lshl_b32 s37, s37, 16
    s_add_u32 s85, s37, s85
    v_mfma_f32_16x16x32_bf16 v[96:99], a[84:87], v[84:87], v[96:99]
    v_mfma_f32_16x16x32_bf16 v[96:99], a[88:91], v[88:91], v[96:99]
    v_mov_b32_dpp v122, v112 quad_perm:[0,0,0,0] row_mask:0xf bank_mask:0xf
    v_mov_b32_dpp v124, v114 quad_perm:[2,2,2,2] row_mask:0xf bank_mask:0xf
    s_nop 0
    v_add_f32_dpp v122, v113, v122 quad_perm:[1,1,1,1] row_mask:0xf bank_mask:0xf
    v_add_f32_dpp v124, v115, v124 quad_perm:[3,3,3,3] row_mask:0xf bank_mask:0xf
    v_add_f32 v122, v122, v124
    v_max_f32 v65, v65, v122
    ds_write_b32 v64, v122 offset:3072
    v_mfma_f32_16x16x32_bf16 v[96:99], a[92:95], v[92:95], v[96:99]
    s_waitcnt vmcnt(5)
    buffer_load_dwordx4 v[144:147], v76, s[52:55], s85 offen offset:0 nt
    v_mfma_f32_16x16x32_bf16 v[112:115], a[96:99], v[80:83], 0
    v_mfma_f32_16x16x32_bf16 v[112:115], a[100:103], v[84:87], v[112:115]
    v_mfma_f32_16x16x32_bf16 v[112:115], a[104:107], v[88:91], v[112:115]
    s_nop 2
    v_mov_b32_dpp v122, v96 quad_perm:[0,0,0,0] row_mask:0xf bank_mask:0xf
    v_mov_b32_dpp v124, v98 quad_perm:[2,2,2,2] row_mask:0xf bank_mask:0xf
    s_nop 0
    v_add_f32_dpp v122, v97, v122 quad_perm:[1,1,1,1] row_mask:0xf bank_mask:0xf
    v_add_f32_dpp v124, v99, v124 quad_perm:[3,3,3,3] row_mask:0xf bank_mask:0xf
    v_add_f32 v122, v122, v124
    v_max_f32 v65, v65, v122
    ds_write_b32 v64, v122 offset:3328
    v_lshlrev_b32 v30, 4, v3
    v_lshl_add_u32 v30, v2, 13, v30
    v_lshrrev_b32 v5, 2, v1
    v_lshlrev_b32 v32, 8, v5
    v_bfe_u32 v5, v1, 0, 2
    v_lshl_add_u32 v32, v5, 4, v32
    s_xor_b32 s37, s90, 4
    s_bfe_u32 s38, s37, 0x30000
    s_lshl_b32 s38, s38, 8
    s_add_u32 s36, s38, 0
    s_lshr_b32 s38, s32, 4
    s_lshl_b32 s38, s38, 7
    s_add_u32 s36, s38, s36
    s_bfe_u32 s38, s32, 0x20000
    s_lshl_b32 s38, s38, 5
    s_add_u32 s36, s38, s36
    s_bfe_u32 s38, s32, 0x20002
    s_lshl_b32 s38, s38, 3
    s_add_u32 s36, s38, s36
    v_bfe_u32 v5, v1, 0, 2
    v_lshlrev_b32 v33, 11, v5
    v_lshl_add_u32 v33, v2, 1, v33
    v_add_u32 v33, s36, v33
    v_and_b32 v5, 31, v1
    v_lshlrev_b32 v34, 4, v5
    s_mul_i32 s38, s34, 320
    s_add_u32 s38, s38, 135168
    v_lshl_add_u32 v35, v5, 3, s38
    s_bfe_u32 s38, s34, 0x10000
    s_lshl_b32 s38, s38, 12
    s_add_u32 s36, s38, s71
    s_lshr_b32 s38, s34, 1
    s_lshl_b32 s38, s38, 24
    s_add_u32 s36, s38, s36
    s_bitcmp1_b32 s90, 2
    s_cselect_b32 s46, s46, s36
    s_cselect_b64 vcc, -1, 0
    v_cndmask_b32 v54, v32, v34, vcc
    v_mfma_f32_16x16x32_bf16 v[112:115], a[108:111], v[92:95], v[112:115]
    s_waitcnt vmcnt(5)
    buffer_load_dwordx4 v[148:151], v77, s[52:55], s85 offen offset:0 nt
    v_mfma_f32_16x16x32_bf16 v[96:99], a[112:115], v[80:83], 0
    v_mfma_f32_16x16x32_bf16 v[96:99], a[116:119], v[84:87], v[96:99]
    v_mfma_f32_16x16x32_bf16 v[96:99], a[120:123], v[88:91], v[96:99]
    s_nop 2
    v_mov_b32_dpp v122, v112 quad_perm:[0,0,0,0] row_mask:0xf bank_mask:0xf
    v_mov_b32_dpp v124, v114 quad_perm:[2,2,2,2] row_mask:0xf bank_mask:0xf
    s_nop 0
    v_add_f32_dpp v122, v113, v122 quad_perm:[1,1,1,1] row_mask:0xf bank_mask:0xf
    v_add_f32_dpp v124, v115, v124 quad_perm:[3,3,3,3] row_mask:0xf bank_mask:0xf
    v_add_f32 v122, v122, v124
    v_max_f32 v65, v65, v122
    ds_write_b32 v64, v122 offset:3584
    v_mfma_f32_16x16x32_bf16 v[96:99], a[124:127], v[92:95], v[96:99]
    v_add_u32 v64, 3840, v64
    s_mov_b32 s97, 8
    s_mov_b32 s92, 1
    s_lshl_b32 s38, s32, 13
    s_add_u32 s80, s38, 3145728
    s_lshl_b32 s38, s3, 11
    s_add_u32 s80, s38, s80
    v_lshrrev_b32 v4, 2, v1
    v_lshlrev_b32 v55, 3, v4
    s_mov_b32 s66, 134217728
    s_mov_b32 s67, 0x20000
    s_mov_b64 s[64:65], s[52:53]
    v_mov_b32 v62, v76
    v_mov_b32 v63, v77
    s_branch L_bloop
L_ql:
    v_lshrrev_b32 v4, 2, v3
    v_and_b32 v5, 3, v3
    v_lshlrev_b32 v19, 6, v2
    v_lshl_add_u32 v19, v5, 4, v19
    v_lshl_add_u32 v14, v4, 18, v19
    s_and_b32 s61, s32, 28
    s_add_u32 s61, s61, s34
    s_and_b32 s60, s32, 3
    s_lshl_b32 s38, s60, 20
    s_add_u32 s63, s38, 0
    s_lshl_b32 s38, s61, 8
    s_add_u32 s63, s38, s63
    s_mov_b32 s74, 4194304
    s_mov_b32 s75, 0x20000
    s_waitcnt lgkmcnt(0)
    s_mov_b64 s[72:73], s[10:11]
    buffer_load_dwordx4 a[128:131], v14, s[72:75], s63 offen nt
    s_add_u32 s63, s63, 8192
    buffer_load_dwordx4 a[132:135], v14, s[72:75], s63 offen nt
    s_add_u32 s63, s63, 8192
    buffer_load_dwordx4 a[136:139], v14, s[72:75], s63 offen nt
    s_add_u32 s63, s63, 8192
    buffer_load_dwordx4 a[140:143], v14, s[72:75], s63 offen nt
    s_add_u32 s63, s63, 8192
    buffer_load_dwordx4 a[144:147], v14, s[72:75], s63 offen nt
    s_add_u32 s63, s63, 8192
    buffer_load_dwordx4 a[148:151], v14, s[72:75], s63 offen nt
    s_add_u32 s63, s63, 8192
    buffer_load_dwordx4 a[152:155], v14, s[72:75], s63 offen nt
    s_add_u32 s63, s63, 8192
    buffer_load_dwordx4 a[156:159], v14, s[72:75], s63 offen nt
    s_add_u32 s63, s63, 8192
    v_lshlrev_b32 v15, 1, v19
    v_lshl_add_u32 v15, v4, 9, v15
    v_lshl_add_u32 v19, v4, 15, v19
    s_load_dword s35, s[30:31], 0
    s_mov_b32 s48, s30
    s_and_b32 s49, s31, 0xffff
    s_mov_b32 s50, 8388608
    s_mov_b32 s51, 0x20000
    s_mov_b32 s82, 0xffffff00
    s_mov_b32 s83, 0x3e0293ee
    s_mov_b32 s84, 8388608
    s_lshl_b32 s38, s61, 12
    s_add_u32 s95, s38, 264192
    s_lshl_b32 s38, s61, 10
    s_add_u32 s94, s38, 393216
    s_lshl_b32 s38, s60, 8
    s_add_u32 s94, s38, s94
    buffer_load_dwordx4 a[160:163], v14, s[72:75], s63 offen nt
    s_add_u32 s63, s63, 8192
    buffer_load_dwordx4 a[164:167], v14, s[72:75], s63 offen nt
    s_add_u32 s63, s63, 8192
    buffer_load_dwordx4 a[168:171], v14, s[72:75], s63 offen nt
    s_add_u32 s63, s63, 8192
    buffer_load_dwordx4 a[172:175], v14, s[72:75], s63 offen nt
    s_add_u32 s63, s63, 8192
    s_waitcnt vmcnt(11)
    buffer_load_dwordx4 a[176:179], v14, s[72:75], s63 offen nt
    s_add_u32 s63, s63, 8192
    v_and_b32 v4, 1, v1
    v_lshlrev_b32 v4, 4, v4
    v_mov_b32 v5, 0xffff
    v_lshlrev_b32 v4, v4, v5
    v_bfe_u32 v5, v1, 1, 2
    v_cmp_eq_u32 vcc, 0, v5
    s_nop 1
    v_cndmask_b32 v10, 0, v4, vcc
    v_cmp_eq_u32 vcc, 1, v5
    s_nop 1
    v_cndmask_b32 v11, 0, v4, vcc
    v_cmp_eq_u32 vcc, 2, v5
    s_nop 1
    v_cndmask_b32 v12, 0, v4, vcc
    v_cmp_eq_u32 vcc, 3, v5
    s_nop 1
    v_cndmask_b32 v13, 0, v4, vcc
    s_waitcnt vmcnt(11)
    buffer_load_dwordx4 a[180:183], v14, s[72:75], s63 offen nt
    s_add_u32 s63, s63, 8192
    s_waitcnt vmcnt(11)
    buffer_load_dwordx4 a[184:187], v14, s[72:75], s63 offen nt
    s_add_u32 s63, s63, 8192
    s_waitcnt vmcnt(11)
    buffer_load_dwordx4 a[188:191], v14, s[72:75], s63 offen nt
    s_add_u32 s63, s63, 8192
    s_waitcnt vmcnt(11)
    buffer_load_dwordx4 a[192:195], v14, s[72:75], s63 offen nt
    s_add_u32 s63, s63, 8192
    v_lshrrev_b32 v4, 2, v3
    v_and_b32 v5, 3, v3
    v_lshlrev_b32 v76, 8, v4
    v_lshlrev_b32 v126, 8, v2
    v_lshl_add_u32 v76, v2, 6, v76
    v_lshl_add_u32 v76, v5, 4, v76
    v_lshl_add_u32 v126, v3, 4, v126
    v_xor_b32 v77, 32768, v76
    v_xor_b32 v127, 32768, v126
    s_add_u32 s3, s34, s33
    s_and_b32 s3, s3, 3
    s_lshl_b32 s89, s3, 5
    s_add_u32 s89, s89, s32
    s_lshl_b32 s89, s89, 20
    s_mul_i32 s88, s32, 8
    s_mul_i32 s38, s3, 2
    s_add_u32 s88, s88, s38
    s_lshl_b32 s87, s33, 1
    s_waitcnt vmcnt(11)
    buffer_load_dwordx4 a[196:199], v14, s[72:75], s63 offen nt
    s_add_u32 s63, s63, 8192
    s_waitcnt vmcnt(11)
    buffer_load_dwordx4 a[200:203], v14, s[72:75], s63 offen nt
    s_add_u32 s63, s63, 8192
    s_waitcnt vmcnt(11)
    buffer_load_dwordx4 a[204:207], v14, s[72:75], s63 offen nt
    s_add_u32 s63, s63, 8192
    s_waitcnt vmcnt(11)
    buffer_load_dwordx4 a[208:211], v14, s[72:75], s63 offen nt
    s_add_u32 s63, s63, 8192
    s_mov_b32 s52, s18
    s_and_b32 s53, s19, 0xffff
    s_mov_b32 s54, 134217728
    s_mov_b32 s55, 0x20000
    s_mov_b32 s56, s20
    s_and_b32 s57, s21, 0xffff
    s_mov_b32 s58, 134217728
    s_mov_b32 s59, 0x20000
    s_waitcnt vmcnt(11)
    buffer_load_dwordx4 a[212:215], v14, s[72:75], s63 offen nt
    s_add_u32 s63, s63, 8192
    s_waitcnt vmcnt(11)
    buffer_load_dwordx4 a[216:219], v14, s[72:75], s63 offen nt
    s_add_u32 s63, s63, 8192
    s_waitcnt vmcnt(11)
    buffer_load_dwordx4 a[220:223], v14, s[72:75], s63 offen nt
    s_add_u32 s63, s63, 8192
    s_waitcnt vmcnt(11)
    buffer_load_dwordx4 a[224:227], v14, s[72:75], s63 offen nt
    s_add_u32 s63, s63, 8192
    v_mov_b32 v120, 0xff7f0000
    v_mov_b32 v121, 0
    v_mov_b32 v18, 1
    v_mov_b32 v116, 0
    v_mov_b32 v117, 0
    v_mov_b32 v118, 0
    v_mov_b32 v119, 0
    v_lshlrev_b32 v0, 3, v1
    ds_write_b64 v0, v[116:117] offset:8192
    v_mov_b32 v0, 8192
    s_lshl_b32 s38, s32, 10
    s_add_u32 s96, s38, 65536
    s_lshr_b32 s38, s32, 3
    s_lshl_b32 s38, s38, 8
    s_add_u32 s96, s38, s96
    v_mov_b32 v9, s96
    s_lshl_b32 s38, s32, 15
    s_add_u32 s96, s38, 1048576
    s_lshl_b32 s38, s3, 13
    s_add_u32 s96, s38, s96
    s_lshl_b32 s38, s33, 10
    s_add_u32 s96, s38, s96
    v_and_b32 v5, 3, v3
    v_lshlrev_b32 v78, 7, v2
    v_lshl_add_u32 v78, v5, 5, v78
    s_lshl_b32 s38, s32, 12
    s_add_u32 s91, s38, 262144
    s_lshl_b32 s38, s3, 9
    s_add_u32 s91, s38, s91
    v_lshlrev_b32 v4, 7, v2
    v_lshl_add_u32 v4, v3, 4, v4
    v_mov_b32 v5, 512
    v_cmp_gt_u32 vcc, 8, v3
    s_nop 1
    v_cndmask_b32 v79, v5, v4, vcc
    s_waitcnt vmcnt(11)
    buffer_load_dwordx4 a[228:231], v14, s[72:75], s63 offen nt
    s_add_u32 s63, s63, 8192
    s_waitcnt vmcnt(11)
    buffer_load_dwordx4 a[232:235], v14, s[72:75], s63 offen nt
    s_add_u32 s63, s63, 8192
    s_waitcnt vmcnt(11)
    buffer_load_dwordx4 a[236:239], v14, s[72:75], s63 offen nt
    s_add_u32 s63, s63, 8192
    s_waitcnt vmcnt(11)
    buffer_load_dwordx4 a[240:243], v14, s[72:75], s63 offen nt
    s_add_u32 s63, s63, 8192
    s_waitcnt vmcnt(11)
    buffer_load_dwordx4 a[244:247], v14, s[72:75], s63 offen nt
    s_add_u32 s63, s63, 8192
    s_waitcnt vmcnt(11)
    buffer_load_dwordx4 a[248:251], v14, s[72:75], s63 offen nt
    s_add_u32 s63, s63, 8192
    s_waitcnt vmcnt(11)
    buffer_load_dwordx4 a[252:255], v14, s[72:75], s63 offen nt
    s_add_u32 s63, s63, 8192
    s_waitcnt lgkmcnt(0)
    s_add_u32 s35, s35, 0x5b
    s_and_b32 s35, s35, 0xff
    v_mov_b32 v8, s35
    s_or_b32 s68, s35, 0x6b3ac500
    s_waitcnt vmcnt(6)
    s_add_u32 s39, s87, s88
    s_bfe_u32 s37, s39, 0x10000
    s_lshl_b32 s37, s37, 13
    s_add_u32 s85, s37, s89
    s_bfe_u32 s37, s39, 0x10001
    s_lshl_b32 s37, s37, 12
    s_add_u32 s85, s37, s85
    s_bfe_u32 s37, s39, 0x10002
    s_lshl_b32 s37, s37, 11
    s_add_u32 s85, s37, s85
    s_bfe_u32 s37, s39, 0x10003
    s_lshl_b32 s37, s37, 14
    s_add_u32 s85, s37, s85
    s_bfe_u32 s37, s39, 0x40004
    s_lshl_b32 s37, s37, 16
    s_add_u32 s85, s37, s85
    buffer_load_dwordx4 v[128:131], v76, s[52:55], s85 offen offset:0 nt
    s_waitcnt vmcnt(6)
    buffer_load_dwordx4 v[132:135], v77, s[52:55], s85 offen offset:0 nt
    s_waitcnt vmcnt(6)
    buffer_load_dwordx4 v[136:139], v76, s[52:55], s85 offen offset:1024 nt
    s_waitcnt vmcnt(6)
    buffer_load_dwordx4 v[140:143], v77, s[52:55], s85 offen offset:1024 nt
    s_add_u32 s87, s87, 1
    s_add_u32 s39, s87, s88
    s_bfe_u32 s37, s39, 0x10000
    s_lshl_b32 s37, s37, 13
    s_add_u32 s85, s37, s89
    s_bfe_u32 s37, s39, 0x10001
    s_lshl_b32 s37, s37, 12
    s_add_u32 s85, s37, s85
    s_bfe_u32 s37, s39, 0x10002
    s_lshl_b32 s37, s37, 11
    s_add_u32 s85, s37, s85
    s_bfe_u32 s37, s39, 0x10003
    s_lshl_b32 s37, s37, 14
    s_add_u32 s85, s37, s85
    s_bfe_u32 s37, s39, 0x40004
    s_lshl_b32 s37, s37, 16
    s_add_u32 s85, s37, s85
    s_waitcnt vmcnt(6)
    buffer_load_dwordx4 v[144:147], v76, s[52:55], s85 offen offset:0 nt
    s_waitcnt vmcnt(6)
    buffer_load_dwordx4 v[148:151], v77, s[52:55], s85 offen offset:0 nt
    s_waitcnt vmcnt(6)
    buffer_load_dwordx4 v[152:155], v76, s[52:55], s85 offen offset:1024 nt
    s_waitcnt vmcnt(6)
    buffer_load_dwordx4 v[156:159], v77, s[52:55], s85 offen offset:1024 nt
    s_add_u32 s87, s87, 13
    s_add_u32 s39, s87, s88
    s_bfe_u32 s37, s39, 0x10000
    s_lshl_b32 s37, s37, 13
    s_add_u32 s85, s37, s89
    s_bfe_u32 s37, s39, 0x10001
    s_lshl_b32 s37, s37, 12
    s_add_u32 s85, s37, s85
    s_bfe_u32 s37, s39, 0x10002
    s_lshl_b32 s37, s37, 11
    s_add_u32 s85, s37, s85
    s_bfe_u32 s37, s39, 0x10003
    s_lshl_b32 s37, s37, 14
    s_add_u32 s85, s37, s85
    s_bfe_u32 s37, s39, 0x40004
    s_lshl_b32 s37, s37, 16
    s_add_u32 s85, s37, s85
    s_waitcnt vmcnt(6)
    buffer_load_dwordx4 v[160:163], v76, s[52:55], s85 offen offset:0 nt
    s_waitcnt vmcnt(6)
    buffer_load_dwordx4 v[164:167], v77, s[52:55], s85 offen offset:0 nt
    s_waitcnt vmcnt(6)
    buffer_load_dwordx4 v[168:171], v76, s[52:55], s85 offen offset:1024 nt
    s_waitcnt vmcnt(6)
    buffer_load_dwordx4 v[172:175], v77, s[52:55], s85 offen offset:1024 nt
    s_add_u32 s87, s87, 1
    s_add_u32 s39, s87, s88
    s_bfe_u32 s37, s39, 0x10000
    s_lshl_b32 s37, s37, 13
    s_add_u32 s85, s37, s89
    s_bfe_u32 s37, s39, 0x10001
    s_lshl_b32 s37, s37, 12
    s_add_u32 s85, s37, s85
    s_bfe_u32 s37, s39, 0x10002
    s_lshl_b32 s37, s37, 11
    s_add_u32 s85, s37, s85
    s_bfe_u32 s37, s39, 0x10003
    s_lshl_b32 s37, s37, 14
    s_add_u32 s85, s37, s85
    s_bfe_u32 s37, s39, 0x40004
    s_lshl_b32 s37, s37, 16
    s_add_u32 s85, s37, s85
    s_waitcnt vmcnt(6)
    buffer_load_dwordx4 v[176:179], v76, s[52:55], s85 offen offset:0 nt
    s_waitcnt vmcnt(6)
    buffer_load_dwordx4 v[180:183], v77, s[52:55], s85 offen offset:0 nt
    s_waitcnt vmcnt(6)
    buffer_load_dwordx4 v[184:187], v76, s[52:55], s85 offen offset:1024 nt
    s_waitcnt vmcnt(6)
    buffer_load_dwordx4 v[188:191], v77, s[52:55], s85 offen offset:1024 nt
    s_add_u32 s87, s87, 13
    s_add_u32 s39, s87, s88
    s_bfe_u32 s37, s39, 0x10000
    s_lshl_b32 s37, s37, 13
    s_add_u32 s85, s37, s89
    s_bfe_u32 s37, s39, 0x10001
    s_lshl_b32 s37, s37, 12
    s_add_u32 s85, s37, s85
    s_bfe_u32 s37, s39, 0x10002
    s_lshl_b32 s37, s37, 11
    s_add_u32 s85, s37, s85
    s_bfe_u32 s37, s39, 0x10003
    s_lshl_b32 s37, s37, 14
    s_add_u32 s85, s37, s85
    s_bfe_u32 s37, s39, 0x40004
    s_lshl_b32 s37, s37, 16
    s_add_u32 s85, s37, s85
    s_waitcnt vmcnt(6)
    buffer_load_dwordx4 v[192:195], v76, s[52:55], s85 offen offset:0 nt
    s_waitcnt vmcnt(6)
    buffer_load_dwordx4 v[196:199], v77, s[52:55], s85 offen offset:0 nt
    s_waitcnt vmcnt(6)
    buffer_load_dwordx4 v[200:203], v76, s[52:55], s85 offen offset:1024 nt
    s_waitcnt vmcnt(6)
    buffer_load_dwordx4 v[204:207], v77, s[52:55], s85 offen offset:1024 nt
    s_add_u32 s87, s87, 1
    s_add_u32 s39, s87, s88
    s_bfe_u32 s37, s39, 0x10000
    s_lshl_b32 s37, s37, 13
    s_add_u32 s85, s37, s89
    s_bfe_u32 s37, s39, 0x10001
    s_lshl_b32 s37, s37, 12
    s_add_u32 s85, s37, s85
    s_bfe_u32 s37, s39, 0x10002
    s_lshl_b32 s37, s37, 11
    s_add_u32 s85, s37, s85
    s_bfe_u32 s37, s39, 0x10003
    s_lshl_b32 s37, s37, 14
    s_add_u32 s85, s37, s85
    s_bfe_u32 s37, s39, 0x40004
    s_lshl_b32 s37, s37, 16
    s_add_u32 s85, s37, s85
    s_waitcnt vmcnt(6)
    buffer_load_dwordx4 v[208:211], v76, s[52:55], s85 offen offset:0 nt
    s_waitcnt vmcnt(6)
    buffer_load_dwordx4 v[212:215], v77, s[52:55], s85 offen offset:0 nt
    s_waitcnt vmcnt(6)
    buffer_load_dwordx4 v[216:219], v76, s[52:55], s85 offen offset:1024 nt
    s_waitcnt vmcnt(6)
    buffer_load_dwordx4 v[220:223], v77, s[52:55], s85 offen offset:1024 nt
    s_add_u32 s87, s87, 13
    s_add_u32 s39, s87, s88
    s_bfe_u32 s37, s39, 0x10000
    s_lshl_b32 s37, s37, 13
    s_add_u32 s85, s37, s89
    s_bfe_u32 s37, s39, 0x10001
    s_lshl_b32 s37, s37, 12
    s_add_u32 s85, s37, s85
    s_bfe_u32 s37, s39, 0x10002
    s_lshl_b32 s37, s37, 11
    s_add_u32 s85, s37, s85
    s_bfe_u32 s37, s39, 0x10003
    s_lshl_b32 s37, s37, 14
    s_add_u32 s85, s37, s85
    s_bfe_u32 s37, s39, 0x40004
    s_lshl_b32 s37, s37, 16
    s_add_u32 s85, s37, s85
    s_waitcnt vmcnt(6)
    buffer_load_dwordx4 v[224:227], v76, s[52:55], s85 offen offset:0 nt
    s_waitcnt vmcnt(6)
    buffer_load_dwordx4 v[228:231], v77, s[52:55], s85 offen offset:0 nt
    s_waitcnt vmcnt(6)
    buffer_load_dwordx4 v[232:235], v76, s[52:55], s85 offen offset:1024 nt
    s_waitcnt vmcnt(6)
    buffer_load_dwordx4 v[236:239], v77, s[52:55], s85 offen offset:1024 nt
    s_add_u32 s87, s87, 1
    s_add_u32 s39, s87, s88
    s_bfe_u32 s37, s39, 0x10000
    s_lshl_b32 s37, s37, 13
    s_add_u32 s85, s37, s89
    s_bfe_u32 s37, s39, 0x10001
    s_lshl_b32 s37, s37, 12
    s_add_u32 s85, s37, s85
    s_bfe_u32 s37, s39, 0x10002
    s_lshl_b32 s37, s37, 11
    s_add_u32 s85, s37, s85
    s_bfe_u32 s37, s39, 0x10003
    s_lshl_b32 s37, s37, 14
    s_add_u32 s85, s37, s85
    s_bfe_u32 s37, s39, 0x40004
    s_lshl_b32 s37, s37, 16
    s_add_u32 s85, s37, s85
    s_waitcnt vmcnt(6)
    buffer_load_dwordx4 v[240:243], v76, s[52:55], s85 offen offset:0 nt
    s_waitcnt vmcnt(6)
    buffer_load_dwordx4 v[244:247], v77, s[52:55], s85 offen offset:0 nt
    buffer_load_dwordx4 v[20:23], v15, s[48:51], s95 offen offset:0 sc1
    buffer_load_dwordx4 v[24:27], v15, s[48:51], s95 offen offset:16 sc1
    s_waitcnt vmcnt(8)
    buffer_load_dwordx4 v[248:251], v76, s[52:55], s85 offen offset:1024 nt
    s_waitcnt vmcnt(8)
    buffer_load_dwordx4 v[252:255], v77, s[52:55], s85 offen offset:1024 nt
    s_add_u32 s87, s87, 13
    s_add_u32 s39, s87, s88
    s_bfe_u32 s37, s39, 0x10000
    s_lshl_b32 s37, s37, 13
    s_add_u32 s85, s37, s89
    s_bfe_u32 s37, s39, 0x10001
    s_lshl_b32 s37, s37, 12
    s_add_u32 s85, s37, s85
    s_bfe_u32 s37, s39, 0x10002
    s_lshl_b32 s37, s37, 11
    s_add_u32 s85, s37, s85
    s_bfe_u32 s37, s39, 0x10003
    s_lshl_b32 s37, s37, 14
    s_add_u32 s85, s37, s85
    s_bfe_u32 s37, s39, 0x40004
    s_lshl_b32 s37, s37, 16
    s_add_u32 s85, s37, s85
    s_waitcnt vmcnt(8)
    buffer_load_dwordx4 a[0:3], v76, s[52:55], s85 offen offset:0 nt
    s_waitcnt vmcnt(8)
    buffer_load_dwordx4 a[4:7], v77, s[52:55], s85 offen offset:0 nt
    s_waitcnt vmcnt(8)
    buffer_load_dwordx4 a[8:11], v76, s[52:55], s85 offen offset:1024 nt
    s_waitcnt vmcnt(8)
    buffer_load_dwordx4 a[12:15], v77, s[52:55], s85 offen offset:1024 nt
    s_add_u32 s87, s87, 1
    s_add_u32 s39, s87, s88
    s_bfe_u32 s37, s39, 0x10000
    s_lshl_b32 s37, s37, 13
    s_add_u32 s85, s37, s89
    s_bfe_u32 s37, s39, 0x10001
    s_lshl_b32 s37, s37, 12
    s_add_u32 s85, s37, s85
    s_bfe_u32 s37, s39, 0x10002
    s_lshl_b32 s37, s37, 11
    s_add_u32 s85, s37, s85
    s_bfe_u32 s37, s39, 0x10003
    s_lshl_b32 s37, s37, 14
    s_add_u32 s85, s37, s85
    s_bfe_u32 s37, s39, 0x40004
    s_lshl_b32 s37, s37, 16
    s_add_u32 s85, s37, s85
    s_waitcnt vmcnt(6)
L_qacheck_41:
    v_xor_b32 v20, s35, v20
    v_xor_b32 v21, s35, v21
    v_xor_b32 v22, s35, v22
    v_xor_b32 v23, s35, v23
    v_xor_b32 v24, s35, v24
    v_xor_b32 v25, s35, v25
    v_xor_b32 v26, s35, v26
    v_xor_b32 v27, s35, v27
    v_or_b32 v4, v20, v21
    v_or3_b32 v4, v4, v22, v23
    v_or3_b32 v4, v4, v24, v25
    v_or3_b32 v4, v4, v26, v27
    v_and_b32 v4, 0xff, v4
    v_cmp_ne_u32 vcc, 0, v4
    s_cbranch_vccz L_qaok_42
    buffer_load_dwordx4 v[20:23], v15, s[48:51], s95 offen offset:0 sc1
    buffer_load_dwordx4 v[24:27], v15, s[48:51], s95 offen offset:16 sc1
    s_waitcnt vmcnt(0)
    s_sub_u32 s84, s84, 1
    s_cmp_lg_u32 s84, 0
    s_cbranch_scc1 L_qacheck_41
    s_branch L_end
L_qaok_42:
    buffer_load_dwordx4 v[68:71], v78, s[48:51], s91 offen offset:0 sc1
    buffer_load_dwordx4 v[72:75], v78, s[48:51], s91 offen offset:16 sc1
    v_cvt_pk_bf16_f32 v20, v20, v21
    v_cvt_pk_bf16_f32 v21, v22, v23
    v_cvt_pk_bf16_f32 v22, v24, v25
    v_cvt_pk_bf16_f32 v23, v26, v27
    s_nop 1
    v_mfma_f32_16x16x32_bf16 v[28:31], a[128:131], v[20:23], 0
    v_mfma_f32_16x16x32_bf16 v[32:35], a[132:135], v[20:23], 0
    v_mfma_f32_16x16x32_bf16 v[36:39], a[136:139], v[20:23], 0
    s_nop 5
    v_mov_b32_dpp v60, v28 quad_perm:[0,0,0,0] row_mask:0xf bank_mask:0xf
    v_mov_b32_dpp v4, v30 quad_perm:[2,2,2,2] row_mask:0xf bank_mask:0xf
    s_nop 0
    v_add_f32_dpp v60, v29, v60 quad_perm:[1,1,1,1] row_mask:0xf bank_mask:0xf
    v_add_f32_dpp v4, v31, v4 quad_perm:[3,3,3,3] row_mask:0xf bank_mask:0xf
    v_add_f32 v60, v60, v4
    v_mfma_f32_16x16x32_bf16 v[40:43], a[140:143], v[20:23], 0
    v_mov_b32_dpp v61, v32 quad_perm:[0,0,0,0] row_mask:0xf bank_mask:0xf
    v_mov_b32_dpp v4, v34 quad_perm:[2,2,2,2] row_mask:0xf bank_mask:0xf
    s_nop 0
    v_add_f32_dpp v61, v33, v61 quad_perm:[1,1,1,1] row_mask:0xf bank_mask:0xf
    v_add_f32_dpp v4, v35, v4 quad_perm:[3,3,3,3] row_mask:0xf bank_mask:0xf
    v_add_f32 v61, v61, v4
    v_cvt_pk_bf16_f32 v44, v60, v61
    v_mfma_f32_16x16x32_bf16 v[28:31], a[144:147], v[20:23], 0
    v_mov_b32_dpp v60, v36 quad_perm:[0,0,0,0] row_mask:0xf bank_mask:0xf
    v_mov_b32_dpp v4, v38 quad_perm:[2,2,2,2] row_mask:0xf bank_mask:0xf
    s_nop 0
    v_add_f32_dpp v60, v37, v60 quad_perm:[1,1,1,1] row_mask:0xf bank_mask:0xf
    v_add_f32_dpp v4, v39, v4 quad_perm:[3,3,3,3] row_mask:0xf bank_mask:0xf
    v_add_f32 v60, v60, v4
    buffer_load_dwordx4 a[16:19], v76, s[52:55], s85 offen offset:0 nt
    v_mfma_f32_16x16x32_bf16 v[32:35], a[148:151], v[20:23], 0
    v_mov_b32_dpp v61, v40 quad_perm:[0,0,0,0] row_mask:0xf bank_mask:0xf
    v_mov_b32_dpp v4, v42 quad_perm:[2,2,2,2] row_mask:0xf bank_mask:0xf
    s_nop 0
    v_add_f32_dpp v61, v41, v61 quad_perm:[1,1,1,1] row_mask:0xf bank_mask:0xf
    v_add_f32_dpp v4, v43, v4 quad_perm:[3,3,3,3] row_mask:0xf bank_mask:0xf
    v_add_f32 v61, v61, v4
    v_cvt_pk_bf16_f32 v45, v60, v61
    v_mfma_f32_16x16x32_bf16 v[36:39], a[152:155], v[20:23], 0
    v_mov_b32_dpp v60, v28 quad_perm:[0,0,0,0] row_mask:0xf bank_mask:0xf
    v_mov_b32_dpp v4, v30 quad_perm:[2,2,2,2] row_mask:0xf bank_mask:0xf
    s_nop 0
    v_add_f32_dpp v60, v29, v60 quad_perm:[1,1,1,1] row_mask:0xf bank_mask:0xf
    v_add_f32_dpp v4, v31, v4 quad_perm:[3,3,3,3] row_mask:0xf bank_mask:0xf
    v_add_f32 v60, v60, v4
    v_mfma_f32_16x16x32_bf16 v[40:43], a[156:159], v[20:23], 0
    v_mov_b32_dpp v61, v32 quad_perm:[0,0,0,0] row_mask:0xf bank_mask:0xf
    v_mov_b32_dpp v4, v34 quad_perm:[2,2,2,2] row_mask:0xf bank_mask:0xf
    s_nop 0
    v_add_f32_dpp v61, v33, v61 quad_perm:[1,1,1,1] row_mask:0xf bank_mask:0xf
    v_add_f32_dpp v4, v35, v4 quad_perm:[3,3,3,3] row_mask:0xf bank_mask:0xf
    v_add_f32 v61, v61, v4
    v_cvt_pk_bf16_f32 v46, v60, v61
    v_mfma_f32_16x16x32_bf16 v[28:31], a[160:163], v[20:23], 0
    v_mov_b32_dpp v60, v36 quad_perm:[0,0,0,0] row_mask:0xf bank_mask:0xf
    v_mov_b32_dpp v4, v38 quad_perm:[2,2,2,2] row_mask:0xf bank_mask:0xf
    s_nop 0
    v_add_f32_dpp v60, v37, v60 quad_perm:[1,1,1,1] row_mask:0xf bank_mask:0xf
    v_add_f32_dpp v4, v39, v4 quad_perm:[3,3,3,3] row_mask:0xf bank_mask:0xf
    v_add_f32 v60, v60, v4
    v_mfma_f32_16x16x32_bf16 v[32:35], a[164:167], v[20:23], 0
    v_mov_b32_dpp v61, v40 quad_perm:[0,0,0,0] row_mask:0xf bank_mask:0xf
    v_mov_b32_dpp v4, v42 quad_perm:[2,2,2,2] row_mask:0xf bank_mask:0xf
    s_nop 0
    v_add_f32_dpp v61, v41, v61 quad_perm:[1,1,1,1] row_mask:0xf bank_mask:0xf
    v_add_f32_dpp v4, v43, v4 quad_perm:[3,3,3,3] row_mask:0xf bank_mask:0xf
    v_add_f32 v61, v61, v4
    v_cvt_pk_bf16_f32 v47, v60, v61
    v_mfma_f32_16x16x32_bf16 v[36:39], a[168:171], v[20:23], 0
    v_mov_b32_dpp v60, v28 quad_perm:[0,0,0,0] row_mask:0xf bank_mask:0xf
    v_mov_b32_dpp v4, v30 quad_perm:[2,2,2,2] row_mask:0xf bank_mask:0xf
    s_nop 0
    v_add_f32_dpp v60, v29, v60 quad_perm:[1,1,1,1] row_mask:0xf bank_mask:0xf
    v_add_f32_dpp v4, v31, v4 quad_perm:[3,3,3,3] row_mask:0xf bank_mask:0xf
    v_add_f32 v60, v60, v4
    v_mfma_f32_16x16x32_bf16 v[40:43], a[172:175], v[20:23], 0
    v_mov_b32_dpp v61, v32 quad_perm:[0,0,0,0] row_mask:0xf bank_mask:0xf
    v_mov_b32_dpp v4, v34 quad_perm:[2,2,2,2] row_mask:0xf bank_mask:0xf
    s_nop 0
    v_add_f32_dpp v61, v33, v61 quad_perm:[1,1,1,1] row_mask:0xf bank_mask:0xf
    v_add_f32_dpp v4, v35, v4 quad_perm:[3,3,3,3] row_mask:0xf bank_mask:0xf
    v_add_f32 v61, v61, v4
    v_cvt_pk_bf16_f32 v48, v60, v61
    v_mfma_f32_16x16x32_bf16 v[28:31], a[176:179], v[20:23], 0
    v_mov_b32_dpp v60, v36 quad_perm:[0,0,0,0] row_mask:0xf bank_mask:0xf
    v_mov_b32_dpp v4, v38 quad_perm:[2,2,2,2] row_mask:0xf bank_mask:0xf
    s_nop 0
    v_add_f32_dpp v60, v37, v60 quad_perm:[1,1,1,1] row_mask:0xf bank_mask:0xf
    v_add_f32_dpp v4, v39, v4 quad_perm:[3,3,3,3] row_mask:0xf bank_mask:0xf
    v_add_f32 v60, v60, v4
    buffer_load_dwordx4 a[20:23], v77, s[52:55], s85 offen offset:0 nt
    v_mfma_f32_16x16x32_bf16 v[32:35], a[180:183], v[20:23], 0
    v_mov_b32_dpp v61, v40 quad_perm:[0,0,0,0] row_mask:0xf bank_mask:0xf
    v_mov_b32_dpp v4, v42 quad_perm:[2,2,2,2] row_mask:0xf bank_mask:0xf
    s_nop 0
    v_add_f32_dpp v61, v41, v61 quad_perm:[1,1,1,1] row_mask:0xf bank_mask:0xf
    v_add_f32_dpp v4, v43, v4 quad_perm:[3,3,3,3] row_mask:0xf bank_mask:0xf
    v_add_f32 v61, v61, v4
    v_cvt_pk_bf16_f32 v49, v60, v61
    v_mfma_f32_16x16x32_bf16 v[36:39], a[184:187], v[20:23], 0
    v_mov_b32_dpp v60, v28 quad_perm:[0,0,0,0] row_mask:0xf bank_mask:0xf
    v_mov_b32_dpp v4, v30 quad_perm:[2,2,2,2] row_mask:0xf bank_mask:0xf
    s_nop 0
    v_add_f32_dpp v60, v29, v60 quad_perm:[1,1,1,1] row_mask:0xf bank_mask:0xf
    v_add_f32_dpp v4, v31, v4 quad_perm:[3,3,3,3] row_mask:0xf bank_mask:0xf
    v_add_f32 v60, v60, v4
    v_mfma_f32_16x16x32_bf16 v[40:43], a[188:191], v[20:23], 0
    v_mov_b32_dpp v61, v32 quad_perm:[0,0,0,0] row_mask:0xf bank_mask:0xf
    v_mov_b32_dpp v4, v34 quad_perm:[2,2,2,2] row_mask:0xf bank_mask:0xf
    s_nop 0
    v_add_f32_dpp v61, v33, v61 quad_perm:[1,1,1,1] row_mask:0xf bank_mask:0xf
    v_add_f32_dpp v4, v35, v4 quad_perm:[3,3,3,3] row_mask:0xf bank_mask:0xf
    v_add_f32 v61, v61, v4
    v_cvt_pk_bf16_f32 v50, v60, v61
    v_mfma_f32_16x16x32_bf16 v[28:31], a[192:195], v[20:23], 0
    v_mov_b32_dpp v60, v36 quad_perm:[0,0,0,0] row_mask:0xf bank_mask:0xf
    v_mov_b32_dpp v4, v38 quad_perm:[2,2,2,2] row_mask:0xf bank_mask:0xf
    s_nop 0
    v_add_f32_dpp v60, v37, v60 quad_perm:[1,1,1,1] row_mask:0xf bank_mask:0xf
    v_add_f32_dpp v4, v39, v4 quad_perm:[3,3,3,3] row_mask:0xf bank_mask:0xf
    v_add_f32 v60, v60, v4
    v_mfma_f32_16x16x32_bf16 v[32:35], a[196:199], v[20:23], 0
    v_mov_b32_dpp v61, v40 quad_perm:[0,0,0,0] row_mask:0xf bank_mask:0xf
    v_mov_b32_dpp v4, v42 quad_perm:[2,2,2,2] row_mask:0xf bank_mask:0xf
    s_nop 0
    v_add_f32_dpp v61, v41, v61 quad_perm:[1,1,1,1] row_mask:0xf bank_mask:0xf
    v_add_f32_dpp v4, v43, v4 quad_perm:[3,3,3,3] row_mask:0xf bank_mask:0xf
    v_add_f32 v61, v61, v4
    v_cvt_pk_bf16_f32 v51, v60, v61
    v_mfma_f32_16x16x32_bf16 v[36:39], a[200:203], v[20:23], 0
    v_mov_b32_dpp v60, v28 quad_perm:[0,0,0,0] row_mask:0xf bank_mask:0xf
    v_mov_b32_dpp v4, v30 quad_perm:[2,2,2,2] row_mask:0xf bank_mask:0xf
    s_nop 0
    v_add_f32_dpp v60, v29, v60 quad_perm:[1,1,1,1] row_mask:0xf bank_mask:0xf
    v_add_f32_dpp v4, v31, v4 quad_perm:[3,3,3,3] row_mask:0xf bank_mask:0xf
    v_add_f32 v60, v60, v4
    v_mfma_f32_16x16x32_bf16 v[40:43], a[204:207], v[20:23], 0
    v_mov_b32_dpp v61, v32 quad_perm:[0,0,0,0] row_mask:0xf bank_mask:0xf
    v_mov_b32_dpp v4, v34 quad_perm:[2,2,2,2] row_mask:0xf bank_mask:0xf
    s_nop 0
    v_add_f32_dpp v61, v33, v61 quad_perm:[1,1,1,1] row_mask:0xf bank_mask:0xf
    v_add_f32_dpp v4, v35, v4 quad_perm:[3,3,3,3] row_mask:0xf bank_mask:0xf
    v_add_f32 v61, v61, v4
    v_cvt_pk_bf16_f32 v52, v60, v61
    v_mfma_f32_16x16x32_bf16 v[28:31], a[208:211], v[20:23], 0
    v_mov_b32_dpp v60, v36 quad_perm:[0,0,0,0] row_mask:0xf bank_mask:0xf
    v_mov_b32_dpp v4, v38 quad_perm:[2,2,2,2] row_mask:0xf bank_mask:0xf
    s_nop 0
    v_add_f32_dpp v60, v37, v60 quad_perm:[1,1,1,1] row_mask:0xf bank_mask:0xf
    v_add_f32_dpp v4, v39, v4 quad_perm:[3,3,3,3] row_mask:0xf bank_mask:0xf
    v_add_f32 v60, v60, v4
    buffer_load_dwordx4 a[24:27], v76, s[52:55], s85 offen offset:1024 nt
    v_mfma_f32_16x16x32_bf16 v[32:35], a[212:215], v[20:23], 0
    v_mov_b32_dpp v61, v40 quad_perm:[0,0,0,0] row_mask:0xf bank_mask:0xf
    v_mov_b32_dpp v4, v42 quad_perm:[2,2,2,2] row_mask:0xf bank_mask:0xf
    s_nop 0
    v_add_f32_dpp v61, v41, v61 quad_perm:[1,1,1,1] row_mask:0xf bank_mask:0xf
    v_add_f32_dpp v4, v43, v4 quad_perm:[3,3,3,3] row_mask:0xf bank_mask:0xf
    v_add_f32 v61, v61, v4
    v_cvt_pk_bf16_f32 v53, v60, v61
    v_mfma_f32_16x16x32_bf16 v[36:39], a[216:219], v[20:23], 0
    v_mov_b32_dpp v60, v28 quad_perm:[0,0,0,0] row_mask:0xf bank_mask:0xf
    v_mov_b32_dpp v4, v30 quad_perm:[2,2,2,2] row_mask:0xf bank_mask:0xf
    s_nop 0
    v_add_f32_dpp v60, v29, v60 quad_perm:[1,1,1,1] row_mask:0xf bank_mask:0xf
    v_add_f32_dpp v4, v31, v4 quad_perm:[3,3,3,3] row_mask:0xf bank_mask:0xf
    v_add_f32 v60, v60, v4
    v_mfma_f32_16x16x32_bf16 v[40:43], a[220:223], v[20:23], 0
    v_mov_b32_dpp v61, v32 quad_perm:[0,0,0,0] row_mask:0xf bank_mask:0xf
    v_mov_b32_dpp v4, v34 quad_perm:[2,2,2,2] row_mask:0xf bank_mask:0xf
    s_nop 0
    v_add_f32_dpp v61, v33, v61 quad_perm:[1,1,1,1] row_mask:0xf bank_mask:0xf
    v_add_f32_dpp v4, v35, v4 quad_perm:[3,3,3,3] row_mask:0xf bank_mask:0xf
    v_add_f32 v61, v61, v4
    v_cvt_pk_bf16_f32 v54, v60, v61
    v_mfma_f32_16x16x32_bf16 v[28:31], a[224:227], v[20:23], 0
    v_mov_b32_dpp v60, v36 quad_perm:[0,0,0,0] row_mask:0xf bank_mask:0xf
    v_mov_b32_dpp v4, v38 quad_perm:[2,2,2,2] row_mask:0xf bank_mask:0xf
    s_nop 0
    v_add_f32_dpp v60, v37, v60 quad_perm:[1,1,1,1] row_mask:0xf bank_mask:0xf
    v_add_f32_dpp v4, v39, v4 quad_perm:[3,3,3,3] row_mask:0xf bank_mask:0xf
    v_add_f32 v60, v60, v4
    v_mfma_f32_16x16x32_bf16 v[32:35], a[228:231], v[20:23], 0
    v_mov_b32_dpp v61, v40 quad_perm:[0,0,0,0] row_mask:0xf bank_mask:0xf
    v_mov_b32_dpp v4, v42 quad_perm:[2,2,2,2] row_mask:0xf bank_mask:0xf
    s_nop 0
    v_add_f32_dpp v61, v41, v61 quad_perm:[1,1,1,1] row_mask:0xf bank_mask:0xf
    v_add_f32_dpp v4, v43, v4 quad_perm:[3,3,3,3] row_mask:0xf bank_mask:0xf
    v_add_f32 v61, v61, v4
    v_cvt_pk_bf16_f32 v55, v60, v61
    v_mfma_f32_16x16x32_bf16 v[36:39], a[232:235], v[20:23], 0
    v_mov_b32_dpp v60, v28 quad_perm:[0,0,0,0] row_mask:0xf bank_mask:0xf
    v_mov_b32_dpp v4, v30 quad_perm:[2,2,2,2] row_mask:0xf bank_mask:0xf
    s_nop 0
    v_add_f32_dpp v60, v29, v60 quad_perm:[1,1,1,1] row_mask:0xf bank_mask:0xf
    v_add_f32_dpp v4, v31, v4 quad_perm:[3,3,3,3] row_mask:0xf bank_mask:0xf
    v_add_f32 v60, v60, v4
    v_mfma_f32_16x16x32_bf16 v[40:43], a[236:239], v[20:23], 0
    v_mov_b32_dpp v61, v32 quad_perm:[0,0,0,0] row_mask:0xf bank_mask:0xf
    v_mov_b32_dpp v4, v34 quad_perm:[2,2,2,2] row_mask:0xf bank_mask:0xf
    s_nop 0
    v_add_f32_dpp v61, v33, v61 quad_perm:[1,1,1,1] row_mask:0xf bank_mask:0xf
    v_add_f32_dpp v4, v35, v4 quad_perm:[3,3,3,3] row_mask:0xf bank_mask:0xf
    v_add_f32 v61, v61, v4
    v_cvt_pk_bf16_f32 v56, v60, v61
    v_mfma_f32_16x16x32_bf16 v[28:31], a[240:243], v[20:23], 0
    v_mov_b32_dpp v60, v36 quad_perm:[0,0,0,0] row_mask:0xf bank_mask:0xf
    v_mov_b32_dpp v4, v38 quad_perm:[2,2,2,2] row_mask:0xf bank_mask:0xf
    s_nop 0
    v_add_f32_dpp v60, v37, v60 quad_perm:[1,1,1,1] row_mask:0xf bank_mask:0xf
    v_add_f32_dpp v4, v39, v4 quad_perm:[3,3,3,3] row_mask:0xf bank_mask:0xf
    v_add_f32 v60, v60, v4
    buffer_load_dwordx4 a[28:31], v77, s[52:55], s85 offen offset:1024 nt
    s_add_u32 s87, s87, 13
    s_add_u32 s39, s87, s88
    s_bfe_u32 s37, s39, 0x10000
    s_lshl_b32 s37, s37, 13
    s_add_u32 s85, s37, s89
    s_bfe_u32 s37, s39, 0x10001
    s_lshl_b32 s37, s37, 12
    s_add_u32 s85, s37, s85
    s_bfe_u32 s37, s39, 0x10002
    s_lshl_b32 s37, s37, 11
    s_add_u32 s85, s37, s85
    s_bfe_u32 s37, s39, 0x10003
    s_lshl_b32 s37, s37, 14
    s_add_u32 s85, s37, s85
    s_bfe_u32 s37, s39, 0x40004
    s_lshl_b32 s37, s37, 16
    s_add_u32 s85, s37, s85
    v_mfma_f32_16x16x32_bf16 v[32:35], a[244:247], v[20:23], 0
    v_mov_b32_dpp v61, v40 quad_perm:[0,0,0,0] row_mask:0xf bank_mask:0xf
    v_mov_b32_dpp v4, v42 quad_perm:[2,2,2,2] row_mask:0xf bank_mask:0xf
    s_nop 0
    v_add_f32_dpp v61, v41, v61 quad_perm:[1,1,1,1] row_mask:0xf bank_mask:0xf
    v_add_f32_dpp v4, v43, v4 quad_perm:[3,3,3,3] row_mask:0xf bank_mask:0xf
    v_add_f32 v61, v61, v4
    v_cvt_pk_bf16_f32 v57, v60, v61
    v_mfma_f32_16x16x32_bf16 v[36:39], a[248:251], v[20:23], 0
    v_mov_b32_dpp v60, v28 quad_perm:[0,0,0,0] row_mask:0xf bank_mask:0xf
    v_mov_b32_dpp v4, v30 quad_perm:[2,2,2,2] row_mask:0xf bank_mask:0xf
    s_nop 0
    v_add_f32_dpp v60, v29, v60 quad_perm:[1,1,1,1] row_mask:0xf bank_mask:0xf
    v_add_f32_dpp v4, v31, v4 quad_perm:[3,3,3,3] row_mask:0xf bank_mask:0xf
    v_add_f32 v60, v60, v4
    v_mfma_f32_16x16x32_bf16 v[40:43], a[252:255], v[20:23], 0
    v_mov_b32_dpp v61, v32 quad_perm:[0,0,0,0] row_mask:0xf bank_mask:0xf
    v_mov_b32_dpp v4, v34 quad_perm:[2,2,2,2] row_mask:0xf bank_mask:0xf
    s_nop 0
    v_add_f32_dpp v61, v33, v61 quad_perm:[1,1,1,1] row_mask:0xf bank_mask:0xf
    v_add_f32_dpp v4, v35, v4 quad_perm:[3,3,3,3] row_mask:0xf bank_mask:0xf
    v_add_f32 v61, v61, v4
    v_cvt_pk_bf16_f32 v58, v60, v61
    v_mov_b32_dpp v60, v36 quad_perm:[0,0,0,0] row_mask:0xf bank_mask:0xf
    v_mov_b32_dpp v4, v38 quad_perm:[2,2,2,2] row_mask:0xf bank_mask:0xf
    s_nop 0
    v_add_f32_dpp v60, v37, v60 quad_perm:[1,1,1,1] row_mask:0xf bank_mask:0xf
    v_add_f32_dpp v4, v39, v4 quad_perm:[3,3,3,3] row_mask:0xf bank_mask:0xf
    v_add_f32 v60, v60, v4
    v_mov_b32_dpp v61, v40 quad_perm:[0,0,0,0] row_mask:0xf bank_mask:0xf
    v_mov_b32_dpp v4, v42 quad_perm:[2,2,2,2] row_mask:0xf bank_mask:0xf
    s_nop 0
    v_add_f32_dpp v61, v41, v61 quad_perm:[1,1,1,1] row_mask:0xf bank_mask:0xf
    v_add_f32_dpp v4, v43, v4 quad_perm:[3,3,3,3] row_mask:0xf bank_mask:0xf
    v_add_f32 v61, v61, v4
    v_cvt_pk_bf16_f32 v59, v60, v61
    s_mov_b32 exec_lo, 0x22222222
    s_mov_b32 exec_hi, 0x22222222
    v_mov_b32 v44, v48
    v_mov_b32 v45, v49
    v_mov_b32 v46, v50
    v_mov_b32 v47, v51
    s_mov_b32 exec_lo, 0x44444444
    s_mov_b32 exec_hi, 0x44444444
    v_mov_b32 v44, v52
    v_mov_b32 v45, v53
    v_mov_b32 v46, v54
    v_mov_b32 v47, v55
    s_mov_b32 exec_lo, 0x88888888
    s_mov_b32 exec_hi, 0x88888888
    v_mov_b32 v44, v56
    v_mov_b32 v45, v57
    v_mov_b32 v46, v58
    v_mov_b32 v47, v59
    s_mov_b64 exec, -1
    buffer_store_dwordx4 v[44:47], v19, s[48:51], s94 offen sc1
    s_waitcnt vmcnt(5)
L_qcheck_43:
    v_xor_b32 v68, s35, v68
    v_xor_b32 v69, s35, v69
    v_xor_b32 v70, s35, v70
    v_xor_b32 v71, s35, v71
    v_xor_b32 v72, s35, v72
    v_xor_b32 v73, s35, v73
    v_xor_b32 v74, s35, v74
    v_xor_b32 v75, s35, v75
    v_or_b32 v4, v68, v69
    v_or3_b32 v4, v4, v70, v71
    v_or3_b32 v4, v4, v72, v73
    v_or3_b32 v4, v4, v74, v75
    v_and_b32 v4, 0xff, v4
    v_cmp_ne_u32 vcc, 0, v4
    s_cbranch_vccz L_qok_44
    buffer_load_dwordx4 v[68:71], v78, s[48:51], s91 offen offset:0 sc1
    buffer_load_dwordx4 v[72:75], v78, s[48:51], s91 offen offset:16 sc1
    s_waitcnt vmcnt(0)
    s_sub_u32 s84, s84, 1
    s_cmp_lg_u32 s84, 0
    s_cbranch_scc1 L_qcheck_43
    s_branch L_end
L_qok_44:
    v_cvt_pk_bf16_f32 v68, v68, v69
    v_cvt_pk_bf16_f32 v69, v70, v71
    v_cvt_pk_bf16_f32 v70, v72, v73
    v_cvt_pk_bf16_f32 v71, v74, v75
    s_mov_b32 vcc_lo, 0xf000f
    s_mov_b32 vcc_hi, 0xf000f
    v_cndmask_b32 v80, 0, v68, vcc
    v_cndmask_b32 v81, 0, v69, vcc
    v_cndmask_b32 v82, 0, v70, vcc
    v_cndmask_b32 v83, 0, v71, vcc
    s_mov_b32 vcc_lo, 0xf000f0
    s_mov_b32 vcc_hi, 0xf000f0
    v_cndmask_b32 v84, 0, v68, vcc
    v_cndmask_b32 v85, 0, v69, vcc
    v_cndmask_b32 v86, 0, v70, vcc
    v_cndmask_b32 v87, 0, v71, vcc
    s_mov_b32 vcc_lo, 0xf000f00
    s_mov_b32 vcc_hi, 0xf000f00
    v_cndmask_b32 v88, 0, v68, vcc
    v_cndmask_b32 v89, 0, v69, vcc
    v_cndmask_b32 v90, 0, v70, vcc
    v_cndmask_b32 v91, 0, v71, vcc
    s_mov_b32 vcc_lo, 0xf000f000
    s_mov_b32 vcc_hi, 0xf000f000
    v_cndmask_b32 v92, 0, v68, vcc
    v_cndmask_b32 v93, 0, v69, vcc
    v_cndmask_b32 v94, 0, v70, vcc
    v_cndmask_b32 v95, 0, v71, vcc
    s_getreg_b32 s70, hwreg(HW_REG_XCC_ID, 0, 4)
    s_lshl_b32 s70, s70, 8
    s_or_b32 s70, s70, s35
    s_or_b32 s70, s70, 0x5e9d0000
    s_bfe_u32 s38, s2, 0x30000
    s_lshl_b32 s38, s38, 8
    s_add_u32 s69, s38, 32768
    s_lshl_b32 s38, s32, 2
    s_add_u32 s69, s38, s69
    s_lshl_b32 s38, s34, 24
    s_add_u32 s69, s38, s69
    v_mov_b32 v72, s69
    v_mov_b32 v73, s70
    s_mov_b64 exec, 1
    buffer_store_dword v73, v72, s[48:51], 0 offen sc1
    s_mov_b64 exec, -1
    v_mov_b32 v65, 0xff7f0000
    s_lshl_b32 s38, s34, 14
    s_add_u32 s38, s38, 16384
    v_lshl_add_u32 v64, v1, 2, s38
    buffer_load_dwordx4 a[32:35], v76, s[52:55], s85 offen offset:0 nt
    v_mfma_f32_16x16x32_bf16 v[112:115], v[128:131], v[80:83], 0
    v_mfma_f32_16x16x32_bf16 v[112:115], v[132:135], v[84:87], v[112:115]
    buffer_load_dwordx4 a[36:39], v77, s[52:55], s85 offen offset:0 nt
    v_mfma_f32_16x16x32_bf16 v[112:115], v[136:139], v[88:91], v[112:115]
    v_mfma_f32_16x16x32_bf16 v[112:115], v[140:143], v[92:95], v[112:115]
    buffer_load_dwordx4 a[40:43], v76, s[52:55], s85 offen offset:1024 nt
    v_mfma_f32_16x16x32_bf16 v[96:99], v[144:147], v[80:83], 0
    v_mfma_f32_16x16x32_bf16 v[96:99], v[148:151], v[84:87], v[96:99]
    s_waitcnt vmcnt(8)
    buffer_load_dwordx4 a[44:47], v77, s[52:55], s85 offen offset:1024 nt
    s_add_u32 s87, s87, 1
    s_add_u32 s39, s87, s88
    s_bfe_u32 s37, s39, 0x10000
    s_lshl_b32 s37, s37, 13
    s_add_u32 s85, s37, s89
    s_bfe_u32 s37, s39, 0x10001
    s_lshl_b32 s37, s37, 12
    s_add_u32 s85, s37, s85
    s_bfe_u32 s37, s39, 0x10002
    s_lshl_b32 s37, s37, 11
    s_add_u32 s85, s37, s85
    s_bfe_u32 s37, s39, 0x10003
    s_lshl_b32 s37, s37, 14
    s_add_u32 s85, s37, s85
    s_bfe_u32 s37, s39, 0x40004
    s_lshl_b32 s37, s37, 16
    s_add_u32 s85, s37, s85
    v_mfma_f32_16x16x32_bf16 v[96:99], v[152:155], v[88:91], v[96:99]
    v_mov_b32_dpp v122, v112 quad_perm:[0,0,0,0] row_mask:0xf bank_mask:0xf
    v_mov_b32_dpp v124, v114 quad_perm:[2,2,2,2] row_mask:0xf bank_mask:0xf
    s_nop 0
    v_add_f32_dpp v122, v113, v122 quad_perm:[1,1,1,1] row_mask:0xf bank_mask:0xf
    v_add_f32_dpp v124, v115, v124 quad_perm:[3,3,3,3] row_mask:0xf bank_mask:0xf
    v_add_f32 v122, v122, v124
    v_max_f32 v65, v65, v122
    ds_write_b32 v64, v122 offset:0
    v_mfma_f32_16x16x32_bf16 v[96:99], v[156:159], v[92:95], v[96:99]
    s_waitcnt vmcnt(8)
    buffer_load_dwordx4 a[48:51], v76, s[52:55], s85 offen offset:0 nt
    v_mfma_f32_16x16x32_bf16 v[112:115], v[160:163], v[80:83], 0
    v_mfma_f32_16x16x32_bf16 v[112:115], v[164:167], v[84:87], v[112:115]
    s_waitcnt vmcnt(8)
    buffer_load_dwordx4 a[52:55], v77, s[52:55], s85 offen offset:0 nt
    v_mfma_f32_16x16x32_bf16 v[112:115], v[168:171], v[88:91], v[112:115]
    s_nop 0
    v_mov_b32_dpp v122, v96 quad_perm:[0,0,0,0] row_mask:0xf bank_mask:0xf
    v_mov_b32_dpp v124, v98 quad_perm:[2,2,2,2] row_mask:0xf bank_mask:0xf
    s_nop 0
    v_add_f32_dpp v122, v97, v122 quad_perm:[1,1,1,1] row_mask:0xf bank_mask:0xf
    v_add_f32_dpp v124, v99, v124 quad_perm:[3,3,3,3] row_mask:0xf bank_mask:0xf
    v_add_f32 v122, v122, v124
    v_max_f32 v65, v65, v122
    ds_write_b32 v64, v122 offset:256
    v_mfma_f32_16x16x32_bf16 v[112:115], v[172:175], v[92:95], v[112:115]
    s_waitcnt vmcnt(8)
    buffer_load_dwordx4 a[56:59], v76, s[52:55], s85 offen offset:1024 nt
    v_mfma_f32_16x16x32_bf16 v[96:99], v[176:179], v[80:83], 0
    v_mfma_f32_16x16x32_bf16 v[96:99], v[180:183], v[84:87], v[96:99]
    s_waitcnt vmcnt(6)
    buffer_load_dwordx4 a[60:63], v77, s[52:55], s85 offen offset:1024 nt
    s_add_u32 s87, s87, 13
    s_add_u32 s39, s87, s88
    s_bfe_u32 s37, s39, 0x10000
    s_lshl_b32 s37, s37, 13
    s_add_u32 s85, s37, s89
    s_bfe_u32 s37, s39, 0x10001
    s_lshl_b32 s37, s37, 12
    s_add_u32 s85, s37, s85
    s_bfe_u32 s37, s39, 0x10002
    s_lshl_b32 s37, s37, 11
    s_add_u32 s85, s37, s85
    s_bfe_u32 s37, s39, 0x10003
    s_lshl_b32 s37, s37, 14
    s_add_u32 s85, s37, s85
    s_bfe_u32 s37, s39, 0x40004
    s_lshl_b32 s37, s37, 16
    s_add_u32 s85, s37, s85
    v_mfma_f32_16x16x32_bf16 v[96:99], v[184:187], v[88:91], v[96:99]
    v_mov_b32_dpp v122, v112 quad_perm:[0,0,0,0] row_mask:0xf bank_mask:0xf
    v_mov_b32_dpp v124, v114 quad_perm:[2,2,2,2] row_mask:0xf bank_mask:0xf
    s_nop 0
    v_add_f32_dpp v122, v113, v122 quad_perm:[1,1,1,1] row_mask:0xf bank_mask:0xf
    v_add_f32_dpp v124, v115, v124 quad_perm:[3,3,3,3] row_mask:0xf bank_mask:0xf
    v_add_f32 v122, v122, v124
    v_max_f32 v65, v65, v122
    ds_write_b32 v64, v122 offset:512
    s_lshl_b32 s38, s32, 8
    s_add_u32 s69, s38, 98304
    s_lshl_b32 s38, s34, 23
    s_add_u32 s69, s38, s69
    v_mov_b32 v48, s69
    v_mov_b32 v49, s68
    s_barrier
    s_mov_b64 exec, 1
    buffer_store_dword v49, v48, s[48:51], 0 offen sc1
    s_mov_b64 exec, -1
    v_mfma_f32_16x16x32_bf16 v[96:99], v[188:191], v[92:95], v[96:99]
    v_mfma_f32_16x16x32_bf16 v[112:115], v[192:195], v[80:83], 0
    s_waitcnt vmcnt(7)
    buffer_load_dwordx4 a[64:67], v76, s[52:55], s85 offen offset:0 nt
    v_mfma_f32_16x16x32_bf16 v[112:115], v[196:199], v[84:87], v[112:115]
    v_mfma_f32_16x16x32_bf16 v[112:115], v[200:203], v[88:91], v[112:115]
    s_nop 2
    v_mov_b32_dpp v122, v96 quad_perm:[0,0,0,0] row_mask:0xf bank_mask:0xf
    v_mov_b32_dpp v124, v98 quad_perm:[2,2,2,2] row_mask:0xf bank_mask:0xf
    s_nop 0
    v_add_f32_dpp v122, v97, v122 quad_perm:[1,1,1,1] row_mask:0xf bank_mask:0xf
    v_add_f32_dpp v124, v99, v124 quad_perm:[3,3,3,3] row_mask:0xf bank_mask:0xf
    v_add_f32 v122, v122, v124
    v_max_f32 v65, v65, v122
    ds_write_b32 v64, v122 offset:768
    s_waitcnt vmcnt(7)
    buffer_load_dwordx4 a[68:71], v77, s[52:55], s85 offen offset:0 nt
    v_mfma_f32_16x16x32_bf16 v[112:115], v[204:207], v[92:95], v[112:115]
    v_mfma_f32_16x16x32_bf16 v[96:99], v[208:211], v[80:83], 0
    s_waitcnt vmcnt(7)
    buffer_load_dwordx4 a[72:75], v76, s[52:55], s85 offen offset:1024 nt
    v_mfma_f32_16x16x32_bf16 v[96:99], v[212:215], v[84:87], v[96:99]
    v_mfma_f32_16x16x32_bf16 v[96:99], v[216:219], v[88:91], v[96:99]
    s_nop 2
    v_mov_b32_dpp v122, v112 quad_perm:[0,0,0,0] row_mask:0xf bank_mask:0xf
    v_mov_b32_dpp v124, v114 quad_perm:[2,2,2,2] row_mask:0xf bank_mask:0xf
    s_nop 0
    v_add_f32_dpp v122, v113, v122 quad_perm:[1,1,1,1] row_mask:0xf bank_mask:0xf
    v_add_f32_dpp v124, v115, v124 quad_perm:[3,3,3,3] row_mask:0xf bank_mask:0xf
    v_add_f32 v122, v122, v124
    v_max_f32 v65, v65, v122
    ds_write_b32 v64, v122 offset:1024
    s_waitcnt vmcnt(7)
    buffer_load_dwordx4 a[76:79], v77, s[52:55], s85 offen offset:1024 nt
    s_add_u32 s87, s87, 1
    s_add_u32 s39, s87, s88
    s_bfe_u32 s37, s39, 0x10000
    s_lshl_b32 s37, s37, 13
    s_add_u32 s85, s37, s89
    s_bfe_u32 s37, s39, 0x10001
    s_lshl_b32 s37, s37, 12
    s_add_u32 s85, s37, s85
    s_bfe_u32 s37, s39, 0x10002
    s_lshl_b32 s37, s37, 11
    s_add_u32 s85, s37, s85
    s_bfe_u32 s37, s39, 0x10003
    s_lshl_b32 s37, s37, 14
    s_add_u32 s85, s37, s85
    s_bfe_u32 s37, s39, 0x40004
    s_lshl_b32 s37, s37, 16
    s_add_u32 s85, s37, s85
    v_mfma_f32_16x16x32_bf16 v[96:99], v[220:223], v[92:95], v[96:99]
    v_mfma_f32_16x16x32_bf16 v[112:115], v[224:227], v[80:83], 0
    s_waitcnt vmcnt(7)
    buffer_load_dwordx4 a[80:83], v76, s[52:55], s85 offen offset:0 nt
    v_mfma_f32_16x16x32_bf16 v[112:115], v[228:231], v[84:87], v[112:115]
    v_mfma_f32_16x16x32_bf16 v[112:115], v[232:235], v[88:91], v[112:115]
    s_nop 2
    v_mov_b32_dpp v122, v96 quad_perm:[0,0,0,0] row_mask:0xf bank_mask:0xf
    v_mov_b32_dpp v124, v98 quad_perm:[2,2,2,2] row_mask:0xf bank_mask:0xf
    s_nop 0
    v_add_f32_dpp v122, v97, v122 quad_perm:[1,1,1,1] row_mask:0xf bank_mask:0xf
    v_add_f32_dpp v124, v99, v124 quad_perm:[3,3,3,3] row_mask:0xf bank_mask:0xf
    v_add_f32 v122, v122, v124
    v_max_f32 v65, v65, v122
    ds_write_b32 v64, v122 offset:1280
    s_waitcnt vmcnt(7)
    buffer_load_dwordx4 a[84:87], v77, s[52:55], s85 offen offset:0 nt
    v_mfma_f32_16x16x32_bf16 v[112:115], v[236:239], v[92:95], v[112:115]
    v_mfma_f32_16x16x32_bf16 v[96:99], v[240:243], v[80:83], 0
    s_waitcnt vmcnt(7)
    buffer_load_dwordx4 a[88:91], v76, s[52:55], s85 offen offset:1024 nt
    v_mfma_f32_16x16x32_bf16 v[96:99], v[244:247], v[84:87], v[96:99]
    v_mfma_f32_16x16x32_bf16 v[96:99], v[248:251], v[88:91], v[96:99]
    s_nop 2
    v_mov_b32_dpp v122, v112 quad_perm:[0,0,0,0] row_mask:0xf bank_mask:0xf
    v_mov_b32_dpp v124, v114 quad_perm:[2,2,2,2] row_mask:0xf bank_mask:0xf
    s_nop 0
    v_add_f32_dpp v122, v113, v122 quad_perm:[1,1,1,1] row_mask:0xf bank_mask:0xf
    v_add_f32_dpp v124, v115, v124 quad_perm:[3,3,3,3] row_mask:0xf bank_mask:0xf
    v_add_f32 v122, v122, v124
    v_max_f32 v65, v65, v122
    ds_write_b32 v64, v122 offset:1536
    v_mfma_f32_16x16x32_bf16 v[96:99], v[252:255], v[92:95], v[96:99]
    s_waitcnt vmcnt(6)
    buffer_load_dwordx4 a[92:95], v77, s[52:55], s85 offen offset:1024 nt
    s_add_u32 s87, s87, 13
    s_add_u32 s39, s87, s88
    s_bfe_u32 s37, s39, 0x10000
    s_lshl_b32 s37, s37, 13
    s_add_u32 s85, s37, s89
    s_bfe_u32 s37, s39, 0x10001
    s_lshl_b32 s37, s37, 12
    s_add_u32 s85, s37, s85
    s_bfe_u32 s37, s39, 0x10002
    s_lshl_b32 s37, s37, 11
    s_add_u32 s85, s37, s85
    s_bfe_u32 s37, s39, 0x10003
    s_lshl_b32 s37, s37, 14
    s_add_u32 s85, s37, s85
    s_bfe_u32 s37, s39, 0x40004
    s_lshl_b32 s37, s37, 16
    s_add_u32 s85, s37, s85
    v_mfma_f32_16x16x32_bf16 v[112:115], a[0:3], v[80:83], 0
    v_mfma_f32_16x16x32_bf16 v[112:115], a[4:7], v[84:87], v[112:115]
    s_waitcnt vmcnt(6)
    buffer_load_dwordx4 a[96:99], v76, s[52:55], s85 offen offset:0 nt
    v_mfma_f32_16x16x32_bf16 v[112:115], a[8:11], v[88:91], v[112:115]
    v_mov_b32_dpp v122, v96 quad_perm:[0,0,0,0] row_mask:0xf bank_mask:0xf
    v_mov_b32_dpp v124, v98 quad_perm:[2,2,2,2] row_mask:0xf bank_mask:0xf
    s_nop 0
    v_add_f32_dpp v122, v97, v122 quad_perm:[1,1,1,1] row_mask:0xf bank_mask:0xf
    v_add_f32_dpp v124, v99, v124 quad_perm:[3,3,3,3] row_mask:0xf bank_mask:0xf
    v_add_f32 v122, v122, v124
    v_max_f32 v65, v65, v122
    ds_write_b32 v64, v122 offset:1792
    v_mfma_f32_16x16x32_bf16 v[112:115], a[12:15], v[92:95], v[112:115]
    s_waitcnt vmcnt(6)
    buffer_load_dwordx4 a[100:103], v77, s[52:55], s85 offen offset:0 nt
    v_mfma_f32_16x16x32_bf16 v[96:99], a[16:19], v[80:83], 0
    v_mfma_f32_16x16x32_bf16 v[96:99], a[20:23], v[84:87], v[96:99]
    s_waitcnt vmcnt(6)
    buffer_load_dwordx4 a[104:107], v76, s[52:55], s85 offen offset:1024 nt
    v_mfma_f32_16x16x32_bf16 v[96:99], a[24:27], v[88:91], v[96:99]
    s_nop 0
    v_mov_b32_dpp v122, v112 quad_perm:[0,0,0,0] row_mask:0xf bank_mask:0xf
    v_mov_b32_dpp v124, v114 quad_perm:[2,2,2,2] row_mask:0xf bank_mask:0xf
    s_nop 0
    v_add_f32_dpp v122, v113, v122 quad_perm:[1,1,1,1] row_mask:0xf bank_mask:0xf
    v_add_f32_dpp v124, v115, v124 quad_perm:[3,3,3,3] row_mask:0xf bank_mask:0xf
    v_add_f32 v122, v122, v124
    v_max_f32 v65, v65, v122
    ds_write_b32 v64, v122 offset:2048
    v_mfma_f32_16x16x32_bf16 v[96:99], a[28:31], v[92:95], v[96:99]
    s_waitcnt vmcnt(6)
    buffer_load_dwordx4 a[108:111], v77, s[52:55], s85 offen offset:1024 nt
    s_add_u32 s87, s87, 1
    s_add_u32 s39, s87, s88
    s_bfe_u32 s37, s39, 0x10000
    s_lshl_b32 s37, s37, 13
    s_add_u32 s85, s37, s89
    s_bfe_u32 s37, s39, 0x10001
    s_lshl_b32 s37, s37, 12
    s_add_u32 s85, s37, s85
    s_bfe_u32 s37, s39, 0x10002
    s_lshl_b32 s37, s37, 11
    s_add_u32 s85, s37, s85
    s_bfe_u32 s37, s39, 0x10003
    s_lshl_b32 s37, s37, 14
    s_add_u32 s85, s37, s85
    s_bfe_u32 s37, s39, 0x40004
    s_lshl_b32 s37, s37, 16
    s_add_u32 s85, s37, s85
    v_mfma_f32_16x16x32_bf16 v[112:115], a[32:35], v[80:83], 0
    s_bfe_u32 s38, s2, 0x20001
    s_lshl_b32 s38, s38, 0
    s_add_u32 s90, s38, 0
    s_bfe_u32 s38, s2, 0x10000
    s_lshl_b32 s38, s38, 2
    s_add_u32 s90, s38, s90
    s_and_b32 s36, s90, 3
    s_bitcmp0_b32 s90, 2
    s_cselect_b64 s[40:41], s[24:25], s[14:15]
    s_cselect_b32 s45, 262144, 0
    s_add_u32 s45, s45, 524288
    s_lshl_b32 s38, s36, 16
    s_add_u32 s71, s38, s45
    s_lshr_b32 s38, s32, 2
    s_lshl_b32 s38, s38, 13
    s_add_u32 s71, s38, s71
    s_bfe_u32 s38, s32, 0x20000
    s_lshl_b32 s38, s38, 6
    s_add_u32 s71, s38, s71
    s_mov_b32 s42, 4194304
    s_mov_b32 s43, 0x20000
    s_lshl_b32 s38, s32, 17
    s_add_u32 s44, s38, 0
    s_lshl_b32 s38, s34, 15
    s_add_u32 s44, s38, s44
    s_lshl_b32 s38, s36, 8
    s_add_u32 s44, s38, s44
    s_lshl_b32 s38, s36, 16
    s_add_u32 s45, s38, s45
    s_lshr_b32 s38, s34, 1
    s_lshl_b32 s38, s38, 15
    s_add_u32 s45, s38, s45
    s_lshl_b32 s38, s32, 8
    s_add_u32 s45, s38, s45
    s_bfe_u32 s38, s34, 0x10000
    s_lshl_b32 s38, s38, 7
    s_add_u32 s45, s38, s45
    s_lshl_b32 s38, s32, 11
    s_add_u32 s46, s38, 196608
    s_lshl_b32 s38, s34, 9
    s_add_u32 s46, s38, s46
    s_mov_b32 s72, s26
    s_and_b32 s73, s27, 0xffff
    s_mov_b32 s74, 8192
    s_mov_b32 s75, 0x20000
    v_mfma_f32_16x16x32_bf16 v[112:115], a[36:39], v[84:87], v[112:115]
    s_waitcnt vmcnt(6)
    buffer_load_dwordx4 a[112:115], v76, s[52:55], s85 offen offset:0 nt
    v_mfma_f32_16x16x32_bf16 v[112:115], a[40:43], v[88:91], v[112:115]
    v_mov_b32_dpp v122, v96 quad_perm:[0,0,0,0] row_mask:0xf bank_mask:0xf
    v_mov_b32_dpp v124, v98 quad_perm:[2,2,2,2] row_mask:0xf bank_mask:0xf
    s_nop 0
    v_add_f32_dpp v122, v97, v122 quad_perm:[1,1,1,1] row_mask:0xf bank_mask:0xf
    v_add_f32_dpp v124, v99, v124 quad_perm:[3,3,3,3] row_mask:0xf bank_mask:0xf
    v_add_f32 v122, v122, v124
    v_max_f32 v65, v65, v122
    ds_write_b32 v64, v122 offset:2304
    v_mfma_f32_16x16x32_bf16 v[112:115], a[44:47], v[92:95], v[112:115]
    s_waitcnt vmcnt(6)
    buffer_load_dwordx4 a[116:119], v77, s[52:55], s85 offen offset:0 nt
    v_mfma_f32_16x16x32_bf16 v[96:99], a[48:51], v[80:83], 0
    v_mfma_f32_16x16x32_bf16 v[96:99], a[52:55], v[84:87], v[96:99]
    s_waitcnt vmcnt(6)
    buffer_load_dwordx4 a[120:123], v76, s[52:55], s85 offen offset:1024 nt
    v_mfma_f32_16x16x32_bf16 v[96:99], a[56:59], v[88:91], v[96:99]
    s_nop 0
    v_mov_b32_dpp v122, v112 quad_perm:[0,0,0,0] row_mask:0xf bank_mask:0xf
    v_mov_b32_dpp v124, v114 quad_perm:[2,2,2,2] row_mask:0xf bank_mask:0xf
    s_nop 0
    v_add_f32_dpp v122, v113, v122 quad_perm:[1,1,1,1] row_mask:0xf bank_mask:0xf
    v_add_f32_dpp v124, v115, v124 quad_perm:[3,3,3,3] row_mask:0xf bank_mask:0xf
    v_add_f32 v122, v122, v124
    v_max_f32 v65, v65, v122
    ds_write_b32 v64, v122 offset:2560
    v_lshlrev_b32 v4, 2, v2
    v_xor_b32 v4, v4, v3
    v_xor_b32 v5, 0, v4
    v_lshlrev_b32 v5, 4, v5
    v_lshl_add_u32 v20, v2, 10, v5
    v_xor_b32 v5, 1, v4
    v_lshlrev_b32 v5, 4, v5
    v_lshl_add_u32 v21, v2, 10, v5
    v_add_u32 v21, 3072, v21
    v_xor_b32 v5, 2, v4
    v_lshlrev_b32 v5, 4, v5
    v_lshl_add_u32 v22, v2, 10, v5
    v_add_u32 v22, 6144, v22
    v_xor_b32 v5, 3, v4
    v_lshlrev_b32 v5, 4, v5
    v_lshl_add_u32 v23, v2, 10, v5
    v_add_u32 v23, 9216, v23
    s_lshl_b32 s38, s32, 15
    s_add_u32 s47, s38, 1048576
    s_lshl_b32 s38, s3, 13
    s_add_u32 s47, s38, s47
    v_lshlrev_b32 v6, 7, v2
    v_bfe_u32 v5, v3, 0, 3
    v_lshl_add_u32 v6, v5, 4, v6
    v_lshrrev_b32 v4, 3, v3
    v_and_b32 v7, 3, v3
    v_min_u32 v7, 2, v7
    v_lshl_add_u32 v7, v7, 1, v4
    v_add_u32 v5, 0, v4
    v_cmp_le_u32 vcc, s33, v5
    s_nop 1
    v_addc_co_u32 v5, vcc, 0, v5, vcc
    v_lshl_add_u32 v50, v5, 10, v6
    v_add_u32 v5, 2, v4
    v_cmp_le_u32 vcc, s33, v5
    s_nop 1
    v_addc_co_u32 v5, vcc, 0, v5, vcc
    v_lshl_add_u32 v51, v5, 10, v6
    v_add_u32 v5, 4, v4
    v_cmp_le_u32 vcc, s33, v5
    s_nop 1
    v_addc_co_u32 v5, vcc, 0, v5, vcc
    v_lshl_add_u32 v52, v5, 10, v6
    v_mov_b32 v5, v7
    v_mov_b32 v6, 512
    v_cmp_le_u32 vcc, s33, v5
    s_nop 1
    v_addc_co_u32 v5, vcc, 0, v5, vcc
    v_lshl_add_u32 v53, v5, 10, v6
    s_mul_i32 s38, s3, 320
    s_add_u32 s38, s38, 135168
    v_lshlrev_b32 v4, 6, v2
    v_lshl_add_u32 v4, v3, 1, v4
    v_add_u32 v31, s38, v4
    v_mfma_f32_16x16x32_bf16 v[96:99], a[60:63], v[92:95], v[96:99]
    v_mfma_f32_16x16x32_bf16 v[112:115], a[64:67], v[80:83], 0
    s_waitcnt vmcnt(6)
    buffer_load_dwordx4 a[124:127], v77, s[52:55], s85 offen offset:1024 nt
    s_add_u32 s87, s87, 13
    s_add_u32 s39, s87, s88
    s_bfe_u32 s37, s39, 0x10000
    s_lshl_b32 s37, s37, 13
    s_add_u32 s85, s37, s89
    s_bfe_u32 s37, s39, 0x10001
    s_lshl_b32 s37, s37, 12
    s_add_u32 s85, s37, s85
    s_bfe_u32 s37, s39, 0x10002
    s_lshl_b32 s37, s37, 11
    s_add_u32 s85, s37, s85
    s_bfe_u32 s37, s39, 0x10003
    s_lshl_b32 s37, s37, 14
    s_add_u32 s85, s37, s85
    s_bfe_u32 s37, s39, 0x40004
    s_lshl_b32 s37, s37, 16
    s_add_u32 s85, s37, s85
    v_mfma_f32_16x16x32_bf16 v[112:115], a[68:71], v[84:87], v[112:115]
    v_mfma_f32_16x16x32_bf16 v[112:115], a[72:75], v[88:91], v[112:115]
    v_mov_b32_dpp v122, v96 quad_perm:[0,0,0,0] row_mask:0xf bank_mask:0xf
    v_mov_b32_dpp v124, v98 quad_perm:[2,2,2,2] row_mask:0xf bank_mask:0xf
    s_nop 0
    v_add_f32_dpp v122, v97, v122 quad_perm:[1,1,1,1] row_mask:0xf bank_mask:0xf
    v_add_f32_dpp v124, v99, v124 quad_perm:[3,3,3,3] row_mask:0xf bank_mask:0xf
    v_add_f32 v122, v122, v124
    v_max_f32 v65, v65, v122
    ds_write_b32 v64, v122 offset:2816
    s_waitcnt vmcnt(5)
    buffer_load_dwordx4 v[128:131], v76, s[52:55], s85 offen offset:0 nt
    v_mfma_f32_16x16x32_bf16 v[112:115], a[76:79], v[92:95], v[112:115]
    v_mfma_f32_16x16x32_bf16 v[96:99], a[80:83], v[80:83], 0
    v_lshlrev_b32 v4, 11, v2
    v_bfe_u32 v5, v1, 2, 2
    v_lshl_add_u32 v4, v5, 8, v4
    v_bfe_u32 v5, v1, 2, 2
    v_lshl_add_u32 v4, v5, 6, v4
    v_bfe_u32 v5, v1, 4, 1
    v_lshl_add_u32 v4, v5, 5, v4
    v_bfe_u32 v5, v1, 1, 1
    v_lshl_add_u32 v4, v5, 4, v4
    v_bfe_u32 v5, v1, 0, 1
    v_lshl_add_u32 v4, v5, 3, v4
    s_lshl_b32 s38, s34, 6
    s_add_u32 s38, s38, 98304
    v_xor_b32 v24, s38, v4
    v_xor_b32 v25, 16, v24
    v_xor_b32 v26, 32, v24
    v_xor_b32 v27, 48, v24
    v_and_b32 v4, 3, v3
    v_lshrrev_b32 v5, 2, v3
    v_lshlrev_b32 v6, 4, v2
    v_add_u32 v6, 135168, v6
    s_movk_i32 s36, 320
    v_cmp_eq_u32 vcc, 0, v5
    s_nop 1
    v_cndmask_b32 v28, 4, v4, vcc
    v_mad_u32_u24 v28, v28, s36, v6
    v_cmp_eq_u32 vcc, 1, v5
    s_nop 1
    v_cndmask_b32 v29, 4, v4, vcc
    v_mad_u32_u24 v29, v29, s36, v6
    v_lshlrev_b32 v5, 2, v1
    v_add_u32 v5, 136448, v5
    v_mov_b32 v6, 0
    ds_write_b32 v5, v6
    s_waitcnt vmcnt(5)
    buffer_load_dwordx4 v[132:135], v77, s[52:55], s85 offen offset:0 nt
    v_mfma_f32_16x16x32_bf16 v[96:99], a[84:87], v[84:87], v[96:99]
    v_mfma_f32_16x16x32_bf16 v[96:99], a[88:91], v[88:91], v[96:99]
    v_mov_b32_dpp v122, v112 quad_perm:[0,0,0,0] row_mask:0xf bank_mask:0xf
    v_mov_b32_dpp v124, v114 quad_perm:[2,2,2,2] row_mask:0xf bank_mask:0xf
    s_nop 0
    v_add_f32_dpp v122, v113, v122 quad_perm:[1,1,1,1] row_mask:0xf bank_mask:0xf
    v_add_f32_dpp v124, v115, v124 quad_perm:[3,3,3,3] row_mask:0xf bank_mask:0xf
    v_add_f32 v122, v122, v124
    v_max_f32 v65, v65, v122
    ds_write_b32 v64, v122 offset:3072
    s_waitcnt vmcnt(5)
    buffer_load_dwordx4 v[136:139], v76, s[52:55], s85 offen offset:1024 nt
    v_mfma_f32_16x16x32_bf16 v[96:99], a[92:95], v[92:95], v[96:99]
    v_mfma_f32_16x16x32_bf16 v[112:115], a[96:99], v[80:83], 0
    s_waitcnt vmcnt(5)
    buffer_load_dwordx4 v[140:143], v77, s[52:55], s85 offen offset:1024 nt
    s_add_u32 s87, s87, 1
    s_add_u32 s39, s87, s88
    s_bfe_u32 s37, s39, 0x10000
    s_lshl_b32 s37, s37, 13
    s_add_u32 s85, s37, s89
    s_bfe_u32 s37, s39, 0x10001
    s_lshl_b32 s37, s37, 12
    s_add_u32 s85, s37, s85
    s_bfe_u32 s37, s39, 0x10002
    s_lshl_b32 s37, s37, 11
    s_add_u32 s85, s37, s85
    s_bfe_u32 s37, s39, 0x10003
    s_lshl_b32 s37, s37, 14
    s_add_u32 s85, s37, s85
    s_bfe_u32 s37, s39, 0x40004
    s_lshl_b32 s37, s37, 16
    s_add_u32 s85, s37, s85
    v_mfma_f32_16x16x32_bf16 v[112:115], a[100:103], v[84:87], v[112:115]
    v_mfma_f32_16x16x32_bf16 v[112:115], a[104:107], v[88:91], v[112:115]
    v_mov_b32_dpp v122, v96 quad_perm:[0,0,0,0] row_mask:0xf bank_mask:0xf
    v_mov_b32_dpp v124, v98 quad_perm:[2,2,2,2] row_mask:0xf bank_mask:0xf
    s_nop 0
    v_add_f32_dpp v122, v97, v122 quad_perm:[1,1,1,1] row_mask:0xf bank_mask:0xf
    v_add_f32_dpp v124, v99, v124 quad_perm:[3,3,3,3] row_mask:0xf bank_mask:0xf
    v_add_f32 v122, v122, v124
    v_max_f32 v65, v65, v122
    ds_write_b32 v64, v122 offset:3328
    v_lshlrev_b32 v30, 4, v3
    v_lshl_add_u32 v30, v2, 13, v30
    v_lshrrev_b32 v5, 2, v1
    v_lshlrev_b32 v32, 8, v5
    v_bfe_u32 v5, v1, 0, 2
    v_lshl_add_u32 v32, v5, 4, v32
    s_xor_b32 s37, s90, 4
    s_bfe_u32 s38, s37, 0x30000
    s_lshl_b32 s38, s38, 8
    s_add_u32 s36, s38, 0
    s_lshr_b32 s38, s32, 4
    s_lshl_b32 s38, s38, 7
    s_add_u32 s36, s38, s36
    s_bfe_u32 s38, s32, 0x20000
    s_lshl_b32 s38, s38, 5
    s_add_u32 s36, s38, s36
    s_bfe_u32 s38, s32, 0x20002
    s_lshl_b32 s38, s38, 3
    s_add_u32 s36, s38, s36
    v_bfe_u32 v5, v1, 0, 2
    v_lshlrev_b32 v33, 11, v5
    v_lshl_add_u32 v33, v2, 1, v33
    v_add_u32 v33, s36, v33
    v_and_b32 v5, 31, v1
    v_lshlrev_b32 v34, 4, v5
    s_mul_i32 s38, s34, 320
    s_add_u32 s38, s38, 135168
    v_lshl_add_u32 v35, v5, 3, s38
    s_bfe_u32 s38, s34, 0x10000
    s_lshl_b32 s38, s38, 12
    s_add_u32 s36, s38, s71
    s_lshr_b32 s38, s34, 1
    s_lshl_b32 s38, s38, 24
    s_add_u32 s36, s38, s36
    s_bitcmp1_b32 s90, 2
    s_cselect_b32 s46, s46, s36
    s_cselect_b64 vcc, -1, 0
    v_cndmask_b32 v54, v32, v34, vcc
    s_waitcnt vmcnt(5)
    buffer_load_dwordx4 v[144:147], v76, s[52:55], s85 offen offset:0 nt
    v_mfma_f32_16x16x32_bf16 v[112:115], a[108:111], v[92:95], v[112:115]
    v_mfma_f32_16x16x32_bf16 v[96:99], a[112:115], v[80:83], 0
    s_waitcnt vmcnt(5)
    buffer_load_dwordx4 v[148:151], v77, s[52:55], s85 offen offset:0 nt
    v_mfma_f32_16x16x32_bf16 v[96:99], a[116:119], v[84:87], v[96:99]
    v_mfma_f32_16x16x32_bf16 v[96:99], a[120:123], v[88:91], v[96:99]
    s_nop 2
    v_mov_b32_dpp v122, v112 quad_perm:[0,0,0,0] row_mask:0xf bank_mask:0xf
    v_mov_b32_dpp v124, v114 quad_perm:[2,2,2,2] row_mask:0xf bank_mask:0xf
    s_nop 0
    v_add_f32_dpp v122, v113, v122 quad_perm:[1,1,1,1] row_mask:0xf bank_mask:0xf
    v_add_f32_dpp v124, v115, v124 quad_perm:[3,3,3,3] row_mask:0xf bank_mask:0xf
    v_add_f32 v122, v122, v124
    v_max_f32 v65, v65, v122
    ds_write_b32 v64, v122 offset:3584
    v_mfma_f32_16x16x32_bf16 v[96:99], a[124:127], v[92:95], v[96:99]
    v_add_u32 v64, 3840, v64
    s_mov_b32 s97, 8
    s_mov_b32 s92, 1
    s_lshl_b32 s38, s32, 13
    s_add_u32 s80, s38, 3145728
    s_lshl_b32 s38, s3, 11
    s_add_u32 s80, s38, s80
    v_lshrrev_b32 v4, 2, v1
    v_lshlrev_b32 v55, 3, v4
    s_mov_b32 s66, 134217728
    s_mov_b32 s67, 0x20000
    s_mov_b64 s[64:65], s[52:53]
    v_mov_b32 v62, v76
    v_mov_b32 v63, v77
    s_branch L_bloop
L_aux:
    v_lshlrev_b32 v4, 2, v2
    v_xor_b32 v4, v4, v3
    v_xor_b32 v96, 0, v4
    v_lshlrev_b32 v96, 4, v96
    v_lshl_add_u32 v10, v2, 13, v96
    v_xor_b32 v97, 1, v4
    v_lshlrev_b32 v97, 4, v97
    v_lshl_add_u32 v11, v2, 13, v97
    v_add_u32 v11, 31744, v11
    v_xor_b32 v98, 2, v4
    v_lshlrev_b32 v98, 4, v98
    v_lshl_add_u32 v12, v2, 13, v98
    v_add_u32 v12, 63488, v12
    v_xor_b32 v99, 3, v4
    v_lshlrev_b32 v99, 4, v99
    v_lshl_add_u32 v13, v2, 13, v99
    v_add_u32 v13, 95232, v13
    s_lshl_b32 s56, s34, 15
    s_mov_b32 s62, 0
    s_lshl_b32 s38, s34, 20
    s_add_u32 s95, s38, 0
    s_lshl_b32 s38, s32, 8
    s_add_u32 s95, s38, s95
    s_waitcnt lgkmcnt(0)
    s_mov_b32 s52, s12
    s_and_b32 s53, s13, 0xffff
    s_mov_b32 s54, 4194304
    s_mov_b32 s55, 0x20000
    s_add_u32 s39, s56, s62
    s_mov_b32 m0, s39
    s_add_u32 s62, s62, 4096
    s_and_b32 s62, s62, 0x7fff
    buffer_load_dwordx4 v10, s[52:55], s95 offen offset:0 nt lds
    buffer_load_dwordx4 v11, s[52:55], s95 offen offset:1024 nt lds
    buffer_load_dwordx4 v12, s[52:55], s95 offen offset:2048 nt lds
    buffer_load_dwordx4 v13, s[52:55], s95 offen offset:3072 nt lds
    s_add_u32 s95, s95, 131072
    s_add_u32 s39, s56, s62
    s_mov_b32 m0, s39
    s_add_u32 s62, s62, 4096
    s_and_b32 s62, s62, 0x7fff
    buffer_load_dwordx4 v10, s[52:55], s95 offen offset:0 nt lds
    buffer_load_dwordx4 v11, s[52:55], s95 offen offset:1024 nt lds
    buffer_load_dwordx4 v12, s[52:55], s95 offen offset:2048 nt lds
    buffer_load_dwordx4 v13, s[52:55], s95 offen offset:3072 nt lds
    s_add_u32 s95, s95, 131072
    s_load_dword s35, s[30:31], 0
    s_mov_b32 s48, s30
    s_and_b32 s49, s31, 0xffff
    s_mov_b32 s50, 8388608
    s_mov_b32 s51, 0x20000
    s_mov_b32 s82, 0xffffff00
    s_mov_b32 s83, 0x3e0293ee
    s_mov_b32 s84, 8388608
    v_lshl_add_u32 v76, v2, 10, v96
    v_lshl_add_u32 v96, v2, 8, v96
    v_lshl_add_u32 v77, v2, 10, v97
    v_lshl_add_u32 v97, v2, 8, v97
    v_add_u32 v77, 3072, v77
    v_lshl_add_u32 v78, v2, 10, v98
    v_lshl_add_u32 v98, v2, 8, v98
    v_add_u32 v78, 6144, v78
    v_lshl_add_u32 v79, v2, 10, v99
    v_lshl_add_u32 v99, v2, 8, v99
    v_add_u32 v79, 9216, v79
    v_bfe_u32 v100, v1, 0, 5
    v_lshlrev_b32 v101, 8, v100
    v_lshlrev_b32 v9, 4, v3
    v_lshl_add_u32 v9, v2, 10, v9
    v_xor_b32 v5, v3, v2
    v_bfe_u32 v4, v3, 2, 1
    v_lshlrev_b32 v6, 11, v4
    v_bfe_u32 v4, v3, 3, 1
    v_lshl_add_u32 v6, v4, 10, v6
    v_bfe_u32 v4, v3, 0, 2
    v_lshl_add_u32 v6, v4, 8, v6
    v_bfe_u32 v4, v5, 0, 2
    v_lshl_add_u32 v6, v4, 6, v6
    v_bfe_u32 v4, v3, 2, 1
    v_lshl_add_u32 v6, v4, 5, v6
    v_bfe_u32 v4, v3, 3, 1
    v_lshl_add_u32 v6, v4, 4, v6
    v_add_u32 v60, s56, v6
    v_xor_b32 v61, 16, v60
    v_xor_b32 v62, 32, v60
    v_xor_b32 v63, 48, v60
    v_lshrrev_b32 v5, 4, v1
    v_xor_b32 v5, v5, v1
    v_bfe_u32 v4, v1, 4, 1
    v_lshlrev_b32 v6, 11, v4
    v_bfe_u32 v4, v1, 5, 1
    v_lshl_add_u32 v6, v4, 10, v6
    v_bfe_u32 v4, v1, 2, 2
    v_lshl_add_u32 v6, v4, 8, v6
    v_bfe_u32 v4, v1, 2, 2
    v_lshl_add_u32 v6, v4, 6, v6
    v_bfe_u32 v4, v1, 4, 1
    v_lshl_add_u32 v6, v4, 5, v6
    v_bfe_u32 v4, v5, 1, 1
    v_lshl_add_u32 v6, v4, 4, v6
    v_bfe_u32 v4, v1, 0, 1
    v_lshl_add_u32 v6, v4, 3, v6
    v_add_u32 v82, s56, v6
    v_xor_b32 v83, 32, v82
    v_xor_b32 v84, 64, v82
    v_xor_b32 v85, 96, v82
    v_xor_b32 v86, 128, v82
    v_xor_b32 v87, 160, v82
    v_xor_b32 v88, 192, v82
    v_xor_b32 v89, 224, v82
    v_lshlrev_b32 v6, 11, v2
    v_bfe_u32 v4, v1, 2, 2
    v_lshl_add_u32 v6, v4, 8, v6
    v_bfe_u32 v4, v1, 2, 2
    v_lshl_add_u32 v6, v4, 6, v6
    v_bfe_u32 v4, v1, 4, 1
    v_lshl_add_u32 v6, v4, 5, v6
    v_bfe_u32 v4, v1, 1, 1
    v_lshl_add_u32 v6, v4, 4, v6
    v_bfe_u32 v4, v1, 0, 1
    v_lshl_add_u32 v6, v4, 3, v6
    v_add_u32 v136, s56, v6
    v_xor_b32 v137, 16, v136
    v_xor_b32 v138, 32, v136
    v_xor_b32 v139, 48, v136
    v_xor_b32 v140, 64, v136
    v_xor_b32 v141, 80, v136
    v_xor_b32 v142, 96, v136
    v_xor_b32 v143, 112, v136
    v_xor_b32 v144, 128, v136
    v_xor_b32 v145, 144, v136
    v_xor_b32 v146, 160, v136
    v_xor_b32 v147, 176, v136
    v_xor_b32 v148, 192, v136
    v_xor_b32 v149, 208, v136
    v_xor_b32 v150, 224, v136
    v_xor_b32 v151, 240, v136
    s_lshl_b32 s85, s34, 13
    s_add_u32 s85, s85, 131072
    v_lshl_add_u32 v94, v1, 4, s85
    v_add_u32 v96, s85, v96
    v_add_u32 v97, s85, v97
    v_add_u32 v98, s85, v98
    v_add_u32 v99, s85, v99
    s_add_u32 s39, s56, s62
    s_mov_b32 m0, s39
    s_add_u32 s62, s62, 4096
    s_and_b32 s62, s62, 0x7fff
    buffer_load_dwordx4 v10, s[52:55], s95 offen offset:0 nt lds
    buffer_load_dwordx4 v11, s[52:55], s95 offen offset:1024 nt lds
    buffer_load_dwordx4 v12, s[52:55], s95 offen offset:2048 nt lds
    buffer_load_dwordx4 v13, s[52:55], s95 offen offset:3072 nt lds
    s_add_u32 s95, s95, 131072
    s_add_u32 s39, s56, s62
    s_mov_b32 m0, s39
    s_add_u32 s62, s62, 4096
    s_and_b32 s62, s62, 0x7fff
    buffer_load_dwordx4 v10, s[52:55], s95 offen offset:0 nt lds
    buffer_load_dwordx4 v11, s[52:55], s95 offen offset:1024 nt lds
    buffer_load_dwordx4 v12, s[52:55], s95 offen offset:2048 nt lds
    buffer_load_dwordx4 v13, s[52:55], s95 offen offset:3072 nt lds
    s_add_u32 s95, s95, 131072
    s_add_u32 s39, s56, s62
    s_mov_b32 m0, s39
    s_add_u32 s62, s62, 4096
    s_and_b32 s62, s62, 0x7fff
    buffer_load_dwordx4 v10, s[52:55], s95 offen offset:0 nt lds
    buffer_load_dwordx4 v11, s[52:55], s95 offen offset:1024 nt lds
    buffer_load_dwordx4 v12, s[52:55], s95 offen offset:2048 nt lds
    buffer_load_dwordx4 v13, s[52:55], s95 offen offset:3072 nt lds
    s_add_u32 s95, s95, 131072
    s_add_u32 s39, s56, s62
    s_mov_b32 m0, s39
    s_add_u32 s62, s62, 4096
    s_and_b32 s62, s62, 0x7fff
    buffer_load_dwordx4 v10, s[52:55], s95 offen offset:0 nt lds
    buffer_load_dwordx4 v11, s[52:55], s95 offen offset:1024 nt lds
    buffer_load_dwordx4 v12, s[52:55], s95 offen offset:2048 nt lds
    buffer_load_dwordx4 v13, s[52:55], s95 offen offset:3072 nt lds
    s_add_u32 s95, s95, 131072
    s_add_u32 s39, s56, s62
    s_mov_b32 m0, s39
    s_add_u32 s62, s62, 4096
    s_and_b32 s62, s62, 0x7fff
    buffer_load_dwordx4 v10, s[52:55], s95 offen offset:0 nt lds
    buffer_load_dwordx4 v11, s[52:55], s95 offen offset:1024 nt lds
    buffer_load_dwordx4 v12, s[52:55], s95 offen offset:2048 nt lds
    buffer_load_dwordx4 v13, s[52:55], s95 offen offset:3072 nt lds
    s_add_u32 s95, s95, 131072
    s_add_u32 s39, s56, s62
    s_mov_b32 m0, s39
    s_add_u32 s62, s62, 4096
    s_and_b32 s62, s62, 0x7fff
    buffer_load_dwordx4 v10, s[52:55], s95 offen offset:0 nt lds
    buffer_load_dwordx4 v11, s[52:55], s95 offen offset:1024 nt lds
    buffer_load_dwordx4 v12, s[52:55], s95 offen offset:2048 nt lds
    buffer_load_dwordx4 v13, s[52:55], s95 offen offset:3072 nt lds
    s_add_u32 s95, s95, 131072
    s_waitcnt lgkmcnt(0)
    s_add_u32 s35, s35, 0x5b
    s_and_b32 s35, s35, 0xff
    v_mov_b32 v8, s35
    s_or_b32 s68, s35, 0x6b3ac500
    s_getreg_b32 s70, hwreg(HW_REG_XCC_ID, 0, 4)
    s_lshl_b32 s70, s70, 8
    s_or_b32 s70, s70, s35
    s_or_b32 s70, s70, 0x5e9d0000
    s_bfe_u32 s38, s2, 0x30000
    s_lshl_b32 s38, s38, 8
    s_add_u32 s69, s38, 32768
    s_lshl_b32 s38, s32, 2
    s_add_u32 s69, s38, s69
    s_lshl_b32 s38, s34, 24
    s_add_u32 s69, s38, s69
    v_mov_b32 v4, s69
    v_mov_b32 v5, s70
    s_mov_b64 exec, 1
    buffer_store_dword v5, v4, s[48:51], 0 offen sc1
    s_mov_b64 exec, -1
    s_mov_b32 s52, s6
    s_and_b32 s53, s7, 0xffff
    s_mov_b32 s54, 16777216
    s_mov_b32 s55, 0x20000
    s_bfe_u32 s38, s32, 0x30000
    s_lshl_b32 s38, s38, 1
    s_add_u32 s3, s38, 0
    s_lshr_b32 s38, s32, 4
    s_lshl_b32 s38, s38, 0
    s_add_u32 s3, s38, s3
    s_bfe_u32 s94, s32, 0x10003
    s_lshl_b32 s38, s3, 20
    s_add_u32 s95, s38, 0
    s_lshl_b32 s38, s34, 8
    s_add_u32 s95, s38, s95
    s_waitcnt vmcnt(25)
    ds_read_b64_tr_b16 a[128:129], v136 offset:0
    ds_read_b64_tr_b16 a[130:131], v137 offset:1024
    ds_read_b64_tr_b16 a[144:145], v138 offset:0
    ds_read_b64_tr_b16 a[146:147], v139 offset:1024
    ds_read_b64_tr_b16 a[160:161], v140 offset:0
    ds_read_b64_tr_b16 a[162:163], v141 offset:1024
    ds_read_b64_tr_b16 a[176:177], v142 offset:0
    ds_read_b64_tr_b16 a[178:179], v143 offset:1024
    ds_read_b64_tr_b16 a[192:193], v144 offset:0
    ds_read_b64_tr_b16 a[194:195], v145 offset:1024
    ds_read_b64_tr_b16 a[208:209], v146 offset:0
    ds_read_b64_tr_b16 a[210:211], v147 offset:1024
    ds_read_b64_tr_b16 a[224:225], v148 offset:0
    ds_read_b64_tr_b16 a[226:227], v149 offset:1024
    ds_read_b64_tr_b16 a[240:241], v150 offset:0
    ds_read_b64_tr_b16 a[242:243], v151 offset:1024
    s_waitcnt lgkmcnt(0)
    s_add_u32 s39, s56, s62
    s_mov_b32 m0, s39
    s_add_u32 s62, s62, 4096
    s_and_b32 s62, s62, 0x7fff
    buffer_load_dwordx4 v76, s[52:55], s95 offen offset:0 nt lds
    buffer_load_dwordx4 v77, s[52:55], s95 offen offset:1024 nt lds
    buffer_load_dwordx4 v78, s[52:55], s95 offen offset:2048 nt lds
    buffer_load_dwordx4 v79, s[52:55], s95 offen offset:3072 nt lds
    s_add_u32 s95, s95, 16384
    s_add_u32 s39, s56, s62
    s_mov_b32 m0, s39
    s_add_u32 s62, s62, 4096
    s_and_b32 s62, s62, 0x7fff
    buffer_load_dwordx4 v76, s[52:55], s95 offen offset:0 nt lds
    buffer_load_dwordx4 v77, s[52:55], s95 offen offset:1024 nt lds
    buffer_load_dwordx4 v78, s[52:55], s95 offen offset:2048 nt lds
    buffer_load_dwordx4 v79, s[52:55], s95 offen offset:3072 nt lds
    s_add_u32 s95, s95, 16384
    s_waitcnt vmcnt(25)
    ds_read_b64_tr_b16 a[132:133], v136 offset:8192
    ds_read_b64_tr_b16 a[134:135], v137 offset:9216
    ds_read_b64_tr_b16 a[148:149], v138 offset:8192
    ds_read_b64_tr_b16 a[150:151], v139 offset:9216
    ds_read_b64_tr_b16 a[164:165], v140 offset:8192
    ds_read_b64_tr_b16 a[166:167], v141 offset:9216
    ds_read_b64_tr_b16 a[180:181], v142 offset:8192
    ds_read_b64_tr_b16 a[182:183], v143 offset:9216
    ds_read_b64_tr_b16 a[196:197], v144 offset:8192
    ds_read_b64_tr_b16 a[198:199], v145 offset:9216
    ds_read_b64_tr_b16 a[212:213], v146 offset:8192
    ds_read_b64_tr_b16 a[214:215], v147 offset:9216
    ds_read_b64_tr_b16 a[228:229], v148 offset:8192
    ds_read_b64_tr_b16 a[230:231], v149 offset:9216
    ds_read_b64_tr_b16 a[244:245], v150 offset:8192
    ds_read_b64_tr_b16 a[246:247], v151 offset:9216
    s_waitcnt lgkmcnt(0)
    s_add_u32 s39, s56, s62
    s_mov_b32 m0, s39
    s_add_u32 s62, s62, 4096
    s_and_b32 s62, s62, 0x7fff
    buffer_load_dwordx4 v76, s[52:55], s95 offen offset:0 nt lds
    buffer_load_dwordx4 v77, s[52:55], s95 offen offset:1024 nt lds
    buffer_load_dwordx4 v78, s[52:55], s95 offen offset:2048 nt lds
    buffer_load_dwordx4 v79, s[52:55], s95 offen offset:3072 nt lds
    s_add_u32 s95, s95, 16384
    s_add_u32 s39, s56, s62
    s_mov_b32 m0, s39
    s_add_u32 s62, s62, 4096
    s_and_b32 s62, s62, 0x7fff
    buffer_load_dwordx4 v76, s[52:55], s95 offen offset:0 nt lds
    buffer_load_dwordx4 v77, s[52:55], s95 offen offset:1024 nt lds
    buffer_load_dwordx4 v78, s[52:55], s95 offen offset:2048 nt lds
    buffer_load_dwordx4 v79, s[52:55], s95 offen offset:3072 nt lds
    s_add_u32 s95, s95, 16384
    s_waitcnt vmcnt(25)
    ds_read_b64_tr_b16 a[136:137], v136 offset:16384
    ds_read_b64_tr_b16 a[138:139], v137 offset:17408
    ds_read_b64_tr_b16 a[152:153], v138 offset:16384
    ds_read_b64_tr_b16 a[154:155], v139 offset:17408
    ds_read_b64_tr_b16 a[168:169], v140 offset:16384
    ds_read_b64_tr_b16 a[170:171], v141 offset:17408
    ds_read_b64_tr_b16 a[184:185], v142 offset:16384
    ds_read_b64_tr_b16 a[186:187], v143 offset:17408
    ds_read_b64_tr_b16 a[200:201], v144 offset:16384
    ds_read_b64_tr_b16 a[202:203], v145 offset:17408
    ds_read_b64_tr_b16 a[216:217], v146 offset:16384
    ds_read_b64_tr_b16 a[218:219], v147 offset:17408
    ds_read_b64_tr_b16 a[232:233], v148 offset:16384
    ds_read_b64_tr_b16 a[234:235], v149 offset:17408
    ds_read_b64_tr_b16 a[248:249], v150 offset:16384
    ds_read_b64_tr_b16 a[250:251], v151 offset:17408
    s_waitcnt lgkmcnt(0)
    s_add_u32 s39, s56, s62
    s_mov_b32 m0, s39
    s_add_u32 s62, s62, 4096
    s_and_b32 s62, s62, 0x7fff
    buffer_load_dwordx4 v76, s[52:55], s95 offen offset:0 nt lds
    buffer_load_dwordx4 v77, s[52:55], s95 offen offset:1024 nt lds
    buffer_load_dwordx4 v78, s[52:55], s95 offen offset:2048 nt lds
    buffer_load_dwordx4 v79, s[52:55], s95 offen offset:3072 nt lds
    s_add_u32 s95, s95, 16384
    s_add_u32 s39, s56, s62
    s_mov_b32 m0, s39
    s_add_u32 s62, s62, 4096
    s_and_b32 s62, s62, 0x7fff
    buffer_load_dwordx4 v76, s[52:55], s95 offen offset:0 nt lds
    buffer_load_dwordx4 v77, s[52:55], s95 offen offset:1024 nt lds
    buffer_load_dwordx4 v78, s[52:55], s95 offen offset:2048 nt lds
    buffer_load_dwordx4 v79, s[52:55], s95 offen offset:3072 nt lds
    s_add_u32 s95, s95, 16384
    s_waitcnt vmcnt(25)
    ds_read_b64_tr_b16 a[140:141], v136 offset:24576
    ds_read_b64_tr_b16 a[142:143], v137 offset:25600
    ds_read_b64_tr_b16 a[156:157], v138 offset:24576
    ds_read_b64_tr_b16 a[158:159], v139 offset:25600
    ds_read_b64_tr_b16 a[172:173], v140 offset:24576
    ds_read_b64_tr_b16 a[174:175], v141 offset:25600
    ds_read_b64_tr_b16 a[188:189], v142 offset:24576
    ds_read_b64_tr_b16 a[190:191], v143 offset:25600
    ds_read_b64_tr_b16 a[204:205], v144 offset:24576
    ds_read_b64_tr_b16 a[206:207], v145 offset:25600
    ds_read_b64_tr_b16 a[220:221], v146 offset:24576
    ds_read_b64_tr_b16 a[222:223], v147 offset:25600
    ds_read_b64_tr_b16 a[236:237], v148 offset:24576
    ds_read_b64_tr_b16 a[238:239], v149 offset:25600
    ds_read_b64_tr_b16 a[252:253], v150 offset:24576
    ds_read_b64_tr_b16 a[254:255], v151 offset:25600
    s_waitcnt lgkmcnt(0)
    s_add_u32 s39, s56, s62
    s_mov_b32 m0, s39
    s_add_u32 s62, s62, 4096
    s_and_b32 s62, s62, 0x7fff
    buffer_load_dwordx4 v76, s[52:55], s95 offen offset:0 nt lds
    buffer_load_dwordx4 v77, s[52:55], s95 offen offset:1024 nt lds
    s_mov_b32 s86, 98304
    buffer_load_dword v7, v101, s[48:51], s86 offen sc1
    v_mov_b32 v104, 0
    v_mov_b32 v105, 0
    v_mov_b32 v106, 0
    v_mov_b32 v107, 0
    v_mov_b32 v108, 0
    v_mov_b32 v109, 0
    v_mov_b32 v110, 0
    v_mov_b32 v111, 0
    v_mov_b32 v112, 0
    v_mov_b32 v113, 0
    v_mov_b32 v114, 0
    v_mov_b32 v115, 0
    v_mov_b32 v116, 0
    v_mov_b32 v117, 0
    v_mov_b32 v118, 0
    v_mov_b32 v119, 0
    v_mov_b32 v120, 0
    v_mov_b32 v121, 0
    v_mov_b32 v122, 0
    v_mov_b32 v123, 0
    v_mov_b32 v124, 0
    v_mov_b32 v125, 0
    v_mov_b32 v126, 0
    v_mov_b32 v127, 0
    v_mov_b32 v128, 0
    v_mov_b32 v129, 0
    v_mov_b32 v130, 0
    v_mov_b32 v131, 0
    v_mov_b32 v132, 0
    v_mov_b32 v133, 0
    v_mov_b32 v134, 0
    v_mov_b32 v135, 0
    v_mov_b32 v90, 0xff7f0000
    s_mov_b32 s93, 0
    v_mov_b32 v102, 0
    v_mov_b32 v103, 0
    s_mov_b32 s60, s83
    s_mov_b32 s61, s83
    v_xor_b32 v5, v3, v2
    v_lshlrev_b32 v6, 8, v3
    v_bfe_u32 v4, v5, 0, 2
    v_lshl_add_u32 v6, v4, 6, v6
    v_lshrrev_b32 v4, 2, v3
    v_lshl_add_u32 v6, v4, 4, v6
    v_add_u32 v52, s85, v6
    v_xor_b32 v53, 16, v52
    v_xor_b32 v54, 32, v52
    v_xor_b32 v55, 48, v52
    s_lshr_b32 s38, s3, 2
    s_lshl_b32 s38, s38, 15
    s_add_u32 s36, s38, 393216
    s_lshl_b32 s38, s94, 14
    s_add_u32 s36, s38, s36
    s_lshl_b32 s38, s34, 8
    s_add_u32 s36, s38, s36
    s_waitcnt vmcnt(0)
L_fcheck_45:
    v_cmp_ne_u32 vcc, s68, v7
    s_cbranch_vccz L_fok_46
    s_sleep 2
    s_mov_b32 s86, 98304
    buffer_load_dword v7, v101, s[48:51], s86 offen sc1
    s_waitcnt vmcnt(0)
    s_sub_u32 s84, s84, 1
    s_cmp_lg_u32 s84, 0
    s_cbranch_scc1 L_fcheck_45
    s_branch L_end
L_fok_46:
    buffer_load_dwordx4 v[200:203], v9, s[48:51], s36 offen sc1
    s_add_u32 s36, s36, 4096
    buffer_load_dwordx4 v[204:207], v9, s[48:51], s36 offen sc1
    s_add_u32 s36, s36, 4096
    buffer_load_dwordx4 v[208:211], v9, s[48:51], s36 offen sc1
    s_add_u32 s36, s36, 4096
    buffer_load_dwordx4 v[212:215], v9, s[48:51], s36 offen sc1
    ds_read_b128 v[136:139], v60 offset:0
    ds_read_b128 v[140:143], v61 offset:0
    ds_read_b128 v[144:147], v62 offset:0
    ds_read_b128 v[148:151], v63 offset:0
    ds_read_b128 v[152:155], v60 offset:4096
    ds_read_b128 v[156:159], v61 offset:4096
    ds_read_b128 v[160:163], v62 offset:4096
    ds_read_b128 v[164:167], v63 offset:4096
    ds_read_b128 v[168:171], v60 offset:8192
    ds_read_b128 v[172:175], v61 offset:8192
    ds_read_b128 v[176:179], v62 offset:8192
    ds_read_b128 v[180:183], v63 offset:8192
    ds_read_b128 v[184:187], v60 offset:12288
    ds_read_b128 v[188:191], v61 offset:12288
    ds_read_b128 v[192:195], v62 offset:12288
    ds_read_b128 v[196:199], v63 offset:12288
    s_waitcnt vmcnt(3)
    ds_write_b128 v96, v[200:203] offset:0
    s_waitcnt vmcnt(2)
    ds_write_b128 v97, v[204:207] offset:1024
    s_waitcnt vmcnt(1)
    ds_write_b128 v98, v[208:211] offset:2048
    s_waitcnt vmcnt(0)
    ds_write_b128 v99, v[212:215] offset:3072
    s_waitcnt lgkmcnt(0)
    ds_read_b128 v[36:39], v52
    ds_read_b128 v[40:43], v53
    ds_read_b128 v[44:47], v54
    ds_read_b128 v[48:51], v55
L_att:
    s_waitcnt lgkmcnt(0)
    v_mfma_f32_16x16x32_bf16 v[200:203], v[136:139], v[36:39], 0
    ds_read_b64_tr_b16 a[0:1], v82 offset:0
    ds_read_b64_tr_b16 a[2:3], v82 offset:4096
    buffer_load_dwordx4 v78, s[52:55], s95 offen offset:2048 nt lds
    v_mfma_f32_16x16x32_bf16 v[200:203], v[140:143], v[40:43], v[200:203]
    ds_read_b64_tr_b16 a[4:5], v83 offset:0
    ds_read_b64_tr_b16 a[6:7], v83 offset:4096
    v_mfma_f32_16x16x32_bf16 v[200:203], v[144:147], v[44:47], v[200:203]
    ds_read_b64_tr_b16 a[8:9], v84 offset:0
    ds_read_b64_tr_b16 a[10:11], v84 offset:4096
    v_mfma_f32_16x16x32_bf16 v[200:203], v[148:151], v[48:51], v[200:203]
    ds_read_b64_tr_b16 a[12:13], v85 offset:0
    ds_read_b64_tr_b16 a[14:15], v85 offset:4096
    buffer_load_dwordx4 v79, s[52:55], s95 offen offset:3072 nt lds
    s_add_u32 s95, s95, 16384
    v_mfma_f32_16x16x32_bf16 v[204:207], v[152:155], v[36:39], 0
    ds_read_b64_tr_b16 a[16:17], v86 offset:0
    ds_read_b64_tr_b16 a[18:19], v86 offset:4096
    v_mfma_f32_16x16x32_bf16 v[204:207], v[156:159], v[40:43], v[204:207]
    ds_read_b64_tr_b16 a[20:21], v87 offset:0
    ds_read_b64_tr_b16 a[22:23], v87 offset:4096
    v_mfma_f32_16x16x32_bf16 v[204:207], v[160:163], v[44:47], v[204:207]
    ds_read_b64_tr_b16 a[24:25], v88 offset:0
    ds_read_b64_tr_b16 a[26:27], v88 offset:4096
    s_add_u32 s39, s56, s62
    s_mov_b32 m0, s39
    s_add_u32 s62, s62, 4096
    s_and_b32 s62, s62, 0x7fff
    buffer_load_dwordx4 v76, s[52:55], s95 offen offset:0 nt lds
    v_mfma_f32_16x16x32_bf16 v[204:207], v[164:167], v[48:51], v[204:207]
    ds_read_b64_tr_b16 a[28:29], v89 offset:0
    ds_read_b64_tr_b16 a[30:31], v89 offset:4096
    ds_write_b128 v94, v[200:203] offset:0
    v_mfma_f32_16x16x32_bf16 v[208:211], v[168:171], v[36:39], 0
    ds_read_b64_tr_b16 a[32:33], v82 offset:8192
    ds_read_b64_tr_b16 a[34:35], v82 offset:12288
    v_mfma_f32_16x16x32_bf16 v[208:211], v[172:175], v[40:43], v[208:211]
    ds_read_b64_tr_b16 a[36:37], v83 offset:8192
    ds_read_b64_tr_b16 a[38:39], v83 offset:12288
    buffer_load_dwordx4 v77, s[52:55], s95 offen offset:1024 nt lds
    v_mfma_f32_16x16x32_bf16 v[208:211], v[176:179], v[44:47], v[208:211]
    ds_read_b64_tr_b16 a[40:41], v84 offset:8192
    ds_read_b64_tr_b16 a[42:43], v84 offset:12288
    v_mfma_f32_16x16x32_bf16 v[208:211], v[180:183], v[48:51], v[208:211]
    ds_read_b64_tr_b16 a[44:45], v85 offset:8192
    ds_read_b64_tr_b16 a[46:47], v85 offset:12288
    ds_write_b128 v94, v[204:207] offset:1024
    v_mfma_f32_16x16x32_bf16 v[212:215], v[184:187], v[36:39], 0
    ds_read_b64_tr_b16 a[48:49], v86 offset:8192
    ds_read_b64_tr_b16 a[50:51], v86 offset:12288
    buffer_load_dwordx4 v78, s[52:55], s95 offen offset:2048 nt lds
    v_mfma_f32_16x16x32_bf16 v[212:215], v[188:191], v[40:43], v[212:215]
    ds_read_b64_tr_b16 a[52:53], v87 offset:8192
    ds_read_b64_tr_b16 a[54:55], v87 offset:12288
    v_mfma_f32_16x16x32_bf16 v[212:215], v[192:195], v[44:47], v[212:215]
    ds_read_b64_tr_b16 a[56:57], v88 offset:8192
    ds_read_b64_tr_b16 a[58:59], v88 offset:12288
    v_mfma_f32_16x16x32_bf16 v[212:215], v[196:199], v[48:51], v[212:215]
    ds_read_b64_tr_b16 a[60:61], v89 offset:8192
    ds_read_b64_tr_b16 a[62:63], v89 offset:12288
    buffer_load_dwordx4 v79, s[52:55], s95 offen offset:3072 nt lds
    s_add_u32 s95, s95, 16384
    ds_write_b128 v94, v[208:211] offset:2048
    v_xor_b32 v5, 0x2000, v94
    v_xor_b32 v6, 0x4000, v94
    v_xor_b32 v7, 0x6000, v94
    s_cmp_eq_u32 s93, 14
    s_cselect_b32 s95, 16777216, s95
    ds_write_b128 v94, v[212:215] offset:3072
    v_xor_b32 v82, 0x4000, v82
    v_xor_b32 v83, 0x4000, v83
    v_xor_b32 v84, 0x4000, v84
    v_xor_b32 v85, 0x4000, v85
    v_xor_b32 v86, 0x4000, v86
    v_xor_b32 v87, 0x4000, v87
    v_xor_b32 v88, 0x4000, v88
    v_xor_b32 v89, 0x4000, v89
    v_xor_b32 v60, 0x4000, v60
    v_xor_b32 v61, 0x4000, v61
    v_xor_b32 v62, 0x4000, v62
    v_xor_b32 v63, 0x4000, v63
    s_waitcnt lgkmcnt(0)
    s_barrier
    ds_read_b128 v[136:139], v5 offset:0
    ds_read_b128 v[152:155], v6 offset:0
    ds_read_b128 v[168:171], v7 offset:0
    ds_read_b128 v[140:143], v5 offset:1024
    ds_read_b128 v[156:159], v6 offset:1024
    ds_read_b128 v[172:175], v7 offset:1024
    ds_read_b128 v[144:147], v5 offset:2048
    ds_read_b128 v[160:163], v6 offset:2048
    ds_read_b128 v[176:179], v7 offset:2048
    ds_read_b128 v[148:151], v5 offset:3072
    ds_read_b128 v[164:167], v6 offset:3072
    ds_read_b128 v[180:183], v7 offset:3072
    v_xor_b32 v94, 0x1000, v94
    s_add_u32 s39, s56, s62
    s_mov_b32 m0, s39
    s_add_u32 s62, s62, 4096
    s_and_b32 s62, s62, 0x7fff
    buffer_load_dwordx4 v76, s[52:55], s95 offen offset:0 nt lds
    buffer_load_dwordx4 v77, s[52:55], s95 offen offset:1024 nt lds
    buffer_load_dwordx4 v78, s[52:55], s95 offen offset:2048 nt lds
    s_waitcnt lgkmcnt(9)
    v_pk_add_f32 v[200:201], v[200:201], v[136:137]
    v_pk_add_f32 v[152:153], v[152:153], v[168:169]
    v_pk_add_f32 v[202:203], v[202:203], v[138:139]
    v_pk_add_f32 v[154:155], v[154:155], v[170:171]
    v_pk_add_f32 v[200:201], v[200:201], v[152:153]
    v_pk_add_f32 v[202:203], v[202:203], v[154:155]
    s_waitcnt lgkmcnt(6)
    v_pk_add_f32 v[204:205], v[204:205], v[140:141]
    v_pk_add_f32 v[156:157], v[156:157], v[172:173]
    v_pk_add_f32 v[206:207], v[206:207], v[142:143]
    v_pk_add_f32 v[158:159], v[158:159], v[174:175]
    v_pk_add_f32 v[204:205], v[204:205], v[156:157]
    v_pk_add_f32 v[206:207], v[206:207], v[158:159]
    s_waitcnt lgkmcnt(3)
    v_pk_add_f32 v[208:209], v[208:209], v[144:145]
    v_pk_add_f32 v[160:161], v[160:161], v[176:177]
    v_pk_add_f32 v[210:211], v[210:211], v[146:147]
    v_pk_add_f32 v[162:163], v[162:163], v[178:179]
    v_pk_add_f32 v[208:209], v[208:209], v[160:161]
    v_pk_add_f32 v[210:211], v[210:211], v[162:163]
    s_waitcnt lgkmcnt(0)
    v_pk_add_f32 v[212:213], v[212:213], v[148:149]
    v_pk_add_f32 v[164:165], v[164:165], v[180:181]
    v_pk_add_f32 v[214:215], v[214:215], v[150:151]
    v_pk_add_f32 v[166:167], v[166:167], v[182:183]
    v_pk_add_f32 v[212:213], v[212:213], v[164:165]
    v_pk_add_f32 v[214:215], v[214:215], v[166:167]
    buffer_load_dwordx4 v79, s[52:55], s95 offen offset:3072 nt lds
    s_add_u32 s95, s95, 16384
    s_waitcnt vmcnt(4)
    v_max_f32 v4, v200, v201
    v_max3_f32 v4, v4, v202, v203
    v_max3_f32 v4, v4, v204, v205
    v_max3_f32 v4, v4, v206, v207
    v_max3_f32 v4, v4, v208, v209
    v_max3_f32 v4, v4, v210, v211
    v_max3_f32 v4, v4, v212, v213
    v_max3_f32 v4, v4, v214, v215
    v_mov_b32 v5, v4
    ds_read_b128 v[136:139], v60 offset:0
    ds_read_b128 v[140:143], v61 offset:0
    v_permlane16_swap_b32 v4, v5
    v_max_f32 v4, v4, v5
    v_mov_b32 v5, v4
    ds_read_b128 v[144:147], v62 offset:0
    ds_read_b128 v[148:151], v63 offset:0
    v_permlane32_swap_b32 v4, v5
    v_max_f32 v4, v4, v5
    v_mul_f32 v4, s83, v4
    v_max_f32 v4, v4, v90
    v_sub_f32 v92, v90, v4
    v_exp_f32 v92, v92
    v_mov_b32 v90, v4
    s_add_u32 s39, s56, s62
    s_mov_b32 m0, s39
    s_add_u32 s62, s62, 4096
    s_and_b32 s62, s62, 0x7fff
    buffer_load_dwordx4 v76, s[52:55], s95 offen offset:0 nt lds
    v_pk_fma_f32 v[200:201], v[200:201], s[60:61], v[90:91] op_sel_hi:[1,1,0] neg_lo:[0,0,1] neg_hi:[0,0,1]
    v_pk_fma_f32 v[202:203], v[202:203], s[60:61], v[90:91] op_sel_hi:[1,1,0] neg_lo:[0,0,1] neg_hi:[0,0,1]
    v_pk_fma_f32 v[204:205], v[204:205], s[60:61], v[90:91] op_sel_hi:[1,1,0] neg_lo:[0,0,1] neg_hi:[0,0,1]
    v_pk_fma_f32 v[206:207], v[206:207], s[60:61], v[90:91] op_sel_hi:[1,1,0] neg_lo:[0,0,1] neg_hi:[0,0,1]
    v_pk_fma_f32 v[208:209], v[208:209], s[60:61], v[90:91] op_sel_hi:[1,1,0] neg_lo:[0,0,1] neg_hi:[0,0,1]
    v_pk_fma_f32 v[210:211], v[210:211], s[60:61], v[90:91] op_sel_hi:[1,1,0] neg_lo:[0,0,1] neg_hi:[0,0,1]
    v_pk_fma_f32 v[212:213], v[212:213], s[60:61], v[90:91] op_sel_hi:[1,1,0] neg_lo:[0,0,1] neg_hi:[0,0,1]
    v_pk_fma_f32 v[214:215], v[214:215], s[60:61], v[90:91] op_sel_hi:[1,1,0] neg_lo:[0,0,1] neg_hi:[0,0,1]
    v_exp_f32 v200, v200
    v_exp_f32 v201, v201
    ds_read_b128 v[152:155], v60 offset:4096
    v_exp_f32 v202, v202
    v_exp_f32 v203, v203
    v_exp_f32 v204, v204
    v_exp_f32 v205, v205
    ds_read_b128 v[156:159], v61 offset:4096
    v_exp_f32 v206, v206
    v_exp_f32 v207, v207
    buffer_load_dwordx4 v77, s[52:55], s95 offen offset:1024 nt lds
    v_exp_f32 v208, v208
    v_exp_f32 v209, v209
    ds_read_b128 v[160:163], v62 offset:4096
    v_exp_f32 v210, v210
    v_exp_f32 v211, v211
    v_exp_f32 v212, v212
    v_exp_f32 v213, v213
    ds_read_b128 v[164:167], v63 offset:4096
    v_exp_f32 v214, v214
    v_exp_f32 v215, v215
    buffer_load_dwordx4 v78, s[52:55], s95 offen offset:2048 nt lds
    v_pk_mul_f32 v[102:103], v[102:103], v[92:93] op_sel_hi:[1,0]
    v_pk_mul_f32 v[104:105], v[104:105], v[92:93] op_sel_hi:[1,0]
    v_pk_mul_f32 v[106:107], v[106:107], v[92:93] op_sel_hi:[1,0]
    v_pk_mul_f32 v[108:109], v[108:109], v[92:93] op_sel_hi:[1,0]
    v_pk_mul_f32 v[110:111], v[110:111], v[92:93] op_sel_hi:[1,0]
    v_pk_mul_f32 v[112:113], v[112:113], v[92:93] op_sel_hi:[1,0]
    v_pk_mul_f32 v[114:115], v[114:115], v[92:93] op_sel_hi:[1,0]
    v_pk_mul_f32 v[116:117], v[116:117], v[92:93] op_sel_hi:[1,0]
    v_pk_mul_f32 v[118:119], v[118:119], v[92:93] op_sel_hi:[1,0]
    v_pk_mul_f32 v[120:121], v[120:121], v[92:93] op_sel_hi:[1,0]
    v_pk_mul_f32 v[122:123], v[122:123], v[92:93] op_sel_hi:[1,0]
    v_pk_mul_f32 v[124:125], v[124:125], v[92:93] op_sel_hi:[1,0]
    v_pk_mul_f32 v[126:127], v[126:127], v[92:93] op_sel_hi:[1,0]
    v_pk_mul_f32 v[128:129], v[128:129], v[92:93] op_sel_hi:[1,0]
    v_pk_mul_f32 v[130:131], v[130:131], v[92:93] op_sel_hi:[1,0]
    v_pk_mul_f32 v[132:133], v[132:133], v[92:93] op_sel_hi:[1,0]
    v_pk_mul_f32 v[134:135], v[134:135], v[92:93] op_sel_hi:[1,0]
    buffer_load_dwordx4 v79, s[52:55], s95 offen offset:3072 nt lds
    s_add_u32 s95, s95, 16384
    v_cvt_pk_bf16_f32 v52, v200, v201
    v_pk_add_f32 v[102:103], v[102:103], v[200:201]
    v_cvt_pk_bf16_f32 v53, v202, v203
    v_pk_add_f32 v[102:103], v[102:103], v[202:203]
    v_cvt_pk_bf16_f32 v54, v204, v205
    v_pk_add_f32 v[102:103], v[102:103], v[204:205]
    v_cvt_pk_bf16_f32 v55, v206, v207
    v_pk_add_f32 v[102:103], v[102:103], v[206:207]
    v_cvt_pk_bf16_f32 v56, v208, v209
    v_pk_add_f32 v[102:103], v[102:103], v[208:209]
    v_cvt_pk_bf16_f32 v57, v210, v211
    v_pk_add_f32 v[102:103], v[102:103], v[210:211]
    v_cvt_pk_bf16_f32 v58, v212, v213
    v_pk_add_f32 v[102:103], v[102:103], v[212:213]
    v_cvt_pk_bf16_f32 v59, v214, v215
    v_pk_add_f32 v[102:103], v[102:103], v[214:215]
    v_mfma_f32_16x16x32_bf16 v[104:107], a[0:3], v[52:55], v[104:107]
    ds_read_b128 v[168:171], v60 offset:8192
    v_mfma_f32_16x16x32_bf16 v[108:111], a[4:7], v[52:55], v[108:111]
    ds_read_b128 v[172:175], v61 offset:8192
    v_mfma_f32_16x16x32_bf16 v[112:115], a[8:11], v[52:55], v[112:115]
    ds_read_b128 v[176:179], v62 offset:8192
    v_mfma_f32_16x16x32_bf16 v[116:119], a[12:15], v[52:55], v[116:119]
    ds_read_b128 v[180:183], v63 offset:8192
    v_mfma_f32_16x16x32_bf16 v[120:123], a[16:19], v[52:55], v[120:123]
    ds_read_b128 v[184:187], v60 offset:12288
    v_mfma_f32_16x16x32_bf16 v[124:127], a[20:23], v[52:55], v[124:127]
    ds_read_b128 v[188:191], v61 offset:12288
    v_mfma_f32_16x16x32_bf16 v[128:131], a[24:27], v[52:55], v[128:131]
    ds_read_b128 v[192:195], v62 offset:12288
    v_mfma_f32_16x16x32_bf16 v[132:135], a[28:31], v[52:55], v[132:135]
    ds_read_b128 v[196:199], v63 offset:12288
    v_mfma_f32_16x16x32_bf16 v[104:107], a[32:35], v[56:59], v[104:107]
    v_mfma_f32_16x16x32_bf16 v[108:111], a[36:39], v[56:59], v[108:111]
    s_add_u32 s39, s56, s62
    s_mov_b32 m0, s39
    s_add_u32 s62, s62, 4096
    s_and_b32 s62, s62, 0x7fff
    buffer_load_dwordx4 v76, s[52:55], s95 offen offset:0 nt lds
    v_mfma_f32_16x16x32_bf16 v[112:115], a[40:43], v[56:59], v[112:115]
    v_mfma_f32_16x16x32_bf16 v[116:119], a[44:47], v[56:59], v[116:119]
    v_mfma_f32_16x16x32_bf16 v[120:123], a[48:51], v[56:59], v[120:123]
    v_mfma_f32_16x16x32_bf16 v[124:127], a[52:55], v[56:59], v[124:127]
    buffer_load_dwordx4 v77, s[52:55], s95 offen offset:1024 nt lds
    v_mfma_f32_16x16x32_bf16 v[128:131], a[56:59], v[56:59], v[128:131]
    v_mfma_f32_16x16x32_bf16 v[132:135], a[60:63], v[56:59], v[132:135]
    s_add_u32 s93, s93, 1
    s_cmp_lt_u32 s93, 16
    s_cbranch_scc1 L_att
    v_add_f32 v91, v102, v103
    v_mov_b32 v5, v91
    s_nop 1
    v_permlane16_swap_b32 v91, v5
    v_add_f32 v91, v91, v5
    v_mov_b32 v5, v91
    s_nop 1
    v_permlane32_swap_b32 v91, v5
    v_add_f32 v91, v91, v5
    v_lshrrev_b32 v6, 1, v2
    v_xor_b32 v6, v6, v3
    v_lshlrev_b32 v5, 8, v3
    v_lshl_add_u32 v5, v6, 4, v5
    v_bfe_u32 v4, v2, 0, 1
    v_lshl_add_u32 v5, v4, 3, v5
    v_add_u32 v5, s85, v5
    s_waitcnt vmcnt(0) lgkmcnt(0)
    s_barrier
    v_cvt_pk_bf16_f32 v216, v104, v105
    v_cvt_pk_bf16_f32 v217, v106, v107
    v_xor_b32 v82, 0, v5
    ds_write_b64 v82, v[216:217]
    v_cvt_pk_bf16_f32 v218, v108, v109
    v_cvt_pk_bf16_f32 v219, v110, v111
    v_xor_b32 v83, 32, v5
    ds_write_b64 v83, v[218:219]
    v_cvt_pk_bf16_f32 v220, v112, v113
    v_cvt_pk_bf16_f32 v221, v114, v115
    v_xor_b32 v84, 64, v5
    ds_write_b64 v84, v[220:221]
    v_cvt_pk_bf16_f32 v222, v116, v117
    v_cvt_pk_bf16_f32 v223, v118, v119
    v_xor_b32 v85, 96, v5
    ds_write_b64 v85, v[222:223]
    v_cvt_pk_bf16_f32 v224, v120, v121
    v_cvt_pk_bf16_f32 v225, v122, v123
    v_xor_b32 v86, 128, v5
    ds_write_b64 v86, v[224:225]
    v_cvt_pk_bf16_f32 v226, v124, v125
    v_cvt_pk_bf16_f32 v227, v126, v127
    v_xor_b32 v87, 160, v5
    ds_write_b64 v87, v[226:227]
    v_cvt_pk_bf16_f32 v228, v128, v129
    v_cvt_pk_bf16_f32 v229, v130, v131
    v_xor_b32 v88, 192, v5
    ds_write_b64 v88, v[228:229]
    v_cvt_pk_bf16_f32 v230, v132, v133
    v_cvt_pk_bf16_f32 v231, v134, v135
    v_xor_b32 v89, 224, v5
    ds_write_b64 v89, v[230:231]
    v_xor_b32 v6, v3, v2
    v_lshlrev_b32 v6, 4, v6
    v_lshl_add_u32 v4, v2, 8, v6
    v_add_u32 v4, s85, v4
    v_xor_b32 v60, 0, v4
    v_xor_b32 v61, 64, v4
    v_xor_b32 v62, 128, v4
    v_xor_b32 v63, 192, v4
    v_lshlrev_b32 v7, 4, v3
    v_lshl_add_u32 v7, v2, 14, v7
    s_lshl_b32 s38, s94, 18
    s_add_u32 s36, s38, 2097152
    s_lshl_b32 s38, s3, 10
    s_add_u32 s36, s38, s36
    s_lshl_b32 s38, s34, 8
    s_add_u32 s36, s38, s36
    s_waitcnt lgkmcnt(0)
    ds_read_b128 v[200:203], v60 offset:0
    ds_read_b128 v[204:207], v61 offset:1024
    ds_read_b128 v[208:211], v62 offset:2048
    ds_read_b128 v[212:215], v63 offset:3072
    v_lshlrev_b32 v4, 3, v3
    s_lshl_b32 s38, s3, 8
    s_add_u32 s37, s38, 163840
    s_lshl_b32 s38, s94, 7
    s_add_u32 s37, s38, s37
    s_lshl_b32 s38, s34, 23
    s_add_u32 s37, s38, s37
    s_mov_b32 exec_lo, 0xffff
    s_mov_b32 exec_hi, 0x0
    buffer_store_dwordx2 v[90:91], v4, s[48:51], s37 offen sc1
    s_mov_b64 exec, -1
    s_waitcnt lgkmcnt(3)
    buffer_store_dwordx4 v[200:203], v7, s[48:51], s36 offen sc1
    s_add_u32 s36, s36, 65536
    s_waitcnt lgkmcnt(2)
    buffer_store_dwordx4 v[204:207], v7, s[48:51], s36 offen sc1
    s_add_u32 s36, s36, 65536
    s_waitcnt lgkmcnt(1)
    buffer_store_dwordx4 v[208:211], v7, s[48:51], s36 offen sc1
    s_add_u32 s36, s36, 65536
    s_waitcnt lgkmcnt(0)
    buffer_store_dwordx4 v[212:215], v7, s[48:51], s36 offen sc1
    s_bfe_u32 s38, s2, 0x20001
    s_lshl_b32 s38, s38, 0
    s_add_u32 s90, s38, 0
    s_bfe_u32 s38, s2, 0x10000
    s_lshl_b32 s38, s38, 2
    s_add_u32 s90, s38, s90
    s_and_b32 s36, s90, 3
    s_bitcmp0_b32 s90, 2
    s_cselect_b64 s[40:41], s[24:25], s[14:15]
    s_cselect_b32 s45, 262144, 0
    s_add_u32 s45, s45, 524288
    s_lshl_b32 s38, s36, 16
    s_add_u32 s71, s38, s45
    s_lshr_b32 s38, s32, 2
    s_lshl_b32 s38, s38, 13
    s_add_u32 s71, s38, s71
    s_bfe_u32 s38, s32, 0x20000
    s_lshl_b32 s38, s38, 6
    s_add_u32 s71, s38, s71
    s_mov_b32 s42, 4194304
    s_mov_b32 s43, 0x20000
    s_lshl_b32 s38, s32, 17
    s_add_u32 s44, s38, 0
    s_lshl_b32 s38, s34, 15
    s_add_u32 s44, s38, s44
    s_lshl_b32 s38, s36, 8
    s_add_u32 s44, s38, s44
    s_lshl_b32 s38, s36, 16
    s_add_u32 s45, s38, s45
    s_lshr_b32 s38, s34, 1
    s_lshl_b32 s38, s38, 15
    s_add_u32 s45, s38, s45
    s_lshl_b32 s38, s32, 8
    s_add_u32 s45, s38, s45
    s_bfe_u32 s38, s34, 0x10000
    s_lshl_b32 s38, s38, 7
    s_add_u32 s45, s38, s45
    s_lshl_b32 s38, s32, 11
    s_add_u32 s46, s38, 196608
    s_lshl_b32 s38, s34, 9
    s_add_u32 s46, s38, s46
    s_mov_b32 s72, s26
    s_and_b32 s73, s27, 0xffff
    s_mov_b32 s74, 8192
    s_mov_b32 s75, 0x20000
    v_lshlrev_b32 v30, 4, v3
    v_lshl_add_u32 v30, v2, 13, v30
    v_lshrrev_b32 v5, 2, v1
    v_lshlrev_b32 v32, 8, v5
    v_bfe_u32 v5, v1, 0, 2
    v_lshl_add_u32 v32, v5, 4, v32
    s_xor_b32 s37, s90, 4
    s_bfe_u32 s38, s37, 0x30000
    s_lshl_b32 s38, s38, 8
    s_add_u32 s36, s38, 0
    s_lshr_b32 s38, s32, 4
    s_lshl_b32 s38, s38, 7
    s_add_u32 s36, s38, s36
    s_bfe_u32 s38, s32, 0x20000
    s_lshl_b32 s38, s38, 5
    s_add_u32 s36, s38, s36
    s_bfe_u32 s38, s32, 0x20002
    s_lshl_b32 s38, s38, 3
    s_add_u32 s36, s38, s36
    v_bfe_u32 v5, v1, 0, 2
    v_lshlrev_b32 v33, 11, v5
    v_lshl_add_u32 v33, v2, 1, v33
    v_add_u32 v33, s36, v33
    v_and_b32 v5, 31, v1
    v_lshlrev_b32 v34, 4, v5
    s_mul_i32 s38, s34, 320
    s_add_u32 s38, s38, 135168
    v_lshl_add_u32 v35, v5, 3, s38
    s_bfe_u32 s38, s34, 0x10000
    s_lshl_b32 s38, s38, 12
    s_add_u32 s36, s38, s71
    s_lshr_b32 s38, s34, 1
    s_lshl_b32 s38, s38, 24
    s_add_u32 s36, s38, s36
    s_bitcmp1_b32 s90, 2
    s_cselect_b32 s46, s46, s36
    s_cselect_b64 vcc, -1, 0
    v_cndmask_b32 v54, v32, v34, vcc
    s_bfe_u32 s38, s2, 0x30000
    s_lshl_b32 s38, s38, 8
    s_add_u32 s69, s38, 32768
    v_lshrrev_b32 v64, 2, v34
    buffer_load_dword v64, v64, s[48:51], s69 offen sc1
    v_bfe_u32 v5, v3, 0, 2
    v_lshlrev_b32 v81, 10, v5
    v_lshrrev_b32 v5, 2, v3
    v_lshl_add_u32 v81, v5, 8, v81
    v_add3_u32 v82, v81, v6, s85
    v_xor_b32 v83, 64, v82
    v_xor_b32 v84, 128, v82
    v_xor_b32 v85, 192, v82
    v_bfe_u32 v5, v3, 0, 2
    v_lshlrev_b32 v94, 9, v5
    v_lshl_add_u32 v94, v2, 4, v94
    v_add_u32 v94, s85, v94
    s_lshl_b32 s38, s34, 9
    s_add_u32 s38, s38, 131072
    v_add_u32 v102, s38, v34
    s_lshl_b32 s38, s32, 14
    s_add_u32 s36, s38, 2097152
    s_lshl_b32 s38, s34, 8
    s_add_u32 s36, s38, s36
    s_lshl_b32 s38, s32, 3
    s_add_u32 s37, s38, 163840
    s_lshl_b32 s38, s32, 8
    s_add_u32 s69, s38, 131072
    s_lshl_b32 s38, s34, 23
    s_add_u32 s69, s38, s69
    v_mov_b32 v4, s69
    v_mov_b32 v5, s68
    s_waitcnt vmcnt(1)
    s_barrier
    s_mov_b64 exec, 1
    buffer_store_dword v5, v4, s[48:51], 0 offen sc1
    s_mov_b64 exec, -1
    s_mov_b32 s86, 131072
    buffer_load_dword v7, v101, s[48:51], s86 offen sc1
    s_waitcnt vmcnt(0)
L_fcheck_47:
    v_cmp_ne_u32 vcc, s68, v7
    s_cbranch_vccz L_fok_48
    s_sleep 2
    s_mov_b32 s86, 131072
    buffer_load_dword v7, v101, s[48:51], s86 offen sc1
    s_waitcnt vmcnt(0)
    s_sub_u32 s84, s84, 1
    s_cmp_lg_u32 s84, 0
    s_cbranch_scc1 L_fcheck_47
    s_branch L_end
L_fok_48:
    buffer_load_dwordx2 v[52:53], v81, s[48:51], s37 offen sc1
    buffer_load_dwordx4 v[200:203], v9, s[48:51], s36 offen sc1
    s_add_u32 s36, s36, 4096
    buffer_load_dwordx4 v[204:207], v9, s[48:51], s36 offen sc1
    s_add_u32 s36, s36, 4096
    buffer_load_dwordx4 v[208:211], v9, s[48:51], s36 offen sc1
    s_add_u32 s36, s36, 4096
    buffer_load_dwordx4 v[212:215], v9, s[48:51], s36 offen sc1
    s_waitcnt vmcnt(4)
    v_max_f32_dpp v4, v52, v52 row_ror:8 row_mask:0xf bank_mask:0xf
    s_nop 1
    v_max_f32_dpp v4, v4, v4 row_ror:4 row_mask:0xf bank_mask:0xf
    v_sub_f32 v52, v52, v4
    v_exp_f32 v52, v52
    s_nop 0
    v_mul_f32 v5, v52, v53
    s_nop 1
    v_add_f32_dpp v5, v5, v5 row_ror:8 row_mask:0xf bank_mask:0xf
    s_nop 1
    v_add_f32_dpp v5, v5, v5 row_ror:4 row_mask:0xf bank_mask:0xf
    v_rcp_f32 v5, v5
    s_nop 0
    v_mul_f32 v52, v52, v5
    s_waitcnt vmcnt(3)
    ds_write_b128 v96, v[200:203] offset:0
    s_waitcnt vmcnt(2)
    ds_write_b128 v97, v[204:207] offset:1024
    s_waitcnt vmcnt(1)
    ds_write_b128 v98, v[208:211] offset:2048
    s_waitcnt vmcnt(0)
    ds_write_b128 v99, v[212:215] offset:3072
    s_waitcnt lgkmcnt(0)
    ds_read_b128 v[136:139], v82
    ds_read_b128 v[140:143], v83
    ds_read_b128 v[144:147], v84
    ds_read_b128 v[148:151], v85
    s_waitcnt lgkmcnt(0)
    v_mfma_f32_16x16x32_bf16 v[104:107], a[128:131], v[136:139], 0
    v_mfma_f32_16x16x32_bf16 v[104:107], a[132:135], v[140:143], v[104:107]
    v_mfma_f32_16x16x32_bf16 v[104:107], a[136:139], v[144:147], v[104:107]
    v_mfma_f32_16x16x32_bf16 v[104:107], a[140:143], v[148:151], v[104:107]
    v_mfma_f32_16x16x32_bf16 v[108:111], a[144:147], v[136:139], 0
    v_mfma_f32_16x16x32_bf16 v[108:111], a[148:151], v[140:143], v[108:111]
    v_mfma_f32_16x16x32_bf16 v[108:111], a[152:155], v[144:147], v[108:111]
    v_mfma_f32_16x16x32_bf16 v[108:111], a[156:159], v[148:151], v[108:111]
    v_mfma_f32_16x16x32_bf16 v[112:115], a[160:163], v[136:139], 0
    v_mfma_f32_16x16x32_bf16 v[112:115], a[164:167], v[140:143], v[112:115]
    v_mfma_f32_16x16x32_bf16 v[112:115], a[168:171], v[144:147], v[112:115]
    v_mfma_f32_16x16x32_bf16 v[112:115], a[172:175], v[148:151], v[112:115]
    v_mul_f32 v104, v104, v52
    v_mul_f32 v105, v105, v52
    v_mul_f32 v106, v106, v52
    v_mul_f32 v107, v107, v52
    v_add_f32_dpp v104, v104, v104 row_ror:8 row_mask:0xf bank_mask:0xf
    v_add_f32_dpp v105, v105, v105 row_ror:8 row_mask:0xf bank_mask:0xf
    v_add_f32_dpp v106, v106, v106 row_ror:8 row_mask:0xf bank_mask:0xf
    v_add_f32_dpp v107, v107, v107 row_ror:8 row_mask:0xf bank_mask:0xf
    v_add_f32_dpp v104, v104, v104 row_ror:4 row_mask:0xf bank_mask:0xf
    v_add_f32_dpp v105, v105, v105 row_ror:4 row_mask:0xf bank_mask:0xf
    v_add_f32_dpp v106, v106, v106 row_ror:4 row_mask:0xf bank_mask:0xf
    v_add_f32_dpp v107, v107, v107 row_ror:4 row_mask:0xf bank_mask:0xf
    ds_write_b128 v94, v[104:107] offset:0
    v_mfma_f32_16x16x32_bf16 v[116:119], a[176:179], v[136:139], 0
    v_mfma_f32_16x16x32_bf16 v[116:119], a[180:183], v[140:143], v[116:119]
    v_mfma_f32_16x16x32_bf16 v[116:119], a[184:187], v[144:147], v[116:119]
    v_mfma_f32_16x16x32_bf16 v[116:119], a[188:191], v[148:151], v[116:119]
    v_mul_f32 v108, v108, v52
    v_mul_f32 v109, v109, v52
    v_mul_f32 v110, v110, v52
    v_mul_f32 v111, v111, v52
    v_add_f32_dpp v108, v108, v108 row_ror:8 row_mask:0xf bank_mask:0xf
    v_add_f32_dpp v109, v109, v109 row_ror:8 row_mask:0xf bank_mask:0xf
    v_add_f32_dpp v110, v110, v110 row_ror:8 row_mask:0xf bank_mask:0xf
    v_add_f32_dpp v111, v111, v111 row_ror:8 row_mask:0xf bank_mask:0xf
    v_add_f32_dpp v108, v108, v108 row_ror:4 row_mask:0xf bank_mask:0xf
    v_add_f32_dpp v109, v109, v109 row_ror:4 row_mask:0xf bank_mask:0xf
    v_add_f32_dpp v110, v110, v110 row_ror:4 row_mask:0xf bank_mask:0xf
    v_add_f32_dpp v111, v111, v111 row_ror:4 row_mask:0xf bank_mask:0xf
    ds_write_b128 v94, v[108:111] offset:64
    v_mfma_f32_16x16x32_bf16 v[120:123], a[192:195], v[136:139], 0
    v_mfma_f32_16x16x32_bf16 v[120:123], a[196:199], v[140:143], v[120:123]
    v_mfma_f32_16x16x32_bf16 v[120:123], a[200:203], v[144:147], v[120:123]
    v_mfma_f32_16x16x32_bf16 v[120:123], a[204:207], v[148:151], v[120:123]
    v_mul_f32 v112, v112, v52
    v_mul_f32 v113, v113, v52
    v_mul_f32 v114, v114, v52
    v_mul_f32 v115, v115, v52
    v_add_f32_dpp v112, v112, v112 row_ror:8 row_mask:0xf bank_mask:0xf
    v_add_f32_dpp v113, v113, v113 row_ror:8 row_mask:0xf bank_mask:0xf
    v_add_f32_dpp v114, v114, v114 row_ror:8 row_mask:0xf bank_mask:0xf
    v_add_f32_dpp v115, v115, v115 row_ror:8 row_mask:0xf bank_mask:0xf
    v_add_f32_dpp v112, v112, v112 row_ror:4 row_mask:0xf bank_mask:0xf
    v_add_f32_dpp v113, v113, v113 row_ror:4 row_mask:0xf bank_mask:0xf
    v_add_f32_dpp v114, v114, v114 row_ror:4 row_mask:0xf bank_mask:0xf
    v_add_f32_dpp v115, v115, v115 row_ror:4 row_mask:0xf bank_mask:0xf
    ds_write_b128 v94, v[112:115] offset:128
    v_mfma_f32_16x16x32_bf16 v[124:127], a[208:211], v[136:139], 0
    v_mfma_f32_16x16x32_bf16 v[124:127], a[212:215], v[140:143], v[124:127]
    v_mfma_f32_16x16x32_bf16 v[124:127], a[216:219], v[144:147], v[124:127]
    v_mfma_f32_16x16x32_bf16 v[124:127], a[220:223], v[148:151], v[124:127]
    v_mul_f32 v116, v116, v52
    v_mul_f32 v117, v117, v52
    v_mul_f32 v118, v118, v52
    v_mul_f32 v119, v119, v52
    v_add_f32_dpp v116, v116, v116 row_ror:8 row_mask:0xf bank_mask:0xf
    v_add_f32_dpp v117, v117, v117 row_ror:8 row_mask:0xf bank_mask:0xf
    v_add_f32_dpp v118, v118, v118 row_ror:8 row_mask:0xf bank_mask:0xf
    v_add_f32_dpp v119, v119, v119 row_ror:8 row_mask:0xf bank_mask:0xf
    v_add_f32_dpp v116, v116, v116 row_ror:4 row_mask:0xf bank_mask:0xf
    v_add_f32_dpp v117, v117, v117 row_ror:4 row_mask:0xf bank_mask:0xf
    v_add_f32_dpp v118, v118, v118 row_ror:4 row_mask:0xf bank_mask:0xf
    v_add_f32_dpp v119, v119, v119 row_ror:4 row_mask:0xf bank_mask:0xf
    ds_write_b128 v94, v[116:119] offset:192
    v_mfma_f32_16x16x32_bf16 v[128:131], a[224:227], v[136:139], 0
    v_mfma_f32_16x16x32_bf16 v[128:131], a[228:231], v[140:143], v[128:131]
    v_mfma_f32_16x16x32_bf16 v[128:131], a[232:235], v[144:147], v[128:131]
    v_mfma_f32_16x16x32_bf16 v[128:131], a[236:239], v[148:151], v[128:131]
    v_mul_f32 v120, v120, v52
    v_mul_f32 v121, v121, v52
    v_mul_f32 v122, v122, v52
    v_mul_f32 v123, v123, v52
    v_add_f32_dpp v120, v120, v120 row_ror:8 row_mask:0xf bank_mask:0xf
    v_add_f32_dpp v121, v121, v121 row_ror:8 row_mask:0xf bank_mask:0xf
    v_add_f32_dpp v122, v122, v122 row_ror:8 row_mask:0xf bank_mask:0xf
    v_add_f32_dpp v123, v123, v123 row_ror:8 row_mask:0xf bank_mask:0xf
    v_add_f32_dpp v120, v120, v120 row_ror:4 row_mask:0xf bank_mask:0xf
    v_add_f32_dpp v121, v121, v121 row_ror:4 row_mask:0xf bank_mask:0xf
    v_add_f32_dpp v122, v122, v122 row_ror:4 row_mask:0xf bank_mask:0xf
    v_add_f32_dpp v123, v123, v123 row_ror:4 row_mask:0xf bank_mask:0xf
    ds_write_b128 v94, v[120:123] offset:256
    v_mfma_f32_16x16x32_bf16 v[132:135], a[240:243], v[136:139], 0
    v_mfma_f32_16x16x32_bf16 v[132:135], a[244:247], v[140:143], v[132:135]
    v_mfma_f32_16x16x32_bf16 v[132:135], a[248:251], v[144:147], v[132:135]
    v_mfma_f32_16x16x32_bf16 v[132:135], a[252:255], v[148:151], v[132:135]
    v_mul_f32 v124, v124, v52
    v_mul_f32 v125, v125, v52
    v_mul_f32 v126, v126, v52
    v_mul_f32 v127, v127, v52
    v_add_f32_dpp v124, v124, v124 row_ror:8 row_mask:0xf bank_mask:0xf
    v_add_f32_dpp v125, v125, v125 row_ror:8 row_mask:0xf bank_mask:0xf
    v_add_f32_dpp v126, v126, v126 row_ror:8 row_mask:0xf bank_mask:0xf
    v_add_f32_dpp v127, v127, v127 row_ror:8 row_mask:0xf bank_mask:0xf
    v_add_f32_dpp v124, v124, v124 row_ror:4 row_mask:0xf bank_mask:0xf
    v_add_f32_dpp v125, v125, v125 row_ror:4 row_mask:0xf bank_mask:0xf
    v_add_f32_dpp v126, v126, v126 row_ror:4 row_mask:0xf bank_mask:0xf
    v_add_f32_dpp v127, v127, v127 row_ror:4 row_mask:0xf bank_mask:0xf
    ds_write_b128 v94, v[124:127] offset:320
    v_mul_f32 v128, v128, v52
    v_mul_f32 v129, v129, v52
    v_mul_f32 v130, v130, v52
    v_mul_f32 v131, v131, v52
    v_add_f32_dpp v128, v128, v128 row_ror:8 row_mask:0xf bank_mask:0xf
    v_add_f32_dpp v129, v129, v129 row_ror:8 row_mask:0xf bank_mask:0xf
    v_add_f32_dpp v130, v130, v130 row_ror:8 row_mask:0xf bank_mask:0xf
    v_add_f32_dpp v131, v131, v131 row_ror:8 row_mask:0xf bank_mask:0xf
    v_add_f32_dpp v128, v128, v128 row_ror:4 row_mask:0xf bank_mask:0xf
    v_add_f32_dpp v129, v129, v129 row_ror:4 row_mask:0xf bank_mask:0xf
    v_add_f32_dpp v130, v130, v130 row_ror:4 row_mask:0xf bank_mask:0xf
    v_add_f32_dpp v131, v131, v131 row_ror:4 row_mask:0xf bank_mask:0xf
    ds_write_b128 v94, v[128:131] offset:384
    v_mul_f32 v132, v132, v52
    v_mul_f32 v133, v133, v52
    v_mul_f32 v134, v134, v52
    v_mul_f32 v135, v135, v52
    v_add_f32_dpp v132, v132, v132 row_ror:8 row_mask:0xf bank_mask:0xf
    v_add_f32_dpp v133, v133, v133 row_ror:8 row_mask:0xf bank_mask:0xf
    v_add_f32_dpp v134, v134, v134 row_ror:8 row_mask:0xf bank_mask:0xf
    v_add_f32_dpp v135, v135, v135 row_ror:8 row_mask:0xf bank_mask:0xf
    v_add_f32_dpp v132, v132, v132 row_ror:4 row_mask:0xf bank_mask:0xf
    v_add_f32_dpp v133, v133, v133 row_ror:4 row_mask:0xf bank_mask:0xf
    v_add_f32_dpp v134, v134, v134 row_ror:4 row_mask:0xf bank_mask:0xf
    v_add_f32_dpp v135, v135, v135 row_ror:4 row_mask:0xf bank_mask:0xf
    ds_write_b128 v94, v[132:135] offset:448
    s_waitcnt lgkmcnt(0)
    s_barrier
    ds_read_b128 v[136:139], v102 offset:0
    ds_read_b128 v[140:143], v102 offset:8192
    ds_read_b128 v[144:147], v102 offset:16384
    ds_read_b128 v[148:151], v102 offset:24576
    s_waitcnt lgkmcnt(0)
    v_add_f32 v136, v136, v140
    v_add_f32 v144, v144, v148
    v_add_f32 v137, v137, v141
    v_add_f32 v145, v145, v149
    v_add_f32 v138, v138, v142
    v_add_f32 v146, v146, v150
    v_add_f32 v139, v139, v143
    v_add_f32 v147, v147, v151
    v_add_f32 v136, v136, v144
    v_add_f32 v137, v137, v145
    v_add_f32 v138, v138, v146
    v_add_f32 v139, v139, v147
    s_mov_b32 s38, 0xffff0000
    v_cvt_pk_bf16_f32 v136, v136, v136
    v_cvt_pk_bf16_f32 v137, v137, v137
    v_cvt_pk_bf16_f32 v138, v138, v138
    v_cvt_pk_bf16_f32 v139, v139, v139
    v_and_or_b32 v136, v136, s38, v8
    v_and_or_b32 v137, v137, s38, v8
    v_and_or_b32 v138, v138, s38, v8
    v_and_or_b32 v139, v139, s38, v8
    s_lshl_b32 s38, s32, 11
    s_add_u32 s36, s38, 196608
    s_lshl_b32 s38, s34, 9
    s_add_u32 s36, s38, s36
    s_mov_b32 exec_lo, 0xffffffff
    s_mov_b32 exec_hi, 0x0
    buffer_store_dwordx4 v[136:139], v34, s[48:51], s36 offen sc1
    s_mov_b64 exec, -1
    v_xor_b32 v224, s35, v136
    v_xor_b32 v225, s35, v137
    v_xor_b32 v226, s35, v138
    v_xor_b32 v227, s35, v139
    v_lshlrev_b32 v4, 11, v2
    v_bfe_u32 v5, v1, 2, 2
    v_lshl_add_u32 v4, v5, 8, v4
    v_bfe_u32 v5, v1, 2, 2
    v_lshl_add_u32 v4, v5, 6, v4
    v_bfe_u32 v5, v1, 4, 1
    v_lshl_add_u32 v4, v5, 5, v4
    v_bfe_u32 v5, v1, 1, 1
    v_lshl_add_u32 v4, v5, 4, v4
    v_bfe_u32 v5, v1, 0, 1
    v_lshl_add_u32 v4, v5, 3, v4
    s_lshl_b32 s38, s34, 6
    s_add_u32 s38, s38, 98304
    v_xor_b32 v24, s38, v4
    v_xor_b32 v25, 16, v24
    v_xor_b32 v26, 32, v24
    v_xor_b32 v27, 48, v24
    v_and_b32 v4, 3, v3
    v_lshrrev_b32 v5, 2, v3
    v_lshlrev_b32 v6, 4, v2
    v_add_u32 v6, 135168, v6
    s_movk_i32 s36, 320
    v_cmp_eq_u32 vcc, 0, v5
    s_nop 1
    v_cndmask_b32 v28, 4, v4, vcc
    v_mad_u32_u24 v28, v28, s36, v6
    v_cmp_eq_u32 vcc, 1, v5
    s_nop 1
    v_cndmask_b32 v29, 4, v4, vcc
    v_mad_u32_u24 v29, v29, s36, v6
    v_lshlrev_b32 v5, 2, v1
    v_add_u32 v5, 136448, v5
    v_mov_b32 v6, 0
    ds_write_b32 v5, v6
    v_cmp_ne_u32 vcc, s70, v64
    s_nop 0
    s_cmp_eq_u64 vcc, 0
    s_cselect_b32 s70, 1, 0
    s_mov_b32 s3, s34
    v_lshlrev_b32 v4, 2, v2
    v_xor_b32 v4, v4, v3
    v_xor_b32 v5, 0, v4
    v_lshlrev_b32 v5, 4, v5
    v_lshl_add_u32 v20, v2, 10, v5
    v_xor_b32 v5, 1, v4
    v_lshlrev_b32 v5, 4, v5
    v_lshl_add_u32 v21, v2, 10, v5
    v_add_u32 v21, 3072, v21
    v_xor_b32 v5, 2, v4
    v_lshlrev_b32 v5, 4, v5
    v_lshl_add_u32 v22, v2, 10, v5
    v_add_u32 v22, 6144, v22
    v_xor_b32 v5, 3, v4
    v_lshlrev_b32 v5, 4, v5
    v_lshl_add_u32 v23, v2, 10, v5
    v_add_u32 v23, 9216, v23
    s_lshl_b32 s38, s32, 15
    s_add_u32 s47, s38, 1048576
    s_lshl_b32 s38, s3, 13
    s_add_u32 s47, s38, s47
    v_lshlrev_b32 v6, 7, v2
    v_bfe_u32 v5, v3, 0, 3
    v_lshl_add_u32 v6, v5, 4, v6
    v_lshrrev_b32 v4, 3, v3
    v_and_b32 v7, 3, v3
    v_min_u32 v7, 2, v7
    v_lshl_add_u32 v7, v7, 1, v4
    v_add_u32 v5, 0, v4
    v_cmp_le_u32 vcc, s33, v5
    s_nop 1
    v_addc_co_u32 v5, vcc, 0, v5, vcc
    v_lshl_add_u32 v50, v5, 10, v6
    v_add_u32 v5, 2, v4
    v_cmp_le_u32 vcc, s33, v5
    s_nop 1
    v_addc_co_u32 v5, vcc, 0, v5, vcc
    v_lshl_add_u32 v51, v5, 10, v6
    v_add_u32 v5, 4, v4
    v_cmp_le_u32 vcc, s33, v5
    s_nop 1
    v_addc_co_u32 v5, vcc, 0, v5, vcc
    v_lshl_add_u32 v52, v5, 10, v6
    v_mov_b32 v5, v7
    v_mov_b32 v6, 512
    v_cmp_le_u32 vcc, s33, v5
    s_nop 1
    v_addc_co_u32 v5, vcc, 0, v5, vcc
    v_lshl_add_u32 v53, v5, 10, v6
    s_mul_i32 s38, s3, 320
    s_add_u32 s38, s38, 135168
    v_lshlrev_b32 v4, 6, v2
    v_lshl_add_u32 v4, v3, 1, v4
    v_add_u32 v31, s38, v4
    v_lshlrev_b32 v4, 7, v2
    v_lshl_add_u32 v4, v3, 4, v4
    v_mov_b32 v5, 512
    v_cmp_gt_u32 vcc, 8, v3
    s_nop 1
    v_cndmask_b32 v79, v5, v4, vcc
    s_mov_b32 s86, 0x88888888
    s_mov_b32 s87, 0x88888888
    v_mov_b32 v120, 0xff7f0000
    s_lshl_b32 s38, s32, 10
    s_add_u32 s37, s38, 65540
    s_lshr_b32 s38, s32, 3
    s_lshl_b32 s38, s38, 8
    s_add_u32 s37, s38, s37
    s_bitcmp1_b32 s90, 2
    s_cselect_b32 s36, 22, 18
    v_mov_b32 v5, 0
L_watch:
    buffer_load_dword v6, v5, s[48:51], s37 offen sc1
    s_waitcnt vmcnt(0)
    v_cmp_le_u32 vcc, s36, v6
    s_cbranch_vccnz L_seen
    s_sleep 4
    s_sub_u32 s84, s84, 1
    s_cmp_lg_u32 s84, 0
    s_cbranch_scc1 L_watch
    s_branch L_end
L_seen:
    s_lshl_b32 s39, s34, 13
    s_add_u32 s39, s39, 98304
    s_mov_b32 m0, s39
    s_nop 0
    buffer_load_dwordx4 v20, s[40:43], s44 offen offset:0 nt lds
    buffer_load_dwordx4 v21, s[40:43], s44 offen offset:1024 nt lds
    buffer_load_dwordx4 v22, s[40:43], s44 offen offset:2048 nt lds
    buffer_load_dwordx4 v23, s[40:43], s44 offen offset:3072 nt lds
    s_lshl_b32 s39, s34, 13
    s_add_u32 s39, s39, 102400
    s_mov_b32 m0, s39
    s_add_u32 s44, s44, 16384
    buffer_load_dwordx4 v20, s[40:43], s44 offen offset:0 nt lds
    buffer_load_dwordx4 v21, s[40:43], s44 offen offset:1024 nt lds
    buffer_load_dwordx4 v22, s[40:43], s44 offen offset:2048 nt lds
    buffer_load_dwordx4 v23, s[40:43], s44 offen offset:3072 nt lds
    s_bitcmp1_b32 s90, 2
    s_cbranch_scc1 L_ctxok
    buffer_load_dwordx4 v[224:227], v54, s[48:51], s46 offen sc1
    s_add_u32 s37, s47, 6144
L_auxpoll:
    buffer_load_dwordx4 v[204:207], v53, s[48:51], s47 offen sc1
    buffer_load_dwordx4 v[192:195], v50, s[48:51], s47 offen sc1
    buffer_load_dwordx4 v[196:199], v51, s[48:51], s47 offen sc1
    buffer_load_dwordx4 v[200:203], v52, s[48:51], s47 offen sc1
    buffer_load_dwordx4 v[104:107], v79, s[48:51], s37 offen sc1
    s_waitcnt vmcnt(0)
    v_xor_b32 v104, s35, v104
    v_xor_b32 v105, s35, v105
    v_xor_b32 v106, s35, v106
    v_xor_b32 v107, s35, v107
    v_xor_b32 v192, s35, v192
    v_xor_b32 v193, s35, v193
    v_xor_b32 v194, s35, v194
    v_xor_b32 v195, s35, v195
    v_xor_b32 v196, s35, v196
    v_xor_b32 v197, s35, v197
    v_xor_b32 v198, s35, v198
    v_xor_b32 v199, s35, v199
    v_xor_b32 v200, s35, v200
    v_xor_b32 v201, s35, v201
    v_xor_b32 v202, s35, v202
    v_xor_b32 v203, s35, v203
    v_xor_b32 v204, s35, v204
    v_xor_b32 v205, s35, v205
    v_xor_b32 v206, s35, v206
    v_xor_b32 v207, s35, v207
    v_or_b32 v4, v104, v105
    v_or3_b32 v4, v4, v106, v107
    v_or3_b32 v4, v4, v192, v193
    v_or3_b32 v4, v4, v194, v195
    v_or3_b32 v4, v4, v196, v197
    v_or3_b32 v4, v4, v198, v199
    v_or3_b32 v4, v4, v200, v201
    v_or3_b32 v4, v4, v202, v203
    v_or3_b32 v4, v4, v204, v205
    v_or3_b32 v4, v4, v206, v207
    v_and_b32 v4, 0xff, v4
    v_cmp_ne_u32 vcc, 0, v4
    v_add_f32 v123, v104, v106
    v_add_f32 v122, v204, v206
    v_mov_b32_dpp v121, v105 row_newbcast:8 row_mask:0xf bank_mask:0xf
    v_mov_b32_dpp v120, v123 row_newbcast:8 row_mask:0xf bank_mask:0x3
    s_cbranch_vccz L_hop1ok
    s_sub_u32 s84, s84, 1
    s_cmp_lg_u32 s84, 0
    s_cbranch_scc1 L_auxpoll
    s_branch L_end
.section .rodata,"a"
.p2align 6
.amdhsa_kernel concat_heads__compressed_kv_cla__mha_block_cached__decode_kernel
  .amdhsa_next_free_vgpr 512
  .amdhsa_next_free_sgpr 102
  .amdhsa_accum_offset 256
  .amdhsa_group_segment_fixed_size 0
  .amdhsa_kernarg_size 112
  .amdhsa_user_sgpr_count 2
  .amdhsa_user_sgpr_kernarg_segment_ptr 1
  .amdhsa_system_sgpr_workgroup_id_x 1
.end_amdhsa_kernel
```

```asm
; @launch grid=(256,1,1) block=(256,1,1) lds=163840
    .amdgcn_target "amdgcn-amd-amdhsa--gfx950"
    .text
    .globl concat_heads__compressed_kv_cla__mha_block_cached__decode_kernel
    .p2align 8
    .type concat_heads__compressed_kv_cla__mha_block_cached__decode_kernel,@function
concat_heads__compressed_kv_cla__mha_block_cached__decode_kernel:
    s_cmp_ge_u32 s2, 256
    s_cbranch_scc1 L_end
    s_load_dwordx16 s[4:19], s[0:1], 0
    s_load_dwordx8 s[20:27], s[0:1], 64
    s_load_dwordx4 s[28:31], s[0:1], 96
    v_lshrrev_b32 v4, 6, v0
    v_and_b32 v1, 63, v0
    v_readfirstlane_b32 s34, v4
    s_lshr_b32 s32, s2, 3
    s_sub_u32 s33, s2, s32
    s_sub_u32 s33, s33, 1
    s_and_b32 s33, s33, 7
    v_lshrrev_b32 v2, 4, v1
    v_and_b32 v3, 15, v1
    s_cmp_lt_u32 s33, 2
    s_cbranch_scc1 L_qp
    s_cmp_eq_u32 s33, 2
    s_cbranch_scc1 L_ql
    s_cmp_eq_u32 s33, 7
    s_cbranch_scc1 L_aux
    s_bfe_u32 s38, s2, 0x30000
    s_lshl_b32 s38, s38, 21
    s_add_u32 s36, s38, -393216
    s_lshr_b32 s38, s32, 3
    s_lshl_b32 s38, s38, 19
    s_add_u32 s36, s38, s36
    s_lshl_b32 s38, s33, 17
    s_add_u32 s36, s38, s36
    s_lshl_b32 s38, s34, 12
    s_add_u32 s36, s38, s36
    v_bfe_u32 v5, v1, 0, 5
    v_lshlrev_b32 v4, 7, v5
    v_lshrrev_b32 v5, 5, v1
    v_lshl_add_u32 v4, v5, 15, v4
    s_mov_b32 s42, 16777216
    s_mov_b32 s43, 0x20000
    s_waitcnt lgkmcnt(0)
    s_mov_b64 s[40:41], s[6:7]
    buffer_load_dword v20, v4, s[40:43], s36 offen
    s_add_u32 s36, s36, 16384
    buffer_load_dword v21, v4, s[40:43], s36 offen
    s_add_u32 s36, s36, 49152
    buffer_load_dword v22, v4, s[40:43], s36 offen
    s_add_u32 s36, s36, 16384
    buffer_load_dword v23, v4, s[40:43], s36 offen
    s_load_dword s35, s[30:31], 0
    s_mov_b32 s48, s30
    s_and_b32 s49, s31, 0xffff
    s_mov_b32 s50, 8388608
    s_mov_b32 s51, 0x20000
    s_mov_b32 s82, 0xffffff00
    s_mov_b32 s83, 0x3e0293ee
    s_mov_b32 s84, 8388608
    v_lshrrev_b32 v4, 2, v3
    v_and_b32 v5, 3, v3
    v_lshlrev_b32 v76, 8, v4
    v_lshlrev_b32 v126, 8, v2
    v_lshl_add_u32 v76, v2, 6, v76
    v_lshl_add_u32 v76, v5, 4, v76
    v_lshl_add_u32 v126, v3, 4, v126
    v_xor_b32 v77, 32768, v76
    v_xor_b32 v127, 32768, v126
    s_add_u32 s3, s34, s33
    s_and_b32 s3, s3, 3
    s_lshl_b32 s89, s3, 5
    s_add_u32 s89, s89, s32
    s_lshl_b32 s89, s89, 20
    s_mul_i32 s88, s32, 8
    s_mul_i32 s38, s3, 2
    s_add_u32 s88, s88, s38
    s_lshl_b32 s87, s33, 1
    s_mov_b32 s52, s18
    s_and_b32 s53, s19, 0xffff
    s_mov_b32 s54, 134217728
    s_mov_b32 s55, 0x20000
    s_mov_b32 s56, s20
    s_and_b32 s57, s21, 0xffff
    s_mov_b32 s58, 134217728
    s_mov_b32 s59, 0x20000
    v_and_b32 v4, 1, v1
    v_lshlrev_b32 v4, 4, v4
    v_mov_b32 v5, 0xffff
    v_lshlrev_b32 v4, v4, v5
    v_bfe_u32 v5, v1, 1, 2
    v_cmp_eq_u32 vcc, 0, v5
    s_nop 1
    v_cndmask_b32 v10, 0, v4, vcc
    v_cmp_eq_u32 vcc, 1, v5
    s_nop 1
    v_cndmask_b32 v11, 0, v4, vcc
    v_cmp_eq_u32 vcc, 2, v5
    s_nop 1
    v_cndmask_b32 v12, 0, v4, vcc
    v_cmp_eq_u32 vcc, 3, v5
    s_nop 1
    v_cndmask_b32 v13, 0, v4, vcc
    v_mov_b32 v120, 0xff7f0000
    v_mov_b32 v121, 0
    v_mov_b32 v18, 1
    v_mov_b32 v116, 0
    v_mov_b32 v117, 0
    v_mov_b32 v118, 0
    v_mov_b32 v119, 0
    v_lshlrev_b32 v0, 3, v1
    ds_write_b64 v0, v[116:117] offset:8192
    v_mov_b32 v0, 8192
    s_lshl_b32 s38, s32, 10
    s_add_u32 s96, s38, 65536
    s_lshr_b32 s38, s32, 3
    s_lshl_b32 s38, s38, 8
    s_add_u32 s96, s38, s96
    v_mov_b32 v9, s96
    s_lshl_b32 s38, s32, 15
    s_add_u32 s96, s38, 1048576
    s_lshl_b32 s38, s3, 13
    s_add_u32 s96, s38, s96
    s_lshl_b32 s38, s33, 10
    s_add_u32 s96, s38, s96
    v_and_b32 v5, 3, v3
    v_lshlrev_b32 v78, 7, v2
    v_lshl_add_u32 v78, v5, 5, v78
    s_lshl_b32 s38, s32, 12
    s_add_u32 s91, s38, 262144
    s_lshl_b32 s38, s3, 9
    s_add_u32 s91, s38, s91
    v_lshlrev_b32 v4, 7, v2
    v_lshl_add_u32 v4, v3, 4, v4
    v_mov_b32 v5, 512
    v_cmp_gt_u32 vcc, 8, v3
    s_nop 1
    v_cndmask_b32 v79, v5, v4, vcc
    s_add_u32 s39, s87, s88
    s_bfe_u32 s37, s39, 0x10000
    s_lshl_b32 s37, s37, 13
    s_add_u32 s85, s37, s89
    s_bfe_u32 s37, s39, 0x10001
    s_lshl_b32 s37, s37, 12
    s_add_u32 s85, s37, s85
    s_bfe_u32 s37, s39, 0x10002
    s_lshl_b32 s37, s37, 11
    s_add_u32 s85, s37, s85
    s_bfe_u32 s37, s39, 0x10003
    s_lshl_b32 s37, s37, 14
    s_add_u32 s85, s37, s85
    s_bfe_u32 s37, s39, 0x40004
    s_lshl_b32 s37, s37, 16
    s_add_u32 s85, s37, s85
    buffer_load_dwordx4 v[128:131], v76, s[52:55], s85 offen offset:0 nt
    buffer_load_dwordx4 v[132:135], v77, s[52:55], s85 offen offset:0 nt
    buffer_load_dwordx4 v[136:139], v76, s[52:55], s85 offen offset:1024 nt
    buffer_load_dwordx4 v[140:143], v77, s[52:55], s85 offen offset:1024 nt
    s_add_u32 s87, s87, 1
    s_add_u32 s39, s87, s88
    s_bfe_u32 s37, s39, 0x10000
    s_lshl_b32 s37, s37, 13
    s_add_u32 s85, s37, s89
    s_bfe_u32 s37, s39, 0x10001
    s_lshl_b32 s37, s37, 12
    s_add_u32 s85, s37, s85
    s_bfe_u32 s37, s39, 0x10002
    s_lshl_b32 s37, s37, 11
    s_add_u32 s85, s37, s85
    s_bfe_u32 s37, s39, 0x10003
    s_lshl_b32 s37, s37, 14
    s_add_u32 s85, s37, s85
    s_bfe_u32 s37, s39, 0x40004
    s_lshl_b32 s37, s37, 16
    s_add_u32 s85, s37, s85
    buffer_load_dwordx4 v[144:147], v76, s[52:55], s85 offen offset:0 nt
    buffer_load_dwordx4 v[148:151], v77, s[52:55], s85 offen offset:0 nt
    buffer_load_dwordx4 v[152:155], v76, s[52:55], s85 offen offset:1024 nt
    s_waitcnt lgkmcnt(0)
    s_add_u32 s35, s35, 0x5b
    s_and_b32 s35, s35, 0xff
    v_mov_b32 v8, s35
    s_barrier
    s_waitcnt vmcnt(6)
    buffer_load_dwordx4 v[156:159], v77, s[52:55], s85 offen offset:1024 nt
    s_add_u32 s87, s87, 13
    s_add_u32 s39, s87, s88
    s_bfe_u32 s37, s39, 0x10000
    s_lshl_b32 s37, s37, 13
    s_add_u32 s85, s37, s89
    s_bfe_u32 s37, s39, 0x10001
    s_lshl_b32 s37, s37, 12
    s_add_u32 s85, s37, s85
    s_bfe_u32 s37, s39, 0x10002
    s_lshl_b32 s37, s37, 11
    s_add_u32 s85, s37, s85
    s_bfe_u32 s37, s39, 0x10003
    s_lshl_b32 s37, s37, 14
    s_add_u32 s85, s37, s85
    s_bfe_u32 s37, s39, 0x40004
    s_lshl_b32 s37, s37, 16
    s_add_u32 s85, s37, s85
    s_waitcnt vmcnt(6)
    buffer_load_dwordx4 v[160:163], v76, s[52:55], s85 offen offset:0 nt
    s_waitcnt vmcnt(6)
    buffer_load_dwordx4 v[164:167], v77, s[52:55], s85 offen offset:0 nt
    s_waitcnt vmcnt(6)
    buffer_load_dwordx4 v[168:171], v76, s[52:55], s85 offen offset:1024 nt
    s_waitcnt vmcnt(6)
    buffer_load_dwordx4 v[172:175], v77, s[52:55], s85 offen offset:1024 nt
    s_add_u32 s87, s87, 1
    s_add_u32 s39, s87, s88
    s_bfe_u32 s37, s39, 0x10000
    s_lshl_b32 s37, s37, 13
    s_add_u32 s85, s37, s89
    s_bfe_u32 s37, s39, 0x10001
    s_lshl_b32 s37, s37, 12
    s_add_u32 s85, s37, s85
    s_bfe_u32 s37, s39, 0x10002
    s_lshl_b32 s37, s37, 11
    s_add_u32 s85, s37, s85
    s_bfe_u32 s37, s39, 0x10003
    s_lshl_b32 s37, s37, 14
    s_add_u32 s85, s37, s85
    s_bfe_u32 s37, s39, 0x40004
    s_lshl_b32 s37, s37, 16
    s_add_u32 s85, s37, s85
    s_waitcnt vmcnt(6)
    buffer_load_dwordx4 v[176:179], v76, s[52:55], s85 offen offset:0 nt
    s_waitcnt vmcnt(6)
    buffer_load_dwordx4 v[180:183], v77, s[52:55], s85 offen offset:0 nt
    s_waitcnt vmcnt(6)
    buffer_load_dwordx4 v[184:187], v76, s[52:55], s85 offen offset:1024 nt
    s_waitcnt vmcnt(6)
    buffer_load_dwordx4 v[188:191], v77, s[52:55], s85 offen offset:1024 nt
    s_add_u32 s87, s87, 13
    s_add_u32 s39, s87, s88
    s_bfe_u32 s37, s39, 0x10000
    s_lshl_b32 s37, s37, 13
    s_add_u32 s85, s37, s89
    s_bfe_u32 s37, s39, 0x10001
    s_lshl_b32 s37, s37, 12
    s_add_u32 s85, s37, s85
    s_bfe_u32 s37, s39, 0x10002
    s_lshl_b32 s37, s37, 11
    s_add_u32 s85, s37, s85
    s_bfe_u32 s37, s39, 0x10003
    s_lshl_b32 s37, s37, 14
    s_add_u32 s85, s37, s85
    s_bfe_u32 s37, s39, 0x40004
    s_lshl_b32 s37, s37, 16
    s_add_u32 s85, s37, s85
    s_waitcnt vmcnt(6)
    buffer_load_dwordx4 v[192:195], v76, s[52:55], s85 offen offset:0 nt
    s_waitcnt vmcnt(6)
    buffer_load_dwordx4 v[196:199], v77, s[52:55], s85 offen offset:0 nt
    s_waitcnt vmcnt(6)
    buffer_load_dwordx4 v[200:203], v76, s[52:55], s85 offen offset:1024 nt
    s_waitcnt vmcnt(6)
    buffer_load_dwordx4 v[204:207], v77, s[52:55], s85 offen offset:1024 nt
    s_add_u32 s87, s87, 1
    s_add_u32 s39, s87, s88
    s_bfe_u32 s37, s39, 0x10000
    s_lshl_b32 s37, s37, 13
    s_add_u32 s85, s37, s89
    s_bfe_u32 s37, s39, 0x10001
    s_lshl_b32 s37, s37, 12
    s_add_u32 s85, s37, s85
    s_bfe_u32 s37, s39, 0x10002
    s_lshl_b32 s37, s37, 11
    s_add_u32 s85, s37, s85
    s_bfe_u32 s37, s39, 0x10003
    s_lshl_b32 s37, s37, 14
    s_add_u32 s85, s37, s85
    s_bfe_u32 s37, s39, 0x40004
    s_lshl_b32 s37, s37, 16
    s_add_u32 s85, s37, s85
    s_waitcnt vmcnt(6)
    buffer_load_dwordx4 v[208:211], v76, s[52:55], s85 offen offset:0 nt
    s_waitcnt vmcnt(6)
    buffer_load_dwordx4 v[212:215], v77, s[52:55], s85 offen offset:0 nt
    s_waitcnt vmcnt(6)
    buffer_load_dwordx4 v[216:219], v76, s[52:55], s85 offen offset:1024 nt
    s_waitcnt vmcnt(6)
    buffer_load_dwordx4 v[220:223], v77, s[52:55], s85 offen offset:1024 nt
    s_add_u32 s87, s87, 13
    s_add_u32 s39, s87, s88
    s_bfe_u32 s37, s39, 0x10000
    s_lshl_b32 s37, s37, 13
    s_add_u32 s85, s37, s89
    s_bfe_u32 s37, s39, 0x10001
    s_lshl_b32 s37, s37, 12
    s_add_u32 s85, s37, s85
    s_bfe_u32 s37, s39, 0x10002
    s_lshl_b32 s37, s37, 11
    s_add_u32 s85, s37, s85
    s_bfe_u32 s37, s39, 0x10003
    s_lshl_b32 s37, s37, 14
    s_add_u32 s85, s37, s85
    s_bfe_u32 s37, s39, 0x40004
    s_lshl_b32 s37, s37, 16
    s_add_u32 s85, s37, s85
    s_waitcnt vmcnt(6)
    buffer_load_dwordx4 v[224:227], v76, s[52:55], s85 offen offset:0 nt
    s_waitcnt vmcnt(6)
    buffer_load_dwordx4 v[228:231], v77, s[52:55], s85 offen offset:0 nt
    s_waitcnt vmcnt(6)
    buffer_load_dwordx4 v[232:235], v76, s[52:55], s85 offen offset:1024 nt
    s_waitcnt vmcnt(6)
    buffer_load_dwordx4 v[236:239], v77, s[52:55], s85 offen offset:1024 nt
    s_add_u32 s87, s87, 1
    s_add_u32 s39, s87, s88
    s_bfe_u32 s37, s39, 0x10000
    s_lshl_b32 s37, s37, 13
    s_add_u32 s85, s37, s89
    s_bfe_u32 s37, s39, 0x10001
    s_lshl_b32 s37, s37, 12
    s_add_u32 s85, s37, s85
    s_bfe_u32 s37, s39, 0x10002
    s_lshl_b32 s37, s37, 11
    s_add_u32 s85, s37, s85
    s_bfe_u32 s37, s39, 0x10003
    s_lshl_b32 s37, s37, 14
    s_add_u32 s85, s37, s85
    s_bfe_u32 s37, s39, 0x40004
    s_lshl_b32 s37, s37, 16
    s_add_u32 s85, s37, s85
    s_waitcnt vmcnt(6)
    buffer_load_dwordx4 v[240:243], v76, s[52:55], s85 offen offset:0 nt
    s_waitcnt vmcnt(6)
    buffer_load_dwordx4 v[244:247], v77, s[52:55], s85 offen offset:0 nt
    s_waitcnt vmcnt(6)
    buffer_load_dwordx4 v[248:251], v76, s[52:55], s85 offen offset:1024 nt
    s_waitcnt vmcnt(6)
    buffer_load_dwordx4 v[252:255], v77, s[52:55], s85 offen offset:1024 nt
    s_add_u32 s87, s87, 13
    s_add_u32 s39, s87, s88
    s_bfe_u32 s37, s39, 0x10000
    s_lshl_b32 s37, s37, 13
    s_add_u32 s85, s37, s89
    s_bfe_u32 s37, s39, 0x10001
    s_lshl_b32 s37, s37, 12
    s_add_u32 s85, s37, s85
    s_bfe_u32 s37, s39, 0x10002
    s_lshl_b32 s37, s37, 11
    s_add_u32 s85, s37, s85
    s_bfe_u32 s37, s39, 0x10003
    s_lshl_b32 s37, s37, 14
    s_add_u32 s85, s37, s85
    s_bfe_u32 s37, s39, 0x40004
    s_lshl_b32 s37, s37, 16
    s_add_u32 s85, s37, s85
    s_waitcnt vmcnt(6)
    buffer_load_dwordx4 a[0:3], v76, s[52:55], s85 offen offset:0 nt
    s_waitcnt vmcnt(6)
    buffer_load_dwordx4 a[4:7], v77, s[52:55], s85 offen offset:0 nt
    s_waitcnt vmcnt(6)
    buffer_load_dwordx4 a[8:11], v76, s[52:55], s85 offen offset:1024 nt
    s_waitcnt vmcnt(6)
    buffer_load_dwordx4 a[12:15], v77, s[52:55], s85 offen offset:1024 nt
    s_add_u32 s87, s87, 1
    s_add_u32 s39, s87, s88
    s_bfe_u32 s37, s39, 0x10000
    s_lshl_b32 s37, s37, 13
    s_add_u32 s85, s37, s89
    s_bfe_u32 s37, s39, 0x10001
    s_lshl_b32 s37, s37, 12
    s_add_u32 s85, s37, s85
    s_bfe_u32 s37, s39, 0x10002
    s_lshl_b32 s37, s37, 11
    s_add_u32 s85, s37, s85
    s_bfe_u32 s37, s39, 0x10003
    s_lshl_b32 s37, s37, 14
    s_add_u32 s85, s37, s85
    s_bfe_u32 s37, s39, 0x40004
    s_lshl_b32 s37, s37, 16
    s_add_u32 s85, s37, s85
    s_waitcnt vmcnt(6)
    buffer_load_dwordx4 a[16:19], v76, s[52:55], s85 offen offset:0 nt
    s_waitcnt vmcnt(6)
    buffer_load_dwordx4 a[20:23], v77, s[52:55], s85 offen offset:0 nt
    s_waitcnt vmcnt(6)
    buffer_load_dwordx4 a[24:27], v76, s[52:55], s85 offen offset:1024 nt
    s_waitcnt vmcnt(6)
    buffer_load_dwordx4 a[28:31], v77, s[52:55], s85 offen offset:1024 nt
    s_add_u32 s87, s87, 13
    s_add_u32 s39, s87, s88
    s_bfe_u32 s37, s39, 0x10000
    s_lshl_b32 s37, s37, 13
    s_add_u32 s85, s37, s89
    s_bfe_u32 s37, s39, 0x10001
    s_lshl_b32 s37, s37, 12
    s_add_u32 s85, s37, s85
    s_bfe_u32 s37, s39, 0x10002
    s_lshl_b32 s37, s37, 11
    s_add_u32 s85, s37, s85
    s_bfe_u32 s37, s39, 0x10003
    s_lshl_b32 s37, s37, 14
    s_add_u32 s85, s37, s85
    s_bfe_u32 s37, s39, 0x40004
    s_lshl_b32 s37, s37, 16
    s_add_u32 s85, s37, s85
    s_waitcnt vmcnt(6)
    buffer_load_dwordx4 a[32:35], v76, s[52:55], s85 offen offset:0 nt
    s_waitcnt vmcnt(6)
    buffer_load_dwordx4 a[36:39], v77, s[52:55], s85 offen offset:0 nt
    s_waitcnt vmcnt(6)
    buffer_load_dwordx4 a[40:43], v76, s[52:55], s85 offen offset:1024 nt
    s_waitcnt vmcnt(6)
    buffer_load_dwordx4 a[44:47], v77, s[52:55], s85 offen offset:1024 nt
    s_add_u32 s87, s87, 1
    s_add_u32 s39, s87, s88
    s_bfe_u32 s37, s39, 0x10000
    s_lshl_b32 s37, s37, 13
    s_add_u32 s85, s37, s89
    s_bfe_u32 s37, s39, 0x10001
    s_lshl_b32 s37, s37, 12
    s_add_u32 s85, s37, s85
    s_bfe_u32 s37, s39, 0x10002
    s_lshl_b32 s37, s37, 11
    s_add_u32 s85, s37, s85
    s_bfe_u32 s37, s39, 0x10003
    s_lshl_b32 s37, s37, 14
    s_add_u32 s85, s37, s85
    s_bfe_u32 s37, s39, 0x40004
    s_lshl_b32 s37, s37, 16
    s_add_u32 s85, s37, s85
    s_waitcnt vmcnt(6)
    buffer_load_dwordx4 a[48:51], v76, s[52:55], s85 offen offset:0 nt
    s_waitcnt vmcnt(6)
    buffer_load_dwordx4 a[52:55], v77, s[52:55], s85 offen offset:0 nt
    buffer_load_dwordx4 v[68:71], v78, s[48:51], s91 offen offset:0 sc1
    buffer_load_dwordx4 v[72:75], v78, s[48:51], s91 offen offset:16 sc1
    s_waitcnt vmcnt(8)
    buffer_load_dwordx4 a[56:59], v76, s[52:55], s85 offen offset:1024 nt
    s_waitcnt vmcnt(8)
    buffer_load_dwordx4 a[60:63], v77, s[52:55], s85 offen offset:1024 nt
    s_add_u32 s87, s87, 13
    s_add_u32 s39, s87, s88
    s_bfe_u32 s37, s39, 0x10000
    s_lshl_b32 s37, s37, 13
    s_add_u32 s85, s37, s89
    s_bfe_u32 s37, s39, 0x10001
    s_lshl_b32 s37, s37, 12
    s_add_u32 s85, s37, s85
    s_bfe_u32 s37, s39, 0x10002
    s_lshl_b32 s37, s37, 11
    s_add_u32 s85, s37, s85
    s_bfe_u32 s37, s39, 0x10003
    s_lshl_b32 s37, s37, 14
    s_add_u32 s85, s37, s85
    s_bfe_u32 s37, s39, 0x40004
    s_lshl_b32 s37, s37, 16
    s_add_u32 s85, s37, s85
    s_waitcnt vmcnt(8)
    buffer_load_dwordx4 a[64:67], v76, s[52:55], s85 offen offset:0 nt
    s_waitcnt vmcnt(8)
    buffer_load_dwordx4 a[68:71], v77, s[52:55], s85 offen offset:0 nt
    s_waitcnt vmcnt(8)
    buffer_load_dwordx4 a[72:75], v76, s[52:55], s85 offen offset:1024 nt
    s_waitcnt vmcnt(8)
    buffer_load_dwordx4 a[76:79], v77, s[52:55], s85 offen offset:1024 nt
    s_add_u32 s87, s87, 1
    s_add_u32 s39, s87, s88
    s_bfe_u32 s37, s39, 0x10000
    s_lshl_b32 s37, s37, 13
    s_add_u32 s85, s37, s89
    s_bfe_u32 s37, s39, 0x10001
    s_lshl_b32 s37, s37, 12
    s_add_u32 s85, s37, s85
    s_bfe_u32 s37, s39, 0x10002
    s_lshl_b32 s37, s37, 11
    s_add_u32 s85, s37, s85
    s_bfe_u32 s37, s39, 0x10003
    s_lshl_b32 s37, s37, 14
    s_add_u32 s85, s37, s85
    s_bfe_u32 s37, s39, 0x40004
    s_lshl_b32 s37, s37, 16
    s_add_u32 s85, s37, s85
    s_waitcnt vmcnt(6)
L_qcheck_1:
    v_xor_b32 v68, s35, v68
    v_xor_b32 v69, s35, v69
    v_xor_b32 v70, s35, v70
    v_xor_b32 v71, s35, v71
    v_xor_b32 v72, s35, v72
    v_xor_b32 v73, s35, v73
    v_xor_b32 v74, s35, v74
    v_xor_b32 v75, s35, v75
    v_or_b32 v4, v68, v69
    v_or3_b32 v4, v4, v70, v71
    v_or3_b32 v4, v4, v72, v73
    v_or3_b32 v4, v4, v74, v75
    v_and_b32 v4, 0xff, v4
    v_cmp_ne_u32 vcc, 0, v4
    s_cbranch_vccz L_qok_2
    buffer_load_dwordx4 v[68:71], v78, s[48:51], s91 offen offset:0 sc1
    buffer_load_dwordx4 v[72:75], v78, s[48:51], s91 offen offset:16 sc1
    s_waitcnt vmcnt(0)
    s_sub_u32 s84, s84, 1
    s_cmp_lg_u32 s84, 0
    s_cbranch_scc1 L_qcheck_1
    s_branch L_end
L_qok_2:
    v_cvt_pk_bf16_f32 v68, v68, v69
    v_cvt_pk_bf16_f32 v69, v70, v71
    v_cvt_pk_bf16_f32 v70, v72, v73
    v_cvt_pk_bf16_f32 v71, v74, v75
    s_mov_b32 vcc_lo, 0xf000f
    s_mov_b32 vcc_hi, 0xf000f
    v_cndmask_b32 v80, 0, v68, vcc
    v_cndmask_b32 v81, 0, v69, vcc
    v_cndmask_b32 v82, 0, v70, vcc
    v_cndmask_b32 v83, 0, v71, vcc
    s_mov_b32 vcc_lo, 0xf000f0
    s_mov_b32 vcc_hi, 0xf000f0
    v_cndmask_b32 v84, 0, v68, vcc
    v_cndmask_b32 v85, 0, v69, vcc
    v_cndmask_b32 v86, 0, v70, vcc
    v_cndmask_b32 v87, 0, v71, vcc
    s_mov_b32 vcc_lo, 0xf000f00
    s_mov_b32 vcc_hi, 0xf000f00
    v_cndmask_b32 v88, 0, v68, vcc
    v_cndmask_b32 v89, 0, v69, vcc
    v_cndmask_b32 v90, 0, v70, vcc
    v_cndmask_b32 v91, 0, v71, vcc
    s_mov_b32 vcc_lo, 0xf000f000
    s_mov_b32 vcc_hi, 0xf000f000
    v_cndmask_b32 v92, 0, v68, vcc
    v_cndmask_b32 v93, 0, v69, vcc
    v_cndmask_b32 v94, 0, v70, vcc
    v_cndmask_b32 v95, 0, v71, vcc
    s_getreg_b32 s70, hwreg(HW_REG_XCC_ID, 0, 4)
    s_lshl_b32 s70, s70, 8
    s_or_b32 s70, s70, s35
    s_or_b32 s70, s70, 0x5e9d0000
    s_bfe_u32 s38, s2, 0x30000
    s_lshl_b32 s38, s38, 8
    s_add_u32 s69, s38, 32768
    s_lshl_b32 s38, s32, 2
    s_add_u32 s69, s38, s69
    s_lshl_b32 s38, s34, 24
    s_add_u32 s69, s38, s69
    v_mov_b32 v72, s69
    v_mov_b32 v73, s70
    s_mov_b64 exec, 1
    buffer_store_dword v73, v72, s[48:51], 0 offen sc1
    s_mov_b64 exec, -1
    v_mov_b32 v65, 0xff7f0000
    s_lshl_b32 s38, s34, 14
    s_add_u32 s38, s38, 16384
    v_lshl_add_u32 v64, v1, 2, s38
    buffer_load_dwordx4 a[80:83], v76, s[52:55], s85 offen offset:0 nt
    v_mfma_f32_16x16x32_bf16 v[112:115], v[128:131], v[80:83], 0
    v_mfma_f32_16x16x32_bf16 v[112:115], v[132:135], v[84:87], v[112:115]
    v_mfma_f32_16x16x32_bf16 v[112:115], v[136:139], v[88:91], v[112:115]
    s_waitcnt vmcnt(7)
    buffer_load_dwordx4 a[84:87], v77, s[52:55], s85 offen offset:0 nt
    v_mfma_f32_16x16x32_bf16 v[112:115], v[140:143], v[92:95], v[112:115]
    v_mfma_f32_16x16x32_bf16 v[96:99], v[144:147], v[80:83], 0
    v_mfma_f32_16x16x32_bf16 v[96:99], v[148:151], v[84:87], v[96:99]
    v_mfma_f32_16x16x32_bf16 v[96:99], v[152:155], v[88:91], v[96:99]
    s_nop 4
    v_mov_b32_dpp v122, v112 quad_perm:[0,0,0,0] row_mask:0xf bank_mask:0xf
    v_mov_b32_dpp v124, v114 quad_perm:[2,2,2,2] row_mask:0xf bank_mask:0xf
    s_nop 0
    v_add_f32_dpp v122, v113, v122 quad_perm:[1,1,1,1] row_mask:0xf bank_mask:0xf
    v_add_f32_dpp v124, v115, v124 quad_perm:[3,3,3,3] row_mask:0xf bank_mask:0xf
    v_add_f32 v122, v122, v124
    v_max_f32 v65, v65, v122
    ds_write_b32 v64, v122 offset:0
    s_waitcnt vmcnt(7)
    buffer_load_dwordx4 a[88:91], v76, s[52:55], s85 offen offset:1024 nt
    v_mfma_f32_16x16x32_bf16 v[96:99], v[156:159], v[92:95], v[96:99]
    v_mfma_f32_16x16x32_bf16 v[112:115], v[160:163], v[80:83], 0
    v_mfma_f32_16x16x32_bf16 v[112:115], v[164:167], v[84:87], v[112:115]
    s_waitcnt vmcnt(7)
    buffer_load_dwordx4 a[92:95], v77, s[52:55], s85 offen offset:1024 nt
    s_add_u32 s87, s87, 13
    s_add_u32 s39, s87, s88
    s_bfe_u32 s37, s39, 0x10000
    s_lshl_b32 s37, s37, 13
    s_add_u32 s85, s37, s89
    s_bfe_u32 s37, s39, 0x10001
    s_lshl_b32 s37, s37, 12
    s_add_u32 s85, s37, s85
    s_bfe_u32 s37, s39, 0x10002
    s_lshl_b32 s37, s37, 11
    s_add_u32 s85, s37, s85
    s_bfe_u32 s37, s39, 0x10003
    s_lshl_b32 s37, s37, 14
    s_add_u32 s85, s37, s85
    s_bfe_u32 s37, s39, 0x40004
    s_lshl_b32 s37, s37, 16
    s_add_u32 s85, s37, s85
    v_mfma_f32_16x16x32_bf16 v[112:115], v[168:171], v[88:91], v[112:115]
    v_mov_b32_dpp v122, v96 quad_perm:[0,0,0,0] row_mask:0xf bank_mask:0xf
    v_mov_b32_dpp v124, v98 quad_perm:[2,2,2,2] row_mask:0xf bank_mask:0xf
    s_nop 0
    v_add_f32_dpp v122, v97, v122 quad_perm:[1,1,1,1] row_mask:0xf bank_mask:0xf
    v_add_f32_dpp v124, v99, v124 quad_perm:[3,3,3,3] row_mask:0xf bank_mask:0xf
    v_add_f32 v122, v122, v124
    v_max_f32 v65, v65, v122
    ds_write_b32 v64, v122 offset:256
    v_mfma_f32_16x16x32_bf16 v[112:115], v[172:175], v[92:95], v[112:115]
    v_mfma_f32_16x16x32_bf16 v[96:99], v[176:179], v[80:83], 0
    v_mfma_f32_16x16x32_bf16 v[96:99], v[180:183], v[84:87], v[96:99]
    s_waitcnt vmcnt(7)
    buffer_load_dwordx4 a[96:99], v76, s[52:55], s85 offen offset:0 nt
    v_mfma_f32_16x16x32_bf16 v[96:99], v[184:187], v[88:91], v[96:99]
    s_nop 2
    v_mov_b32_dpp v122, v112 quad_perm:[0,0,0,0] row_mask:0xf bank_mask:0xf
    v_mov_b32_dpp v124, v114 quad_perm:[2,2,2,2] row_mask:0xf bank_mask:0xf
    s_nop 0
    v_add_f32_dpp v122, v113, v122 quad_perm:[1,1,1,1] row_mask:0xf bank_mask:0xf
    v_add_f32_dpp v124, v115, v124 quad_perm:[3,3,3,3] row_mask:0xf bank_mask:0xf
    v_add_f32 v122, v122, v124
    v_max_f32 v65, v65, v122
    ds_write_b32 v64, v122 offset:512
    v_mfma_f32_16x16x32_bf16 v[96:99], v[188:191], v[92:95], v[96:99]
    v_mfma_f32_16x16x32_bf16 v[112:115], v[192:195], v[80:83], 0
    s_waitcnt vmcnt(7)
    buffer_load_dwordx4 a[100:103], v77, s[52:55], s85 offen offset:0 nt
    v_mfma_f32_16x16x32_bf16 v[112:115], v[196:199], v[84:87], v[112:115]
    v_mfma_f32_16x16x32_bf16 v[112:115], v[200:203], v[88:91], v[112:115]
    s_nop 2
    v_mov_b32_dpp v122, v96 quad_perm:[0,0,0,0] row_mask:0xf bank_mask:0xf
    v_mov_b32_dpp v124, v98 quad_perm:[2,2,2,2] row_mask:0xf bank_mask:0xf
    s_nop 0
    v_add_f32_dpp v122, v97, v122 quad_perm:[1,1,1,1] row_mask:0xf bank_mask:0xf
    v_add_f32_dpp v124, v99, v124 quad_perm:[3,3,3,3] row_mask:0xf bank_mask:0xf
    v_add_f32 v122, v122, v124
    v_max_f32 v65, v65, v122
    ds_write_b32 v64, v122 offset:768
    v_mfma_f32_16x16x32_bf16 v[112:115], v[204:207], v[92:95], v[112:115]
    v_mfma_f32_16x16x32_bf16 v[96:99], v[208:211], v[80:83], 0
    s_waitcnt vmcnt(7)
    buffer_load_dwordx4 a[104:107], v76, s[52:55], s85 offen offset:1024 nt
    v_mfma_f32_16x16x32_bf16 v[96:99], v[212:215], v[84:87], v[96:99]
    v_mfma_f32_16x16x32_bf16 v[96:99], v[216:219], v[88:91], v[96:99]
    s_nop 2
    v_mov_b32_dpp v122, v112 quad_perm:[0,0,0,0] row_mask:0xf bank_mask:0xf
    v_mov_b32_dpp v124, v114 quad_perm:[2,2,2,2] row_mask:0xf bank_mask:0xf
    s_nop 0
    v_add_f32_dpp v122, v113, v122 quad_perm:[1,1,1,1] row_mask:0xf bank_mask:0xf
    v_add_f32_dpp v124, v115, v124 quad_perm:[3,3,3,3] row_mask:0xf bank_mask:0xf
    v_add_f32 v122, v122, v124
    v_max_f32 v65, v65, v122
    ds_write_b32 v64, v122 offset:1024
    v_mfma_f32_16x16x32_bf16 v[96:99], v[220:223], v[92:95], v[96:99]
    s_waitcnt vmcnt(6)
    buffer_load_dwordx4 a[108:111], v77, s[52:55], s85 offen offset:1024 nt
    s_add_u32 s87, s87, 1
    s_add_u32 s39, s87, s88
    s_bfe_u32 s37, s39, 0x10000
    s_lshl_b32 s37, s37, 13
    s_add_u32 s85, s37, s89
    s_bfe_u32 s37, s39, 0x10001
    s_lshl_b32 s37, s37, 12
    s_add_u32 s85, s37, s85
    s_bfe_u32 s37, s39, 0x10002
    s_lshl_b32 s37, s37, 11
    s_add_u32 s85, s37, s85
    s_bfe_u32 s37, s39, 0x10003
    s_lshl_b32 s37, s37, 14
    s_add_u32 s85, s37, s85
    s_bfe_u32 s37, s39, 0x40004
    s_lshl_b32 s37, s37, 16
    s_add_u32 s85, s37, s85
    v_mfma_f32_16x16x32_bf16 v[112:115], v[224:227], v[80:83], 0
    v_mfma_f32_16x16x32_bf16 v[112:115], v[228:231], v[84:87], v[112:115]
    v_mfma_f32_16x16x32_bf16 v[112:115], v[232:235], v[88:91], v[112:115]
    v_mov_b32_dpp v122, v96 quad_perm:[0,0,0,0] row_mask:0xf bank_mask:0xf
    v_mov_b32_dpp v124, v98 quad_perm:[2,2,2,2] row_mask:0xf bank_mask:0xf
    s_nop 0
    v_add_f32_dpp v122, v97, v122 quad_perm:[1,1,1,1] row_mask:0xf bank_mask:0xf
    v_add_f32_dpp v124, v99, v124 quad_perm:[3,3,3,3] row_mask:0xf bank_mask:0xf
    v_add_f32 v122, v122, v124
    v_max_f32 v65, v65, v122
    ds_write_b32 v64, v122 offset:1280
    v_mfma_f32_16x16x32_bf16 v[112:115], v[236:239], v[92:95], v[112:115]
    s_waitcnt vmcnt(6)
    buffer_load_dwordx4 a[112:115], v76, s[52:55], s85 offen offset:0 nt
    v_mfma_f32_16x16x32_bf16 v[96:99], v[240:243], v[80:83], 0
    v_mfma_f32_16x16x32_bf16 v[96:99], v[244:247], v[84:87], v[96:99]
    v_mfma_f32_16x16x32_bf16 v[96:99], v[248:251], v[88:91], v[96:99]
    s_nop 2
    v_mov_b32_dpp v122, v112 quad_perm:[0,0,0,0] row_mask:0xf bank_mask:0xf
    v_mov_b32_dpp v124, v114 quad_perm:[2,2,2,2] row_mask:0xf bank_mask:0xf
    s_nop 0
    v_add_f32_dpp v122, v113, v122 quad_perm:[1,1,1,1] row_mask:0xf bank_mask:0xf
    v_add_f32_dpp v124, v115, v124 quad_perm:[3,3,3,3] row_mask:0xf bank_mask:0xf
    v_add_f32 v122, v122, v124
    v_max_f32 v65, v65, v122
    ds_write_b32 v64, v122 offset:1536
    v_mfma_f32_16x16x32_bf16 v[96:99], v[252:255], v[92:95], v[96:99]
    s_waitcnt vmcnt(6)
    buffer_load_dwordx4 a[116:119], v77, s[52:55], s85 offen offset:0 nt
    v_mfma_f32_16x16x32_bf16 v[112:115], a[0:3], v[80:83], 0
    v_mfma_f32_16x16x32_bf16 v[112:115], a[4:7], v[84:87], v[112:115]
    v_mfma_f32_16x16x32_bf16 v[112:115], a[8:11], v[88:91], v[112:115]
    s_nop 2
    v_mov_b32_dpp v122, v96 quad_perm:[0,0,0,0] row_mask:0xf bank_mask:0xf
    v_mov_b32_dpp v124, v98 quad_perm:[2,2,2,2] row_mask:0xf bank_mask:0xf
    s_nop 0
    v_add_f32_dpp v122, v97, v122 quad_perm:[1,1,1,1] row_mask:0xf bank_mask:0xf
    v_add_f32_dpp v124, v99, v124 quad_perm:[3,3,3,3] row_mask:0xf bank_mask:0xf
    v_add_f32 v122, v122, v124
    v_max_f32 v65, v65, v122
    ds_write_b32 v64, v122 offset:1792
    s_waitcnt vmcnt(6)
    buffer_load_dwordx4 a[120:123], v76, s[52:55], s85 offen offset:1024 nt
    v_mfma_f32_16x16x32_bf16 v[112:115], a[12:15], v[92:95], v[112:115]
    v_mfma_f32_16x16x32_bf16 v[96:99], a[16:19], v[80:83], 0
    v_mfma_f32_16x16x32_bf16 v[96:99], a[20:23], v[84:87], v[96:99]
    v_mfma_f32_16x16x32_bf16 v[96:99], a[24:27], v[88:91], v[96:99]
    s_nop 4
    v_mov_b32_dpp v122, v112 quad_perm:[0,0,0,0] row_mask:0xf bank_mask:0xf
    v_mov_b32_dpp v124, v114 quad_perm:[2,2,2,2] row_mask:0xf bank_mask:0xf
    s_nop 0
    v_add_f32_dpp v122, v113, v122 quad_perm:[1,1,1,1] row_mask:0xf bank_mask:0xf
    v_add_f32_dpp v124, v115, v124 quad_perm:[3,3,3,3] row_mask:0xf bank_mask:0xf
    v_add_f32 v122, v122, v124
    v_max_f32 v65, v65, v122
    ds_write_b32 v64, v122 offset:2048
    s_waitcnt vmcnt(6)
    buffer_load_dwordx4 a[124:127], v77, s[52:55], s85 offen offset:1024 nt
    s_add_u32 s87, s87, 13
    s_add_u32 s39, s87, s88
    s_bfe_u32 s37, s39, 0x10000
    s_lshl_b32 s37, s37, 13
    s_add_u32 s85, s37, s89
    s_bfe_u32 s37, s39, 0x10001
    s_lshl_b32 s37, s37, 12
    s_add_u32 s85, s37, s85
    s_bfe_u32 s37, s39, 0x10002
    s_lshl_b32 s37, s37, 11
    s_add_u32 s85, s37, s85
    s_bfe_u32 s37, s39, 0x10003
    s_lshl_b32 s37, s37, 14
    s_add_u32 s85, s37, s85
    s_bfe_u32 s37, s39, 0x40004
    s_lshl_b32 s37, s37, 16
    s_add_u32 s85, s37, s85
    v_mfma_f32_16x16x32_bf16 v[96:99], a[28:31], v[92:95], v[96:99]
    v_mfma_f32_16x16x32_bf16 v[112:115], a[32:35], v[80:83], 0
    s_bfe_u32 s38, s2, 0x20001
    s_lshl_b32 s38, s38, 0
    s_add_u32 s90, s38, 0
    s_bfe_u32 s38, s2, 0x10000
    s_lshl_b32 s38, s38, 2
    s_add_u32 s90, s38, s90
    s_and_b32 s36, s90, 3
    s_bitcmp0_b32 s90, 2
    s_cselect_b64 s[40:41], s[24:25], s[14:15]
    s_cselect_b32 s45, 262144, 0
    s_add_u32 s45, s45, 524288
    s_lshl_b32 s38, s36, 16
    s_add_u32 s71, s38, s45
    s_lshr_b32 s38, s32, 2
    s_lshl_b32 s38, s38, 13
    s_add_u32 s71, s38, s71
    s_bfe_u32 s38, s32, 0x20000
    s_lshl_b32 s38, s38, 6
    s_add_u32 s71, s38, s71
    s_mov_b32 s42, 4194304
    s_mov_b32 s43, 0x20000
    s_lshl_b32 s38, s32, 17
    s_add_u32 s44, s38, 0
    s_lshl_b32 s38, s34, 15
    s_add_u32 s44, s38, s44
    s_lshl_b32 s38, s36, 8
    s_add_u32 s44, s38, s44
    s_lshl_b32 s38, s36, 16
    s_add_u32 s45, s38, s45
    s_lshr_b32 s38, s34, 1
    s_lshl_b32 s38, s38, 15
    s_add_u32 s45, s38, s45
    s_lshl_b32 s38, s32, 8
    s_add_u32 s45, s38, s45
    s_bfe_u32 s38, s34, 0x10000
    s_lshl_b32 s38, s38, 7
    s_add_u32 s45, s38, s45
    s_lshl_b32 s38, s32, 11
    s_add_u32 s46, s38, 196608
    s_lshl_b32 s38, s34, 9
    s_add_u32 s46, s38, s46
    s_mov_b32 s72, s26
    s_and_b32 s73, s27, 0xffff
    s_mov_b32 s74, 8192
    s_mov_b32 s75, 0x20000
    v_mfma_f32_16x16x32_bf16 v[112:115], a[36:39], v[84:87], v[112:115]
    s_waitcnt vmcnt(5)
    buffer_load_dwordx4 v[128:131], v76, s[52:55], s85 offen offset:0 nt
    v_mfma_f32_16x16x32_bf16 v[112:115], a[40:43], v[88:91], v[112:115]
    v_mov_b32_dpp v122, v96 quad_perm:[0,0,0,0] row_mask:0xf bank_mask:0xf
    v_mov_b32_dpp v124, v98 quad_perm:[2,2,2,2] row_mask:0xf bank_mask:0xf
    s_nop 0
    v_add_f32_dpp v122, v97, v122 quad_perm:[1,1,1,1] row_mask:0xf bank_mask:0xf
    v_add_f32_dpp v124, v99, v124 quad_perm:[3,3,3,3] row_mask:0xf bank_mask:0xf
    v_add_f32 v122, v122, v124
    v_max_f32 v65, v65, v122
    ds_write_b32 v64, v122 offset:2304
    v_mfma_f32_16x16x32_bf16 v[112:115], a[44:47], v[92:95], v[112:115]
    v_mfma_f32_16x16x32_bf16 v[96:99], a[48:51], v[80:83], 0
    v_mfma_f32_16x16x32_bf16 v[96:99], a[52:55], v[84:87], v[96:99]
    s_waitcnt vmcnt(5)
    buffer_load_dwordx4 v[132:135], v77, s[52:55], s85 offen offset:0 nt
    v_mfma_f32_16x16x32_bf16 v[96:99], a[56:59], v[88:91], v[96:99]
    s_nop 2
    v_mov_b32_dpp v122, v112 quad_perm:[0,0,0,0] row_mask:0xf bank_mask:0xf
    v_mov_b32_dpp v124, v114 quad_perm:[2,2,2,2] row_mask:0xf bank_mask:0xf
    s_nop 0
    v_add_f32_dpp v122, v113, v122 quad_perm:[1,1,1,1] row_mask:0xf bank_mask:0xf
    v_add_f32_dpp v124, v115, v124 quad_perm:[3,3,3,3] row_mask:0xf bank_mask:0xf
    v_add_f32 v122, v122, v124
    v_max_f32 v65, v65, v122
    ds_write_b32 v64, v122 offset:2560
    v_lshlrev_b32 v4, 2, v2
    v_xor_b32 v4, v4, v3
    v_xor_b32 v5, 0, v4
    v_lshlrev_b32 v5, 4, v5
    v_lshl_add_u32 v20, v2, 10, v5
    v_xor_b32 v5, 1, v4
    v_lshlrev_b32 v5, 4, v5
    v_lshl_add_u32 v21, v2, 10, v5
    v_add_u32 v21, 3072, v21
    v_xor_b32 v5, 2, v4
    v_lshlrev_b32 v5, 4, v5
    v_lshl_add_u32 v22, v2, 10, v5
    v_add_u32 v22, 6144, v22
    v_xor_b32 v5, 3, v4
    v_lshlrev_b32 v5, 4, v5
    v_lshl_add_u32 v23, v2, 10, v5
    v_add_u32 v23, 9216, v23
    s_lshl_b32 s38, s32, 15
    s_add_u32 s47, s38, 1048576
    s_lshl_b32 s38, s3, 13
    s_add_u32 s47, s38, s47
    v_lshlrev_b32 v6, 7, v2
    v_bfe_u32 v5, v3, 0, 3
    v_lshl_add_u32 v6, v5, 4, v6
    v_lshrrev_b32 v4, 3, v3
    v_and_b32 v7, 3, v3
    v_min_u32 v7, 2, v7
    v_lshl_add_u32 v7, v7, 1, v4
    v_add_u32 v5, 0, v4
    v_cmp_le_u32 vcc, s33, v5
    s_nop 1
    v_addc_co_u32 v5, vcc, 0, v5, vcc
    v_lshl_add_u32 v50, v5, 10, v6
    v_add_u32 v5, 2, v4
    v_cmp_le_u32 vcc, s33, v5
    s_nop 1
    v_addc_co_u32 v5, vcc, 0, v5, vcc
    v_lshl_add_u32 v51, v5, 10, v6
    v_add_u32 v5, 4, v4
    v_cmp_le_u32 vcc, s33, v5
    s_nop 1
    v_addc_co_u32 v5, vcc, 0, v5, vcc
    v_lshl_add_u32 v52, v5, 10, v6
    v_mov_b32 v5, v7
    v_mov_b32 v6, 512
    v_cmp_le_u32 vcc, s33, v5
    s_nop 1
    v_addc_co_u32 v5, vcc, 0, v5, vcc
    v_lshl_add_u32 v53, v5, 10, v6
    s_mul_i32 s38, s3, 320
    s_add_u32 s38, s38, 135168
    v_lshlrev_b32 v4, 6, v2
    v_lshl_add_u32 v4, v3, 1, v4
    v_add_u32 v31, s38, v4
    v_mfma_f32_16x16x32_bf16 v[96:99], a[60:63], v[92:95], v[96:99]
    v_mfma_f32_16x16x32_bf16 v[112:115], a[64:67], v[80:83], 0
    s_waitcnt vmcnt(5)
    buffer_load_dwordx4 v[136:139], v76, s[52:55], s85 offen offset:1024 nt
    v_mfma_f32_16x16x32_bf16 v[112:115], a[68:71], v[84:87], v[112:115]
    v_mfma_f32_16x16x32_bf16 v[112:115], a[72:75], v[88:91], v[112:115]
    s_nop 2
    v_mov_b32_dpp v122, v96 quad_perm:[0,0,0,0] row_mask:0xf bank_mask:0xf
    v_mov_b32_dpp v124, v98 quad_perm:[2,2,2,2] row_mask:0xf bank_mask:0xf
    s_nop 0
    v_add_f32_dpp v122, v97, v122 quad_perm:[1,1,1,1] row_mask:0xf bank_mask:0xf
    v_add_f32_dpp v124, v99, v124 quad_perm:[3,3,3,3] row_mask:0xf bank_mask:0xf
    v_add_f32 v122, v122, v124
    v_max_f32 v65, v65, v122
    ds_write_b32 v64, v122 offset:2816
    v_mfma_f32_16x16x32_bf16 v[112:115], a[76:79], v[92:95], v[112:115]
    v_mfma_f32_16x16x32_bf16 v[96:99], a[80:83], v[80:83], 0
    v_lshlrev_b32 v4, 11, v2
    v_bfe_u32 v5, v1, 2, 2
    v_lshl_add_u32 v4, v5, 8, v4
    v_bfe_u32 v5, v1, 2, 2
    v_lshl_add_u32 v4, v5, 6, v4
    v_bfe_u32 v5, v1, 4, 1
    v_lshl_add_u32 v4, v5, 5, v4
    v_bfe_u32 v5, v1, 1, 1
    v_lshl_add_u32 v4, v5, 4, v4
    v_bfe_u32 v5, v1, 0, 1
    v_lshl_add_u32 v4, v5, 3, v4
    s_lshl_b32 s38, s34, 6
    s_add_u32 s38, s38, 98304
    v_xor_b32 v24, s38, v4
    v_xor_b32 v25, 16, v24
    v_xor_b32 v26, 32, v24
    v_xor_b32 v27, 48, v24
    v_and_b32 v4, 3, v3
    v_lshrrev_b32 v5, 2, v3
    v_lshlrev_b32 v6, 4, v2
    v_add_u32 v6, 135168, v6
    s_movk_i32 s36, 320
    v_cmp_eq_u32 vcc, 0, v5
    s_nop 1
    v_cndmask_b32 v28, 4, v4, vcc
    v_mad_u32_u24 v28, v28, s36, v6
    v_cmp_eq_u32 vcc, 1, v5
    s_nop 1
    v_cndmask_b32 v29, 4, v4, vcc
    v_mad_u32_u24 v29, v29, s36, v6
    v_lshlrev_b32 v5, 2, v1
    v_add_u32 v5, 136448, v5
    v_mov_b32 v6, 0
    ds_write_b32 v5, v6
    s_waitcnt vmcnt(5)
    buffer_load_dwordx4 v[140:143], v77, s[52:55], s85 offen offset:1024 nt
    s_add_u32 s87, s87, 1
    s_add_u32 s39, s87, s88
    s_bfe_u32 s37, s39, 0x10000
    s_lshl_b32 s37, s37, 13
    s_add_u32 s85, s37, s89
    s_bfe_u32 s37, s39, 0x10001
    s_lshl_b32 s37, s37, 12
    s_add_u32 s85, s37, s85
    s_bfe_u32 s37, s39, 0x10002
    s_lshl_b32 s37, s37, 11
    s_add_u32 s85, s37, s85
    s_bfe_u32 s37, s39, 0x10003
    s_lshl_b32 s37, s37, 14
    s_add_u32 s85, s37, s85
    s_bfe_u32 s37, s39, 0x40004
    s_lshl_b32 s37, s37, 16
    s_add_u32 s85, s37, s85
    v_mfma_f32_16x16x32_bf16 v[96:99], a[84:87], v[84:87], v[96:99]
    v_mfma_f32_16x16x32_bf16 v[96:99], a[88:91], v[88:91], v[96:99]
    v_mov_b32_dpp v122, v112 quad_perm:[0,0,0,0] row_mask:0xf bank_mask:0xf
    v_mov_b32_dpp v124, v114 quad_perm:[2,2,2,2] row_mask:0xf bank_mask:0xf
    s_nop 0
    v_add_f32_dpp v122, v113, v122 quad_perm:[1,1,1,1] row_mask:0xf bank_mask:0xf
    v_add_f32_dpp v124, v115, v124 quad_perm:[3,3,3,3] row_mask:0xf bank_mask:0xf
    v_add_f32 v122, v122, v124
    v_max_f32 v65, v65, v122
    ds_write_b32 v64, v122 offset:3072
    v_mfma_f32_16x16x32_bf16 v[96:99], a[92:95], v[92:95], v[96:99]
    s_waitcnt vmcnt(5)
    buffer_load_dwordx4 v[144:147], v76, s[52:55], s85 offen offset:0 nt
    v_mfma_f32_16x16x32_bf16 v[112:115], a[96:99], v[80:83], 0
    v_mfma_f32_16x16x32_bf16 v[112:115], a[100:103], v[84:87], v[112:115]
    v_mfma_f32_16x16x32_bf16 v[112:115], a[104:107], v[88:91], v[112:115]
    s_nop 2
    v_mov_b32_dpp v122, v96 quad_perm:[0,0,0,0] row_mask:0xf bank_mask:0xf
    v_mov_b32_dpp v124, v98 quad_perm:[2,2,2,2] row_mask:0xf bank_mask:0xf
    s_nop 0
    v_add_f32_dpp v122, v97, v122 quad_perm:[1,1,1,1] row_mask:0xf bank_mask:0xf
    v_add_f32_dpp v124, v99, v124 quad_perm:[3,3,3,3] row_mask:0xf bank_mask:0xf
    v_add_f32 v122, v122, v124
    v_max_f32 v65, v65, v122
    ds_write_b32 v64, v122 offset:3328
    v_lshlrev_b32 v30, 4, v3
    v_lshl_add_u32 v30, v2, 13, v30
    v_lshrrev_b32 v5, 2, v1
    v_lshlrev_b32 v32, 8, v5
    v_bfe_u32 v5, v1, 0, 2
    v_lshl_add_u32 v32, v5, 4, v32
    s_xor_b32 s37, s90, 4
    s_bfe_u32 s38, s37, 0x30000
    s_lshl_b32 s38, s38, 8
    s_add_u32 s36, s38, 0
    s_lshr_b32 s38, s32, 4
    s_lshl_b32 s38, s38, 7
    s_add_u32 s36, s38, s36
    s_bfe_u32 s38, s32, 0x20000
    s_lshl_b32 s38, s38, 5
    s_add_u32 s36, s38, s36
    s_bfe_u32 s38, s32, 0x20002
    s_lshl_b32 s38, s38, 3
    s_add_u32 s36, s38, s36
    v_bfe_u32 v5, v1, 0, 2
    v_lshlrev_b32 v33, 11, v5
    v_lshl_add_u32 v33, v2, 1, v33
    v_add_u32 v33, s36, v33
    v_and_b32 v5, 31, v1
    v_lshlrev_b32 v34, 4, v5
    s_mul_i32 s38, s34, 320
    s_add_u32 s38, s38, 135168
    v_lshl_add_u32 v35, v5, 3, s38
    s_bfe_u32 s38, s34, 0x10000
    s_lshl_b32 s38, s38, 12
    s_add_u32 s36, s38, s71
    s_lshr_b32 s38, s34, 1
    s_lshl_b32 s38, s38, 24
    s_add_u32 s36, s38, s36
    s_bitcmp1_b32 s90, 2
    s_cselect_b32 s46, s46, s36
    s_cselect_b64 vcc, -1, 0
    v_cndmask_b32 v54, v32, v34, vcc
    v_mfma_f32_16x16x32_bf16 v[112:115], a[108:111], v[92:95], v[112:115]
    s_waitcnt vmcnt(5)
    buffer_load_dwordx4 v[148:151], v77, s[52:55], s85 offen offset:0 nt
    v_mfma_f32_16x16x32_bf16 v[96:99], a[112:115], v[80:83], 0
    v_mfma_f32_16x16x32_bf16 v[96:99], a[116:119], v[84:87], v[96:99]
    v_mfma_f32_16x16x32_bf16 v[96:99], a[120:123], v[88:91], v[96:99]
    s_nop 2
    v_mov_b32_dpp v122, v112 quad_perm:[0,0,0,0] row_mask:0xf bank_mask:0xf
    v_mov_b32_dpp v124, v114 quad_perm:[2,2,2,2] row_mask:0xf bank_mask:0xf
    s_nop 0
    v_add_f32_dpp v122, v113, v122 quad_perm:[1,1,1,1] row_mask:0xf bank_mask:0xf
    v_add_f32_dpp v124, v115, v124 quad_perm:[3,3,3,3] row_mask:0xf bank_mask:0xf
    v_add_f32 v122, v122, v124
    v_max_f32 v65, v65, v122
    ds_write_b32 v64, v122 offset:3584
    v_mfma_f32_16x16x32_bf16 v[96:99], a[124:127], v[92:95], v[96:99]
    v_add_u32 v64, 3840, v64
    s_and_b32 s36, s32, 3
    s_sub_u32 s95, s36, 2
    s_cmp_ge_u32 s36, 2
    s_cselect_b32 s95, s95, 8
    s_cselect_b32 s94, 17, 16
    s_cmp_eq_u32 s95, s33
    s_cselect_b32 s63, 15, 16
    s_sub_u32 s97, s63, 8
    s_add_u32 s95, s95, 105
    s_mov_b32 s92, 1
    s_lshl_b32 s38, s32, 2
    s_add_u32 s80, s38, 0
    s_lshl_b32 s38, s3, 0
    s_add_u32 s80, s38, s80
    s_mul_i32 s80, s80, 2176
    s_add_u32 s80, s80, 3145728
    v_lshrrev_b32 v4, 2, v1
    v_lshlrev_b32 v55, 3, v4
    s_mov_b32 s66, 134217728
    s_mov_b32 s67, 0x20000
    s_mov_b64 s[64:65], s[52:53]
    v_mov_b32 v62, v76
    v_mov_b32 v63, v77
L_bloop:
    s_waitcnt vmcnt(5)
    buffer_load_dwordx4 v[152:155], v62, s[64:67], s85 offen offset:1024 nt
    v_mfma_f32_16x16x32_bf16 v[112:115], v[128:131], v[80:83], 0
    s_waitcnt vmcnt(5)
    buffer_load_dwordx4 v[156:159], v63, s[64:67], s85 offen offset:1024 nt
    v_mfma_f32_16x16x32_bf16 v[112:115], v[132:135], v[84:87], v[112:115]
    s_cmp_le_u32 s97, 2
    s_cbranch_scc1 L_rare_3
L_back_4:
    s_add_u32 s87, s87, 13
L_done_5:
    s_add_u32 s39, s87, s88
    s_bfe_u32 s37, s39, 0x10000
    s_lshl_b32 s37, s37, 13
    s_add_u32 s85, s37, s89
    s_bfe_u32 s37, s39, 0x10001
    s_lshl_b32 s37, s37, 12
    s_add_u32 s85, s37, s85
    s_bfe_u32 s37, s39, 0x10002
    s_lshl_b32 s37, s37, 11
    s_add_u32 s85, s37, s85
    s_bfe_u32 s37, s39, 0x10003
    s_lshl_b32 s37, s37, 14
    s_add_u32 s85, s37, s85
    s_bfe_u32 s37, s39, 0x40004
    s_lshl_b32 s37, s37, 16
    s_add_u32 s85, s37, s85
    v_mov_b32_dpp v122, v96 quad_perm:[0,0,0,0] row_mask:0xf bank_mask:0xf
    v_mov_b32_dpp v124, v98 quad_perm:[2,2,2,2] row_mask:0xf bank_mask:0xf
    s_nop 0
    v_add_f32_dpp v122, v97, v122 quad_perm:[1,1,1,1] row_mask:0xf bank_mask:0xf
    v_add_f32_dpp v124, v99, v124 quad_perm:[3,3,3,3] row_mask:0xf bank_mask:0xf
    v_add_f32 v122, v122, v124
    v_max_f32 v65, v65, v122
    ds_write_b32 v64, v122 offset:0
    s_waitcnt vmcnt(5)
    buffer_load_dwordx4 v[128:131], v62, s[64:67], s85 offen offset:0 nt
    v_mfma_f32_16x16x32_bf16 v[112:115], v[136:139], v[88:91], v[112:115]
    s_waitcnt vmcnt(5)
    buffer_load_dwordx4 v[132:135], v63, s[64:67], s85 offen offset:0 nt
    v_mfma_f32_16x16x32_bf16 v[112:115], v[140:143], v[92:95], v[112:115]
    s_waitcnt vmcnt(5)
    buffer_load_dwordx4 v[136:139], v62, s[64:67], s85 offen offset:1024 nt
    v_mfma_f32_16x16x32_bf16 v[96:99], v[144:147], v[80:83], 0
    s_waitcnt vmcnt(5)
    buffer_load_dwordx4 v[140:143], v63, s[64:67], s85 offen offset:1024 nt
    v_mfma_f32_16x16x32_bf16 v[96:99], v[148:151], v[84:87], v[96:99]
    s_add_u32 s87, s87, s92
    s_add_u32 s39, s87, s88
    s_bfe_u32 s37, s39, 0x10000
    s_lshl_b32 s37, s37, 13
    s_add_u32 s85, s37, s89
    s_bfe_u32 s37, s39, 0x10001
    s_lshl_b32 s37, s37, 12
    s_add_u32 s85, s37, s85
    s_bfe_u32 s37, s39, 0x10002
    s_lshl_b32 s37, s37, 11
    s_add_u32 s85, s37, s85
    s_bfe_u32 s37, s39, 0x10003
    s_lshl_b32 s37, s37, 14
    s_add_u32 s85, s37, s85
    s_bfe_u32 s37, s39, 0x40004
    s_lshl_b32 s37, s37, 16
    s_add_u32 s85, s37, s85
    v_mov_b32_dpp v122, v112 quad_perm:[0,0,0,0] row_mask:0xf bank_mask:0xf
    v_mov_b32_dpp v124, v114 quad_perm:[2,2,2,2] row_mask:0xf bank_mask:0xf
    s_nop 0
    v_add_f32_dpp v122, v113, v122 quad_perm:[1,1,1,1] row_mask:0xf bank_mask:0xf
    v_add_f32_dpp v124, v115, v124 quad_perm:[3,3,3,3] row_mask:0xf bank_mask:0xf
    v_add_f32 v122, v122, v124
    v_max_f32 v65, v65, v122
    ds_write_b32 v64, v122 offset:256
    s_waitcnt vmcnt(5)
    buffer_load_dwordx4 v[144:147], v62, s[64:67], s85 offen offset:0 nt
    v_mfma_f32_16x16x32_bf16 v[96:99], v[152:155], v[88:91], v[96:99]
    s_waitcnt vmcnt(5)
    buffer_load_dwordx4 v[148:151], v63, s[64:67], s85 offen offset:0 nt
    v_mfma_f32_16x16x32_bf16 v[96:99], v[156:159], v[92:95], v[96:99]
    v_add_u32 v64, 512, v64
    s_sub_u32 s97, s97, 1
    s_cmp_lg_u32 s97, 0
    s_cbranch_scc1 L_bloop
    s_bfe_u32 s38, s2, 0x30000
    s_lshl_b32 s38, s38, 8
    s_add_u32 s69, s38, 32768
    v_lshrrev_b32 v68, 2, v34
    buffer_load_dword v68, v68, s[48:51], s69 offen sc1
    v_mov_b32_dpp v122, v96 quad_perm:[0,0,0,0] row_mask:0xf bank_mask:0xf
    v_mov_b32_dpp v124, v98 quad_perm:[2,2,2,2] row_mask:0xf bank_mask:0xf
    s_nop 0
    v_add_f32_dpp v122, v97, v122 quad_perm:[1,1,1,1] row_mask:0xf bank_mask:0xf
    v_add_f32_dpp v124, v99, v124 quad_perm:[3,3,3,3] row_mask:0xf bank_mask:0xf
    v_add_f32 v122, v122, v124
    v_max_f32 v65, v65, v122
    ds_write_b32 v64, v122 offset:0
    v_mov_b32 v123, 0xff7f0000
    ds_write_b32 v64, v123 offset:256
    s_lshl_b32 s38, s34, 14
    s_add_u32 s38, s38, 16384
    v_lshl_add_u32 v64, v1, 2, s38
    ds_read_b32 v66, v64
    ds_read_b32 v67, v64 offset:256
    v_mul_f32 v65, s83, v65
    s_nop 1
    v_max_f32_dpp v124, v65, v65 row_ror:4 row_mask:0xf bank_mask:0xf
    s_nop 1
    v_max_f32_dpp v124, v124, v124 row_ror:8 row_mask:0xf bank_mask:0xf
    v_mov_b32 v125, v124
    s_nop 1
    v_permlane16_swap_b32 v124, v125
    v_max_f32 v124, v124, v125
    v_mov_b32 v125, v124
    s_nop 1
    v_permlane32_swap_b32 v124, v125
    v_max_f32 v124, v124, v125
    v_mov_b32 v120, v124
    s_mov_b32 s97, s63
    s_waitcnt lgkmcnt(1)
    v_fma_f32 v123, v66, s83, -v120
    v_exp_f32 v123, v123
    ds_read_b32 v66, v64 offset:512
    v_cvt_pk_bf16_f32 v100, v123, v123
    v_add_f32 v121, v121, v123
    v_and_b32 v65, 1, v1
    v_lshl_add_u32 v65, v65, 2, v55
    s_mov_b32 vcc_lo, 0xaaaaaaaa
    s_mov_b32 vcc_hi, 0xaaaaaaaa
    s_cmp_ge_u32 s93, s94
    s_cbranch_scc1 L_kdone
L_kdyn:
    s_lshl_b32 s81, s93, 7
    s_add_u32 s81, s81, s80
    s_waitcnt vmcnt(5)
    buffer_load_dwordx4 v[152:155], v62, s[64:67], s85 offen offset:1024 nt
    v_mfma_f32_16x16x32_bf16 v[112:115], v[128:131], v[80:83], 0
    s_waitcnt vmcnt(5)
    buffer_load_dwordx4 v[156:159], v63, s[64:67], s85 offen offset:1024 nt
    v_mfma_f32_16x16x32_bf16 v[112:115], v[132:135], v[84:87], v[112:115]
    s_cmp_lg_u32 s62, 0
    s_cbranch_scc1 L_nopost_11
    v_add_u32 v19, 1, v19
    s_mov_b64 exec, 1
    ds_write_b32 v0, v19 offset:4
L_nopost_11:
    s_mov_b64 exec, 1
    ds_add_rtn_u32 v5, v0, v18 offset:8
    s_mov_b64 exec, -1
L_again_12:
    ds_read_b32 v4, v0 offset:4
    s_waitcnt lgkmcnt(0)
    v_readfirstlane_b32 s93, v4
    s_nop 0
    s_sub_u32 s93, s93, 1
    s_cbranch_scc1 L_retry_13
    v_add_u32 v0, 8, v0
    s_cmp_ge_u32 s93, s94
    s_cbranch_scc1 L_gone_10
    s_add_u32 s87, s93, 112
    s_cmp_eq_u32 s93, 16
    s_cselect_b32 s87, s95, s87
    s_lshl_b32 s87, s87, 1
    s_add_u32 s36, s93, 1
    v_mov_b32 v19, 64
    s_mov_b32 s62, 0
    s_cmp_ge_u32 s36, s94
    s_cbranch_scc1 L_lastone_14
    v_readfirstlane_b32 s62, v5
    s_nop 0
    s_cmp_lg_u32 s62, 0
    s_cbranch_scc1 L_nodraw_15
    s_mov_b64 exec, 1
    global_atomic_add v19, v9, v18, s[30:31] offset:0 sc0 sc1
    s_mov_b64 exec, -1
L_nodraw_15:
L_lastone_14:
L_done_9:
    s_add_u32 s39, s87, s88
    s_bfe_u32 s37, s39, 0x10000
    s_lshl_b32 s37, s37, 13
    s_add_u32 s85, s37, s89
    s_bfe_u32 s37, s39, 0x10001
    s_lshl_b32 s37, s37, 12
    s_add_u32 s85, s37, s85
    s_bfe_u32 s37, s39, 0x10002
    s_lshl_b32 s37, s37, 11
    s_add_u32 s85, s37, s85
    s_bfe_u32 s37, s39, 0x10003
    s_lshl_b32 s37, s37, 14
    s_add_u32 s85, s37, s85
    s_bfe_u32 s37, s39, 0x40004
    s_lshl_b32 s37, s37, 16
    s_add_u32 s85, s37, s85
    s_waitcnt vmcnt(5)
    buffer_load_dwordx4 v[128:131], v62, s[64:67], s85 offen offset:0 nt
    v_mfma_f32_16x16x32_bf16 v[112:115], v[136:139], v[88:91], v[112:115]
    s_waitcnt vmcnt(5)
    buffer_load_dwordx4 v[132:135], v63, s[64:67], s85 offen offset:0 nt
    v_mfma_f32_16x16x32_bf16 v[112:115], v[140:143], v[92:95], v[112:115]
    s_waitcnt vmcnt(5)
    buffer_load_dwordx4 v[136:139], v62, s[64:67], s85 offen offset:1024 nt
    v_mfma_f32_16x16x32_bf16 v[96:99], v[144:147], v[80:83], 0
    s_waitcnt vmcnt(5)
    buffer_load_dwordx4 v[140:143], v63, s[64:67], s85 offen offset:1024 nt
    v_mfma_f32_16x16x32_bf16 v[96:99], v[148:151], v[84:87], v[96:99]
    s_add_u32 s87, s87, s92
    s_add_u32 s39, s87, s88
    s_bfe_u32 s37, s39, 0x10000
    s_lshl_b32 s37, s37, 13
    s_add_u32 s85, s37, s89
    s_bfe_u32 s37, s39, 0x10001
    s_lshl_b32 s37, s37, 12
    s_add_u32 s85, s37, s85
    s_bfe_u32 s37, s39, 0x10002
    s_lshl_b32 s37, s37, 11
    s_add_u32 s85, s37, s85
    s_bfe_u32 s37, s39, 0x10003
    s_lshl_b32 s37, s37, 14
    s_add_u32 s85, s37, s85
    s_bfe_u32 s37, s39, 0x40004
    s_lshl_b32 s37, s37, 16
    s_add_u32 s85, s37, s85
    v_mov_b32_dpp v123, v112 quad_perm:[0,0,0,0] row_mask:0xf bank_mask:0xf
    v_mov_b32_dpp v124, v114 quad_perm:[2,2,2,2] row_mask:0xf bank_mask:0xf
    s_nop 0
    v_add_f32_dpp v123, v113, v123 quad_perm:[1,1,1,1] row_mask:0xf bank_mask:0xf
    v_add_f32_dpp v124, v115, v124 quad_perm:[3,3,3,3] row_mask:0xf bank_mask:0xf
    v_add_f32 v123, v123, v124
    s_waitcnt vmcnt(5)
    buffer_load_dwordx4 v[144:147], v62, s[64:67], s85 offen offset:0 nt
    v_mfma_f32_16x16x32_bf16 v[96:99], v[152:155], v[88:91], v[96:99]
    s_waitcnt vmcnt(5)
    buffer_load_dwordx4 v[148:151], v63, s[64:67], s85 offen offset:0 nt
    v_mfma_f32_16x16x32_bf16 v[96:99], v[156:159], v[92:95], v[96:99]
    s_nop 7
    v_mov_b32_dpp v122, v96 quad_perm:[0,0,0,0] row_mask:0xf bank_mask:0xf
    v_mov_b32_dpp v124, v98 quad_perm:[2,2,2,2] row_mask:0xf bank_mask:0xf
    s_nop 0
    v_add_f32_dpp v122, v97, v122 quad_perm:[1,1,1,1] row_mask:0xf bank_mask:0xf
    v_add_f32_dpp v124, v99, v124 quad_perm:[3,3,3,3] row_mask:0xf bank_mask:0xf
    v_add_f32 v122, v122, v124
    v_cndmask_b32 v123, v123, v122, vcc
    v_and_or_b32 v123, v123, s82, v8
    s_mov_b32 exec_lo, 0x33333333
    s_mov_b32 exec_hi, 0x33333333
    buffer_store_dword v123, v65, s[48:51], s81 offen sc1
    s_mov_b64 exec, -1
    s_cmp_lt_u32 s93, s94
    s_cbranch_scc1 L_kdyn
L_kdone:
L_vloop:
    v_and_b32_dpp v104, v100, v10 row_newbcast:0 row_mask:0xf bank_mask:0xf
    v_and_b32_dpp v105, v100, v11 row_newbcast:0 row_mask:0xf bank_mask:0xf
    v_and_b32_dpp v106, v100, v12 row_newbcast:0 row_mask:0xf bank_mask:0xf
    v_and_b32_dpp v107, v100, v13 row_newbcast:0 row_mask:0xf bank_mask:0xf
    s_waitcnt vmcnt(5)
    buffer_load_dwordx4 v[152:155], v62, s[64:67], s85 offen offset:1024 nt
    v_mfma_f32_16x16x32_bf16 v[116:119], v[128:131], v[104:107], v[116:119]
    v_and_b32_dpp v108, v100, v10 row_newbcast:4 row_mask:0xf bank_mask:0xf
    v_and_b32_dpp v109, v100, v11 row_newbcast:4 row_mask:0xf bank_mask:0xf
    v_and_b32_dpp v110, v100, v12 row_newbcast:4 row_mask:0xf bank_mask:0xf
    v_and_b32_dpp v111, v100, v13 row_newbcast:4 row_mask:0xf bank_mask:0xf
    s_waitcnt vmcnt(5)
    buffer_load_dwordx4 v[156:159], v63, s[64:67], s85 offen offset:1024 nt
    v_mfma_f32_16x16x32_bf16 v[116:119], v[132:135], v[108:111], v[116:119]
    s_cmp_le_u32 s97, 2
    s_cbranch_scc1 L_rare_16
L_back_17:
    s_add_u32 s87, s87, 13
L_done_18:
    s_add_u32 s39, s87, s88
    s_bfe_u32 s37, s39, 0x10000
    s_lshl_b32 s37, s37, 13
    s_add_u32 s85, s37, s89
    s_bfe_u32 s37, s39, 0x10001
    s_lshl_b32 s37, s37, 12
    s_add_u32 s85, s37, s85
    s_bfe_u32 s37, s39, 0x10002
    s_lshl_b32 s37, s37, 11
    s_add_u32 s85, s37, s85
    s_bfe_u32 s37, s39, 0x10003
    s_lshl_b32 s37, s37, 14
    s_add_u32 s85, s37, s85
    s_bfe_u32 s37, s39, 0x40004
    s_lshl_b32 s37, s37, 16
    s_add_u32 s85, s37, s85
    s_waitcnt lgkmcnt(1)
    v_fma_f32 v123, v67, s83, -v120
    v_exp_f32 v123, v123
    ds_read_b32 v67, v64 offset:768
    v_cvt_pk_bf16_f32 v101, v123, v123
    v_add_f32 v121, v121, v123
    v_and_b32_dpp v104, v100, v10 row_newbcast:8 row_mask:0xf bank_mask:0xf
    v_and_b32_dpp v105, v100, v11 row_newbcast:8 row_mask:0xf bank_mask:0xf
    v_and_b32_dpp v106, v100, v12 row_newbcast:8 row_mask:0xf bank_mask:0xf
    v_and_b32_dpp v107, v100, v13 row_newbcast:8 row_mask:0xf bank_mask:0xf
    s_waitcnt vmcnt(5)
    buffer_load_dwordx4 v[128:131], v62, s[64:67], s85 offen offset:0 nt
    v_mfma_f32_16x16x32_bf16 v[116:119], v[136:139], v[104:107], v[116:119]
    v_and_b32_dpp v108, v100, v10 row_newbcast:12 row_mask:0xf bank_mask:0xf
    v_and_b32_dpp v109, v100, v11 row_newbcast:12 row_mask:0xf bank_mask:0xf
    v_and_b32_dpp v110, v100, v12 row_newbcast:12 row_mask:0xf bank_mask:0xf
    v_and_b32_dpp v111, v100, v13 row_newbcast:12 row_mask:0xf bank_mask:0xf
    s_waitcnt vmcnt(5)
    buffer_load_dwordx4 v[132:135], v63, s[64:67], s85 offen offset:0 nt
    v_mfma_f32_16x16x32_bf16 v[116:119], v[140:143], v[108:111], v[116:119]
    v_and_b32_dpp v104, v101, v10 row_newbcast:0 row_mask:0xf bank_mask:0xf
    v_and_b32_dpp v105, v101, v11 row_newbcast:0 row_mask:0xf bank_mask:0xf
    v_and_b32_dpp v106, v101, v12 row_newbcast:0 row_mask:0xf bank_mask:0xf
    v_and_b32_dpp v107, v101, v13 row_newbcast:0 row_mask:0xf bank_mask:0xf
    s_waitcnt vmcnt(5)
    buffer_load_dwordx4 v[136:139], v62, s[64:67], s85 offen offset:1024 nt
    v_mfma_f32_16x16x32_bf16 v[116:119], v[144:147], v[104:107], v[116:119]
    v_and_b32_dpp v108, v101, v10 row_newbcast:4 row_mask:0xf bank_mask:0xf
    v_and_b32_dpp v109, v101, v11 row_newbcast:4 row_mask:0xf bank_mask:0xf
    v_and_b32_dpp v110, v101, v12 row_newbcast:4 row_mask:0xf bank_mask:0xf
    v_and_b32_dpp v111, v101, v13 row_newbcast:4 row_mask:0xf bank_mask:0xf
    s_waitcnt vmcnt(5)
    buffer_load_dwordx4 v[140:143], v63, s[64:67], s85 offen offset:1024 nt
    v_mfma_f32_16x16x32_bf16 v[116:119], v[148:151], v[108:111], v[116:119]
    s_add_u32 s87, s87, s92
    s_add_u32 s39, s87, s88
    s_bfe_u32 s37, s39, 0x10000
    s_lshl_b32 s37, s37, 13
    s_add_u32 s85, s37, s89
    s_bfe_u32 s37, s39, 0x10001
    s_lshl_b32 s37, s37, 12
    s_add_u32 s85, s37, s85
    s_bfe_u32 s37, s39, 0x10002
    s_lshl_b32 s37, s37, 11
    s_add_u32 s85, s37, s85
    s_bfe_u32 s37, s39, 0x10003
    s_lshl_b32 s37, s37, 14
    s_add_u32 s85, s37, s85
    s_bfe_u32 s37, s39, 0x40004
    s_lshl_b32 s37, s37, 16
    s_add_u32 s85, s37, s85
    v_add_u32 v64, 512, v64
    s_waitcnt lgkmcnt(1)
    v_fma_f32 v123, v66, s83, -v120
    v_exp_f32 v123, v123
    ds_read_b32 v66, v64 offset:512
    v_cvt_pk_bf16_f32 v100, v123, v123
    v_add_f32 v121, v121, v123
    v_and_b32_dpp v104, v101, v10 row_newbcast:8 row_mask:0xf bank_mask:0xf
    v_and_b32_dpp v105, v101, v11 row_newbcast:8 row_mask:0xf bank_mask:0xf
    v_and_b32_dpp v106, v101, v12 row_newbcast:8 row_mask:0xf bank_mask:0xf
    v_and_b32_dpp v107, v101, v13 row_newbcast:8 row_mask:0xf bank_mask:0xf
    s_waitcnt vmcnt(5)
    buffer_load_dwordx4 v[144:147], v62, s[64:67], s85 offen offset:0 nt
    v_mfma_f32_16x16x32_bf16 v[116:119], v[152:155], v[104:107], v[116:119]
    v_and_b32_dpp v108, v101, v10 row_newbcast:12 row_mask:0xf bank_mask:0xf
    v_and_b32_dpp v109, v101, v11 row_newbcast:12 row_mask:0xf bank_mask:0xf
    v_and_b32_dpp v110, v101, v12 row_newbcast:12 row_mask:0xf bank_mask:0xf
    v_and_b32_dpp v111, v101, v13 row_newbcast:12 row_mask:0xf bank_mask:0xf
    s_waitcnt vmcnt(5)
    buffer_load_dwordx4 v[148:151], v63, s[64:67], s85 offen offset:0 nt
    v_mfma_f32_16x16x32_bf16 v[116:119], v[156:159], v[108:111], v[116:119]
    s_sub_u32 s97, s97, 1
    s_cmp_lg_u32 s97, 0
    s_cbranch_scc1 L_vloop
    buffer_load_dwordx4 v[152:155], v62, s[64:67], s85 offen offset:1024 nt
    v_cmp_ne_u32 vcc, s70, v68
    s_nop 0
    s_cmp_eq_u64 vcc, 0
    s_cselect_b32 s70, 1, 0
    s_cmp_ge_u32 s93, s94
    s_cbranch_scc1 L_none
L_vdyn:
    s_waitcnt vmcnt(6)
    buffer_load_dwordx4 v[156:159], v63, s[64:67], s85 offen offset:1024 nt
L_sccheck:
    v_xor_b32 v102, s35, v102
    v_xor_b32 v103, s35, v103
    v_or_b32 v4, v102, v103
    v_and_b32 v4, 0xff, v4
    v_cmp_ne_u32 vcc, 0, v4
    v_fma_f32 v123, v102, s83, -v120
    v_fma_f32 v122, v103, s83, -v120
    s_cbranch_vccnz L_scretry
    v_max_f32 v124, v123, v122
    v_cmp_lt_f32 vcc, 0, v124
    s_cbranch_vccnz L_newmax
L_oldmax:
    v_exp_f32 v123, v123
    v_exp_f32 v122, v122
    v_cvt_pk_bf16_f32 v100, v123, v123
    v_add_f32 v121, v121, v123
    v_cvt_pk_bf16_f32 v101, v122, v122
    v_add_f32 v121, v121, v122
    s_cmp_lg_u32 s62, 0
    s_cbranch_scc1 L_nopost_20
    v_add_u32 v19, 1, v19
    s_mov_b64 exec, 1
    ds_write_b32 v0, v19 offset:4
L_nopost_20:
    s_mov_b64 exec, 1
    ds_add_rtn_u32 v5, v0, v18 offset:8
    s_mov_b64 exec, -1
L_again_21:
    ds_read_b32 v4, v0 offset:4
    s_waitcnt lgkmcnt(0)
    v_readfirstlane_b32 s93, v4
    s_nop 0
    s_sub_u32 s93, s93, 1
    s_cbranch_scc1 L_retry_22
    v_add_u32 v0, 8, v0
    s_cmp_ge_u32 s93, s94
    s_cbranch_scc1 L_last
    s_lshl_b32 s81, s93, 7
    s_add_u32 s81, s81, s80
    buffer_load_dwordx2 v[102:103], v55, s[48:51], s81 offen sc1
    s_add_u32 s87, s93, 112
    s_cmp_eq_u32 s93, 16
    s_cselect_b32 s87, s95, s87
    s_lshl_b32 s87, s87, 1
    s_add_u32 s36, s93, 1
    v_mov_b32 v19, 64
    s_mov_b32 s62, 0
    s_cmp_ge_u32 s36, s94
    s_cbranch_scc1 L_lastone_23
    v_readfirstlane_b32 s62, v5
    s_nop 0
    s_cmp_lg_u32 s62, 0
    s_cbranch_scc1 L_nodraw_24
    s_mov_b64 exec, 1
    global_atomic_add v19, v9, v18, s[30:31] offset:4 sc0 sc1
    s_mov_b64 exec, -1
L_nodraw_24:
L_lastone_23:
    s_add_u32 s39, s87, s88
    s_bfe_u32 s37, s39, 0x10000
    s_lshl_b32 s37, s37, 13
    s_add_u32 s85, s37, s89
    s_bfe_u32 s37, s39, 0x10001
    s_lshl_b32 s37, s37, 12
    s_add_u32 s85, s37, s85
    s_bfe_u32 s37, s39, 0x10002
    s_lshl_b32 s37, s37, 11
    s_add_u32 s85, s37, s85
    s_bfe_u32 s37, s39, 0x10003
    s_lshl_b32 s37, s37, 14
    s_add_u32 s85, s37, s85
    s_bfe_u32 s37, s39, 0x40004
    s_lshl_b32 s37, s37, 16
    s_add_u32 s85, s37, s85
    v_and_b32_dpp v104, v100, v10 row_newbcast:0 row_mask:0xf bank_mask:0xf
    v_and_b32_dpp v105, v100, v11 row_newbcast:0 row_mask:0xf bank_mask:0xf
    v_and_b32_dpp v106, v100, v12 row_newbcast:0 row_mask:0xf bank_mask:0xf
    v_and_b32_dpp v107, v100, v13 row_newbcast:0 row_mask:0xf bank_mask:0xf
    s_nop 1
    v_mfma_f32_16x16x32_bf16 v[116:119], v[128:131], v[104:107], v[116:119]
    v_and_b32_dpp v108, v100, v10 row_newbcast:4 row_mask:0xf bank_mask:0xf
    v_and_b32_dpp v109, v100, v11 row_newbcast:4 row_mask:0xf bank_mask:0xf
    v_and_b32_dpp v110, v100, v12 row_newbcast:4 row_mask:0xf bank_mask:0xf
    v_and_b32_dpp v111, v100, v13 row_newbcast:4 row_mask:0xf bank_mask:0xf
    s_waitcnt vmcnt(7)
    buffer_load_dwordx4 v[128:131], v62, s[64:67], s85 offen offset:0 nt
    v_mfma_f32_16x16x32_bf16 v[116:119], v[132:135], v[108:111], v[116:119]
    v_and_b32_dpp v104, v100, v10 row_newbcast:8 row_mask:0xf bank_mask:0xf
    v_and_b32_dpp v105, v100, v11 row_newbcast:8 row_mask:0xf bank_mask:0xf
    v_and_b32_dpp v106, v100, v12 row_newbcast:8 row_mask:0xf bank_mask:0xf
    v_and_b32_dpp v107, v100, v13 row_newbcast:8 row_mask:0xf bank_mask:0xf
    s_waitcnt vmcnt(7)
    buffer_load_dwordx4 v[132:135], v63, s[64:67], s85 offen offset:0 nt
    v_mfma_f32_16x16x32_bf16 v[116:119], v[136:139], v[104:107], v[116:119]
    v_and_b32_dpp v108, v100, v10 row_newbcast:12 row_mask:0xf bank_mask:0xf
    v_and_b32_dpp v109, v100, v11 row_newbcast:12 row_mask:0xf bank_mask:0xf
    v_and_b32_dpp v110, v100, v12 row_newbcast:12 row_mask:0xf bank_mask:0xf
    v_and_b32_dpp v111, v100, v13 row_newbcast:12 row_mask:0xf bank_mask:0xf
    s_waitcnt vmcnt(7)
    buffer_load_dwordx4 v[136:139], v62, s[64:67], s85 offen offset:1024 nt
    v_mfma_f32_16x16x32_bf16 v[116:119], v[140:143], v[108:111], v[116:119]
    v_and_b32_dpp v104, v101, v10 row_newbcast:0 row_mask:0xf bank_mask:0xf
    v_and_b32_dpp v105, v101, v11 row_newbcast:0 row_mask:0xf bank_mask:0xf
    v_and_b32_dpp v106, v101, v12 row_newbcast:0 row_mask:0xf bank_mask:0xf
    v_and_b32_dpp v107, v101, v13 row_newbcast:0 row_mask:0xf bank_mask:0xf
    s_waitcnt vmcnt(7)
    buffer_load_dwordx4 v[140:143], v63, s[64:67], s85 offen offset:1024 nt
    v_mfma_f32_16x16x32_bf16 v[116:119], v[144:147], v[104:107], v[116:119]
    s_add_u32 s87, s87, s92
    s_add_u32 s39, s87, s88
    s_bfe_u32 s37, s39, 0x10000
    s_lshl_b32 s37, s37, 13
    s_add_u32 s85, s37, s89
    s_bfe_u32 s37, s39, 0x10001
    s_lshl_b32 s37, s37, 12
    s_add_u32 s85, s37, s85
    s_bfe_u32 s37, s39, 0x10002
    s_lshl_b32 s37, s37, 11
    s_add_u32 s85, s37, s85
    s_bfe_u32 s37, s39, 0x10003
    s_lshl_b32 s37, s37, 14
    s_add_u32 s85, s37, s85
    s_bfe_u32 s37, s39, 0x40004
    s_lshl_b32 s37, s37, 16
    s_add_u32 s85, s37, s85
    v_and_b32_dpp v108, v101, v10 row_newbcast:4 row_mask:0xf bank_mask:0xf
    v_and_b32_dpp v109, v101, v11 row_newbcast:4 row_mask:0xf bank_mask:0xf
    v_and_b32_dpp v110, v101, v12 row_newbcast:4 row_mask:0xf bank_mask:0xf
    v_and_b32_dpp v111, v101, v13 row_newbcast:4 row_mask:0xf bank_mask:0xf
    s_waitcnt vmcnt(7)
    buffer_load_dwordx4 v[144:147], v62, s[64:67], s85 offen offset:0 nt
    v_mfma_f32_16x16x32_bf16 v[116:119], v[148:151], v[108:111], v[116:119]
    v_and_b32_dpp v104, v101, v10 row_newbcast:8 row_mask:0xf bank_mask:0xf
    v_and_b32_dpp v105, v101, v11 row_newbcast:8 row_mask:0xf bank_mask:0xf
    v_and_b32_dpp v106, v101, v12 row_newbcast:8 row_mask:0xf bank_mask:0xf
    v_and_b32_dpp v107, v101, v13 row_newbcast:8 row_mask:0xf bank_mask:0xf
    s_waitcnt vmcnt(7)
    buffer_load_dwordx4 v[148:151], v63, s[64:67], s85 offen offset:0 nt
    v_mfma_f32_16x16x32_bf16 v[116:119], v[152:155], v[104:107], v[116:119]
    v_and_b32_dpp v108, v101, v10 row_newbcast:12 row_mask:0xf bank_mask:0xf
    v_and_b32_dpp v109, v101, v11 row_newbcast:12 row_mask:0xf bank_mask:0xf
    v_and_b32_dpp v110, v101, v12 row_newbcast:12 row_mask:0xf bank_mask:0xf
    v_and_b32_dpp v111, v101, v13 row_newbcast:12 row_mask:0xf bank_mask:0xf
    s_waitcnt vmcnt(7)
    buffer_load_dwordx4 v[152:155], v62, s[64:67], s85 offen offset:1024 nt
    v_mfma_f32_16x16x32_bf16 v[116:119], v[156:159], v[108:111], v[116:119]
    s_branch L_vdyn
L_scretry:
    buffer_load_dwordx2 v[102:103], v55, s[48:51], s81 offen sc1
    s_waitcnt vmcnt(0)
    s_sub_u32 s84, s84, 1
    s_cmp_lg_u32 s84, 0
    s_cbranch_scc1 L_sccheck
    s_branch L_end
L_newmax:
    v_max_f32 v123, v102, v103
    v_mul_f32 v123, s83, v123
    s_nop 1
    v_max_f32_dpp v124, v123, v123 row_ror:4 row_mask:0xf bank_mask:0xf
    s_nop 1
    v_max_f32_dpp v124, v124, v124 row_ror:8 row_mask:0xf bank_mask:0xf
    v_mov_b32 v125, v124
    s_nop 1
    v_permlane16_swap_b32 v124, v125
    v_max_f32 v124, v124, v125
    v_mov_b32 v125, v124
    s_nop 1
    v_permlane32_swap_b32 v124, v125
    v_max_f32 v124, v124, v125
    v_max_f32 v124, v124, v120
    v_sub_f32 v125, v120, v124
    v_exp_f32 v125, v125
    v_mov_b32 v120, v124
    v_fma_f32 v123, v102, s83, -v120
    v_fma_f32 v122, v103, s83, -v120
    v_mul_f32 v121, v121, v125
    v_mul_f32 v116, v116, v125
    v_mul_f32 v117, v117, v125
    v_mul_f32 v118, v118, v125
    v_mul_f32 v119, v119, v125
    s_branch L_oldmax
L_rare_3:
    s_cmp_eq_u32 s97, 1
    s_cbranch_scc1 L_last_25
    s_mov_b64 exec, 1
    ds_add_rtn_u32 v5, v0, v18 offset:0
    s_mov_b64 exec, -1
    s_waitcnt lgkmcnt(0)
    v_readfirstlane_b32 s62, v5
    s_nop 0
    s_cmp_lg_u32 s62, 0
    s_cbranch_scc1 L_nodraw_26
    s_mov_b64 exec, 1
    global_atomic_add v19, v9, v18, s[30:31] offset:0 sc0 sc1
    s_mov_b64 exec, -1
L_nodraw_26:
    s_branch L_back_4
L_last_25:
    s_cmp_lg_u32 s62, 0
    s_cbranch_scc1 L_nopost_27
    v_add_u32 v19, 1, v19
    s_mov_b64 exec, 1
    ds_write_b32 v0, v19 offset:4
L_nopost_27:
    s_mov_b64 exec, 1
    ds_add_rtn_u32 v5, v0, v18 offset:8
    s_mov_b64 exec, -1
L_again_28:
    ds_read_b32 v4, v0 offset:4
    s_waitcnt lgkmcnt(0)
    v_readfirstlane_b32 s93, v4
    s_nop 0
    s_sub_u32 s93, s93, 1
    s_cbranch_scc1 L_retry_29
    v_add_u32 v0, 8, v0
    s_cmp_ge_u32 s93, s94
    s_cbranch_scc1 L_gone_6
    s_add_u32 s87, s93, 112
    s_cmp_eq_u32 s93, 16
    s_cselect_b32 s87, s95, s87
    s_lshl_b32 s87, s87, 1
    s_add_u32 s36, s93, 1
    v_mov_b32 v19, 64
    s_mov_b32 s62, 0
    s_cmp_ge_u32 s36, s94
    s_cbranch_scc1 L_lastone_30
    v_readfirstlane_b32 s62, v5
    s_nop 0
    s_cmp_lg_u32 s62, 0
    s_cbranch_scc1 L_nodraw_31
    s_mov_b64 exec, 1
    global_atomic_add v19, v9, v18, s[30:31] offset:0 sc0 sc1
    s_mov_b64 exec, -1
L_nodraw_31:
L_lastone_30:
    s_branch L_done_5
L_gone_6:
    s_mov_b64 s[64:65], s[56:57]
    v_mov_b32 v62, v126
    v_mov_b32 v63, v127
    s_lshl_b32 s87, s33, 1
    s_mov_b32 s92, 1
    v_add_u32 v0, 8, v0
    s_branch L_done_5
L_retry_13:
    s_sub_u32 s84, s84, 1
    s_cmp_lg_u32 s84, 0
    s_cbranch_scc1 L_again_12
    s_branch L_end
L_gone_10:
    s_mov_b64 s[64:65], s[56:57]
    v_mov_b32 v62, v126
    v_mov_b32 v63, v127
    s_lshl_b32 s87, s33, 1
    s_mov_b32 s92, 1
    v_add_u32 v0, 8, v0
    s_branch L_done_9
L_rare_16:
    s_cmp_eq_u32 s97, 1
    s_cbranch_scc1 L_last_32
    s_mov_b64 exec, 1
    ds_add_rtn_u32 v5, v0, v18 offset:0
    s_mov_b64 exec, -1
    s_waitcnt lgkmcnt(0)
    v_readfirstlane_b32 s62, v5
    s_nop 0
    s_cmp_lg_u32 s62, 0
    s_cbranch_scc1 L_nodraw_33
    s_mov_b64 exec, 1
    global_atomic_add v19, v9, v18, s[30:31] offset:4 sc0 sc1
    s_mov_b64 exec, -1
L_nodraw_33:
    s_branch L_back_17
L_last_32:
    s_cmp_lg_u32 s62, 0
    s_cbranch_scc1 L_nopost_34
    v_add_u32 v19, 1, v19
    s_mov_b64 exec, 1
    ds_write_b32 v0, v19 offset:4
L_nopost_34:
    s_mov_b64 exec, 1
    ds_add_rtn_u32 v5, v0, v18 offset:8
    s_mov_b64 exec, -1
L_again_35:
    ds_read_b32 v4, v0 offset:4
    s_waitcnt lgkmcnt(0)
    v_readfirstlane_b32 s93, v4
    s_nop 0
    s_sub_u32 s93, s93, 1
    s_cbranch_scc1 L_retry_36
    v_add_u32 v0, 8, v0
    s_cmp_ge_u32 s93, s94
    s_cbranch_scc1 L_gone_19
    s_lshl_b32 s81, s93, 7
    s_add_u32 s81, s81, s80
    buffer_load_dwordx2 v[102:103], v55, s[48:51], s81 offen sc1
    s_add_u32 s87, s93, 112
    s_cmp_eq_u32 s93, 16
    s_cselect_b32 s87, s95, s87
    s_lshl_b32 s87, s87, 1
    s_add_u32 s36, s93, 1
    v_mov_b32 v19, 64
    s_mov_b32 s62, 0
    s_cmp_ge_u32 s36, s94
    s_cbranch_scc1 L_lastone_37
    v_readfirstlane_b32 s62, v5
    s_nop 0
    s_cmp_lg_u32 s62, 0
    s_cbranch_scc1 L_nodraw_38
    s_mov_b64 exec, 1
    global_atomic_add v19, v9, v18, s[30:31] offset:4 sc0 sc1
    s_mov_b64 exec, -1
L_nodraw_38:
L_lastone_37:
    s_branch L_done_18
L_gone_19:
    s_mov_b32 s89, 134217728
    s_branch L_done_18
L_retry_22:
    s_sub_u32 s84, s84, 1
    s_cmp_lg_u32 s84, 0
    s_cbranch_scc1 L_again_21
    s_branch L_end
L_retry_29:
    s_sub_u32 s84, s84, 1
    s_cmp_lg_u32 s84, 0
    s_cbranch_scc1 L_again_28
    s_branch L_end
L_retry_36:
    s_sub_u32 s84, s84, 1
    s_cmp_lg_u32 s84, 0
    s_cbranch_scc1 L_again_35
    s_branch L_end
L_none:
    buffer_load_dwordx4 v[224:227], v54, s[48:51], s46 offen sc1
    s_mov_b32 s86, s44
    s_bitcmp1_b32 s90, 2
    s_cselect_b32 s44, 4194304, s44
    s_lshl_b32 s39, s34, 13
    s_add_u32 s39, s39, 98304
    s_mov_b32 m0, s39
    s_nop 0
    buffer_load_dwordx4 v20, s[40:43], s44 offen offset:0 nt lds
    buffer_load_dwordx4 v21, s[40:43], s44 offen offset:1024 nt lds
    buffer_load_dwordx4 v22, s[40:43], s44 offen offset:2048 nt lds
    buffer_load_dwordx4 v23, s[40:43], s44 offen offset:3072 nt lds
    s_lshl_b32 s39, s34, 13
    s_add_u32 s39, s39, 102400
    s_mov_b32 m0, s39
    s_add_u32 s44, s44, 16384
    buffer_load_dwordx4 v20, s[40:43], s44 offen offset:0 nt lds
    buffer_load_dwordx4 v21, s[40:43], s44 offen offset:1024 nt lds
    v_add_f32_dpp v121, v121, v121 row_ror:8 row_mask:0xf bank_mask:0xf
    s_nop 1
    v_add_f32_dpp v121, v121, v121 row_ror:4 row_mask:0xf bank_mask:0xf
    v_mov_b32 v125, v121
    s_nop 1
    v_permlane16_swap_b32 v121, v125
    v_add_f32 v121, v121, v125
    v_mov_b32 v125, v121
    s_nop 1
    v_permlane32_swap_b32 v121, v125
    v_add_f32 v121, v121, v125
    v_and_b32 v125, s82, v120
    v_sub_f32 v125, v120, v125
    s_mov_b32 vcc_lo, 0xff00ff00
    s_mov_b32 vcc_hi, 0xff00ff00
    s_branch L_bdone
L_last:
    buffer_load_dwordx4 v[224:227], v54, s[48:51], s46 offen sc1
    s_mov_b32 s86, s44
    s_bitcmp1_b32 s90, 2
    s_cselect_b32 s44, 4194304, s44
    v_and_b32_dpp v104, v100, v10 row_newbcast:0 row_mask:0xf bank_mask:0xf
    v_and_b32_dpp v105, v100, v11 row_newbcast:0 row_mask:0xf bank_mask:0xf
    v_and_b32_dpp v106, v100, v12 row_newbcast:0 row_mask:0xf bank_mask:0xf
    v_and_b32_dpp v107, v100, v13 row_newbcast:0 row_mask:0xf bank_mask:0xf
    s_lshl_b32 s39, s34, 13
    s_add_u32 s39, s39, 98304
    s_mov_b32 m0, s39
    s_nop 0
    buffer_load_dwordx4 v20, s[40:43], s44 offen offset:0 nt lds
    v_mfma_f32_16x16x32_bf16 v[116:119], v[128:131], v[104:107], v[116:119]
    v_and_b32_dpp v108, v100, v10 row_newbcast:4 row_mask:0xf bank_mask:0xf
    v_and_b32_dpp v109, v100, v11 row_newbcast:4 row_mask:0xf bank_mask:0xf
    v_and_b32_dpp v110, v100, v12 row_newbcast:4 row_mask:0xf bank_mask:0xf
    v_and_b32_dpp v111, v100, v13 row_newbcast:4 row_mask:0xf bank_mask:0xf
    s_waitcnt vmcnt(8)
    buffer_load_dwordx4 v21, s[40:43], s44 offen offset:1024 nt lds
    v_mfma_f32_16x16x32_bf16 v[116:119], v[132:135], v[108:111], v[116:119]
    v_add_f32_dpp v121, v121, v121 row_ror:8 row_mask:0xf bank_mask:0xf
    s_nop 1
    v_add_f32_dpp v121, v121, v121 row_ror:4 row_mask:0xf bank_mask:0xf
    v_mov_b32 v125, v121
    s_nop 1
    v_permlane16_swap_b32 v121, v125
    v_add_f32 v121, v121, v125
    v_mov_b32 v125, v121
    s_nop 1
    v_permlane32_swap_b32 v121, v125
    v_add_f32 v121, v121, v125
    v_and_b32 v125, s82, v120
    v_sub_f32 v125, v120, v125
    s_mov_b32 vcc_lo, 0xff00ff00
    s_mov_b32 vcc_hi, 0xff00ff00
    v_and_b32_dpp v104, v100, v10 row_newbcast:8 row_mask:0xf bank_mask:0xf
    v_and_b32_dpp v105, v100, v11 row_newbcast:8 row_mask:0xf bank_mask:0xf
    v_and_b32_dpp v106, v100, v12 row_newbcast:8 row_mask:0xf bank_mask:0xf
    v_and_b32_dpp v107, v100, v13 row_newbcast:8 row_mask:0xf bank_mask:0xf
    s_waitcnt vmcnt(8)
    buffer_load_dwordx4 v22, s[40:43], s44 offen offset:2048 nt lds
    v_mfma_f32_16x16x32_bf16 v[116:119], v[136:139], v[104:107], v[116:119]
    v_and_b32_dpp v108, v100, v10 row_newbcast:12 row_mask:0xf bank_mask:0xf
    v_and_b32_dpp v109, v100, v11 row_newbcast:12 row_mask:0xf bank_mask:0xf
    v_and_b32_dpp v110, v100, v12 row_newbcast:12 row_mask:0xf bank_mask:0xf
    v_and_b32_dpp v111, v100, v13 row_newbcast:12 row_mask:0xf bank_mask:0xf
    s_waitcnt vmcnt(8)
    buffer_load_dwordx4 v23, s[40:43], s44 offen offset:3072 nt lds
    v_mfma_f32_16x16x32_bf16 v[116:119], v[140:143], v[108:111], v[116:119]
    v_and_b32_dpp v104, v101, v10 row_newbcast:0 row_mask:0xf bank_mask:0xf
    v_and_b32_dpp v105, v101, v11 row_newbcast:0 row_mask:0xf bank_mask:0xf
    v_and_b32_dpp v106, v101, v12 row_newbcast:0 row_mask:0xf bank_mask:0xf
    v_and_b32_dpp v107, v101, v13 row_newbcast:0 row_mask:0xf bank_mask:0xf
    s_waitcnt vmcnt(8)
    s_lshl_b32 s39, s34, 13
    s_add_u32 s39, s39, 102400
    s_mov_b32 m0, s39
    s_add_u32 s44, s44, 16384
    buffer_load_dwordx4 v20, s[40:43], s44 offen offset:0 nt lds
    v_mfma_f32_16x16x32_bf16 v[116:119], v[144:147], v[104:107], v[116:119]
    v_and_b32_dpp v108, v101, v10 row_newbcast:4 row_mask:0xf bank_mask:0xf
    v_and_b32_dpp v109, v101, v11 row_newbcast:4 row_mask:0xf bank_mask:0xf
    v_and_b32_dpp v110, v101, v12 row_newbcast:4 row_mask:0xf bank_mask:0xf
    v_and_b32_dpp v111, v101, v13 row_newbcast:4 row_mask:0xf bank_mask:0xf
    s_waitcnt vmcnt(8)
    buffer_load_dwordx4 v21, s[40:43], s44 offen offset:1024 nt lds
    v_mfma_f32_16x16x32_bf16 v[116:119], v[148:151], v[108:111], v[116:119]
    v_and_b32_dpp v104, v101, v10 row_newbcast:8 row_mask:0xf bank_mask:0xf
    v_and_b32_dpp v105, v101, v11 row_newbcast:8 row_mask:0xf bank_mask:0xf
    v_and_b32_dpp v106, v101, v12 row_newbcast:8 row_mask:0xf bank_mask:0xf
    v_and_b32_dpp v107, v101, v13 row_newbcast:8 row_mask:0xf bank_mask:0xf
    s_waitcnt vmcnt(8)
    s_nop 0
    v_mfma_f32_16x16x32_bf16 v[116:119], v[152:155], v[104:107], v[116:119]
    v_and_b32_dpp v108, v101, v10 row_newbcast:12 row_mask:0xf bank_mask:0xf
    v_and_b32_dpp v109, v101, v11 row_newbcast:12 row_mask:0xf bank_mask:0xf
    v_and_b32_dpp v110, v101, v12 row_newbcast:12 row_mask:0xf bank_mask:0xf
    v_and_b32_dpp v111, v101, v13 row_newbcast:12 row_mask:0xf bank_mask:0xf
    s_waitcnt vmcnt(7)
    s_nop 0
    v_mfma_f32_16x16x32_bf16 v[116:119], v[156:159], v[108:111], v[116:119]
L_bdone:
    s_nop 7
    v_cndmask_b32 v116, v116, v120, vcc
    v_cndmask_b32 v117, v117, v121, vcc
    v_cndmask_b32 v118, v118, v125, vcc
    v_and_or_b32 v119, v119, s82, v8
    v_and_or_b32 v116, v116, s82, v8
    v_and_or_b32 v117, v117, s82, v8
    v_and_or_b32 v118, v118, s82, v8
    s_mov_b32 exec_lo, 0xff01ff
    s_mov_b32 exec_hi, 0xff00ff
    buffer_store_dwordx4 v[116:119], v79, s[48:51], s96 offen sc1
    s_mov_b64 exec, -1
    s_barrier
    s_bitcmp1_b32 s90, 2
    s_cbranch_scc1 L_ctx
    buffer_load_dwordx4 v[204:207], v53, s[48:51], s47 offen sc1
    buffer_load_dwordx4 v[192:195], v50, s[48:51], s47 offen sc1
    buffer_load_dwordx4 v[196:199], v51, s[48:51], s47 offen sc1
    buffer_load_dwordx4 v[200:203], v52, s[48:51], s47 offen sc1
    buffer_load_dwordx4 v22, s[40:43], s44 offen offset:2048 nt lds
    buffer_load_dwordx4 v23, s[40:43], s44 offen offset:3072 nt lds
    v_xor_b32 v104, s35, v116
    v_xor_b32 v105, s35, v117
    v_xor_b32 v106, s35, v118
    v_xor_b32 v107, s35, v119
    v_mov_b32 v5, 0xff7f0000
    v_cndmask_b32 v120, v120, v5, vcc
    v_and_b32 v121, s82, v121
    s_mov_b32 s86, 0x88888888
    s_mov_b32 s87, 0x88888888
    s_waitcnt vmcnt(2)
L_hop1poll:
    v_xor_b32 v192, s35, v192
    v_xor_b32 v193, s35, v193
    v_xor_b32 v194, s35, v194
    v_xor_b32 v195, s35, v195
    v_xor_b32 v196, s35, v196
    v_xor_b32 v197, s35, v197
    v_xor_b32 v198, s35, v198
    v_xor_b32 v199, s35, v199
    v_xor_b32 v200, s35, v200
    v_xor_b32 v201, s35, v201
    v_xor_b32 v202, s35, v202
    v_xor_b32 v203, s35, v203
    v_xor_b32 v204, s35, v204
    v_xor_b32 v205, s35, v205
    v_xor_b32 v206, s35, v206
    v_xor_b32 v207, s35, v207
    v_or_b32 v4, v192, v193
    v_or3_b32 v4, v4, v194, v195
    v_or3_b32 v4, v4, v196, v197
    v_or3_b32 v4, v4, v198, v199
    v_or3_b32 v4, v4, v200, v201
    v_or3_b32 v4, v4, v202, v203
    v_or3_b32 v4, v4, v204, v205
    v_or3_b32 v4, v4, v206, v207
    v_and_b32 v4, 0xff, v4
    v_cmp_ne_u32 vcc, 0, v4
    v_add_f32 v122, v204, v206
    s_cbranch_vccz L_hop1ok
    buffer_load_dwordx4 v[204:207], v53, s[48:51], s47 offen sc1
    buffer_load_dwordx4 v[192:195], v50, s[48:51], s47 offen sc1
    buffer_load_dwordx4 v[196:199], v51, s[48:51], s47 offen sc1
    buffer_load_dwordx4 v[200:203], v52, s[48:51], s47 offen sc1
    s_waitcnt vmcnt(0)
    s_sub_u32 s84, s84, 1
    s_cmp_lg_u32 s84, 0
    s_cbranch_scc1 L_hop1poll
    s_branch L_end
L_ctx:
    s_mov_b32 s44, s86
    s_lshl_b32 s39, s34, 13
    s_add_u32 s39, s39, 98304
    s_mov_b32 m0, s39
    s_nop 0
    buffer_load_dwordx4 v20, s[40:43], s44 offen offset:0 nt lds
    buffer_load_dwordx4 v21, s[40:43], s44 offen offset:1024 nt lds
    buffer_load_dwordx4 v22, s[40:43], s44 offen offset:2048 nt lds
    buffer_load_dwordx4 v23, s[40:43], s44 offen offset:3072 nt lds
    s_lshl_b32 s39, s34, 13
    s_add_u32 s39, s39, 102400
    s_mov_b32 m0, s39
    s_add_u32 s44, s44, 16384
    buffer_load_dwordx4 v20, s[40:43], s44 offen offset:0 nt lds
    buffer_load_dwordx4 v21, s[40:43], s44 offen offset:1024 nt lds
    buffer_load_dwordx4 v22, s[40:43], s44 offen offset:2048 nt lds
    buffer_load_dwordx4 v23, s[40:43], s44 offen offset:3072 nt lds
    s_waitcnt vmcnt(9)
L_ctxcheck:
    v_xor_b32 v224, s35, v224
    v_xor_b32 v225, s35, v225
    v_xor_b32 v226, s35, v226
    v_xor_b32 v227, s35, v227
    v_or_b32 v4, v224, v225
    v_or3_b32 v4, v4, v226, v227
    v_and_b32 v4, 0xff, v4
    v_cmp_ne_u32 vcc, 0, v4
    s_cbranch_vccz L_ctxok
    buffer_load_dwordx4 v[224:227], v54, s[48:51], s46 offen sc1
    s_waitcnt vmcnt(0)
    s_sub_u32 s84, s84, 1
    s_cmp_lg_u32 s84, 0
    s_cbranch_scc1 L_ctxcheck
    s_branch L_end
L_ctxok:
    v_cvt_pk_bf16_f32 v224, v224, v225
    v_cvt_pk_bf16_f32 v225, v226, v227
    ds_write_b64 v35, v[224:225]
    s_branch L_final
L_hop1ok:
    v_cndmask_b32 v122, v122, v120, s[86:87]
    v_cndmask_b32 v123, v205, v121, s[86:87]
    s_nop 0
    v_max_f32_dpp v5, v122, v122 quad_perm:[1,0,3,2] row_mask:0xf bank_mask:0xf
    s_nop 1
    v_max_f32_dpp v5, v5, v5 quad_perm:[2,3,0,1] row_mask:0xf bank_mask:0xf
    s_nop 1
    v_max_f32_dpp v5, v5, v5 row_ror:8 row_mask:0xf bank_mask:0xf
    v_sub_f32 v122, v122, v5
    v_exp_f32 v122, v122
    s_nop 0
    v_mul_f32 v123, v123, v122
    v_mul_f32_dpp v104, v122, v104 quad_perm:[3,3,3,3] row_mask:0xf bank_mask:0xf
    v_mul_f32_dpp v105, v122, v105 quad_perm:[3,3,3,3] row_mask:0xf bank_mask:0xf
    v_mul_f32_dpp v106, v122, v106 quad_perm:[3,3,3,3] row_mask:0xf bank_mask:0xf
    v_mul_f32_dpp v107, v122, v107 quad_perm:[3,3,3,3] row_mask:0xf bank_mask:0xf
    v_add_f32_dpp v123, v123, v123 quad_perm:[1,0,3,2] row_mask:0xf bank_mask:0xf
    v_fmac_f32_dpp v104, v122, v192 quad_perm:[0,0,0,0] row_mask:0xf bank_mask:0xf
    v_fmac_f32_dpp v105, v122, v193 quad_perm:[0,0,0,0] row_mask:0xf bank_mask:0xf
    v_fmac_f32_dpp v106, v122, v194 quad_perm:[0,0,0,0] row_mask:0xf bank_mask:0xf
    v_fmac_f32_dpp v107, v122, v195 quad_perm:[0,0,0,0] row_mask:0xf bank_mask:0xf
    v_add_f32_dpp v123, v123, v123 quad_perm:[2,3,0,1] row_mask:0xf bank_mask:0xf
    v_fmac_f32_dpp v104, v122, v196 quad_perm:[1,1,1,1] row_mask:0xf bank_mask:0xf
    v_fmac_f32_dpp v105, v122, v197 quad_perm:[1,1,1,1] row_mask:0xf bank_mask:0xf
    v_fmac_f32_dpp v106, v122, v198 quad_perm:[1,1,1,1] row_mask:0xf bank_mask:0xf
    v_fmac_f32_dpp v107, v122, v199 quad_perm:[1,1,1,1] row_mask:0xf bank_mask:0xf
    v_add_f32_dpp v123, v123, v123 row_ror:8 row_mask:0xf bank_mask:0xf
    v_fmac_f32_dpp v104, v122, v200 quad_perm:[2,2,2,2] row_mask:0xf bank_mask:0xf
    v_fmac_f32_dpp v105, v122, v201 quad_perm:[2,2,2,2] row_mask:0xf bank_mask:0xf
    v_fmac_f32_dpp v106, v122, v202 quad_perm:[2,2,2,2] row_mask:0xf bank_mask:0xf
    v_fmac_f32_dpp v107, v122, v203 quad_perm:[2,2,2,2] row_mask:0xf bank_mask:0xf
    v_rcp_f32 v123, v123
    v_add_f32_dpp v104, v104, v104 row_ror:8 row_mask:0xf bank_mask:0xf
    v_add_f32_dpp v105, v105, v105 row_ror:8 row_mask:0xf bank_mask:0xf
    v_add_f32_dpp v106, v106, v106 row_ror:8 row_mask:0xf bank_mask:0xf
    v_add_f32_dpp v107, v107, v107 row_ror:8 row_mask:0xf bank_mask:0xf
    v_mul_f32 v104, v104, v123
    v_mul_f32 v105, v105, v123
    v_mul_f32 v106, v106, v123
    v_mul_f32 v107, v107, v123
    v_cvt_pk_bf16_f32 v104, v104, v105
    v_cvt_pk_bf16_f32 v106, v106, v107
    s_mov_b32 exec_lo, 0xff00ff
    s_mov_b32 exec_hi, 0xff00ff
    ds_write_b16 v31, v104
    ds_write_b16_d16_hi v31, v104 offset:16
    ds_write_b16 v31, v106 offset:32
    ds_write_b16_d16_hi v31, v106 offset:48
    s_mov_b64 exec, -1
L_final:
    s_waitcnt vmcnt(0) lgkmcnt(0)
    s_barrier
    ds_read_b64_tr_b16 v[128:129], v24 offset:0
    ds_read_b64_tr_b16 v[130:131], v25 offset:1024
    ds_read_b128 v[160:163], v28 offset:0
    ds_read_b64_tr_b16 v[132:133], v24 offset:8192
    ds_read_b64_tr_b16 v[134:135], v25 offset:9216
    ds_read_b128 v[164:167], v28 offset:64
    ds_read_b64_tr_b16 v[136:137], v24 offset:16384
    ds_read_b64_tr_b16 v[138:139], v25 offset:17408
    ds_read_b128 v[168:171], v28 offset:128
    ds_read_b64_tr_b16 v[140:141], v24 offset:24576
    ds_read_b64_tr_b16 v[142:143], v25 offset:25600
    ds_read_b128 v[172:175], v28 offset:192
    ds_read_b64_tr_b16 v[144:145], v26 offset:0
    ds_read_b64_tr_b16 v[146:147], v27 offset:1024
    ds_read_b128 v[176:179], v29 offset:0
    s_waitcnt lgkmcnt(12)
    v_mfma_f32_16x16x32_bf16 v[112:115], v[128:131], v[160:163], 0
    ds_read_b64_tr_b16 v[148:149], v26 offset:8192
    ds_read_b64_tr_b16 v[150:151], v27 offset:9216
    ds_read_b128 v[180:183], v29 offset:64
    s_waitcnt lgkmcnt(12)
    v_mfma_f32_16x16x32_bf16 v[112:115], v[132:135], v[164:167], v[112:115]
    ds_read_b64_tr_b16 v[152:153], v26 offset:16384
    ds_read_b64_tr_b16 v[154:155], v27 offset:17408
    ds_read_b128 v[184:187], v29 offset:128
    s_waitcnt lgkmcnt(12)
    v_mfma_f32_16x16x32_bf16 v[112:115], v[136:139], v[168:171], v[112:115]
    ds_read_b64_tr_b16 v[156:157], v26 offset:24576
    ds_read_b64_tr_b16 v[158:159], v27 offset:25600
    ds_read_b128 v[188:191], v29 offset:192
    s_waitcnt lgkmcnt(12)
    v_mfma_f32_16x16x32_bf16 v[112:115], v[140:143], v[172:175], v[112:115]
    s_waitcnt lgkmcnt(9)
    v_mfma_f32_16x16x32_bf16 v[112:115], v[144:147], v[176:179], v[112:115]
    s_waitcnt lgkmcnt(6)
    v_mfma_f32_16x16x32_bf16 v[112:115], v[148:151], v[180:183], v[112:115]
    s_waitcnt lgkmcnt(3)
    v_mfma_f32_16x16x32_bf16 v[112:115], v[152:155], v[184:187], v[112:115]
    s_waitcnt lgkmcnt(0)
    v_mfma_f32_16x16x32_bf16 v[112:115], v[156:159], v[188:191], v[112:115]
    s_add_u32 s37, s71, 4096
    s_cmp_eq_u32 s70, 1
    s_mov_b32 exec_lo, 0xff00ff
    s_mov_b32 exec_hi, 0xff00ff
    s_nop 3
    v_and_or_b32 v112, v112, s82, v8
    v_and_or_b32 v113, v113, s82, v8
    v_and_or_b32 v114, v114, s82, v8
    v_and_or_b32 v115, v115, s82, v8
    s_cbranch_scc1 L_ylocal
    buffer_store_dwordx4 v[112:115], v30, s[48:51], s45 offen sc1
    s_branch L_ydone
L_ylocal:
    buffer_store_dwordx4 v[112:115], v30, s[48:51], s45 offen
L_ydone:
    s_mov_b64 exec, -1
    s_cmp_lg_u32 s34, 0
    s_cbranch_scc1 L_done
L_hop2:
    buffer_load_dwordx4 v[224:227], v32, s[48:51], s71 offen sc1
    buffer_load_dwordx4 v[228:231], v32, s[48:51], s37 offen sc1
    s_waitcnt vmcnt(0)
    v_xor_b32 v224, s35, v224
    v_xor_b32 v225, s35, v225
    v_xor_b32 v226, s35, v226
    v_xor_b32 v227, s35, v227
    v_xor_b32 v228, s35, v228
    v_xor_b32 v229, s35, v229
    v_xor_b32 v230, s35, v230
    v_xor_b32 v231, s35, v231
    v_or_b32 v4, v224, v225
    v_or3_b32 v4, v4, v226, v227
    v_or3_b32 v4, v4, v228, v229
    v_or3_b32 v4, v4, v230, v231
    v_and_b32 v4, 0xff, v4
    v_cmp_ne_u32 vcc, 0, v4
    v_add_f32 v232, v224, v228
    v_add_f32 v233, v225, v229
    v_add_f32 v234, v226, v230
    v_add_f32 v235, v227, v231
    s_cbranch_vccz L_hop2ok
    s_sub_u32 s84, s84, 1
    s_cmp_lg_u32 s84, 0
    s_cbranch_scc1 L_hop2
    s_branch L_end
L_hop2ok:
    v_permlane16_swap_b32 v232, v233
    v_permlane16_swap_b32 v234, v235
    v_add_f32 v232, v232, v233
    v_add_f32 v234, v234, v235
    s_nop 1
    v_permlane32_swap_b32 v232, v234
    v_add_f32 v232, v232, v234
    s_nop 1
    v_add_f32_dpp v232, v232, v232 row_ror:8 row_mask:0xf bank_mask:0xf
    s_nop 1
    v_add_f32_dpp v232, v232, v232 row_ror:4 row_mask:0xf bank_mask:0xf
    v_cvt_pk_bf16_f32 v232, v232, v232
    s_mov_b32 exec_lo, 0xf000f
    s_mov_b32 exec_hi, 0xf000f
    buffer_store_short v232, v33, s[72:75], 0 offen
    s_cmp_lg_u32 s2, 0
    s_cbranch_scc1 L_done
    v_mov_b32 v4, 0
    s_mov_b64 exec, 1
    buffer_store_dword v8, v4, s[48:51], 0 offen
L_done:
L_end:
    s_endpgm
L_qp:
    v_lshlrev_b32 v4, 18, v2
    v_lshl_add_u32 v14, v3, 4, v4
    v_lshrrev_b32 v5, 3, v3
    v_lshlrev_b32 v5, 10, v5
    v_lshl_add_u32 v15, v2, 6, v5
    s_cmp_eq_u32 s33, 0
    s_cselect_b32 s61, 3, 2
    s_xor_b32 s61, s61, s32
    s_lshl_b32 s86, s34, 8
    s_lshl_b32 s63, s34, 20
    s_lshl_b32 s38, s61, 8
    s_add_u32 s63, s63, s38
    s_mov_b32 s42, 4194304
    s_mov_b32 s43, 0x20000
    s_mov_b32 s46, 4096
    s_mov_b32 s47, 0x20000
    s_cmp_eq_u32 s33, 0
    s_waitcnt lgkmcnt(0)
    s_cselect_b64 s[40:41], s[22:23], s[8:9]
    s_cselect_b64 s[44:45], s[16:17], s[4:5]
    buffer_load_dwordx4 a[128:131], v14, s[40:43], s63 offen nt
    s_add_u32 s63, s63, 8192
    buffer_load_dwordx4 a[132:135], v14, s[40:43], s63 offen nt
    s_add_u32 s63, s63, 8192
    buffer_load_dwordx4 v[20:23], v15, s[44:47], s86 offen offset:0
    buffer_load_dwordx4 v[36:39], v15, s[44:47], s86 offen offset:2048
    buffer_load_dwordx4 a[136:139], v14, s[40:43], s63 offen nt
    s_add_u32 s63, s63, 8192
    buffer_load_dwordx4 a[140:143], v14, s[40:43], s63 offen nt
    s_add_u32 s63, s63, 8192
    buffer_load_dwordx4 a[144:147], v14, s[40:43], s63 offen nt
    s_add_u32 s63, s63, 8192
    buffer_load_dwordx4 a[148:151], v14, s[40:43], s63 offen nt
    s_add_u32 s63, s63, 8192
    buffer_load_dwordx4 a[152:155], v14, s[40:43], s63 offen nt
    s_add_u32 s63, s63, 8192
    buffer_load_dwordx4 a[156:159], v14, s[40:43], s63 offen nt
    s_add_u32 s63, s63, 8192
    s_load_dword s35, s[30:31], 0
    s_mov_b32 s48, s30
    s_and_b32 s49, s31, 0xffff
    s_mov_b32 s50, 8388608
    s_mov_b32 s51, 0x20000
    s_mov_b32 s82, 0xffffff00
    s_mov_b32 s83, 0x3e0293ee
    s_mov_b32 s84, 8388608
    v_and_b32 v4, 1, v1
    v_lshlrev_b32 v4, 4, v4
    v_mov_b32 v5, 0xffff
    v_lshlrev_b32 v4, v4, v5
    v_bfe_u32 v5, v1, 1, 2
    v_cmp_eq_u32 vcc, 0, v5
    s_nop 1
    v_cndmask_b32 v10, 0, v4, vcc
    v_cmp_eq_u32 vcc, 1, v5
    s_nop 1
    v_cndmask_b32 v11, 0, v4, vcc
    v_cmp_eq_u32 vcc, 2, v5
    s_nop 1
    v_cndmask_b32 v12, 0, v4, vcc
    v_cmp_eq_u32 vcc, 3, v5
    s_nop 1
    v_cndmask_b32 v13, 0, v4, vcc
    buffer_load_dwordx4 v[24:27], v15, s[44:47], s86 offen offset:16
    buffer_load_dwordx4 v[40:43], v15, s[44:47], s86 offen offset:2064
    buffer_load_dwordx4 v[28:31], v15, s[44:47], s86 offen offset:32
    buffer_load_dwordx4 v[44:47], v15, s[44:47], s86 offen offset:2080
    buffer_load_dwordx4 v[32:35], v15, s[44:47], s86 offen offset:48
    buffer_load_dwordx4 v[48:51], v15, s[44:47], s86 offen offset:2096
    s_lshl_b32 s38, s61, 10
    s_add_u32 s36, s38, 65536
    s_lshr_b32 s38, s61, 3
    s_lshl_b32 s38, s38, 8
    s_add_u32 s36, s38, s36
    s_lshl_b32 s38, s34, 23
    s_add_u32 s36, s38, s36
    v_mov_b32 v18, 0
    v_mov_b32 v19, 0
    s_cmp_eq_u32 s33, 0
    s_cselect_b32 s38, s36, 8388608
    s_mov_b64 exec, 1
    buffer_store_dwordx2 v[18:19], v19, s[48:51], s38 offen sc1
    s_mov_b64 exec, -1
    buffer_load_dwordx4 a[160:163], v14, s[40:43], s63 offen nt
    s_add_u32 s63, s63, 8192
    buffer_load_dwordx4 a[164:167], v14, s[40:43], s63 offen nt
    s_add_u32 s63, s63, 8192
    buffer_load_dwordx4 a[168:171], v14, s[40:43], s63 offen nt
    s_add_u32 s63, s63, 8192
    buffer_load_dwordx4 a[172:175], v14, s[40:43], s63 offen nt
    s_add_u32 s63, s63, 8192
    s_mov_b32 s80, 0x01000100
    s_mov_b32 s81, 0x03020302
    s_waitcnt vmcnt(17)
    buffer_load_dwordx4 a[176:179], v14, s[40:43], s63 offen nt
    s_add_u32 s63, s63, 8192
    v_perm_b32 v4, v20, v20, s80
    v_perm_b32 v5, v36, v36, s80
    v_and_b32 v52, v4, v10
    v_and_b32 v53, v4, v11
    v_and_b32 v54, v4, v12
    v_and_b32 v55, v4, v13
    v_and_b32 v56, v5, v10
    v_and_b32 v57, v5, v11
    v_and_b32 v58, v5, v12
    v_and_b32 v59, v5, v13
    v_mfma_f32_16x16x32_bf16 v[60:63], a[128:131], v[52:55], 0
    s_nop 0
    v_mfma_f32_16x16x32_bf16 v[64:67], a[128:131], v[56:59], 0
    buffer_load_dwordx4 a[180:183], v14, s[40:43], s63 offen nt
    s_add_u32 s63, s63, 8192
    v_perm_b32 v4, v20, v20, s81
    v_perm_b32 v5, v36, v36, s81
    v_and_b32 v52, v4, v10
    v_and_b32 v53, v4, v11
    v_and_b32 v54, v4, v12
    v_and_b32 v55, v4, v13
    v_and_b32 v56, v5, v10
    v_and_b32 v57, v5, v11
    v_and_b32 v58, v5, v12
    v_and_b32 v59, v5, v13
    v_mfma_f32_16x16x32_bf16 v[60:63], a[132:135], v[52:55], v[60:63]
    s_nop 0
    v_mfma_f32_16x16x32_bf16 v[64:67], a[132:135], v[56:59], v[64:67]
    s_waitcnt vmcnt(18)
    buffer_load_dwordx4 a[184:187], v14, s[40:43], s63 offen nt
    s_add_u32 s63, s63, 8192
    v_perm_b32 v4, v21, v21, s80
    v_perm_b32 v5, v37, v37, s80
    v_and_b32 v52, v4, v10
    v_and_b32 v53, v4, v11
    v_and_b32 v54, v4, v12
    v_and_b32 v55, v4, v13
    v_and_b32 v56, v5, v10
    v_and_b32 v57, v5, v11
    v_and_b32 v58, v5, v12
    v_and_b32 v59, v5, v13
    v_mfma_f32_16x16x32_bf16 v[60:63], a[136:139], v[52:55], v[60:63]
    s_nop 0
    v_mfma_f32_16x16x32_bf16 v[64:67], a[136:139], v[56:59], v[64:67]
    s_waitcnt vmcnt(18)
    buffer_load_dwordx4 a[188:191], v14, s[40:43], s63 offen nt
    s_add_u32 s63, s63, 8192
    v_perm_b32 v4, v21, v21, s81
    v_perm_b32 v5, v37, v37, s81
    v_and_b32 v52, v4, v10
    v_and_b32 v53, v4, v11
    v_and_b32 v54, v4, v12
    v_and_b32 v55, v4, v13
    v_and_b32 v56, v5, v10
    v_and_b32 v57, v5, v11
    v_and_b32 v58, v5, v12
    v_and_b32 v59, v5, v13
    v_mfma_f32_16x16x32_bf16 v[60:63], a[140:143], v[52:55], v[60:63]
    s_nop 0
    v_mfma_f32_16x16x32_bf16 v[64:67], a[140:143], v[56:59], v[64:67]
    s_waitcnt vmcnt(18)
    buffer_load_dwordx4 a[192:195], v14, s[40:43], s63 offen nt
    s_add_u32 s63, s63, 8192
    v_lshrrev_b32 v4, 2, v3
    v_and_b32 v5, 3, v3
    v_lshlrev_b32 v76, 8, v4
    v_lshlrev_b32 v126, 8, v2
    v_lshl_add_u32 v76, v2, 6, v76
    v_lshl_add_u32 v76, v5, 4, v76
    v_lshl_add_u32 v126, v3, 4, v126
    v_xor_b32 v77, 32768, v76
    v_xor_b32 v127, 32768, v126
    s_add_u32 s3, s34, s33
    s_and_b32 s3, s3, 3
    s_lshl_b32 s89, s3, 5
    s_add_u32 s89, s89, s32
    s_lshl_b32 s89, s89, 20
    s_mul_i32 s88, s32, 8
    s_mul_i32 s38, s3, 2
    s_add_u32 s88, s88, s38
    s_lshl_b32 s87, s33, 1
    v_perm_b32 v4, v22, v22, s80
    v_perm_b32 v5, v38, v38, s80
    v_and_b32 v52, v4, v10
    v_and_b32 v53, v4, v11
    v_and_b32 v54, v4, v12
    v_and_b32 v55, v4, v13
    v_and_b32 v56, v5, v10
    v_and_b32 v57, v5, v11
    v_and_b32 v58, v5, v12
    v_and_b32 v59, v5, v13
    v_mfma_f32_16x16x32_bf16 v[60:63], a[144:147], v[52:55], v[60:63]
    s_nop 0
    v_mfma_f32_16x16x32_bf16 v[64:67], a[144:147], v[56:59], v[64:67]
    s_waitcnt vmcnt(18)
    buffer_load_dwordx4 a[196:199], v14, s[40:43], s63 offen nt
    s_add_u32 s63, s63, 8192
    v_perm_b32 v4, v22, v22, s81
    v_perm_b32 v5, v38, v38, s81
    v_and_b32 v52, v4, v10
    v_and_b32 v53, v4, v11
    v_and_b32 v54, v4, v12
    v_and_b32 v55, v4, v13
    v_and_b32 v56, v5, v10
    v_and_b32 v57, v5, v11
    v_and_b32 v58, v5, v12
    v_and_b32 v59, v5, v13
    v_mfma_f32_16x16x32_bf16 v[60:63], a[148:151], v[52:55], v[60:63]
    s_nop 0
    v_mfma_f32_16x16x32_bf16 v[64:67], a[148:151], v[56:59], v[64:67]
    s_waitcnt vmcnt(18)
    buffer_load_dwordx4 a[200:203], v14, s[40:43], s63 offen nt
    s_add_u32 s63, s63, 8192
    v_perm_b32 v4, v23, v23, s80
    v_perm_b32 v5, v39, v39, s80
    v_and_b32 v52, v4, v10
    v_and_b32 v53, v4, v11
    v_and_b32 v54, v4, v12
    v_and_b32 v55, v4, v13
    v_and_b32 v56, v5, v10
    v_and_b32 v57, v5, v11
    v_and_b32 v58, v5, v12
    v_and_b32 v59, v5, v13
    v_mfma_f32_16x16x32_bf16 v[60:63], a[152:155], v[52:55], v[60:63]
    s_nop 0
    v_mfma_f32_16x16x32_bf16 v[64:67], a[152:155], v[56:59], v[64:67]
    s_waitcnt vmcnt(18)
    buffer_load_dwordx4 a[204:207], v14, s[40:43], s63 offen nt
    s_add_u32 s63, s63, 8192
    v_perm_b32 v4, v23, v23, s81
    v_perm_b32 v5, v39, v39, s81
    v_and_b32 v52, v4, v10
    v_and_b32 v53, v4, v11
    v_and_b32 v54, v4, v12
    v_and_b32 v55, v4, v13
    v_and_b32 v56, v5, v10
    v_and_b32 v57, v5, v11
    v_and_b32 v58, v5, v12
    v_and_b32 v59, v5, v13
    v_mfma_f32_16x16x32_bf16 v[60:63], a[156:159], v[52:55], v[60:63]
    s_nop 0
    v_mfma_f32_16x16x32_bf16 v[64:67], a[156:159], v[56:59], v[64:67]
    s_waitcnt vmcnt(17)
    s_waitcnt vmcnt(11)
    buffer_load_dwordx4 a[208:211], v14, s[40:43], s63 offen nt
    s_add_u32 s63, s63, 8192
    s_mov_b32 s52, s18
    s_and_b32 s53, s19, 0xffff
    s_mov_b32 s54, 134217728
    s_mov_b32 s55, 0x20000
    s_mov_b32 s56, s20
    s_and_b32 s57, s21, 0xffff
    s_mov_b32 s58, 134217728
    s_mov_b32 s59, 0x20000
    v_perm_b32 v4, v24, v24, s80
    v_perm_b32 v5, v40, v40, s80
    v_and_b32 v52, v4, v10
    v_and_b32 v53, v4, v11
    v_and_b32 v54, v4, v12
    v_and_b32 v55, v4, v13
    v_and_b32 v56, v5, v10
    v_and_b32 v57, v5, v11
    v_and_b32 v58, v5, v12
    v_and_b32 v59, v5, v13
    v_mfma_f32_16x16x32_bf16 v[60:63], a[160:163], v[52:55], v[60:63]
    s_nop 0
    v_mfma_f32_16x16x32_bf16 v[64:67], a[160:163], v[56:59], v[64:67]
    s_waitcnt vmcnt(11)
    buffer_load_dwordx4 a[212:215], v14, s[40:43], s63 offen nt
    s_add_u32 s63, s63, 8192
    v_perm_b32 v4, v24, v24, s81
    v_perm_b32 v5, v40, v40, s81
    v_and_b32 v52, v4, v10
    v_and_b32 v53, v4, v11
    v_and_b32 v54, v4, v12
    v_and_b32 v55, v4, v13
    v_and_b32 v56, v5, v10
    v_and_b32 v57, v5, v11
    v_and_b32 v58, v5, v12
    v_and_b32 v59, v5, v13
    v_mfma_f32_16x16x32_bf16 v[60:63], a[164:167], v[52:55], v[60:63]
    s_nop 0
    v_mfma_f32_16x16x32_bf16 v[64:67], a[164:167], v[56:59], v[64:67]
    s_waitcnt vmcnt(11)
    buffer_load_dwordx4 a[216:219], v14, s[40:43], s63 offen nt
    s_add_u32 s63, s63, 8192
    v_perm_b32 v4, v25, v25, s80
    v_perm_b32 v5, v41, v41, s80
    v_and_b32 v52, v4, v10
    v_and_b32 v53, v4, v11
    v_and_b32 v54, v4, v12
    v_and_b32 v55, v4, v13
    v_and_b32 v56, v5, v10
    v_and_b32 v57, v5, v11
    v_and_b32 v58, v5, v12
    v_and_b32 v59, v5, v13
    v_mfma_f32_16x16x32_bf16 v[60:63], a[168:171], v[52:55], v[60:63]
    s_nop 0
    v_mfma_f32_16x16x32_bf16 v[64:67], a[168:171], v[56:59], v[64:67]
    s_waitcnt vmcnt(11)
    buffer_load_dwordx4 a[220:223], v14, s[40:43], s63 offen nt
    s_add_u32 s63, s63, 8192
    v_perm_b32 v4, v25, v25, s81
    v_perm_b32 v5, v41, v41, s81
    v_and_b32 v52, v4, v10
    v_and_b32 v53, v4, v11
    v_and_b32 v54, v4, v12
    v_and_b32 v55, v4, v13
    v_and_b32 v56, v5, v10
    v_and_b32 v57, v5, v11
    v_and_b32 v58, v5, v12
    v_and_b32 v59, v5, v13
    v_mfma_f32_16x16x32_bf16 v[60:63], a[172:175], v[52:55], v[60:63]
    s_nop 0
    v_mfma_f32_16x16x32_bf16 v[64:67], a[172:175], v[56:59], v[64:67]
    s_waitcnt vmcnt(11)
    buffer_load_dwordx4 a[224:227], v14, s[40:43], s63 offen nt
    s_add_u32 s63, s63, 8192
    v_mov_b32 v120, 0xff7f0000
    v_mov_b32 v121, 0
    v_mov_b32 v18, 1
    v_mov_b32 v116, 0
    v_mov_b32 v117, 0
    v_mov_b32 v118, 0
    v_mov_b32 v119, 0
    v_lshlrev_b32 v0, 3, v1
    ds_write_b64 v0, v[116:117] offset:8192
    v_mov_b32 v0, 8192
    s_lshl_b32 s38, s32, 10
    s_add_u32 s96, s38, 65536
    s_lshr_b32 s38, s32, 3
    s_lshl_b32 s38, s38, 8
    s_add_u32 s96, s38, s96
    v_mov_b32 v9, s96
    s_lshl_b32 s38, s32, 15
    s_add_u32 s96, s38, 1048576
    s_lshl_b32 s38, s3, 13
    s_add_u32 s96, s38, s96
    s_lshl_b32 s38, s33, 10
    s_add_u32 s96, s38, s96
    v_and_b32 v5, 3, v3
    v_lshlrev_b32 v78, 7, v2
    v_lshl_add_u32 v78, v5, 5, v78
    s_lshl_b32 s38, s32, 12
    s_add_u32 s91, s38, 262144
    s_lshl_b32 s38, s3, 9
    s_add_u32 s91, s38, s91
    v_lshlrev_b32 v4, 7, v2
    v_lshl_add_u32 v4, v3, 4, v4
    v_mov_b32 v5, 512
    v_cmp_gt_u32 vcc, 8, v3
    s_nop 1
    v_cndmask_b32 v79, v5, v4, vcc
    v_perm_b32 v4, v26, v26, s80
    v_perm_b32 v5, v42, v42, s80
    v_and_b32 v52, v4, v10
    v_and_b32 v53, v4, v11
    v_and_b32 v54, v4, v12
    v_and_b32 v55, v4, v13
    v_and_b32 v56, v5, v10
    v_and_b32 v57, v5, v11
    v_and_b32 v58, v5, v12
    v_and_b32 v59, v5, v13
    v_mfma_f32_16x16x32_bf16 v[60:63], a[176:179], v[52:55], v[60:63]
    s_nop 0
    v_mfma_f32_16x16x32_bf16 v[64:67], a[176:179], v[56:59], v[64:67]
    s_waitcnt vmcnt(11)
    buffer_load_dwordx4 a[228:231], v14, s[40:43], s63 offen nt
    s_add_u32 s63, s63, 8192
    v_perm_b32 v4, v26, v26, s81
    v_perm_b32 v5, v42, v42, s81
    v_and_b32 v52, v4, v10
    v_and_b32 v53, v4, v11
    v_and_b32 v54, v4, v12
    v_and_b32 v55, v4, v13
    v_and_b32 v56, v5, v10
    v_and_b32 v57, v5, v11
    v_and_b32 v58, v5, v12
    v_and_b32 v59, v5, v13
    v_mfma_f32_16x16x32_bf16 v[60:63], a[180:183], v[52:55], v[60:63]
    s_nop 0
    v_mfma_f32_16x16x32_bf16 v[64:67], a[180:183], v[56:59], v[64:67]
    s_waitcnt vmcnt(11)
    buffer_load_dwordx4 a[232:235], v14, s[40:43], s63 offen nt
    s_add_u32 s63, s63, 8192
    v_perm_b32 v4, v27, v27, s80
    v_perm_b32 v5, v43, v43, s80
    v_and_b32 v52, v4, v10
    v_and_b32 v53, v4, v11
    v_and_b32 v54, v4, v12
    v_and_b32 v55, v4, v13
    v_and_b32 v56, v5, v10
    v_and_b32 v57, v5, v11
    v_and_b32 v58, v5, v12
    v_and_b32 v59, v5, v13
    v_mfma_f32_16x16x32_bf16 v[60:63], a[184:187], v[52:55], v[60:63]
    s_nop 0
    v_mfma_f32_16x16x32_bf16 v[64:67], a[184:187], v[56:59], v[64:67]
    s_waitcnt vmcnt(11)
    buffer_load_dwordx4 a[236:239], v14, s[40:43], s63 offen nt
    s_add_u32 s63, s63, 8192
    v_perm_b32 v4, v27, v27, s81
    v_perm_b32 v5, v43, v43, s81
    v_and_b32 v52, v4, v10
    v_and_b32 v53, v4, v11
    v_and_b32 v54, v4, v12
    v_and_b32 v55, v4, v13
    v_and_b32 v56, v5, v10
    v_and_b32 v57, v5, v11
    v_and_b32 v58, v5, v12
    v_and_b32 v59, v5, v13
    v_mfma_f32_16x16x32_bf16 v[60:63], a[188:191], v[52:55], v[60:63]
    s_nop 0
    v_mfma_f32_16x16x32_bf16 v[64:67], a[188:191], v[56:59], v[64:67]
    s_waitcnt vmcnt(11)
    buffer_load_dwordx4 a[240:243], v14, s[40:43], s63 offen nt
    s_add_u32 s63, s63, 8192
    v_perm_b32 v4, v28, v28, s80
    v_perm_b32 v5, v44, v44, s80
    v_and_b32 v52, v4, v10
    v_and_b32 v53, v4, v11
    v_and_b32 v54, v4, v12
    v_and_b32 v55, v4, v13
    v_and_b32 v56, v5, v10
    v_and_b32 v57, v5, v11
    v_and_b32 v58, v5, v12
    v_and_b32 v59, v5, v13
    v_mfma_f32_16x16x32_bf16 v[60:63], a[192:195], v[52:55], v[60:63]
    s_nop 0
    v_mfma_f32_16x16x32_bf16 v[64:67], a[192:195], v[56:59], v[64:67]
    s_waitcnt vmcnt(11)
    buffer_load_dwordx4 a[244:247], v14, s[40:43], s63 offen nt
    s_add_u32 s63, s63, 8192
    v_perm_b32 v4, v28, v28, s81
    v_perm_b32 v5, v44, v44, s81
    v_and_b32 v52, v4, v10
    v_and_b32 v53, v4, v11
    v_and_b32 v54, v4, v12
    v_and_b32 v55, v4, v13
    v_and_b32 v56, v5, v10
    v_and_b32 v57, v5, v11
    v_and_b32 v58, v5, v12
    v_and_b32 v59, v5, v13
    v_mfma_f32_16x16x32_bf16 v[60:63], a[196:199], v[52:55], v[60:63]
    s_nop 0
    v_mfma_f32_16x16x32_bf16 v[64:67], a[196:199], v[56:59], v[64:67]
    s_waitcnt vmcnt(11)
    buffer_load_dwordx4 a[248:251], v14, s[40:43], s63 offen nt
    s_add_u32 s63, s63, 8192
    v_perm_b32 v4, v29, v29, s80
    v_perm_b32 v5, v45, v45, s80
    v_and_b32 v52, v4, v10
    v_and_b32 v53, v4, v11
    v_and_b32 v54, v4, v12
    v_and_b32 v55, v4, v13
    v_and_b32 v56, v5, v10
    v_and_b32 v57, v5, v11
    v_and_b32 v58, v5, v12
    v_and_b32 v59, v5, v13
    v_mfma_f32_16x16x32_bf16 v[60:63], a[200:203], v[52:55], v[60:63]
    s_nop 0
    v_mfma_f32_16x16x32_bf16 v[64:67], a[200:203], v[56:59], v[64:67]
    s_waitcnt vmcnt(11)
    buffer_load_dwordx4 a[252:255], v14, s[40:43], s63 offen nt
    s_add_u32 s63, s63, 8192
    v_perm_b32 v4, v29, v29, s81
    v_perm_b32 v5, v45, v45, s81
    v_and_b32 v52, v4, v10
    v_and_b32 v53, v4, v11
    v_and_b32 v54, v4, v12
    v_and_b32 v55, v4, v13
    v_and_b32 v56, v5, v10
    v_and_b32 v57, v5, v11
    v_and_b32 v58, v5, v12
    v_and_b32 v59, v5, v13
    v_mfma_f32_16x16x32_bf16 v[60:63], a[204:207], v[52:55], v[60:63]
    s_nop 0
    v_mfma_f32_16x16x32_bf16 v[64:67], a[204:207], v[56:59], v[64:67]
    s_waitcnt vmcnt(11)
    v_perm_b32 v4, v30, v30, s80
    v_perm_b32 v5, v46, v46, s80
    v_and_b32 v52, v4, v10
    v_and_b32 v53, v4, v11
    v_and_b32 v54, v4, v12
    v_and_b32 v55, v4, v13
    v_and_b32 v56, v5, v10
    v_and_b32 v57, v5, v11
    v_and_b32 v58, v5, v12
    v_and_b32 v59, v5, v13
    v_mfma_f32_16x16x32_bf16 v[60:63], a[208:211], v[52:55], v[60:63]
    s_nop 0
    v_mfma_f32_16x16x32_bf16 v[64:67], a[208:211], v[56:59], v[64:67]
    s_waitcnt vmcnt(10)
    v_perm_b32 v4, v30, v30, s81
    v_perm_b32 v5, v46, v46, s81
    v_and_b32 v52, v4, v10
    v_and_b32 v53, v4, v11
    v_and_b32 v54, v4, v12
    v_and_b32 v55, v4, v13
    v_and_b32 v56, v5, v10
    v_and_b32 v57, v5, v11
    v_and_b32 v58, v5, v12
    v_and_b32 v59, v5, v13
    v_mfma_f32_16x16x32_bf16 v[60:63], a[212:215], v[52:55], v[60:63]
    s_nop 0
    v_mfma_f32_16x16x32_bf16 v[64:67], a[212:215], v[56:59], v[64:67]
    s_waitcnt vmcnt(9)
    v_perm_b32 v4, v31, v31, s80
    v_perm_b32 v5, v47, v47, s80
    v_and_b32 v52, v4, v10
    v_and_b32 v53, v4, v11
    v_and_b32 v54, v4, v12
    v_and_b32 v55, v4, v13
    v_and_b32 v56, v5, v10
    v_and_b32 v57, v5, v11
    v_and_b32 v58, v5, v12
    v_and_b32 v59, v5, v13
    v_mfma_f32_16x16x32_bf16 v[60:63], a[216:219], v[52:55], v[60:63]
    s_nop 0
    v_mfma_f32_16x16x32_bf16 v[64:67], a[216:219], v[56:59], v[64:67]
    s_waitcnt vmcnt(8)
    v_perm_b32 v4, v31, v31, s81
    v_perm_b32 v5, v47, v47, s81
    v_and_b32 v52, v4, v10
    v_and_b32 v53, v4, v11
    v_and_b32 v54, v4, v12
    v_and_b32 v55, v4, v13
    v_and_b32 v56, v5, v10
    v_and_b32 v57, v5, v11
    v_and_b32 v58, v5, v12
    v_and_b32 v59, v5, v13
    v_mfma_f32_16x16x32_bf16 v[60:63], a[220:223], v[52:55], v[60:63]
    s_nop 0
    v_mfma_f32_16x16x32_bf16 v[64:67], a[220:223], v[56:59], v[64:67]
    s_waitcnt vmcnt(7)
    v_perm_b32 v4, v32, v32, s80
    v_perm_b32 v5, v48, v48, s80
    v_and_b32 v52, v4, v10
    v_and_b32 v53, v4, v11
    v_and_b32 v54, v4, v12
    v_and_b32 v55, v4, v13
    v_and_b32 v56, v5, v10
    v_and_b32 v57, v5, v11
    v_and_b32 v58, v5, v12
    v_and_b32 v59, v5, v13
    v_mfma_f32_16x16x32_bf16 v[60:63], a[224:227], v[52:55], v[60:63]
    s_nop 0
    v_mfma_f32_16x16x32_bf16 v[64:67], a[224:227], v[56:59], v[64:67]
    s_waitcnt vmcnt(6)
    s_add_u32 s39, s87, s88
    s_bfe_u32 s37, s39, 0x10000
    s_lshl_b32 s37, s37, 13
    s_add_u32 s85, s37, s89
    s_bfe_u32 s37, s39, 0x10001
    s_lshl_b32 s37, s37, 12
    s_add_u32 s85, s37, s85
    s_bfe_u32 s37, s39, 0x10002
    s_lshl_b32 s37, s37, 11
    s_add_u32 s85, s37, s85
    s_bfe_u32 s37, s39, 0x10003
    s_lshl_b32 s37, s37, 14
    s_add_u32 s85, s37, s85
    s_bfe_u32 s37, s39, 0x40004
    s_lshl_b32 s37, s37, 16
    s_add_u32 s85, s37, s85
    buffer_load_dwordx4 v[128:131], v76, s[52:55], s85 offen offset:0 nt
    v_perm_b32 v4, v32, v32, s81
    v_perm_b32 v5, v48, v48, s81
    v_and_b32 v52, v4, v10
    v_and_b32 v53, v4, v11
    v_and_b32 v54, v4, v12
    v_and_b32 v55, v4, v13
    v_and_b32 v56, v5, v10
    v_and_b32 v57, v5, v11
    v_and_b32 v58, v5, v12
    v_and_b32 v59, v5, v13
    v_mfma_f32_16x16x32_bf16 v[60:63], a[228:231], v[52:55], v[60:63]
    s_nop 0
    v_mfma_f32_16x16x32_bf16 v[64:67], a[228:231], v[56:59], v[64:67]
    s_waitcnt vmcnt(6)
    buffer_load_dwordx4 v[132:135], v77, s[52:55], s85 offen offset:0 nt
    v_perm_b32 v4, v33, v33, s80
    v_perm_b32 v5, v49, v49, s80
    v_and_b32 v52, v4, v10
    v_and_b32 v53, v4, v11
    v_and_b32 v54, v4, v12
    v_and_b32 v55, v4, v13
    v_and_b32 v56, v5, v10
    v_and_b32 v57, v5, v11
    v_and_b32 v58, v5, v12
    v_and_b32 v59, v5, v13
    v_mfma_f32_16x16x32_bf16 v[60:63], a[232:235], v[52:55], v[60:63]
    s_nop 0
    v_mfma_f32_16x16x32_bf16 v[64:67], a[232:235], v[56:59], v[64:67]
    s_waitcnt vmcnt(6)
    buffer_load_dwordx4 v[136:139], v76, s[52:55], s85 offen offset:1024 nt
    v_perm_b32 v4, v33, v33, s81
    v_perm_b32 v5, v49, v49, s81
    v_and_b32 v52, v4, v10
    v_and_b32 v53, v4, v11
    v_and_b32 v54, v4, v12
    v_and_b32 v55, v4, v13
    v_and_b32 v56, v5, v10
    v_and_b32 v57, v5, v11
    v_and_b32 v58, v5, v12
    v_and_b32 v59, v5, v13
    v_mfma_f32_16x16x32_bf16 v[60:63], a[236:239], v[52:55], v[60:63]
    s_nop 0
    v_mfma_f32_16x16x32_bf16 v[64:67], a[236:239], v[56:59], v[64:67]
    s_waitcnt vmcnt(6)
    buffer_load_dwordx4 v[140:143], v77, s[52:55], s85 offen offset:1024 nt
    s_add_u32 s87, s87, 1
    s_add_u32 s39, s87, s88
    s_bfe_u32 s37, s39, 0x10000
    s_lshl_b32 s37, s37, 13
    s_add_u32 s85, s37, s89
    s_bfe_u32 s37, s39, 0x10001
    s_lshl_b32 s37, s37, 12
    s_add_u32 s85, s37, s85
    s_bfe_u32 s37, s39, 0x10002
    s_lshl_b32 s37, s37, 11
    s_add_u32 s85, s37, s85
    s_bfe_u32 s37, s39, 0x10003
    s_lshl_b32 s37, s37, 14
    s_add_u32 s85, s37, s85
    s_bfe_u32 s37, s39, 0x40004
    s_lshl_b32 s37, s37, 16
    s_add_u32 s85, s37, s85
    v_perm_b32 v4, v34, v34, s80
    v_perm_b32 v5, v50, v50, s80
    v_and_b32 v52, v4, v10
    v_and_b32 v53, v4, v11
    v_and_b32 v54, v4, v12
    v_and_b32 v55, v4, v13
    v_and_b32 v56, v5, v10
    v_and_b32 v57, v5, v11
    v_and_b32 v58, v5, v12
    v_and_b32 v59, v5, v13
    v_mfma_f32_16x16x32_bf16 v[60:63], a[240:243], v[52:55], v[60:63]
    s_nop 0
    v_mfma_f32_16x16x32_bf16 v[64:67], a[240:243], v[56:59], v[64:67]
    s_waitcnt vmcnt(6)
    buffer_load_dwordx4 v[144:147], v76, s[52:55], s85 offen offset:0 nt
    v_perm_b32 v4, v34, v34, s81
    v_perm_b32 v5, v50, v50, s81
    v_and_b32 v52, v4, v10
    v_and_b32 v53, v4, v11
    v_and_b32 v54, v4, v12
    v_and_b32 v55, v4, v13
    v_and_b32 v56, v5, v10
    v_and_b32 v57, v5, v11
    v_and_b32 v58, v5, v12
    v_and_b32 v59, v5, v13
    v_mfma_f32_16x16x32_bf16 v[60:63], a[244:247], v[52:55], v[60:63]
    s_nop 0
    v_mfma_f32_16x16x32_bf16 v[64:67], a[244:247], v[56:59], v[64:67]
    s_waitcnt vmcnt(6)
    buffer_load_dwordx4 v[148:151], v77, s[52:55], s85 offen offset:0 nt
    v_perm_b32 v4, v35, v35, s80
    v_perm_b32 v5, v51, v51, s80
    v_and_b32 v52, v4, v10
    v_and_b32 v53, v4, v11
    v_and_b32 v54, v4, v12
    v_and_b32 v55, v4, v13
    v_and_b32 v56, v5, v10
    v_and_b32 v57, v5, v11
    v_and_b32 v58, v5, v12
    v_and_b32 v59, v5, v13
    v_mfma_f32_16x16x32_bf16 v[60:63], a[248:251], v[52:55], v[60:63]
    s_nop 0
    v_mfma_f32_16x16x32_bf16 v[64:67], a[248:251], v[56:59], v[64:67]
    s_waitcnt vmcnt(6)
    buffer_load_dwordx4 v[152:155], v76, s[52:55], s85 offen offset:1024 nt
    v_perm_b32 v4, v35, v35, s81
    v_perm_b32 v5, v51, v51, s81
    v_and_b32 v52, v4, v10
    v_and_b32 v53, v4, v11
    v_and_b32 v54, v4, v12
    v_and_b32 v55, v4, v13
    v_and_b32 v56, v5, v10
    v_and_b32 v57, v5, v11
    v_and_b32 v58, v5, v12
    v_and_b32 v59, v5, v13
    v_mfma_f32_16x16x32_bf16 v[60:63], a[252:255], v[52:55], v[60:63]
    s_nop 0
    v_mfma_f32_16x16x32_bf16 v[64:67], a[252:255], v[56:59], v[64:67]
    s_lshl_b32 s38, s34, 11
    v_lshrrev_b32 v4, 3, v3
    v_lshlrev_b32 v4, 9, v4
    v_lshl_add_u32 v4, v2, 7, v4
    v_and_b32 v5, 7, v3
    v_lshl_add_u32 v4, v5, 2, v4
    v_add_u32 v4, s38, v4
    ds_write_b32 v4, v60 offset:0
    ds_write_b32 v4, v61 offset:32
    ds_write_b32 v4, v62 offset:64
    ds_write_b32 v4, v63 offset:96
    ds_write_b32 v4, v64 offset:1024
    ds_write_b32 v4, v65 offset:1056
    ds_write_b32 v4, v66 offset:1088
    ds_write_b32 v4, v67 offset:1120
    s_lshl_b32 s38, s34, 9
    v_and_b32 v5, 31, v1
    v_lshl_add_u32 v5, v5, 4, s38
    s_waitcnt lgkmcnt(0)
    s_add_u32 s35, s35, 0x5b
    s_and_b32 s35, s35, 0xff
    v_mov_b32 v8, s35
    s_barrier
    ds_read_b128 v[20:23], v5 offset:0
    ds_read_b128 v[24:27], v5 offset:2048
    ds_read_b128 v[28:31], v5 offset:4096
    ds_read_b128 v[32:35], v5 offset:6144
    s_lshl_b32 s38, s61, 12
    s_add_u32 s36, s38, 262144
    s_lshl_b32 s38, s33, 11
    s_add_u32 s36, s38, s36
    s_waitcnt lgkmcnt(0)
    v_add_f32 v20, v20, v24
    v_add_f32 v28, v28, v32
    v_add_f32 v21, v21, v25
    v_add_f32 v29, v29, v33
    v_add_f32 v22, v22, v26
    v_add_f32 v30, v30, v34
    v_add_f32 v23, v23, v27
    v_add_f32 v31, v31, v35
    v_add_f32 v20, v20, v28
    v_add_f32 v21, v21, v29
    v_add_f32 v22, v22, v30
    v_add_f32 v23, v23, v31
    s_mov_b32 s38, 0xffff0000
    v_cvt_pk_bf16_f32 v20, v20, v20
    v_cvt_pk_bf16_f32 v21, v21, v21
    v_cvt_pk_bf16_f32 v22, v22, v22
    v_cvt_pk_bf16_f32 v23, v23, v23
    v_and_or_b32 v20, v20, s38, v8
    v_and_or_b32 v21, v21, s38, v8
    v_and_or_b32 v22, v22, s38, v8
    v_and_or_b32 v23, v23, s38, v8
    s_mov_b32 exec_lo, 0xffffffff
    s_mov_b32 exec_hi, 0x0
    buffer_store_dwordx4 v[20:23], v5, s[48:51], s36 offen sc1
    s_mov_b64 exec, -1
    s_waitcnt vmcnt(7)
    buffer_load_dwordx4 v[156:159], v77, s[52:55], s85 offen offset:1024 nt
    s_add_u32 s87, s87, 13
    s_add_u32 s39, s87, s88
    s_bfe_u32 s37, s39, 0x10000
    s_lshl_b32 s37, s37, 13
    s_add_u32 s85, s37, s89
    s_bfe_u32 s37, s39, 0x10001
    s_lshl_b32 s37, s37, 12
    s_add_u32 s85, s37, s85
    s_bfe_u32 s37, s39, 0x10002
    s_lshl_b32 s37, s37, 11
    s_add_u32 s85, s37, s85
    s_bfe_u32 s37, s39, 0x10003
    s_lshl_b32 s37, s37, 14
    s_add_u32 s85, s37, s85
    s_bfe_u32 s37, s39, 0x40004
    s_lshl_b32 s37, s37, 16
    s_add_u32 s85, s37, s85
    s_waitcnt vmcnt(7)
    buffer_load_dwordx4 v[160:163], v76, s[52:55], s85 offen offset:0 nt
    s_waitcnt vmcnt(7)
    buffer_load_dwordx4 v[164:167], v77, s[52:55], s85 offen offset:0 nt
    s_waitcnt vmcnt(7)
    buffer_load_dwordx4 v[168:171], v76, s[52:55], s85 offen offset:1024 nt
    s_waitcnt vmcnt(7)
    buffer_load_dwordx4 v[172:175], v77, s[52:55], s85 offen offset:1024 nt
    s_add_u32 s87, s87, 1
    s_add_u32 s39, s87, s88
    s_bfe_u32 s37, s39, 0x10000
    s_lshl_b32 s37, s37, 13
    s_add_u32 s85, s37, s89
    s_bfe_u32 s37, s39, 0x10001
    s_lshl_b32 s37, s37, 12
    s_add_u32 s85, s37, s85
    s_bfe_u32 s37, s39, 0x10002
    s_lshl_b32 s37, s37, 11
    s_add_u32 s85, s37, s85
    s_bfe_u32 s37, s39, 0x10003
    s_lshl_b32 s37, s37, 14
    s_add_u32 s85, s37, s85
    s_bfe_u32 s37, s39, 0x40004
    s_lshl_b32 s37, s37, 16
    s_add_u32 s85, s37, s85
    s_waitcnt vmcnt(7)
    buffer_load_dwordx4 v[176:179], v76, s[52:55], s85 offen offset:0 nt
    s_waitcnt vmcnt(7)
    buffer_load_dwordx4 v[180:183], v77, s[52:55], s85 offen offset:0 nt
    s_waitcnt vmcnt(6)
    buffer_load_dwordx4 v[184:187], v76, s[52:55], s85 offen offset:1024 nt
    s_waitcnt vmcnt(6)
    buffer_load_dwordx4 v[188:191], v77, s[52:55], s85 offen offset:1024 nt
    s_add_u32 s87, s87, 13
    s_add_u32 s39, s87, s88
    s_bfe_u32 s37, s39, 0x10000
    s_lshl_b32 s37, s37, 13
    s_add_u32 s85, s37, s89
    s_bfe_u32 s37, s39, 0x10001
    s_lshl_b32 s37, s37, 12
    s_add_u32 s85, s37, s85
    s_bfe_u32 s37, s39, 0x10002
    s_lshl_b32 s37, s37, 11
    s_add_u32 s85, s37, s85
    s_bfe_u32 s37, s39, 0x10003
    s_lshl_b32 s37, s37, 14
    s_add_u32 s85, s37, s85
    s_bfe_u32 s37, s39, 0x40004
    s_lshl_b32 s37, s37, 16
    s_add_u32 s85, s37, s85
    s_waitcnt vmcnt(6)
    buffer_load_dwordx4 v[192:195], v76, s[52:55], s85 offen offset:0 nt
    s_waitcnt vmcnt(6)
    buffer_load_dwordx4 v[196:199], v77, s[52:55], s85 offen offset:0 nt
    s_waitcnt vmcnt(6)
    buffer_load_dwordx4 v[200:203], v76, s[52:55], s85 offen offset:1024 nt
    s_waitcnt vmcnt(6)
    buffer_load_dwordx4 v[204:207], v77, s[52:55], s85 offen offset:1024 nt
    s_add_u32 s87, s87, 1
    s_add_u32 s39, s87, s88
    s_bfe_u32 s37, s39, 0x10000
    s_lshl_b32 s37, s37, 13
    s_add_u32 s85, s37, s89
    s_bfe_u32 s37, s39, 0x10001
    s_lshl_b32 s37, s37, 12
    s_add_u32 s85, s37, s85
    s_bfe_u32 s37, s39, 0x10002
    s_lshl_b32 s37, s37, 11
    s_add_u32 s85, s37, s85
    s_bfe_u32 s37, s39, 0x10003
    s_lshl_b32 s37, s37, 14
    s_add_u32 s85, s37, s85
    s_bfe_u32 s37, s39, 0x40004
    s_lshl_b32 s37, s37, 16
    s_add_u32 s85, s37, s85
    s_waitcnt vmcnt(6)
    buffer_load_dwordx4 v[208:211], v76, s[52:55], s85 offen offset:0 nt
    s_waitcnt vmcnt(6)
    buffer_load_dwordx4 v[212:215], v77, s[52:55], s85 offen offset:0 nt
    s_waitcnt vmcnt(6)
    buffer_load_dwordx4 v[216:219], v76, s[52:55], s85 offen offset:1024 nt
    s_waitcnt vmcnt(6)
    buffer_load_dwordx4 v[220:223], v77, s[52:55], s85 offen offset:1024 nt
    s_add_u32 s87, s87, 13
    s_add_u32 s39, s87, s88
    s_bfe_u32 s37, s39, 0x10000
    s_lshl_b32 s37, s37, 13
    s_add_u32 s85, s37, s89
    s_bfe_u32 s37, s39, 0x10001
    s_lshl_b32 s37, s37, 12
    s_add_u32 s85, s37, s85
    s_bfe_u32 s37, s39, 0x10002
    s_lshl_b32 s37, s37, 11
    s_add_u32 s85, s37, s85
    s_bfe_u32 s37, s39, 0x10003
    s_lshl_b32 s37, s37, 14
    s_add_u32 s85, s37, s85
    s_bfe_u32 s37, s39, 0x40004
    s_lshl_b32 s37, s37, 16
    s_add_u32 s85, s37, s85
    s_waitcnt vmcnt(6)
    buffer_load_dwordx4 v[224:227], v76, s[52:55], s85 offen offset:0 nt
    s_waitcnt vmcnt(6)
    buffer_load_dwordx4 v[228:231], v77, s[52:55], s85 offen offset:0 nt
    s_waitcnt vmcnt(6)
    buffer_load_dwordx4 v[232:235], v76, s[52:55], s85 offen offset:1024 nt
    s_waitcnt vmcnt(6)
    buffer_load_dwordx4 v[236:239], v77, s[52:55], s85 offen offset:1024 nt
    s_add_u32 s87, s87, 1
    s_add_u32 s39, s87, s88
    s_bfe_u32 s37, s39, 0x10000
    s_lshl_b32 s37, s37, 13
    s_add_u32 s85, s37, s89
    s_bfe_u32 s37, s39, 0x10001
    s_lshl_b32 s37, s37, 12
    s_add_u32 s85, s37, s85
    s_bfe_u32 s37, s39, 0x10002
    s_lshl_b32 s37, s37, 11
    s_add_u32 s85, s37, s85
    s_bfe_u32 s37, s39, 0x10003
    s_lshl_b32 s37, s37, 14
    s_add_u32 s85, s37, s85
    s_bfe_u32 s37, s39, 0x40004
    s_lshl_b32 s37, s37, 16
    s_add_u32 s85, s37, s85
    s_waitcnt vmcnt(6)
    buffer_load_dwordx4 v[240:243], v76, s[52:55], s85 offen offset:0 nt
    s_waitcnt vmcnt(6)
    buffer_load_dwordx4 v[244:247], v77, s[52:55], s85 offen offset:0 nt
    s_waitcnt vmcnt(6)
    buffer_load_dwordx4 v[248:251], v76, s[52:55], s85 offen offset:1024 nt
    s_waitcnt vmcnt(6)
    buffer_load_dwordx4 v[252:255], v77, s[52:55], s85 offen offset:1024 nt
    s_add_u32 s87, s87, 13
    s_add_u32 s39, s87, s88
    s_bfe_u32 s37, s39, 0x10000
    s_lshl_b32 s37, s37, 13
    s_add_u32 s85, s37, s89
    s_bfe_u32 s37, s39, 0x10001
    s_lshl_b32 s37, s37, 12
    s_add_u32 s85, s37, s85
    s_bfe_u32 s37, s39, 0x10002
    s_lshl_b32 s37, s37, 11
    s_add_u32 s85, s37, s85
    s_bfe_u32 s37, s39, 0x10003
    s_lshl_b32 s37, s37, 14
    s_add_u32 s85, s37, s85
    s_bfe_u32 s37, s39, 0x40004
    s_lshl_b32 s37, s37, 16
    s_add_u32 s85, s37, s85
    s_waitcnt vmcnt(6)
    buffer_load_dwordx4 a[0:3], v76, s[52:55], s85 offen offset:0 nt
    s_waitcnt vmcnt(6)
    buffer_load_dwordx4 a[4:7], v77, s[52:55], s85 offen offset:0 nt
    s_waitcnt vmcnt(6)
    buffer_load_dwordx4 a[8:11], v76, s[52:55], s85 offen offset:1024 nt
    s_waitcnt vmcnt(6)
    buffer_load_dwordx4 a[12:15], v77, s[52:55], s85 offen offset:1024 nt
    s_add_u32 s87, s87, 1
    s_add_u32 s39, s87, s88
    s_bfe_u32 s37, s39, 0x10000
    s_lshl_b32 s37, s37, 13
    s_add_u32 s85, s37, s89
    s_bfe_u32 s37, s39, 0x10001
    s_lshl_b32 s37, s37, 12
    s_add_u32 s85, s37, s85
    s_bfe_u32 s37, s39, 0x10002
    s_lshl_b32 s37, s37, 11
    s_add_u32 s85, s37, s85
    s_bfe_u32 s37, s39, 0x10003
    s_lshl_b32 s37, s37, 14
    s_add_u32 s85, s37, s85
    s_bfe_u32 s37, s39, 0x40004
    s_lshl_b32 s37, s37, 16
    s_add_u32 s85, s37, s85
    s_waitcnt vmcnt(6)
    buffer_load_dwordx4 a[16:19], v76, s[52:55], s85 offen offset:0 nt
    s_waitcnt vmcnt(6)
    buffer_load_dwordx4 a[20:23], v77, s[52:55], s85 offen offset:0 nt
    s_waitcnt vmcnt(6)
    buffer_load_dwordx4 a[24:27], v76, s[52:55], s85 offen offset:1024 nt
    s_waitcnt vmcnt(6)
    buffer_load_dwordx4 a[28:31], v77, s[52:55], s85 offen offset:1024 nt
    s_add_u32 s87, s87, 13
    s_add_u32 s39, s87, s88
    s_bfe_u32 s37, s39, 0x10000
    s_lshl_b32 s37, s37, 13
    s_add_u32 s85, s37, s89
    s_bfe_u32 s37, s39, 0x10001
    s_lshl_b32 s37, s37, 12
    s_add_u32 s85, s37, s85
    s_bfe_u32 s37, s39, 0x10002
    s_lshl_b32 s37, s37, 11
    s_add_u32 s85, s37, s85
    s_bfe_u32 s37, s39, 0x10003
    s_lshl_b32 s37, s37, 14
    s_add_u32 s85, s37, s85
    s_bfe_u32 s37, s39, 0x40004
    s_lshl_b32 s37, s37, 16
    s_add_u32 s85, s37, s85
    s_waitcnt vmcnt(6)
    buffer_load_dwordx4 a[32:35], v76, s[52:55], s85 offen offset:0 nt
    s_waitcnt vmcnt(6)
    buffer_load_dwordx4 a[36:39], v77, s[52:55], s85 offen offset:0 nt
    s_waitcnt vmcnt(6)
    buffer_load_dwordx4 a[40:43], v76, s[52:55], s85 offen offset:1024 nt
    s_waitcnt vmcnt(6)
    buffer_load_dwordx4 a[44:47], v77, s[52:55], s85 offen offset:1024 nt
    s_add_u32 s87, s87, 1
    s_add_u32 s39, s87, s88
    s_bfe_u32 s37, s39, 0x10000
    s_lshl_b32 s37, s37, 13
    s_add_u32 s85, s37, s89
    s_bfe_u32 s37, s39, 0x10001
    s_lshl_b32 s37, s37, 12
    s_add_u32 s85, s37, s85
    s_bfe_u32 s37, s39, 0x10002
    s_lshl_b32 s37, s37, 11
    s_add_u32 s85, s37, s85
    s_bfe_u32 s37, s39, 0x10003
    s_lshl_b32 s37, s37, 14
    s_add_u32 s85, s37, s85
    s_bfe_u32 s37, s39, 0x40004
    s_lshl_b32 s37, s37, 16
    s_add_u32 s85, s37, s85
    s_waitcnt vmcnt(6)
    buffer_load_dwordx4 a[48:51], v76, s[52:55], s85 offen offset:0 nt
    s_waitcnt vmcnt(6)
    buffer_load_dwordx4 a[52:55], v77, s[52:55], s85 offen offset:0 nt
    buffer_load_dwordx4 v[68:71], v78, s[48:51], s91 offen offset:0 sc1
    buffer_load_dwordx4 v[72:75], v78, s[48:51], s91 offen offset:16 sc1
    s_waitcnt vmcnt(8)
    buffer_load_dwordx4 a[56:59], v76, s[52:55], s85 offen offset:1024 nt
    s_waitcnt vmcnt(8)
    buffer_load_dwordx4 a[60:63], v77, s[52:55], s85 offen offset:1024 nt
    s_add_u32 s87, s87, 13
    s_add_u32 s39, s87, s88
    s_bfe_u32 s37, s39, 0x10000
    s_lshl_b32 s37, s37, 13
    s_add_u32 s85, s37, s89
    s_bfe_u32 s37, s39, 0x10001
    s_lshl_b32 s37, s37, 12
    s_add_u32 s85, s37, s85
    s_bfe_u32 s37, s39, 0x10002
    s_lshl_b32 s37, s37, 11
    s_add_u32 s85, s37, s85
    s_bfe_u32 s37, s39, 0x10003
    s_lshl_b32 s37, s37, 14
    s_add_u32 s85, s37, s85
    s_bfe_u32 s37, s39, 0x40004
    s_lshl_b32 s37, s37, 16
    s_add_u32 s85, s37, s85
    s_waitcnt vmcnt(8)
    buffer_load_dwordx4 a[64:67], v76, s[52:55], s85 offen offset:0 nt
    s_waitcnt vmcnt(8)
    buffer_load_dwordx4 a[68:71], v77, s[52:55], s85 offen offset:0 nt
    s_waitcnt vmcnt(8)
    buffer_load_dwordx4 a[72:75], v76, s[52:55], s85 offen offset:1024 nt
    s_waitcnt vmcnt(8)
    buffer_load_dwordx4 a[76:79], v77, s[52:55], s85 offen offset:1024 nt
    s_add_u32 s87, s87, 1
    s_add_u32 s39, s87, s88
    s_bfe_u32 s37, s39, 0x10000
    s_lshl_b32 s37, s37, 13
    s_add_u32 s85, s37, s89
    s_bfe_u32 s37, s39, 0x10001
    s_lshl_b32 s37, s37, 12
    s_add_u32 s85, s37, s85
    s_bfe_u32 s37, s39, 0x10002
    s_lshl_b32 s37, s37, 11
    s_add_u32 s85, s37, s85
    s_bfe_u32 s37, s39, 0x10003
    s_lshl_b32 s37, s37, 14
    s_add_u32 s85, s37, s85
    s_bfe_u32 s37, s39, 0x40004
    s_lshl_b32 s37, s37, 16
    s_add_u32 s85, s37, s85
    s_waitcnt vmcnt(6)
L_qcheck_39:
    v_xor_b32 v68, s35, v68
    v_xor_b32 v69, s35, v69
    v_xor_b32 v70, s35, v70
    v_xor_b32 v71, s35, v71
    v_xor_b32 v72, s35, v72
    v_xor_b32 v73, s35, v73
    v_xor_b32 v74, s35, v74
    v_xor_b32 v75, s35, v75
    v_or_b32 v4, v68, v69
    v_or3_b32 v4, v4, v70, v71
    v_or3_b32 v4, v4, v72, v73
    v_or3_b32 v4, v4, v74, v75
    v_and_b32 v4, 0xff, v4
    v_cmp_ne_u32 vcc, 0, v4
    s_cbranch_vccz L_qok_40
    buffer_load_dwordx4 v[68:71], v78, s[48:51], s91 offen offset:0 sc1
    buffer_load_dwordx4 v[72:75], v78, s[48:51], s91 offen offset:16 sc1
    s_waitcnt vmcnt(0)
    s_sub_u32 s84, s84, 1
    s_cmp_lg_u32 s84, 0
    s_cbranch_scc1 L_qcheck_39
    s_branch L_end
L_qok_40:
    v_cvt_pk_bf16_f32 v68, v68, v69
    v_cvt_pk_bf16_f32 v69, v70, v71
    v_cvt_pk_bf16_f32 v70, v72, v73
    v_cvt_pk_bf16_f32 v71, v74, v75
    s_mov_b32 vcc_lo, 0xf000f
    s_mov_b32 vcc_hi, 0xf000f
    v_cndmask_b32 v80, 0, v68, vcc
    v_cndmask_b32 v81, 0, v69, vcc
    v_cndmask_b32 v82, 0, v70, vcc
    v_cndmask_b32 v83, 0, v71, vcc
    s_mov_b32 vcc_lo, 0xf000f0
    s_mov_b32 vcc_hi, 0xf000f0
    v_cndmask_b32 v84, 0, v68, vcc
    v_cndmask_b32 v85, 0, v69, vcc
    v_cndmask_b32 v86, 0, v70, vcc
    v_cndmask_b32 v87, 0, v71, vcc
    s_mov_b32 vcc_lo, 0xf000f00
    s_mov_b32 vcc_hi, 0xf000f00
    v_cndmask_b32 v88, 0, v68, vcc
    v_cndmask_b32 v89, 0, v69, vcc
    v_cndmask_b32 v90, 0, v70, vcc
    v_cndmask_b32 v91, 0, v71, vcc
    s_mov_b32 vcc_lo, 0xf000f000
    s_mov_b32 vcc_hi, 0xf000f000
    v_cndmask_b32 v92, 0, v68, vcc
    v_cndmask_b32 v93, 0, v69, vcc
    v_cndmask_b32 v94, 0, v70, vcc
    v_cndmask_b32 v95, 0, v71, vcc
    s_getreg_b32 s70, hwreg(HW_REG_XCC_ID, 0, 4)
    s_lshl_b32 s70, s70, 8
    s_or_b32 s70, s70, s35
    s_or_b32 s70, s70, 0x5e9d0000
    s_bfe_u32 s38, s2, 0x30000
    s_lshl_b32 s38, s38, 8
    s_add_u32 s69, s38, 32768
    s_lshl_b32 s38, s32, 2
    s_add_u32 s69, s38, s69
    s_lshl_b32 s38, s34, 24
    s_add_u32 s69, s38, s69
    v_mov_b32 v72, s69
    v_mov_b32 v73, s70
    s_mov_b64 exec, 1
    buffer_store_dword v73, v72, s[48:51], 0 offen sc1
    s_mov_b64 exec, -1
    v_mov_b32 v65, 0xff7f0000
    s_lshl_b32 s38, s34, 14
    s_add_u32 s38, s38, 16384
    v_lshl_add_u32 v64, v1, 2, s38
    buffer_load_dwordx4 a[80:83], v76, s[52:55], s85 offen offset:0 nt
    v_mfma_f32_16x16x32_bf16 v[112:115], v[128:131], v[80:83], 0
    v_mfma_f32_16x16x32_bf16 v[112:115], v[132:135], v[84:87], v[112:115]
    v_mfma_f32_16x16x32_bf16 v[112:115], v[136:139], v[88:91], v[112:115]
    s_waitcnt vmcnt(7)
    buffer_load_dwordx4 a[84:87], v77, s[52:55], s85 offen offset:0 nt
    v_mfma_f32_16x16x32_bf16 v[112:115], v[140:143], v[92:95], v[112:115]
    v_mfma_f32_16x16x32_bf16 v[96:99], v[144:147], v[80:83], 0
    v_mfma_f32_16x16x32_bf16 v[96:99], v[148:151], v[84:87], v[96:99]
    v_mfma_f32_16x16x32_bf16 v[96:99], v[152:155], v[88:91], v[96:99]
    s_nop 4
    v_mov_b32_dpp v122, v112 quad_perm:[0,0,0,0] row_mask:0xf bank_mask:0xf
    v_mov_b32_dpp v124, v114 quad_perm:[2,2,2,2] row_mask:0xf bank_mask:0xf
    s_nop 0
    v_add_f32_dpp v122, v113, v122 quad_perm:[1,1,1,1] row_mask:0xf bank_mask:0xf
    v_add_f32_dpp v124, v115, v124 quad_perm:[3,3,3,3] row_mask:0xf bank_mask:0xf
    v_add_f32 v122, v122, v124
    v_max_f32 v65, v65, v122
    ds_write_b32 v64, v122 offset:0
    s_waitcnt vmcnt(7)
    buffer_load_dwordx4 a[88:91], v76, s[52:55], s85 offen offset:1024 nt
    v_mfma_f32_16x16x32_bf16 v[96:99], v[156:159], v[92:95], v[96:99]
    v_mfma_f32_16x16x32_bf16 v[112:115], v[160:163], v[80:83], 0
    v_mfma_f32_16x16x32_bf16 v[112:115], v[164:167], v[84:87], v[112:115]
    s_waitcnt vmcnt(7)
    buffer_load_dwordx4 a[92:95], v77, s[52:55], s85 offen offset:1024 nt
    s_add_u32 s87, s87, 13
    s_add_u32 s39, s87, s88
    s_bfe_u32 s37, s39, 0x10000
    s_lshl_b32 s37, s37, 13
    s_add_u32 s85, s37, s89
    s_bfe_u32 s37, s39, 0x10001
    s_lshl_b32 s37, s37, 12
    s_add_u32 s85, s37, s85
    s_bfe_u32 s37, s39, 0x10002
    s_lshl_b32 s37, s37, 11
    s_add_u32 s85, s37, s85
    s_bfe_u32 s37, s39, 0x10003
    s_lshl_b32 s37, s37, 14
    s_add_u32 s85, s37, s85
    s_bfe_u32 s37, s39, 0x40004
    s_lshl_b32 s37, s37, 16
    s_add_u32 s85, s37, s85
    v_mfma_f32_16x16x32_bf16 v[112:115], v[168:171], v[88:91], v[112:115]
    v_mov_b32_dpp v122, v96 quad_perm:[0,0,0,0] row_mask:0xf bank_mask:0xf
    v_mov_b32_dpp v124, v98 quad_perm:[2,2,2,2] row_mask:0xf bank_mask:0xf
    s_nop 0
    v_add_f32_dpp v122, v97, v122 quad_perm:[1,1,1,1] row_mask:0xf bank_mask:0xf
    v_add_f32_dpp v124, v99, v124 quad_perm:[3,3,3,3] row_mask:0xf bank_mask:0xf
    v_add_f32 v122, v122, v124
    v_max_f32 v65, v65, v122
    ds_write_b32 v64, v122 offset:256
    v_mfma_f32_16x16x32_bf16 v[112:115], v[172:175], v[92:95], v[112:115]
    v_mfma_f32_16x16x32_bf16 v[96:99], v[176:179], v[80:83], 0
    v_mfma_f32_16x16x32_bf16 v[96:99], v[180:183], v[84:87], v[96:99]
    s_waitcnt vmcnt(7)
    buffer_load_dwordx4 a[96:99], v76, s[52:55], s85 offen offset:0 nt
    v_mfma_f32_16x16x32_bf16 v[96:99], v[184:187], v[88:91], v[96:99]
    s_nop 2
    v_mov_b32_dpp v122, v112 quad_perm:[0,0,0,0] row_mask:0xf bank_mask:0xf
    v_mov_b32_dpp v124, v114 quad_perm:[2,2,2,2] row_mask:0xf bank_mask:0xf
    s_nop 0
    v_add_f32_dpp v122, v113, v122 quad_perm:[1,1,1,1] row_mask:0xf bank_mask:0xf
    v_add_f32_dpp v124, v115, v124 quad_perm:[3,3,3,3] row_mask:0xf bank_mask:0xf
    v_add_f32 v122, v122, v124
    v_max_f32 v65, v65, v122
    ds_write_b32 v64, v122 offset:512
    v_mfma_f32_16x16x32_bf16 v[96:99], v[188:191], v[92:95], v[96:99]
    v_mfma_f32_16x16x32_bf16 v[112:115], v[192:195], v[80:83], 0
    s_waitcnt vmcnt(7)
    buffer_load_dwordx4 a[100:103], v77, s[52:55], s85 offen offset:0 nt
    v_mfma_f32_16x16x32_bf16 v[112:115], v[196:199], v[84:87], v[112:115]
    v_mfma_f32_16x16x32_bf16 v[112:115], v[200:203], v[88:91], v[112:115]
    s_nop 2
    v_mov_b32_dpp v122, v96 quad_perm:[0,0,0,0] row_mask:0xf bank_mask:0xf
    v_mov_b32_dpp v124, v98 quad_perm:[2,2,2,2] row_mask:0xf bank_mask:0xf
    s_nop 0
    v_add_f32_dpp v122, v97, v122 quad_perm:[1,1,1,1] row_mask:0xf bank_mask:0xf
    v_add_f32_dpp v124, v99, v124 quad_perm:[3,3,3,3] row_mask:0xf bank_mask:0xf
    v_add_f32 v122, v122, v124
    v_max_f32 v65, v65, v122
    ds_write_b32 v64, v122 offset:768
    v_mfma_f32_16x16x32_bf16 v[112:115], v[204:207], v[92:95], v[112:115]
    v_mfma_f32_16x16x32_bf16 v[96:99], v[208:211], v[80:83], 0
    s_waitcnt vmcnt(7)
    buffer_load_dwordx4 a[104:107], v76, s[52:55], s85 offen offset:1024 nt
    v_mfma_f32_16x16x32_bf16 v[96:99], v[212:215], v[84:87], v[96:99]
    v_mfma_f32_16x16x32_bf16 v[96:99], v[216:219], v[88:91], v[96:99]
    s_nop 2
    v_mov_b32_dpp v122, v112 quad_perm:[0,0,0,0] row_mask:0xf bank_mask:0xf
    v_mov_b32_dpp v124, v114 quad_perm:[2,2,2,2] row_mask:0xf bank_mask:0xf
    s_nop 0
    v_add_f32_dpp v122, v113, v122 quad_perm:[1,1,1,1] row_mask:0xf bank_mask:0xf
    v_add_f32_dpp v124, v115, v124 quad_perm:[3,3,3,3] row_mask:0xf bank_mask:0xf
    v_add_f32 v122, v122, v124
    v_max_f32 v65, v65, v122
    ds_write_b32 v64, v122 offset:1024
    v_mfma_f32_16x16x32_bf16 v[96:99], v[220:223], v[92:95], v[96:99]
    s_waitcnt vmcnt(6)
    buffer_load_dwordx4 a[108:111], v77, s[52:55], s85 offen offset:1024 nt
    s_add_u32 s87, s87, 1
    s_add_u32 s39, s87, s88
    s_bfe_u32 s37, s39, 0x10000
    s_lshl_b32 s37, s37, 13
    s_add_u32 s85, s37, s89
    s_bfe_u32 s37, s39, 0x10001
    s_lshl_b32 s37, s37, 12
    s_add_u32 s85, s37, s85
    s_bfe_u32 s37, s39, 0x10002
    s_lshl_b32 s37, s37, 11
    s_add_u32 s85, s37, s85
    s_bfe_u32 s37, s39, 0x10003
    s_lshl_b32 s37, s37, 14
    s_add_u32 s85, s37, s85
    s_bfe_u32 s37, s39, 0x40004
    s_lshl_b32 s37, s37, 16
    s_add_u32 s85, s37, s85
    v_mfma_f32_16x16x32_bf16 v[112:115], v[224:227], v[80:83], 0
    v_mfma_f32_16x16x32_bf16 v[112:115], v[228:231], v[84:87], v[112:115]
    v_mfma_f32_16x16x32_bf16 v[112:115], v[232:235], v[88:91], v[112:115]
    v_mov_b32_dpp v122, v96 quad_perm:[0,0,0,0] row_mask:0xf bank_mask:0xf
    v_mov_b32_dpp v124, v98 quad_perm:[2,2,2,2] row_mask:0xf bank_mask:0xf
    s_nop 0
    v_add_f32_dpp v122, v97, v122 quad_perm:[1,1,1,1] row_mask:0xf bank_mask:0xf
    v_add_f32_dpp v124, v99, v124 quad_perm:[3,3,3,3] row_mask:0xf bank_mask:0xf
    v_add_f32 v122, v122, v124
    v_max_f32 v65, v65, v122
    ds_write_b32 v64, v122 offset:1280
    v_mfma_f32_16x16x32_bf16 v[112:115], v[236:239], v[92:95], v[112:115]
    s_waitcnt vmcnt(6)
    buffer_load_dwordx4 a[112:115], v76, s[52:55], s85 offen offset:0 nt
    v_mfma_f32_16x16x32_bf16 v[96:99], v[240:243], v[80:83], 0
    v_mfma_f32_16x16x32_bf16 v[96:99], v[244:247], v[84:87], v[96:99]
    v_mfma_f32_16x16x32_bf16 v[96:99], v[248:251], v[88:91], v[96:99]
    s_nop 2
    v_mov_b32_dpp v122, v112 quad_perm:[0,0,0,0] row_mask:0xf bank_mask:0xf
    v_mov_b32_dpp v124, v114 quad_perm:[2,2,2,2] row_mask:0xf bank_mask:0xf
    s_nop 0
    v_add_f32_dpp v122, v113, v122 quad_perm:[1,1,1,1] row_mask:0xf bank_mask:0xf
    v_add_f32_dpp v124, v115, v124 quad_perm:[3,3,3,3] row_mask:0xf bank_mask:0xf
    v_add_f32 v122, v122, v124
    v_max_f32 v65, v65, v122
    ds_write_b32 v64, v122 offset:1536
    v_mfma_f32_16x16x32_bf16 v[96:99], v[252:255], v[92:95], v[96:99]
    s_waitcnt vmcnt(6)
    buffer_load_dwordx4 a[116:119], v77, s[52:55], s85 offen offset:0 nt
    v_mfma_f32_16x16x32_bf16 v[112:115], a[0:3], v[80:83], 0
    v_mfma_f32_16x16x32_bf16 v[112:115], a[4:7], v[84:87], v[112:115]
    v_mfma_f32_16x16x32_bf16 v[112:115], a[8:11], v[88:91], v[112:115]
    s_nop 2
    v_mov_b32_dpp v122, v96 quad_perm:[0,0,0,0] row_mask:0xf bank_mask:0xf
    v_mov_b32_dpp v124, v98 quad_perm:[2,2,2,2] row_mask:0xf bank_mask:0xf
    s_nop 0
    v_add_f32_dpp v122, v97, v122 quad_perm:[1,1,1,1] row_mask:0xf bank_mask:0xf
    v_add_f32_dpp v124, v99, v124 quad_perm:[3,3,3,3] row_mask:0xf bank_mask:0xf
    v_add_f32 v122, v122, v124
    v_max_f32 v65, v65, v122
    ds_write_b32 v64, v122 offset:1792
    s_waitcnt vmcnt(6)
    buffer_load_dwordx4 a[120:123], v76, s[52:55], s85 offen offset:1024 nt
    v_mfma_f32_16x16x32_bf16 v[112:115], a[12:15], v[92:95], v[112:115]
    v_mfma_f32_16x16x32_bf16 v[96:99], a[16:19], v[80:83], 0
    v_mfma_f32_16x16x32_bf16 v[96:99], a[20:23], v[84:87], v[96:99]
    v_mfma_f32_16x16x32_bf16 v[96:99], a[24:27], v[88:91], v[96:99]
    s_nop 4
    v_mov_b32_dpp v122, v112 quad_perm:[0,0,0,0] row_mask:0xf bank_mask:0xf
    v_mov_b32_dpp v124, v114 quad_perm:[2,2,2,2] row_mask:0xf bank_mask:0xf
    s_nop 0
    v_add_f32_dpp v122, v113, v122 quad_perm:[1,1,1,1] row_mask:0xf bank_mask:0xf
    v_add_f32_dpp v124, v115, v124 quad_perm:[3,3,3,3] row_mask:0xf bank_mask:0xf
    v_add_f32 v122, v122, v124
    v_max_f32 v65, v65, v122
    ds_write_b32 v64, v122 offset:2048
    s_waitcnt vmcnt(6)
    buffer_load_dwordx4 a[124:127], v77, s[52:55], s85 offen offset:1024 nt
    s_add_u32 s87, s87, 13
    s_add_u32 s39, s87, s88
    s_bfe_u32 s37, s39, 0x10000
    s_lshl_b32 s37, s37, 13
    s_add_u32 s85, s37, s89
    s_bfe_u32 s37, s39, 0x10001
    s_lshl_b32 s37, s37, 12
    s_add_u32 s85, s37, s85
    s_bfe_u32 s37, s39, 0x10002
    s_lshl_b32 s37, s37, 11
    s_add_u32 s85, s37, s85
    s_bfe_u32 s37, s39, 0x10003
    s_lshl_b32 s37, s37, 14
    s_add_u32 s85, s37, s85
    s_bfe_u32 s37, s39, 0x40004
    s_lshl_b32 s37, s37, 16
    s_add_u32 s85, s37, s85
    v_mfma_f32_16x16x32_bf16 v[96:99], a[28:31], v[92:95], v[96:99]
    v_mfma_f32_16x16x32_bf16 v[112:115], a[32:35], v[80:83], 0
    s_bfe_u32 s38, s2, 0x20001
    s_lshl_b32 s38, s38, 0
    s_add_u32 s90, s38, 0
    s_bfe_u32 s38, s2, 0x10000
    s_lshl_b32 s38, s38, 2
    s_add_u32 s90, s38, s90
    s_and_b32 s36, s90, 3
    s_bitcmp0_b32 s90, 2
    s_cselect_b64 s[40:41], s[24:25], s[14:15]
    s_cselect_b32 s45, 262144, 0
    s_add_u32 s45, s45, 524288
    s_lshl_b32 s38, s36, 16
    s_add_u32 s71, s38, s45
    s_lshr_b32 s38, s32, 2
    s_lshl_b32 s38, s38, 13
    s_add_u32 s71, s38, s71
    s_bfe_u32 s38, s32, 0x20000
    s_lshl_b32 s38, s38, 6
    s_add_u32 s71, s38, s71
    s_mov_b32 s42, 4194304
    s_mov_b32 s43, 0x20000
    s_lshl_b32 s38, s32, 17
    s_add_u32 s44, s38, 0
    s_lshl_b32 s38, s34, 15
    s_add_u32 s44, s38, s44
    s_lshl_b32 s38, s36, 8
    s_add_u32 s44, s38, s44
    s_lshl_b32 s38, s36, 16
    s_add_u32 s45, s38, s45
    s_lshr_b32 s38, s34, 1
    s_lshl_b32 s38, s38, 15
    s_add_u32 s45, s38, s45
    s_lshl_b32 s38, s32, 8
    s_add_u32 s45, s38, s45
    s_bfe_u32 s38, s34, 0x10000
    s_lshl_b32 s38, s38, 7
    s_add_u32 s45, s38, s45
    s_lshl_b32 s38, s32, 11
    s_add_u32 s46, s38, 196608
    s_lshl_b32 s38, s34, 9
    s_add_u32 s46, s38, s46
    s_mov_b32 s72, s26
    s_and_b32 s73, s27, 0xffff
    s_mov_b32 s74, 8192
    s_mov_b32 s75, 0x20000
    v_mfma_f32_16x16x32_bf16 v[112:115], a[36:39], v[84:87], v[112:115]
    s_waitcnt vmcnt(5)
    buffer_load_dwordx4 v[128:131], v76, s[52:55], s85 offen offset:0 nt
    v_mfma_f32_16x16x32_bf16 v[112:115], a[40:43], v[88:91], v[112:115]
    v_mov_b32_dpp v122, v96 quad_perm:[0,0,0,0] row_mask:0xf bank_mask:0xf
    v_mov_b32_dpp v124, v98 quad_perm:[2,2,2,2] row_mask:0xf bank_mask:0xf
    s_nop 0
    v_add_f32_dpp v122, v97, v122 quad_perm:[1,1,1,1] row_mask:0xf bank_mask:0xf
    v_add_f32_dpp v124, v99, v124 quad_perm:[3,3,3,3] row_mask:0xf bank_mask:0xf
    v_add_f32 v122, v122, v124
    v_max_f32 v65, v65, v122
    ds_write_b32 v64, v122 offset:2304
    v_mfma_f32_16x16x32_bf16 v[112:115], a[44:47], v[92:95], v[112:115]
    v_mfma_f32_16x16x32_bf16 v[96:99], a[48:51], v[80:83], 0
    v_mfma_f32_16x16x32_bf16 v[96:99], a[52:55], v[84:87], v[96:99]
    s_waitcnt vmcnt(5)
    buffer_load_dwordx4 v[132:135], v77, s[52:55], s85 offen offset:0 nt
    v_mfma_f32_16x16x32_bf16 v[96:99], a[56:59], v[88:91], v[96:99]
    s_nop 2
    v_mov_b32_dpp v122, v112 quad_perm:[0,0,0,0] row_mask:0xf bank_mask:0xf
    v_mov_b32_dpp v124, v114 quad_perm:[2,2,2,2] row_mask:0xf bank_mask:0xf
    s_nop 0
    v_add_f32_dpp v122, v113, v122 quad_perm:[1,1,1,1] row_mask:0xf bank_mask:0xf
    v_add_f32_dpp v124, v115, v124 quad_perm:[3,3,3,3] row_mask:0xf bank_mask:0xf
    v_add_f32 v122, v122, v124
    v_max_f32 v65, v65, v122
    ds_write_b32 v64, v122 offset:2560
    v_lshlrev_b32 v4, 2, v2
    v_xor_b32 v4, v4, v3
    v_xor_b32 v5, 0, v4
    v_lshlrev_b32 v5, 4, v5
    v_lshl_add_u32 v20, v2, 10, v5
    v_xor_b32 v5, 1, v4
    v_lshlrev_b32 v5, 4, v5
    v_lshl_add_u32 v21, v2, 10, v5
    v_add_u32 v21, 3072, v21
    v_xor_b32 v5, 2, v4
    v_lshlrev_b32 v5, 4, v5
    v_lshl_add_u32 v22, v2, 10, v5
    v_add_u32 v22, 6144, v22
    v_xor_b32 v5, 3, v4
    v_lshlrev_b32 v5, 4, v5
    v_lshl_add_u32 v23, v2, 10, v5
    v_add_u32 v23, 9216, v23
    s_lshl_b32 s38, s32, 15
    s_add_u32 s47, s38, 1048576
    s_lshl_b32 s38, s3, 13
    s_add_u32 s47, s38, s47
    v_lshlrev_b32 v6, 7, v2
    v_bfe_u32 v5, v3, 0, 3
    v_lshl_add_u32 v6, v5, 4, v6
    v_lshrrev_b32 v4, 3, v3
    v_and_b32 v7, 3, v3
    v_min_u32 v7, 2, v7
    v_lshl_add_u32 v7, v7, 1, v4
    v_add_u32 v5, 0, v4
    v_cmp_le_u32 vcc, s33, v5
    s_nop 1
    v_addc_co_u32 v5, vcc, 0, v5, vcc
    v_lshl_add_u32 v50, v5, 10, v6
    v_add_u32 v5, 2, v4
    v_cmp_le_u32 vcc, s33, v5
    s_nop 1
    v_addc_co_u32 v5, vcc, 0, v5, vcc
    v_lshl_add_u32 v51, v5, 10, v6
    v_add_u32 v5, 4, v4
    v_cmp_le_u32 vcc, s33, v5
    s_nop 1
    v_addc_co_u32 v5, vcc, 0, v5, vcc
    v_lshl_add_u32 v52, v5, 10, v6
    v_mov_b32 v5, v7
    v_mov_b32 v6, 512
    v_cmp_le_u32 vcc, s33, v5
    s_nop 1
    v_addc_co_u32 v5, vcc, 0, v5, vcc
    v_lshl_add_u32 v53, v5, 10, v6
    s_mul_i32 s38, s3, 320
    s_add_u32 s38, s38, 135168
    v_lshlrev_b32 v4, 6, v2
    v_lshl_add_u32 v4, v3, 1, v4
    v_add_u32 v31, s38, v4
    v_mfma_f32_16x16x32_bf16 v[96:99], a[60:63], v[92:95], v[96:99]
    v_mfma_f32_16x16x32_bf16 v[112:115], a[64:67], v[80:83], 0
    s_waitcnt vmcnt(5)
    buffer_load_dwordx4 v[136:139], v76, s[52:55], s85 offen offset:1024 nt
    v_mfma_f32_16x16x32_bf16 v[112:115], a[68:71], v[84:87], v[112:115]
    v_mfma_f32_16x16x32_bf16 v[112:115], a[72:75], v[88:91], v[112:115]
    s_nop 2
    v_mov_b32_dpp v122, v96 quad_perm:[0,0,0,0] row_mask:0xf bank_mask:0xf
    v_mov_b32_dpp v124, v98 quad_perm:[2,2,2,2] row_mask:0xf bank_mask:0xf
    s_nop 0
    v_add_f32_dpp v122, v97, v122 quad_perm:[1,1,1,1] row_mask:0xf bank_mask:0xf
    v_add_f32_dpp v124, v99, v124 quad_perm:[3,3,3,3] row_mask:0xf bank_mask:0xf
    v_add_f32 v122, v122, v124
    v_max_f32 v65, v65, v122
    ds_write_b32 v64, v122 offset:2816
    v_mfma_f32_16x16x32_bf16 v[112:115], a[76:79], v[92:95], v[112:115]
    v_mfma_f32_16x16x32_bf16 v[96:99], a[80:83], v[80:83], 0
    v_lshlrev_b32 v4, 11, v2
    v_bfe_u32 v5, v1, 2, 2
    v_lshl_add_u32 v4, v5, 8, v4
    v_bfe_u32 v5, v1, 2, 2
    v_lshl_add_u32 v4, v5, 6, v4
    v_bfe_u32 v5, v1, 4, 1
    v_lshl_add_u32 v4, v5, 5, v4
    v_bfe_u32 v5, v1, 1, 1
    v_lshl_add_u32 v4, v5, 4, v4
    v_bfe_u32 v5, v1, 0, 1
    v_lshl_add_u32 v4, v5, 3, v4
    s_lshl_b32 s38, s34, 6
    s_add_u32 s38, s38, 98304
    v_xor_b32 v24, s38, v4
    v_xor_b32 v25, 16, v24
    v_xor_b32 v26, 32, v24
    v_xor_b32 v27, 48, v24
    v_and_b32 v4, 3, v3
    v_lshrrev_b32 v5, 2, v3
    v_lshlrev_b32 v6, 4, v2
    v_add_u32 v6, 135168, v6
    s_movk_i32 s36, 320
    v_cmp_eq_u32 vcc, 0, v5
    s_nop 1
    v_cndmask_b32 v28, 4, v4, vcc
    v_mad_u32_u24 v28, v28, s36, v6
    v_cmp_eq_u32 vcc, 1, v5
    s_nop 1
    v_cndmask_b32 v29, 4, v4, vcc
    v_mad_u32_u24 v29, v29, s36, v6
    v_lshlrev_b32 v5, 2, v1
    v_add_u32 v5, 136448, v5
    v_mov_b32 v6, 0
    ds_write_b32 v5, v6
    s_waitcnt vmcnt(5)
    buffer_load_dwordx4 v[140:143], v77, s[52:55], s85 offen offset:1024 nt
    s_add_u32 s87, s87, 1
    s_add_u32 s39, s87, s88
    s_bfe_u32 s37, s39, 0x10000
    s_lshl_b32 s37, s37, 13
    s_add_u32 s85, s37, s89
    s_bfe_u32 s37, s39, 0x10001
    s_lshl_b32 s37, s37, 12
    s_add_u32 s85, s37, s85
    s_bfe_u32 s37, s39, 0x10002
    s_lshl_b32 s37, s37, 11
    s_add_u32 s85, s37, s85
    s_bfe_u32 s37, s39, 0x10003
    s_lshl_b32 s37, s37, 14
    s_add_u32 s85, s37, s85
    s_bfe_u32 s37, s39, 0x40004
    s_lshl_b32 s37, s37, 16
    s_add_u32 s85, s37, s85
    v_mfma_f32_16x16x32_bf16 v[96:99], a[84:87], v[84:87], v[96:99]
    v_mfma_f32_16x16x32_bf16 v[96:99], a[88:91], v[88:91], v[96:99]
    v_mov_b32_dpp v122, v112 quad_perm:[0,0,0,0] row_mask:0xf bank_mask:0xf
    v_mov_b32_dpp v124, v114 quad_perm:[2,2,2,2] row_mask:0xf bank_mask:0xf
    s_nop 0
    v_add_f32_dpp v122, v113, v122 quad_perm:[1,1,1,1] row_mask:0xf bank_mask:0xf
    v_add_f32_dpp v124, v115, v124 quad_perm:[3,3,3,3] row_mask:0xf bank_mask:0xf
    v_add_f32 v122, v122, v124
    v_max_f32 v65, v65, v122
    ds_write_b32 v64, v122 offset:3072
    v_mfma_f32_16x16x32_bf16 v[96:99], a[92:95], v[92:95], v[96:99]
    s_waitcnt vmcnt(5)
    buffer_load_dwordx4 v[144:147], v76, s[52:55], s85 offen offset:0 nt
    v_mfma_f32_16x16x32_bf16 v[112:115], a[96:99], v[80:83], 0
    v_mfma_f32_16x16x32_bf16 v[112:115], a[100:103], v[84:87], v[112:115]
    v_mfma_f32_16x16x32_bf16 v[112:115], a[104:107], v[88:91], v[112:115]
    s_nop 2
    v_mov_b32_dpp v122, v96 quad_perm:[0,0,0,0] row_mask:0xf bank_mask:0xf
    v_mov_b32_dpp v124, v98 quad_perm:[2,2,2,2] row_mask:0xf bank_mask:0xf
    s_nop 0
    v_add_f32_dpp v122, v97, v122 quad_perm:[1,1,1,1] row_mask:0xf bank_mask:0xf
    v_add_f32_dpp v124, v99, v124 quad_perm:[3,3,3,3] row_mask:0xf bank_mask:0xf
    v_add_f32 v122, v122, v124
    v_max_f32 v65, v65, v122
    ds_write_b32 v64, v122 offset:3328
    v_lshlrev_b32 v30, 4, v3
    v_lshl_add_u32 v30, v2, 13, v30
    v_lshrrev_b32 v5, 2, v1
    v_lshlrev_b32 v32, 8, v5
    v_bfe_u32 v5, v1, 0, 2
    v_lshl_add_u32 v32, v5, 4, v32
    s_xor_b32 s37, s90, 4
    s_bfe_u32 s38, s37, 0x30000
    s_lshl_b32 s38, s38, 8
    s_add_u32 s36, s38, 0
    s_lshr_b32 s38, s32, 4
    s_lshl_b32 s38, s38, 7
    s_add_u32 s36, s38, s36
    s_bfe_u32 s38, s32, 0x20000
    s_lshl_b32 s38, s38, 5
    s_add_u32 s36, s38, s36
    s_bfe_u32 s38, s32, 0x20002
    s_lshl_b32 s38, s38, 3
    s_add_u32 s36, s38, s36
    v_bfe_u32 v5, v1, 0, 2
    v_lshlrev_b32 v33, 11, v5
    v_lshl_add_u32 v33, v2, 1, v33
    v_add_u32 v33, s36, v33
    v_and_b32 v5, 31, v1
    v_lshlrev_b32 v34, 4, v5
    s_mul_i32 s38, s34, 320
    s_add_u32 s38, s38, 135168
    v_lshl_add_u32 v35, v5, 3, s38
    s_bfe_u32 s38, s34, 0x10000
    s_lshl_b32 s38, s38, 12
    s_add_u32 s36, s38, s71
    s_lshr_b32 s38, s34, 1
    s_lshl_b32 s38, s38, 24
    s_add_u32 s36, s38, s36
    s_bitcmp1_b32 s90, 2
    s_cselect_b32 s46, s46, s36
    s_cselect_b64 vcc, -1, 0
    v_cndmask_b32 v54, v32, v34, vcc
    v_mfma_f32_16x16x32_bf16 v[112:115], a[108:111], v[92:95], v[112:115]
    s_waitcnt vmcnt(5)
    buffer_load_dwordx4 v[148:151], v77, s[52:55], s85 offen offset:0 nt
    v_mfma_f32_16x16x32_bf16 v[96:99], a[112:115], v[80:83], 0
    v_mfma_f32_16x16x32_bf16 v[96:99], a[116:119], v[84:87], v[96:99]
    v_mfma_f32_16x16x32_bf16 v[96:99], a[120:123], v[88:91], v[96:99]
    s_nop 2
    v_mov_b32_dpp v122, v112 quad_perm:[0,0,0,0] row_mask:0xf bank_mask:0xf
    v_mov_b32_dpp v124, v114 quad_perm:[2,2,2,2] row_mask:0xf bank_mask:0xf
    s_nop 0
    v_add_f32_dpp v122, v113, v122 quad_perm:[1,1,1,1] row_mask:0xf bank_mask:0xf
    v_add_f32_dpp v124, v115, v124 quad_perm:[3,3,3,3] row_mask:0xf bank_mask:0xf
    v_add_f32 v122, v122, v124
    v_max_f32 v65, v65, v122
    ds_write_b32 v64, v122 offset:3584
    v_mfma_f32_16x16x32_bf16 v[96:99], a[124:127], v[92:95], v[96:99]
    v_add_u32 v64, 3840, v64
    s_and_b32 s36, s32, 3
    s_sub_u32 s95, s36, 2
    s_cmp_ge_u32 s36, 2
    s_cselect_b32 s95, s95, 8
    s_cselect_b32 s94, 17, 16
    s_cmp_eq_u32 s95, s33
    s_cselect_b32 s63, 15, 16
    s_sub_u32 s97, s63, 8
    s_add_u32 s95, s95, 105
    s_mov_b32 s92, 1
    s_lshl_b32 s38, s32, 2
    s_add_u32 s80, s38, 0
    s_lshl_b32 s38, s3, 0
    s_add_u32 s80, s38, s80
    s_mul_i32 s80, s80, 2176
    s_add_u32 s80, s80, 3145728
    v_lshrrev_b32 v4, 2, v1
    v_lshlrev_b32 v55, 3, v4
    s_mov_b32 s66, 134217728
    s_mov_b32 s67, 0x20000
    s_mov_b64 s[64:65], s[52:53]
    v_mov_b32 v62, v76
    v_mov_b32 v63, v77
    s_branch L_bloop
L_ql:
    v_lshrrev_b32 v4, 2, v3
    v_and_b32 v5, 3, v3
    v_lshlrev_b32 v19, 6, v2
    v_lshl_add_u32 v19, v5, 4, v19
    v_lshl_add_u32 v14, v4, 18, v19
    s_and_b32 s61, s32, 28
    s_add_u32 s61, s61, s34
    s_and_b32 s60, s32, 3
    s_lshl_b32 s38, s60, 20
    s_add_u32 s63, s38, 0
    s_lshl_b32 s38, s61, 8
    s_add_u32 s63, s38, s63
    s_mov_b32 s74, 4194304
    s_mov_b32 s75, 0x20000
    s_waitcnt lgkmcnt(0)
    s_mov_b64 s[72:73], s[10:11]
    buffer_load_dwordx4 a[128:131], v14, s[72:75], s63 offen nt
    s_add_u32 s63, s63, 8192
    buffer_load_dwordx4 a[132:135], v14, s[72:75], s63 offen nt
    s_add_u32 s63, s63, 8192
    buffer_load_dwordx4 a[136:139], v14, s[72:75], s63 offen nt
    s_add_u32 s63, s63, 8192
    buffer_load_dwordx4 a[140:143], v14, s[72:75], s63 offen nt
    s_add_u32 s63, s63, 8192
    buffer_load_dwordx4 a[144:147], v14, s[72:75], s63 offen nt
    s_add_u32 s63, s63, 8192
    buffer_load_dwordx4 a[148:151], v14, s[72:75], s63 offen nt
    s_add_u32 s63, s63, 8192
    buffer_load_dwordx4 a[152:155], v14, s[72:75], s63 offen nt
    s_add_u32 s63, s63, 8192
    buffer_load_dwordx4 a[156:159], v14, s[72:75], s63 offen nt
    s_add_u32 s63, s63, 8192
    v_lshlrev_b32 v15, 1, v19
    v_lshl_add_u32 v15, v4, 9, v15
    v_lshl_add_u32 v19, v4, 15, v19
    s_load_dword s35, s[30:31], 0
    s_mov_b32 s48, s30
    s_and_b32 s49, s31, 0xffff
    s_mov_b32 s50, 8388608
    s_mov_b32 s51, 0x20000
    s_mov_b32 s82, 0xffffff00
    s_mov_b32 s83, 0x3e0293ee
    s_mov_b32 s84, 8388608
    s_lshl_b32 s38, s61, 12
    s_add_u32 s95, s38, 264192
    s_lshl_b32 s38, s61, 10
    s_add_u32 s94, s38, 393216
    s_lshl_b32 s38, s60, 8
    s_add_u32 s94, s38, s94
    buffer_load_dwordx4 a[160:163], v14, s[72:75], s63 offen nt
    s_add_u32 s63, s63, 8192
    buffer_load_dwordx4 a[164:167], v14, s[72:75], s63 offen nt
    s_add_u32 s63, s63, 8192
    buffer_load_dwordx4 a[168:171], v14, s[72:75], s63 offen nt
    s_add_u32 s63, s63, 8192
    buffer_load_dwordx4 a[172:175], v14, s[72:75], s63 offen nt
    s_add_u32 s63, s63, 8192
    s_waitcnt vmcnt(11)
    buffer_load_dwordx4 a[176:179], v14, s[72:75], s63 offen nt
    s_add_u32 s63, s63, 8192
    v_and_b32 v4, 1, v1
    v_lshlrev_b32 v4, 4, v4
    v_mov_b32 v5, 0xffff
    v_lshlrev_b32 v4, v4, v5
    v_bfe_u32 v5, v1, 1, 2
    v_cmp_eq_u32 vcc, 0, v5
    s_nop 1
    v_cndmask_b32 v10, 0, v4, vcc
    v_cmp_eq_u32 vcc, 1, v5
    s_nop 1
    v_cndmask_b32 v11, 0, v4, vcc
    v_cmp_eq_u32 vcc, 2, v5
    s_nop 1
    v_cndmask_b32 v12, 0, v4, vcc
    v_cmp_eq_u32 vcc, 3, v5
    s_nop 1
    v_cndmask_b32 v13, 0, v4, vcc
    s_waitcnt vmcnt(11)
    buffer_load_dwordx4 a[180:183], v14, s[72:75], s63 offen nt
    s_add_u32 s63, s63, 8192
    s_waitcnt vmcnt(11)
    buffer_load_dwordx4 a[184:187], v14, s[72:75], s63 offen nt
    s_add_u32 s63, s63, 8192
    s_waitcnt vmcnt(11)
    buffer_load_dwordx4 a[188:191], v14, s[72:75], s63 offen nt
    s_add_u32 s63, s63, 8192
    s_waitcnt vmcnt(11)
    buffer_load_dwordx4 a[192:195], v14, s[72:75], s63 offen nt
    s_add_u32 s63, s63, 8192
    v_lshrrev_b32 v4, 2, v3
    v_and_b32 v5, 3, v3
    v_lshlrev_b32 v76, 8, v4
    v_lshlrev_b32 v126, 8, v2
    v_lshl_add_u32 v76, v2, 6, v76
    v_lshl_add_u32 v76, v5, 4, v76
    v_lshl_add_u32 v126, v3, 4, v126
    v_xor_b32 v77, 32768, v76
    v_xor_b32 v127, 32768, v126
    s_add_u32 s3, s34, s33
    s_and_b32 s3, s3, 3
    s_lshl_b32 s89, s3, 5
    s_add_u32 s89, s89, s32
    s_lshl_b32 s89, s89, 20
    s_mul_i32 s88, s32, 8
    s_mul_i32 s38, s3, 2
    s_add_u32 s88, s88, s38
    s_lshl_b32 s87, s33, 1
    s_waitcnt vmcnt(11)
    buffer_load_dwordx4 a[196:199], v14, s[72:75], s63 offen nt
    s_add_u32 s63, s63, 8192
    s_waitcnt vmcnt(11)
    buffer_load_dwordx4 a[200:203], v14, s[72:75], s63 offen nt
    s_add_u32 s63, s63, 8192
    s_waitcnt vmcnt(11)
    buffer_load_dwordx4 a[204:207], v14, s[72:75], s63 offen nt
    s_add_u32 s63, s63, 8192
    s_waitcnt vmcnt(11)
    buffer_load_dwordx4 a[208:211], v14, s[72:75], s63 offen nt
    s_add_u32 s63, s63, 8192
    s_mov_b32 s52, s18
    s_and_b32 s53, s19, 0xffff
    s_mov_b32 s54, 134217728
    s_mov_b32 s55, 0x20000
    s_mov_b32 s56, s20
    s_and_b32 s57, s21, 0xffff
    s_mov_b32 s58, 134217728
    s_mov_b32 s59, 0x20000
    s_waitcnt vmcnt(11)
    buffer_load_dwordx4 a[212:215], v14, s[72:75], s63 offen nt
    s_add_u32 s63, s63, 8192
    s_waitcnt vmcnt(11)
    buffer_load_dwordx4 a[216:219], v14, s[72:75], s63 offen nt
    s_add_u32 s63, s63, 8192
    s_waitcnt vmcnt(11)
    buffer_load_dwordx4 a[220:223], v14, s[72:75], s63 offen nt
    s_add_u32 s63, s63, 8192
    s_waitcnt vmcnt(11)
    buffer_load_dwordx4 a[224:227], v14, s[72:75], s63 offen nt
    s_add_u32 s63, s63, 8192
    v_mov_b32 v120, 0xff7f0000
    v_mov_b32 v121, 0
    v_mov_b32 v18, 1
    v_mov_b32 v116, 0
    v_mov_b32 v117, 0
    v_mov_b32 v118, 0
    v_mov_b32 v119, 0
    v_lshlrev_b32 v0, 3, v1
    ds_write_b64 v0, v[116:117] offset:8192
    v_mov_b32 v0, 8192
    s_lshl_b32 s38, s32, 10
    s_add_u32 s96, s38, 65536
    s_lshr_b32 s38, s32, 3
    s_lshl_b32 s38, s38, 8
    s_add_u32 s96, s38, s96
    v_mov_b32 v9, s96
    s_lshl_b32 s38, s32, 15
    s_add_u32 s96, s38, 1048576
    s_lshl_b32 s38, s3, 13
    s_add_u32 s96, s38, s96
    s_lshl_b32 s38, s33, 10
    s_add_u32 s96, s38, s96
    v_and_b32 v5, 3, v3
    v_lshlrev_b32 v78, 7, v2
    v_lshl_add_u32 v78, v5, 5, v78
    s_lshl_b32 s38, s32, 12
    s_add_u32 s91, s38, 262144
    s_lshl_b32 s38, s3, 9
    s_add_u32 s91, s38, s91
    v_lshlrev_b32 v4, 7, v2
    v_lshl_add_u32 v4, v3, 4, v4
    v_mov_b32 v5, 512
    v_cmp_gt_u32 vcc, 8, v3
    s_nop 1
    v_cndmask_b32 v79, v5, v4, vcc
    s_waitcnt vmcnt(11)
    buffer_load_dwordx4 a[228:231], v14, s[72:75], s63 offen nt
    s_add_u32 s63, s63, 8192
    s_waitcnt vmcnt(11)
    buffer_load_dwordx4 a[232:235], v14, s[72:75], s63 offen nt
    s_add_u32 s63, s63, 8192
    s_waitcnt vmcnt(11)
    buffer_load_dwordx4 a[236:239], v14, s[72:75], s63 offen nt
    s_add_u32 s63, s63, 8192
    s_waitcnt vmcnt(11)
    buffer_load_dwordx4 a[240:243], v14, s[72:75], s63 offen nt
    s_add_u32 s63, s63, 8192
    s_waitcnt vmcnt(11)
    buffer_load_dwordx4 a[244:247], v14, s[72:75], s63 offen nt
    s_add_u32 s63, s63, 8192
    s_waitcnt vmcnt(11)
    buffer_load_dwordx4 a[248:251], v14, s[72:75], s63 offen nt
    s_add_u32 s63, s63, 8192
    s_waitcnt vmcnt(11)
    buffer_load_dwordx4 a[252:255], v14, s[72:75], s63 offen nt
    s_add_u32 s63, s63, 8192
    s_waitcnt lgkmcnt(0)
    s_add_u32 s35, s35, 0x5b
    s_and_b32 s35, s35, 0xff
    v_mov_b32 v8, s35
    s_or_b32 s68, s35, 0x6b3ac500
    s_waitcnt vmcnt(6)
    s_add_u32 s39, s87, s88
    s_bfe_u32 s37, s39, 0x10000
    s_lshl_b32 s37, s37, 13
    s_add_u32 s85, s37, s89
    s_bfe_u32 s37, s39, 0x10001
    s_lshl_b32 s37, s37, 12
    s_add_u32 s85, s37, s85
    s_bfe_u32 s37, s39, 0x10002
    s_lshl_b32 s37, s37, 11
    s_add_u32 s85, s37, s85
    s_bfe_u32 s37, s39, 0x10003
    s_lshl_b32 s37, s37, 14
    s_add_u32 s85, s37, s85
    s_bfe_u32 s37, s39, 0x40004
    s_lshl_b32 s37, s37, 16
    s_add_u32 s85, s37, s85
    buffer_load_dwordx4 v[128:131], v76, s[52:55], s85 offen offset:0 nt
    s_waitcnt vmcnt(6)
    buffer_load_dwordx4 v[132:135], v77, s[52:55], s85 offen offset:0 nt
    s_waitcnt vmcnt(6)
    buffer_load_dwordx4 v[136:139], v76, s[52:55], s85 offen offset:1024 nt
    s_waitcnt vmcnt(6)
    buffer_load_dwordx4 v[140:143], v77, s[52:55], s85 offen offset:1024 nt
    s_add_u32 s87, s87, 1
    s_add_u32 s39, s87, s88
    s_bfe_u32 s37, s39, 0x10000
    s_lshl_b32 s37, s37, 13
    s_add_u32 s85, s37, s89
    s_bfe_u32 s37, s39, 0x10001
    s_lshl_b32 s37, s37, 12
    s_add_u32 s85, s37, s85
    s_bfe_u32 s37, s39, 0x10002
    s_lshl_b32 s37, s37, 11
    s_add_u32 s85, s37, s85
    s_bfe_u32 s37, s39, 0x10003
    s_lshl_b32 s37, s37, 14
    s_add_u32 s85, s37, s85
    s_bfe_u32 s37, s39, 0x40004
    s_lshl_b32 s37, s37, 16
    s_add_u32 s85, s37, s85
    s_waitcnt vmcnt(6)
    buffer_load_dwordx4 v[144:147], v76, s[52:55], s85 offen offset:0 nt
    s_waitcnt vmcnt(6)
    buffer_load_dwordx4 v[148:151], v77, s[52:55], s85 offen offset:0 nt
    s_waitcnt vmcnt(6)
    buffer_load_dwordx4 v[152:155], v76, s[52:55], s85 offen offset:1024 nt
    s_waitcnt vmcnt(6)
    buffer_load_dwordx4 v[156:159], v77, s[52:55], s85 offen offset:1024 nt
    s_add_u32 s87, s87, 13
    s_add_u32 s39, s87, s88
    s_bfe_u32 s37, s39, 0x10000
    s_lshl_b32 s37, s37, 13
    s_add_u32 s85, s37, s89
    s_bfe_u32 s37, s39, 0x10001
    s_lshl_b32 s37, s37, 12
    s_add_u32 s85, s37, s85
    s_bfe_u32 s37, s39, 0x10002
    s_lshl_b32 s37, s37, 11
    s_add_u32 s85, s37, s85
    s_bfe_u32 s37, s39, 0x10003
    s_lshl_b32 s37, s37, 14
    s_add_u32 s85, s37, s85
    s_bfe_u32 s37, s39, 0x40004
    s_lshl_b32 s37, s37, 16
    s_add_u32 s85, s37, s85
    s_waitcnt vmcnt(6)
    buffer_load_dwordx4 v[160:163], v76, s[52:55], s85 offen offset:0 nt
    s_waitcnt vmcnt(6)
    buffer_load_dwordx4 v[164:167], v77, s[52:55], s85 offen offset:0 nt
    s_waitcnt vmcnt(6)
    buffer_load_dwordx4 v[168:171], v76, s[52:55], s85 offen offset:1024 nt
    s_waitcnt vmcnt(6)
    buffer_load_dwordx4 v[172:175], v77, s[52:55], s85 offen offset:1024 nt
    s_add_u32 s87, s87, 1
    s_add_u32 s39, s87, s88
    s_bfe_u32 s37, s39, 0x10000
    s_lshl_b32 s37, s37, 13
    s_add_u32 s85, s37, s89
    s_bfe_u32 s37, s39, 0x10001
    s_lshl_b32 s37, s37, 12
    s_add_u32 s85, s37, s85
    s_bfe_u32 s37, s39, 0x10002
    s_lshl_b32 s37, s37, 11
    s_add_u32 s85, s37, s85
    s_bfe_u32 s37, s39, 0x10003
    s_lshl_b32 s37, s37, 14
    s_add_u32 s85, s37, s85
    s_bfe_u32 s37, s39, 0x40004
    s_lshl_b32 s37, s37, 16
    s_add_u32 s85, s37, s85
    s_waitcnt vmcnt(6)
    buffer_load_dwordx4 v[176:179], v76, s[52:55], s85 offen offset:0 nt
    s_waitcnt vmcnt(6)
    buffer_load_dwordx4 v[180:183], v77, s[52:55], s85 offen offset:0 nt
    s_waitcnt vmcnt(6)
    buffer_load_dwordx4 v[184:187], v76, s[52:55], s85 offen offset:1024 nt
    s_waitcnt vmcnt(6)
    buffer_load_dwordx4 v[188:191], v77, s[52:55], s85 offen offset:1024 nt
    s_add_u32 s87, s87, 13
    s_add_u32 s39, s87, s88
    s_bfe_u32 s37, s39, 0x10000
    s_lshl_b32 s37, s37, 13
    s_add_u32 s85, s37, s89
    s_bfe_u32 s37, s39, 0x10001
    s_lshl_b32 s37, s37, 12
    s_add_u32 s85, s37, s85
    s_bfe_u32 s37, s39, 0x10002
    s_lshl_b32 s37, s37, 11
    s_add_u32 s85, s37, s85
    s_bfe_u32 s37, s39, 0x10003
    s_lshl_b32 s37, s37, 14
    s_add_u32 s85, s37, s85
    s_bfe_u32 s37, s39, 0x40004
    s_lshl_b32 s37, s37, 16
    s_add_u32 s85, s37, s85
    s_waitcnt vmcnt(6)
    buffer_load_dwordx4 v[192:195], v76, s[52:55], s85 offen offset:0 nt
    s_waitcnt vmcnt(6)
    buffer_load_dwordx4 v[196:199], v77, s[52:55], s85 offen offset:0 nt
    s_waitcnt vmcnt(6)
    buffer_load_dwordx4 v[200:203], v76, s[52:55], s85 offen offset:1024 nt
    s_waitcnt vmcnt(6)
    buffer_load_dwordx4 v[204:207], v77, s[52:55], s85 offen offset:1024 nt
    s_add_u32 s87, s87, 1
    s_add_u32 s39, s87, s88
    s_bfe_u32 s37, s39, 0x10000
    s_lshl_b32 s37, s37, 13
    s_add_u32 s85, s37, s89
    s_bfe_u32 s37, s39, 0x10001
    s_lshl_b32 s37, s37, 12
    s_add_u32 s85, s37, s85
    s_bfe_u32 s37, s39, 0x10002
    s_lshl_b32 s37, s37, 11
    s_add_u32 s85, s37, s85
    s_bfe_u32 s37, s39, 0x10003
    s_lshl_b32 s37, s37, 14
    s_add_u32 s85, s37, s85
    s_bfe_u32 s37, s39, 0x40004
    s_lshl_b32 s37, s37, 16
    s_add_u32 s85, s37, s85
    s_waitcnt vmcnt(6)
    buffer_load_dwordx4 v[208:211], v76, s[52:55], s85 offen offset:0 nt
    s_waitcnt vmcnt(6)
    buffer_load_dwordx4 v[212:215], v77, s[52:55], s85 offen offset:0 nt
    s_waitcnt vmcnt(6)
    buffer_load_dwordx4 v[216:219], v76, s[52:55], s85 offen offset:1024 nt
    s_waitcnt vmcnt(6)
    buffer_load_dwordx4 v[220:223], v77, s[52:55], s85 offen offset:1024 nt
    s_add_u32 s87, s87, 13
    s_add_u32 s39, s87, s88
    s_bfe_u32 s37, s39, 0x10000
    s_lshl_b32 s37, s37, 13
    s_add_u32 s85, s37, s89
    s_bfe_u32 s37, s39, 0x10001
    s_lshl_b32 s37, s37, 12
    s_add_u32 s85, s37, s85
    s_bfe_u32 s37, s39, 0x10002
    s_lshl_b32 s37, s37, 11
    s_add_u32 s85, s37, s85
    s_bfe_u32 s37, s39, 0x10003
    s_lshl_b32 s37, s37, 14
    s_add_u32 s85, s37, s85
    s_bfe_u32 s37, s39, 0x40004
    s_lshl_b32 s37, s37, 16
    s_add_u32 s85, s37, s85
    s_waitcnt vmcnt(6)
    buffer_load_dwordx4 v[224:227], v76, s[52:55], s85 offen offset:0 nt
    s_waitcnt vmcnt(6)
    buffer_load_dwordx4 v[228:231], v77, s[52:55], s85 offen offset:0 nt
    s_waitcnt vmcnt(6)
    buffer_load_dwordx4 v[232:235], v76, s[52:55], s85 offen offset:1024 nt
    s_waitcnt vmcnt(6)
    buffer_load_dwordx4 v[236:239], v77, s[52:55], s85 offen offset:1024 nt
    s_add_u32 s87, s87, 1
    s_add_u32 s39, s87, s88
    s_bfe_u32 s37, s39, 0x10000
    s_lshl_b32 s37, s37, 13
    s_add_u32 s85, s37, s89
    s_bfe_u32 s37, s39, 0x10001
    s_lshl_b32 s37, s37, 12
    s_add_u32 s85, s37, s85
    s_bfe_u32 s37, s39, 0x10002
    s_lshl_b32 s37, s37, 11
    s_add_u32 s85, s37, s85
    s_bfe_u32 s37, s39, 0x10003
    s_lshl_b32 s37, s37, 14
    s_add_u32 s85, s37, s85
    s_bfe_u32 s37, s39, 0x40004
    s_lshl_b32 s37, s37, 16
    s_add_u32 s85, s37, s85
    s_waitcnt vmcnt(6)
    buffer_load_dwordx4 v[240:243], v76, s[52:55], s85 offen offset:0 nt
    s_waitcnt vmcnt(6)
    buffer_load_dwordx4 v[244:247], v77, s[52:55], s85 offen offset:0 nt
    buffer_load_dwordx4 v[20:23], v15, s[48:51], s95 offen offset:0 sc1
    buffer_load_dwordx4 v[24:27], v15, s[48:51], s95 offen offset:16 sc1
    s_waitcnt vmcnt(8)
    buffer_load_dwordx4 v[248:251], v76, s[52:55], s85 offen offset:1024 nt
    s_waitcnt vmcnt(8)
    buffer_load_dwordx4 v[252:255], v77, s[52:55], s85 offen offset:1024 nt
    s_add_u32 s87, s87, 13
    s_add_u32 s39, s87, s88
    s_bfe_u32 s37, s39, 0x10000
    s_lshl_b32 s37, s37, 13
    s_add_u32 s85, s37, s89
    s_bfe_u32 s37, s39, 0x10001
    s_lshl_b32 s37, s37, 12
    s_add_u32 s85, s37, s85
    s_bfe_u32 s37, s39, 0x10002
    s_lshl_b32 s37, s37, 11
    s_add_u32 s85, s37, s85
    s_bfe_u32 s37, s39, 0x10003
    s_lshl_b32 s37, s37, 14
    s_add_u32 s85, s37, s85
    s_bfe_u32 s37, s39, 0x40004
    s_lshl_b32 s37, s37, 16
    s_add_u32 s85, s37, s85
    s_waitcnt vmcnt(8)
    buffer_load_dwordx4 a[0:3], v76, s[52:55], s85 offen offset:0 nt
    s_waitcnt vmcnt(8)
    buffer_load_dwordx4 a[4:7], v77, s[52:55], s85 offen offset:0 nt
    s_waitcnt vmcnt(8)
    buffer_load_dwordx4 a[8:11], v76, s[52:55], s85 offen offset:1024 nt
    s_waitcnt vmcnt(8)
    buffer_load_dwordx4 a[12:15], v77, s[52:55], s85 offen offset:1024 nt
    s_add_u32 s87, s87, 1
    s_add_u32 s39, s87, s88
    s_bfe_u32 s37, s39, 0x10000
    s_lshl_b32 s37, s37, 13
    s_add_u32 s85, s37, s89
    s_bfe_u32 s37, s39, 0x10001
    s_lshl_b32 s37, s37, 12
    s_add_u32 s85, s37, s85
    s_bfe_u32 s37, s39, 0x10002
    s_lshl_b32 s37, s37, 11
    s_add_u32 s85, s37, s85
    s_bfe_u32 s37, s39, 0x10003
    s_lshl_b32 s37, s37, 14
    s_add_u32 s85, s37, s85
    s_bfe_u32 s37, s39, 0x40004
    s_lshl_b32 s37, s37, 16
    s_add_u32 s85, s37, s85
    s_waitcnt vmcnt(6)
L_qacheck_41:
    v_xor_b32 v20, s35, v20
    v_xor_b32 v21, s35, v21
    v_xor_b32 v22, s35, v22
    v_xor_b32 v23, s35, v23
    v_xor_b32 v24, s35, v24
    v_xor_b32 v25, s35, v25
    v_xor_b32 v26, s35, v26
    v_xor_b32 v27, s35, v27
    v_or_b32 v4, v20, v21
    v_or3_b32 v4, v4, v22, v23
    v_or3_b32 v4, v4, v24, v25
    v_or3_b32 v4, v4, v26, v27
    v_and_b32 v4, 0xff, v4
    v_cmp_ne_u32 vcc, 0, v4
    s_cbranch_vccz L_qaok_42
    buffer_load_dwordx4 v[20:23], v15, s[48:51], s95 offen offset:0 sc1
    buffer_load_dwordx4 v[24:27], v15, s[48:51], s95 offen offset:16 sc1
    s_waitcnt vmcnt(0)
    s_sub_u32 s84, s84, 1
    s_cmp_lg_u32 s84, 0
    s_cbranch_scc1 L_qacheck_41
    s_branch L_end
L_qaok_42:
    buffer_load_dwordx4 v[68:71], v78, s[48:51], s91 offen offset:0 sc1
    buffer_load_dwordx4 v[72:75], v78, s[48:51], s91 offen offset:16 sc1
    v_cvt_pk_bf16_f32 v20, v20, v21
    v_cvt_pk_bf16_f32 v21, v22, v23
    v_cvt_pk_bf16_f32 v22, v24, v25
    v_cvt_pk_bf16_f32 v23, v26, v27
    s_nop 1
    v_mfma_f32_16x16x32_bf16 v[28:31], a[128:131], v[20:23], 0
    v_mfma_f32_16x16x32_bf16 v[32:35], a[132:135], v[20:23], 0
    v_mfma_f32_16x16x32_bf16 v[36:39], a[136:139], v[20:23], 0
    s_nop 5
    v_mov_b32_dpp v60, v28 quad_perm:[0,0,0,0] row_mask:0xf bank_mask:0xf
    v_mov_b32_dpp v4, v30 quad_perm:[2,2,2,2] row_mask:0xf bank_mask:0xf
    s_nop 0
    v_add_f32_dpp v60, v29, v60 quad_perm:[1,1,1,1] row_mask:0xf bank_mask:0xf
    v_add_f32_dpp v4, v31, v4 quad_perm:[3,3,3,3] row_mask:0xf bank_mask:0xf
    v_add_f32 v60, v60, v4
    v_mfma_f32_16x16x32_bf16 v[40:43], a[140:143], v[20:23], 0
    v_mov_b32_dpp v61, v32 quad_perm:[0,0,0,0] row_mask:0xf bank_mask:0xf
    v_mov_b32_dpp v4, v34 quad_perm:[2,2,2,2] row_mask:0xf bank_mask:0xf
    s_nop 0
    v_add_f32_dpp v61, v33, v61 quad_perm:[1,1,1,1] row_mask:0xf bank_mask:0xf
    v_add_f32_dpp v4, v35, v4 quad_perm:[3,3,3,3] row_mask:0xf bank_mask:0xf
    v_add_f32 v61, v61, v4
    v_cvt_pk_bf16_f32 v44, v60, v61
    v_mfma_f32_16x16x32_bf16 v[28:31], a[144:147], v[20:23], 0
    v_mov_b32_dpp v60, v36 quad_perm:[0,0,0,0] row_mask:0xf bank_mask:0xf
    v_mov_b32_dpp v4, v38 quad_perm:[2,2,2,2] row_mask:0xf bank_mask:0xf
    s_nop 0
    v_add_f32_dpp v60, v37, v60 quad_perm:[1,1,1,1] row_mask:0xf bank_mask:0xf
    v_add_f32_dpp v4, v39, v4 quad_perm:[3,3,3,3] row_mask:0xf bank_mask:0xf
    v_add_f32 v60, v60, v4
    buffer_load_dwordx4 a[16:19], v76, s[52:55], s85 offen offset:0 nt
    v_mfma_f32_16x16x32_bf16 v[32:35], a[148:151], v[20:23], 0
    v_mov_b32_dpp v61, v40 quad_perm:[0,0,0,0] row_mask:0xf bank_mask:0xf
    v_mov_b32_dpp v4, v42 quad_perm:[2,2,2,2] row_mask:0xf bank_mask:0xf
    s_nop 0
    v_add_f32_dpp v61, v41, v61 quad_perm:[1,1,1,1] row_mask:0xf bank_mask:0xf
    v_add_f32_dpp v4, v43, v4 quad_perm:[3,3,3,3] row_mask:0xf bank_mask:0xf
    v_add_f32 v61, v61, v4
    v_cvt_pk_bf16_f32 v45, v60, v61
    v_mfma_f32_16x16x32_bf16 v[36:39], a[152:155], v[20:23], 0
    v_mov_b32_dpp v60, v28 quad_perm:[0,0,0,0] row_mask:0xf bank_mask:0xf
    v_mov_b32_dpp v4, v30 quad_perm:[2,2,2,2] row_mask:0xf bank_mask:0xf
    s_nop 0
    v_add_f32_dpp v60, v29, v60 quad_perm:[1,1,1,1] row_mask:0xf bank_mask:0xf
    v_add_f32_dpp v4, v31, v4 quad_perm:[3,3,3,3] row_mask:0xf bank_mask:0xf
    v_add_f32 v60, v60, v4
    v_mfma_f32_16x16x32_bf16 v[40:43], a[156:159], v[20:23], 0
    v_mov_b32_dpp v61, v32 quad_perm:[0,0,0,0] row_mask:0xf bank_mask:0xf
    v_mov_b32_dpp v4, v34 quad_perm:[2,2,2,2] row_mask:0xf bank_mask:0xf
    s_nop 0
    v_add_f32_dpp v61, v33, v61 quad_perm:[1,1,1,1] row_mask:0xf bank_mask:0xf
    v_add_f32_dpp v4, v35, v4 quad_perm:[3,3,3,3] row_mask:0xf bank_mask:0xf
    v_add_f32 v61, v61, v4
    v_cvt_pk_bf16_f32 v46, v60, v61
    v_mfma_f32_16x16x32_bf16 v[28:31], a[160:163], v[20:23], 0
    v_mov_b32_dpp v60, v36 quad_perm:[0,0,0,0] row_mask:0xf bank_mask:0xf
    v_mov_b32_dpp v4, v38 quad_perm:[2,2,2,2] row_mask:0xf bank_mask:0xf
    s_nop 0
    v_add_f32_dpp v60, v37, v60 quad_perm:[1,1,1,1] row_mask:0xf bank_mask:0xf
    v_add_f32_dpp v4, v39, v4 quad_perm:[3,3,3,3] row_mask:0xf bank_mask:0xf
    v_add_f32 v60, v60, v4
    v_mfma_f32_16x16x32_bf16 v[32:35], a[164:167], v[20:23], 0
    v_mov_b32_dpp v61, v40 quad_perm:[0,0,0,0] row_mask:0xf bank_mask:0xf
    v_mov_b32_dpp v4, v42 quad_perm:[2,2,2,2] row_mask:0xf bank_mask:0xf
    s_nop 0
    v_add_f32_dpp v61, v41, v61 quad_perm:[1,1,1,1] row_mask:0xf bank_mask:0xf
    v_add_f32_dpp v4, v43, v4 quad_perm:[3,3,3,3] row_mask:0xf bank_mask:0xf
    v_add_f32 v61, v61, v4
    v_cvt_pk_bf16_f32 v47, v60, v61
    v_mfma_f32_16x16x32_bf16 v[36:39], a[168:171], v[20:23], 0
    v_mov_b32_dpp v60, v28 quad_perm:[0,0,0,0] row_mask:0xf bank_mask:0xf
    v_mov_b32_dpp v4, v30 quad_perm:[2,2,2,2] row_mask:0xf bank_mask:0xf
    s_nop 0
    v_add_f32_dpp v60, v29, v60 quad_perm:[1,1,1,1] row_mask:0xf bank_mask:0xf
    v_add_f32_dpp v4, v31, v4 quad_perm:[3,3,3,3] row_mask:0xf bank_mask:0xf
    v_add_f32 v60, v60, v4
    v_mfma_f32_16x16x32_bf16 v[40:43], a[172:175], v[20:23], 0
    v_mov_b32_dpp v61, v32 quad_perm:[0,0,0,0] row_mask:0xf bank_mask:0xf
    v_mov_b32_dpp v4, v34 quad_perm:[2,2,2,2] row_mask:0xf bank_mask:0xf
    s_nop 0
    v_add_f32_dpp v61, v33, v61 quad_perm:[1,1,1,1] row_mask:0xf bank_mask:0xf
    v_add_f32_dpp v4, v35, v4 quad_perm:[3,3,3,3] row_mask:0xf bank_mask:0xf
    v_add_f32 v61, v61, v4
    v_cvt_pk_bf16_f32 v48, v60, v61
    v_mfma_f32_16x16x32_bf16 v[28:31], a[176:179], v[20:23], 0
    v_mov_b32_dpp v60, v36 quad_perm:[0,0,0,0] row_mask:0xf bank_mask:0xf
    v_mov_b32_dpp v4, v38 quad_perm:[2,2,2,2] row_mask:0xf bank_mask:0xf
    s_nop 0
    v_add_f32_dpp v60, v37, v60 quad_perm:[1,1,1,1] row_mask:0xf bank_mask:0xf
    v_add_f32_dpp v4, v39, v4 quad_perm:[3,3,3,3] row_mask:0xf bank_mask:0xf
    v_add_f32 v60, v60, v4
    buffer_load_dwordx4 a[20:23], v77, s[52:55], s85 offen offset:0 nt
    v_mfma_f32_16x16x32_bf16 v[32:35], a[180:183], v[20:23], 0
    v_mov_b32_dpp v61, v40 quad_perm:[0,0,0,0] row_mask:0xf bank_mask:0xf
    v_mov_b32_dpp v4, v42 quad_perm:[2,2,2,2] row_mask:0xf bank_mask:0xf
    s_nop 0
    v_add_f32_dpp v61, v41, v61 quad_perm:[1,1,1,1] row_mask:0xf bank_mask:0xf
    v_add_f32_dpp v4, v43, v4 quad_perm:[3,3,3,3] row_mask:0xf bank_mask:0xf
    v_add_f32 v61, v61, v4
    v_cvt_pk_bf16_f32 v49, v60, v61
    v_mfma_f32_16x16x32_bf16 v[36:39], a[184:187], v[20:23], 0
    v_mov_b32_dpp v60, v28 quad_perm:[0,0,0,0] row_mask:0xf bank_mask:0xf
    v_mov_b32_dpp v4, v30 quad_perm:[2,2,2,2] row_mask:0xf bank_mask:0xf
    s_nop 0
    v_add_f32_dpp v60, v29, v60 quad_perm:[1,1,1,1] row_mask:0xf bank_mask:0xf
    v_add_f32_dpp v4, v31, v4 quad_perm:[3,3,3,3] row_mask:0xf bank_mask:0xf
    v_add_f32 v60, v60, v4
    v_mfma_f32_16x16x32_bf16 v[40:43], a[188:191], v[20:23], 0
    v_mov_b32_dpp v61, v32 quad_perm:[0,0,0,0] row_mask:0xf bank_mask:0xf
    v_mov_b32_dpp v4, v34 quad_perm:[2,2,2,2] row_mask:0xf bank_mask:0xf
    s_nop 0
    v_add_f32_dpp v61, v33, v61 quad_perm:[1,1,1,1] row_mask:0xf bank_mask:0xf
    v_add_f32_dpp v4, v35, v4 quad_perm:[3,3,3,3] row_mask:0xf bank_mask:0xf
    v_add_f32 v61, v61, v4
    v_cvt_pk_bf16_f32 v50, v60, v61
    v_mfma_f32_16x16x32_bf16 v[28:31], a[192:195], v[20:23], 0
    v_mov_b32_dpp v60, v36 quad_perm:[0,0,0,0] row_mask:0xf bank_mask:0xf
    v_mov_b32_dpp v4, v38 quad_perm:[2,2,2,2] row_mask:0xf bank_mask:0xf
    s_nop 0
    v_add_f32_dpp v60, v37, v60 quad_perm:[1,1,1,1] row_mask:0xf bank_mask:0xf
    v_add_f32_dpp v4, v39, v4 quad_perm:[3,3,3,3] row_mask:0xf bank_mask:0xf
    v_add_f32 v60, v60, v4
    v_mfma_f32_16x16x32_bf16 v[32:35], a[196:199], v[20:23], 0
    v_mov_b32_dpp v61, v40 quad_perm:[0,0,0,0] row_mask:0xf bank_mask:0xf
    v_mov_b32_dpp v4, v42 quad_perm:[2,2,2,2] row_mask:0xf bank_mask:0xf
    s_nop 0
    v_add_f32_dpp v61, v41, v61 quad_perm:[1,1,1,1] row_mask:0xf bank_mask:0xf
    v_add_f32_dpp v4, v43, v4 quad_perm:[3,3,3,3] row_mask:0xf bank_mask:0xf
    v_add_f32 v61, v61, v4
    v_cvt_pk_bf16_f32 v51, v60, v61
    v_mfma_f32_16x16x32_bf16 v[36:39], a[200:203], v[20:23], 0
    v_mov_b32_dpp v60, v28 quad_perm:[0,0,0,0] row_mask:0xf bank_mask:0xf
    v_mov_b32_dpp v4, v30 quad_perm:[2,2,2,2] row_mask:0xf bank_mask:0xf
    s_nop 0
    v_add_f32_dpp v60, v29, v60 quad_perm:[1,1,1,1] row_mask:0xf bank_mask:0xf
    v_add_f32_dpp v4, v31, v4 quad_perm:[3,3,3,3] row_mask:0xf bank_mask:0xf
    v_add_f32 v60, v60, v4
    v_mfma_f32_16x16x32_bf16 v[40:43], a[204:207], v[20:23], 0
    v_mov_b32_dpp v61, v32 quad_perm:[0,0,0,0] row_mask:0xf bank_mask:0xf
    v_mov_b32_dpp v4, v34 quad_perm:[2,2,2,2] row_mask:0xf bank_mask:0xf
    s_nop 0
    v_add_f32_dpp v61, v33, v61 quad_perm:[1,1,1,1] row_mask:0xf bank_mask:0xf
    v_add_f32_dpp v4, v35, v4 quad_perm:[3,3,3,3] row_mask:0xf bank_mask:0xf
    v_add_f32 v61, v61, v4
    v_cvt_pk_bf16_f32 v52, v60, v61
    v_mfma_f32_16x16x32_bf16 v[28:31], a[208:211], v[20:23], 0
    v_mov_b32_dpp v60, v36 quad_perm:[0,0,0,0] row_mask:0xf bank_mask:0xf
    v_mov_b32_dpp v4, v38 quad_perm:[2,2,2,2] row_mask:0xf bank_mask:0xf
    s_nop 0
    v_add_f32_dpp v60, v37, v60 quad_perm:[1,1,1,1] row_mask:0xf bank_mask:0xf
    v_add_f32_dpp v4, v39, v4 quad_perm:[3,3,3,3] row_mask:0xf bank_mask:0xf
    v_add_f32 v60, v60, v4
    buffer_load_dwordx4 a[24:27], v76, s[52:55], s85 offen offset:1024 nt
    v_mfma_f32_16x16x32_bf16 v[32:35], a[212:215], v[20:23], 0
    v_mov_b32_dpp v61, v40 quad_perm:[0,0,0,0] row_mask:0xf bank_mask:0xf
    v_mov_b32_dpp v4, v42 quad_perm:[2,2,2,2] row_mask:0xf bank_mask:0xf
    s_nop 0
    v_add_f32_dpp v61, v41, v61 quad_perm:[1,1,1,1] row_mask:0xf bank_mask:0xf
    v_add_f32_dpp v4, v43, v4 quad_perm:[3,3,3,3] row_mask:0xf bank_mask:0xf
    v_add_f32 v61, v61, v4
    v_cvt_pk_bf16_f32 v53, v60, v61
    v_mfma_f32_16x16x32_bf16 v[36:39], a[216:219], v[20:23], 0
    v_mov_b32_dpp v60, v28 quad_perm:[0,0,0,0] row_mask:0xf bank_mask:0xf
    v_mov_b32_dpp v4, v30 quad_perm:[2,2,2,2] row_mask:0xf bank_mask:0xf
    s_nop 0
    v_add_f32_dpp v60, v29, v60 quad_perm:[1,1,1,1] row_mask:0xf bank_mask:0xf
    v_add_f32_dpp v4, v31, v4 quad_perm:[3,3,3,3] row_mask:0xf bank_mask:0xf
    v_add_f32 v60, v60, v4
    v_mfma_f32_16x16x32_bf16 v[40:43], a[220:223], v[20:23], 0
    v_mov_b32_dpp v61, v32 quad_perm:[0,0,0,0] row_mask:0xf bank_mask:0xf
    v_mov_b32_dpp v4, v34 quad_perm:[2,2,2,2] row_mask:0xf bank_mask:0xf
    s_nop 0
    v_add_f32_dpp v61, v33, v61 quad_perm:[1,1,1,1] row_mask:0xf bank_mask:0xf
    v_add_f32_dpp v4, v35, v4 quad_perm:[3,3,3,3] row_mask:0xf bank_mask:0xf
    v_add_f32 v61, v61, v4
    v_cvt_pk_bf16_f32 v54, v60, v61
    v_mfma_f32_16x16x32_bf16 v[28:31], a[224:227], v[20:23], 0
    v_mov_b32_dpp v60, v36 quad_perm:[0,0,0,0] row_mask:0xf bank_mask:0xf
    v_mov_b32_dpp v4, v38 quad_perm:[2,2,2,2] row_mask:0xf bank_mask:0xf
    s_nop 0
    v_add_f32_dpp v60, v37, v60 quad_perm:[1,1,1,1] row_mask:0xf bank_mask:0xf
    v_add_f32_dpp v4, v39, v4 quad_perm:[3,3,3,3] row_mask:0xf bank_mask:0xf
    v_add_f32 v60, v60, v4
    v_mfma_f32_16x16x32_bf16 v[32:35], a[228:231], v[20:23], 0
    v_mov_b32_dpp v61, v40 quad_perm:[0,0,0,0] row_mask:0xf bank_mask:0xf
    v_mov_b32_dpp v4, v42 quad_perm:[2,2,2,2] row_mask:0xf bank_mask:0xf
    s_nop 0
    v_add_f32_dpp v61, v41, v61 quad_perm:[1,1,1,1] row_mask:0xf bank_mask:0xf
    v_add_f32_dpp v4, v43, v4 quad_perm:[3,3,3,3] row_mask:0xf bank_mask:0xf
    v_add_f32 v61, v61, v4
    v_cvt_pk_bf16_f32 v55, v60, v61
    v_mfma_f32_16x16x32_bf16 v[36:39], a[232:235], v[20:23], 0
    v_mov_b32_dpp v60, v28 quad_perm:[0,0,0,0] row_mask:0xf bank_mask:0xf
    v_mov_b32_dpp v4, v30 quad_perm:[2,2,2,2] row_mask:0xf bank_mask:0xf
    s_nop 0
    v_add_f32_dpp v60, v29, v60 quad_perm:[1,1,1,1] row_mask:0xf bank_mask:0xf
    v_add_f32_dpp v4, v31, v4 quad_perm:[3,3,3,3] row_mask:0xf bank_mask:0xf
    v_add_f32 v60, v60, v4
    v_mfma_f32_16x16x32_bf16 v[40:43], a[236:239], v[20:23], 0
    v_mov_b32_dpp v61, v32 quad_perm:[0,0,0,0] row_mask:0xf bank_mask:0xf
    v_mov_b32_dpp v4, v34 quad_perm:[2,2,2,2] row_mask:0xf bank_mask:0xf
    s_nop 0
    v_add_f32_dpp v61, v33, v61 quad_perm:[1,1,1,1] row_mask:0xf bank_mask:0xf
    v_add_f32_dpp v4, v35, v4 quad_perm:[3,3,3,3] row_mask:0xf bank_mask:0xf
    v_add_f32 v61, v61, v4
    v_cvt_pk_bf16_f32 v56, v60, v61
    v_mfma_f32_16x16x32_bf16 v[28:31], a[240:243], v[20:23], 0
    v_mov_b32_dpp v60, v36 quad_perm:[0,0,0,0] row_mask:0xf bank_mask:0xf
    v_mov_b32_dpp v4, v38 quad_perm:[2,2,2,2] row_mask:0xf bank_mask:0xf
    s_nop 0
    v_add_f32_dpp v60, v37, v60 quad_perm:[1,1,1,1] row_mask:0xf bank_mask:0xf
    v_add_f32_dpp v4, v39, v4 quad_perm:[3,3,3,3] row_mask:0xf bank_mask:0xf
    v_add_f32 v60, v60, v4
    buffer_load_dwordx4 a[28:31], v77, s[52:55], s85 offen offset:1024 nt
    s_add_u32 s87, s87, 13
    s_add_u32 s39, s87, s88
    s_bfe_u32 s37, s39, 0x10000
    s_lshl_b32 s37, s37, 13
    s_add_u32 s85, s37, s89
    s_bfe_u32 s37, s39, 0x10001
    s_lshl_b32 s37, s37, 12
    s_add_u32 s85, s37, s85
    s_bfe_u32 s37, s39, 0x10002
    s_lshl_b32 s37, s37, 11
    s_add_u32 s85, s37, s85
    s_bfe_u32 s37, s39, 0x10003
    s_lshl_b32 s37, s37, 14
    s_add_u32 s85, s37, s85
    s_bfe_u32 s37, s39, 0x40004
    s_lshl_b32 s37, s37, 16
    s_add_u32 s85, s37, s85
    v_mfma_f32_16x16x32_bf16 v[32:35], a[244:247], v[20:23], 0
    v_mov_b32_dpp v61, v40 quad_perm:[0,0,0,0] row_mask:0xf bank_mask:0xf
    v_mov_b32_dpp v4, v42 quad_perm:[2,2,2,2] row_mask:0xf bank_mask:0xf
    s_nop 0
    v_add_f32_dpp v61, v41, v61 quad_perm:[1,1,1,1] row_mask:0xf bank_mask:0xf
    v_add_f32_dpp v4, v43, v4 quad_perm:[3,3,3,3] row_mask:0xf bank_mask:0xf
    v_add_f32 v61, v61, v4
    v_cvt_pk_bf16_f32 v57, v60, v61
    v_mfma_f32_16x16x32_bf16 v[36:39], a[248:251], v[20:23], 0
    v_mov_b32_dpp v60, v28 quad_perm:[0,0,0,0] row_mask:0xf bank_mask:0xf
    v_mov_b32_dpp v4, v30 quad_perm:[2,2,2,2] row_mask:0xf bank_mask:0xf
    s_nop 0
    v_add_f32_dpp v60, v29, v60 quad_perm:[1,1,1,1] row_mask:0xf bank_mask:0xf
    v_add_f32_dpp v4, v31, v4 quad_perm:[3,3,3,3] row_mask:0xf bank_mask:0xf
    v_add_f32 v60, v60, v4
    v_mfma_f32_16x16x32_bf16 v[40:43], a[252:255], v[20:23], 0
    v_mov_b32_dpp v61, v32 quad_perm:[0,0,0,0] row_mask:0xf bank_mask:0xf
    v_mov_b32_dpp v4, v34 quad_perm:[2,2,2,2] row_mask:0xf bank_mask:0xf
    s_nop 0
    v_add_f32_dpp v61, v33, v61 quad_perm:[1,1,1,1] row_mask:0xf bank_mask:0xf
    v_add_f32_dpp v4, v35, v4 quad_perm:[3,3,3,3] row_mask:0xf bank_mask:0xf
    v_add_f32 v61, v61, v4
    v_cvt_pk_bf16_f32 v58, v60, v61
    v_mov_b32_dpp v60, v36 quad_perm:[0,0,0,0] row_mask:0xf bank_mask:0xf
    v_mov_b32_dpp v4, v38 quad_perm:[2,2,2,2] row_mask:0xf bank_mask:0xf
    s_nop 0
    v_add_f32_dpp v60, v37, v60 quad_perm:[1,1,1,1] row_mask:0xf bank_mask:0xf
    v_add_f32_dpp v4, v39, v4 quad_perm:[3,3,3,3] row_mask:0xf bank_mask:0xf
    v_add_f32 v60, v60, v4
    v_mov_b32_dpp v61, v40 quad_perm:[0,0,0,0] row_mask:0xf bank_mask:0xf
    v_mov_b32_dpp v4, v42 quad_perm:[2,2,2,2] row_mask:0xf bank_mask:0xf
    s_nop 0
    v_add_f32_dpp v61, v41, v61 quad_perm:[1,1,1,1] row_mask:0xf bank_mask:0xf
    v_add_f32_dpp v4, v43, v4 quad_perm:[3,3,3,3] row_mask:0xf bank_mask:0xf
    v_add_f32 v61, v61, v4
    v_cvt_pk_bf16_f32 v59, v60, v61
    s_mov_b32 exec_lo, 0x22222222
    s_mov_b32 exec_hi, 0x22222222
    v_mov_b32 v44, v48
    v_mov_b32 v45, v49
    v_mov_b32 v46, v50
    v_mov_b32 v47, v51
    s_mov_b32 exec_lo, 0x44444444
    s_mov_b32 exec_hi, 0x44444444
    v_mov_b32 v44, v52
    v_mov_b32 v45, v53
    v_mov_b32 v46, v54
    v_mov_b32 v47, v55
    s_mov_b32 exec_lo, 0x88888888
    s_mov_b32 exec_hi, 0x88888888
    v_mov_b32 v44, v56
    v_mov_b32 v45, v57
    v_mov_b32 v46, v58
    v_mov_b32 v47, v59
    s_mov_b64 exec, -1
    buffer_store_dwordx4 v[44:47], v19, s[48:51], s94 offen sc1
    s_waitcnt vmcnt(5)
L_qcheck_43:
    v_xor_b32 v68, s35, v68
    v_xor_b32 v69, s35, v69
    v_xor_b32 v70, s35, v70
    v_xor_b32 v71, s35, v71
    v_xor_b32 v72, s35, v72
    v_xor_b32 v73, s35, v73
    v_xor_b32 v74, s35, v74
    v_xor_b32 v75, s35, v75
    v_or_b32 v4, v68, v69
    v_or3_b32 v4, v4, v70, v71
    v_or3_b32 v4, v4, v72, v73
    v_or3_b32 v4, v4, v74, v75
    v_and_b32 v4, 0xff, v4
    v_cmp_ne_u32 vcc, 0, v4
    s_cbranch_vccz L_qok_44
    buffer_load_dwordx4 v[68:71], v78, s[48:51], s91 offen offset:0 sc1
    buffer_load_dwordx4 v[72:75], v78, s[48:51], s91 offen offset:16 sc1
    s_waitcnt vmcnt(0)
    s_sub_u32 s84, s84, 1
    s_cmp_lg_u32 s84, 0
    s_cbranch_scc1 L_qcheck_43
    s_branch L_end
L_qok_44:
    v_cvt_pk_bf16_f32 v68, v68, v69
    v_cvt_pk_bf16_f32 v69, v70, v71
    v_cvt_pk_bf16_f32 v70, v72, v73
    v_cvt_pk_bf16_f32 v71, v74, v75
    s_mov_b32 vcc_lo, 0xf000f
    s_mov_b32 vcc_hi, 0xf000f
    v_cndmask_b32 v80, 0, v68, vcc
    v_cndmask_b32 v81, 0, v69, vcc
    v_cndmask_b32 v82, 0, v70, vcc
    v_cndmask_b32 v83, 0, v71, vcc
    s_mov_b32 vcc_lo, 0xf000f0
    s_mov_b32 vcc_hi, 0xf000f0
    v_cndmask_b32 v84, 0, v68, vcc
    v_cndmask_b32 v85, 0, v69, vcc
    v_cndmask_b32 v86, 0, v70, vcc
    v_cndmask_b32 v87, 0, v71, vcc
    s_mov_b32 vcc_lo, 0xf000f00
    s_mov_b32 vcc_hi, 0xf000f00
    v_cndmask_b32 v88, 0, v68, vcc
    v_cndmask_b32 v89, 0, v69, vcc
    v_cndmask_b32 v90, 0, v70, vcc
    v_cndmask_b32 v91, 0, v71, vcc
    s_mov_b32 vcc_lo, 0xf000f000
    s_mov_b32 vcc_hi, 0xf000f000
    v_cndmask_b32 v92, 0, v68, vcc
    v_cndmask_b32 v93, 0, v69, vcc
    v_cndmask_b32 v94, 0, v70, vcc
    v_cndmask_b32 v95, 0, v71, vcc
    s_getreg_b32 s70, hwreg(HW_REG_XCC_ID, 0, 4)
    s_lshl_b32 s70, s70, 8
    s_or_b32 s70, s70, s35
    s_or_b32 s70, s70, 0x5e9d0000
    s_bfe_u32 s38, s2, 0x30000
    s_lshl_b32 s38, s38, 8
    s_add_u32 s69, s38, 32768
    s_lshl_b32 s38, s32, 2
    s_add_u32 s69, s38, s69
    s_lshl_b32 s38, s34, 24
    s_add_u32 s69, s38, s69
    v_mov_b32 v72, s69
    v_mov_b32 v73, s70
    s_mov_b64 exec, 1
    buffer_store_dword v73, v72, s[48:51], 0 offen sc1
    s_mov_b64 exec, -1
    v_mov_b32 v65, 0xff7f0000
    s_lshl_b32 s38, s34, 14
    s_add_u32 s38, s38, 16384
    v_lshl_add_u32 v64, v1, 2, s38
    buffer_load_dwordx4 a[32:35], v76, s[52:55], s85 offen offset:0 nt
    v_mfma_f32_16x16x32_bf16 v[112:115], v[128:131], v[80:83], 0
    v_mfma_f32_16x16x32_bf16 v[112:115], v[132:135], v[84:87], v[112:115]
    buffer_load_dwordx4 a[36:39], v77, s[52:55], s85 offen offset:0 nt
    v_mfma_f32_16x16x32_bf16 v[112:115], v[136:139], v[88:91], v[112:115]
    v_mfma_f32_16x16x32_bf16 v[112:115], v[140:143], v[92:95], v[112:115]
    buffer_load_dwordx4 a[40:43], v76, s[52:55], s85 offen offset:1024 nt
    v_mfma_f32_16x16x32_bf16 v[96:99], v[144:147], v[80:83], 0
    v_mfma_f32_16x16x32_bf16 v[96:99], v[148:151], v[84:87], v[96:99]
    s_waitcnt vmcnt(8)
    buffer_load_dwordx4 a[44:47], v77, s[52:55], s85 offen offset:1024 nt
    s_add_u32 s87, s87, 1
    s_add_u32 s39, s87, s88
    s_bfe_u32 s37, s39, 0x10000
    s_lshl_b32 s37, s37, 13
    s_add_u32 s85, s37, s89
    s_bfe_u32 s37, s39, 0x10001
    s_lshl_b32 s37, s37, 12
    s_add_u32 s85, s37, s85
    s_bfe_u32 s37, s39, 0x10002
    s_lshl_b32 s37, s37, 11
    s_add_u32 s85, s37, s85
    s_bfe_u32 s37, s39, 0x10003
    s_lshl_b32 s37, s37, 14
    s_add_u32 s85, s37, s85
    s_bfe_u32 s37, s39, 0x40004
    s_lshl_b32 s37, s37, 16
    s_add_u32 s85, s37, s85
    v_mfma_f32_16x16x32_bf16 v[96:99], v[152:155], v[88:91], v[96:99]
    v_mov_b32_dpp v122, v112 quad_perm:[0,0,0,0] row_mask:0xf bank_mask:0xf
    v_mov_b32_dpp v124, v114 quad_perm:[2,2,2,2] row_mask:0xf bank_mask:0xf
    s_nop 0
    v_add_f32_dpp v122, v113, v122 quad_perm:[1,1,1,1] row_mask:0xf bank_mask:0xf
    v_add_f32_dpp v124, v115, v124 quad_perm:[3,3,3,3] row_mask:0xf bank_mask:0xf
    v_add_f32 v122, v122, v124
    v_max_f32 v65, v65, v122
    ds_write_b32 v64, v122 offset:0
    v_mfma_f32_16x16x32_bf16 v[96:99], v[156:159], v[92:95], v[96:99]
    s_waitcnt vmcnt(8)
    buffer_load_dwordx4 a[48:51], v76, s[52:55], s85 offen offset:0 nt
    v_mfma_f32_16x16x32_bf16 v[112:115], v[160:163], v[80:83], 0
    v_mfma_f32_16x16x32_bf16 v[112:115], v[164:167], v[84:87], v[112:115]
    s_waitcnt vmcnt(8)
    buffer_load_dwordx4 a[52:55], v77, s[52:55], s85 offen offset:0 nt
    v_mfma_f32_16x16x32_bf16 v[112:115], v[168:171], v[88:91], v[112:115]
    s_nop 0
    v_mov_b32_dpp v122, v96 quad_perm:[0,0,0,0] row_mask:0xf bank_mask:0xf
    v_mov_b32_dpp v124, v98 quad_perm:[2,2,2,2] row_mask:0xf bank_mask:0xf
    s_nop 0
    v_add_f32_dpp v122, v97, v122 quad_perm:[1,1,1,1] row_mask:0xf bank_mask:0xf
    v_add_f32_dpp v124, v99, v124 quad_perm:[3,3,3,3] row_mask:0xf bank_mask:0xf
    v_add_f32 v122, v122, v124
    v_max_f32 v65, v65, v122
    ds_write_b32 v64, v122 offset:256
    v_mfma_f32_16x16x32_bf16 v[112:115], v[172:175], v[92:95], v[112:115]
    s_waitcnt vmcnt(8)
    buffer_load_dwordx4 a[56:59], v76, s[52:55], s85 offen offset:1024 nt
    v_mfma_f32_16x16x32_bf16 v[96:99], v[176:179], v[80:83], 0
    v_mfma_f32_16x16x32_bf16 v[96:99], v[180:183], v[84:87], v[96:99]
    s_waitcnt vmcnt(6)
    buffer_load_dwordx4 a[60:63], v77, s[52:55], s85 offen offset:1024 nt
    s_add_u32 s87, s87, 13
    s_add_u32 s39, s87, s88
    s_bfe_u32 s37, s39, 0x10000
    s_lshl_b32 s37, s37, 13
    s_add_u32 s85, s37, s89
    s_bfe_u32 s37, s39, 0x10001
    s_lshl_b32 s37, s37, 12
    s_add_u32 s85, s37, s85
    s_bfe_u32 s37, s39, 0x10002
    s_lshl_b32 s37, s37, 11
    s_add_u32 s85, s37, s85
    s_bfe_u32 s37, s39, 0x10003
    s_lshl_b32 s37, s37, 14
    s_add_u32 s85, s37, s85
    s_bfe_u32 s37, s39, 0x40004
    s_lshl_b32 s37, s37, 16
    s_add_u32 s85, s37, s85
    v_mfma_f32_16x16x32_bf16 v[96:99], v[184:187], v[88:91], v[96:99]
    v_mov_b32_dpp v122, v112 quad_perm:[0,0,0,0] row_mask:0xf bank_mask:0xf
    v_mov_b32_dpp v124, v114 quad_perm:[2,2,2,2] row_mask:0xf bank_mask:0xf
    s_nop 0
    v_add_f32_dpp v122, v113, v122 quad_perm:[1,1,1,1] row_mask:0xf bank_mask:0xf
    v_add_f32_dpp v124, v115, v124 quad_perm:[3,3,3,3] row_mask:0xf bank_mask:0xf
    v_add_f32 v122, v122, v124
    v_max_f32 v65, v65, v122
    ds_write_b32 v64, v122 offset:512
    s_lshl_b32 s38, s32, 8
    s_add_u32 s69, s38, 98304
    s_lshl_b32 s38, s34, 23
    s_add_u32 s69, s38, s69
    v_mov_b32 v48, s69
    v_mov_b32 v49, s68
    s_barrier
    s_mov_b64 exec, 1
    buffer_store_dword v49, v48, s[48:51], 0 offen sc1
    s_mov_b64 exec, -1
    v_mfma_f32_16x16x32_bf16 v[96:99], v[188:191], v[92:95], v[96:99]
    v_mfma_f32_16x16x32_bf16 v[112:115], v[192:195], v[80:83], 0
    s_waitcnt vmcnt(7)
    buffer_load_dwordx4 a[64:67], v76, s[52:55], s85 offen offset:0 nt
    v_mfma_f32_16x16x32_bf16 v[112:115], v[196:199], v[84:87], v[112:115]
    v_mfma_f32_16x16x32_bf16 v[112:115], v[200:203], v[88:91], v[112:115]
    s_nop 2
    v_mov_b32_dpp v122, v96 quad_perm:[0,0,0,0] row_mask:0xf bank_mask:0xf
    v_mov_b32_dpp v124, v98 quad_perm:[2,2,2,2] row_mask:0xf bank_mask:0xf
    s_nop 0
    v_add_f32_dpp v122, v97, v122 quad_perm:[1,1,1,1] row_mask:0xf bank_mask:0xf
    v_add_f32_dpp v124, v99, v124 quad_perm:[3,3,3,3] row_mask:0xf bank_mask:0xf
    v_add_f32 v122, v122, v124
    v_max_f32 v65, v65, v122
    ds_write_b32 v64, v122 offset:768
    s_waitcnt vmcnt(7)
    buffer_load_dwordx4 a[68:71], v77, s[52:55], s85 offen offset:0 nt
    v_mfma_f32_16x16x32_bf16 v[112:115], v[204:207], v[92:95], v[112:115]
    v_mfma_f32_16x16x32_bf16 v[96:99], v[208:211], v[80:83], 0
    s_waitcnt vmcnt(7)
    buffer_load_dwordx4 a[72:75], v76, s[52:55], s85 offen offset:1024 nt
    v_mfma_f32_16x16x32_bf16 v[96:99], v[212:215], v[84:87], v[96:99]
    v_mfma_f32_16x16x32_bf16 v[96:99], v[216:219], v[88:91], v[96:99]
    s_nop 2
    v_mov_b32_dpp v122, v112 quad_perm:[0,0,0,0] row_mask:0xf bank_mask:0xf
    v_mov_b32_dpp v124, v114 quad_perm:[2,2,2,2] row_mask:0xf bank_mask:0xf
    s_nop 0
    v_add_f32_dpp v122, v113, v122 quad_perm:[1,1,1,1] row_mask:0xf bank_mask:0xf
    v_add_f32_dpp v124, v115, v124 quad_perm:[3,3,3,3] row_mask:0xf bank_mask:0xf
    v_add_f32 v122, v122, v124
    v_max_f32 v65, v65, v122
    ds_write_b32 v64, v122 offset:1024
    s_waitcnt vmcnt(7)
    buffer_load_dwordx4 a[76:79], v77, s[52:55], s85 offen offset:1024 nt
    s_add_u32 s87, s87, 1
    s_add_u32 s39, s87, s88
    s_bfe_u32 s37, s39, 0x10000
    s_lshl_b32 s37, s37, 13
    s_add_u32 s85, s37, s89
    s_bfe_u32 s37, s39, 0x10001
    s_lshl_b32 s37, s37, 12
    s_add_u32 s85, s37, s85
    s_bfe_u32 s37, s39, 0x10002
    s_lshl_b32 s37, s37, 11
    s_add_u32 s85, s37, s85
    s_bfe_u32 s37, s39, 0x10003
    s_lshl_b32 s37, s37, 14
    s_add_u32 s85, s37, s85
    s_bfe_u32 s37, s39, 0x40004
    s_lshl_b32 s37, s37, 16
    s_add_u32 s85, s37, s85
    v_mfma_f32_16x16x32_bf16 v[96:99], v[220:223], v[92:95], v[96:99]
    v_mfma_f32_16x16x32_bf16 v[112:115], v[224:227], v[80:83], 0
    s_waitcnt vmcnt(7)
    buffer_load_dwordx4 a[80:83], v76, s[52:55], s85 offen offset:0 nt
    v_mfma_f32_16x16x32_bf16 v[112:115], v[228:231], v[84:87], v[112:115]
    v_mfma_f32_16x16x32_bf16 v[112:115], v[232:235], v[88:91], v[112:115]
    s_nop 2
    v_mov_b32_dpp v122, v96 quad_perm:[0,0,0,0] row_mask:0xf bank_mask:0xf
    v_mov_b32_dpp v124, v98 quad_perm:[2,2,2,2] row_mask:0xf bank_mask:0xf
    s_nop 0
    v_add_f32_dpp v122, v97, v122 quad_perm:[1,1,1,1] row_mask:0xf bank_mask:0xf
    v_add_f32_dpp v124, v99, v124 quad_perm:[3,3,3,3] row_mask:0xf bank_mask:0xf
    v_add_f32 v122, v122, v124
    v_max_f32 v65, v65, v122
    ds_write_b32 v64, v122 offset:1280
    s_waitcnt vmcnt(7)
    buffer_load_dwordx4 a[84:87], v77, s[52:55], s85 offen offset:0 nt
    v_mfma_f32_16x16x32_bf16 v[112:115], v[236:239], v[92:95], v[112:115]
    v_mfma_f32_16x16x32_bf16 v[96:99], v[240:243], v[80:83], 0
    s_waitcnt vmcnt(7)
    buffer_load_dwordx4 a[88:91], v76, s[52:55], s85 offen offset:1024 nt
    v_mfma_f32_16x16x32_bf16 v[96:99], v[244:247], v[84:87], v[96:99]
    v_mfma_f32_16x16x32_bf16 v[96:99], v[248:251], v[88:91], v[96:99]
    s_nop 2
    v_mov_b32_dpp v122, v112 quad_perm:[0,0,0,0] row_mask:0xf bank_mask:0xf
    v_mov_b32_dpp v124, v114 quad_perm:[2,2,2,2] row_mask:0xf bank_mask:0xf
    s_nop 0
    v_add_f32_dpp v122, v113, v122 quad_perm:[1,1,1,1] row_mask:0xf bank_mask:0xf
    v_add_f32_dpp v124, v115, v124 quad_perm:[3,3,3,3] row_mask:0xf bank_mask:0xf
    v_add_f32 v122, v122, v124
    v_max_f32 v65, v65, v122
    ds_write_b32 v64, v122 offset:1536
    v_mfma_f32_16x16x32_bf16 v[96:99], v[252:255], v[92:95], v[96:99]
    s_waitcnt vmcnt(6)
    buffer_load_dwordx4 a[92:95], v77, s[52:55], s85 offen offset:1024 nt
    s_add_u32 s87, s87, 13
    s_add_u32 s39, s87, s88
    s_bfe_u32 s37, s39, 0x10000
    s_lshl_b32 s37, s37, 13
    s_add_u32 s85, s37, s89
    s_bfe_u32 s37, s39, 0x10001
    s_lshl_b32 s37, s37, 12
    s_add_u32 s85, s37, s85
    s_bfe_u32 s37, s39, 0x10002
    s_lshl_b32 s37, s37, 11
    s_add_u32 s85, s37, s85
    s_bfe_u32 s37, s39, 0x10003
    s_lshl_b32 s37, s37, 14
    s_add_u32 s85, s37, s85
    s_bfe_u32 s37, s39, 0x40004
    s_lshl_b32 s37, s37, 16
    s_add_u32 s85, s37, s85
    v_mfma_f32_16x16x32_bf16 v[112:115], a[0:3], v[80:83], 0
    v_mfma_f32_16x16x32_bf16 v[112:115], a[4:7], v[84:87], v[112:115]
    s_waitcnt vmcnt(6)
    buffer_load_dwordx4 a[96:99], v76, s[52:55], s85 offen offset:0 nt
    v_mfma_f32_16x16x32_bf16 v[112:115], a[8:11], v[88:91], v[112:115]
    v_mov_b32_dpp v122, v96 quad_perm:[0,0,0,0] row_mask:0xf bank_mask:0xf
    v_mov_b32_dpp v124, v98 quad_perm:[2,2,2,2] row_mask:0xf bank_mask:0xf
    s_nop 0
    v_add_f32_dpp v122, v97, v122 quad_perm:[1,1,1,1] row_mask:0xf bank_mask:0xf
    v_add_f32_dpp v124, v99, v124 quad_perm:[3,3,3,3] row_mask:0xf bank_mask:0xf
    v_add_f32 v122, v122, v124
    v_max_f32 v65, v65, v122
    ds_write_b32 v64, v122 offset:1792
    v_mfma_f32_16x16x32_bf16 v[112:115], a[12:15], v[92:95], v[112:115]
    s_waitcnt vmcnt(6)
    buffer_load_dwordx4 a[100:103], v77, s[52:55], s85 offen offset:0 nt
    v_mfma_f32_16x16x32_bf16 v[96:99], a[16:19], v[80:83], 0
    v_mfma_f32_16x16x32_bf16 v[96:99], a[20:23], v[84:87], v[96:99]
    s_waitcnt vmcnt(6)
    buffer_load_dwordx4 a[104:107], v76, s[52:55], s85 offen offset:1024 nt
    v_mfma_f32_16x16x32_bf16 v[96:99], a[24:27], v[88:91], v[96:99]
    s_nop 0
    v_mov_b32_dpp v122, v112 quad_perm:[0,0,0,0] row_mask:0xf bank_mask:0xf
    v_mov_b32_dpp v124, v114 quad_perm:[2,2,2,2] row_mask:0xf bank_mask:0xf
    s_nop 0
    v_add_f32_dpp v122, v113, v122 quad_perm:[1,1,1,1] row_mask:0xf bank_mask:0xf
    v_add_f32_dpp v124, v115, v124 quad_perm:[3,3,3,3] row_mask:0xf bank_mask:0xf
    v_add_f32 v122, v122, v124
    v_max_f32 v65, v65, v122
    ds_write_b32 v64, v122 offset:2048
    v_mfma_f32_16x16x32_bf16 v[96:99], a[28:31], v[92:95], v[96:99]
    s_waitcnt vmcnt(6)
    buffer_load_dwordx4 a[108:111], v77, s[52:55], s85 offen offset:1024 nt
    s_add_u32 s87, s87, 1
    s_add_u32 s39, s87, s88
    s_bfe_u32 s37, s39, 0x10000
    s_lshl_b32 s37, s37, 13
    s_add_u32 s85, s37, s89
    s_bfe_u32 s37, s39, 0x10001
    s_lshl_b32 s37, s37, 12
    s_add_u32 s85, s37, s85
    s_bfe_u32 s37, s39, 0x10002
    s_lshl_b32 s37, s37, 11
    s_add_u32 s85, s37, s85
    s_bfe_u32 s37, s39, 0x10003
    s_lshl_b32 s37, s37, 14
    s_add_u32 s85, s37, s85
    s_bfe_u32 s37, s39, 0x40004
    s_lshl_b32 s37, s37, 16
    s_add_u32 s85, s37, s85
    v_mfma_f32_16x16x32_bf16 v[112:115], a[32:35], v[80:83], 0
    s_bfe_u32 s38, s2, 0x20001
    s_lshl_b32 s38, s38, 0
    s_add_u32 s90, s38, 0
    s_bfe_u32 s38, s2, 0x10000
    s_lshl_b32 s38, s38, 2
    s_add_u32 s90, s38, s90
    s_and_b32 s36, s90, 3
    s_bitcmp0_b32 s90, 2
    s_cselect_b64 s[40:41], s[24:25], s[14:15]
    s_cselect_b32 s45, 262144, 0
    s_add_u32 s45, s45, 524288
    s_lshl_b32 s38, s36, 16
    s_add_u32 s71, s38, s45
    s_lshr_b32 s38, s32, 2
    s_lshl_b32 s38, s38, 13
    s_add_u32 s71, s38, s71
    s_bfe_u32 s38, s32, 0x20000
    s_lshl_b32 s38, s38, 6
    s_add_u32 s71, s38, s71
    s_mov_b32 s42, 4194304
    s_mov_b32 s43, 0x20000
    s_lshl_b32 s38, s32, 17
    s_add_u32 s44, s38, 0
    s_lshl_b32 s38, s34, 15
    s_add_u32 s44, s38, s44
    s_lshl_b32 s38, s36, 8
    s_add_u32 s44, s38, s44
    s_lshl_b32 s38, s36, 16
    s_add_u32 s45, s38, s45
    s_lshr_b32 s38, s34, 1
    s_lshl_b32 s38, s38, 15
    s_add_u32 s45, s38, s45
    s_lshl_b32 s38, s32, 8
    s_add_u32 s45, s38, s45
    s_bfe_u32 s38, s34, 0x10000
    s_lshl_b32 s38, s38, 7
    s_add_u32 s45, s38, s45
    s_lshl_b32 s38, s32, 11
    s_add_u32 s46, s38, 196608
    s_lshl_b32 s38, s34, 9
    s_add_u32 s46, s38, s46
    s_mov_b32 s72, s26
    s_and_b32 s73, s27, 0xffff
    s_mov_b32 s74, 8192
    s_mov_b32 s75, 0x20000
    v_mfma_f32_16x16x32_bf16 v[112:115], a[36:39], v[84:87], v[112:115]
    s_waitcnt vmcnt(6)
    buffer_load_dwordx4 a[112:115], v76, s[52:55], s85 offen offset:0 nt
    v_mfma_f32_16x16x32_bf16 v[112:115], a[40:43], v[88:91], v[112:115]
    v_mov_b32_dpp v122, v96 quad_perm:[0,0,0,0] row_mask:0xf bank_mask:0xf
    v_mov_b32_dpp v124, v98 quad_perm:[2,2,2,2] row_mask:0xf bank_mask:0xf
    s_nop 0
    v_add_f32_dpp v122, v97, v122 quad_perm:[1,1,1,1] row_mask:0xf bank_mask:0xf
    v_add_f32_dpp v124, v99, v124 quad_perm:[3,3,3,3] row_mask:0xf bank_mask:0xf
    v_add_f32 v122, v122, v124
    v_max_f32 v65, v65, v122
    ds_write_b32 v64, v122 offset:2304
    v_mfma_f32_16x16x32_bf16 v[112:115], a[44:47], v[92:95], v[112:115]
    s_waitcnt vmcnt(6)
    buffer_load_dwordx4 a[116:119], v77, s[52:55], s85 offen offset:0 nt
    v_mfma_f32_16x16x32_bf16 v[96:99], a[48:51], v[80:83], 0
    v_mfma_f32_16x16x32_bf16 v[96:99], a[52:55], v[84:87], v[96:99]
    s_waitcnt vmcnt(6)
    buffer_load_dwordx4 a[120:123], v76, s[52:55], s85 offen offset:1024 nt
    v_mfma_f32_16x16x32_bf16 v[96:99], a[56:59], v[88:91], v[96:99]
    s_nop 0
    v_mov_b32_dpp v122, v112 quad_perm:[0,0,0,0] row_mask:0xf bank_mask:0xf
    v_mov_b32_dpp v124, v114 quad_perm:[2,2,2,2] row_mask:0xf bank_mask:0xf
    s_nop 0
    v_add_f32_dpp v122, v113, v122 quad_perm:[1,1,1,1] row_mask:0xf bank_mask:0xf
    v_add_f32_dpp v124, v115, v124 quad_perm:[3,3,3,3] row_mask:0xf bank_mask:0xf
    v_add_f32 v122, v122, v124
    v_max_f32 v65, v65, v122
    ds_write_b32 v64, v122 offset:2560
    v_lshlrev_b32 v4, 2, v2
    v_xor_b32 v4, v4, v3
    v_xor_b32 v5, 0, v4
    v_lshlrev_b32 v5, 4, v5
    v_lshl_add_u32 v20, v2, 10, v5
    v_xor_b32 v5, 1, v4
    v_lshlrev_b32 v5, 4, v5
    v_lshl_add_u32 v21, v2, 10, v5
    v_add_u32 v21, 3072, v21
    v_xor_b32 v5, 2, v4
    v_lshlrev_b32 v5, 4, v5
    v_lshl_add_u32 v22, v2, 10, v5
    v_add_u32 v22, 6144, v22
    v_xor_b32 v5, 3, v4
    v_lshlrev_b32 v5, 4, v5
    v_lshl_add_u32 v23, v2, 10, v5
    v_add_u32 v23, 9216, v23
    s_lshl_b32 s38, s32, 15
    s_add_u32 s47, s38, 1048576
    s_lshl_b32 s38, s3, 13
    s_add_u32 s47, s38, s47
    v_lshlrev_b32 v6, 7, v2
    v_bfe_u32 v5, v3, 0, 3
    v_lshl_add_u32 v6, v5, 4, v6
    v_lshrrev_b32 v4, 3, v3
    v_and_b32 v7, 3, v3
    v_min_u32 v7, 2, v7
    v_lshl_add_u32 v7, v7, 1, v4
    v_add_u32 v5, 0, v4
    v_cmp_le_u32 vcc, s33, v5
    s_nop 1
    v_addc_co_u32 v5, vcc, 0, v5, vcc
    v_lshl_add_u32 v50, v5, 10, v6
    v_add_u32 v5, 2, v4
    v_cmp_le_u32 vcc, s33, v5
    s_nop 1
    v_addc_co_u32 v5, vcc, 0, v5, vcc
    v_lshl_add_u32 v51, v5, 10, v6
    v_add_u32 v5, 4, v4
    v_cmp_le_u32 vcc, s33, v5
    s_nop 1
    v_addc_co_u32 v5, vcc, 0, v5, vcc
    v_lshl_add_u32 v52, v5, 10, v6
    v_mov_b32 v5, v7
    v_mov_b32 v6, 512
    v_cmp_le_u32 vcc, s33, v5
    s_nop 1
    v_addc_co_u32 v5, vcc, 0, v5, vcc
    v_lshl_add_u32 v53, v5, 10, v6
    s_mul_i32 s38, s3, 320
    s_add_u32 s38, s38, 135168
    v_lshlrev_b32 v4, 6, v2
    v_lshl_add_u32 v4, v3, 1, v4
    v_add_u32 v31, s38, v4
    v_mfma_f32_16x16x32_bf16 v[96:99], a[60:63], v[92:95], v[96:99]
    v_mfma_f32_16x16x32_bf16 v[112:115], a[64:67], v[80:83], 0
    s_waitcnt vmcnt(6)
    buffer_load_dwordx4 a[124:127], v77, s[52:55], s85 offen offset:1024 nt
    s_add_u32 s87, s87, 13
    s_add_u32 s39, s87, s88
    s_bfe_u32 s37, s39, 0x10000
    s_lshl_b32 s37, s37, 13
    s_add_u32 s85, s37, s89
    s_bfe_u32 s37, s39, 0x10001
    s_lshl_b32 s37, s37, 12
    s_add_u32 s85, s37, s85
    s_bfe_u32 s37, s39, 0x10002
    s_lshl_b32 s37, s37, 11
    s_add_u32 s85, s37, s85
    s_bfe_u32 s37, s39, 0x10003
    s_lshl_b32 s37, s37, 14
    s_add_u32 s85, s37, s85
    s_bfe_u32 s37, s39, 0x40004
    s_lshl_b32 s37, s37, 16
    s_add_u32 s85, s37, s85
    v_mfma_f32_16x16x32_bf16 v[112:115], a[68:71], v[84:87], v[112:115]
    v_mfma_f32_16x16x32_bf16 v[112:115], a[72:75], v[88:91], v[112:115]
    v_mov_b32_dpp v122, v96 quad_perm:[0,0,0,0] row_mask:0xf bank_mask:0xf
    v_mov_b32_dpp v124, v98 quad_perm:[2,2,2,2] row_mask:0xf bank_mask:0xf
    s_nop 0
    v_add_f32_dpp v122, v97, v122 quad_perm:[1,1,1,1] row_mask:0xf bank_mask:0xf
    v_add_f32_dpp v124, v99, v124 quad_perm:[3,3,3,3] row_mask:0xf bank_mask:0xf
    v_add_f32 v122, v122, v124
    v_max_f32 v65, v65, v122
    ds_write_b32 v64, v122 offset:2816
    s_waitcnt vmcnt(5)
    buffer_load_dwordx4 v[128:131], v76, s[52:55], s85 offen offset:0 nt
    v_mfma_f32_16x16x32_bf16 v[112:115], a[76:79], v[92:95], v[112:115]
    v_mfma_f32_16x16x32_bf16 v[96:99], a[80:83], v[80:83], 0
    v_lshlrev_b32 v4, 11, v2
    v_bfe_u32 v5, v1, 2, 2
    v_lshl_add_u32 v4, v5, 8, v4
    v_bfe_u32 v5, v1, 2, 2
    v_lshl_add_u32 v4, v5, 6, v4
    v_bfe_u32 v5, v1, 4, 1
    v_lshl_add_u32 v4, v5, 5, v4
    v_bfe_u32 v5, v1, 1, 1
    v_lshl_add_u32 v4, v5, 4, v4
    v_bfe_u32 v5, v1, 0, 1
    v_lshl_add_u32 v4, v5, 3, v4
    s_lshl_b32 s38, s34, 6
    s_add_u32 s38, s38, 98304
    v_xor_b32 v24, s38, v4
    v_xor_b32 v25, 16, v24
    v_xor_b32 v26, 32, v24
    v_xor_b32 v27, 48, v24
    v_and_b32 v4, 3, v3
    v_lshrrev_b32 v5, 2, v3
    v_lshlrev_b32 v6, 4, v2
    v_add_u32 v6, 135168, v6
    s_movk_i32 s36, 320
    v_cmp_eq_u32 vcc, 0, v5
    s_nop 1
    v_cndmask_b32 v28, 4, v4, vcc
    v_mad_u32_u24 v28, v28, s36, v6
    v_cmp_eq_u32 vcc, 1, v5
    s_nop 1
    v_cndmask_b32 v29, 4, v4, vcc
    v_mad_u32_u24 v29, v29, s36, v6
    v_lshlrev_b32 v5, 2, v1
    v_add_u32 v5, 136448, v5
    v_mov_b32 v6, 0
    ds_write_b32 v5, v6
    s_waitcnt vmcnt(5)
    buffer_load_dwordx4 v[132:135], v77, s[52:55], s85 offen offset:0 nt
    v_mfma_f32_16x16x32_bf16 v[96:99], a[84:87], v[84:87], v[96:99]
    v_mfma_f32_16x16x32_bf16 v[96:99], a[88:91], v[88:91], v[96:99]
    v_mov_b32_dpp v122, v112 quad_perm:[0,0,0,0] row_mask:0xf bank_mask:0xf
    v_mov_b32_dpp v124, v114 quad_perm:[2,2,2,2] row_mask:0xf bank_mask:0xf
    s_nop 0
    v_add_f32_dpp v122, v113, v122 quad_perm:[1,1,1,1] row_mask:0xf bank_mask:0xf
    v_add_f32_dpp v124, v115, v124 quad_perm:[3,3,3,3] row_mask:0xf bank_mask:0xf
    v_add_f32 v122, v122, v124
    v_max_f32 v65, v65, v122
    ds_write_b32 v64, v122 offset:3072
    s_waitcnt vmcnt(5)
    buffer_load_dwordx4 v[136:139], v76, s[52:55], s85 offen offset:1024 nt
    v_mfma_f32_16x16x32_bf16 v[96:99], a[92:95], v[92:95], v[96:99]
    v_mfma_f32_16x16x32_bf16 v[112:115], a[96:99], v[80:83], 0
    s_waitcnt vmcnt(5)
    buffer_load_dwordx4 v[140:143], v77, s[52:55], s85 offen offset:1024 nt
    s_add_u32 s87, s87, 1
    s_add_u32 s39, s87, s88
    s_bfe_u32 s37, s39, 0x10000
    s_lshl_b32 s37, s37, 13
    s_add_u32 s85, s37, s89
    s_bfe_u32 s37, s39, 0x10001
    s_lshl_b32 s37, s37, 12
    s_add_u32 s85, s37, s85
    s_bfe_u32 s37, s39, 0x10002
    s_lshl_b32 s37, s37, 11
    s_add_u32 s85, s37, s85
    s_bfe_u32 s37, s39, 0x10003
    s_lshl_b32 s37, s37, 14
    s_add_u32 s85, s37, s85
    s_bfe_u32 s37, s39, 0x40004
    s_lshl_b32 s37, s37, 16
    s_add_u32 s85, s37, s85
    v_mfma_f32_16x16x32_bf16 v[112:115], a[100:103], v[84:87], v[112:115]
    v_mfma_f32_16x16x32_bf16 v[112:115], a[104:107], v[88:91], v[112:115]
    v_mov_b32_dpp v122, v96 quad_perm:[0,0,0,0] row_mask:0xf bank_mask:0xf
    v_mov_b32_dpp v124, v98 quad_perm:[2,2,2,2] row_mask:0xf bank_mask:0xf
    s_nop 0
    v_add_f32_dpp v122, v97, v122 quad_perm:[1,1,1,1] row_mask:0xf bank_mask:0xf
    v_add_f32_dpp v124, v99, v124 quad_perm:[3,3,3,3] row_mask:0xf bank_mask:0xf
    v_add_f32 v122, v122, v124
    v_max_f32 v65, v65, v122
    ds_write_b32 v64, v122 offset:3328
    v_lshlrev_b32 v30, 4, v3
    v_lshl_add_u32 v30, v2, 13, v30
    v_lshrrev_b32 v5, 2, v1
    v_lshlrev_b32 v32, 8, v5
    v_bfe_u32 v5, v1, 0, 2
    v_lshl_add_u32 v32, v5, 4, v32
    s_xor_b32 s37, s90, 4
    s_bfe_u32 s38, s37, 0x30000
    s_lshl_b32 s38, s38, 8
    s_add_u32 s36, s38, 0
    s_lshr_b32 s38, s32, 4
    s_lshl_b32 s38, s38, 7
    s_add_u32 s36, s38, s36
    s_bfe_u32 s38, s32, 0x20000
    s_lshl_b32 s38, s38, 5
    s_add_u32 s36, s38, s36
    s_bfe_u32 s38, s32, 0x20002
    s_lshl_b32 s38, s38, 3
    s_add_u32 s36, s38, s36
    v_bfe_u32 v5, v1, 0, 2
    v_lshlrev_b32 v33, 11, v5
    v_lshl_add_u32 v33, v2, 1, v33
    v_add_u32 v33, s36, v33
    v_and_b32 v5, 31, v1
    v_lshlrev_b32 v34, 4, v5
    s_mul_i32 s38, s34, 320
    s_add_u32 s38, s38, 135168
    v_lshl_add_u32 v35, v5, 3, s38
    s_bfe_u32 s38, s34, 0x10000
    s_lshl_b32 s38, s38, 12
    s_add_u32 s36, s38, s71
    s_lshr_b32 s38, s34, 1
    s_lshl_b32 s38, s38, 24
    s_add_u32 s36, s38, s36
    s_bitcmp1_b32 s90, 2
    s_cselect_b32 s46, s46, s36
    s_cselect_b64 vcc, -1, 0
    v_cndmask_b32 v54, v32, v34, vcc
    s_waitcnt vmcnt(5)
    buffer_load_dwordx4 v[144:147], v76, s[52:55], s85 offen offset:0 nt
    v_mfma_f32_16x16x32_bf16 v[112:115], a[108:111], v[92:95], v[112:115]
    v_mfma_f32_16x16x32_bf16 v[96:99], a[112:115], v[80:83], 0
    s_waitcnt vmcnt(5)
    buffer_load_dwordx4 v[148:151], v77, s[52:55], s85 offen offset:0 nt
    v_mfma_f32_16x16x32_bf16 v[96:99], a[116:119], v[84:87], v[96:99]
    v_mfma_f32_16x16x32_bf16 v[96:99], a[120:123], v[88:91], v[96:99]
    s_nop 2
    v_mov_b32_dpp v122, v112 quad_perm:[0,0,0,0] row_mask:0xf bank_mask:0xf
    v_mov_b32_dpp v124, v114 quad_perm:[2,2,2,2] row_mask:0xf bank_mask:0xf
    s_nop 0
    v_add_f32_dpp v122, v113, v122 quad_perm:[1,1,1,1] row_mask:0xf bank_mask:0xf
    v_add_f32_dpp v124, v115, v124 quad_perm:[3,3,3,3] row_mask:0xf bank_mask:0xf
    v_add_f32 v122, v122, v124
    v_max_f32 v65, v65, v122
    ds_write_b32 v64, v122 offset:3584
    v_mfma_f32_16x16x32_bf16 v[96:99], a[124:127], v[92:95], v[96:99]
    v_add_u32 v64, 3840, v64
    s_and_b32 s36, s32, 3
    s_sub_u32 s95, s36, 2
    s_cmp_ge_u32 s36, 2
    s_cselect_b32 s95, s95, 8
    s_cselect_b32 s94, 17, 16
    s_cmp_eq_u32 s95, s33
    s_cselect_b32 s63, 15, 16
    s_sub_u32 s97, s63, 8
    s_add_u32 s95, s95, 105
    s_mov_b32 s92, 1
    s_lshl_b32 s38, s32, 2
    s_add_u32 s80, s38, 0
    s_lshl_b32 s38, s3, 0
    s_add_u32 s80, s38, s80
    s_mul_i32 s80, s80, 2176
    s_add_u32 s80, s80, 3145728
    v_lshrrev_b32 v4, 2, v1
    v_lshlrev_b32 v55, 3, v4
    s_mov_b32 s66, 134217728
    s_mov_b32 s67, 0x20000
    s_mov_b64 s[64:65], s[52:53]
    v_mov_b32 v62, v76
    v_mov_b32 v63, v77
    s_branch L_bloop
L_aux:
    v_lshlrev_b32 v4, 2, v2
    v_xor_b32 v4, v4, v3
    v_xor_b32 v96, 0, v4
    v_lshlrev_b32 v96, 4, v96
    v_lshl_add_u32 v10, v2, 13, v96
    v_xor_b32 v97, 1, v4
    v_lshlrev_b32 v97, 4, v97
    v_lshl_add_u32 v11, v2, 13, v97
    v_add_u32 v11, 31744, v11
    v_xor_b32 v98, 2, v4
    v_lshlrev_b32 v98, 4, v98
    v_lshl_add_u32 v12, v2, 13, v98
    v_add_u32 v12, 63488, v12
    v_xor_b32 v99, 3, v4
    v_lshlrev_b32 v99, 4, v99
    v_lshl_add_u32 v13, v2, 13, v99
    v_add_u32 v13, 95232, v13
    s_lshl_b32 s56, s34, 15
    s_mov_b32 s62, 0
    s_lshl_b32 s38, s34, 20
    s_add_u32 s95, s38, 0
    s_lshl_b32 s38, s32, 8
    s_add_u32 s95, s38, s95
    s_waitcnt lgkmcnt(0)
    s_mov_b32 s52, s12
    s_and_b32 s53, s13, 0xffff
    s_mov_b32 s54, 4194304
    s_mov_b32 s55, 0x20000
    s_add_u32 s39, s56, s62
    s_mov_b32 m0, s39
    s_add_u32 s62, s62, 4096
    s_and_b32 s62, s62, 0x7fff
    buffer_load_dwordx4 v10, s[52:55], s95 offen offset:0 nt lds
    buffer_load_dwordx4 v11, s[52:55], s95 offen offset:1024 nt lds
    buffer_load_dwordx4 v12, s[52:55], s95 offen offset:2048 nt lds
    buffer_load_dwordx4 v13, s[52:55], s95 offen offset:3072 nt lds
    s_add_u32 s95, s95, 131072
    s_add_u32 s39, s56, s62
    s_mov_b32 m0, s39
    s_add_u32 s62, s62, 4096
    s_and_b32 s62, s62, 0x7fff
    buffer_load_dwordx4 v10, s[52:55], s95 offen offset:0 nt lds
    buffer_load_dwordx4 v11, s[52:55], s95 offen offset:1024 nt lds
    buffer_load_dwordx4 v12, s[52:55], s95 offen offset:2048 nt lds
    buffer_load_dwordx4 v13, s[52:55], s95 offen offset:3072 nt lds
    s_add_u32 s95, s95, 131072
    s_load_dword s35, s[30:31], 0
    s_mov_b32 s48, s30
    s_and_b32 s49, s31, 0xffff
    s_mov_b32 s50, 8388608
    s_mov_b32 s51, 0x20000
    s_mov_b32 s82, 0xffffff00
    s_mov_b32 s83, 0x3e0293ee
    s_mov_b32 s84, 8388608
    v_lshl_add_u32 v76, v2, 10, v96
    v_lshl_add_u32 v96, v2, 8, v96
    v_lshl_add_u32 v77, v2, 10, v97
    v_lshl_add_u32 v97, v2, 8, v97
    v_add_u32 v77, 3072, v77
    v_lshl_add_u32 v78, v2, 10, v98
    v_lshl_add_u32 v98, v2, 8, v98
    v_add_u32 v78, 6144, v78
    v_lshl_add_u32 v79, v2, 10, v99
    v_lshl_add_u32 v99, v2, 8, v99
    v_add_u32 v79, 9216, v79
    v_bfe_u32 v100, v1, 0, 5
    v_lshlrev_b32 v101, 8, v100
    v_lshlrev_b32 v9, 4, v3
    v_lshl_add_u32 v9, v2, 10, v9
    v_xor_b32 v5, v3, v2
    v_bfe_u32 v4, v3, 2, 1
    v_lshlrev_b32 v6, 11, v4
    v_bfe_u32 v4, v3, 3, 1
    v_lshl_add_u32 v6, v4, 10, v6
    v_bfe_u32 v4, v3, 0, 2
    v_lshl_add_u32 v6, v4, 8, v6
    v_bfe_u32 v4, v5, 0, 2
    v_lshl_add_u32 v6, v4, 6, v6
    v_bfe_u32 v4, v3, 2, 1
    v_lshl_add_u32 v6, v4, 5, v6
    v_bfe_u32 v4, v3, 3, 1
    v_lshl_add_u32 v6, v4, 4, v6
    v_add_u32 v60, s56, v6
    v_xor_b32 v61, 16, v60
    v_xor_b32 v62, 32, v60
    v_xor_b32 v63, 48, v60
    v_lshrrev_b32 v5, 4, v1
    v_xor_b32 v5, v5, v1
    v_bfe_u32 v4, v1, 4, 1
    v_lshlrev_b32 v6, 11, v4
    v_bfe_u32 v4, v1, 5, 1
    v_lshl_add_u32 v6, v4, 10, v6
    v_bfe_u32 v4, v1, 2, 2
    v_lshl_add_u32 v6, v4, 8, v6
    v_bfe_u32 v4, v1, 2, 2
    v_lshl_add_u32 v6, v4, 6, v6
    v_bfe_u32 v4, v1, 4, 1
    v_lshl_add_u32 v6, v4, 5, v6
    v_bfe_u32 v4, v5, 1, 1
    v_lshl_add_u32 v6, v4, 4, v6
    v_bfe_u32 v4, v1, 0, 1
    v_lshl_add_u32 v6, v4, 3, v6
    v_add_u32 v82, s56, v6
    v_xor_b32 v83, 32, v82
    v_xor_b32 v84, 64, v82
    v_xor_b32 v85, 96, v82
    v_xor_b32 v86, 128, v82
    v_xor_b32 v87, 160, v82
    v_xor_b32 v88, 192, v82
    v_xor_b32 v89, 224, v82
    v_lshlrev_b32 v6, 11, v2
    v_bfe_u32 v4, v1, 2, 2
    v_lshl_add_u32 v6, v4, 8, v6
    v_bfe_u32 v4, v1, 2, 2
    v_lshl_add_u32 v6, v4, 6, v6
    v_bfe_u32 v4, v1, 4, 1
    v_lshl_add_u32 v6, v4, 5, v6
    v_bfe_u32 v4, v1, 1, 1
    v_lshl_add_u32 v6, v4, 4, v6
    v_bfe_u32 v4, v1, 0, 1
    v_lshl_add_u32 v6, v4, 3, v6
    v_add_u32 v136, s56, v6
    v_xor_b32 v137, 16, v136
    v_xor_b32 v138, 32, v136
    v_xor_b32 v139, 48, v136
    v_xor_b32 v140, 64, v136
    v_xor_b32 v141, 80, v136
    v_xor_b32 v142, 96, v136
    v_xor_b32 v143, 112, v136
    v_xor_b32 v144, 128, v136
    v_xor_b32 v145, 144, v136
    v_xor_b32 v146, 160, v136
    v_xor_b32 v147, 176, v136
    v_xor_b32 v148, 192, v136
    v_xor_b32 v149, 208, v136
    v_xor_b32 v150, 224, v136
    v_xor_b32 v151, 240, v136
    s_lshl_b32 s85, s34, 13
    s_add_u32 s85, s85, 131072
    v_lshl_add_u32 v94, v1, 4, s85
    v_add_u32 v96, s85, v96
    v_add_u32 v97, s85, v97
    v_add_u32 v98, s85, v98
    v_add_u32 v99, s85, v99
    s_add_u32 s39, s56, s62
    s_mov_b32 m0, s39
    s_add_u32 s62, s62, 4096
    s_and_b32 s62, s62, 0x7fff
    buffer_load_dwordx4 v10, s[52:55], s95 offen offset:0 nt lds
    buffer_load_dwordx4 v11, s[52:55], s95 offen offset:1024 nt lds
    buffer_load_dwordx4 v12, s[52:55], s95 offen offset:2048 nt lds
    buffer_load_dwordx4 v13, s[52:55], s95 offen offset:3072 nt lds
    s_add_u32 s95, s95, 131072
    s_add_u32 s39, s56, s62
    s_mov_b32 m0, s39
    s_add_u32 s62, s62, 4096
    s_and_b32 s62, s62, 0x7fff
    buffer_load_dwordx4 v10, s[52:55], s95 offen offset:0 nt lds
    buffer_load_dwordx4 v11, s[52:55], s95 offen offset:1024 nt lds
    buffer_load_dwordx4 v12, s[52:55], s95 offen offset:2048 nt lds
    buffer_load_dwordx4 v13, s[52:55], s95 offen offset:3072 nt lds
    s_add_u32 s95, s95, 131072
    s_add_u32 s39, s56, s62
    s_mov_b32 m0, s39
    s_add_u32 s62, s62, 4096
    s_and_b32 s62, s62, 0x7fff
    buffer_load_dwordx4 v10, s[52:55], s95 offen offset:0 nt lds
    buffer_load_dwordx4 v11, s[52:55], s95 offen offset:1024 nt lds
    buffer_load_dwordx4 v12, s[52:55], s95 offen offset:2048 nt lds
    buffer_load_dwordx4 v13, s[52:55], s95 offen offset:3072 nt lds
    s_add_u32 s95, s95, 131072
    s_add_u32 s39, s56, s62
    s_mov_b32 m0, s39
    s_add_u32 s62, s62, 4096
    s_and_b32 s62, s62, 0x7fff
    buffer_load_dwordx4 v10, s[52:55], s95 offen offset:0 nt lds
    buffer_load_dwordx4 v11, s[52:55], s95 offen offset:1024 nt lds
    buffer_load_dwordx4 v12, s[52:55], s95 offen offset:2048 nt lds
    buffer_load_dwordx4 v13, s[52:55], s95 offen offset:3072 nt lds
    s_add_u32 s95, s95, 131072
    s_add_u32 s39, s56, s62
    s_mov_b32 m0, s39
    s_add_u32 s62, s62, 4096
    s_and_b32 s62, s62, 0x7fff
    buffer_load_dwordx4 v10, s[52:55], s95 offen offset:0 nt lds
    buffer_load_dwordx4 v11, s[52:55], s95 offen offset:1024 nt lds
    buffer_load_dwordx4 v12, s[52:55], s95 offen offset:2048 nt lds
    buffer_load_dwordx4 v13, s[52:55], s95 offen offset:3072 nt lds
    s_add_u32 s95, s95, 131072
    s_add_u32 s39, s56, s62
    s_mov_b32 m0, s39
    s_add_u32 s62, s62, 4096
    s_and_b32 s62, s62, 0x7fff
    buffer_load_dwordx4 v10, s[52:55], s95 offen offset:0 nt lds
    buffer_load_dwordx4 v11, s[52:55], s95 offen offset:1024 nt lds
    buffer_load_dwordx4 v12, s[52:55], s95 offen offset:2048 nt lds
    buffer_load_dwordx4 v13, s[52:55], s95 offen offset:3072 nt lds
    s_add_u32 s95, s95, 131072
    s_waitcnt lgkmcnt(0)
    s_add_u32 s35, s35, 0x5b
    s_and_b32 s35, s35, 0xff
    v_mov_b32 v8, s35
    s_or_b32 s68, s35, 0x6b3ac500
    s_getreg_b32 s70, hwreg(HW_REG_XCC_ID, 0, 4)
    s_lshl_b32 s70, s70, 8
    s_or_b32 s70, s70, s35
    s_or_b32 s70, s70, 0x5e9d0000
    s_bfe_u32 s38, s2, 0x30000
    s_lshl_b32 s38, s38, 8
    s_add_u32 s69, s38, 32768
    s_lshl_b32 s38, s32, 2
    s_add_u32 s69, s38, s69
    s_lshl_b32 s38, s34, 24
    s_add_u32 s69, s38, s69
    v_mov_b32 v4, s69
    v_mov_b32 v5, s70
    s_mov_b64 exec, 1
    buffer_store_dword v5, v4, s[48:51], 0 offen sc1
    s_mov_b64 exec, -1
    s_mov_b32 s52, s6
    s_and_b32 s53, s7, 0xffff
    s_mov_b32 s54, 16777216
    s_mov_b32 s55, 0x20000
    s_bfe_u32 s38, s32, 0x30000
    s_lshl_b32 s38, s38, 1
    s_add_u32 s3, s38, 0
    s_lshr_b32 s38, s32, 4
    s_lshl_b32 s38, s38, 0
    s_add_u32 s3, s38, s3
    s_bfe_u32 s94, s32, 0x10003
    s_lshl_b32 s38, s3, 20
    s_add_u32 s95, s38, 0
    s_lshl_b32 s38, s34, 8
    s_add_u32 s95, s38, s95
    s_waitcnt vmcnt(25)
    ds_read_b64_tr_b16 a[128:129], v136 offset:0
    ds_read_b64_tr_b16 a[130:131], v137 offset:1024
    ds_read_b64_tr_b16 a[144:145], v138 offset:0
    ds_read_b64_tr_b16 a[146:147], v139 offset:1024
    ds_read_b64_tr_b16 a[160:161], v140 offset:0
    ds_read_b64_tr_b16 a[162:163], v141 offset:1024
    ds_read_b64_tr_b16 a[176:177], v142 offset:0
    ds_read_b64_tr_b16 a[178:179], v143 offset:1024
    ds_read_b64_tr_b16 a[192:193], v144 offset:0
    ds_read_b64_tr_b16 a[194:195], v145 offset:1024
    ds_read_b64_tr_b16 a[208:209], v146 offset:0
    ds_read_b64_tr_b16 a[210:211], v147 offset:1024
    ds_read_b64_tr_b16 a[224:225], v148 offset:0
    ds_read_b64_tr_b16 a[226:227], v149 offset:1024
    ds_read_b64_tr_b16 a[240:241], v150 offset:0
    ds_read_b64_tr_b16 a[242:243], v151 offset:1024
    s_waitcnt lgkmcnt(0)
    s_add_u32 s39, s56, s62
    s_mov_b32 m0, s39
    s_add_u32 s62, s62, 4096
    s_and_b32 s62, s62, 0x7fff
    buffer_load_dwordx4 v76, s[52:55], s95 offen offset:0 nt lds
    buffer_load_dwordx4 v77, s[52:55], s95 offen offset:1024 nt lds
    buffer_load_dwordx4 v78, s[52:55], s95 offen offset:2048 nt lds
    buffer_load_dwordx4 v79, s[52:55], s95 offen offset:3072 nt lds
    s_add_u32 s95, s95, 16384
    s_add_u32 s39, s56, s62
    s_mov_b32 m0, s39
    s_add_u32 s62, s62, 4096
    s_and_b32 s62, s62, 0x7fff
    buffer_load_dwordx4 v76, s[52:55], s95 offen offset:0 nt lds
    buffer_load_dwordx4 v77, s[52:55], s95 offen offset:1024 nt lds
    buffer_load_dwordx4 v78, s[52:55], s95 offen offset:2048 nt lds
    buffer_load_dwordx4 v79, s[52:55], s95 offen offset:3072 nt lds
    s_add_u32 s95, s95, 16384
    s_waitcnt vmcnt(25)
    ds_read_b64_tr_b16 a[132:133], v136 offset:8192
    ds_read_b64_tr_b16 a[134:135], v137 offset:9216
    ds_read_b64_tr_b16 a[148:149], v138 offset:8192
    ds_read_b64_tr_b16 a[150:151], v139 offset:9216
    ds_read_b64_tr_b16 a[164:165], v140 offset:8192
    ds_read_b64_tr_b16 a[166:167], v141 offset:9216
    ds_read_b64_tr_b16 a[180:181], v142 offset:8192
    ds_read_b64_tr_b16 a[182:183], v143 offset:9216
    ds_read_b64_tr_b16 a[196:197], v144 offset:8192
    ds_read_b64_tr_b16 a[198:199], v145 offset:9216
    ds_read_b64_tr_b16 a[212:213], v146 offset:8192
    ds_read_b64_tr_b16 a[214:215], v147 offset:9216
    ds_read_b64_tr_b16 a[228:229], v148 offset:8192
    ds_read_b64_tr_b16 a[230:231], v149 offset:9216
    ds_read_b64_tr_b16 a[244:245], v150 offset:8192
    ds_read_b64_tr_b16 a[246:247], v151 offset:9216
    s_waitcnt lgkmcnt(0)
    s_add_u32 s39, s56, s62
    s_mov_b32 m0, s39
    s_add_u32 s62, s62, 4096
    s_and_b32 s62, s62, 0x7fff
    buffer_load_dwordx4 v76, s[52:55], s95 offen offset:0 nt lds
    buffer_load_dwordx4 v77, s[52:55], s95 offen offset:1024 nt lds
    buffer_load_dwordx4 v78, s[52:55], s95 offen offset:2048 nt lds
    buffer_load_dwordx4 v79, s[52:55], s95 offen offset:3072 nt lds
    s_add_u32 s95, s95, 16384
    s_add_u32 s39, s56, s62
    s_mov_b32 m0, s39
    s_add_u32 s62, s62, 4096
    s_and_b32 s62, s62, 0x7fff
    buffer_load_dwordx4 v76, s[52:55], s95 offen offset:0 nt lds
    buffer_load_dwordx4 v77, s[52:55], s95 offen offset:1024 nt lds
    buffer_load_dwordx4 v78, s[52:55], s95 offen offset:2048 nt lds
    buffer_load_dwordx4 v79, s[52:55], s95 offen offset:3072 nt lds
    s_add_u32 s95, s95, 16384
    s_waitcnt vmcnt(25)
    ds_read_b64_tr_b16 a[136:137], v136 offset:16384
    ds_read_b64_tr_b16 a[138:139], v137 offset:17408
    ds_read_b64_tr_b16 a[152:153], v138 offset:16384
    ds_read_b64_tr_b16 a[154:155], v139 offset:17408
    ds_read_b64_tr_b16 a[168:169], v140 offset:16384
    ds_read_b64_tr_b16 a[170:171], v141 offset:17408
    ds_read_b64_tr_b16 a[184:185], v142 offset:16384
    ds_read_b64_tr_b16 a[186:187], v143 offset:17408
    ds_read_b64_tr_b16 a[200:201], v144 offset:16384
    ds_read_b64_tr_b16 a[202:203], v145 offset:17408
    ds_read_b64_tr_b16 a[216:217], v146 offset:16384
    ds_read_b64_tr_b16 a[218:219], v147 offset:17408
    ds_read_b64_tr_b16 a[232:233], v148 offset:16384
    ds_read_b64_tr_b16 a[234:235], v149 offset:17408
    ds_read_b64_tr_b16 a[248:249], v150 offset:16384
    ds_read_b64_tr_b16 a[250:251], v151 offset:17408
    s_waitcnt lgkmcnt(0)
    s_add_u32 s39, s56, s62
    s_mov_b32 m0, s39
    s_add_u32 s62, s62, 4096
    s_and_b32 s62, s62, 0x7fff
    buffer_load_dwordx4 v76, s[52:55], s95 offen offset:0 nt lds
    buffer_load_dwordx4 v77, s[52:55], s95 offen offset:1024 nt lds
    buffer_load_dwordx4 v78, s[52:55], s95 offen offset:2048 nt lds
    buffer_load_dwordx4 v79, s[52:55], s95 offen offset:3072 nt lds
    s_add_u32 s95, s95, 16384
    s_add_u32 s39, s56, s62
    s_mov_b32 m0, s39
    s_add_u32 s62, s62, 4096
    s_and_b32 s62, s62, 0x7fff
    buffer_load_dwordx4 v76, s[52:55], s95 offen offset:0 nt lds
    buffer_load_dwordx4 v77, s[52:55], s95 offen offset:1024 nt lds
    buffer_load_dwordx4 v78, s[52:55], s95 offen offset:2048 nt lds
    buffer_load_dwordx4 v79, s[52:55], s95 offen offset:3072 nt lds
    s_add_u32 s95, s95, 16384
    s_waitcnt vmcnt(25)
    ds_read_b64_tr_b16 a[140:141], v136 offset:24576
    ds_read_b64_tr_b16 a[142:143], v137 offset:25600
    ds_read_b64_tr_b16 a[156:157], v138 offset:24576
    ds_read_b64_tr_b16 a[158:159], v139 offset:25600
    ds_read_b64_tr_b16 a[172:173], v140 offset:24576
    ds_read_b64_tr_b16 a[174:175], v141 offset:25600
    ds_read_b64_tr_b16 a[188:189], v142 offset:24576
    ds_read_b64_tr_b16 a[190:191], v143 offset:25600
    ds_read_b64_tr_b16 a[204:205], v144 offset:24576
    ds_read_b64_tr_b16 a[206:207], v145 offset:25600
    ds_read_b64_tr_b16 a[220:221], v146 offset:24576
    ds_read_b64_tr_b16 a[222:223], v147 offset:25600
    ds_read_b64_tr_b16 a[236:237], v148 offset:24576
    ds_read_b64_tr_b16 a[238:239], v149 offset:25600
    ds_read_b64_tr_b16 a[252:253], v150 offset:24576
    ds_read_b64_tr_b16 a[254:255], v151 offset:25600
    s_waitcnt lgkmcnt(0)
    s_add_u32 s39, s56, s62
    s_mov_b32 m0, s39
    s_add_u32 s62, s62, 4096
    s_and_b32 s62, s62, 0x7fff
    buffer_load_dwordx4 v76, s[52:55], s95 offen offset:0 nt lds
    buffer_load_dwordx4 v77, s[52:55], s95 offen offset:1024 nt lds
    s_mov_b32 s86, 98304
    buffer_load_dword v7, v101, s[48:51], s86 offen sc1
    v_mov_b32 v104, 0
    v_mov_b32 v105, 0
    v_mov_b32 v106, 0
    v_mov_b32 v107, 0
    v_mov_b32 v108, 0
    v_mov_b32 v109, 0
    v_mov_b32 v110, 0
    v_mov_b32 v111, 0
    v_mov_b32 v112, 0
    v_mov_b32 v113, 0
    v_mov_b32 v114, 0
    v_mov_b32 v115, 0
    v_mov_b32 v116, 0
    v_mov_b32 v117, 0
    v_mov_b32 v118, 0
    v_mov_b32 v119, 0
    v_mov_b32 v120, 0
    v_mov_b32 v121, 0
    v_mov_b32 v122, 0
    v_mov_b32 v123, 0
    v_mov_b32 v124, 0
    v_mov_b32 v125, 0
    v_mov_b32 v126, 0
    v_mov_b32 v127, 0
    v_mov_b32 v128, 0
    v_mov_b32 v129, 0
    v_mov_b32 v130, 0
    v_mov_b32 v131, 0
    v_mov_b32 v132, 0
    v_mov_b32 v133, 0
    v_mov_b32 v134, 0
    v_mov_b32 v135, 0
    v_mov_b32 v90, 0xff7f0000
    s_mov_b32 s93, 0
    v_mov_b32 v102, 0
    v_mov_b32 v103, 0
    s_mov_b32 s60, s83
    s_mov_b32 s61, s83
    v_xor_b32 v5, v3, v2
    v_lshlrev_b32 v6, 8, v3
    v_bfe_u32 v4, v5, 0, 2
    v_lshl_add_u32 v6, v4, 6, v6
    v_lshrrev_b32 v4, 2, v3
    v_lshl_add_u32 v6, v4, 4, v6
    v_add_u32 v52, s85, v6
    v_xor_b32 v53, 16, v52
    v_xor_b32 v54, 32, v52
    v_xor_b32 v55, 48, v52
    s_lshr_b32 s38, s3, 2
    s_lshl_b32 s38, s38, 15
    s_add_u32 s36, s38, 393216
    s_lshl_b32 s38, s94, 14
    s_add_u32 s36, s38, s36
    s_lshl_b32 s38, s34, 8
    s_add_u32 s36, s38, s36
    s_waitcnt vmcnt(0)
L_fcheck_45:
    v_cmp_ne_u32 vcc, s68, v7
    s_cbranch_vccz L_fok_46
    s_sleep 2
    s_mov_b32 s86, 98304
    buffer_load_dword v7, v101, s[48:51], s86 offen sc1
    s_waitcnt vmcnt(0)
    s_sub_u32 s84, s84, 1
    s_cmp_lg_u32 s84, 0
    s_cbranch_scc1 L_fcheck_45
    s_branch L_end
L_fok_46:
    buffer_load_dwordx4 v[200:203], v9, s[48:51], s36 offen sc1
    s_add_u32 s36, s36, 4096
    buffer_load_dwordx4 v[204:207], v9, s[48:51], s36 offen sc1
    s_add_u32 s36, s36, 4096
    buffer_load_dwordx4 v[208:211], v9, s[48:51], s36 offen sc1
    s_add_u32 s36, s36, 4096
    buffer_load_dwordx4 v[212:215], v9, s[48:51], s36 offen sc1
    ds_read_b128 v[136:139], v60 offset:0
    ds_read_b128 v[140:143], v61 offset:0
    ds_read_b128 v[144:147], v62 offset:0
    ds_read_b128 v[148:151], v63 offset:0
    ds_read_b128 v[152:155], v60 offset:4096
    ds_read_b128 v[156:159], v61 offset:4096
    ds_read_b128 v[160:163], v62 offset:4096
    ds_read_b128 v[164:167], v63 offset:4096
    ds_read_b128 v[168:171], v60 offset:8192
    ds_read_b128 v[172:175], v61 offset:8192
    ds_read_b128 v[176:179], v62 offset:8192
    ds_read_b128 v[180:183], v63 offset:8192
    ds_read_b128 v[184:187], v60 offset:12288
    ds_read_b128 v[188:191], v61 offset:12288
    ds_read_b128 v[192:195], v62 offset:12288
    ds_read_b128 v[196:199], v63 offset:12288
    s_waitcnt vmcnt(3)
    ds_write_b128 v96, v[200:203] offset:0
    s_waitcnt vmcnt(2)
    ds_write_b128 v97, v[204:207] offset:1024
    s_waitcnt vmcnt(1)
    ds_write_b128 v98, v[208:211] offset:2048
    s_waitcnt vmcnt(0)
    ds_write_b128 v99, v[212:215] offset:3072
    s_waitcnt lgkmcnt(0)
    ds_read_b128 v[36:39], v52
    ds_read_b128 v[40:43], v53
    ds_read_b128 v[44:47], v54
    ds_read_b128 v[48:51], v55
L_att:
    s_waitcnt lgkmcnt(0)
    v_mfma_f32_16x16x32_bf16 v[200:203], v[136:139], v[36:39], 0
    ds_read_b64_tr_b16 a[0:1], v82 offset:0
    ds_read_b64_tr_b16 a[2:3], v82 offset:4096
    buffer_load_dwordx4 v78, s[52:55], s95 offen offset:2048 nt lds
    v_mfma_f32_16x16x32_bf16 v[200:203], v[140:143], v[40:43], v[200:203]
    ds_read_b64_tr_b16 a[4:5], v83 offset:0
    ds_read_b64_tr_b16 a[6:7], v83 offset:4096
    v_mfma_f32_16x16x32_bf16 v[200:203], v[144:147], v[44:47], v[200:203]
    ds_read_b64_tr_b16 a[8:9], v84 offset:0
    ds_read_b64_tr_b16 a[10:11], v84 offset:4096
    v_mfma_f32_16x16x32_bf16 v[200:203], v[148:151], v[48:51], v[200:203]
    ds_read_b64_tr_b16 a[12:13], v85 offset:0
    ds_read_b64_tr_b16 a[14:15], v85 offset:4096
    buffer_load_dwordx4 v79, s[52:55], s95 offen offset:3072 nt lds
    s_add_u32 s95, s95, 16384
    v_mfma_f32_16x16x32_bf16 v[204:207], v[152:155], v[36:39], 0
    ds_read_b64_tr_b16 a[16:17], v86 offset:0
    ds_read_b64_tr_b16 a[18:19], v86 offset:4096
    v_mfma_f32_16x16x32_bf16 v[204:207], v[156:159], v[40:43], v[204:207]
    ds_read_b64_tr_b16 a[20:21], v87 offset:0
    ds_read_b64_tr_b16 a[22:23], v87 offset:4096
    v_mfma_f32_16x16x32_bf16 v[204:207], v[160:163], v[44:47], v[204:207]
    ds_read_b64_tr_b16 a[24:25], v88 offset:0
    ds_read_b64_tr_b16 a[26:27], v88 offset:4096
    s_add_u32 s39, s56, s62
    s_mov_b32 m0, s39
    s_add_u32 s62, s62, 4096
    s_and_b32 s62, s62, 0x7fff
    buffer_load_dwordx4 v76, s[52:55], s95 offen offset:0 nt lds
    v_mfma_f32_16x16x32_bf16 v[204:207], v[164:167], v[48:51], v[204:207]
    ds_read_b64_tr_b16 a[28:29], v89 offset:0
    ds_read_b64_tr_b16 a[30:31], v89 offset:4096
    ds_write_b128 v94, v[200:203] offset:0
    v_mfma_f32_16x16x32_bf16 v[208:211], v[168:171], v[36:39], 0
    ds_read_b64_tr_b16 a[32:33], v82 offset:8192
    ds_read_b64_tr_b16 a[34:35], v82 offset:12288
    v_mfma_f32_16x16x32_bf16 v[208:211], v[172:175], v[40:43], v[208:211]
    ds_read_b64_tr_b16 a[36:37], v83 offset:8192
    ds_read_b64_tr_b16 a[38:39], v83 offset:12288
    buffer_load_dwordx4 v77, s[52:55], s95 offen offset:1024 nt lds
    v_mfma_f32_16x16x32_bf16 v[208:211], v[176:179], v[44:47], v[208:211]
    ds_read_b64_tr_b16 a[40:41], v84 offset:8192
    ds_read_b64_tr_b16 a[42:43], v84 offset:12288
    v_mfma_f32_16x16x32_bf16 v[208:211], v[180:183], v[48:51], v[208:211]
    ds_read_b64_tr_b16 a[44:45], v85 offset:8192
    ds_read_b64_tr_b16 a[46:47], v85 offset:12288
    ds_write_b128 v94, v[204:207] offset:1024
    v_mfma_f32_16x16x32_bf16 v[212:215], v[184:187], v[36:39], 0
    ds_read_b64_tr_b16 a[48:49], v86 offset:8192
    ds_read_b64_tr_b16 a[50:51], v86 offset:12288
    buffer_load_dwordx4 v78, s[52:55], s95 offen offset:2048 nt lds
    v_mfma_f32_16x16x32_bf16 v[212:215], v[188:191], v[40:43], v[212:215]
    ds_read_b64_tr_b16 a[52:53], v87 offset:8192
    ds_read_b64_tr_b16 a[54:55], v87 offset:12288
    v_mfma_f32_16x16x32_bf16 v[212:215], v[192:195], v[44:47], v[212:215]
    ds_read_b64_tr_b16 a[56:57], v88 offset:8192
    ds_read_b64_tr_b16 a[58:59], v88 offset:12288
    v_mfma_f32_16x16x32_bf16 v[212:215], v[196:199], v[48:51], v[212:215]
    ds_read_b64_tr_b16 a[60:61], v89 offset:8192
    ds_read_b64_tr_b16 a[62:63], v89 offset:12288
    buffer_load_dwordx4 v79, s[52:55], s95 offen offset:3072 nt lds
    s_add_u32 s95, s95, 16384
    ds_write_b128 v94, v[208:211] offset:2048
    v_xor_b32 v5, 0x2000, v94
    v_xor_b32 v6, 0x4000, v94
    v_xor_b32 v7, 0x6000, v94
    s_cmp_eq_u32 s93, 14
    s_cselect_b32 s95, 16777216, s95
    ds_write_b128 v94, v[212:215] offset:3072
    v_xor_b32 v82, 0x4000, v82
    v_xor_b32 v83, 0x4000, v83
    v_xor_b32 v84, 0x4000, v84
    v_xor_b32 v85, 0x4000, v85
    v_xor_b32 v86, 0x4000, v86
    v_xor_b32 v87, 0x4000, v87
    v_xor_b32 v88, 0x4000, v88
    v_xor_b32 v89, 0x4000, v89
    v_xor_b32 v60, 0x4000, v60
    v_xor_b32 v61, 0x4000, v61
    v_xor_b32 v62, 0x4000, v62
    v_xor_b32 v63, 0x4000, v63
    s_waitcnt lgkmcnt(0)
    s_barrier
    ds_read_b128 v[136:139], v5 offset:0
    ds_read_b128 v[152:155], v6 offset:0
    ds_read_b128 v[168:171], v7 offset:0
    ds_read_b128 v[140:143], v5 offset:1024
    ds_read_b128 v[156:159], v6 offset:1024
    ds_read_b128 v[172:175], v7 offset:1024
    ds_read_b128 v[144:147], v5 offset:2048
    ds_read_b128 v[160:163], v6 offset:2048
    ds_read_b128 v[176:179], v7 offset:2048
    ds_read_b128 v[148:151], v5 offset:3072
    ds_read_b128 v[164:167], v6 offset:3072
    ds_read_b128 v[180:183], v7 offset:3072
    v_xor_b32 v94, 0x1000, v94
    s_add_u32 s39, s56, s62
    s_mov_b32 m0, s39
    s_add_u32 s62, s62, 4096
    s_and_b32 s62, s62, 0x7fff
    buffer_load_dwordx4 v76, s[52:55], s95 offen offset:0 nt lds
    buffer_load_dwordx4 v77, s[52:55], s95 offen offset:1024 nt lds
    buffer_load_dwordx4 v78, s[52:55], s95 offen offset:2048 nt lds
    s_waitcnt lgkmcnt(9)
    v_pk_add_f32 v[200:201], v[200:201], v[136:137]
    v_pk_add_f32 v[152:153], v[152:153], v[168:169]
    v_pk_add_f32 v[202:203], v[202:203], v[138:139]
    v_pk_add_f32 v[154:155], v[154:155], v[170:171]
    v_pk_add_f32 v[200:201], v[200:201], v[152:153]
    v_pk_add_f32 v[202:203], v[202:203], v[154:155]
    s_waitcnt lgkmcnt(6)
    v_pk_add_f32 v[204:205], v[204:205], v[140:141]
    v_pk_add_f32 v[156:157], v[156:157], v[172:173]
    v_pk_add_f32 v[206:207], v[206:207], v[142:143]
    v_pk_add_f32 v[158:159], v[158:159], v[174:175]
    v_pk_add_f32 v[204:205], v[204:205], v[156:157]
    v_pk_add_f32 v[206:207], v[206:207], v[158:159]
    s_waitcnt lgkmcnt(3)
    v_pk_add_f32 v[208:209], v[208:209], v[144:145]
    v_pk_add_f32 v[160:161], v[160:161], v[176:177]
    v_pk_add_f32 v[210:211], v[210:211], v[146:147]
    v_pk_add_f32 v[162:163], v[162:163], v[178:179]
    v_pk_add_f32 v[208:209], v[208:209], v[160:161]
    v_pk_add_f32 v[210:211], v[210:211], v[162:163]
    s_waitcnt lgkmcnt(0)
    v_pk_add_f32 v[212:213], v[212:213], v[148:149]
    v_pk_add_f32 v[164:165], v[164:165], v[180:181]
    v_pk_add_f32 v[214:215], v[214:215], v[150:151]
    v_pk_add_f32 v[166:167], v[166:167], v[182:183]
    v_pk_add_f32 v[212:213], v[212:213], v[164:165]
    v_pk_add_f32 v[214:215], v[214:215], v[166:167]
    buffer_load_dwordx4 v79, s[52:55], s95 offen offset:3072 nt lds
    s_add_u32 s95, s95, 16384
    s_waitcnt vmcnt(4)
    v_max_f32 v4, v200, v201
    v_max3_f32 v4, v4, v202, v203
    v_max3_f32 v4, v4, v204, v205
    v_max3_f32 v4, v4, v206, v207
    v_max3_f32 v4, v4, v208, v209
    v_max3_f32 v4, v4, v210, v211
    v_max3_f32 v4, v4, v212, v213
    v_max3_f32 v4, v4, v214, v215
    v_mov_b32 v5, v4
    ds_read_b128 v[136:139], v60 offset:0
    ds_read_b128 v[140:143], v61 offset:0
    v_permlane16_swap_b32 v4, v5
    v_max_f32 v4, v4, v5
    v_mov_b32 v5, v4
    ds_read_b128 v[144:147], v62 offset:0
    ds_read_b128 v[148:151], v63 offset:0
    v_permlane32_swap_b32 v4, v5
    v_max_f32 v4, v4, v5
    v_mul_f32 v4, s83, v4
    v_max_f32 v4, v4, v90
    v_sub_f32 v92, v90, v4
    v_exp_f32 v92, v92
    v_mov_b32 v90, v4
    s_add_u32 s39, s56, s62
    s_mov_b32 m0, s39
    s_add_u32 s62, s62, 4096
    s_and_b32 s62, s62, 0x7fff
    buffer_load_dwordx4 v76, s[52:55], s95 offen offset:0 nt lds
    v_pk_fma_f32 v[200:201], v[200:201], s[60:61], v[90:91] op_sel_hi:[1,1,0] neg_lo:[0,0,1] neg_hi:[0,0,1]
    v_pk_fma_f32 v[202:203], v[202:203], s[60:61], v[90:91] op_sel_hi:[1,1,0] neg_lo:[0,0,1] neg_hi:[0,0,1]
    v_pk_fma_f32 v[204:205], v[204:205], s[60:61], v[90:91] op_sel_hi:[1,1,0] neg_lo:[0,0,1] neg_hi:[0,0,1]
    v_pk_fma_f32 v[206:207], v[206:207], s[60:61], v[90:91] op_sel_hi:[1,1,0] neg_lo:[0,0,1] neg_hi:[0,0,1]
    v_pk_fma_f32 v[208:209], v[208:209], s[60:61], v[90:91] op_sel_hi:[1,1,0] neg_lo:[0,0,1] neg_hi:[0,0,1]
    v_pk_fma_f32 v[210:211], v[210:211], s[60:61], v[90:91] op_sel_hi:[1,1,0] neg_lo:[0,0,1] neg_hi:[0,0,1]
    v_pk_fma_f32 v[212:213], v[212:213], s[60:61], v[90:91] op_sel_hi:[1,1,0] neg_lo:[0,0,1] neg_hi:[0,0,1]
    v_pk_fma_f32 v[214:215], v[214:215], s[60:61], v[90:91] op_sel_hi:[1,1,0] neg_lo:[0,0,1] neg_hi:[0,0,1]
    v_exp_f32 v200, v200
    v_exp_f32 v201, v201
    ds_read_b128 v[152:155], v60 offset:4096
    v_exp_f32 v202, v202
    v_exp_f32 v203, v203
    v_exp_f32 v204, v204
    v_exp_f32 v205, v205
    ds_read_b128 v[156:159], v61 offset:4096
    v_exp_f32 v206, v206
    v_exp_f32 v207, v207
    buffer_load_dwordx4 v77, s[52:55], s95 offen offset:1024 nt lds
    v_exp_f32 v208, v208
    v_exp_f32 v209, v209
    ds_read_b128 v[160:163], v62 offset:4096
    v_exp_f32 v210, v210
    v_exp_f32 v211, v211
    v_exp_f32 v212, v212
    v_exp_f32 v213, v213
    ds_read_b128 v[164:167], v63 offset:4096
    v_exp_f32 v214, v214
    v_exp_f32 v215, v215
    buffer_load_dwordx4 v78, s[52:55], s95 offen offset:2048 nt lds
    v_pk_mul_f32 v[102:103], v[102:103], v[92:93] op_sel_hi:[1,0]
    v_pk_mul_f32 v[104:105], v[104:105], v[92:93] op_sel_hi:[1,0]
    v_pk_mul_f32 v[106:107], v[106:107], v[92:93] op_sel_hi:[1,0]
    v_pk_mul_f32 v[108:109], v[108:109], v[92:93] op_sel_hi:[1,0]
    v_pk_mul_f32 v[110:111], v[110:111], v[92:93] op_sel_hi:[1,0]
    v_pk_mul_f32 v[112:113], v[112:113], v[92:93] op_sel_hi:[1,0]
    v_pk_mul_f32 v[114:115], v[114:115], v[92:93] op_sel_hi:[1,0]
    v_pk_mul_f32 v[116:117], v[116:117], v[92:93] op_sel_hi:[1,0]
    v_pk_mul_f32 v[118:119], v[118:119], v[92:93] op_sel_hi:[1,0]
    v_pk_mul_f32 v[120:121], v[120:121], v[92:93] op_sel_hi:[1,0]
    v_pk_mul_f32 v[122:123], v[122:123], v[92:93] op_sel_hi:[1,0]
    v_pk_mul_f32 v[124:125], v[124:125], v[92:93] op_sel_hi:[1,0]
    v_pk_mul_f32 v[126:127], v[126:127], v[92:93] op_sel_hi:[1,0]
    v_pk_mul_f32 v[128:129], v[128:129], v[92:93] op_sel_hi:[1,0]
    v_pk_mul_f32 v[130:131], v[130:131], v[92:93] op_sel_hi:[1,0]
    v_pk_mul_f32 v[132:133], v[132:133], v[92:93] op_sel_hi:[1,0]
    v_pk_mul_f32 v[134:135], v[134:135], v[92:93] op_sel_hi:[1,0]
    buffer_load_dwordx4 v79, s[52:55], s95 offen offset:3072 nt lds
    s_add_u32 s95, s95, 16384
    v_cvt_pk_bf16_f32 v52, v200, v201
    v_pk_add_f32 v[102:103], v[102:103], v[200:201]
    v_cvt_pk_bf16_f32 v53, v202, v203
    v_pk_add_f32 v[102:103], v[102:103], v[202:203]
    v_cvt_pk_bf16_f32 v54, v204, v205
    v_pk_add_f32 v[102:103], v[102:103], v[204:205]
    v_cvt_pk_bf16_f32 v55, v206, v207
    v_pk_add_f32 v[102:103], v[102:103], v[206:207]
    v_cvt_pk_bf16_f32 v56, v208, v209
    v_pk_add_f32 v[102:103], v[102:103], v[208:209]
    v_cvt_pk_bf16_f32 v57, v210, v211
    v_pk_add_f32 v[102:103], v[102:103], v[210:211]
    v_cvt_pk_bf16_f32 v58, v212, v213
    v_pk_add_f32 v[102:103], v[102:103], v[212:213]
    v_cvt_pk_bf16_f32 v59, v214, v215
    v_pk_add_f32 v[102:103], v[102:103], v[214:215]
    v_mfma_f32_16x16x32_bf16 v[104:107], a[0:3], v[52:55], v[104:107]
    ds_read_b128 v[168:171], v60 offset:8192
    v_mfma_f32_16x16x32_bf16 v[108:111], a[4:7], v[52:55], v[108:111]
    ds_read_b128 v[172:175], v61 offset:8192
    v_mfma_f32_16x16x32_bf16 v[112:115], a[8:11], v[52:55], v[112:115]
    ds_read_b128 v[176:179], v62 offset:8192
    v_mfma_f32_16x16x32_bf16 v[116:119], a[12:15], v[52:55], v[116:119]
    ds_read_b128 v[180:183], v63 offset:8192
    v_mfma_f32_16x16x32_bf16 v[120:123], a[16:19], v[52:55], v[120:123]
    ds_read_b128 v[184:187], v60 offset:12288
    v_mfma_f32_16x16x32_bf16 v[124:127], a[20:23], v[52:55], v[124:127]
    ds_read_b128 v[188:191], v61 offset:12288
    v_mfma_f32_16x16x32_bf16 v[128:131], a[24:27], v[52:55], v[128:131]
    ds_read_b128 v[192:195], v62 offset:12288
    v_mfma_f32_16x16x32_bf16 v[132:135], a[28:31], v[52:55], v[132:135]
    ds_read_b128 v[196:199], v63 offset:12288
    v_mfma_f32_16x16x32_bf16 v[104:107], a[32:35], v[56:59], v[104:107]
    v_mfma_f32_16x16x32_bf16 v[108:111], a[36:39], v[56:59], v[108:111]
    s_add_u32 s39, s56, s62
    s_mov_b32 m0, s39
    s_add_u32 s62, s62, 4096
    s_and_b32 s62, s62, 0x7fff
    buffer_load_dwordx4 v76, s[52:55], s95 offen offset:0 nt lds
    v_mfma_f32_16x16x32_bf16 v[112:115], a[40:43], v[56:59], v[112:115]
    v_mfma_f32_16x16x32_bf16 v[116:119], a[44:47], v[56:59], v[116:119]
    v_mfma_f32_16x16x32_bf16 v[120:123], a[48:51], v[56:59], v[120:123]
    v_mfma_f32_16x16x32_bf16 v[124:127], a[52:55], v[56:59], v[124:127]
    buffer_load_dwordx4 v77, s[52:55], s95 offen offset:1024 nt lds
    v_mfma_f32_16x16x32_bf16 v[128:131], a[56:59], v[56:59], v[128:131]
    v_mfma_f32_16x16x32_bf16 v[132:135], a[60:63], v[56:59], v[132:135]
    s_add_u32 s93, s93, 1
    s_cmp_lt_u32 s93, 16
    s_cbranch_scc1 L_att
    v_add_f32 v91, v102, v103
    v_mov_b32 v5, v91
    s_nop 1
    v_permlane16_swap_b32 v91, v5
    v_add_f32 v91, v91, v5
    v_mov_b32 v5, v91
    s_nop 1
    v_permlane32_swap_b32 v91, v5
    v_add_f32 v91, v91, v5
    v_lshrrev_b32 v6, 1, v2
    v_xor_b32 v6, v6, v3
    v_lshlrev_b32 v5, 8, v3
    v_lshl_add_u32 v5, v6, 4, v5
    v_bfe_u32 v4, v2, 0, 1
    v_lshl_add_u32 v5, v4, 3, v5
    v_add_u32 v5, s85, v5
    s_waitcnt vmcnt(0) lgkmcnt(0)
    s_barrier
    v_cvt_pk_bf16_f32 v216, v104, v105
    v_cvt_pk_bf16_f32 v217, v106, v107
    v_xor_b32 v82, 0, v5
    ds_write_b64 v82, v[216:217]
    v_cvt_pk_bf16_f32 v218, v108, v109
    v_cvt_pk_bf16_f32 v219, v110, v111
    v_xor_b32 v83, 32, v5
    ds_write_b64 v83, v[218:219]
    v_cvt_pk_bf16_f32 v220, v112, v113
    v_cvt_pk_bf16_f32 v221, v114, v115
    v_xor_b32 v84, 64, v5
    ds_write_b64 v84, v[220:221]
    v_cvt_pk_bf16_f32 v222, v116, v117
    v_cvt_pk_bf16_f32 v223, v118, v119
    v_xor_b32 v85, 96, v5
    ds_write_b64 v85, v[222:223]
    v_cvt_pk_bf16_f32 v224, v120, v121
    v_cvt_pk_bf16_f32 v225, v122, v123
    v_xor_b32 v86, 128, v5
    ds_write_b64 v86, v[224:225]
    v_cvt_pk_bf16_f32 v226, v124, v125
    v_cvt_pk_bf16_f32 v227, v126, v127
    v_xor_b32 v87, 160, v5
    ds_write_b64 v87, v[226:227]
    v_cvt_pk_bf16_f32 v228, v128, v129
    v_cvt_pk_bf16_f32 v229, v130, v131
    v_xor_b32 v88, 192, v5
    ds_write_b64 v88, v[228:229]
    v_cvt_pk_bf16_f32 v230, v132, v133
    v_cvt_pk_bf16_f32 v231, v134, v135
    v_xor_b32 v89, 224, v5
    ds_write_b64 v89, v[230:231]
    v_xor_b32 v6, v3, v2
    v_lshlrev_b32 v6, 4, v6
    v_lshl_add_u32 v4, v2, 8, v6
    v_add_u32 v4, s85, v4
    v_xor_b32 v60, 0, v4
    v_xor_b32 v61, 64, v4
    v_xor_b32 v62, 128, v4
    v_xor_b32 v63, 192, v4
    v_lshlrev_b32 v7, 4, v3
    v_lshl_add_u32 v7, v2, 14, v7
    s_lshl_b32 s38, s94, 18
    s_add_u32 s36, s38, 2097152
    s_lshl_b32 s38, s3, 10
    s_add_u32 s36, s38, s36
    s_lshl_b32 s38, s34, 8
    s_add_u32 s36, s38, s36
    s_waitcnt lgkmcnt(0)
    ds_read_b128 v[200:203], v60 offset:0
    ds_read_b128 v[204:207], v61 offset:1024
    ds_read_b128 v[208:211], v62 offset:2048
    ds_read_b128 v[212:215], v63 offset:3072
    v_lshlrev_b32 v4, 3, v3
    s_lshl_b32 s38, s3, 8
    s_add_u32 s37, s38, 163840
    s_lshl_b32 s38, s94, 7
    s_add_u32 s37, s38, s37
    s_lshl_b32 s38, s34, 23
    s_add_u32 s37, s38, s37
    s_mov_b32 exec_lo, 0xffff
    s_mov_b32 exec_hi, 0x0
    buffer_store_dwordx2 v[90:91], v4, s[48:51], s37 offen sc1
    s_mov_b64 exec, -1
    s_waitcnt lgkmcnt(3)
    buffer_store_dwordx4 v[200:203], v7, s[48:51], s36 offen sc1
    s_add_u32 s36, s36, 65536
    s_waitcnt lgkmcnt(2)
    buffer_store_dwordx4 v[204:207], v7, s[48:51], s36 offen sc1
    s_add_u32 s36, s36, 65536
    s_waitcnt lgkmcnt(1)
    buffer_store_dwordx4 v[208:211], v7, s[48:51], s36 offen sc1
    s_add_u32 s36, s36, 65536
    s_waitcnt lgkmcnt(0)
    buffer_store_dwordx4 v[212:215], v7, s[48:51], s36 offen sc1
    s_bfe_u32 s38, s2, 0x20001
    s_lshl_b32 s38, s38, 0
    s_add_u32 s90, s38, 0
    s_bfe_u32 s38, s2, 0x10000
    s_lshl_b32 s38, s38, 2
    s_add_u32 s90, s38, s90
    s_and_b32 s36, s90, 3
    s_bitcmp0_b32 s90, 2
    s_cselect_b64 s[40:41], s[24:25], s[14:15]
    s_cselect_b32 s45, 262144, 0
    s_add_u32 s45, s45, 524288
    s_lshl_b32 s38, s36, 16
    s_add_u32 s71, s38, s45
    s_lshr_b32 s38, s32, 2
    s_lshl_b32 s38, s38, 13
    s_add_u32 s71, s38, s71
    s_bfe_u32 s38, s32, 0x20000
    s_lshl_b32 s38, s38, 6
    s_add_u32 s71, s38, s71
    s_mov_b32 s42, 4194304
    s_mov_b32 s43, 0x20000
    s_lshl_b32 s38, s32, 17
    s_add_u32 s44, s38, 0
    s_lshl_b32 s38, s34, 15
    s_add_u32 s44, s38, s44
    s_lshl_b32 s38, s36, 8
    s_add_u32 s44, s38, s44
    s_lshl_b32 s38, s36, 16
    s_add_u32 s45, s38, s45
    s_lshr_b32 s38, s34, 1
    s_lshl_b32 s38, s38, 15
    s_add_u32 s45, s38, s45
    s_lshl_b32 s38, s32, 8
    s_add_u32 s45, s38, s45
    s_bfe_u32 s38, s34, 0x10000
    s_lshl_b32 s38, s38, 7
    s_add_u32 s45, s38, s45
    s_lshl_b32 s38, s32, 11
    s_add_u32 s46, s38, 196608
    s_lshl_b32 s38, s34, 9
    s_add_u32 s46, s38, s46
    s_mov_b32 s72, s26
    s_and_b32 s73, s27, 0xffff
    s_mov_b32 s74, 8192
    s_mov_b32 s75, 0x20000
    v_lshlrev_b32 v30, 4, v3
    v_lshl_add_u32 v30, v2, 13, v30
    v_lshrrev_b32 v5, 2, v1
    v_lshlrev_b32 v32, 8, v5
    v_bfe_u32 v5, v1, 0, 2
    v_lshl_add_u32 v32, v5, 4, v32
    s_xor_b32 s37, s90, 4
    s_bfe_u32 s38, s37, 0x30000
    s_lshl_b32 s38, s38, 8
    s_add_u32 s36, s38, 0
    s_lshr_b32 s38, s32, 4
    s_lshl_b32 s38, s38, 7
    s_add_u32 s36, s38, s36
    s_bfe_u32 s38, s32, 0x20000
    s_lshl_b32 s38, s38, 5
    s_add_u32 s36, s38, s36
    s_bfe_u32 s38, s32, 0x20002
    s_lshl_b32 s38, s38, 3
    s_add_u32 s36, s38, s36
    v_bfe_u32 v5, v1, 0, 2
    v_lshlrev_b32 v33, 11, v5
    v_lshl_add_u32 v33, v2, 1, v33
    v_add_u32 v33, s36, v33
    v_and_b32 v5, 31, v1
    v_lshlrev_b32 v34, 4, v5
    s_mul_i32 s38, s34, 320
    s_add_u32 s38, s38, 135168
    v_lshl_add_u32 v35, v5, 3, s38
    s_bfe_u32 s38, s34, 0x10000
    s_lshl_b32 s38, s38, 12
    s_add_u32 s36, s38, s71
    s_lshr_b32 s38, s34, 1
    s_lshl_b32 s38, s38, 24
    s_add_u32 s36, s38, s36
    s_bitcmp1_b32 s90, 2
    s_cselect_b32 s46, s46, s36
    s_cselect_b64 vcc, -1, 0
    v_cndmask_b32 v54, v32, v34, vcc
    s_bfe_u32 s38, s2, 0x30000
    s_lshl_b32 s38, s38, 8
    s_add_u32 s69, s38, 32768
    v_lshrrev_b32 v64, 2, v34
    buffer_load_dword v64, v64, s[48:51], s69 offen sc1
    v_bfe_u32 v5, v3, 0, 2
    v_lshlrev_b32 v81, 10, v5
    v_lshrrev_b32 v5, 2, v3
    v_lshl_add_u32 v81, v5, 8, v81
    v_add3_u32 v82, v81, v6, s85
    v_xor_b32 v83, 64, v82
    v_xor_b32 v84, 128, v82
    v_xor_b32 v85, 192, v82
    v_bfe_u32 v5, v3, 0, 2
    v_lshlrev_b32 v94, 9, v5
    v_lshl_add_u32 v94, v2, 4, v94
    v_add_u32 v94, s85, v94
    s_lshl_b32 s38, s34, 9
    s_add_u32 s38, s38, 131072
    v_add_u32 v102, s38, v34
    s_lshl_b32 s38, s32, 14
    s_add_u32 s36, s38, 2097152
    s_lshl_b32 s38, s34, 8
    s_add_u32 s36, s38, s36
    s_lshl_b32 s38, s32, 3
    s_add_u32 s37, s38, 163840
    s_lshl_b32 s38, s32, 8
    s_add_u32 s69, s38, 131072
    s_lshl_b32 s38, s34, 23
    s_add_u32 s69, s38, s69
    v_mov_b32 v4, s69
    v_mov_b32 v5, s68
    s_waitcnt vmcnt(1)
    s_barrier
    s_mov_b64 exec, 1
    buffer_store_dword v5, v4, s[48:51], 0 offen sc1
    s_mov_b64 exec, -1
    s_mov_b32 s86, 131072
    buffer_load_dword v7, v101, s[48:51], s86 offen sc1
    s_waitcnt vmcnt(0)
L_fcheck_47:
    v_cmp_ne_u32 vcc, s68, v7
    s_cbranch_vccz L_fok_48
    s_sleep 2
    s_mov_b32 s86, 131072
    buffer_load_dword v7, v101, s[48:51], s86 offen sc1
    s_waitcnt vmcnt(0)
    s_sub_u32 s84, s84, 1
    s_cmp_lg_u32 s84, 0
    s_cbranch_scc1 L_fcheck_47
    s_branch L_end
L_fok_48:
    buffer_load_dwordx2 v[52:53], v81, s[48:51], s37 offen sc1
    buffer_load_dwordx4 v[200:203], v9, s[48:51], s36 offen sc1
    s_add_u32 s36, s36, 4096
    buffer_load_dwordx4 v[204:207], v9, s[48:51], s36 offen sc1
    s_add_u32 s36, s36, 4096
    buffer_load_dwordx4 v[208:211], v9, s[48:51], s36 offen sc1
    s_add_u32 s36, s36, 4096
    buffer_load_dwordx4 v[212:215], v9, s[48:51], s36 offen sc1
    s_waitcnt vmcnt(4)
    v_max_f32_dpp v4, v52, v52 row_ror:8 row_mask:0xf bank_mask:0xf
    s_nop 1
    v_max_f32_dpp v4, v4, v4 row_ror:4 row_mask:0xf bank_mask:0xf
    v_sub_f32 v52, v52, v4
    v_exp_f32 v52, v52
    s_nop 0
    v_mul_f32 v5, v52, v53
    s_nop 1
    v_add_f32_dpp v5, v5, v5 row_ror:8 row_mask:0xf bank_mask:0xf
    s_nop 1
    v_add_f32_dpp v5, v5, v5 row_ror:4 row_mask:0xf bank_mask:0xf
    v_rcp_f32 v5, v5
    s_nop 0
    v_mul_f32 v52, v52, v5
    s_waitcnt vmcnt(3)
    ds_write_b128 v96, v[200:203] offset:0
    s_waitcnt vmcnt(2)
    ds_write_b128 v97, v[204:207] offset:1024
    s_waitcnt vmcnt(1)
    ds_write_b128 v98, v[208:211] offset:2048
    s_waitcnt vmcnt(0)
    ds_write_b128 v99, v[212:215] offset:3072
    s_waitcnt lgkmcnt(0)
    ds_read_b128 v[136:139], v82
    ds_read_b128 v[140:143], v83
    ds_read_b128 v[144:147], v84
    ds_read_b128 v[148:151], v85
    s_waitcnt lgkmcnt(0)
    v_mfma_f32_16x16x32_bf16 v[104:107], a[128:131], v[136:139], 0
    v_mfma_f32_16x16x32_bf16 v[104:107], a[132:135], v[140:143], v[104:107]
    v_mfma_f32_16x16x32_bf16 v[104:107], a[136:139], v[144:147], v[104:107]
    v_mfma_f32_16x16x32_bf16 v[104:107], a[140:143], v[148:151], v[104:107]
    v_mfma_f32_16x16x32_bf16 v[108:111], a[144:147], v[136:139], 0
    v_mfma_f32_16x16x32_bf16 v[108:111], a[148:151], v[140:143], v[108:111]
    v_mfma_f32_16x16x32_bf16 v[108:111], a[152:155], v[144:147], v[108:111]
    v_mfma_f32_16x16x32_bf16 v[108:111], a[156:159], v[148:151], v[108:111]
    v_mfma_f32_16x16x32_bf16 v[112:115], a[160:163], v[136:139], 0
    v_mfma_f32_16x16x32_bf16 v[112:115], a[164:167], v[140:143], v[112:115]
    v_mfma_f32_16x16x32_bf16 v[112:115], a[168:171], v[144:147], v[112:115]
    v_mfma_f32_16x16x32_bf16 v[112:115], a[172:175], v[148:151], v[112:115]
    v_mul_f32 v104, v104, v52
    v_mul_f32 v105, v105, v52
    v_mul_f32 v106, v106, v52
    v_mul_f32 v107, v107, v52
    v_add_f32_dpp v104, v104, v104 row_ror:8 row_mask:0xf bank_mask:0xf
    v_add_f32_dpp v105, v105, v105 row_ror:8 row_mask:0xf bank_mask:0xf
    v_add_f32_dpp v106, v106, v106 row_ror:8 row_mask:0xf bank_mask:0xf
    v_add_f32_dpp v107, v107, v107 row_ror:8 row_mask:0xf bank_mask:0xf
    v_add_f32_dpp v104, v104, v104 row_ror:4 row_mask:0xf bank_mask:0xf
    v_add_f32_dpp v105, v105, v105 row_ror:4 row_mask:0xf bank_mask:0xf
    v_add_f32_dpp v106, v106, v106 row_ror:4 row_mask:0xf bank_mask:0xf
    v_add_f32_dpp v107, v107, v107 row_ror:4 row_mask:0xf bank_mask:0xf
    ds_write_b128 v94, v[104:107] offset:0
    v_mfma_f32_16x16x32_bf16 v[116:119], a[176:179], v[136:139], 0
    v_mfma_f32_16x16x32_bf16 v[116:119], a[180:183], v[140:143], v[116:119]
    v_mfma_f32_16x16x32_bf16 v[116:119], a[184:187], v[144:147], v[116:119]
    v_mfma_f32_16x16x32_bf16 v[116:119], a[188:191], v[148:151], v[116:119]
    v_mul_f32 v108, v108, v52
    v_mul_f32 v109, v109, v52
    v_mul_f32 v110, v110, v52
    v_mul_f32 v111, v111, v52
    v_add_f32_dpp v108, v108, v108 row_ror:8 row_mask:0xf bank_mask:0xf
    v_add_f32_dpp v109, v109, v109 row_ror:8 row_mask:0xf bank_mask:0xf
    v_add_f32_dpp v110, v110, v110 row_ror:8 row_mask:0xf bank_mask:0xf
    v_add_f32_dpp v111, v111, v111 row_ror:8 row_mask:0xf bank_mask:0xf
    v_add_f32_dpp v108, v108, v108 row_ror:4 row_mask:0xf bank_mask:0xf
    v_add_f32_dpp v109, v109, v109 row_ror:4 row_mask:0xf bank_mask:0xf
    v_add_f32_dpp v110, v110, v110 row_ror:4 row_mask:0xf bank_mask:0xf
    v_add_f32_dpp v111, v111, v111 row_ror:4 row_mask:0xf bank_mask:0xf
    ds_write_b128 v94, v[108:111] offset:64
    v_mfma_f32_16x16x32_bf16 v[120:123], a[192:195], v[136:139], 0
    v_mfma_f32_16x16x32_bf16 v[120:123], a[196:199], v[140:143], v[120:123]
    v_mfma_f32_16x16x32_bf16 v[120:123], a[200:203], v[144:147], v[120:123]
    v_mfma_f32_16x16x32_bf16 v[120:123], a[204:207], v[148:151], v[120:123]
    v_mul_f32 v112, v112, v52
    v_mul_f32 v113, v113, v52
    v_mul_f32 v114, v114, v52
    v_mul_f32 v115, v115, v52
    v_add_f32_dpp v112, v112, v112 row_ror:8 row_mask:0xf bank_mask:0xf
    v_add_f32_dpp v113, v113, v113 row_ror:8 row_mask:0xf bank_mask:0xf
    v_add_f32_dpp v114, v114, v114 row_ror:8 row_mask:0xf bank_mask:0xf
    v_add_f32_dpp v115, v115, v115 row_ror:8 row_mask:0xf bank_mask:0xf
    v_add_f32_dpp v112, v112, v112 row_ror:4 row_mask:0xf bank_mask:0xf
    v_add_f32_dpp v113, v113, v113 row_ror:4 row_mask:0xf bank_mask:0xf
    v_add_f32_dpp v114, v114, v114 row_ror:4 row_mask:0xf bank_mask:0xf
    v_add_f32_dpp v115, v115, v115 row_ror:4 row_mask:0xf bank_mask:0xf
    ds_write_b128 v94, v[112:115] offset:128
    v_mfma_f32_16x16x32_bf16 v[124:127], a[208:211], v[136:139], 0
    v_mfma_f32_16x16x32_bf16 v[124:127], a[212:215], v[140:143], v[124:127]
    v_mfma_f32_16x16x32_bf16 v[124:127], a[216:219], v[144:147], v[124:127]
    v_mfma_f32_16x16x32_bf16 v[124:127], a[220:223], v[148:151], v[124:127]
    v_mul_f32 v116, v116, v52
    v_mul_f32 v117, v117, v52
    v_mul_f32 v118, v118, v52
    v_mul_f32 v119, v119, v52
    v_add_f32_dpp v116, v116, v116 row_ror:8 row_mask:0xf bank_mask:0xf
    v_add_f32_dpp v117, v117, v117 row_ror:8 row_mask:0xf bank_mask:0xf
    v_add_f32_dpp v118, v118, v118 row_ror:8 row_mask:0xf bank_mask:0xf
    v_add_f32_dpp v119, v119, v119 row_ror:8 row_mask:0xf bank_mask:0xf
    v_add_f32_dpp v116, v116, v116 row_ror:4 row_mask:0xf bank_mask:0xf
    v_add_f32_dpp v117, v117, v117 row_ror:4 row_mask:0xf bank_mask:0xf
    v_add_f32_dpp v118, v118, v118 row_ror:4 row_mask:0xf bank_mask:0xf
    v_add_f32_dpp v119, v119, v119 row_ror:4 row_mask:0xf bank_mask:0xf
    ds_write_b128 v94, v[116:119] offset:192
    v_mfma_f32_16x16x32_bf16 v[128:131], a[224:227], v[136:139], 0
    v_mfma_f32_16x16x32_bf16 v[128:131], a[228:231], v[140:143], v[128:131]
    v_mfma_f32_16x16x32_bf16 v[128:131], a[232:235], v[144:147], v[128:131]
    v_mfma_f32_16x16x32_bf16 v[128:131], a[236:239], v[148:151], v[128:131]
    v_mul_f32 v120, v120, v52
    v_mul_f32 v121, v121, v52
    v_mul_f32 v122, v122, v52
    v_mul_f32 v123, v123, v52
    v_add_f32_dpp v120, v120, v120 row_ror:8 row_mask:0xf bank_mask:0xf
    v_add_f32_dpp v121, v121, v121 row_ror:8 row_mask:0xf bank_mask:0xf
    v_add_f32_dpp v122, v122, v122 row_ror:8 row_mask:0xf bank_mask:0xf
    v_add_f32_dpp v123, v123, v123 row_ror:8 row_mask:0xf bank_mask:0xf
    v_add_f32_dpp v120, v120, v120 row_ror:4 row_mask:0xf bank_mask:0xf
    v_add_f32_dpp v121, v121, v121 row_ror:4 row_mask:0xf bank_mask:0xf
    v_add_f32_dpp v122, v122, v122 row_ror:4 row_mask:0xf bank_mask:0xf
    v_add_f32_dpp v123, v123, v123 row_ror:4 row_mask:0xf bank_mask:0xf
    ds_write_b128 v94, v[120:123] offset:256
    v_mfma_f32_16x16x32_bf16 v[132:135], a[240:243], v[136:139], 0
    v_mfma_f32_16x16x32_bf16 v[132:135], a[244:247], v[140:143], v[132:135]
    v_mfma_f32_16x16x32_bf16 v[132:135], a[248:251], v[144:147], v[132:135]
    v_mfma_f32_16x16x32_bf16 v[132:135], a[252:255], v[148:151], v[132:135]
    v_mul_f32 v124, v124, v52
    v_mul_f32 v125, v125, v52
    v_mul_f32 v126, v126, v52
    v_mul_f32 v127, v127, v52
    v_add_f32_dpp v124, v124, v124 row_ror:8 row_mask:0xf bank_mask:0xf
    v_add_f32_dpp v125, v125, v125 row_ror:8 row_mask:0xf bank_mask:0xf
    v_add_f32_dpp v126, v126, v126 row_ror:8 row_mask:0xf bank_mask:0xf
    v_add_f32_dpp v127, v127, v127 row_ror:8 row_mask:0xf bank_mask:0xf
    v_add_f32_dpp v124, v124, v124 row_ror:4 row_mask:0xf bank_mask:0xf
    v_add_f32_dpp v125, v125, v125 row_ror:4 row_mask:0xf bank_mask:0xf
    v_add_f32_dpp v126, v126, v126 row_ror:4 row_mask:0xf bank_mask:0xf
    v_add_f32_dpp v127, v127, v127 row_ror:4 row_mask:0xf bank_mask:0xf
    ds_write_b128 v94, v[124:127] offset:320
    v_mul_f32 v128, v128, v52
    v_mul_f32 v129, v129, v52
    v_mul_f32 v130, v130, v52
    v_mul_f32 v131, v131, v52
    v_add_f32_dpp v128, v128, v128 row_ror:8 row_mask:0xf bank_mask:0xf
    v_add_f32_dpp v129, v129, v129 row_ror:8 row_mask:0xf bank_mask:0xf
    v_add_f32_dpp v130, v130, v130 row_ror:8 row_mask:0xf bank_mask:0xf
    v_add_f32_dpp v131, v131, v131 row_ror:8 row_mask:0xf bank_mask:0xf
    v_add_f32_dpp v128, v128, v128 row_ror:4 row_mask:0xf bank_mask:0xf
    v_add_f32_dpp v129, v129, v129 row_ror:4 row_mask:0xf bank_mask:0xf
    v_add_f32_dpp v130, v130, v130 row_ror:4 row_mask:0xf bank_mask:0xf
    v_add_f32_dpp v131, v131, v131 row_ror:4 row_mask:0xf bank_mask:0xf
    ds_write_b128 v94, v[128:131] offset:384
    v_mul_f32 v132, v132, v52
    v_mul_f32 v133, v133, v52
    v_mul_f32 v134, v134, v52
    v_mul_f32 v135, v135, v52
    v_add_f32_dpp v132, v132, v132 row_ror:8 row_mask:0xf bank_mask:0xf
    v_add_f32_dpp v133, v133, v133 row_ror:8 row_mask:0xf bank_mask:0xf
    v_add_f32_dpp v134, v134, v134 row_ror:8 row_mask:0xf bank_mask:0xf
    v_add_f32_dpp v135, v135, v135 row_ror:8 row_mask:0xf bank_mask:0xf
    v_add_f32_dpp v132, v132, v132 row_ror:4 row_mask:0xf bank_mask:0xf
    v_add_f32_dpp v133, v133, v133 row_ror:4 row_mask:0xf bank_mask:0xf
    v_add_f32_dpp v134, v134, v134 row_ror:4 row_mask:0xf bank_mask:0xf
    v_add_f32_dpp v135, v135, v135 row_ror:4 row_mask:0xf bank_mask:0xf
    ds_write_b128 v94, v[132:135] offset:448
    s_waitcnt lgkmcnt(0)
    s_barrier
    ds_read_b128 v[136:139], v102 offset:0
    ds_read_b128 v[140:143], v102 offset:8192
    ds_read_b128 v[144:147], v102 offset:16384
    ds_read_b128 v[148:151], v102 offset:24576
    s_waitcnt lgkmcnt(0)
    v_add_f32 v136, v136, v140
    v_add_f32 v144, v144, v148
    v_add_f32 v137, v137, v141
    v_add_f32 v145, v145, v149
    v_add_f32 v138, v138, v142
    v_add_f32 v146, v146, v150
    v_add_f32 v139, v139, v143
    v_add_f32 v147, v147, v151
    v_add_f32 v136, v136, v144
    v_add_f32 v137, v137, v145
    v_add_f32 v138, v138, v146
    v_add_f32 v139, v139, v147
    s_mov_b32 s38, 0xffff0000
    v_cvt_pk_bf16_f32 v136, v136, v136
    v_cvt_pk_bf16_f32 v137, v137, v137
    v_cvt_pk_bf16_f32 v138, v138, v138
    v_cvt_pk_bf16_f32 v139, v139, v139
    v_and_or_b32 v136, v136, s38, v8
    v_and_or_b32 v137, v137, s38, v8
    v_and_or_b32 v138, v138, s38, v8
    v_and_or_b32 v139, v139, s38, v8
    s_lshl_b32 s38, s32, 11
    s_add_u32 s36, s38, 196608
    s_lshl_b32 s38, s34, 9
    s_add_u32 s36, s38, s36
    s_mov_b32 exec_lo, 0xffffffff
    s_mov_b32 exec_hi, 0x0
    buffer_store_dwordx4 v[136:139], v34, s[48:51], s36 offen sc1
    s_mov_b64 exec, -1
    v_xor_b32 v224, s35, v136
    v_xor_b32 v225, s35, v137
    v_xor_b32 v226, s35, v138
    v_xor_b32 v227, s35, v139
    v_lshlrev_b32 v4, 11, v2
    v_bfe_u32 v5, v1, 2, 2
    v_lshl_add_u32 v4, v5, 8, v4
    v_bfe_u32 v5, v1, 2, 2
    v_lshl_add_u32 v4, v5, 6, v4
    v_bfe_u32 v5, v1, 4, 1
    v_lshl_add_u32 v4, v5, 5, v4
    v_bfe_u32 v5, v1, 1, 1
    v_lshl_add_u32 v4, v5, 4, v4
    v_bfe_u32 v5, v1, 0, 1
    v_lshl_add_u32 v4, v5, 3, v4
    s_lshl_b32 s38, s34, 6
    s_add_u32 s38, s38, 98304
    v_xor_b32 v24, s38, v4
    v_xor_b32 v25, 16, v24
    v_xor_b32 v26, 32, v24
    v_xor_b32 v27, 48, v24
    v_and_b32 v4, 3, v3
    v_lshrrev_b32 v5, 2, v3
    v_lshlrev_b32 v6, 4, v2
    v_add_u32 v6, 135168, v6
    s_movk_i32 s36, 320
    v_cmp_eq_u32 vcc, 0, v5
    s_nop 1
    v_cndmask_b32 v28, 4, v4, vcc
    v_mad_u32_u24 v28, v28, s36, v6
    v_cmp_eq_u32 vcc, 1, v5
    s_nop 1
    v_cndmask_b32 v29, 4, v4, vcc
    v_mad_u32_u24 v29, v29, s36, v6
    v_lshlrev_b32 v5, 2, v1
    v_add_u32 v5, 136448, v5
    v_mov_b32 v6, 0
    ds_write_b32 v5, v6
    v_cmp_ne_u32 vcc, s70, v64
    s_nop 0
    s_cmp_eq_u64 vcc, 0
    s_cselect_b32 s70, 1, 0
    s_mov_b32 s3, s34
    v_lshlrev_b32 v4, 2, v2
    v_xor_b32 v4, v4, v3
    v_xor_b32 v5, 0, v4
    v_lshlrev_b32 v5, 4, v5
    v_lshl_add_u32 v20, v2, 10, v5
    v_xor_b32 v5, 1, v4
    v_lshlrev_b32 v5, 4, v5
    v_lshl_add_u32 v21, v2, 10, v5
    v_add_u32 v21, 3072, v21
    v_xor_b32 v5, 2, v4
    v_lshlrev_b32 v5, 4, v5
    v_lshl_add_u32 v22, v2, 10, v5
    v_add_u32 v22, 6144, v22
    v_xor_b32 v5, 3, v4
    v_lshlrev_b32 v5, 4, v5
    v_lshl_add_u32 v23, v2, 10, v5
    v_add_u32 v23, 9216, v23
    s_lshl_b32 s38, s32, 15
    s_add_u32 s47, s38, 1048576
    s_lshl_b32 s38, s3, 13
    s_add_u32 s47, s38, s47
    v_lshlrev_b32 v6, 7, v2
    v_bfe_u32 v5, v3, 0, 3
    v_lshl_add_u32 v6, v5, 4, v6
    v_lshrrev_b32 v4, 3, v3
    v_and_b32 v7, 3, v3
    v_min_u32 v7, 2, v7
    v_lshl_add_u32 v7, v7, 1, v4
    v_add_u32 v5, 0, v4
    v_cmp_le_u32 vcc, s33, v5
    s_nop 1
    v_addc_co_u32 v5, vcc, 0, v5, vcc
    v_lshl_add_u32 v50, v5, 10, v6
    v_add_u32 v5, 2, v4
    v_cmp_le_u32 vcc, s33, v5
    s_nop 1
    v_addc_co_u32 v5, vcc, 0, v5, vcc
    v_lshl_add_u32 v51, v5, 10, v6
    v_add_u32 v5, 4, v4
    v_cmp_le_u32 vcc, s33, v5
    s_nop 1
    v_addc_co_u32 v5, vcc, 0, v5, vcc
    v_lshl_add_u32 v52, v5, 10, v6
    v_mov_b32 v5, v7
    v_mov_b32 v6, 512
    v_cmp_le_u32 vcc, s33, v5
    s_nop 1
    v_addc_co_u32 v5, vcc, 0, v5, vcc
    v_lshl_add_u32 v53, v5, 10, v6
    s_mul_i32 s38, s3, 320
    s_add_u32 s38, s38, 135168
    v_lshlrev_b32 v4, 6, v2
    v_lshl_add_u32 v4, v3, 1, v4
    v_add_u32 v31, s38, v4
    v_lshlrev_b32 v4, 7, v2
    v_lshl_add_u32 v4, v3, 4, v4
    v_mov_b32 v5, 512
    v_cmp_gt_u32 vcc, 8, v3
    s_nop 1
    v_cndmask_b32 v79, v5, v4, vcc
    s_mov_b32 s86, 0x88888888
    s_mov_b32 s87, 0x88888888
    v_mov_b32 v120, 0xff7f0000
    s_lshl_b32 s38, s32, 10
    s_add_u32 s37, s38, 65540
    s_lshr_b32 s38, s32, 3
    s_lshl_b32 s38, s38, 8
    s_add_u32 s37, s38, s37
    s_and_b32 s36, s32, 3
    s_sub_u32 s95, s36, 2
    s_cmp_ge_u32 s36, 2
    s_cselect_b32 s95, s95, 8
    s_cselect_b32 s94, 17, 16
    s_bitcmp1_b32 s90, 2
    s_cselect_b32 s36, 6, 2
    s_add_u32 s36, s36, s94
    v_mov_b32 v5, 0
L_watch:
    buffer_load_dword v6, v5, s[48:51], s37 offen sc1
    s_waitcnt vmcnt(0)
    v_cmp_le_u32 vcc, s36, v6
    s_cbranch_vccnz L_seen
    s_sleep 4
    s_sub_u32 s84, s84, 1
    s_cmp_lg_u32 s84, 0
    s_cbranch_scc1 L_watch
    s_branch L_end
L_seen:
    s_lshl_b32 s39, s34, 13
    s_add_u32 s39, s39, 98304
    s_mov_b32 m0, s39
    s_nop 0
    buffer_load_dwordx4 v20, s[40:43], s44 offen offset:0 nt lds
    buffer_load_dwordx4 v21, s[40:43], s44 offen offset:1024 nt lds
    buffer_load_dwordx4 v22, s[40:43], s44 offen offset:2048 nt lds
    buffer_load_dwordx4 v23, s[40:43], s44 offen offset:3072 nt lds
    s_lshl_b32 s39, s34, 13
    s_add_u32 s39, s39, 102400
    s_mov_b32 m0, s39
    s_add_u32 s44, s44, 16384
    buffer_load_dwordx4 v20, s[40:43], s44 offen offset:0 nt lds
    buffer_load_dwordx4 v21, s[40:43], s44 offen offset:1024 nt lds
    buffer_load_dwordx4 v22, s[40:43], s44 offen offset:2048 nt lds
    buffer_load_dwordx4 v23, s[40:43], s44 offen offset:3072 nt lds
    s_bitcmp1_b32 s90, 2
    s_cbranch_scc1 L_ctxok
    buffer_load_dwordx4 v[224:227], v54, s[48:51], s46 offen sc1
    s_add_u32 s37, s47, 6144
L_auxpoll:
    buffer_load_dwordx4 v[204:207], v53, s[48:51], s47 offen sc1
    buffer_load_dwordx4 v[192:195], v50, s[48:51], s47 offen sc1
    buffer_load_dwordx4 v[196:199], v51, s[48:51], s47 offen sc1
    buffer_load_dwordx4 v[200:203], v52, s[48:51], s47 offen sc1
    buffer_load_dwordx4 v[104:107], v79, s[48:51], s37 offen sc1
    s_waitcnt vmcnt(0)
    v_xor_b32 v104, s35, v104
    v_xor_b32 v105, s35, v105
    v_xor_b32 v106, s35, v106
    v_xor_b32 v107, s35, v107
    v_xor_b32 v192, s35, v192
    v_xor_b32 v193, s35, v193
    v_xor_b32 v194, s35, v194
    v_xor_b32 v195, s35, v195
    v_xor_b32 v196, s35, v196
    v_xor_b32 v197, s35, v197
    v_xor_b32 v198, s35, v198
    v_xor_b32 v199, s35, v199
    v_xor_b32 v200, s35, v200
    v_xor_b32 v201, s35, v201
    v_xor_b32 v202, s35, v202
    v_xor_b32 v203, s35, v203
    v_xor_b32 v204, s35, v204
    v_xor_b32 v205, s35, v205
    v_xor_b32 v206, s35, v206
    v_xor_b32 v207, s35, v207
    v_or_b32 v4, v104, v105
    v_or3_b32 v4, v4, v106, v107
    v_or3_b32 v4, v4, v192, v193
    v_or3_b32 v4, v4, v194, v195
    v_or3_b32 v4, v4, v196, v197
    v_or3_b32 v4, v4, v198, v199
    v_or3_b32 v4, v4, v200, v201
    v_or3_b32 v4, v4, v202, v203
    v_or3_b32 v4, v4, v204, v205
    v_or3_b32 v4, v4, v206, v207
    v_and_b32 v4, 0xff, v4
    v_cmp_ne_u32 vcc, 0, v4
    v_add_f32 v123, v104, v106
    v_add_f32 v122, v204, v206
    v_mov_b32_dpp v121, v105 row_newbcast:8 row_mask:0xf bank_mask:0xf
    v_mov_b32_dpp v120, v123 row_newbcast:8 row_mask:0xf bank_mask:0x3
    s_cbranch_vccz L_hop1ok
    s_sub_u32 s84, s84, 1
    s_cmp_lg_u32 s84, 0
    s_cbranch_scc1 L_auxpoll
    s_branch L_end
.section .rodata,"a"
.p2align 6
.amdhsa_kernel concat_heads__compressed_kv_cla__mha_block_cached__decode_kernel
  .amdhsa_next_free_vgpr 512
  .amdhsa_next_free_sgpr 102
  .amdhsa_accum_offset 256
  .amdhsa_group_segment_fixed_size 0
  .amdhsa_kernarg_size 112
  .amdhsa_user_sgpr_count 2
  .amdhsa_user_sgpr_kernarg_segment_ptr 1
  .amdhsa_system_sgpr_workgroup_id_x 1
.end_amdhsa_kernel
```
